```python
import torch

def _softmax(x, axis=-1):
    return torch.softmax(x, dim=axis)
def _gelu(x):
    return torch.nn.functional.gelu(x, approximate="tanh")
def _silu(x):
    return torch.nn.functional.silu(x)
def _sigmoid(x):
    return torch.sigmoid(x)
def _layernorm(x, axis=-1, eps=1e-5):
    m = x.mean(dim=axis, keepdim=True)
    v = x.var(dim=axis, keepdim=True, unbiased=False)
    return (x - m) / torch.sqrt(v + eps)
def _scatter_add(tgt, idx, src, axis=0):
    return tgt.clone().index_add_(axis, idx, src)
def _segment_sum(src, seg, n):
    out = torch.zeros((n,) + src.shape[1:], dtype=src.dtype)
    return out.index_add_(0, seg, src)
def _pad(x, pw):
    flat = tuple(v for pair in reversed(pw) for v in pair)
    return torch.nn.functional.pad(x, flat)

kernel_name = 'gated_mix__compressed_kv_cla__linear_attn_block__prompt'

def setup_inputs():

    _w = (lambda a: (lambda t: t.to(torch.bfloat16) if t.is_floating_point() else t)(torch.as_tensor(a)))
    def _A_setup():
        B, H, Sq, Sk, D, M = 1, 32, 2048, 2048, 128, 512
        Dc = 4 * D
        return {
            "x": _w((lambda *s: torch.randn(*s, dtype=torch.bfloat16) * 0.05)(B, Sq, M)),
            "c_kv": _w((lambda *s: torch.randn(*s, dtype=torch.bfloat16) * 1.6)(B, Sk, Dc)),
            "w_q": _w((lambda *s: torch.randn(*s, dtype=torch.bfloat16) * 3.2)(M, H, D) * (M ** -0.5)),
            "w_uk": _w((lambda *s: torch.randn(*s, dtype=torch.bfloat16) * 3.2)(Dc, H, D) * (Dc ** -0.5)),
            "w_uv": _w((lambda *s: torch.randn(*s, dtype=torch.bfloat16) * 1.6)(Dc, H, D) * (Dc ** -0.5)),
            "w_o": _w((lambda *s: torch.randn(*s, dtype=torch.bfloat16) * 1.6)(H, D, M) * ((H * D) ** -0.5)),
        }
    _A_in = _A_setup()

    def _B_setup():
        B, S, D = 1, 2048, 512
        return {
            "x": _w((lambda *s: torch.randn(*s, dtype=torch.bfloat16) * 0.05)(B, S, D)),
            "wqkv": _w((lambda *s: torch.randn(*s, dtype=torch.bfloat16) * 3.2)(D, 3 * D)),
            "wo": _w((lambda *s: torch.randn(*s, dtype=torch.bfloat16) * 0.4)(D, D)),
        }
    _B_in = _B_setup()

    return {
        "A_x": _A_in["x"],
        "A_c_kv": _A_in["c_kv"],
        "A_w_q": _A_in["w_q"],
        "A_w_uk": _A_in["w_uk"],
        "A_w_uv": _A_in["w_uv"],
        "A_w_o": _A_in["w_o"],
        "B_x": _B_in["x"],
        "B_wqkv": _B_in["wqkv"],
        "B_wo": _B_in["wo"],
        "gate_w": _w((lambda *s: torch.randn(*s, dtype=torch.bfloat16) * 0.05)(512) * 16.0),
    }

def reference(A_x, A_c_kv, A_w_q, A_w_uk, A_w_uv, A_w_o, B_x, B_wqkv, B_wo, gate_w):
    def _A_ref(x, c_kv, w_q, w_uk, w_uv, w_o):
        B, Sq, M = x.shape[0], x.shape[1], x.shape[2]
        Sk = c_kv.shape[1]
        H, D = w_q.shape[1], w_q.shape[2]
        q = torch.einsum("bqm,mhd->bhqd", x, w_q)
        k = torch.einsum("bkc,chd->bhkd", c_kv, w_uk)
        v = torch.einsum("bkc,chd->bhkd", c_kv, w_uv)
        scores = torch.einsum("bhqd,bhkd->bhqk", q, k) * (D ** -0.5)
        off = Sk - Sq
        qi = torch.arange(Sq)[:, None]
        kj = torch.arange(Sk)[None, :]
        cmask = kj <= (qi + off)
        scores = torch.where(cmask[None, None], scores, -1e9)
        p = _softmax(scores, axis=-1)
        ctx = torch.einsum("bhqk,bhkd->bhqd", p, v)
        return torch.einsum("bhqd,hdm->bqm", ctx, w_o)

    def _B_ref(x, wqkv, wo):
        B, S, D = x.shape
        H = 32; Dh = D // H
        qkv = (lambda x, *d: x.permute(*d))((x @ wqkv).reshape(B, S, 3, H, Dh), 2, 0, 3, 1, 4)
        q, k, v = qkv[0], qkv[1], qkv[2]
        phi = lambda t: torch.where(t > 0, t + 1, torch.exp(t)) + 1e-6
        pq, pk = phi(q), phi(k)
        kv = torch.einsum("bhsd,bhse->bhde", pk, v)
        z = torch.einsum("bhsd->bhd", pk)
        num = torch.einsum("bhqd,bhde->bhqe", pq, kv)
        den = torch.einsum("bhqd,bhd->bhq", pq, z)[..., None] + 1e-6
        o = num / den
        return (lambda x, *d: x.permute(*d))(o, 0, 2, 1, 3).reshape(B, S, D) @ wo

    x = A_x
    g = _sigmoid((x * gate_w).sum(-1, keepdims=True))
    a = _A_ref(x, A_c_kv, A_w_q, A_w_uk, A_w_uv, A_w_o)
    b = _B_ref(x, B_wqkv, B_wo)
    return g * a + (1 - g) * b
```

```asm
; @launch kernel=fused_kernel grid=(256,1,1) block=(512,1,1) lds=163840
.amdgcn_target "amdgcn-amd-amdhsa--gfx950"
.text
.p2align 8
.globl fused_kernel
.type fused_kernel,@function
fused_kernel:
s_cmp_lt_u32 s2,256
s_cbranch_scc1 L_k1_go
s_endpgm
L_k1_go:
s_mov_b32 s3,s2
s_mov_b32 s98,s2
s_mov_b32 s99,s2
s_mov_b32 s101,0
s_mov_b32 s96,0
v_mov_b32 v14,0
L_k1_entry:
s_load_dwordx2 s[92:93],s[0:1],88
s_mov_b32 s94,256
s_mov_b32 s95,0x20000
s_load_dwordx16 s[4:19],s[0:1],0
s_load_dwordx8 s[20:27],s[0:1],64
s_load_dwordx2 s[28:29],s[0:1],96
v_and_b32 v1,63,v0
v_lshrrev_b32 v24,6,v0
s_lshr_b32 s48,s3,5
v_readfirstlane_b32 s50,v24
s_getpc_b64 s[30:31]
L_cp1:
s_sub_u32 s30,s30,L_cp1-fused_kernel
s_subb_u32 s31,s31,0
s_lshr_b32 s88,s2,3
s_lshl_b32 s88,s88,3
s_add_u32 s88,s88,s50
s_mul_i32 s88,s88,512
v_min_u32 v22,7,v1
v_lshlrev_b32 v22,6,v22
v_add_u32 v22,s88,v22
v_min_u32 v22,L_code_end-fused_kernel-4,v22
global_load_dword v191,v22,s[30:31]
s_and_b32 s49,s3,7
s_lshl_b32 s49,s49,2
s_bfe_u32 s53,s3,0x20003
s_add_u32 s49,s49,s53
s_mul_i32 s68,s53,0
s_lshr_b32 s54,s48,0
s_mul_i32 s54,s54,1
s_add_u32 s68,s68,s54
s_and_b32 s68,s68,7
v_lshrrev_b32 v24,3,v1
v_and_b32 v25,7,v1
v_bfe_u32 v26,v1,4,1
v_lshlrev_b32 v26,2,v26
v_xor_b32 v25,v25,v26
v_lshlrev_b32 v26,4,v25
v_lshrrev_b32 v27,2,v25
v_lshrrev_b32 v28,2,v1
v_and_b32 v29,3,v1
v_bfe_u32 v30,v1,4,2
v_xor_b32 v29,v29,v30
v_lshlrev_b32 v29,4,v29
v_lshl_add_u32 v3,v28,10,v29
s_lshl_b32 s53,s48,3
s_add_u32 s53,s53,s50
s_lshl_b32 s55,s53,15
s_lshl_b32 s58,s50,13
s_lshl_b32 s59,s50,12
s_lshl_b32 s60,s50,10
s_mov_b32 s34,2097152
s_mov_b32 s35,0x20000
s_mov_b32 s39,0x20000
s_mov_b32 s42,268435456
s_mov_b32 s43,0x20000
s_mov_b32 s47,0x20000
s_mov_b32 s52,5

s_cmp_ge_u32 s49,28
s_cbranch_scc1 L_k1_p_bkv
s_cmp_ge_u32 s49,26
s_cbranch_scc1 L_k1_p_bq
s_cmp_eq_u32 s49,25
s_cbranch_scc1 L_k1_p_v4
s_cmp_ge_u32 s49,13
s_cbranch_scc1 L_k1_p_v5
L_k1_p_k5:
s_and_b32 s53,s50,1
s_lshl_b32 s53,s53,4
v_xor_b32 v26,s53,v26
s_mov_b32 s38,4194304
s_sub_u32 s53,s49,0
s_mul_i32 s51,s53,5
s_min_u32 s51,s51,59
s_mul_i32 s54,s51,128
s_add_u32 s54,s54,0
s_mul_i32 s56,s50,65536
s_add_u32 s56,s56,s54
v_mul_u32_u24 v2,8192,v24
v_add_u32 v2,v2,v26
s_mov_b32 s52,5
s_waitcnt lgkmcnt(0)
s_mov_b64 s[32:33],s[6:7]
s_mov_b64 s[36:37],s[10:11]
s_mov_b64 s[40:41],s[28:29]
s_add_u32 s53,s68,0
s_and_b32 s53,s53,7
s_mul_i32 s72,s53,524288
s_add_u32 s72,s72,s56
s_lshl_b32 s53,s53,7
s_add_u32 s80,s55,s53
s_add_u32 m0,s60,65536
s_add_u32 s53,s72,0
buffer_load_dwordx4 v2,s[36:39],s53 offen lds
s_add_u32 m0,s58,0
s_add_u32 s53,s80,0
buffer_load_dwordx4 v3,s[32:35],s53 offen lds
s_add_u32 m0,s58,1024
s_add_u32 s53,s80,16384
buffer_load_dwordx4 v3,s[32:35],s53 offen lds
s_add_u32 m0,s58,2048
s_add_u32 s53,s80,64
buffer_load_dwordx4 v3,s[32:35],s53 offen lds
s_add_u32 m0,s58,3072
s_add_u32 s53,s80,16448
buffer_load_dwordx4 v3,s[32:35],s53 offen lds
s_add_u32 m0,s60,73728
s_add_u32 s53,s72,128
buffer_load_dwordx4 v2,s[36:39],s53 offen lds
s_add_u32 s53,s68,1
s_and_b32 s53,s53,7
s_mul_i32 s73,s53,524288
s_add_u32 s73,s73,s56
s_lshl_b32 s53,s53,7
s_add_u32 s81,s55,s53
s_add_u32 m0,s60,81920
s_add_u32 s53,s72,256
buffer_load_dwordx4 v2,s[36:39],s53 offen lds
v_lshrrev_b32 v66,4,v1
v_bfe_u32 v65,v1,2,2
v_lshl_add_u32 v64,v66,3,v65
v_lshlrev_b32 v64,7,v64
v_xor_b32 v66,v65,v66
v_bfe_u32 v65,v1,3,1
v_lshl_add_u32 v64,v65,6,v64
v_bfe_u32 v65,v1,4,1
v_lshl_add_u32 v64,v65,4,v64
v_bfe_u32 v65,v1,1,1
v_lshl_add_u32 v64,v65,5,v64
v_and_b32 v65,1,v1
v_lshl_add_u32 v64,v65,3,v64
v_add_u32 v5,65536,v64
v_xor_b32 v6,16,v5
v_xor_b32 v7,64,v5
v_xor_b32 v8,64,v6
v_and_b32 v64,15,v1
v_lshlrev_b32 v66,4,v66
v_lshl_add_u32 v64,v64,6,v66
v_add_u32 v9,s58,v64
s_lshr_b32 s54,s55,16
s_lshl_b32 s54,s54,15
s_bfe_u32 s57,s55,0x1000f
s_lshl_b32 s57,s57,13
s_add_u32 s54,s54,s57
v_lshrrev_b32 v4,4,v1
v_and_b32 v64,15,v1
v_lshlrev_b32 v64,4,v64
v_lshl_add_u32 v4,v4,9,v64
v_add_u32 v4,s54,v4
s_mov_b32 s61,0x3fb8aa3b
s_mov_b32 s71,0x3e0293ee
s_mov_b32 s62,0x358637bd
s_add_u32 m0,s60,90112
s_add_u32 s53,s72,384
buffer_load_dwordx4 v2,s[36:39],s53 offen lds
s_add_u32 m0,s58,4096
s_add_u32 s53,s81,0
buffer_load_dwordx4 v3,s[32:35],s53 offen lds
s_add_u32 m0,s58,5120
s_add_u32 s53,s81,16384
buffer_load_dwordx4 v3,s[32:35],s53 offen lds
s_add_u32 m0,s60,98304
s_add_u32 s53,s72,512
buffer_load_dwordx4 v2,s[36:39],s53 offen lds
s_add_u32 m0,s60,106496
s_add_u32 s53,s73,0
buffer_load_dwordx4 v2,s[36:39],s53 offen lds
s_add_u32 m0,s58,6144
s_add_u32 s53,s81,64
buffer_load_dwordx4 v3,s[32:35],s53 offen lds
s_add_u32 m0,s58,7168
s_add_u32 s53,s81,16448
buffer_load_dwordx4 v3,s[32:35],s53 offen lds
s_add_u32 m0,s60,114688
s_add_u32 s53,s73,128
buffer_load_dwordx4 v2,s[36:39],s53 offen lds
s_add_u32 m0,s60,122880
s_add_u32 s53,s73,256
buffer_load_dwordx4 v2,s[36:39],s53 offen lds
s_add_u32 s53,s68,2
s_and_b32 s53,s53,7
s_mul_i32 s74,s53,524288
s_add_u32 s74,s74,s56
s_lshl_b32 s53,s53,7
s_add_u32 s82,s55,s53
s_add_u32 s53,s68,3
s_and_b32 s53,s53,7
s_mul_i32 s75,s53,524288
s_add_u32 s75,s75,s56
s_lshl_b32 s53,s53,7
s_add_u32 s83,s55,s53
s_add_u32 s53,s68,4
s_and_b32 s53,s53,7
s_mul_i32 s76,s53,524288
s_add_u32 s76,s76,s56
s_lshl_b32 s53,s53,7
s_add_u32 s84,s55,s53
s_add_u32 s53,s68,5
s_and_b32 s53,s53,7
s_mul_i32 s77,s53,524288
s_add_u32 s77,s77,s56
s_lshl_b32 s53,s53,7
s_add_u32 s85,s55,s53
s_add_u32 s53,s68,6
s_and_b32 s53,s53,7
s_mul_i32 s78,s53,524288
s_add_u32 s78,s78,s56
s_lshl_b32 s53,s53,7
s_add_u32 s86,s55,s53
s_add_u32 s53,s68,7
s_and_b32 s53,s53,7
s_mul_i32 s79,s53,524288
s_add_u32 s79,s79,s56
s_lshl_b32 s53,s53,7
s_add_u32 s87,s55,s53
s_mov_b32 s16,s50
s_and_b32 s26,s98,7
s_lshr_b32 s27,s98,3
s_and_b32 s17,s27,3
s_lshl_b32 s26,s26,2
s_add_u32 s17,s17,s26
s_lshr_b32 s18,s27,2
s_lshl_b32 s26,s18,2
s_add_u32 s19,s26,s16
s_sub_u32 s27,67,s19
s_cmp_lt_u32 s16,4
s_cselect_b32 s19,s19,s27
s_cselect_b32 s28,1,0
s_waitcnt vmcnt(13)
ds_read_b128 v[80:83],v9 offset:0
ds_read_b128 v[84:87],v9 offset:1024
s_waitcnt vmcnt(11)
ds_read_b128 v[88:91],v9 offset:2048
ds_read_b128 v[92:95],v9 offset:3072
s_waitcnt vmcnt(9)
s_barrier
ds_read_b64_tr_b16 v[40:41],v5 offset:0
ds_read_b64_tr_b16 v[42:43],v5 offset:512
ds_read_b64_tr_b16 v[44:45],v6 offset:0
ds_read_b64_tr_b16 v[46:47],v6 offset:512
ds_read_b64_tr_b16 v[64:65],v7 offset:0
ds_read_b64_tr_b16 v[66:67],v7 offset:512
ds_read_b64_tr_b16 v[68:69],v8 offset:0
ds_read_b64_tr_b16 v[70:71],v8 offset:512
ds_read_b64_tr_b16 v[72:73],v5 offset:4096
ds_read_b64_tr_b16 v[74:75],v5 offset:4608
s_setprio 3
s_waitcnt lgkmcnt(8)
v_mfma_f32_16x16x32_bf16 v[128:131],v[40:43],v[80:83],0
s_add_u32 m0,s60,131072
s_add_u32 s53,s73,384
buffer_load_dwordx4 v2,s[36:39],s53 offen lds
ds_read_b64_tr_b16 v[76:77],v6 offset:4096
ds_read_b64_tr_b16 v[78:79],v6 offset:4608
v_mfma_f32_16x16x32_bf16 v[136:139],v[40:43],v[84:87],0
s_add_u32 m0,s58,0
s_add_u32 s53,s82,0
buffer_load_dwordx4 v3,s[32:35],s53 offen lds
s_waitcnt lgkmcnt(8)
v_mfma_f32_16x16x32_bf16 v[140:143],v[44:47],v[84:87],0
s_add_u32 m0,s60,139264
s_add_u32 s53,s73,512
buffer_load_dwordx4 v2,s[36:39],s53 offen lds
v_mfma_f32_16x16x32_bf16 v[132:135],v[44:47],v[80:83],0
s_add_u32 m0,s58,1024
s_add_u32 s53,s82,16384
buffer_load_dwordx4 v3,s[32:35],s53 offen lds
ds_read_b64_tr_b16 v[40:41],v7 offset:4096
ds_read_b64_tr_b16 v[42:43],v7 offset:4608
s_waitcnt lgkmcnt(8)
v_mfma_f32_16x16x32_bf16 v[144:147],v[64:67],v[80:83],0
ds_read_b64_tr_b16 v[44:45],v8 offset:4096
ds_read_b64_tr_b16 v[46:47],v8 offset:4608
v_mfma_f32_16x16x32_bf16 v[152:155],v[64:67],v[84:87],0
s_add_u32 m0,s58,2048
s_add_u32 s53,s82,64
buffer_load_dwordx4 v3,s[32:35],s53 offen lds
s_waitcnt lgkmcnt(8)
v_mfma_f32_16x16x32_bf16 v[156:159],v[68:71],v[84:87],0
s_add_u32 m0,s60,147456
s_add_u32 s53,s74,0
buffer_load_dwordx4 v2,s[36:39],s53 offen lds
v_mfma_f32_16x16x32_bf16 v[148:151],v[68:71],v[80:83],0
s_add_u32 m0,s58,3072
s_add_u32 s53,s82,16448
buffer_load_dwordx4 v3,s[32:35],s53 offen lds
ds_read_b64_tr_b16 v[64:65],v5 offset:8192
ds_read_b64_tr_b16 v[66:67],v5 offset:8704
s_setprio 2
s_waitcnt lgkmcnt(8)
v_mfma_f32_16x16x32_bf16 v[128:131],v[72:75],v[88:91],v[128:131]
ds_read_b64_tr_b16 v[68:69],v6 offset:8192
ds_read_b64_tr_b16 v[70:71],v6 offset:8704
v_mfma_f32_16x16x32_bf16 v[136:139],v[72:75],v[92:95],v[136:139]
s_add_u32 m0,s60,155648
s_add_u32 s53,s74,128
buffer_load_dwordx4 v2,s[36:39],s53 offen lds
s_waitcnt lgkmcnt(8)
v_mfma_f32_16x16x32_bf16 v[140:143],v[76:79],v[92:95],v[140:143]
v_mfma_f32_16x16x32_bf16 v[132:135],v[76:79],v[88:91],v[132:135]
ds_read_b64_tr_b16 v[72:73],v7 offset:8192
ds_read_b64_tr_b16 v[74:75],v7 offset:8704
s_waitcnt lgkmcnt(8)
v_mfma_f32_16x16x32_bf16 v[144:147],v[40:43],v[88:91],v[144:147]
ds_read_b64_tr_b16 v[76:77],v8 offset:8192
ds_read_b64_tr_b16 v[78:79],v8 offset:8704
v_mfma_f32_16x16x32_bf16 v[152:155],v[40:43],v[92:95],v[152:155]
s_waitcnt lgkmcnt(8)
v_mfma_f32_16x16x32_bf16 v[156:159],v[44:47],v[92:95],v[156:159]
v_mfma_f32_16x16x32_bf16 v[148:151],v[44:47],v[88:91],v[148:151]
ds_read_b64_tr_b16 v[40:41],v5 offset:12288
ds_read_b64_tr_b16 v[42:43],v5 offset:12800
s_setprio 1
s_waitcnt lgkmcnt(8)
v_mfma_f32_16x16x32_bf16 v[24:27],v[64:67],v[80:83],0
ds_read_b64_tr_b16 v[44:45],v6 offset:12288
ds_read_b64_tr_b16 v[46:47],v6 offset:12800
v_mfma_f32_16x16x32_bf16 v[32:35],v[64:67],v[84:87],0
s_waitcnt lgkmcnt(8)
v_mfma_f32_16x16x32_bf16 v[36:39],v[68:71],v[84:87],0
v_mfma_f32_16x16x32_bf16 v[28:31],v[68:71],v[80:83],0
ds_read_b64_tr_b16 v[64:65],v7 offset:12288
ds_read_b64_tr_b16 v[66:67],v7 offset:12800
s_waitcnt lgkmcnt(8)
v_mfma_f32_16x16x32_bf16 v[48:51],v[72:75],v[80:83],0
ds_read_b64_tr_b16 v[68:69],v8 offset:12288
ds_read_b64_tr_b16 v[70:71],v8 offset:12800
v_mfma_f32_16x16x32_bf16 v[56:59],v[72:75],v[84:87],0
s_waitcnt lgkmcnt(8)
v_mfma_f32_16x16x32_bf16 v[60:63],v[76:79],v[84:87],0
v_mfma_f32_16x16x32_bf16 v[52:55],v[76:79],v[80:83],0
ds_read_b64_tr_b16 v[72:73],v5 offset:16384
ds_read_b64_tr_b16 v[74:75],v5 offset:16896
s_setprio 0
s_waitcnt lgkmcnt(8)
v_mfma_f32_16x16x32_bf16 v[24:27],v[40:43],v[88:91],v[24:27]
ds_read_b64_tr_b16 v[76:77],v6 offset:16384
ds_read_b64_tr_b16 v[78:79],v6 offset:16896
v_mfma_f32_16x16x32_bf16 v[32:35],v[40:43],v[92:95],v[32:35]
s_waitcnt lgkmcnt(8)
v_mfma_f32_16x16x32_bf16 v[36:39],v[44:47],v[92:95],v[36:39]
v_mfma_f32_16x16x32_bf16 v[28:31],v[44:47],v[88:91],v[28:31]
ds_read_b64_tr_b16 v[40:41],v7 offset:16384
ds_read_b64_tr_b16 v[42:43],v7 offset:16896
s_waitcnt lgkmcnt(8)
v_mfma_f32_16x16x32_bf16 v[48:51],v[64:67],v[88:91],v[48:51]
ds_read_b64_tr_b16 v[44:45],v8 offset:16384
ds_read_b64_tr_b16 v[46:47],v8 offset:16896
v_mfma_f32_16x16x32_bf16 v[56:59],v[64:67],v[92:95],v[56:59]
s_waitcnt lgkmcnt(8)
v_mfma_f32_16x16x32_bf16 v[60:63],v[68:71],v[92:95],v[60:63]
v_mfma_f32_16x16x32_bf16 v[52:55],v[68:71],v[88:91],v[52:55]
s_waitcnt vmcnt(12)
s_barrier
ds_read_b64_tr_b16 v[64:65],v5 offset:20480
ds_read_b64_tr_b16 v[66:67],v5 offset:20992
s_setprio 3
s_waitcnt lgkmcnt(8)
v_mfma_f32_16x16x32_bf16 v[160:163],v[72:75],v[80:83],0
ds_read_b64_tr_b16 v[68:69],v6 offset:20480
ds_read_b64_tr_b16 v[70:71],v6 offset:20992
v_mfma_f32_16x16x32_bf16 v[168:171],v[72:75],v[84:87],0
s_add_u32 m0,s60,65536
s_add_u32 s53,s74,256
buffer_load_dwordx4 v2,s[36:39],s53 offen lds
s_waitcnt lgkmcnt(8)
v_mfma_f32_16x16x32_bf16 v[172:175],v[76:79],v[84:87],0
v_mfma_f32_16x16x32_bf16 v[164:167],v[76:79],v[80:83],0
ds_read_b64_tr_b16 v[72:73],v7 offset:20480
ds_read_b64_tr_b16 v[74:75],v7 offset:20992
s_waitcnt lgkmcnt(8)
v_mfma_f32_16x16x32_bf16 v[176:179],v[40:43],v[80:83],0
ds_read_b64_tr_b16 v[76:77],v8 offset:20480
ds_read_b64_tr_b16 v[78:79],v8 offset:20992
v_mfma_f32_16x16x32_bf16 v[184:187],v[40:43],v[84:87],0
s_waitcnt lgkmcnt(8)
v_mfma_f32_16x16x32_bf16 v[188:191],v[44:47],v[84:87],0
v_mfma_f32_16x16x32_bf16 v[180:183],v[44:47],v[80:83],0
ds_read_b64_tr_b16 v[40:41],v5 offset:24576
ds_read_b64_tr_b16 v[42:43],v5 offset:25088
s_waitcnt lgkmcnt(8)
v_mfma_f32_16x16x32_bf16 v[160:163],v[64:67],v[88:91],v[160:163]
ds_read_b64_tr_b16 v[44:45],v6 offset:24576
ds_read_b64_tr_b16 v[46:47],v6 offset:25088
v_mfma_f32_16x16x32_bf16 v[168:171],v[64:67],v[92:95],v[168:171]
s_add_u32 m0,s60,73728
s_add_u32 s53,s74,384
buffer_load_dwordx4 v2,s[36:39],s53 offen lds
s_waitcnt lgkmcnt(8)
v_mfma_f32_16x16x32_bf16 v[172:175],v[68:71],v[92:95],v[172:175]
v_mfma_f32_16x16x32_bf16 v[164:167],v[68:71],v[88:91],v[164:167]
ds_read_b64_tr_b16 v[64:65],v7 offset:24576
ds_read_b64_tr_b16 v[66:67],v7 offset:25088
s_setprio 2
s_waitcnt lgkmcnt(8)
v_mfma_f32_16x16x32_bf16 v[176:179],v[72:75],v[88:91],v[176:179]
ds_read_b64_tr_b16 v[68:69],v8 offset:24576
ds_read_b64_tr_b16 v[70:71],v8 offset:25088
v_mfma_f32_16x16x32_bf16 v[184:187],v[72:75],v[92:95],v[184:187]
s_waitcnt lgkmcnt(8)
v_mfma_f32_16x16x32_bf16 v[188:191],v[76:79],v[92:95],v[188:191]
v_mfma_f32_16x16x32_bf16 v[180:183],v[76:79],v[88:91],v[180:183]
ds_read_b64_tr_b16 v[72:73],v5 offset:28672
ds_read_b64_tr_b16 v[74:75],v5 offset:29184
s_waitcnt lgkmcnt(8)
v_mfma_f32_16x16x32_bf16 v[192:195],v[40:43],v[80:83],0
ds_read_b64_tr_b16 v[76:77],v6 offset:28672
ds_read_b64_tr_b16 v[78:79],v6 offset:29184
v_mfma_f32_16x16x32_bf16 v[200:203],v[40:43],v[84:87],0
ds_read_b128 v[96:99],v9 offset:4096
ds_read_b128 v[100:103],v9 offset:5120
s_waitcnt lgkmcnt(10)
v_mfma_f32_16x16x32_bf16 v[204:207],v[44:47],v[84:87],0
v_mfma_f32_16x16x32_bf16 v[196:199],v[44:47],v[80:83],0
ds_read_b64_tr_b16 v[40:41],v7 offset:28672
ds_read_b64_tr_b16 v[42:43],v7 offset:29184
s_waitcnt lgkmcnt(10)
v_mfma_f32_16x16x32_bf16 v[208:211],v[64:67],v[80:83],0
ds_read_b64_tr_b16 v[44:45],v8 offset:28672
ds_read_b64_tr_b16 v[46:47],v8 offset:29184
v_mfma_f32_16x16x32_bf16 v[216:219],v[64:67],v[84:87],0
s_waitcnt lgkmcnt(10)
v_mfma_f32_16x16x32_bf16 v[220:223],v[68:71],v[84:87],0
v_mfma_f32_16x16x32_bf16 v[212:215],v[68:71],v[80:83],0
ds_read_b64_tr_b16 v[64:65],v5 offset:32768
ds_read_b64_tr_b16 v[66:67],v5 offset:33280
s_setprio 1
s_waitcnt lgkmcnt(10)
v_mfma_f32_16x16x32_bf16 v[192:195],v[72:75],v[88:91],v[192:195]
ds_read_b64_tr_b16 v[68:69],v6 offset:32768
ds_read_b64_tr_b16 v[70:71],v6 offset:33280
v_mfma_f32_16x16x32_bf16 v[200:203],v[72:75],v[92:95],v[200:203]
s_waitcnt lgkmcnt(10)
v_mfma_f32_16x16x32_bf16 v[204:207],v[76:79],v[92:95],v[204:207]
v_mfma_f32_16x16x32_bf16 v[196:199],v[76:79],v[88:91],v[196:199]
ds_read_b64_tr_b16 v[72:73],v7 offset:32768
ds_read_b64_tr_b16 v[74:75],v7 offset:33280
s_waitcnt lgkmcnt(8)
v_mfma_f32_16x16x32_bf16 v[208:211],v[40:43],v[88:91],v[208:211]
ds_read_b64_tr_b16 v[76:77],v8 offset:32768
ds_read_b64_tr_b16 v[78:79],v8 offset:33280
v_mfma_f32_16x16x32_bf16 v[216:219],v[40:43],v[92:95],v[216:219]
s_add_u32 m0,s58,4096
s_add_u32 s53,s83,0
buffer_load_dwordx4 v3,s[32:35],s53 offen lds
s_waitcnt lgkmcnt(8)
v_mfma_f32_16x16x32_bf16 v[220:223],v[44:47],v[92:95],v[220:223]
v_mfma_f32_16x16x32_bf16 v[212:215],v[44:47],v[88:91],v[212:215]
s_add_u32 m0,s58,5120
s_add_u32 s53,s83,16384
buffer_load_dwordx4 v3,s[32:35],s53 offen lds
ds_read_b64_tr_b16 v[40:41],v5 offset:36864
ds_read_b64_tr_b16 v[42:43],v5 offset:37376
s_waitcnt lgkmcnt(8)
v_mfma_f32_16x16x32_bf16 v[224:227],v[64:67],v[80:83],0
ds_read_b64_tr_b16 v[44:45],v6 offset:36864
ds_read_b64_tr_b16 v[46:47],v6 offset:37376
v_mfma_f32_16x16x32_bf16 v[232:235],v[64:67],v[84:87],0
s_waitcnt lgkmcnt(8)
v_mfma_f32_16x16x32_bf16 v[236:239],v[68:71],v[84:87],0
v_mfma_f32_16x16x32_bf16 v[228:231],v[68:71],v[80:83],0
ds_read_b64_tr_b16 v[64:65],v7 offset:36864
ds_read_b64_tr_b16 v[66:67],v7 offset:37376
s_setprio 0
s_waitcnt lgkmcnt(8)
v_mfma_f32_16x16x32_bf16 v[240:243],v[72:75],v[80:83],0
ds_read_b64_tr_b16 v[68:69],v8 offset:36864
ds_read_b64_tr_b16 v[70:71],v8 offset:37376
v_mfma_f32_16x16x32_bf16 v[248:251],v[72:75],v[84:87],0
s_waitcnt lgkmcnt(8)
v_mfma_f32_16x16x32_bf16 v[252:255],v[76:79],v[84:87],0
v_mfma_f32_16x16x32_bf16 v[244:247],v[76:79],v[80:83],0
ds_read_b64_tr_b16 v[72:73],v5 offset:40960
ds_read_b64_tr_b16 v[74:75],v5 offset:41472
s_waitcnt lgkmcnt(8)
v_mfma_f32_16x16x32_bf16 v[224:227],v[40:43],v[88:91],v[224:227]
ds_read_b64_tr_b16 v[76:77],v6 offset:40960
ds_read_b64_tr_b16 v[78:79],v6 offset:41472
v_mfma_f32_16x16x32_bf16 v[232:235],v[40:43],v[92:95],v[232:235]
s_waitcnt lgkmcnt(8)
v_mfma_f32_16x16x32_bf16 v[236:239],v[44:47],v[92:95],v[236:239]
v_mfma_f32_16x16x32_bf16 v[228:231],v[44:47],v[88:91],v[228:231]
s_waitcnt vmcnt(14)
ds_read_b128 v[104:107],v9 offset:6144
ds_read_b128 v[108:111],v9 offset:7168
ds_read_b64_tr_b16 v[40:41],v7 offset:40960
ds_read_b64_tr_b16 v[42:43],v7 offset:41472
s_waitcnt lgkmcnt(10)
v_mfma_f32_16x16x32_bf16 v[240:243],v[64:67],v[88:91],v[240:243]
ds_read_b64_tr_b16 v[44:45],v8 offset:40960
ds_read_b64_tr_b16 v[46:47],v8 offset:41472
v_mfma_f32_16x16x32_bf16 v[248:251],v[64:67],v[92:95],v[248:251]
s_waitcnt lgkmcnt(10)
v_mfma_f32_16x16x32_bf16 v[252:255],v[68:71],v[92:95],v[252:255]
v_mfma_f32_16x16x32_bf16 v[244:247],v[68:71],v[88:91],v[244:247]
s_waitcnt vmcnt(6)
s_barrier
ds_read_b64_tr_b16 v[64:65],v5 offset:45056
ds_read_b64_tr_b16 v[66:67],v5 offset:45568
s_setprio 3
s_waitcnt lgkmcnt(10)
v_mfma_f32_16x16x32_bf16 v[128:131],v[72:75],v[96:99],v[128:131]
ds_read_b64_tr_b16 v[68:69],v6 offset:45056
ds_read_b64_tr_b16 v[70:71],v6 offset:45568
v_mfma_f32_16x16x32_bf16 v[136:139],v[72:75],v[100:103],v[136:139]
s_add_u32 m0,s60,81920
s_add_u32 s53,s74,512
buffer_load_dwordx4 v2,s[36:39],s53 offen lds
s_waitcnt lgkmcnt(10)
v_mfma_f32_16x16x32_bf16 v[140:143],v[76:79],v[100:103],v[140:143]
v_mfma_f32_16x16x32_bf16 v[132:135],v[76:79],v[96:99],v[132:135]
ds_read_b64_tr_b16 v[72:73],v7 offset:45056
ds_read_b64_tr_b16 v[74:75],v7 offset:45568
s_waitcnt lgkmcnt(8)
v_mfma_f32_16x16x32_bf16 v[144:147],v[40:43],v[96:99],v[144:147]
ds_read_b64_tr_b16 v[76:77],v8 offset:45056
ds_read_b64_tr_b16 v[78:79],v8 offset:45568
v_mfma_f32_16x16x32_bf16 v[152:155],v[40:43],v[100:103],v[152:155]
s_waitcnt lgkmcnt(8)
v_mfma_f32_16x16x32_bf16 v[156:159],v[44:47],v[100:103],v[156:159]
v_mfma_f32_16x16x32_bf16 v[148:151],v[44:47],v[96:99],v[148:151]
s_add_u32 m0,s58,6144
s_add_u32 s53,s83,64
buffer_load_dwordx4 v3,s[32:35],s53 offen lds
ds_read_b64_tr_b16 v[40:41],v5 offset:49152
ds_read_b64_tr_b16 v[42:43],v5 offset:49664
s_waitcnt lgkmcnt(8)
v_mfma_f32_16x16x32_bf16 v[128:131],v[64:67],v[104:107],v[128:131]
ds_read_b64_tr_b16 v[44:45],v6 offset:49152
ds_read_b64_tr_b16 v[46:47],v6 offset:49664
v_mfma_f32_16x16x32_bf16 v[136:139],v[64:67],v[108:111],v[136:139]
s_add_u32 m0,s58,7168
s_add_u32 s53,s83,16448
buffer_load_dwordx4 v3,s[32:35],s53 offen lds
s_waitcnt lgkmcnt(8)
v_mfma_f32_16x16x32_bf16 v[140:143],v[68:71],v[108:111],v[140:143]
v_mfma_f32_16x16x32_bf16 v[132:135],v[68:71],v[104:107],v[132:135]
s_add_u32 m0,s60,90112
s_add_u32 s53,s75,0
buffer_load_dwordx4 v2,s[36:39],s53 offen lds
ds_read_b64_tr_b16 v[64:65],v7 offset:49152
ds_read_b64_tr_b16 v[66:67],v7 offset:49664
s_waitcnt lgkmcnt(8)
v_mfma_f32_16x16x32_bf16 v[144:147],v[72:75],v[104:107],v[144:147]
ds_read_b64_tr_b16 v[68:69],v8 offset:49152
ds_read_b64_tr_b16 v[70:71],v8 offset:49664
v_mfma_f32_16x16x32_bf16 v[152:155],v[72:75],v[108:111],v[152:155]
s_waitcnt lgkmcnt(8)
v_mfma_f32_16x16x32_bf16 v[156:159],v[76:79],v[108:111],v[156:159]
v_mfma_f32_16x16x32_bf16 v[148:151],v[76:79],v[104:107],v[148:151]
ds_read_b64_tr_b16 v[72:73],v5 offset:53248
ds_read_b64_tr_b16 v[74:75],v5 offset:53760
s_waitcnt lgkmcnt(8)
v_mfma_f32_16x16x32_bf16 v[24:27],v[40:43],v[96:99],v[24:27]
ds_read_b64_tr_b16 v[76:77],v6 offset:53248
ds_read_b64_tr_b16 v[78:79],v6 offset:53760
v_mfma_f32_16x16x32_bf16 v[32:35],v[40:43],v[100:103],v[32:35]
s_waitcnt lgkmcnt(8)
v_mfma_f32_16x16x32_bf16 v[36:39],v[44:47],v[100:103],v[36:39]
v_mfma_f32_16x16x32_bf16 v[28:31],v[44:47],v[96:99],v[28:31]
ds_read_b64_tr_b16 v[40:41],v7 offset:53248
ds_read_b64_tr_b16 v[42:43],v7 offset:53760
s_setprio 2
s_waitcnt lgkmcnt(8)
v_mfma_f32_16x16x32_bf16 v[48:51],v[64:67],v[96:99],v[48:51]
s_add_u32 m0,s60,98304
s_add_u32 s53,s75,128
buffer_load_dwordx4 v2,s[36:39],s53 offen lds
ds_read_b64_tr_b16 v[44:45],v8 offset:53248
ds_read_b64_tr_b16 v[46:47],v8 offset:53760
v_mfma_f32_16x16x32_bf16 v[56:59],v[64:67],v[100:103],v[56:59]
ds_read_b128 v[112:115],v9 offset:0
ds_read_b128 v[116:119],v9 offset:1024
s_waitcnt lgkmcnt(10)
v_mfma_f32_16x16x32_bf16 v[60:63],v[68:71],v[100:103],v[60:63]
v_mfma_f32_16x16x32_bf16 v[52:55],v[68:71],v[96:99],v[52:55]
ds_read_b64_tr_b16 v[64:65],v5 offset:57344
ds_read_b64_tr_b16 v[66:67],v5 offset:57856
s_waitcnt lgkmcnt(10)
v_mfma_f32_16x16x32_bf16 v[24:27],v[72:75],v[104:107],v[24:27]
ds_read_b64_tr_b16 v[68:69],v6 offset:57344
ds_read_b64_tr_b16 v[70:71],v6 offset:57856
v_mfma_f32_16x16x32_bf16 v[32:35],v[72:75],v[108:111],v[32:35]
s_waitcnt lgkmcnt(10)
v_mfma_f32_16x16x32_bf16 v[36:39],v[76:79],v[108:111],v[36:39]
v_mfma_f32_16x16x32_bf16 v[28:31],v[76:79],v[104:107],v[28:31]
ds_read_b64_tr_b16 v[72:73],v7 offset:57344
ds_read_b64_tr_b16 v[74:75],v7 offset:57856
s_waitcnt lgkmcnt(10)
v_mfma_f32_16x16x32_bf16 v[48:51],v[40:43],v[104:107],v[48:51]
ds_read_b64_tr_b16 v[76:77],v8 offset:57344
ds_read_b64_tr_b16 v[78:79],v8 offset:57856
v_mfma_f32_16x16x32_bf16 v[56:59],v[40:43],v[108:111],v[56:59]
s_waitcnt lgkmcnt(10)
v_mfma_f32_16x16x32_bf16 v[60:63],v[44:47],v[108:111],v[60:63]
v_mfma_f32_16x16x32_bf16 v[52:55],v[44:47],v[104:107],v[52:55]
ds_read_b64_tr_b16 v[40:41],v5 offset:61440
ds_read_b64_tr_b16 v[42:43],v5 offset:61952
s_waitcnt lgkmcnt(8)
v_mfma_f32_16x16x32_bf16 v[160:163],v[64:67],v[96:99],v[160:163]
ds_read_b64_tr_b16 v[44:45],v6 offset:61440
ds_read_b64_tr_b16 v[46:47],v6 offset:61952
v_mfma_f32_16x16x32_bf16 v[168:171],v[64:67],v[100:103],v[168:171]
s_add_u32 m0,s58,0
s_add_u32 s53,s84,0
buffer_load_dwordx4 v3,s[32:35],s53 offen lds
s_waitcnt lgkmcnt(8)
v_mfma_f32_16x16x32_bf16 v[172:175],v[68:71],v[100:103],v[172:175]
v_mfma_f32_16x16x32_bf16 v[164:167],v[68:71],v[96:99],v[164:167]
s_add_u32 m0,s58,1024
s_add_u32 s53,s84,16384
buffer_load_dwordx4 v3,s[32:35],s53 offen lds
ds_read_b64_tr_b16 v[64:65],v7 offset:61440
ds_read_b64_tr_b16 v[66:67],v7 offset:61952
s_waitcnt lgkmcnt(8)
v_mfma_f32_16x16x32_bf16 v[176:179],v[72:75],v[96:99],v[176:179]
ds_read_b64_tr_b16 v[68:69],v8 offset:61440
ds_read_b64_tr_b16 v[70:71],v8 offset:61952
v_mfma_f32_16x16x32_bf16 v[184:187],v[72:75],v[100:103],v[184:187]
s_waitcnt lgkmcnt(8)
v_mfma_f32_16x16x32_bf16 v[188:191],v[76:79],v[100:103],v[188:191]
v_mfma_f32_16x16x32_bf16 v[180:183],v[76:79],v[96:99],v[180:183]
v_add_u32 v5,0x10000,v5
ds_read_b64_tr_b16 v[72:73],v5 offset:0
ds_read_b64_tr_b16 v[74:75],v5 offset:512
s_setprio 1
s_waitcnt lgkmcnt(8)
v_mfma_f32_16x16x32_bf16 v[160:163],v[40:43],v[104:107],v[160:163]
v_add_u32 v6,0x10000,v6
ds_read_b64_tr_b16 v[76:77],v6 offset:0
ds_read_b64_tr_b16 v[78:79],v6 offset:512
v_mfma_f32_16x16x32_bf16 v[168:171],v[40:43],v[108:111],v[168:171]
s_waitcnt lgkmcnt(8)
v_mfma_f32_16x16x32_bf16 v[172:175],v[44:47],v[108:111],v[172:175]
v_mfma_f32_16x16x32_bf16 v[164:167],v[44:47],v[104:107],v[164:167]
v_add_u32 v7,0x10000,v7
ds_read_b64_tr_b16 v[40:41],v7 offset:0
ds_read_b64_tr_b16 v[42:43],v7 offset:512
s_waitcnt lgkmcnt(8)
v_mfma_f32_16x16x32_bf16 v[176:179],v[64:67],v[104:107],v[176:179]
v_add_u32 v8,0x10000,v8
ds_read_b64_tr_b16 v[44:45],v8 offset:0
ds_read_b64_tr_b16 v[46:47],v8 offset:512
v_mfma_f32_16x16x32_bf16 v[184:187],v[64:67],v[108:111],v[184:187]
s_waitcnt lgkmcnt(8)
v_mfma_f32_16x16x32_bf16 v[188:191],v[68:71],v[108:111],v[188:191]
v_mfma_f32_16x16x32_bf16 v[180:183],v[68:71],v[104:107],v[180:183]
s_waitcnt vmcnt(12)
ds_read_b128 v[120:123],v9 offset:2048
ds_read_b128 v[124:127],v9 offset:3072
ds_read_b64_tr_b16 v[64:65],v5 offset:4096
ds_read_b64_tr_b16 v[66:67],v5 offset:4608
s_waitcnt lgkmcnt(10)
v_mfma_f32_16x16x32_bf16 v[192:195],v[72:75],v[96:99],v[192:195]
ds_read_b64_tr_b16 v[68:69],v6 offset:4096
ds_read_b64_tr_b16 v[70:71],v6 offset:4608
v_mfma_f32_16x16x32_bf16 v[200:203],v[72:75],v[100:103],v[200:203]
s_waitcnt lgkmcnt(10)
v_mfma_f32_16x16x32_bf16 v[204:207],v[76:79],v[100:103],v[204:207]
v_mfma_f32_16x16x32_bf16 v[196:199],v[76:79],v[96:99],v[196:199]
ds_read_b64_tr_b16 v[72:73],v7 offset:4096
ds_read_b64_tr_b16 v[74:75],v7 offset:4608
s_waitcnt lgkmcnt(10)
v_mfma_f32_16x16x32_bf16 v[208:211],v[40:43],v[96:99],v[208:211]
ds_read_b64_tr_b16 v[76:77],v8 offset:4096
ds_read_b64_tr_b16 v[78:79],v8 offset:4608
v_mfma_f32_16x16x32_bf16 v[216:219],v[40:43],v[100:103],v[216:219]
s_waitcnt lgkmcnt(10)
v_mfma_f32_16x16x32_bf16 v[220:223],v[44:47],v[100:103],v[220:223]
v_mfma_f32_16x16x32_bf16 v[212:215],v[44:47],v[96:99],v[212:215]
ds_read_b64_tr_b16 v[40:41],v5 offset:8192
ds_read_b64_tr_b16 v[42:43],v5 offset:8704
s_waitcnt lgkmcnt(8)
v_mfma_f32_16x16x32_bf16 v[192:195],v[64:67],v[104:107],v[192:195]
ds_read_b64_tr_b16 v[44:45],v6 offset:8192
ds_read_b64_tr_b16 v[46:47],v6 offset:8704
v_mfma_f32_16x16x32_bf16 v[200:203],v[64:67],v[108:111],v[200:203]
s_waitcnt lgkmcnt(8)
v_mfma_f32_16x16x32_bf16 v[204:207],v[68:71],v[108:111],v[204:207]
v_mfma_f32_16x16x32_bf16 v[196:199],v[68:71],v[104:107],v[196:199]
s_add_u32 m0,s58,2048
s_add_u32 s53,s84,64
buffer_load_dwordx4 v3,s[32:35],s53 offen lds
ds_read_b64_tr_b16 v[64:65],v7 offset:8192
ds_read_b64_tr_b16 v[66:67],v7 offset:8704
s_setprio 0
s_waitcnt lgkmcnt(8)
v_mfma_f32_16x16x32_bf16 v[208:211],v[72:75],v[104:107],v[208:211]
ds_read_b64_tr_b16 v[68:69],v8 offset:8192
ds_read_b64_tr_b16 v[70:71],v8 offset:8704
v_mfma_f32_16x16x32_bf16 v[216:219],v[72:75],v[108:111],v[216:219]
s_add_u32 m0,s58,3072
s_add_u32 s53,s84,16448
buffer_load_dwordx4 v3,s[32:35],s53 offen lds
s_waitcnt lgkmcnt(8)
v_mfma_f32_16x16x32_bf16 v[220:223],v[76:79],v[108:111],v[220:223]
v_mfma_f32_16x16x32_bf16 v[212:215],v[76:79],v[104:107],v[212:215]
ds_read_b64_tr_b16 v[72:73],v5 offset:12288
ds_read_b64_tr_b16 v[74:75],v5 offset:12800
s_waitcnt lgkmcnt(8)
v_mfma_f32_16x16x32_bf16 v[224:227],v[40:43],v[96:99],v[224:227]
ds_read_b64_tr_b16 v[76:77],v6 offset:12288
ds_read_b64_tr_b16 v[78:79],v6 offset:12800
v_mfma_f32_16x16x32_bf16 v[232:235],v[40:43],v[100:103],v[232:235]
s_waitcnt lgkmcnt(8)
v_mfma_f32_16x16x32_bf16 v[236:239],v[44:47],v[100:103],v[236:239]
v_mfma_f32_16x16x32_bf16 v[228:231],v[44:47],v[96:99],v[228:231]
ds_read_b64_tr_b16 v[40:41],v7 offset:12288
ds_read_b64_tr_b16 v[42:43],v7 offset:12800
s_waitcnt lgkmcnt(8)
v_mfma_f32_16x16x32_bf16 v[240:243],v[64:67],v[96:99],v[240:243]
ds_read_b64_tr_b16 v[44:45],v8 offset:12288
ds_read_b64_tr_b16 v[46:47],v8 offset:12800
v_mfma_f32_16x16x32_bf16 v[248:251],v[64:67],v[100:103],v[248:251]
s_waitcnt lgkmcnt(8)
v_mfma_f32_16x16x32_bf16 v[252:255],v[68:71],v[100:103],v[252:255]
v_mfma_f32_16x16x32_bf16 v[244:247],v[68:71],v[96:99],v[244:247]
ds_read_b64_tr_b16 v[64:65],v5 offset:16384
ds_read_b64_tr_b16 v[66:67],v5 offset:16896
s_waitcnt lgkmcnt(8)
v_mfma_f32_16x16x32_bf16 v[224:227],v[72:75],v[104:107],v[224:227]
ds_read_b64_tr_b16 v[68:69],v6 offset:16384
ds_read_b64_tr_b16 v[70:71],v6 offset:16896
v_mfma_f32_16x16x32_bf16 v[232:235],v[72:75],v[108:111],v[232:235]
s_waitcnt vmcnt(9)
ds_read_b128 v[80:83],v9 offset:4096
ds_read_b128 v[84:87],v9 offset:5120
s_waitcnt lgkmcnt(10)
v_mfma_f32_16x16x32_bf16 v[236:239],v[76:79],v[108:111],v[236:239]
v_mfma_f32_16x16x32_bf16 v[228:231],v[76:79],v[104:107],v[228:231]
ds_read_b64_tr_b16 v[72:73],v7 offset:16384
ds_read_b64_tr_b16 v[74:75],v7 offset:16896
s_waitcnt lgkmcnt(10)
v_mfma_f32_16x16x32_bf16 v[240:243],v[40:43],v[104:107],v[240:243]
ds_read_b64_tr_b16 v[76:77],v8 offset:16384
ds_read_b64_tr_b16 v[78:79],v8 offset:16896
v_mfma_f32_16x16x32_bf16 v[248:251],v[40:43],v[108:111],v[248:251]
s_waitcnt lgkmcnt(10)
v_mfma_f32_16x16x32_bf16 v[252:255],v[44:47],v[108:111],v[252:255]
v_mfma_f32_16x16x32_bf16 v[244:247],v[44:47],v[104:107],v[244:247]
s_waitcnt vmcnt(5)
s_barrier
ds_read_b64_tr_b16 v[40:41],v5 offset:20480
ds_read_b64_tr_b16 v[42:43],v5 offset:20992
s_setprio 3
s_waitcnt lgkmcnt(10)
v_mfma_f32_16x16x32_bf16 v[128:131],v[64:67],v[112:115],v[128:131]
ds_read_b64_tr_b16 v[44:45],v6 offset:20480
ds_read_b64_tr_b16 v[46:47],v6 offset:20992
v_mfma_f32_16x16x32_bf16 v[136:139],v[64:67],v[116:119],v[136:139]
s_add_u32 m0,s60,106496
s_add_u32 s53,s75,256
buffer_load_dwordx4 v2,s[36:39],s53 offen lds
s_waitcnt lgkmcnt(10)
v_mfma_f32_16x16x32_bf16 v[140:143],v[68:71],v[116:119],v[140:143]
v_mfma_f32_16x16x32_bf16 v[132:135],v[68:71],v[112:115],v[132:135]
ds_read_b64_tr_b16 v[64:65],v7 offset:20480
ds_read_b64_tr_b16 v[66:67],v7 offset:20992
s_waitcnt lgkmcnt(8)
v_mfma_f32_16x16x32_bf16 v[144:147],v[72:75],v[112:115],v[144:147]
ds_read_b64_tr_b16 v[68:69],v8 offset:20480
ds_read_b64_tr_b16 v[70:71],v8 offset:20992
v_mfma_f32_16x16x32_bf16 v[152:155],v[72:75],v[116:119],v[152:155]
s_add_u32 m0,s58,4096
s_add_u32 s53,s85,0
buffer_load_dwordx4 v3,s[32:35],s53 offen lds
s_waitcnt lgkmcnt(8)
v_mfma_f32_16x16x32_bf16 v[156:159],v[76:79],v[116:119],v[156:159]
s_add_u32 m0,s60,114688
s_add_u32 s53,s75,384
buffer_load_dwordx4 v2,s[36:39],s53 offen lds
v_mfma_f32_16x16x32_bf16 v[148:151],v[76:79],v[112:115],v[148:151]
s_add_u32 m0,s58,5120
s_add_u32 s53,s85,16384
buffer_load_dwordx4 v3,s[32:35],s53 offen lds
ds_read_b64_tr_b16 v[72:73],v5 offset:24576
ds_read_b64_tr_b16 v[74:75],v5 offset:25088
s_waitcnt lgkmcnt(8)
v_mfma_f32_16x16x32_bf16 v[128:131],v[40:43],v[120:123],v[128:131]
ds_read_b64_tr_b16 v[76:77],v6 offset:24576
ds_read_b64_tr_b16 v[78:79],v6 offset:25088
v_mfma_f32_16x16x32_bf16 v[136:139],v[40:43],v[124:127],v[136:139]
s_waitcnt lgkmcnt(8)
v_mfma_f32_16x16x32_bf16 v[140:143],v[44:47],v[124:127],v[140:143]
v_mfma_f32_16x16x32_bf16 v[132:135],v[44:47],v[120:123],v[132:135]
ds_read_b64_tr_b16 v[40:41],v7 offset:24576
ds_read_b64_tr_b16 v[42:43],v7 offset:25088
s_waitcnt lgkmcnt(8)
v_mfma_f32_16x16x32_bf16 v[144:147],v[64:67],v[120:123],v[144:147]
ds_read_b64_tr_b16 v[44:45],v8 offset:24576
ds_read_b64_tr_b16 v[46:47],v8 offset:25088
v_mfma_f32_16x16x32_bf16 v[152:155],v[64:67],v[124:127],v[152:155]
s_add_u32 m0,s60,122880
s_add_u32 s53,s75,512
buffer_load_dwordx4 v2,s[36:39],s53 offen lds
s_waitcnt lgkmcnt(8)
v_mfma_f32_16x16x32_bf16 v[156:159],v[68:71],v[124:127],v[156:159]
v_mfma_f32_16x16x32_bf16 v[148:151],v[68:71],v[120:123],v[148:151]
ds_read_b64_tr_b16 v[64:65],v5 offset:28672
ds_read_b64_tr_b16 v[66:67],v5 offset:29184
s_waitcnt lgkmcnt(8)
v_mfma_f32_16x16x32_bf16 v[24:27],v[72:75],v[112:115],v[24:27]
ds_read_b64_tr_b16 v[68:69],v6 offset:28672
ds_read_b64_tr_b16 v[70:71],v6 offset:29184
v_mfma_f32_16x16x32_bf16 v[32:35],v[72:75],v[116:119],v[32:35]
s_waitcnt lgkmcnt(8)
v_mfma_f32_16x16x32_bf16 v[36:39],v[76:79],v[116:119],v[36:39]
s_add_u32 m0,s60,131072
s_add_u32 s53,s76,0
buffer_load_dwordx4 v2,s[36:39],s53 offen lds
v_mfma_f32_16x16x32_bf16 v[28:31],v[76:79],v[112:115],v[28:31]
ds_read_b128 v[88:91],v9 offset:6144
ds_read_b128 v[92:95],v9 offset:7168
ds_read_b64_tr_b16 v[72:73],v7 offset:28672
ds_read_b64_tr_b16 v[74:75],v7 offset:29184
s_setprio 2
s_waitcnt lgkmcnt(10)
v_mfma_f32_16x16x32_bf16 v[48:51],v[40:43],v[112:115],v[48:51]
ds_read_b64_tr_b16 v[76:77],v8 offset:28672
ds_read_b64_tr_b16 v[78:79],v8 offset:29184
v_mfma_f32_16x16x32_bf16 v[56:59],v[40:43],v[116:119],v[56:59]
s_waitcnt lgkmcnt(10)
v_mfma_f32_16x16x32_bf16 v[60:63],v[44:47],v[116:119],v[60:63]
v_mfma_f32_16x16x32_bf16 v[52:55],v[44:47],v[112:115],v[52:55]
v_add_u32 v5,0xffff0000,v5
ds_read_b64_tr_b16 v[40:41],v5 offset:0
ds_read_b64_tr_b16 v[42:43],v5 offset:512
s_waitcnt lgkmcnt(10)
v_mfma_f32_16x16x32_bf16 v[24:27],v[64:67],v[120:123],v[24:27]
v_add_u32 v6,0xffff0000,v6
ds_read_b64_tr_b16 v[44:45],v6 offset:0
ds_read_b64_tr_b16 v[46:47],v6 offset:512
v_mfma_f32_16x16x32_bf16 v[32:35],v[64:67],v[124:127],v[32:35]
s_add_u32 m0,s60,139264
s_add_u32 s53,s76,128
buffer_load_dwordx4 v2,s[36:39],s53 offen lds
s_waitcnt lgkmcnt(10)
v_mfma_f32_16x16x32_bf16 v[36:39],v[68:71],v[124:127],v[36:39]
v_mfma_f32_16x16x32_bf16 v[28:31],v[68:71],v[120:123],v[28:31]
v_add_u32 v7,0xffff0000,v7
ds_read_b64_tr_b16 v[64:65],v7 offset:0
ds_read_b64_tr_b16 v[66:67],v7 offset:512
s_waitcnt lgkmcnt(8)
v_mfma_f32_16x16x32_bf16 v[48:51],v[72:75],v[120:123],v[48:51]
v_add_u32 v8,0xffff0000,v8
ds_read_b64_tr_b16 v[68:69],v8 offset:0
ds_read_b64_tr_b16 v[70:71],v8 offset:512
v_mfma_f32_16x16x32_bf16 v[56:59],v[72:75],v[124:127],v[56:59]
s_waitcnt lgkmcnt(8)
v_mfma_f32_16x16x32_bf16 v[60:63],v[76:79],v[124:127],v[60:63]
v_mfma_f32_16x16x32_bf16 v[52:55],v[76:79],v[120:123],v[52:55]
s_add_u32 m0,s58,6144
s_add_u32 s53,s85,64
buffer_load_dwordx4 v3,s[32:35],s53 offen lds
ds_read_b64_tr_b16 v[72:73],v5 offset:4096
ds_read_b64_tr_b16 v[74:75],v5 offset:4608
s_waitcnt lgkmcnt(8)
v_mfma_f32_16x16x32_bf16 v[160:163],v[40:43],v[112:115],v[160:163]
ds_read_b64_tr_b16 v[76:77],v6 offset:4096
ds_read_b64_tr_b16 v[78:79],v6 offset:4608
v_mfma_f32_16x16x32_bf16 v[168:171],v[40:43],v[116:119],v[168:171]
s_add_u32 m0,s58,7168
s_add_u32 s53,s85,16448
buffer_load_dwordx4 v3,s[32:35],s53 offen lds
s_waitcnt lgkmcnt(8)
v_mfma_f32_16x16x32_bf16 v[172:175],v[44:47],v[116:119],v[172:175]
v_mfma_f32_16x16x32_bf16 v[164:167],v[44:47],v[112:115],v[164:167]
ds_read_b64_tr_b16 v[40:41],v7 offset:4096
ds_read_b64_tr_b16 v[42:43],v7 offset:4608
s_waitcnt lgkmcnt(8)
v_mfma_f32_16x16x32_bf16 v[176:179],v[64:67],v[112:115],v[176:179]
ds_read_b64_tr_b16 v[44:45],v8 offset:4096
ds_read_b64_tr_b16 v[46:47],v8 offset:4608
v_mfma_f32_16x16x32_bf16 v[184:187],v[64:67],v[116:119],v[184:187]
s_waitcnt lgkmcnt(8)
v_mfma_f32_16x16x32_bf16 v[188:191],v[68:71],v[116:119],v[188:191]
v_mfma_f32_16x16x32_bf16 v[180:183],v[68:71],v[112:115],v[180:183]
ds_read_b64_tr_b16 v[64:65],v5 offset:8192
ds_read_b64_tr_b16 v[66:67],v5 offset:8704
s_setprio 1
s_waitcnt lgkmcnt(8)
v_mfma_f32_16x16x32_bf16 v[160:163],v[72:75],v[120:123],v[160:163]
ds_read_b64_tr_b16 v[68:69],v6 offset:8192
ds_read_b64_tr_b16 v[70:71],v6 offset:8704
v_mfma_f32_16x16x32_bf16 v[168:171],v[72:75],v[124:127],v[168:171]
s_waitcnt lgkmcnt(8)
v_mfma_f32_16x16x32_bf16 v[172:175],v[76:79],v[124:127],v[172:175]
v_mfma_f32_16x16x32_bf16 v[164:167],v[76:79],v[120:123],v[164:167]
ds_read_b64_tr_b16 v[72:73],v7 offset:8192
ds_read_b64_tr_b16 v[74:75],v7 offset:8704
s_waitcnt lgkmcnt(8)
v_mfma_f32_16x16x32_bf16 v[176:179],v[40:43],v[120:123],v[176:179]
ds_read_b64_tr_b16 v[76:77],v8 offset:8192
ds_read_b64_tr_b16 v[78:79],v8 offset:8704
v_mfma_f32_16x16x32_bf16 v[184:187],v[40:43],v[124:127],v[184:187]
s_waitcnt vmcnt(11)
ds_read_b128 v[96:99],v9 offset:0
ds_read_b128 v[100:103],v9 offset:1024
s_waitcnt lgkmcnt(10)
v_mfma_f32_16x16x32_bf16 v[188:191],v[44:47],v[124:127],v[188:191]
v_mfma_f32_16x16x32_bf16 v[180:183],v[44:47],v[120:123],v[180:183]
ds_read_b64_tr_b16 v[40:41],v5 offset:12288
ds_read_b64_tr_b16 v[42:43],v5 offset:12800
s_waitcnt lgkmcnt(10)
v_mfma_f32_16x16x32_bf16 v[192:195],v[64:67],v[112:115],v[192:195]
ds_read_b64_tr_b16 v[44:45],v6 offset:12288
ds_read_b64_tr_b16 v[46:47],v6 offset:12800
v_mfma_f32_16x16x32_bf16 v[200:203],v[64:67],v[116:119],v[200:203]
s_waitcnt lgkmcnt(10)
v_mfma_f32_16x16x32_bf16 v[204:207],v[68:71],v[116:119],v[204:207]
v_mfma_f32_16x16x32_bf16 v[196:199],v[68:71],v[112:115],v[196:199]
ds_read_b64_tr_b16 v[64:65],v7 offset:12288
ds_read_b64_tr_b16 v[66:67],v7 offset:12800
s_waitcnt lgkmcnt(10)
v_mfma_f32_16x16x32_bf16 v[208:211],v[72:75],v[112:115],v[208:211]
ds_read_b64_tr_b16 v[68:69],v8 offset:12288
ds_read_b64_tr_b16 v[70:71],v8 offset:12800
v_mfma_f32_16x16x32_bf16 v[216:219],v[72:75],v[116:119],v[216:219]
s_waitcnt lgkmcnt(10)
v_mfma_f32_16x16x32_bf16 v[220:223],v[76:79],v[116:119],v[220:223]
v_mfma_f32_16x16x32_bf16 v[212:215],v[76:79],v[112:115],v[212:215]
ds_read_b64_tr_b16 v[72:73],v5 offset:16384
ds_read_b64_tr_b16 v[74:75],v5 offset:16896
s_waitcnt lgkmcnt(8)
v_mfma_f32_16x16x32_bf16 v[192:195],v[40:43],v[120:123],v[192:195]
ds_read_b64_tr_b16 v[76:77],v6 offset:16384
ds_read_b64_tr_b16 v[78:79],v6 offset:16896
v_mfma_f32_16x16x32_bf16 v[200:203],v[40:43],v[124:127],v[200:203]
s_add_u32 m0,s58,0
s_add_u32 s53,s86,0
buffer_load_dwordx4 v3,s[32:35],s53 offen lds
s_waitcnt lgkmcnt(8)
v_mfma_f32_16x16x32_bf16 v[204:207],v[44:47],v[124:127],v[204:207]
v_mfma_f32_16x16x32_bf16 v[196:199],v[44:47],v[120:123],v[196:199]
s_add_u32 m0,s58,1024
s_add_u32 s53,s86,16384
buffer_load_dwordx4 v3,s[32:35],s53 offen lds
ds_read_b64_tr_b16 v[40:41],v7 offset:16384
ds_read_b64_tr_b16 v[42:43],v7 offset:16896
s_setprio 0
s_waitcnt lgkmcnt(8)
v_mfma_f32_16x16x32_bf16 v[208:211],v[64:67],v[120:123],v[208:211]
ds_read_b64_tr_b16 v[44:45],v8 offset:16384
ds_read_b64_tr_b16 v[46:47],v8 offset:16896
v_mfma_f32_16x16x32_bf16 v[216:219],v[64:67],v[124:127],v[216:219]
s_waitcnt lgkmcnt(8)
v_mfma_f32_16x16x32_bf16 v[220:223],v[68:71],v[124:127],v[220:223]
v_mfma_f32_16x16x32_bf16 v[212:215],v[68:71],v[120:123],v[212:215]
ds_read_b64_tr_b16 v[64:65],v5 offset:20480
ds_read_b64_tr_b16 v[66:67],v5 offset:20992
s_waitcnt lgkmcnt(8)
v_mfma_f32_16x16x32_bf16 v[224:227],v[72:75],v[112:115],v[224:227]
ds_read_b64_tr_b16 v[68:69],v6 offset:20480
ds_read_b64_tr_b16 v[70:71],v6 offset:20992
v_mfma_f32_16x16x32_bf16 v[232:235],v[72:75],v[116:119],v[232:235]
s_waitcnt lgkmcnt(8)
v_mfma_f32_16x16x32_bf16 v[236:239],v[76:79],v[116:119],v[236:239]
v_mfma_f32_16x16x32_bf16 v[228:231],v[76:79],v[112:115],v[228:231]
ds_read_b64_tr_b16 v[72:73],v7 offset:20480
ds_read_b64_tr_b16 v[74:75],v7 offset:20992
s_waitcnt lgkmcnt(8)
v_mfma_f32_16x16x32_bf16 v[240:243],v[40:43],v[112:115],v[240:243]
ds_read_b64_tr_b16 v[76:77],v8 offset:20480
ds_read_b64_tr_b16 v[78:79],v8 offset:20992
v_mfma_f32_16x16x32_bf16 v[248:251],v[40:43],v[116:119],v[248:251]
s_waitcnt lgkmcnt(8)
v_mfma_f32_16x16x32_bf16 v[252:255],v[44:47],v[116:119],v[252:255]
v_mfma_f32_16x16x32_bf16 v[244:247],v[44:47],v[112:115],v[244:247]
s_waitcnt vmcnt(11)
ds_read_b128 v[104:107],v9 offset:2048
ds_read_b128 v[108:111],v9 offset:3072
ds_read_b64_tr_b16 v[40:41],v5 offset:24576
ds_read_b64_tr_b16 v[42:43],v5 offset:25088
s_waitcnt lgkmcnt(10)
v_mfma_f32_16x16x32_bf16 v[224:227],v[64:67],v[120:123],v[224:227]
ds_read_b64_tr_b16 v[44:45],v6 offset:24576
ds_read_b64_tr_b16 v[46:47],v6 offset:25088
v_mfma_f32_16x16x32_bf16 v[232:235],v[64:67],v[124:127],v[232:235]
s_waitcnt lgkmcnt(10)
v_mfma_f32_16x16x32_bf16 v[236:239],v[68:71],v[124:127],v[236:239]
v_mfma_f32_16x16x32_bf16 v[228:231],v[68:71],v[120:123],v[228:231]
ds_read_b64_tr_b16 v[64:65],v7 offset:24576
ds_read_b64_tr_b16 v[66:67],v7 offset:25088
s_waitcnt lgkmcnt(10)
v_mfma_f32_16x16x32_bf16 v[240:243],v[72:75],v[120:123],v[240:243]
ds_read_b64_tr_b16 v[68:69],v8 offset:24576
ds_read_b64_tr_b16 v[70:71],v8 offset:25088
v_mfma_f32_16x16x32_bf16 v[248:251],v[72:75],v[124:127],v[248:251]
s_waitcnt lgkmcnt(10)
v_mfma_f32_16x16x32_bf16 v[252:255],v[76:79],v[124:127],v[252:255]
v_mfma_f32_16x16x32_bf16 v[244:247],v[76:79],v[120:123],v[244:247]
s_waitcnt vmcnt(5)
s_barrier
ds_read_b64_tr_b16 v[72:73],v5 offset:28672
ds_read_b64_tr_b16 v[74:75],v5 offset:29184
s_setprio 3
s_waitcnt lgkmcnt(8)
v_mfma_f32_16x16x32_bf16 v[128:131],v[40:43],v[80:83],v[128:131]
ds_read_b64_tr_b16 v[76:77],v6 offset:28672
ds_read_b64_tr_b16 v[78:79],v6 offset:29184
v_mfma_f32_16x16x32_bf16 v[136:139],v[40:43],v[84:87],v[136:139]
s_add_u32 m0,s60,147456
s_add_u32 s53,s77,0
buffer_load_dwordx4 v2,s[36:39],s53 offen lds
s_waitcnt lgkmcnt(8)
v_mfma_f32_16x16x32_bf16 v[140:143],v[44:47],v[84:87],v[140:143]
v_mfma_f32_16x16x32_bf16 v[132:135],v[44:47],v[80:83],v[132:135]
s_add_u32 m0,s58,2048
s_add_u32 s53,s86,64
buffer_load_dwordx4 v3,s[32:35],s53 offen lds
ds_read_b64_tr_b16 v[40:41],v7 offset:28672
ds_read_b64_tr_b16 v[42:43],v7 offset:29184
s_waitcnt lgkmcnt(8)
v_mfma_f32_16x16x32_bf16 v[144:147],v[64:67],v[80:83],v[144:147]
s_add_u32 m0,s58,3072
s_add_u32 s53,s86,16448
buffer_load_dwordx4 v3,s[32:35],s53 offen lds
ds_read_b64_tr_b16 v[44:45],v8 offset:28672
ds_read_b64_tr_b16 v[46:47],v8 offset:29184
v_mfma_f32_16x16x32_bf16 v[152:155],v[64:67],v[84:87],v[152:155]
s_cmp_lg_u32 s50,0
s_cbranch_scc1 L_tag1
s_cmp_lg_u32 s101,0
s_cbranch_scc1 L_tag1
buffer_load_dword v14,off,s[92:95],0 sc1
L_tag1:
s_waitcnt lgkmcnt(8)
v_mfma_f32_16x16x32_bf16 v[156:159],v[68:71],v[84:87],v[156:159]
v_mfma_f32_16x16x32_bf16 v[148:151],v[68:71],v[80:83],v[148:151]
s_add_u32 m0,s60,155648
s_add_u32 s53,s78,0
buffer_load_dwordx4 v2,s[36:39],s53 offen lds
ds_read_b64_tr_b16 v[64:65],v5 offset:32768
ds_read_b64_tr_b16 v[66:67],v5 offset:33280
s_waitcnt lgkmcnt(8)
v_mfma_f32_16x16x32_bf16 v[128:131],v[72:75],v[88:91],v[128:131]
ds_read_b64_tr_b16 v[68:69],v6 offset:32768
ds_read_b64_tr_b16 v[70:71],v6 offset:33280
v_mfma_f32_16x16x32_bf16 v[136:139],v[72:75],v[92:95],v[136:139]
s_waitcnt lgkmcnt(8)
v_mfma_f32_16x16x32_bf16 v[140:143],v[76:79],v[92:95],v[140:143]
v_mfma_f32_16x16x32_bf16 v[132:135],v[76:79],v[88:91],v[132:135]
ds_read_b64_tr_b16 v[72:73],v7 offset:32768
ds_read_b64_tr_b16 v[74:75],v7 offset:33280
s_waitcnt lgkmcnt(8)
v_mfma_f32_16x16x32_bf16 v[144:147],v[40:43],v[88:91],v[144:147]
ds_read_b64_tr_b16 v[76:77],v8 offset:32768
ds_read_b64_tr_b16 v[78:79],v8 offset:33280
v_mfma_f32_16x16x32_bf16 v[152:155],v[40:43],v[92:95],v[152:155]
s_add_u32 m0,s60,65536
s_add_u32 s53,s79,0
buffer_load_dwordx4 v2,s[36:39],s53 offen lds
s_waitcnt lgkmcnt(8)
v_mfma_f32_16x16x32_bf16 v[156:159],v[44:47],v[92:95],v[156:159]
v_mfma_f32_16x16x32_bf16 v[148:151],v[44:47],v[88:91],v[148:151]
ds_read_b64_tr_b16 v[40:41],v5 offset:36864
ds_read_b64_tr_b16 v[42:43],v5 offset:37376
s_waitcnt lgkmcnt(8)
v_mfma_f32_16x16x32_bf16 v[24:27],v[64:67],v[80:83],v[24:27]
ds_read_b64_tr_b16 v[44:45],v6 offset:36864
ds_read_b64_tr_b16 v[46:47],v6 offset:37376
v_mfma_f32_16x16x32_bf16 v[32:35],v[64:67],v[84:87],v[32:35]
ds_read_b128 v[112:115],v9 offset:4096
ds_read_b128 v[116:119],v9 offset:5120
s_waitcnt lgkmcnt(10)
v_mfma_f32_16x16x32_bf16 v[36:39],v[68:71],v[84:87],v[36:39]
v_mfma_f32_16x16x32_bf16 v[28:31],v[68:71],v[80:83],v[28:31]
s_add_u32 m0,s60,73728
s_add_u32 s53,s77,128
buffer_load_dwordx4 v2,s[36:39],s53 offen lds
ds_read_b64_tr_b16 v[64:65],v7 offset:36864
ds_read_b64_tr_b16 v[66:67],v7 offset:37376
s_setprio 2
s_waitcnt lgkmcnt(10)
v_mfma_f32_16x16x32_bf16 v[48:51],v[72:75],v[80:83],v[48:51]
ds_read_b64_tr_b16 v[68:69],v8 offset:36864
ds_read_b64_tr_b16 v[70:71],v8 offset:37376
v_mfma_f32_16x16x32_bf16 v[56:59],v[72:75],v[84:87],v[56:59]
s_waitcnt lgkmcnt(10)
v_mfma_f32_16x16x32_bf16 v[60:63],v[76:79],v[84:87],v[60:63]
v_mfma_f32_16x16x32_bf16 v[52:55],v[76:79],v[80:83],v[52:55]
ds_read_b64_tr_b16 v[72:73],v5 offset:40960
ds_read_b64_tr_b16 v[74:75],v5 offset:41472
s_waitcnt lgkmcnt(10)
v_mfma_f32_16x16x32_bf16 v[24:27],v[40:43],v[88:91],v[24:27]
ds_read_b64_tr_b16 v[76:77],v6 offset:40960
ds_read_b64_tr_b16 v[78:79],v6 offset:41472
v_mfma_f32_16x16x32_bf16 v[32:35],v[40:43],v[92:95],v[32:35]
s_add_u32 m0,s60,81920
s_add_u32 s53,s78,128
buffer_load_dwordx4 v2,s[36:39],s53 offen lds
s_waitcnt lgkmcnt(10)
v_mfma_f32_16x16x32_bf16 v[36:39],v[44:47],v[92:95],v[36:39]
v_mfma_f32_16x16x32_bf16 v[28:31],v[44:47],v[88:91],v[28:31]
ds_read_b64_tr_b16 v[40:41],v7 offset:40960
ds_read_b64_tr_b16 v[42:43],v7 offset:41472
s_waitcnt lgkmcnt(8)
v_mfma_f32_16x16x32_bf16 v[48:51],v[64:67],v[88:91],v[48:51]
ds_read_b64_tr_b16 v[44:45],v8 offset:40960
ds_read_b64_tr_b16 v[46:47],v8 offset:41472
v_mfma_f32_16x16x32_bf16 v[56:59],v[64:67],v[92:95],v[56:59]
s_add_u32 m0,s58,4096
s_add_u32 s53,s87,0
buffer_load_dwordx4 v3,s[32:35],s53 offen lds
s_waitcnt lgkmcnt(8)
v_mfma_f32_16x16x32_bf16 v[60:63],v[68:71],v[92:95],v[60:63]
v_mfma_f32_16x16x32_bf16 v[52:55],v[68:71],v[88:91],v[52:55]
s_add_u32 m0,s58,5120
s_add_u32 s53,s87,16384
buffer_load_dwordx4 v3,s[32:35],s53 offen lds
ds_read_b64_tr_b16 v[64:65],v5 offset:45056
ds_read_b64_tr_b16 v[66:67],v5 offset:45568
s_waitcnt lgkmcnt(8)
v_mfma_f32_16x16x32_bf16 v[160:163],v[72:75],v[80:83],v[160:163]
ds_read_b64_tr_b16 v[68:69],v6 offset:45056
ds_read_b64_tr_b16 v[70:71],v6 offset:45568
v_mfma_f32_16x16x32_bf16 v[168:171],v[72:75],v[84:87],v[168:171]
s_waitcnt lgkmcnt(8)
v_mfma_f32_16x16x32_bf16 v[172:175],v[76:79],v[84:87],v[172:175]
v_mfma_f32_16x16x32_bf16 v[164:167],v[76:79],v[80:83],v[164:167]
ds_read_b64_tr_b16 v[72:73],v7 offset:45056
ds_read_b64_tr_b16 v[74:75],v7 offset:45568
s_waitcnt lgkmcnt(8)
v_mfma_f32_16x16x32_bf16 v[176:179],v[40:43],v[80:83],v[176:179]
ds_read_b64_tr_b16 v[76:77],v8 offset:45056
ds_read_b64_tr_b16 v[78:79],v8 offset:45568
v_mfma_f32_16x16x32_bf16 v[184:187],v[40:43],v[84:87],v[184:187]
s_waitcnt lgkmcnt(8)
v_mfma_f32_16x16x32_bf16 v[188:191],v[44:47],v[84:87],v[188:191]
v_mfma_f32_16x16x32_bf16 v[180:183],v[44:47],v[80:83],v[180:183]
ds_read_b64_tr_b16 v[40:41],v5 offset:49152
ds_read_b64_tr_b16 v[42:43],v5 offset:49664
s_setprio 1
s_waitcnt lgkmcnt(8)
v_mfma_f32_16x16x32_bf16 v[160:163],v[64:67],v[88:91],v[160:163]
ds_read_b64_tr_b16 v[44:45],v6 offset:49152
ds_read_b64_tr_b16 v[46:47],v6 offset:49664
v_mfma_f32_16x16x32_bf16 v[168:171],v[64:67],v[92:95],v[168:171]
s_waitcnt lgkmcnt(8)
v_mfma_f32_16x16x32_bf16 v[172:175],v[68:71],v[92:95],v[172:175]
v_mfma_f32_16x16x32_bf16 v[164:167],v[68:71],v[88:91],v[164:167]
s_waitcnt vmcnt(11)
ds_read_b128 v[120:123],v9 offset:6144
ds_read_b128 v[124:127],v9 offset:7168
ds_read_b64_tr_b16 v[64:65],v7 offset:49152
ds_read_b64_tr_b16 v[66:67],v7 offset:49664
s_waitcnt lgkmcnt(10)
v_mfma_f32_16x16x32_bf16 v[176:179],v[72:75],v[88:91],v[176:179]
ds_read_b64_tr_b16 v[68:69],v8 offset:49152
ds_read_b64_tr_b16 v[70:71],v8 offset:49664
v_mfma_f32_16x16x32_bf16 v[184:187],v[72:75],v[92:95],v[184:187]
s_mov_b64 s[44:45],s[8:9]
s_mov_b32 s46,4194304
v_and_b32 v22,7,v1
v_lshlrev_b32 v22,13,v22
v_bfe_u32 v23,v1,3,1
v_lshl_add_u32 v22,v23,7,v22
s_waitcnt lgkmcnt(10)
v_mfma_f32_16x16x32_bf16 v[188:191],v[76:79],v[92:95],v[188:191]
v_mfma_f32_16x16x32_bf16 v[180:183],v[76:79],v[88:91],v[180:183]
s_and_b32 s88,s2,7
s_lshl_b32 s88,s88,2
s_bfe_u32 s89,s2,0x20003
s_add_u32 s88,s88,s89
s_lshl_b32 s88,s88,8
s_lshr_b32 s89,s2,5
s_lshl_b32 s89,s89,3
s_add_u32 s89,s89,s50
s_lshl_b32 s89,s89,16
s_add_u32 s88,s88,s89
buffer_load_dword v22,v22,s[44:47],s88 offen
ds_read_b64_tr_b16 v[72:73],v5 offset:53248
ds_read_b64_tr_b16 v[74:75],v5 offset:53760
s_waitcnt lgkmcnt(10)
v_mfma_f32_16x16x32_bf16 v[192:195],v[40:43],v[80:83],v[192:195]
ds_read_b64_tr_b16 v[76:77],v6 offset:53248
ds_read_b64_tr_b16 v[78:79],v6 offset:53760
v_mfma_f32_16x16x32_bf16 v[200:203],v[40:43],v[84:87],v[200:203]
s_waitcnt lgkmcnt(10)
v_mfma_f32_16x16x32_bf16 v[204:207],v[44:47],v[84:87],v[204:207]
v_mfma_f32_16x16x32_bf16 v[196:199],v[44:47],v[80:83],v[196:199]
ds_read_b64_tr_b16 v[40:41],v7 offset:53248
ds_read_b64_tr_b16 v[42:43],v7 offset:53760
s_waitcnt lgkmcnt(8)
v_mfma_f32_16x16x32_bf16 v[208:211],v[64:67],v[80:83],v[208:211]
ds_read_b64_tr_b16 v[44:45],v8 offset:53248
ds_read_b64_tr_b16 v[46:47],v8 offset:53760
v_mfma_f32_16x16x32_bf16 v[216:219],v[64:67],v[84:87],v[216:219]
s_waitcnt lgkmcnt(8)
v_mfma_f32_16x16x32_bf16 v[220:223],v[68:71],v[84:87],v[220:223]
v_mfma_f32_16x16x32_bf16 v[212:215],v[68:71],v[80:83],v[212:215]
s_add_u32 m0,s58,6144
s_add_u32 s53,s87,64
buffer_load_dwordx4 v3,s[32:35],s53 offen lds
ds_read_b64_tr_b16 v[64:65],v5 offset:57344
ds_read_b64_tr_b16 v[66:67],v5 offset:57856
s_waitcnt lgkmcnt(8)
v_mfma_f32_16x16x32_bf16 v[192:195],v[72:75],v[88:91],v[192:195]
ds_read_b64_tr_b16 v[68:69],v6 offset:57344
ds_read_b64_tr_b16 v[70:71],v6 offset:57856
v_mfma_f32_16x16x32_bf16 v[200:203],v[72:75],v[92:95],v[200:203]
s_add_u32 m0,s58,7168
s_add_u32 s53,s87,16448
buffer_load_dwordx4 v3,s[32:35],s53 offen lds
s_waitcnt lgkmcnt(8)
v_mfma_f32_16x16x32_bf16 v[204:207],v[76:79],v[92:95],v[204:207]
v_mfma_f32_16x16x32_bf16 v[196:199],v[76:79],v[88:91],v[196:199]
ds_read_b64_tr_b16 v[72:73],v7 offset:57344
ds_read_b64_tr_b16 v[74:75],v7 offset:57856
s_setprio 0
s_waitcnt lgkmcnt(8)
v_mfma_f32_16x16x32_bf16 v[208:211],v[40:43],v[88:91],v[208:211]
ds_read_b64_tr_b16 v[76:77],v8 offset:57344
ds_read_b64_tr_b16 v[78:79],v8 offset:57856
v_mfma_f32_16x16x32_bf16 v[216:219],v[40:43],v[92:95],v[216:219]
s_waitcnt lgkmcnt(8)
v_mfma_f32_16x16x32_bf16 v[220:223],v[44:47],v[92:95],v[220:223]
v_mfma_f32_16x16x32_bf16 v[212:215],v[44:47],v[88:91],v[212:215]
ds_read_b64_tr_b16 v[40:41],v5 offset:61440
ds_read_b64_tr_b16 v[42:43],v5 offset:61952
s_waitcnt lgkmcnt(8)
v_mfma_f32_16x16x32_bf16 v[224:227],v[64:67],v[80:83],v[224:227]
ds_read_b64_tr_b16 v[44:45],v6 offset:61440
ds_read_b64_tr_b16 v[46:47],v6 offset:61952
v_mfma_f32_16x16x32_bf16 v[232:235],v[64:67],v[84:87],v[232:235]
s_waitcnt lgkmcnt(8)
v_mfma_f32_16x16x32_bf16 v[236:239],v[68:71],v[84:87],v[236:239]
v_mfma_f32_16x16x32_bf16 v[228:231],v[68:71],v[80:83],v[228:231]
ds_read_b64_tr_b16 v[64:65],v7 offset:61440
ds_read_b64_tr_b16 v[66:67],v7 offset:61952
s_waitcnt lgkmcnt(8)
v_mfma_f32_16x16x32_bf16 v[240:243],v[72:75],v[80:83],v[240:243]
ds_read_b64_tr_b16 v[68:69],v8 offset:61440
ds_read_b64_tr_b16 v[70:71],v8 offset:61952
v_mfma_f32_16x16x32_bf16 v[248:251],v[72:75],v[84:87],v[248:251]
s_waitcnt lgkmcnt(8)
v_mfma_f32_16x16x32_bf16 v[252:255],v[76:79],v[84:87],v[252:255]
v_mfma_f32_16x16x32_bf16 v[244:247],v[76:79],v[80:83],v[244:247]
v_add_u32 v5,0x10000,v5
ds_read_b64_tr_b16 v[72:73],v5 offset:0
ds_read_b64_tr_b16 v[74:75],v5 offset:512
s_waitcnt lgkmcnt(8)
v_mfma_f32_16x16x32_bf16 v[224:227],v[40:43],v[88:91],v[224:227]
v_add_u32 v6,0x10000,v6
ds_read_b64_tr_b16 v[76:77],v6 offset:0
ds_read_b64_tr_b16 v[78:79],v6 offset:512
v_mfma_f32_16x16x32_bf16 v[232:235],v[40:43],v[92:95],v[232:235]
s_waitcnt lgkmcnt(8)
v_mfma_f32_16x16x32_bf16 v[236:239],v[44:47],v[92:95],v[236:239]
v_mfma_f32_16x16x32_bf16 v[228:231],v[44:47],v[88:91],v[228:231]
v_add_u32 v7,0x10000,v7
ds_read_b64_tr_b16 v[40:41],v7 offset:0
ds_read_b64_tr_b16 v[42:43],v7 offset:512
s_waitcnt lgkmcnt(8)
v_mfma_f32_16x16x32_bf16 v[240:243],v[64:67],v[88:91],v[240:243]
v_add_u32 v8,0x10000,v8
ds_read_b64_tr_b16 v[44:45],v8 offset:0
ds_read_b64_tr_b16 v[46:47],v8 offset:512
v_mfma_f32_16x16x32_bf16 v[248:251],v[64:67],v[92:95],v[248:251]
s_waitcnt lgkmcnt(8)
v_mfma_f32_16x16x32_bf16 v[252:255],v[68:71],v[92:95],v[252:255]
v_mfma_f32_16x16x32_bf16 v[244:247],v[68:71],v[88:91],v[244:247]
s_waitcnt vmcnt(6)
s_barrier
ds_read_b64_tr_b16 v[64:65],v5 offset:4096
ds_read_b64_tr_b16 v[66:67],v5 offset:4608
s_setprio 3
s_waitcnt lgkmcnt(8)
v_mfma_f32_16x16x32_bf16 v[128:131],v[72:75],v[96:99],v[128:131]
s_add_u32 m0,s60,90112
s_add_u32 s53,s79,128
buffer_load_dwordx4 v2,s[36:39],s53 offen lds
ds_read_b64_tr_b16 v[68:69],v6 offset:4096
ds_read_b64_tr_b16 v[70:71],v6 offset:4608
v_mfma_f32_16x16x32_bf16 v[136:139],v[72:75],v[100:103],v[136:139]
ds_read_b128 v[80:83],v9 offset:0
ds_read_b128 v[84:87],v9 offset:1024
s_waitcnt lgkmcnt(10)
v_mfma_f32_16x16x32_bf16 v[140:143],v[76:79],v[100:103],v[140:143]
v_mfma_f32_16x16x32_bf16 v[132:135],v[76:79],v[96:99],v[132:135]
ds_read_b64_tr_b16 v[72:73],v7 offset:4096
ds_read_b64_tr_b16 v[74:75],v7 offset:4608
s_waitcnt lgkmcnt(10)
v_mfma_f32_16x16x32_bf16 v[144:147],v[40:43],v[96:99],v[144:147]
ds_read_b64_tr_b16 v[76:77],v8 offset:4096
ds_read_b64_tr_b16 v[78:79],v8 offset:4608
v_mfma_f32_16x16x32_bf16 v[152:155],v[40:43],v[100:103],v[152:155]
s_cmp_lg_u32 s50,0
s_cbranch_scc1 L_tag2
s_cmp_lg_u32 s101,0
s_cbranch_scc1 L_tag2
s_waitcnt vmcnt(10)
v_readfirstlane_b32 s96,v14
s_cmp_lg_u32 s96,0
s_cbranch_scc1 L_tag2
s_call_b64 s[66:67],L_tag_slow
L_tag2:
s_waitcnt lgkmcnt(10)
v_mfma_f32_16x16x32_bf16 v[156:159],v[44:47],v[100:103],v[156:159]
v_mfma_f32_16x16x32_bf16 v[148:151],v[44:47],v[96:99],v[148:151]
s_add_u32 m0,s60,98304
s_add_u32 s53,s77,256
buffer_load_dwordx4 v2,s[36:39],s53 offen lds
ds_read_b64_tr_b16 v[40:41],v5 offset:8192
ds_read_b64_tr_b16 v[42:43],v5 offset:8704
s_waitcnt lgkmcnt(10)
v_mfma_f32_16x16x32_bf16 v[128:131],v[64:67],v[104:107],v[128:131]
ds_read_b64_tr_b16 v[44:45],v6 offset:8192
ds_read_b64_tr_b16 v[46:47],v6 offset:8704
v_mfma_f32_16x16x32_bf16 v[136:139],v[64:67],v[108:111],v[136:139]
s_waitcnt lgkmcnt(10)
v_mfma_f32_16x16x32_bf16 v[140:143],v[68:71],v[108:111],v[140:143]
v_mfma_f32_16x16x32_bf16 v[132:135],v[68:71],v[104:107],v[132:135]
ds_read_b64_tr_b16 v[64:65],v7 offset:8192
ds_read_b64_tr_b16 v[66:67],v7 offset:8704
s_waitcnt lgkmcnt(8)
v_mfma_f32_16x16x32_bf16 v[144:147],v[72:75],v[104:107],v[144:147]
s_add_u32 m0,s60,106496
s_add_u32 s53,s78,256
buffer_load_dwordx4 v2,s[36:39],s53 offen lds
ds_read_b64_tr_b16 v[68:69],v8 offset:8192
ds_read_b64_tr_b16 v[70:71],v8 offset:8704
v_mfma_f32_16x16x32_bf16 v[152:155],v[72:75],v[108:111],v[152:155]
s_add_u32 m0,s58,0
s_add_u32 s53,s84,0
buffer_load_dwordx4 v3,s[32:35],s53 offen lds
s_waitcnt lgkmcnt(8)
v_mfma_f32_16x16x32_bf16 v[156:159],v[76:79],v[108:111],v[156:159]
ds_read_b128 v[88:91],v9 offset:2048
ds_read_b128 v[92:95],v9 offset:3072
v_mfma_f32_16x16x32_bf16 v[148:151],v[76:79],v[104:107],v[148:151]
s_add_u32 m0,s58,1024
s_add_u32 s53,s84,16384
buffer_load_dwordx4 v3,s[32:35],s53 offen lds
ds_read_b64_tr_b16 v[72:73],v5 offset:12288
ds_read_b64_tr_b16 v[74:75],v5 offset:12800
s_waitcnt lgkmcnt(10)
v_mfma_f32_16x16x32_bf16 v[24:27],v[40:43],v[96:99],v[24:27]
ds_read_b64_tr_b16 v[76:77],v6 offset:12288
ds_read_b64_tr_b16 v[78:79],v6 offset:12800
v_mfma_f32_16x16x32_bf16 v[32:35],v[40:43],v[100:103],v[32:35]
s_waitcnt lgkmcnt(10)
v_mfma_f32_16x16x32_bf16 v[36:39],v[44:47],v[100:103],v[36:39]
v_mfma_f32_16x16x32_bf16 v[28:31],v[44:47],v[96:99],v[28:31]
s_add_u32 m0,s60,114688
s_add_u32 s53,s79,256
buffer_load_dwordx4 v2,s[36:39],s53 offen lds
ds_read_b64_tr_b16 v[40:41],v7 offset:12288
ds_read_b64_tr_b16 v[42:43],v7 offset:12800
s_setprio 2
s_waitcnt lgkmcnt(10)
v_mfma_f32_16x16x32_bf16 v[48:51],v[64:67],v[96:99],v[48:51]
ds_read_b64_tr_b16 v[44:45],v8 offset:12288
ds_read_b64_tr_b16 v[46:47],v8 offset:12800
v_mfma_f32_16x16x32_bf16 v[56:59],v[64:67],v[100:103],v[56:59]
s_waitcnt lgkmcnt(10)
v_mfma_f32_16x16x32_bf16 v[60:63],v[68:71],v[100:103],v[60:63]
v_mfma_f32_16x16x32_bf16 v[52:55],v[68:71],v[96:99],v[52:55]
ds_read_b64_tr_b16 v[64:65],v5 offset:16384
ds_read_b64_tr_b16 v[66:67],v5 offset:16896
s_waitcnt lgkmcnt(8)
v_mfma_f32_16x16x32_bf16 v[24:27],v[72:75],v[104:107],v[24:27]
ds_read_b64_tr_b16 v[68:69],v6 offset:16384
ds_read_b64_tr_b16 v[70:71],v6 offset:16896
v_mfma_f32_16x16x32_bf16 v[32:35],v[72:75],v[108:111],v[32:35]
s_add_u32 m0,s60,122880
s_add_u32 s53,s76,256
buffer_load_dwordx4 v2,s[36:39],s53 offen lds
s_waitcnt lgkmcnt(8)
v_mfma_f32_16x16x32_bf16 v[36:39],v[76:79],v[108:111],v[36:39]
v_mfma_f32_16x16x32_bf16 v[28:31],v[76:79],v[104:107],v[28:31]
s_add_u32 m0,s58,2048
s_add_u32 s53,s84,64
buffer_load_dwordx4 v3,s[32:35],s53 offen lds
ds_read_b64_tr_b16 v[72:73],v7 offset:16384
ds_read_b64_tr_b16 v[74:75],v7 offset:16896
s_waitcnt lgkmcnt(8)
v_mfma_f32_16x16x32_bf16 v[48:51],v[40:43],v[104:107],v[48:51]
ds_read_b64_tr_b16 v[76:77],v8 offset:16384
ds_read_b64_tr_b16 v[78:79],v8 offset:16896
v_mfma_f32_16x16x32_bf16 v[56:59],v[40:43],v[108:111],v[56:59]
s_add_u32 m0,s58,3072
s_add_u32 s53,s84,16448
buffer_load_dwordx4 v3,s[32:35],s53 offen lds
s_waitcnt lgkmcnt(8)
v_mfma_f32_16x16x32_bf16 v[60:63],v[44:47],v[108:111],v[60:63]
v_mfma_f32_16x16x32_bf16 v[52:55],v[44:47],v[104:107],v[52:55]
ds_read_b64_tr_b16 v[40:41],v5 offset:20480
ds_read_b64_tr_b16 v[42:43],v5 offset:20992
s_waitcnt lgkmcnt(8)
v_mfma_f32_16x16x32_bf16 v[128:131],v[64:67],v[112:115],v[128:131]
ds_read_b64_tr_b16 v[44:45],v6 offset:20480
ds_read_b64_tr_b16 v[46:47],v6 offset:20992
v_mfma_f32_16x16x32_bf16 v[136:139],v[64:67],v[116:119],v[136:139]
s_waitcnt lgkmcnt(8)
v_mfma_f32_16x16x32_bf16 v[140:143],v[68:71],v[116:119],v[140:143]
v_mfma_f32_16x16x32_bf16 v[132:135],v[68:71],v[112:115],v[132:135]
ds_read_b64_tr_b16 v[64:65],v7 offset:20480
ds_read_b64_tr_b16 v[66:67],v7 offset:20992
s_waitcnt lgkmcnt(8)
v_mfma_f32_16x16x32_bf16 v[144:147],v[72:75],v[112:115],v[144:147]
ds_read_b64_tr_b16 v[68:69],v8 offset:20480
ds_read_b64_tr_b16 v[70:71],v8 offset:20992
v_mfma_f32_16x16x32_bf16 v[152:155],v[72:75],v[116:119],v[152:155]
s_waitcnt lgkmcnt(8)
v_mfma_f32_16x16x32_bf16 v[156:159],v[76:79],v[116:119],v[156:159]
v_mfma_f32_16x16x32_bf16 v[148:151],v[76:79],v[112:115],v[148:151]
ds_read_b64_tr_b16 v[72:73],v5 offset:24576
ds_read_b64_tr_b16 v[74:75],v5 offset:25088
s_setprio 1
s_waitcnt lgkmcnt(8)
v_mfma_f32_16x16x32_bf16 v[128:131],v[40:43],v[120:123],v[128:131]
ds_read_b64_tr_b16 v[76:77],v6 offset:24576
ds_read_b64_tr_b16 v[78:79],v6 offset:25088
v_mfma_f32_16x16x32_bf16 v[136:139],v[40:43],v[124:127],v[136:139]
s_waitcnt vmcnt(12)
ds_read_b128 v[96:99],v9 offset:4096
ds_read_b128 v[100:103],v9 offset:5120
s_waitcnt lgkmcnt(10)
v_mfma_f32_16x16x32_bf16 v[140:143],v[44:47],v[124:127],v[140:143]
v_mfma_f32_16x16x32_bf16 v[132:135],v[44:47],v[120:123],v[132:135]
ds_read_b64_tr_b16 v[40:41],v7 offset:24576
ds_read_b64_tr_b16 v[42:43],v7 offset:25088
s_waitcnt lgkmcnt(10)
v_mfma_f32_16x16x32_bf16 v[144:147],v[64:67],v[120:123],v[144:147]
ds_read_b64_tr_b16 v[44:45],v8 offset:24576
ds_read_b64_tr_b16 v[46:47],v8 offset:25088
v_mfma_f32_16x16x32_bf16 v[152:155],v[64:67],v[124:127],v[152:155]
s_waitcnt lgkmcnt(10)
v_mfma_f32_16x16x32_bf16 v[156:159],v[68:71],v[124:127],v[156:159]
v_mfma_f32_16x16x32_bf16 v[148:151],v[68:71],v[120:123],v[148:151]
ds_read_b64_tr_b16 v[64:65],v5 offset:28672
ds_read_b64_tr_b16 v[66:67],v5 offset:29184
s_waitcnt lgkmcnt(10)
v_mfma_f32_16x16x32_bf16 v[128:131],v[72:75],v[80:83],v[128:131]
ds_read_b64_tr_b16 v[68:69],v6 offset:28672
ds_read_b64_tr_b16 v[70:71],v6 offset:29184
v_mfma_f32_16x16x32_bf16 v[136:139],v[72:75],v[84:87],v[136:139]
s_waitcnt lgkmcnt(10)
v_mfma_f32_16x16x32_bf16 v[140:143],v[76:79],v[84:87],v[140:143]
v_mfma_f32_16x16x32_bf16 v[132:135],v[76:79],v[80:83],v[132:135]
ds_read_b64_tr_b16 v[72:73],v7 offset:28672
ds_read_b64_tr_b16 v[74:75],v7 offset:29184
s_waitcnt lgkmcnt(8)
v_mfma_f32_16x16x32_bf16 v[144:147],v[40:43],v[80:83],v[144:147]
ds_read_b64_tr_b16 v[76:77],v8 offset:28672
ds_read_b64_tr_b16 v[78:79],v8 offset:29184
v_mfma_f32_16x16x32_bf16 v[152:155],v[40:43],v[84:87],v[152:155]
s_waitcnt lgkmcnt(8)
v_mfma_f32_16x16x32_bf16 v[156:159],v[44:47],v[84:87],v[156:159]
v_mfma_f32_16x16x32_bf16 v[148:151],v[44:47],v[80:83],v[148:151]
v_add_u32 v5,0xffff0000,v5
ds_read_b64_tr_b16 v[40:41],v5 offset:0
ds_read_b64_tr_b16 v[42:43],v5 offset:512
s_waitcnt lgkmcnt(8)
v_mfma_f32_16x16x32_bf16 v[128:131],v[64:67],v[88:91],v[128:131]
v_add_u32 v6,0xffff0000,v6
ds_read_b64_tr_b16 v[44:45],v6 offset:0
ds_read_b64_tr_b16 v[46:47],v6 offset:512
v_mfma_f32_16x16x32_bf16 v[136:139],v[64:67],v[92:95],v[136:139]
s_waitcnt lgkmcnt(8)
v_mfma_f32_16x16x32_bf16 v[140:143],v[68:71],v[92:95],v[140:143]
v_mfma_f32_16x16x32_bf16 v[132:135],v[68:71],v[88:91],v[132:135]
v_add_u32 v7,0xffff0000,v7
ds_read_b64_tr_b16 v[64:65],v7 offset:0
ds_read_b64_tr_b16 v[66:67],v7 offset:512
s_setprio 0
s_waitcnt lgkmcnt(8)
v_mfma_f32_16x16x32_bf16 v[144:147],v[72:75],v[88:91],v[144:147]
v_add_u32 v8,0xffff0000,v8
ds_read_b64_tr_b16 v[68:69],v8 offset:0
ds_read_b64_tr_b16 v[70:71],v8 offset:512
v_mfma_f32_16x16x32_bf16 v[152:155],v[72:75],v[92:95],v[152:155]
s_waitcnt lgkmcnt(8)
v_mfma_f32_16x16x32_bf16 v[156:159],v[76:79],v[92:95],v[156:159]
v_mfma_f32_16x16x32_bf16 v[148:151],v[76:79],v[88:91],v[148:151]
ds_read_b64_tr_b16 v[72:73],v5 offset:4096
ds_read_b64_tr_b16 v[74:75],v5 offset:4608
s_waitcnt lgkmcnt(8)
v_mfma_f32_16x16x32_bf16 v[128:131],v[40:43],v[96:99],v[128:131]
ds_read_b64_tr_b16 v[76:77],v6 offset:4096
ds_read_b64_tr_b16 v[78:79],v6 offset:4608
v_mfma_f32_16x16x32_bf16 v[136:139],v[40:43],v[100:103],v[136:139]
s_waitcnt lgkmcnt(8)
v_mfma_f32_16x16x32_bf16 v[140:143],v[44:47],v[100:103],v[140:143]
v_mfma_f32_16x16x32_bf16 v[132:135],v[44:47],v[96:99],v[132:135]
s_waitcnt vmcnt(9)
ds_read_b128 v[104:107],v9 offset:6144
ds_read_b128 v[108:111],v9 offset:7168
ds_read_b64_tr_b16 v[40:41],v7 offset:4096
ds_read_b64_tr_b16 v[42:43],v7 offset:4608
s_waitcnt lgkmcnt(10)
v_mfma_f32_16x16x32_bf16 v[144:147],v[64:67],v[96:99],v[144:147]
ds_read_b64_tr_b16 v[44:45],v8 offset:4096
ds_read_b64_tr_b16 v[46:47],v8 offset:4608
v_mfma_f32_16x16x32_bf16 v[152:155],v[64:67],v[100:103],v[152:155]
s_waitcnt lgkmcnt(10)
v_mfma_f32_16x16x32_bf16 v[156:159],v[68:71],v[100:103],v[156:159]
v_mfma_f32_16x16x32_bf16 v[148:151],v[68:71],v[96:99],v[148:151]
ds_read_b64_tr_b16 v[64:65],v5 offset:8192
ds_read_b64_tr_b16 v[66:67],v5 offset:8704
s_waitcnt lgkmcnt(7)
v_mfma_f32_16x16x32_bf16 v[128:131],v[72:75],v[104:107],v[128:131]
ds_read_b64_tr_b16 v[68:69],v6 offset:8192
ds_read_b64_tr_b16 v[70:71],v6 offset:8704
s_waitcnt lgkmcnt(8)
v_mfma_f32_16x16x32_bf16 v[136:139],v[72:75],v[108:111],v[136:139]
v_mfma_f32_16x16x32_bf16 v[140:143],v[76:79],v[108:111],v[140:143]
v_mfma_f32_16x16x32_bf16 v[132:135],v[76:79],v[104:107],v[132:135]
ds_read_b64_tr_b16 v[72:73],v7 offset:8192
ds_read_b64_tr_b16 v[74:75],v7 offset:8704
s_waitcnt lgkmcnt(8)
v_mfma_f32_16x16x32_bf16 v[144:147],v[40:43],v[104:107],v[144:147]
ds_read_b64_tr_b16 v[76:77],v8 offset:8192
ds_read_b64_tr_b16 v[78:79],v8 offset:8704
v_mfma_f32_16x16x32_bf16 v[152:155],v[40:43],v[108:111],v[152:155]
s_waitcnt lgkmcnt(8)
v_mfma_f32_16x16x32_bf16 v[156:159],v[44:47],v[108:111],v[156:159]
v_mfma_f32_16x16x32_bf16 v[148:151],v[44:47],v[104:107],v[148:151]
s_waitcnt vmcnt(7)
s_barrier
ds_read_b64_tr_b16 v[40:41],v5 offset:12288
ds_read_b64_tr_b16 v[42:43],v5 offset:12800
s_setprio 3
s_waitcnt lgkmcnt(8)
v_mfma_f32_16x16x32_bf16 v[24:27],v[64:67],v[112:115],v[24:27]
ds_read_b64_tr_b16 v[44:45],v6 offset:12288
ds_read_b64_tr_b16 v[46:47],v6 offset:12800
v_mfma_f32_16x16x32_bf16 v[32:35],v[64:67],v[116:119],v[32:35]
s_add_u32 m0,s60,131072
s_add_u32 s53,s77,384
buffer_load_dwordx4 v2,s[36:39],s53 offen lds
s_waitcnt lgkmcnt(8)
v_mfma_f32_16x16x32_bf16 v[36:39],v[68:71],v[116:119],v[36:39]
v_mfma_f32_16x16x32_bf16 v[28:31],v[68:71],v[112:115],v[28:31]
s_add_u32 m0,s60,139264
s_add_u32 s53,s78,384
buffer_load_dwordx4 v2,s[36:39],s53 offen lds
ds_read_b64_tr_b16 v[64:65],v7 offset:12288
ds_read_b64_tr_b16 v[66:67],v7 offset:12800
s_waitcnt lgkmcnt(8)
v_mfma_f32_16x16x32_bf16 v[48:51],v[72:75],v[112:115],v[48:51]
s_add_u32 s54,s51,0
ds_read_b64_tr_b16 v[68:69],v8 offset:12288
ds_read_b64_tr_b16 v[70:71],v8 offset:12800
v_mfma_f32_16x16x32_bf16 v[56:59],v[72:75],v[116:119],v[56:59]
s_lshr_b32 s57,s54,1
s_lshl_b32 s57,s57,20
s_waitcnt lgkmcnt(8)
v_mfma_f32_16x16x32_bf16 v[60:63],v[76:79],v[116:119],v[60:63]
s_add_u32 m0,s60,147456
s_add_u32 s53,s79,384
buffer_load_dwordx4 v2,s[36:39],s53 offen lds
s_and_b32 s54,s54,1
v_mfma_f32_16x16x32_bf16 v[52:55],v[76:79],v[112:115],v[52:55]
s_lshl_b32 s54,s54,12
s_add_u32 s57,s57,s54
ds_read_b64_tr_b16 v[72:73],v5 offset:16384
ds_read_b64_tr_b16 v[74:75],v5 offset:16896
s_waitcnt lgkmcnt(8)
v_mfma_f32_16x16x32_bf16 v[24:27],v[40:43],v[120:123],v[24:27]
v_mul_f32 v128,s71,v128
ds_read_b64_tr_b16 v[76:77],v6 offset:16384
ds_read_b64_tr_b16 v[78:79],v6 offset:16896
v_mfma_f32_16x16x32_bf16 v[32:35],v[40:43],v[124:127],v[32:35]
v_mul_f32 v129,s71,v129
v_cvt_pk_bf16_f32 v128,v128,v129
s_waitcnt lgkmcnt(8)
v_mfma_f32_16x16x32_bf16 v[36:39],v[44:47],v[124:127],v[36:39]
s_add_u32 m0,s60,155648
s_add_u32 s53,s76,384
buffer_load_dwordx4 v2,s[36:39],s53 offen lds
v_mul_f32 v130,s71,v130
v_mfma_f32_16x16x32_bf16 v[28:31],v[44:47],v[120:123],v[28:31]
v_mul_f32 v131,s71,v131
v_cvt_pk_bf16_f32 v129,v130,v131
ds_read_b64_tr_b16 v[40:41],v7 offset:16384
ds_read_b64_tr_b16 v[42:43],v7 offset:16896
s_setprio 2
s_waitcnt lgkmcnt(8)
v_mfma_f32_16x16x32_bf16 v[48:51],v[64:67],v[120:123],v[48:51]
v_mul_f32 v132,s71,v132
ds_read_b64_tr_b16 v[44:45],v8 offset:16384
ds_read_b64_tr_b16 v[46:47],v8 offset:16896
v_mfma_f32_16x16x32_bf16 v[56:59],v[64:67],v[124:127],v[56:59]
v_mul_f32 v133,s71,v133
v_cvt_pk_bf16_f32 v130,v132,v133
s_waitcnt lgkmcnt(8)
v_mfma_f32_16x16x32_bf16 v[60:63],v[68:71],v[124:127],v[60:63]
s_add_u32 m0,s60,65536
s_add_u32 s53,s77,512
buffer_load_dwordx4 v2,s[36:39],s53 offen lds
v_mul_f32 v134,s71,v134
v_mfma_f32_16x16x32_bf16 v[52:55],v[68:71],v[120:123],v[52:55]
v_mul_f32 v135,s71,v135
v_cvt_pk_bf16_f32 v131,v134,v135
ds_read_b64_tr_b16 v[64:65],v5 offset:20480
ds_read_b64_tr_b16 v[66:67],v5 offset:20992
s_waitcnt lgkmcnt(8)
v_mfma_f32_16x16x32_bf16 v[24:27],v[72:75],v[80:83],v[24:27]
buffer_store_dwordx4 v[128:131],v4,s[40:43],s57 offen offset:0 sc1
ds_read_b64_tr_b16 v[68:69],v6 offset:20480
ds_read_b64_tr_b16 v[70:71],v6 offset:20992
v_mfma_f32_16x16x32_bf16 v[32:35],v[72:75],v[84:87],v[32:35]
v_mul_f32 v136,s71,v136
v_mul_f32 v137,s71,v137
s_waitcnt lgkmcnt(8)
v_mfma_f32_16x16x32_bf16 v[36:39],v[76:79],v[84:87],v[36:39]
v_cvt_pk_bf16_f32 v132,v136,v137
v_mfma_f32_16x16x32_bf16 v[28:31],v[76:79],v[80:83],v[28:31]
v_mul_f32 v138,s71,v138
v_mul_f32 v139,s71,v139
ds_read_b64_tr_b16 v[72:73],v7 offset:20480
ds_read_b64_tr_b16 v[74:75],v7 offset:20992
s_waitcnt lgkmcnt(8)
v_mfma_f32_16x16x32_bf16 v[48:51],v[40:43],v[80:83],v[48:51]
v_cvt_pk_bf16_f32 v133,v138,v139
ds_read_b64_tr_b16 v[76:77],v8 offset:20480
ds_read_b64_tr_b16 v[78:79],v8 offset:20992
v_mfma_f32_16x16x32_bf16 v[56:59],v[40:43],v[84:87],v[56:59]
v_mul_f32 v140,s71,v140
v_mul_f32 v141,s71,v141
s_waitcnt lgkmcnt(8)
v_mfma_f32_16x16x32_bf16 v[60:63],v[44:47],v[84:87],v[60:63]
v_cvt_pk_bf16_f32 v134,v140,v141
v_mfma_f32_16x16x32_bf16 v[52:55],v[44:47],v[80:83],v[52:55]
v_mul_f32 v142,s71,v142
ds_read_b64_tr_b16 v[40:41],v5 offset:24576
ds_read_b64_tr_b16 v[42:43],v5 offset:25088
s_setprio 1
s_waitcnt lgkmcnt(8)
v_mfma_f32_16x16x32_bf16 v[24:27],v[64:67],v[88:91],v[24:27]
v_mul_f32 v143,s71,v143
ds_read_b64_tr_b16 v[44:45],v6 offset:24576
ds_read_b64_tr_b16 v[46:47],v6 offset:25088
v_mfma_f32_16x16x32_bf16 v[32:35],v[64:67],v[92:95],v[32:35]
v_cvt_pk_bf16_f32 v135,v142,v143
buffer_store_dwordx4 v[132:135],v4,s[40:43],s57 offen offset:256 sc1
s_waitcnt lgkmcnt(8)
v_mfma_f32_16x16x32_bf16 v[36:39],v[68:71],v[92:95],v[36:39]
v_mul_f32 v144,s71,v144
v_mfma_f32_16x16x32_bf16 v[28:31],v[68:71],v[88:91],v[28:31]
v_mul_f32 v145,s71,v145
v_cvt_pk_bf16_f32 v144,v144,v145
ds_read_b64_tr_b16 v[64:65],v7 offset:24576
ds_read_b64_tr_b16 v[66:67],v7 offset:25088
s_waitcnt lgkmcnt(8)
v_mfma_f32_16x16x32_bf16 v[48:51],v[72:75],v[88:91],v[48:51]
v_mul_f32 v146,s71,v146
ds_read_b64_tr_b16 v[68:69],v8 offset:24576
ds_read_b64_tr_b16 v[70:71],v8 offset:25088
v_mfma_f32_16x16x32_bf16 v[56:59],v[72:75],v[92:95],v[56:59]
v_mul_f32 v147,s71,v147
v_cvt_pk_bf16_f32 v145,v146,v147
s_waitcnt lgkmcnt(8)
v_mfma_f32_16x16x32_bf16 v[60:63],v[76:79],v[92:95],v[60:63]
v_mul_f32 v148,s71,v148
v_mfma_f32_16x16x32_bf16 v[52:55],v[76:79],v[88:91],v[52:55]
v_mul_f32 v149,s71,v149
v_cvt_pk_bf16_f32 v146,v148,v149
ds_read_b64_tr_b16 v[72:73],v5 offset:28672
ds_read_b64_tr_b16 v[74:75],v5 offset:29184
s_waitcnt lgkmcnt(8)
v_mfma_f32_16x16x32_bf16 v[24:27],v[40:43],v[96:99],v[24:27]
v_mul_f32 v150,s71,v150
ds_read_b64_tr_b16 v[76:77],v6 offset:28672
ds_read_b64_tr_b16 v[78:79],v6 offset:29184
v_mfma_f32_16x16x32_bf16 v[32:35],v[40:43],v[100:103],v[32:35]
v_mul_f32 v151,s71,v151
v_cvt_pk_bf16_f32 v147,v150,v151
s_waitcnt lgkmcnt(8)
v_mfma_f32_16x16x32_bf16 v[36:39],v[44:47],v[100:103],v[36:39]
buffer_store_dwordx4 v[144:147],v4,s[40:43],s57 offen offset:2048 sc1
v_mfma_f32_16x16x32_bf16 v[28:31],v[44:47],v[96:99],v[28:31]
v_mul_f32 v152,s71,v152
v_mul_f32 v153,s71,v153
ds_read_b64_tr_b16 v[40:41],v7 offset:28672
ds_read_b64_tr_b16 v[42:43],v7 offset:29184
s_setprio 0
s_waitcnt lgkmcnt(8)
v_mfma_f32_16x16x32_bf16 v[48:51],v[64:67],v[96:99],v[48:51]
v_cvt_pk_bf16_f32 v148,v152,v153
ds_read_b64_tr_b16 v[44:45],v8 offset:28672
ds_read_b64_tr_b16 v[46:47],v8 offset:29184
v_mfma_f32_16x16x32_bf16 v[56:59],v[64:67],v[100:103],v[56:59]
v_mul_f32 v154,s71,v154
v_mul_f32 v155,s71,v155
s_waitcnt lgkmcnt(8)
v_mfma_f32_16x16x32_bf16 v[60:63],v[68:71],v[100:103],v[60:63]
v_cvt_pk_bf16_f32 v149,v154,v155
v_mfma_f32_16x16x32_bf16 v[52:55],v[68:71],v[96:99],v[52:55]
v_mul_f32 v156,s71,v156
v_mul_f32 v157,s71,v157
ds_read_b64_tr_b16 v[64:65],v5 offset:32768
ds_read_b64_tr_b16 v[66:67],v5 offset:33280
s_waitcnt lgkmcnt(8)
v_mfma_f32_16x16x32_bf16 v[24:27],v[72:75],v[104:107],v[24:27]
v_cvt_pk_bf16_f32 v150,v156,v157
ds_read_b64_tr_b16 v[68:69],v6 offset:32768
ds_read_b64_tr_b16 v[70:71],v6 offset:33280
v_mfma_f32_16x16x32_bf16 v[32:35],v[72:75],v[108:111],v[32:35]
v_mul_f32 v158,s71,v158
v_mul_f32 v159,s71,v159
s_waitcnt lgkmcnt(8)
v_mfma_f32_16x16x32_bf16 v[36:39],v[76:79],v[108:111],v[36:39]
v_cvt_pk_bf16_f32 v151,v158,v159
v_mfma_f32_16x16x32_bf16 v[28:31],v[76:79],v[104:107],v[28:31]
buffer_store_dwordx4 v[148:151],v4,s[40:43],s57 offen offset:2304 sc1
ds_read_b64_tr_b16 v[72:73],v7 offset:32768
ds_read_b64_tr_b16 v[74:75],v7 offset:33280
s_waitcnt lgkmcnt(8)
v_mfma_f32_16x16x32_bf16 v[48:51],v[40:43],v[104:107],v[48:51]
ds_read_b64_tr_b16 v[76:77],v8 offset:32768
ds_read_b64_tr_b16 v[78:79],v8 offset:33280
v_mfma_f32_16x16x32_bf16 v[56:59],v[40:43],v[108:111],v[56:59]
s_waitcnt lgkmcnt(8)
v_mfma_f32_16x16x32_bf16 v[60:63],v[44:47],v[108:111],v[60:63]
v_mfma_f32_16x16x32_bf16 v[52:55],v[44:47],v[104:107],v[52:55]
s_waitcnt vmcnt(8)
s_barrier
ds_read_b64_tr_b16 v[40:41],v5 offset:36864
ds_read_b64_tr_b16 v[42:43],v5 offset:37376
s_setprio 3
s_waitcnt lgkmcnt(8)
v_mfma_f32_16x16x32_bf16 v[160:163],v[64:67],v[112:115],v[160:163]
ds_read_b64_tr_b16 v[44:45],v6 offset:36864
ds_read_b64_tr_b16 v[46:47],v6 offset:37376
v_mfma_f32_16x16x32_bf16 v[168:171],v[64:67],v[116:119],v[168:171]
s_add_u32 m0,s60,73728
s_add_u32 s53,s78,512
buffer_load_dwordx4 v2,s[36:39],s53 offen lds
s_waitcnt lgkmcnt(8)
v_mfma_f32_16x16x32_bf16 v[172:175],v[68:71],v[116:119],v[172:175]
v_mfma_f32_16x16x32_bf16 v[164:167],v[68:71],v[112:115],v[164:167]
s_add_u32 m0,s60,81920
s_add_u32 s53,s79,512
buffer_load_dwordx4 v2,s[36:39],s53 offen lds
ds_read_b64_tr_b16 v[64:65],v7 offset:36864
ds_read_b64_tr_b16 v[66:67],v7 offset:37376
s_waitcnt lgkmcnt(8)
v_mfma_f32_16x16x32_bf16 v[176:179],v[72:75],v[112:115],v[176:179]
s_add_u32 s54,s51,1
ds_read_b64_tr_b16 v[68:69],v8 offset:36864
ds_read_b64_tr_b16 v[70:71],v8 offset:37376
v_mfma_f32_16x16x32_bf16 v[184:187],v[72:75],v[116:119],v[184:187]
s_lshr_b32 s57,s54,1
s_lshl_b32 s57,s57,20
s_waitcnt lgkmcnt(8)
v_mfma_f32_16x16x32_bf16 v[188:191],v[76:79],v[116:119],v[188:191]
s_add_u32 m0,s60,90112
s_add_u32 s53,s76,512
buffer_load_dwordx4 v2,s[36:39],s53 offen lds
v_mfma_f32_16x16x32_bf16 v[180:183],v[76:79],v[112:115],v[180:183]
s_and_b32 s54,s54,1
s_lshl_b32 s54,s54,12
ds_read_b64_tr_b16 v[72:73],v5 offset:40960
ds_read_b64_tr_b16 v[74:75],v5 offset:41472
s_waitcnt lgkmcnt(8)
v_mfma_f32_16x16x32_bf16 v[160:163],v[40:43],v[120:123],v[160:163]
ds_read_b128 v[128:131],v9 offset:0
ds_read_b128 v[132:135],v9 offset:1024
v_mov_b32 v14,s96
v_min_u32 v23,47,v1
v_lshlrev_b32 v23,2,v23
s_and_b32 s88,s2,7
s_lshl_b32 s88,s88,8
s_add_u32 s88,s88,101787648
v_add_u32 v23,s88,v23
s_mov_b32 s7,0
s_cmp_lg_u32 s50,0
s_cbranch_scc1 L_xfp3
s_cmp_lg_u32 s3,s2
s_cbranch_scc1 L_xfp3
buffer_load_dword v14,v23,s[40:43],0 offen sc1
L_xfp3:
ds_read_b64_tr_b16 v[76:77],v6 offset:40960
ds_read_b64_tr_b16 v[78:79],v6 offset:41472
v_mfma_f32_16x16x32_bf16 v[168:171],v[40:43],v[124:127],v[168:171]
s_add_u32 s57,s57,s54
v_mul_f32 v24,s71,v24
s_waitcnt lgkmcnt(10)
v_mfma_f32_16x16x32_bf16 v[172:175],v[44:47],v[124:127],v[172:175]
s_mov_b64 s[76:77],s[8:9]
s_mov_b32 s78,4194304
v_mfma_f32_16x16x32_bf16 v[164:167],v[44:47],v[120:123],v[164:167]
v_mul_f32 v25,s71,v25
v_cvt_pk_bf16_f32 v24,v24,v25
ds_read_b64_tr_b16 v[40:41],v7 offset:40960
ds_read_b64_tr_b16 v[42:43],v7 offset:41472
s_waitcnt lgkmcnt(10)
v_mfma_f32_16x16x32_bf16 v[176:179],v[64:67],v[120:123],v[176:179]
s_mov_b32 s79,0x20000
s_mov_b64 s[8:9],s[40:41]
ds_read_b64_tr_b16 v[44:45],v8 offset:40960
ds_read_b64_tr_b16 v[46:47],v8 offset:41472
v_mfma_f32_16x16x32_bf16 v[184:187],v[64:67],v[124:127],v[184:187]
v_mul_f32 v26,s71,v26
v_mul_f32 v27,s71,v27
s_waitcnt lgkmcnt(10)
v_mfma_f32_16x16x32_bf16 v[188:191],v[68:71],v[124:127],v[188:191]
s_mov_b32 s10,268435456
s_mov_b32 s11,0x20000
v_mfma_f32_16x16x32_bf16 v[180:183],v[68:71],v[120:123],v[180:183]
v_cvt_pk_bf16_f32 v25,v26,v27
v_mul_f32 v28,s71,v28
ds_read_b64_tr_b16 v[64:65],v5 offset:45056
ds_read_b64_tr_b16 v[66:67],v5 offset:45568
s_setprio 2
s_waitcnt lgkmcnt(10)
v_mfma_f32_16x16x32_bf16 v[160:163],v[72:75],v[80:83],v[160:163]
s_mov_b64 s[12:13],s[14:15]
s_mov_b32 s14,4194304
ds_read_b64_tr_b16 v[68:69],v6 offset:45056
ds_read_b64_tr_b16 v[70:71],v6 offset:45568
v_mfma_f32_16x16x32_bf16 v[168:171],v[72:75],v[84:87],v[168:171]
v_mul_f32 v29,s71,v29
v_cvt_pk_bf16_f32 v26,v28,v29
s_waitcnt lgkmcnt(8)
v_mfma_f32_16x16x32_bf16 v[172:175],v[76:79],v[84:87],v[172:175]
s_mov_b32 s15,0x20000
s_mov_b32 s37,s18
v_mfma_f32_16x16x32_bf16 v[164:167],v[76:79],v[80:83],v[164:167]
v_mul_f32 v30,s71,v30
v_mul_f32 v31,s71,v31
ds_read_b64_tr_b16 v[72:73],v7 offset:45056
ds_read_b64_tr_b16 v[74:75],v7 offset:45568
s_waitcnt lgkmcnt(8)
v_mfma_f32_16x16x32_bf16 v[176:179],v[40:43],v[80:83],v[176:179]
s_lshl_b32 s39,s16,11
s_lshl_b32 s29,s16,16
ds_read_b64_tr_b16 v[76:77],v8 offset:45056
ds_read_b64_tr_b16 v[78:79],v8 offset:45568
v_mfma_f32_16x16x32_bf16 v[184:187],v[40:43],v[84:87],v[184:187]
v_cvt_pk_bf16_f32 v27,v30,v31
buffer_store_dwordx4 v[24:27],v4,s[40:43],s57 offen offset:0 sc1
s_waitcnt lgkmcnt(8)
v_mfma_f32_16x16x32_bf16 v[188:191],v[44:47],v[84:87],v[188:191]
s_lshl_b32 s26,s17,8
v_mfma_f32_16x16x32_bf16 v[180:183],v[44:47],v[80:83],v[180:183]
v_mul_f32 v32,s71,v32
v_mul_f32 v33,s71,v33
ds_read_b64_tr_b16 v[40:41],v5 offset:49152
ds_read_b64_tr_b16 v[42:43],v5 offset:49664
s_waitcnt lgkmcnt(8)
v_mfma_f32_16x16x32_bf16 v[160:163],v[64:67],v[88:91],v[160:163]
ds_read_b128 v[136:139],v9 offset:2048
ds_read_b128 v[140:143],v9 offset:3072
s_add_u32 s29,s29,s26
ds_read_b64_tr_b16 v[44:45],v6 offset:49152
ds_read_b64_tr_b16 v[46:47],v6 offset:49664
v_mfma_f32_16x16x32_bf16 v[168:171],v[64:67],v[92:95],v[168:171]
s_lshl_b32 s24,s19,15
v_cvt_pk_bf16_f32 v28,v32,v33
v_mul_f32 v34,s71,v34
s_waitcnt lgkmcnt(10)
v_mfma_f32_16x16x32_bf16 v[172:175],v[68:71],v[92:95],v[172:175]
s_add_u32 s24,s24,41943040
v_lshrrev_b32 v20,4,v1
v_mfma_f32_16x16x32_bf16 v[164:167],v[68:71],v[88:91],v[164:167]
v_mul_f32 v35,s71,v35
v_cvt_pk_bf16_f32 v29,v34,v35
ds_read_b64_tr_b16 v[64:65],v7 offset:49152
ds_read_b64_tr_b16 v[66:67],v7 offset:49664
s_waitcnt lgkmcnt(10)
v_mfma_f32_16x16x32_bf16 v[176:179],v[72:75],v[88:91],v[176:179]
v_lshlrev_b32 v21,2,v20
v_and_b32 v10,15,v1
ds_read_b64_tr_b16 v[68:69],v8 offset:49152
ds_read_b64_tr_b16 v[70:71],v8 offset:49664
v_mfma_f32_16x16x32_bf16 v[184:187],v[72:75],v[92:95],v[184:187]
v_mul_f32 v36,s71,v36
v_mul_f32 v37,s71,v37
s_waitcnt lgkmcnt(10)
v_mfma_f32_16x16x32_bf16 v[188:191],v[76:79],v[92:95],v[188:191]
v_xor_b32 v10,v10,v21
s_and_b32 s26,s16,1
v_mfma_f32_16x16x32_bf16 v[180:183],v[76:79],v[88:91],v[180:183]
v_cvt_pk_bf16_f32 v30,v36,v37
v_mul_f32 v38,s71,v38
ds_read_b64_tr_b16 v[72:73],v5 offset:53248
ds_read_b64_tr_b16 v[74:75],v5 offset:53760
s_setprio 1
s_waitcnt lgkmcnt(10)
v_mfma_f32_16x16x32_bf16 v[160:163],v[40:43],v[96:99],v[160:163]
s_lshl_b32 s26,s26,1
v_xor_b32 v10,s26,v10
ds_read_b64_tr_b16 v[76:77],v6 offset:53248
ds_read_b64_tr_b16 v[78:79],v6 offset:53760
v_mfma_f32_16x16x32_bf16 v[168:171],v[40:43],v[100:103],v[168:171]
v_mul_f32 v39,s71,v39
v_cvt_pk_bf16_f32 v31,v38,v39
buffer_store_dwordx4 v[28:31],v4,s[40:43],s57 offen offset:256 sc1
s_waitcnt lgkmcnt(8)
v_mfma_f32_16x16x32_bf16 v[172:175],v[44:47],v[100:103],v[172:175]
v_lshlrev_b32 v10,4,v10
v_lshl_add_u32 v10,v20,13,v10
v_mfma_f32_16x16x32_bf16 v[164:167],v[44:47],v[96:99],v[164:167]
v_mul_f32 v48,s71,v48
v_mul_f32 v49,s71,v49
ds_read_b64_tr_b16 v[40:41],v7 offset:53248
ds_read_b64_tr_b16 v[42:43],v7 offset:53760
s_waitcnt lgkmcnt(8)
v_mfma_f32_16x16x32_bf16 v[176:179],v[64:67],v[96:99],v[176:179]
v_lshlrev_b32 v2,4,v1
ds_read_b64_tr_b16 v[44:45],v8 offset:53248
ds_read_b64_tr_b16 v[46:47],v8 offset:53760
v_mfma_f32_16x16x32_bf16 v[184:187],v[64:67],v[100:103],v[184:187]
v_cvt_pk_bf16_f32 v48,v48,v49
v_mul_f32 v50,s71,v50
s_waitcnt lgkmcnt(8)
v_mfma_f32_16x16x32_bf16 v[188:191],v[68:71],v[100:103],v[188:191]
s_add_u32 s26,s37,0
s_and_b32 s26,s26,7
v_mfma_f32_16x16x32_bf16 v[180:183],v[68:71],v[96:99],v[180:183]
v_mul_f32 v51,s71,v51
v_cvt_pk_bf16_f32 v49,v50,v51
ds_read_b64_tr_b16 v[64:65],v5 offset:57344
ds_read_b64_tr_b16 v[66:67],v5 offset:57856
s_waitcnt lgkmcnt(8)
v_mfma_f32_16x16x32_bf16 v[160:163],v[72:75],v[104:107],v[160:163]
s_lshl_b32 s80,s26,19
s_add_u32 s80,s80,s29
ds_read_b64_tr_b16 v[68:69],v6 offset:57344
ds_read_b64_tr_b16 v[70:71],v6 offset:57856
v_mfma_f32_16x16x32_bf16 v[168:171],v[72:75],v[108:111],v[168:171]
v_mul_f32 v52,s71,v52
v_mul_f32 v53,s71,v53
s_waitcnt lgkmcnt(8)
v_mfma_f32_16x16x32_bf16 v[172:175],v[76:79],v[108:111],v[172:175]
s_lshl_b32 s26,s26,12
s_add_u32 s88,s26,s24
v_mfma_f32_16x16x32_bf16 v[164:167],v[76:79],v[104:107],v[164:167]
v_cvt_pk_bf16_f32 v50,v52,v53
v_mul_f32 v54,s71,v54
ds_read_b64_tr_b16 v[72:73],v7 offset:57344
ds_read_b64_tr_b16 v[74:75],v7 offset:57856
s_waitcnt lgkmcnt(8)
v_mfma_f32_16x16x32_bf16 v[176:179],v[40:43],v[104:107],v[176:179]
s_add_u32 s26,s37,1
s_and_b32 s26,s26,7
ds_read_b64_tr_b16 v[76:77],v8 offset:57344
ds_read_b64_tr_b16 v[78:79],v8 offset:57856
v_mfma_f32_16x16x32_bf16 v[184:187],v[40:43],v[108:111],v[184:187]
v_mul_f32 v55,s71,v55
v_cvt_pk_bf16_f32 v51,v54,v55
s_waitcnt lgkmcnt(8)
v_mfma_f32_16x16x32_bf16 v[188:191],v[44:47],v[108:111],v[188:191]
s_lshl_b32 s81,s26,19
s_add_u32 s81,s81,s29
v_mfma_f32_16x16x32_bf16 v[180:183],v[44:47],v[104:107],v[180:183]
buffer_store_dwordx4 v[48:51],v4,s[40:43],s57 offen offset:2048 sc1
v_mul_f32 v56,s71,v56
ds_read_b64_tr_b16 v[40:41],v5 offset:61440
ds_read_b64_tr_b16 v[42:43],v5 offset:61952
s_setprio 0
s_waitcnt lgkmcnt(8)
v_mfma_f32_16x16x32_bf16 v[160:163],v[64:67],v[128:131],v[160:163]
s_lshl_b32 s26,s26,12
s_add_u32 s89,s26,s24
ds_read_b64_tr_b16 v[44:45],v6 offset:61440
ds_read_b64_tr_b16 v[46:47],v6 offset:61952
v_mfma_f32_16x16x32_bf16 v[168:171],v[64:67],v[132:135],v[168:171]
v_mul_f32 v57,s71,v57
v_cvt_pk_bf16_f32 v52,v56,v57
s_waitcnt lgkmcnt(8)
v_mfma_f32_16x16x32_bf16 v[172:175],v[68:71],v[132:135],v[172:175]
s_add_u32 s26,s37,2
v_mfma_f32_16x16x32_bf16 v[164:167],v[68:71],v[128:131],v[164:167]
v_mul_f32 v58,s71,v58
v_mul_f32 v59,s71,v59
ds_read_b64_tr_b16 v[64:65],v7 offset:61440
ds_read_b64_tr_b16 v[66:67],v7 offset:61952
s_waitcnt lgkmcnt(8)
v_mfma_f32_16x16x32_bf16 v[176:179],v[72:75],v[128:131],v[176:179]
s_and_b32 s26,s26,7
s_lshl_b32 s82,s26,19
ds_read_b64_tr_b16 v[68:69],v8 offset:61440
ds_read_b64_tr_b16 v[70:71],v8 offset:61952
v_mfma_f32_16x16x32_bf16 v[184:187],v[72:75],v[132:135],v[184:187]
v_cvt_pk_bf16_f32 v53,v58,v59
v_mul_f32 v60,s71,v60
s_waitcnt lgkmcnt(8)
v_mfma_f32_16x16x32_bf16 v[188:191],v[76:79],v[132:135],v[188:191]
s_add_u32 s82,s82,s29
s_lshl_b32 s26,s26,12
v_mfma_f32_16x16x32_bf16 v[180:183],v[76:79],v[128:131],v[180:183]
v_mul_f32 v61,s71,v61
v_cvt_pk_bf16_f32 v54,v60,v61
v_add_u32 v5,0x10000,v5
ds_read_b64_tr_b16 v[72:73],v5 offset:0
ds_read_b64_tr_b16 v[74:75],v5 offset:512
s_waitcnt lgkmcnt(8)
v_mfma_f32_16x16x32_bf16 v[160:163],v[40:43],v[136:139],v[160:163]
s_add_u32 s90,s26,s24
s_add_u32 s26,s37,3
v_add_u32 v6,0x10000,v6
ds_read_b64_tr_b16 v[76:77],v6 offset:0
ds_read_b64_tr_b16 v[78:79],v6 offset:512
v_mfma_f32_16x16x32_bf16 v[168:171],v[40:43],v[140:143],v[168:171]
v_mul_f32 v62,s71,v62
v_mul_f32 v63,s71,v63
s_waitcnt lgkmcnt(8)
v_mfma_f32_16x16x32_bf16 v[172:175],v[44:47],v[140:143],v[172:175]
s_and_b32 s26,s26,7
s_lshl_b32 s83,s26,19
v_mfma_f32_16x16x32_bf16 v[164:167],v[44:47],v[136:139],v[164:167]
v_cvt_pk_bf16_f32 v55,v62,v63
buffer_store_dwordx4 v[52:55],v4,s[40:43],s57 offen offset:2304 sc1
v_add_u32 v7,0x10000,v7
ds_read_b64_tr_b16 v[40:41],v7 offset:0
ds_read_b64_tr_b16 v[42:43],v7 offset:512
s_waitcnt lgkmcnt(8)
v_mfma_f32_16x16x32_bf16 v[176:179],v[64:67],v[136:139],v[176:179]
s_add_u32 s83,s83,s29
v_add_u32 v8,0x10000,v8
ds_read_b64_tr_b16 v[44:45],v8 offset:0
ds_read_b64_tr_b16 v[46:47],v8 offset:512
v_mfma_f32_16x16x32_bf16 v[184:187],v[64:67],v[140:143],v[184:187]
s_lshl_b32 s26,s26,12
s_waitcnt lgkmcnt(8)
v_mfma_f32_16x16x32_bf16 v[188:191],v[68:71],v[140:143],v[188:191]
v_mfma_f32_16x16x32_bf16 v[180:183],v[68:71],v[136:139],v[180:183]
s_add_u32 s91,s26,s24
s_waitcnt vmcnt(11)
s_cmp_lg_u32 s50,0
s_cbranch_scc1 L_xf_ok4
s_waitcnt vmcnt(4)
v_cmp_ne_u32 vcc,s96,v14
s_cbranch_vccnz L_xf_spin4
L_xf_ok4:
s_barrier
ds_read_b64_tr_b16 v[64:65],v5 offset:4096
ds_read_b64_tr_b16 v[66:67],v5 offset:4608
s_setprio 3
s_waitcnt lgkmcnt(8)
v_mfma_f32_16x16x32_bf16 v[192:195],v[72:75],v[112:115],v[192:195]
ds_read_b64_tr_b16 v[68:69],v6 offset:4096
ds_read_b64_tr_b16 v[70:71],v6 offset:4608
v_mfma_f32_16x16x32_bf16 v[200:203],v[72:75],v[116:119],v[200:203]
s_add_u32 m0,s39,0
s_add_u32 s26,s80,0
buffer_load_dwordx4 v10,s[76:79],s26 offen lds
s_waitcnt lgkmcnt(8)
v_mfma_f32_16x16x32_bf16 v[204:207],v[76:79],v[116:119],v[204:207]
v_mfma_f32_16x16x32_bf16 v[196:199],v[76:79],v[112:115],v[196:199]
ds_read_b64_tr_b16 v[72:73],v7 offset:4096
ds_read_b64_tr_b16 v[74:75],v7 offset:4608
s_waitcnt lgkmcnt(8)
v_mfma_f32_16x16x32_bf16 v[208:211],v[40:43],v[112:115],v[208:211]
s_add_u32 m0,s39,1024
s_add_u32 s26,s80,32768
buffer_load_dwordx4 v10,s[76:79],s26 offen lds
s_add_u32 s54,s51,2
ds_read_b64_tr_b16 v[76:77],v8 offset:4096
ds_read_b64_tr_b16 v[78:79],v8 offset:4608
v_mfma_f32_16x16x32_bf16 v[216:219],v[40:43],v[116:119],v[216:219]
s_lshr_b32 s57,s54,1
s_lshl_b32 s57,s57,20
s_waitcnt lgkmcnt(8)
v_mfma_f32_16x16x32_bf16 v[220:223],v[44:47],v[116:119],v[220:223]
s_and_b32 s54,s54,1
v_mfma_f32_16x16x32_bf16 v[212:215],v[44:47],v[112:115],v[212:215]
s_lshl_b32 s54,s54,12
ds_read_b64_tr_b16 v[40:41],v5 offset:8192
ds_read_b64_tr_b16 v[42:43],v5 offset:8704
s_waitcnt lgkmcnt(8)
v_mfma_f32_16x16x32_bf16 v[192:195],v[64:67],v[120:123],v[192:195]
s_add_u32 s57,s57,s54
ds_read_b64_tr_b16 v[44:45],v6 offset:8192
ds_read_b64_tr_b16 v[46:47],v6 offset:8704
v_mfma_f32_16x16x32_bf16 v[200:203],v[64:67],v[124:127],v[200:203]
v_mul_f32 v160,s71,v160
s_waitcnt lgkmcnt(8)
v_mfma_f32_16x16x32_bf16 v[204:207],v[68:71],v[124:127],v[204:207]
buffer_load_dwordx4 v[24:27],v2,s[8:11],s88 offen offset:0 sc1
v_mfma_f32_16x16x32_bf16 v[196:199],v[68:71],v[120:123],v[196:199]
v_mul_f32 v161,s71,v161
v_cvt_pk_bf16_f32 v160,v160,v161
ds_read_b64_tr_b16 v[64:65],v7 offset:8192
ds_read_b64_tr_b16 v[66:67],v7 offset:8704
s_waitcnt lgkmcnt(8)
v_mfma_f32_16x16x32_bf16 v[208:211],v[72:75],v[120:123],v[208:211]
v_mul_f32 v162,s71,v162
ds_read_b64_tr_b16 v[68:69],v8 offset:8192
ds_read_b64_tr_b16 v[70:71],v8 offset:8704
v_mfma_f32_16x16x32_bf16 v[216:219],v[72:75],v[124:127],v[216:219]
v_mul_f32 v163,s71,v163
s_waitcnt lgkmcnt(8)
v_mfma_f32_16x16x32_bf16 v[220:223],v[76:79],v[124:127],v[220:223]
v_cvt_pk_bf16_f32 v161,v162,v163
v_mfma_f32_16x16x32_bf16 v[212:215],v[76:79],v[120:123],v[212:215]
v_mul_f32 v164,s71,v164
ds_read_b64_tr_b16 v[72:73],v5 offset:12288
ds_read_b64_tr_b16 v[74:75],v5 offset:12800
s_setprio 2
s_waitcnt lgkmcnt(8)
v_mfma_f32_16x16x32_bf16 v[192:195],v[40:43],v[80:83],v[192:195]
buffer_load_dwordx4 v[28:31],v2,s[8:11],s88 offen offset:1024 sc1
ds_read_b64_tr_b16 v[76:77],v6 offset:12288
ds_read_b64_tr_b16 v[78:79],v6 offset:12800
v_mfma_f32_16x16x32_bf16 v[200:203],v[40:43],v[84:87],v[200:203]
v_mul_f32 v165,s71,v165
v_cvt_pk_bf16_f32 v162,v164,v165
s_waitcnt lgkmcnt(8)
v_mfma_f32_16x16x32_bf16 v[204:207],v[44:47],v[84:87],v[204:207]
v_mul_f32 v166,s71,v166
v_mfma_f32_16x16x32_bf16 v[196:199],v[44:47],v[80:83],v[196:199]
v_mul_f32 v167,s71,v167
ds_read_b64_tr_b16 v[40:41],v7 offset:12288
ds_read_b64_tr_b16 v[42:43],v7 offset:12800
s_waitcnt lgkmcnt(8)
v_mfma_f32_16x16x32_bf16 v[208:211],v[64:67],v[80:83],v[208:211]
v_cvt_pk_bf16_f32 v163,v166,v167
ds_read_b64_tr_b16 v[44:45],v8 offset:12288
ds_read_b64_tr_b16 v[46:47],v8 offset:12800
v_mfma_f32_16x16x32_bf16 v[216:219],v[64:67],v[84:87],v[216:219]
buffer_store_dwordx4 v[160:163],v4,s[40:43],s57 offen offset:0 sc1
s_waitcnt lgkmcnt(8)
v_mfma_f32_16x16x32_bf16 v[220:223],v[68:71],v[84:87],v[220:223]
buffer_load_dwordx4 v[32:35],v2,s[8:11],s88 offen offset:2048 sc1
v_mfma_f32_16x16x32_bf16 v[212:215],v[68:71],v[80:83],v[212:215]
v_mul_f32 v168,s71,v168
v_mul_f32 v169,s71,v169
ds_read_b64_tr_b16 v[64:65],v5 offset:16384
ds_read_b64_tr_b16 v[66:67],v5 offset:16896
s_waitcnt lgkmcnt(8)
v_mfma_f32_16x16x32_bf16 v[192:195],v[72:75],v[88:91],v[192:195]
v_cvt_pk_bf16_f32 v164,v168,v169
ds_read_b64_tr_b16 v[68:69],v6 offset:16384
ds_read_b64_tr_b16 v[70:71],v6 offset:16896
v_mfma_f32_16x16x32_bf16 v[200:203],v[72:75],v[92:95],v[200:203]
v_mul_f32 v170,s71,v170
s_waitcnt lgkmcnt(8)
v_mfma_f32_16x16x32_bf16 v[204:207],v[76:79],v[92:95],v[204:207]
buffer_load_dwordx4 v[36:39],v2,s[8:11],s88 offen offset:3072 sc1
v_mfma_f32_16x16x32_bf16 v[196:199],v[76:79],v[88:91],v[196:199]
v_mul_f32 v171,s71,v171
v_cvt_pk_bf16_f32 v165,v170,v171
ds_read_b64_tr_b16 v[72:73],v7 offset:16384
ds_read_b64_tr_b16 v[74:75],v7 offset:16896
s_waitcnt lgkmcnt(8)
v_mfma_f32_16x16x32_bf16 v[208:211],v[40:43],v[88:91],v[208:211]
v_mul_f32 v172,s71,v172
ds_read_b64_tr_b16 v[76:77],v8 offset:16384
ds_read_b64_tr_b16 v[78:79],v8 offset:16896
v_mfma_f32_16x16x32_bf16 v[216:219],v[40:43],v[92:95],v[216:219]
v_mul_f32 v173,s71,v173
s_waitcnt lgkmcnt(8)
v_mfma_f32_16x16x32_bf16 v[220:223],v[44:47],v[92:95],v[220:223]
v_cvt_pk_bf16_f32 v166,v172,v173
v_mfma_f32_16x16x32_bf16 v[212:215],v[44:47],v[88:91],v[212:215]
v_mul_f32 v174,s71,v174
ds_read_b64_tr_b16 v[40:41],v5 offset:20480
ds_read_b64_tr_b16 v[42:43],v5 offset:20992
s_setprio 1
s_waitcnt lgkmcnt(8)
v_mfma_f32_16x16x32_bf16 v[192:195],v[64:67],v[96:99],v[192:195]
s_add_u32 m0,s39,16384
s_add_u32 s26,s81,0
buffer_load_dwordx4 v10,s[76:79],s26 offen lds
v_mul_f32 v175,s71,v175
ds_read_b64_tr_b16 v[44:45],v6 offset:20480
ds_read_b64_tr_b16 v[46:47],v6 offset:20992
v_mfma_f32_16x16x32_bf16 v[200:203],v[64:67],v[100:103],v[200:203]
v_cvt_pk_bf16_f32 v167,v174,v175
buffer_store_dwordx4 v[164:167],v4,s[40:43],s57 offen offset:256 sc1
s_waitcnt lgkmcnt(8)
v_mfma_f32_16x16x32_bf16 v[204:207],v[68:71],v[100:103],v[204:207]
v_mul_f32 v176,s71,v176
v_mfma_f32_16x16x32_bf16 v[196:199],v[68:71],v[96:99],v[196:199]
v_mul_f32 v177,s71,v177
ds_read_b64_tr_b16 v[64:65],v7 offset:20480
ds_read_b64_tr_b16 v[66:67],v7 offset:20992
s_waitcnt lgkmcnt(8)
v_mfma_f32_16x16x32_bf16 v[208:211],v[72:75],v[96:99],v[208:211]
v_cvt_pk_bf16_f32 v176,v176,v177
ds_read_b64_tr_b16 v[68:69],v8 offset:20480
ds_read_b64_tr_b16 v[70:71],v8 offset:20992
v_mfma_f32_16x16x32_bf16 v[216:219],v[72:75],v[100:103],v[216:219]
v_mul_f32 v178,s71,v178
s_waitcnt lgkmcnt(8)
v_mfma_f32_16x16x32_bf16 v[220:223],v[76:79],v[100:103],v[220:223]
s_add_u32 m0,s39,17408
s_add_u32 s26,s81,32768
buffer_load_dwordx4 v10,s[76:79],s26 offen lds
v_mfma_f32_16x16x32_bf16 v[212:215],v[76:79],v[96:99],v[212:215]
v_mul_f32 v179,s71,v179
v_cvt_pk_bf16_f32 v177,v178,v179
ds_read_b64_tr_b16 v[72:73],v5 offset:24576
ds_read_b64_tr_b16 v[74:75],v5 offset:25088
s_waitcnt lgkmcnt(8)
v_mfma_f32_16x16x32_bf16 v[192:195],v[40:43],v[104:107],v[192:195]
v_mul_f32 v180,s71,v180
ds_read_b64_tr_b16 v[76:77],v6 offset:24576
ds_read_b64_tr_b16 v[78:79],v6 offset:25088
v_mfma_f32_16x16x32_bf16 v[200:203],v[40:43],v[108:111],v[200:203]
v_mul_f32 v181,s71,v181
s_waitcnt lgkmcnt(8)
v_mfma_f32_16x16x32_bf16 v[204:207],v[44:47],v[108:111],v[204:207]
v_cvt_pk_bf16_f32 v178,v180,v181
v_mfma_f32_16x16x32_bf16 v[196:199],v[44:47],v[104:107],v[196:199]
v_mul_f32 v182,s71,v182
ds_read_b64_tr_b16 v[40:41],v7 offset:24576
ds_read_b64_tr_b16 v[42:43],v7 offset:25088
s_waitcnt lgkmcnt(8)
v_mfma_f32_16x16x32_bf16 v[208:211],v[64:67],v[104:107],v[208:211]
buffer_load_dwordx4 v[48:51],v2,s[8:11],s89 offen offset:0 sc1
ds_read_b64_tr_b16 v[44:45],v8 offset:24576
ds_read_b64_tr_b16 v[46:47],v8 offset:25088
v_mfma_f32_16x16x32_bf16 v[216:219],v[64:67],v[108:111],v[216:219]
v_mul_f32 v183,s71,v183
v_cvt_pk_bf16_f32 v179,v182,v183
s_waitcnt lgkmcnt(8)
v_mfma_f32_16x16x32_bf16 v[220:223],v[68:71],v[108:111],v[220:223]
buffer_store_dwordx4 v[176:179],v4,s[40:43],s57 offen offset:2048 sc1
v_mfma_f32_16x16x32_bf16 v[212:215],v[68:71],v[104:107],v[212:215]
v_mul_f32 v184,s71,v184
ds_read_b64_tr_b16 v[64:65],v5 offset:28672
ds_read_b64_tr_b16 v[66:67],v5 offset:29184
s_setprio 0
s_waitcnt lgkmcnt(8)
v_mfma_f32_16x16x32_bf16 v[192:195],v[72:75],v[128:131],v[192:195]
buffer_load_dwordx4 v[52:55],v2,s[8:11],s89 offen offset:1024 sc1
ds_read_b64_tr_b16 v[68:69],v6 offset:28672
ds_read_b64_tr_b16 v[70:71],v6 offset:29184
v_mfma_f32_16x16x32_bf16 v[200:203],v[72:75],v[132:135],v[200:203]
v_mul_f32 v185,s71,v185
v_cvt_pk_bf16_f32 v180,v184,v185
s_waitcnt lgkmcnt(8)
v_mfma_f32_16x16x32_bf16 v[204:207],v[76:79],v[132:135],v[204:207]
v_mul_f32 v186,s71,v186
v_mfma_f32_16x16x32_bf16 v[196:199],v[76:79],v[128:131],v[196:199]
v_mul_f32 v187,s71,v187
ds_read_b64_tr_b16 v[72:73],v7 offset:28672
ds_read_b64_tr_b16 v[74:75],v7 offset:29184
s_waitcnt lgkmcnt(8)
v_mfma_f32_16x16x32_bf16 v[208:211],v[40:43],v[128:131],v[208:211]
v_cvt_pk_bf16_f32 v181,v186,v187
ds_read_b64_tr_b16 v[76:77],v8 offset:28672
ds_read_b64_tr_b16 v[78:79],v8 offset:29184
v_mfma_f32_16x16x32_bf16 v[216:219],v[40:43],v[132:135],v[216:219]
v_mul_f32 v188,s71,v188
s_waitcnt lgkmcnt(8)
v_mfma_f32_16x16x32_bf16 v[220:223],v[44:47],v[132:135],v[220:223]
buffer_load_dwordx4 v[56:59],v2,s[8:11],s89 offen offset:2048 sc1
v_mfma_f32_16x16x32_bf16 v[212:215],v[44:47],v[128:131],v[212:215]
v_mul_f32 v189,s71,v189
v_cvt_pk_bf16_f32 v182,v188,v189
v_add_u32 v5,0xffff0000,v5
ds_read_b64_tr_b16 v[40:41],v5 offset:0
ds_read_b64_tr_b16 v[42:43],v5 offset:512
s_waitcnt lgkmcnt(8)
v_mfma_f32_16x16x32_bf16 v[192:195],v[64:67],v[136:139],v[192:195]
v_mul_f32 v190,s71,v190
v_add_u32 v6,0xffff0000,v6
ds_read_b64_tr_b16 v[44:45],v6 offset:0
ds_read_b64_tr_b16 v[46:47],v6 offset:512
v_mfma_f32_16x16x32_bf16 v[200:203],v[64:67],v[140:143],v[200:203]
v_mul_f32 v191,s71,v191
s_waitcnt lgkmcnt(8)
v_mfma_f32_16x16x32_bf16 v[204:207],v[68:71],v[140:143],v[204:207]
v_cvt_pk_bf16_f32 v183,v190,v191
v_mfma_f32_16x16x32_bf16 v[196:199],v[68:71],v[136:139],v[196:199]
buffer_store_dwordx4 v[180:183],v4,s[40:43],s57 offen offset:2304 sc1
v_add_u32 v7,0xffff0000,v7
ds_read_b64_tr_b16 v[64:65],v7 offset:0
ds_read_b64_tr_b16 v[66:67],v7 offset:512
s_waitcnt lgkmcnt(8)
v_mfma_f32_16x16x32_bf16 v[208:211],v[72:75],v[136:139],v[208:211]
v_add_u32 v8,0xffff0000,v8
ds_read_b64_tr_b16 v[68:69],v8 offset:0
ds_read_b64_tr_b16 v[70:71],v8 offset:512
v_mfma_f32_16x16x32_bf16 v[216:219],v[72:75],v[140:143],v[216:219]
buffer_load_dwordx4 v[60:63],v2,s[8:11],s89 offen offset:3072 sc1
s_waitcnt lgkmcnt(8)
v_mfma_f32_16x16x32_bf16 v[220:223],v[76:79],v[140:143],v[220:223]
v_mfma_f32_16x16x32_bf16 v[212:215],v[76:79],v[136:139],v[212:215]
s_waitcnt vmcnt(20)
s_barrier
ds_read_b64_tr_b16 v[72:73],v5 offset:4096
ds_read_b64_tr_b16 v[74:75],v5 offset:4608
s_setprio 3
s_waitcnt lgkmcnt(8)
v_mfma_f32_16x16x32_bf16 v[224:227],v[40:43],v[112:115],v[224:227]
ds_read_b64_tr_b16 v[76:77],v6 offset:4096
ds_read_b64_tr_b16 v[78:79],v6 offset:4608
v_mfma_f32_16x16x32_bf16 v[232:235],v[40:43],v[116:119],v[232:235]
s_waitcnt lgkmcnt(8)
v_mfma_f32_16x16x32_bf16 v[236:239],v[44:47],v[116:119],v[236:239]
v_mfma_f32_16x16x32_bf16 v[228:231],v[44:47],v[112:115],v[228:231]
s_add_u32 m0,s39,32768
s_add_u32 s26,s82,0
buffer_load_dwordx4 v10,s[76:79],s26 offen lds
ds_read_b64_tr_b16 v[40:41],v7 offset:4096
ds_read_b64_tr_b16 v[42:43],v7 offset:4608
s_waitcnt lgkmcnt(8)
v_mfma_f32_16x16x32_bf16 v[240:243],v[64:67],v[112:115],v[240:243]
s_add_u32 s54,s51,3
ds_read_b64_tr_b16 v[44:45],v8 offset:4096
ds_read_b64_tr_b16 v[46:47],v8 offset:4608
v_mfma_f32_16x16x32_bf16 v[248:251],v[64:67],v[116:119],v[248:251]
s_lshr_b32 s57,s54,1
s_lshl_b32 s57,s57,20
s_waitcnt lgkmcnt(8)
v_mfma_f32_16x16x32_bf16 v[252:255],v[68:71],v[116:119],v[252:255]
s_add_u32 m0,s39,33792
s_add_u32 s26,s82,32768
buffer_load_dwordx4 v10,s[76:79],s26 offen lds
v_mfma_f32_16x16x32_bf16 v[244:247],v[68:71],v[112:115],v[244:247]
s_and_b32 s54,s54,1
s_lshl_b32 s54,s54,12
ds_read_b64_tr_b16 v[64:65],v5 offset:8192
ds_read_b64_tr_b16 v[66:67],v5 offset:8704
s_waitcnt lgkmcnt(8)
v_mfma_f32_16x16x32_bf16 v[224:227],v[72:75],v[120:123],v[224:227]
s_add_u32 s57,s57,s54
ds_read_b64_tr_b16 v[68:69],v6 offset:8192
ds_read_b64_tr_b16 v[70:71],v6 offset:8704
v_mfma_f32_16x16x32_bf16 v[232:235],v[72:75],v[124:127],v[232:235]
v_mul_f32 v192,s71,v192
s_waitcnt lgkmcnt(8)
v_mfma_f32_16x16x32_bf16 v[236:239],v[76:79],v[124:127],v[236:239]
v_mul_f32 v193,s71,v193
v_mfma_f32_16x16x32_bf16 v[228:231],v[76:79],v[120:123],v[228:231]
v_cvt_pk_bf16_f32 v192,v192,v193
ds_read_b64_tr_b16 v[72:73],v7 offset:8192
ds_read_b64_tr_b16 v[74:75],v7 offset:8704
s_waitcnt lgkmcnt(8)
v_mfma_f32_16x16x32_bf16 v[240:243],v[40:43],v[120:123],v[240:243]
s_add_u32 m0,s39,49152
s_add_u32 s26,s83,0
buffer_load_dwordx4 v10,s[76:79],s26 offen lds
ds_read_b64_tr_b16 v[76:77],v8 offset:8192
ds_read_b64_tr_b16 v[78:79],v8 offset:8704
v_mfma_f32_16x16x32_bf16 v[248:251],v[40:43],v[124:127],v[248:251]
v_mul_f32 v194,s71,v194
v_mul_f32 v195,s71,v195
s_waitcnt lgkmcnt(8)
v_mfma_f32_16x16x32_bf16 v[252:255],v[44:47],v[124:127],v[252:255]
v_cvt_pk_bf16_f32 v193,v194,v195
v_mfma_f32_16x16x32_bf16 v[244:247],v[44:47],v[120:123],v[244:247]
v_mul_f32 v196,s71,v196
ds_read_b64_tr_b16 v[40:41],v5 offset:12288
ds_read_b64_tr_b16 v[42:43],v5 offset:12800
s_setprio 2
s_waitcnt lgkmcnt(8)
v_mfma_f32_16x16x32_bf16 v[224:227],v[64:67],v[80:83],v[224:227]
v_mul_f32 v197,s71,v197
ds_read_b64_tr_b16 v[44:45],v6 offset:12288
ds_read_b64_tr_b16 v[46:47],v6 offset:12800
v_mfma_f32_16x16x32_bf16 v[232:235],v[64:67],v[84:87],v[232:235]
v_cvt_pk_bf16_f32 v194,v196,v197
s_waitcnt lgkmcnt(8)
v_mfma_f32_16x16x32_bf16 v[236:239],v[68:71],v[84:87],v[236:239]
s_add_u32 m0,s39,50176
s_add_u32 s26,s83,32768
buffer_load_dwordx4 v10,s[76:79],s26 offen lds
v_mfma_f32_16x16x32_bf16 v[228:231],v[68:71],v[80:83],v[228:231]
v_mul_f32 v198,s71,v198
v_mul_f32 v199,s71,v199
ds_read_b64_tr_b16 v[64:65],v7 offset:12288
ds_read_b64_tr_b16 v[66:67],v7 offset:12800
s_waitcnt lgkmcnt(8)
v_mfma_f32_16x16x32_bf16 v[240:243],v[72:75],v[80:83],v[240:243]
v_cvt_pk_bf16_f32 v195,v198,v199
ds_read_b64_tr_b16 v[68:69],v8 offset:12288
ds_read_b64_tr_b16 v[70:71],v8 offset:12800
v_mfma_f32_16x16x32_bf16 v[248:251],v[72:75],v[84:87],v[248:251]
buffer_store_dwordx4 v[192:195],v4,s[40:43],s57 offen offset:0 sc1
s_waitcnt lgkmcnt(8)
v_mfma_f32_16x16x32_bf16 v[252:255],v[76:79],v[84:87],v[252:255]
v_mul_f32 v200,s71,v200
v_mfma_f32_16x16x32_bf16 v[244:247],v[76:79],v[80:83],v[244:247]
v_mul_f32 v201,s71,v201
ds_read_b64_tr_b16 v[72:73],v5 offset:16384
ds_read_b64_tr_b16 v[74:75],v5 offset:16896
s_waitcnt lgkmcnt(8)
v_mfma_f32_16x16x32_bf16 v[224:227],v[40:43],v[88:91],v[224:227]
s_add_u32 s26,s37,4
s_and_b32 s26,s26,7
ds_read_b64_tr_b16 v[76:77],v6 offset:16384
ds_read_b64_tr_b16 v[78:79],v6 offset:16896
v_mfma_f32_16x16x32_bf16 v[232:235],v[40:43],v[92:95],v[232:235]
s_lshl_b32 s84,s26,19
v_cvt_pk_bf16_f32 v196,v200,v201
v_mul_f32 v202,s71,v202
s_waitcnt lgkmcnt(8)
v_mfma_f32_16x16x32_bf16 v[236:239],v[44:47],v[92:95],v[236:239]
s_add_u32 s84,s84,s29
s_lshl_b32 s26,s26,12
v_mfma_f32_16x16x32_bf16 v[228:231],v[44:47],v[88:91],v[228:231]
v_mul_f32 v203,s71,v203
v_cvt_pk_bf16_f32 v197,v202,v203
ds_read_b64_tr_b16 v[40:41],v7 offset:16384
ds_read_b64_tr_b16 v[42:43],v7 offset:16896
s_waitcnt lgkmcnt(8)
v_mfma_f32_16x16x32_bf16 v[240:243],v[64:67],v[88:91],v[240:243]
s_add_u32 s92,s26,s24
s_add_u32 s26,s37,5
ds_read_b64_tr_b16 v[44:45],v8 offset:16384
ds_read_b64_tr_b16 v[46:47],v8 offset:16896
v_mfma_f32_16x16x32_bf16 v[248:251],v[64:67],v[92:95],v[248:251]
v_mul_f32 v204,s71,v204
v_mul_f32 v205,s71,v205
s_waitcnt lgkmcnt(8)
v_mfma_f32_16x16x32_bf16 v[252:255],v[68:71],v[92:95],v[252:255]
s_and_b32 s26,s26,7
s_lshl_b32 s85,s26,19
v_mfma_f32_16x16x32_bf16 v[244:247],v[68:71],v[88:91],v[244:247]
v_cvt_pk_bf16_f32 v198,v204,v205
v_mul_f32 v206,s71,v206
ds_read_b64_tr_b16 v[64:65],v5 offset:20480
ds_read_b64_tr_b16 v[66:67],v5 offset:20992
s_setprio 1
s_waitcnt lgkmcnt(8)
v_mfma_f32_16x16x32_bf16 v[224:227],v[72:75],v[96:99],v[224:227]
s_add_u32 s85,s85,s29
s_lshl_b32 s26,s26,12
ds_read_b64_tr_b16 v[68:69],v6 offset:20480
ds_read_b64_tr_b16 v[70:71],v6 offset:20992
v_mfma_f32_16x16x32_bf16 v[232:235],v[72:75],v[100:103],v[232:235]
v_mul_f32 v207,s71,v207
v_cvt_pk_bf16_f32 v199,v206,v207
buffer_store_dwordx4 v[196:199],v4,s[40:43],s57 offen offset:256 sc1
s_waitcnt lgkmcnt(8)
v_mfma_f32_16x16x32_bf16 v[236:239],v[76:79],v[100:103],v[236:239]
s_add_u32 s93,s26,s24
s_add_u32 s26,s37,6
v_mfma_f32_16x16x32_bf16 v[228:231],v[76:79],v[96:99],v[228:231]
v_mul_f32 v208,s71,v208
v_mul_f32 v209,s71,v209
ds_read_b64_tr_b16 v[72:73],v7 offset:20480
ds_read_b64_tr_b16 v[74:75],v7 offset:20992
s_waitcnt lgkmcnt(8)
v_mfma_f32_16x16x32_bf16 v[240:243],v[40:43],v[96:99],v[240:243]
s_and_b32 s26,s26,7
s_lshl_b32 s86,s26,19
ds_read_b64_tr_b16 v[76:77],v8 offset:20480
ds_read_b64_tr_b16 v[78:79],v8 offset:20992
v_mfma_f32_16x16x32_bf16 v[248:251],v[40:43],v[100:103],v[248:251]
v_cvt_pk_bf16_f32 v208,v208,v209
v_mul_f32 v210,s71,v210
s_waitcnt lgkmcnt(8)
v_mfma_f32_16x16x32_bf16 v[252:255],v[44:47],v[100:103],v[252:255]
s_add_u32 s86,s86,s29
s_lshl_b32 s26,s26,12
v_mfma_f32_16x16x32_bf16 v[244:247],v[44:47],v[96:99],v[244:247]
v_mul_f32 v211,s71,v211
v_cvt_pk_bf16_f32 v209,v210,v211
ds_read_b64_tr_b16 v[40:41],v5 offset:24576
ds_read_b64_tr_b16 v[42:43],v5 offset:25088
s_waitcnt lgkmcnt(8)
v_mfma_f32_16x16x32_bf16 v[224:227],v[64:67],v[104:107],v[224:227]
s_add_u32 s94,s26,s24
s_add_u32 s26,s37,7
ds_read_b64_tr_b16 v[44:45],v6 offset:24576
ds_read_b64_tr_b16 v[46:47],v6 offset:25088
v_mfma_f32_16x16x32_bf16 v[232:235],v[64:67],v[108:111],v[232:235]
v_mul_f32 v212,s71,v212
v_mul_f32 v213,s71,v213
s_waitcnt lgkmcnt(8)
v_mfma_f32_16x16x32_bf16 v[236:239],v[68:71],v[108:111],v[236:239]
s_and_b32 s26,s26,7
s_lshl_b32 s87,s26,19
v_mfma_f32_16x16x32_bf16 v[228:231],v[68:71],v[104:107],v[228:231]
v_cvt_pk_bf16_f32 v210,v212,v213
v_mul_f32 v214,s71,v214
ds_read_b64_tr_b16 v[64:65],v7 offset:24576
ds_read_b64_tr_b16 v[66:67],v7 offset:25088
s_waitcnt lgkmcnt(8)
v_mfma_f32_16x16x32_bf16 v[240:243],v[72:75],v[104:107],v[240:243]
s_add_u32 s87,s87,s29
s_lshl_b32 s26,s26,12
ds_read_b64_tr_b16 v[68:69],v8 offset:24576
ds_read_b64_tr_b16 v[70:71],v8 offset:25088
v_mfma_f32_16x16x32_bf16 v[248:251],v[72:75],v[108:111],v[248:251]
v_mul_f32 v215,s71,v215
v_cvt_pk_bf16_f32 v211,v214,v215
s_waitcnt lgkmcnt(8)
v_mfma_f32_16x16x32_bf16 v[252:255],v[76:79],v[108:111],v[252:255]
s_add_u32 s95,s26,s24
s_lshl_b32 s26,s18,1
v_mfma_f32_16x16x32_bf16 v[244:247],v[76:79],v[104:107],v[244:247]
buffer_store_dwordx4 v[208:211],v4,s[40:43],s57 offen offset:2048 sc1
v_mul_f32 v216,s71,v216
ds_read_b64_tr_b16 v[72:73],v5 offset:28672
ds_read_b64_tr_b16 v[74:75],v5 offset:29184
s_setprio 0
s_waitcnt lgkmcnt(8)
v_mfma_f32_16x16x32_bf16 v[224:227],v[40:43],v[128:131],v[224:227]
s_sub_u32 s22,31,s26
s_lshl_b32 s36,s17,20
ds_read_b64_tr_b16 v[76:77],v6 offset:28672
ds_read_b64_tr_b16 v[78:79],v6 offset:29184
v_mfma_f32_16x16x32_bf16 v[232:235],v[40:43],v[132:135],v[232:235]
v_mul_f32 v217,s71,v217
v_cvt_pk_bf16_f32 v212,v216,v217
s_waitcnt lgkmcnt(8)
v_mfma_f32_16x16x32_bf16 v[236:239],v[44:47],v[132:135],v[236:239]
s_mov_b64 s[72:73],s[40:41]
s_mov_b32 s74,268435456
v_mfma_f32_16x16x32_bf16 v[228:231],v[44:47],v[128:131],v[228:231]
v_mul_f32 v218,s71,v218
v_mul_f32 v219,s71,v219
ds_read_b64_tr_b16 v[40:41],v7 offset:28672
ds_read_b64_tr_b16 v[42:43],v7 offset:29184
s_waitcnt lgkmcnt(8)
v_mfma_f32_16x16x32_bf16 v[240:243],v[64:67],v[128:131],v[240:243]
s_mov_b32 s75,0x20000
s_mov_b32 s29,0
ds_read_b64_tr_b16 v[44:45],v8 offset:28672
ds_read_b64_tr_b16 v[46:47],v8 offset:29184
v_mfma_f32_16x16x32_bf16 v[248:251],v[64:67],v[132:135],v[248:251]
v_cvt_pk_bf16_f32 v213,v218,v219
v_mul_f32 v220,s71,v220
s_waitcnt lgkmcnt(8)
v_mfma_f32_16x16x32_bf16 v[252:255],v[68:71],v[132:135],v[252:255]
s_mov_b32 s24,0
s_lshl_b32 s26,s16,13
v_mfma_f32_16x16x32_bf16 v[244:247],v[68:71],v[128:131],v[244:247]
v_mul_f32 v221,s71,v221
v_cvt_pk_bf16_f32 v214,v220,v221
s_waitcnt lgkmcnt(6)
v_mfma_f32_16x16x32_bf16 v[224:227],v[72:75],v[136:139],v[224:227]
s_add_u32 s25,s36,s26
s_add_u32 s25,s25,16384
v_mfma_f32_16x16x32_bf16 v[232:235],v[72:75],v[140:143],v[232:235]
v_mul_f32 v222,s71,v222
v_mul_f32 v223,s71,v223
s_waitcnt lgkmcnt(4)
v_mfma_f32_16x16x32_bf16 v[236:239],v[76:79],v[140:143],v[236:239]
s_mov_b32 s23,32768
s_mov_b32 s21,0
v_mfma_f32_16x16x32_bf16 v[228:231],v[76:79],v[136:139],v[228:231]
v_cvt_pk_bf16_f32 v215,v222,v223
buffer_store_dwordx4 v[212:215],v4,s[40:43],s57 offen offset:2304 sc1
s_waitcnt lgkmcnt(2)
v_mfma_f32_16x16x32_bf16 v[240:243],v[40:43],v[136:139],v[240:243]
s_sub_u32 s20,s19,1
v_mfma_f32_16x16x32_bf16 v[248:251],v[40:43],v[140:143],v[248:251]
s_max_i32 s20,s20,0
s_waitcnt lgkmcnt(0)
v_mfma_f32_16x16x32_bf16 v[252:255],v[44:47],v[140:143],v[252:255]
v_mfma_f32_16x16x32_bf16 v[244:247],v[44:47],v[136:139],v[244:247]
s_nop 1
s_add_u32 s54,s51,4
s_lshr_b32 s57,s54,1
s_lshl_b32 s57,s57,20
s_and_b32 s54,s54,1
s_lshl_b32 s54,s54,12
s_add_u32 s57,s57,s54
v_mul_f32 v224,s71,v224
v_mul_f32 v225,s71,v225
v_cvt_pk_bf16_f32 v224,v224,v225
v_mul_f32 v226,s71,v226
v_mul_f32 v227,s71,v227
v_cvt_pk_bf16_f32 v225,v226,v227
v_mul_f32 v228,s71,v228
v_mul_f32 v229,s71,v229
v_cvt_pk_bf16_f32 v226,v228,v229
v_mul_f32 v230,s71,v230
v_mul_f32 v231,s71,v231
v_cvt_pk_bf16_f32 v227,v230,v231
buffer_store_dwordx4 v[224:227],v4,s[40:43],s57 offen offset:0 sc1
v_mul_f32 v232,s71,v232
v_mul_f32 v233,s71,v233
v_cvt_pk_bf16_f32 v228,v232,v233
v_mul_f32 v234,s71,v234
v_mul_f32 v235,s71,v235
v_cvt_pk_bf16_f32 v229,v234,v235
v_mul_f32 v236,s71,v236
v_mul_f32 v237,s71,v237
v_cvt_pk_bf16_f32 v230,v236,v237
v_mul_f32 v238,s71,v238
v_mul_f32 v239,s71,v239
v_cvt_pk_bf16_f32 v231,v238,v239
buffer_store_dwordx4 v[228:231],v4,s[40:43],s57 offen offset:256 sc1
v_mul_f32 v240,s71,v240
v_mul_f32 v241,s71,v241
v_cvt_pk_bf16_f32 v240,v240,v241
v_mul_f32 v242,s71,v242
v_mul_f32 v243,s71,v243
v_cvt_pk_bf16_f32 v241,v242,v243
v_mul_f32 v244,s71,v244
v_mul_f32 v245,s71,v245
v_cvt_pk_bf16_f32 v242,v244,v245
v_mul_f32 v246,s71,v246
v_mul_f32 v247,s71,v247
v_cvt_pk_bf16_f32 v243,v246,v247
buffer_store_dwordx4 v[240:243],v4,s[40:43],s57 offen offset:2048 sc1
v_mul_f32 v248,s71,v248
v_mul_f32 v249,s71,v249
v_cvt_pk_bf16_f32 v244,v248,v249
v_mul_f32 v250,s71,v250
v_mul_f32 v251,s71,v251
v_cvt_pk_bf16_f32 v245,v250,v251
v_mul_f32 v252,s71,v252
v_mul_f32 v253,s71,v253
v_cvt_pk_bf16_f32 v246,v252,v253
v_mul_f32 v254,s71,v254
v_mul_f32 v255,s71,v255
v_cvt_pk_bf16_f32 v247,v254,v255
buffer_store_dwordx4 v[244:247],v4,s[40:43],s57 offen offset:2304 sc1
s_waitcnt vmcnt(8)
s_branch L_k1_end2
L_k1_p_v5:
s_and_b32 s53,s50,1
s_lshl_b32 s53,s53,4
v_xor_b32 v26,s53,v26
v_lshrrev_b32 v28,5,v1
v_lshl_add_u32 v3,v28,13,v3
s_mov_b32 s38,4194304
s_sub_u32 s53,s49,13
s_mul_i32 s51,s53,5
s_min_u32 s51,s51,59
s_mul_i32 s54,s51,128
s_add_u32 s54,s54,0
s_mul_i32 s56,s50,65536
s_add_u32 s56,s56,s54
v_mul_u32_u24 v2,8192,v24
v_add_u32 v2,v2,v26
s_mov_b32 s52,5
s_waitcnt lgkmcnt(0)
s_mov_b64 s[32:33],s[6:7]
s_mov_b64 s[36:37],s[12:13]
s_mov_b64 s[40:41],s[28:29]
s_add_u32 s53,s68,0
s_and_b32 s53,s53,7
s_mul_i32 s72,s53,524288
s_add_u32 s72,s72,s56
s_lshl_b32 s53,s53,7
s_add_u32 s80,s55,s53
s_add_u32 m0,s60,65536
s_add_u32 s53,s72,0
buffer_load_dwordx4 v2,s[36:39],s53 offen lds
s_add_u32 m0,s58,0
s_add_u32 s53,s80,0
buffer_load_dwordx4 v3,s[32:35],s53 offen lds
s_add_u32 m0,s58,1024
s_add_u32 s53,s80,8192
buffer_load_dwordx4 v3,s[32:35],s53 offen lds
s_add_u32 m0,s58,2048
s_add_u32 s53,s80,64
buffer_load_dwordx4 v3,s[32:35],s53 offen lds
s_add_u32 m0,s58,3072
s_add_u32 s53,s80,8256
buffer_load_dwordx4 v3,s[32:35],s53 offen lds
s_add_u32 m0,s60,73728
s_add_u32 s53,s72,128
buffer_load_dwordx4 v2,s[36:39],s53 offen lds
s_add_u32 s53,s68,1
s_and_b32 s53,s53,7
s_mul_i32 s73,s53,524288
s_add_u32 s73,s73,s56
s_lshl_b32 s53,s53,7
s_add_u32 s81,s55,s53
s_add_u32 m0,s60,81920
s_add_u32 s53,s72,256
buffer_load_dwordx4 v2,s[36:39],s53 offen lds
v_lshrrev_b32 v66,4,v1
v_bfe_u32 v65,v1,2,2
v_lshl_add_u32 v64,v66,3,v65
v_lshlrev_b32 v64,7,v64
v_xor_b32 v66,v65,v66
v_bfe_u32 v65,v1,3,1
v_lshl_add_u32 v64,v65,6,v64
v_bfe_u32 v65,v1,4,1
v_lshl_add_u32 v64,v65,4,v64
v_bfe_u32 v65,v1,1,1
v_lshl_add_u32 v64,v65,5,v64
v_and_b32 v65,1,v1
v_lshl_add_u32 v64,v65,3,v64
v_add_u32 v5,65536,v64
v_xor_b32 v6,16,v5
v_xor_b32 v7,64,v5
v_xor_b32 v8,64,v6
v_and_b32 v64,15,v1
v_lshlrev_b32 v66,4,v66
v_lshl_add_u32 v64,v64,6,v66
v_add_u32 v9,s58,v64
s_lshr_b32 s54,s55,16
s_lshl_b32 s54,s54,15
s_bfe_u32 s57,s55,0x1000f
s_lshl_b32 s57,s57,13
s_add_u32 s54,s54,s57
v_lshrrev_b32 v4,4,v1
v_and_b32 v64,15,v1
v_lshlrev_b32 v64,4,v64
v_lshl_add_u32 v4,v4,9,v64
v_and_b32 v64,8,v1
v_lshl_add_u32 v4,v64,4,v4
v_add_u32 v4,s54,v4
s_mov_b32 s61,0x3fb8aa3b
s_mov_b32 s71,0x3e0293ee
s_mov_b32 s62,0x358637bd
s_add_u32 m0,s60,90112
s_add_u32 s53,s72,384
buffer_load_dwordx4 v2,s[36:39],s53 offen lds
s_add_u32 m0,s58,4096
s_add_u32 s53,s81,0
buffer_load_dwordx4 v3,s[32:35],s53 offen lds
s_add_u32 m0,s58,5120
s_add_u32 s53,s81,8192
buffer_load_dwordx4 v3,s[32:35],s53 offen lds
s_add_u32 m0,s60,98304
s_add_u32 s53,s72,512
buffer_load_dwordx4 v2,s[36:39],s53 offen lds
s_add_u32 m0,s60,106496
s_add_u32 s53,s73,0
buffer_load_dwordx4 v2,s[36:39],s53 offen lds
s_add_u32 m0,s58,6144
s_add_u32 s53,s81,64
buffer_load_dwordx4 v3,s[32:35],s53 offen lds
s_add_u32 m0,s58,7168
s_add_u32 s53,s81,8256
buffer_load_dwordx4 v3,s[32:35],s53 offen lds
s_add_u32 m0,s60,114688
s_add_u32 s53,s73,128
buffer_load_dwordx4 v2,s[36:39],s53 offen lds
s_add_u32 m0,s60,122880
s_add_u32 s53,s73,256
buffer_load_dwordx4 v2,s[36:39],s53 offen lds
s_add_u32 s53,s68,2
s_and_b32 s53,s53,7
s_mul_i32 s74,s53,524288
s_add_u32 s74,s74,s56
s_lshl_b32 s53,s53,7
s_add_u32 s82,s55,s53
s_add_u32 s53,s68,3
s_and_b32 s53,s53,7
s_mul_i32 s75,s53,524288
s_add_u32 s75,s75,s56
s_lshl_b32 s53,s53,7
s_add_u32 s83,s55,s53
s_add_u32 s53,s68,4
s_and_b32 s53,s53,7
s_mul_i32 s76,s53,524288
s_add_u32 s76,s76,s56
s_lshl_b32 s53,s53,7
s_add_u32 s84,s55,s53
s_add_u32 s53,s68,5
s_and_b32 s53,s53,7
s_mul_i32 s77,s53,524288
s_add_u32 s77,s77,s56
s_lshl_b32 s53,s53,7
s_add_u32 s85,s55,s53
s_add_u32 s53,s68,6
s_and_b32 s53,s53,7
s_mul_i32 s78,s53,524288
s_add_u32 s78,s78,s56
s_lshl_b32 s53,s53,7
s_add_u32 s86,s55,s53
s_add_u32 s53,s68,7
s_and_b32 s53,s53,7
s_mul_i32 s79,s53,524288
s_add_u32 s79,s79,s56
s_lshl_b32 s53,s53,7
s_add_u32 s87,s55,s53
s_mov_b32 s16,s50
s_and_b32 s26,s98,7
s_lshr_b32 s27,s98,3
s_and_b32 s17,s27,3
s_lshl_b32 s26,s26,2
s_add_u32 s17,s17,s26
s_lshr_b32 s18,s27,2
s_lshl_b32 s26,s18,2
s_add_u32 s19,s26,s16
s_sub_u32 s27,67,s19
s_cmp_lt_u32 s16,4
s_cselect_b32 s19,s19,s27
s_cselect_b32 s28,1,0
s_waitcnt vmcnt(13)
ds_read_b128 v[80:83],v9 offset:0
ds_read_b128 v[84:87],v9 offset:1024
s_waitcnt vmcnt(11)
ds_read_b128 v[88:91],v9 offset:2048
ds_read_b128 v[92:95],v9 offset:3072
s_waitcnt vmcnt(9)
s_barrier
ds_read_b64_tr_b16 v[40:41],v5 offset:0
ds_read_b64_tr_b16 v[42:43],v5 offset:512
ds_read_b64_tr_b16 v[44:45],v6 offset:0
ds_read_b64_tr_b16 v[46:47],v6 offset:512
ds_read_b64_tr_b16 v[64:65],v7 offset:0
ds_read_b64_tr_b16 v[66:67],v7 offset:512
ds_read_b64_tr_b16 v[68:69],v8 offset:0
ds_read_b64_tr_b16 v[70:71],v8 offset:512
ds_read_b64_tr_b16 v[72:73],v5 offset:4096
ds_read_b64_tr_b16 v[74:75],v5 offset:4608
s_setprio 3
s_waitcnt lgkmcnt(8)
v_mfma_f32_16x16x32_bf16 v[128:131],v[80:83],v[40:43],0
s_add_u32 m0,s60,131072
s_add_u32 s53,s73,384
buffer_load_dwordx4 v2,s[36:39],s53 offen lds
ds_read_b64_tr_b16 v[76:77],v6 offset:4096
ds_read_b64_tr_b16 v[78:79],v6 offset:4608
v_mfma_f32_16x16x32_bf16 v[132:135],v[84:87],v[40:43],0
s_add_u32 m0,s58,0
s_add_u32 s53,s82,0
buffer_load_dwordx4 v3,s[32:35],s53 offen lds
s_waitcnt lgkmcnt(8)
v_mfma_f32_16x16x32_bf16 v[140:143],v[84:87],v[44:47],0
s_add_u32 m0,s60,139264
s_add_u32 s53,s73,512
buffer_load_dwordx4 v2,s[36:39],s53 offen lds
v_mfma_f32_16x16x32_bf16 v[136:139],v[80:83],v[44:47],0
s_add_u32 m0,s58,1024
s_add_u32 s53,s82,8192
buffer_load_dwordx4 v3,s[32:35],s53 offen lds
ds_read_b64_tr_b16 v[40:41],v7 offset:4096
ds_read_b64_tr_b16 v[42:43],v7 offset:4608
s_waitcnt lgkmcnt(8)
v_mfma_f32_16x16x32_bf16 v[144:147],v[80:83],v[64:67],0
ds_read_b64_tr_b16 v[44:45],v8 offset:4096
ds_read_b64_tr_b16 v[46:47],v8 offset:4608
v_mfma_f32_16x16x32_bf16 v[148:151],v[84:87],v[64:67],0
s_add_u32 m0,s58,2048
s_add_u32 s53,s82,64
buffer_load_dwordx4 v3,s[32:35],s53 offen lds
s_waitcnt lgkmcnt(8)
v_mfma_f32_16x16x32_bf16 v[156:159],v[84:87],v[68:71],0
s_add_u32 m0,s60,147456
s_add_u32 s53,s74,0
buffer_load_dwordx4 v2,s[36:39],s53 offen lds
v_mfma_f32_16x16x32_bf16 v[152:155],v[80:83],v[68:71],0
s_add_u32 m0,s58,3072
s_add_u32 s53,s82,8256
buffer_load_dwordx4 v3,s[32:35],s53 offen lds
ds_read_b64_tr_b16 v[64:65],v5 offset:8192
ds_read_b64_tr_b16 v[66:67],v5 offset:8704
s_setprio 2
s_waitcnt lgkmcnt(8)
v_mfma_f32_16x16x32_bf16 v[128:131],v[88:91],v[72:75],v[128:131]
ds_read_b64_tr_b16 v[68:69],v6 offset:8192
ds_read_b64_tr_b16 v[70:71],v6 offset:8704
v_mfma_f32_16x16x32_bf16 v[132:135],v[92:95],v[72:75],v[132:135]
s_add_u32 m0,s60,155648
s_add_u32 s53,s74,128
buffer_load_dwordx4 v2,s[36:39],s53 offen lds
s_waitcnt lgkmcnt(8)
v_mfma_f32_16x16x32_bf16 v[140:143],v[92:95],v[76:79],v[140:143]
v_mfma_f32_16x16x32_bf16 v[136:139],v[88:91],v[76:79],v[136:139]
ds_read_b64_tr_b16 v[72:73],v7 offset:8192
ds_read_b64_tr_b16 v[74:75],v7 offset:8704
s_waitcnt lgkmcnt(8)
v_mfma_f32_16x16x32_bf16 v[144:147],v[88:91],v[40:43],v[144:147]
ds_read_b64_tr_b16 v[76:77],v8 offset:8192
ds_read_b64_tr_b16 v[78:79],v8 offset:8704
v_mfma_f32_16x16x32_bf16 v[148:151],v[92:95],v[40:43],v[148:151]
s_waitcnt lgkmcnt(8)
v_mfma_f32_16x16x32_bf16 v[156:159],v[92:95],v[44:47],v[156:159]
v_mfma_f32_16x16x32_bf16 v[152:155],v[88:91],v[44:47],v[152:155]
ds_read_b64_tr_b16 v[40:41],v5 offset:12288
ds_read_b64_tr_b16 v[42:43],v5 offset:12800
s_setprio 1
s_waitcnt lgkmcnt(8)
v_mfma_f32_16x16x32_bf16 v[24:27],v[80:83],v[64:67],0
ds_read_b64_tr_b16 v[44:45],v6 offset:12288
ds_read_b64_tr_b16 v[46:47],v6 offset:12800
v_mfma_f32_16x16x32_bf16 v[28:31],v[84:87],v[64:67],0
s_waitcnt lgkmcnt(8)
v_mfma_f32_16x16x32_bf16 v[36:39],v[84:87],v[68:71],0
v_mfma_f32_16x16x32_bf16 v[32:35],v[80:83],v[68:71],0
ds_read_b64_tr_b16 v[64:65],v7 offset:12288
ds_read_b64_tr_b16 v[66:67],v7 offset:12800
s_waitcnt lgkmcnt(8)
v_mfma_f32_16x16x32_bf16 v[48:51],v[80:83],v[72:75],0
ds_read_b64_tr_b16 v[68:69],v8 offset:12288
ds_read_b64_tr_b16 v[70:71],v8 offset:12800
v_mfma_f32_16x16x32_bf16 v[52:55],v[84:87],v[72:75],0
s_waitcnt lgkmcnt(8)
v_mfma_f32_16x16x32_bf16 v[60:63],v[84:87],v[76:79],0
v_mfma_f32_16x16x32_bf16 v[56:59],v[80:83],v[76:79],0
ds_read_b64_tr_b16 v[72:73],v5 offset:16384
ds_read_b64_tr_b16 v[74:75],v5 offset:16896
s_setprio 0
s_waitcnt lgkmcnt(8)
v_mfma_f32_16x16x32_bf16 v[24:27],v[88:91],v[40:43],v[24:27]
ds_read_b64_tr_b16 v[76:77],v6 offset:16384
ds_read_b64_tr_b16 v[78:79],v6 offset:16896
v_mfma_f32_16x16x32_bf16 v[28:31],v[92:95],v[40:43],v[28:31]
s_waitcnt lgkmcnt(8)
v_mfma_f32_16x16x32_bf16 v[36:39],v[92:95],v[44:47],v[36:39]
v_mfma_f32_16x16x32_bf16 v[32:35],v[88:91],v[44:47],v[32:35]
ds_read_b64_tr_b16 v[40:41],v7 offset:16384
ds_read_b64_tr_b16 v[42:43],v7 offset:16896
s_waitcnt lgkmcnt(8)
v_mfma_f32_16x16x32_bf16 v[48:51],v[88:91],v[64:67],v[48:51]
ds_read_b64_tr_b16 v[44:45],v8 offset:16384
ds_read_b64_tr_b16 v[46:47],v8 offset:16896
v_mfma_f32_16x16x32_bf16 v[52:55],v[92:95],v[64:67],v[52:55]
s_waitcnt lgkmcnt(8)
v_mfma_f32_16x16x32_bf16 v[60:63],v[92:95],v[68:71],v[60:63]
v_mfma_f32_16x16x32_bf16 v[56:59],v[88:91],v[68:71],v[56:59]
s_waitcnt vmcnt(12)
s_barrier
ds_read_b64_tr_b16 v[64:65],v5 offset:20480
ds_read_b64_tr_b16 v[66:67],v5 offset:20992
s_setprio 3
s_waitcnt lgkmcnt(8)
v_mfma_f32_16x16x32_bf16 v[160:163],v[80:83],v[72:75],0
ds_read_b64_tr_b16 v[68:69],v6 offset:20480
ds_read_b64_tr_b16 v[70:71],v6 offset:20992
v_mfma_f32_16x16x32_bf16 v[164:167],v[84:87],v[72:75],0
s_add_u32 m0,s60,65536
s_add_u32 s53,s74,256
buffer_load_dwordx4 v2,s[36:39],s53 offen lds
s_waitcnt lgkmcnt(8)
v_mfma_f32_16x16x32_bf16 v[172:175],v[84:87],v[76:79],0
v_mfma_f32_16x16x32_bf16 v[168:171],v[80:83],v[76:79],0
ds_read_b64_tr_b16 v[72:73],v7 offset:20480
ds_read_b64_tr_b16 v[74:75],v7 offset:20992
s_waitcnt lgkmcnt(8)
v_mfma_f32_16x16x32_bf16 v[176:179],v[80:83],v[40:43],0
ds_read_b64_tr_b16 v[76:77],v8 offset:20480
ds_read_b64_tr_b16 v[78:79],v8 offset:20992
v_mfma_f32_16x16x32_bf16 v[180:183],v[84:87],v[40:43],0
s_waitcnt lgkmcnt(8)
v_mfma_f32_16x16x32_bf16 v[188:191],v[84:87],v[44:47],0
v_mfma_f32_16x16x32_bf16 v[184:187],v[80:83],v[44:47],0
ds_read_b64_tr_b16 v[40:41],v5 offset:24576
ds_read_b64_tr_b16 v[42:43],v5 offset:25088
s_waitcnt lgkmcnt(8)
v_mfma_f32_16x16x32_bf16 v[160:163],v[88:91],v[64:67],v[160:163]
ds_read_b64_tr_b16 v[44:45],v6 offset:24576
ds_read_b64_tr_b16 v[46:47],v6 offset:25088
v_mfma_f32_16x16x32_bf16 v[164:167],v[92:95],v[64:67],v[164:167]
s_add_u32 m0,s60,73728
s_add_u32 s53,s74,384
buffer_load_dwordx4 v2,s[36:39],s53 offen lds
s_waitcnt lgkmcnt(8)
v_mfma_f32_16x16x32_bf16 v[172:175],v[92:95],v[68:71],v[172:175]
v_mfma_f32_16x16x32_bf16 v[168:171],v[88:91],v[68:71],v[168:171]
ds_read_b64_tr_b16 v[64:65],v7 offset:24576
ds_read_b64_tr_b16 v[66:67],v7 offset:25088
s_setprio 2
s_waitcnt lgkmcnt(8)
v_mfma_f32_16x16x32_bf16 v[176:179],v[88:91],v[72:75],v[176:179]
ds_read_b64_tr_b16 v[68:69],v8 offset:24576
ds_read_b64_tr_b16 v[70:71],v8 offset:25088
v_mfma_f32_16x16x32_bf16 v[180:183],v[92:95],v[72:75],v[180:183]
s_waitcnt lgkmcnt(8)
v_mfma_f32_16x16x32_bf16 v[188:191],v[92:95],v[76:79],v[188:191]
v_mfma_f32_16x16x32_bf16 v[184:187],v[88:91],v[76:79],v[184:187]
ds_read_b64_tr_b16 v[72:73],v5 offset:28672
ds_read_b64_tr_b16 v[74:75],v5 offset:29184
s_waitcnt lgkmcnt(8)
v_mfma_f32_16x16x32_bf16 v[192:195],v[80:83],v[40:43],0
ds_read_b64_tr_b16 v[76:77],v6 offset:28672
ds_read_b64_tr_b16 v[78:79],v6 offset:29184
v_mfma_f32_16x16x32_bf16 v[196:199],v[84:87],v[40:43],0
ds_read_b128 v[96:99],v9 offset:4096
ds_read_b128 v[100:103],v9 offset:5120
s_waitcnt lgkmcnt(10)
v_mfma_f32_16x16x32_bf16 v[204:207],v[84:87],v[44:47],0
v_mfma_f32_16x16x32_bf16 v[200:203],v[80:83],v[44:47],0
ds_read_b64_tr_b16 v[40:41],v7 offset:28672
ds_read_b64_tr_b16 v[42:43],v7 offset:29184
s_waitcnt lgkmcnt(10)
v_mfma_f32_16x16x32_bf16 v[208:211],v[80:83],v[64:67],0
ds_read_b64_tr_b16 v[44:45],v8 offset:28672
ds_read_b64_tr_b16 v[46:47],v8 offset:29184
v_mfma_f32_16x16x32_bf16 v[212:215],v[84:87],v[64:67],0
s_waitcnt lgkmcnt(10)
v_mfma_f32_16x16x32_bf16 v[220:223],v[84:87],v[68:71],0
v_mfma_f32_16x16x32_bf16 v[216:219],v[80:83],v[68:71],0
ds_read_b64_tr_b16 v[64:65],v5 offset:32768
ds_read_b64_tr_b16 v[66:67],v5 offset:33280
s_setprio 1
s_waitcnt lgkmcnt(10)
v_mfma_f32_16x16x32_bf16 v[192:195],v[88:91],v[72:75],v[192:195]
ds_read_b64_tr_b16 v[68:69],v6 offset:32768
ds_read_b64_tr_b16 v[70:71],v6 offset:33280
v_mfma_f32_16x16x32_bf16 v[196:199],v[92:95],v[72:75],v[196:199]
s_waitcnt lgkmcnt(10)
v_mfma_f32_16x16x32_bf16 v[204:207],v[92:95],v[76:79],v[204:207]
v_mfma_f32_16x16x32_bf16 v[200:203],v[88:91],v[76:79],v[200:203]
ds_read_b64_tr_b16 v[72:73],v7 offset:32768
ds_read_b64_tr_b16 v[74:75],v7 offset:33280
s_waitcnt lgkmcnt(8)
v_mfma_f32_16x16x32_bf16 v[208:211],v[88:91],v[40:43],v[208:211]
ds_read_b64_tr_b16 v[76:77],v8 offset:32768
ds_read_b64_tr_b16 v[78:79],v8 offset:33280
v_mfma_f32_16x16x32_bf16 v[212:215],v[92:95],v[40:43],v[212:215]
s_add_u32 m0,s58,4096
s_add_u32 s53,s83,0
buffer_load_dwordx4 v3,s[32:35],s53 offen lds
s_waitcnt lgkmcnt(8)
v_mfma_f32_16x16x32_bf16 v[220:223],v[92:95],v[44:47],v[220:223]
v_mfma_f32_16x16x32_bf16 v[216:219],v[88:91],v[44:47],v[216:219]
s_add_u32 m0,s58,5120
s_add_u32 s53,s83,8192
buffer_load_dwordx4 v3,s[32:35],s53 offen lds
ds_read_b64_tr_b16 v[40:41],v5 offset:36864
ds_read_b64_tr_b16 v[42:43],v5 offset:37376
s_waitcnt lgkmcnt(8)
v_mfma_f32_16x16x32_bf16 v[224:227],v[80:83],v[64:67],0
ds_read_b64_tr_b16 v[44:45],v6 offset:36864
ds_read_b64_tr_b16 v[46:47],v6 offset:37376
v_mfma_f32_16x16x32_bf16 v[228:231],v[84:87],v[64:67],0
s_waitcnt lgkmcnt(8)
v_mfma_f32_16x16x32_bf16 v[236:239],v[84:87],v[68:71],0
v_mfma_f32_16x16x32_bf16 v[232:235],v[80:83],v[68:71],0
ds_read_b64_tr_b16 v[64:65],v7 offset:36864
ds_read_b64_tr_b16 v[66:67],v7 offset:37376
s_setprio 0
s_waitcnt lgkmcnt(8)
v_mfma_f32_16x16x32_bf16 v[240:243],v[80:83],v[72:75],0
ds_read_b64_tr_b16 v[68:69],v8 offset:36864
ds_read_b64_tr_b16 v[70:71],v8 offset:37376
v_mfma_f32_16x16x32_bf16 v[244:247],v[84:87],v[72:75],0
s_waitcnt lgkmcnt(8)
v_mfma_f32_16x16x32_bf16 v[252:255],v[84:87],v[76:79],0
v_mfma_f32_16x16x32_bf16 v[248:251],v[80:83],v[76:79],0
ds_read_b64_tr_b16 v[72:73],v5 offset:40960
ds_read_b64_tr_b16 v[74:75],v5 offset:41472
s_waitcnt lgkmcnt(8)
v_mfma_f32_16x16x32_bf16 v[224:227],v[88:91],v[40:43],v[224:227]
ds_read_b64_tr_b16 v[76:77],v6 offset:40960
ds_read_b64_tr_b16 v[78:79],v6 offset:41472
v_mfma_f32_16x16x32_bf16 v[228:231],v[92:95],v[40:43],v[228:231]
s_waitcnt lgkmcnt(8)
v_mfma_f32_16x16x32_bf16 v[236:239],v[92:95],v[44:47],v[236:239]
v_mfma_f32_16x16x32_bf16 v[232:235],v[88:91],v[44:47],v[232:235]
s_waitcnt vmcnt(14)
ds_read_b128 v[104:107],v9 offset:6144
ds_read_b128 v[108:111],v9 offset:7168
ds_read_b64_tr_b16 v[40:41],v7 offset:40960
ds_read_b64_tr_b16 v[42:43],v7 offset:41472
s_waitcnt lgkmcnt(10)
v_mfma_f32_16x16x32_bf16 v[240:243],v[88:91],v[64:67],v[240:243]
ds_read_b64_tr_b16 v[44:45],v8 offset:40960
ds_read_b64_tr_b16 v[46:47],v8 offset:41472
v_mfma_f32_16x16x32_bf16 v[244:247],v[92:95],v[64:67],v[244:247]
s_waitcnt lgkmcnt(10)
v_mfma_f32_16x16x32_bf16 v[252:255],v[92:95],v[68:71],v[252:255]
v_mfma_f32_16x16x32_bf16 v[248:251],v[88:91],v[68:71],v[248:251]
s_waitcnt vmcnt(6)
s_barrier
ds_read_b64_tr_b16 v[64:65],v5 offset:45056
ds_read_b64_tr_b16 v[66:67],v5 offset:45568
s_setprio 3
s_waitcnt lgkmcnt(10)
v_mfma_f32_16x16x32_bf16 v[128:131],v[96:99],v[72:75],v[128:131]
ds_read_b64_tr_b16 v[68:69],v6 offset:45056
ds_read_b64_tr_b16 v[70:71],v6 offset:45568
v_mfma_f32_16x16x32_bf16 v[132:135],v[100:103],v[72:75],v[132:135]
s_add_u32 m0,s60,81920
s_add_u32 s53,s74,512
buffer_load_dwordx4 v2,s[36:39],s53 offen lds
s_waitcnt lgkmcnt(10)
v_mfma_f32_16x16x32_bf16 v[140:143],v[100:103],v[76:79],v[140:143]
v_mfma_f32_16x16x32_bf16 v[136:139],v[96:99],v[76:79],v[136:139]
ds_read_b64_tr_b16 v[72:73],v7 offset:45056
ds_read_b64_tr_b16 v[74:75],v7 offset:45568
s_waitcnt lgkmcnt(8)
v_mfma_f32_16x16x32_bf16 v[144:147],v[96:99],v[40:43],v[144:147]
ds_read_b64_tr_b16 v[76:77],v8 offset:45056
ds_read_b64_tr_b16 v[78:79],v8 offset:45568
v_mfma_f32_16x16x32_bf16 v[148:151],v[100:103],v[40:43],v[148:151]
s_waitcnt lgkmcnt(8)
v_mfma_f32_16x16x32_bf16 v[156:159],v[100:103],v[44:47],v[156:159]
v_mfma_f32_16x16x32_bf16 v[152:155],v[96:99],v[44:47],v[152:155]
s_add_u32 m0,s58,6144
s_add_u32 s53,s83,64
buffer_load_dwordx4 v3,s[32:35],s53 offen lds
ds_read_b64_tr_b16 v[40:41],v5 offset:49152
ds_read_b64_tr_b16 v[42:43],v5 offset:49664
s_waitcnt lgkmcnt(8)
v_mfma_f32_16x16x32_bf16 v[128:131],v[104:107],v[64:67],v[128:131]
ds_read_b64_tr_b16 v[44:45],v6 offset:49152
ds_read_b64_tr_b16 v[46:47],v6 offset:49664
v_mfma_f32_16x16x32_bf16 v[132:135],v[108:111],v[64:67],v[132:135]
s_add_u32 m0,s58,7168
s_add_u32 s53,s83,8256
buffer_load_dwordx4 v3,s[32:35],s53 offen lds
s_waitcnt lgkmcnt(8)
v_mfma_f32_16x16x32_bf16 v[140:143],v[108:111],v[68:71],v[140:143]
v_mfma_f32_16x16x32_bf16 v[136:139],v[104:107],v[68:71],v[136:139]
s_add_u32 m0,s60,90112
s_add_u32 s53,s75,0
buffer_load_dwordx4 v2,s[36:39],s53 offen lds
ds_read_b64_tr_b16 v[64:65],v7 offset:49152
ds_read_b64_tr_b16 v[66:67],v7 offset:49664
s_waitcnt lgkmcnt(8)
v_mfma_f32_16x16x32_bf16 v[144:147],v[104:107],v[72:75],v[144:147]
ds_read_b64_tr_b16 v[68:69],v8 offset:49152
ds_read_b64_tr_b16 v[70:71],v8 offset:49664
v_mfma_f32_16x16x32_bf16 v[148:151],v[108:111],v[72:75],v[148:151]
s_waitcnt lgkmcnt(8)
v_mfma_f32_16x16x32_bf16 v[156:159],v[108:111],v[76:79],v[156:159]
v_mfma_f32_16x16x32_bf16 v[152:155],v[104:107],v[76:79],v[152:155]
ds_read_b64_tr_b16 v[72:73],v5 offset:53248
ds_read_b64_tr_b16 v[74:75],v5 offset:53760
s_waitcnt lgkmcnt(8)
v_mfma_f32_16x16x32_bf16 v[24:27],v[96:99],v[40:43],v[24:27]
ds_read_b64_tr_b16 v[76:77],v6 offset:53248
ds_read_b64_tr_b16 v[78:79],v6 offset:53760
v_mfma_f32_16x16x32_bf16 v[28:31],v[100:103],v[40:43],v[28:31]
s_waitcnt lgkmcnt(8)
v_mfma_f32_16x16x32_bf16 v[36:39],v[100:103],v[44:47],v[36:39]
v_mfma_f32_16x16x32_bf16 v[32:35],v[96:99],v[44:47],v[32:35]
ds_read_b64_tr_b16 v[40:41],v7 offset:53248
ds_read_b64_tr_b16 v[42:43],v7 offset:53760
s_setprio 2
s_waitcnt lgkmcnt(8)
v_mfma_f32_16x16x32_bf16 v[48:51],v[96:99],v[64:67],v[48:51]
s_add_u32 m0,s60,98304
s_add_u32 s53,s75,128
buffer_load_dwordx4 v2,s[36:39],s53 offen lds
ds_read_b64_tr_b16 v[44:45],v8 offset:53248
ds_read_b64_tr_b16 v[46:47],v8 offset:53760
v_mfma_f32_16x16x32_bf16 v[52:55],v[100:103],v[64:67],v[52:55]
ds_read_b128 v[112:115],v9 offset:0
ds_read_b128 v[116:119],v9 offset:1024
s_waitcnt lgkmcnt(10)
v_mfma_f32_16x16x32_bf16 v[60:63],v[100:103],v[68:71],v[60:63]
v_mfma_f32_16x16x32_bf16 v[56:59],v[96:99],v[68:71],v[56:59]
ds_read_b64_tr_b16 v[64:65],v5 offset:57344
ds_read_b64_tr_b16 v[66:67],v5 offset:57856
s_waitcnt lgkmcnt(10)
v_mfma_f32_16x16x32_bf16 v[24:27],v[104:107],v[72:75],v[24:27]
ds_read_b64_tr_b16 v[68:69],v6 offset:57344
ds_read_b64_tr_b16 v[70:71],v6 offset:57856
v_mfma_f32_16x16x32_bf16 v[28:31],v[108:111],v[72:75],v[28:31]
s_waitcnt lgkmcnt(10)
v_mfma_f32_16x16x32_bf16 v[36:39],v[108:111],v[76:79],v[36:39]
v_mfma_f32_16x16x32_bf16 v[32:35],v[104:107],v[76:79],v[32:35]
ds_read_b64_tr_b16 v[72:73],v7 offset:57344
ds_read_b64_tr_b16 v[74:75],v7 offset:57856
s_waitcnt lgkmcnt(10)
v_mfma_f32_16x16x32_bf16 v[48:51],v[104:107],v[40:43],v[48:51]
ds_read_b64_tr_b16 v[76:77],v8 offset:57344
ds_read_b64_tr_b16 v[78:79],v8 offset:57856
v_mfma_f32_16x16x32_bf16 v[52:55],v[108:111],v[40:43],v[52:55]
s_waitcnt lgkmcnt(10)
v_mfma_f32_16x16x32_bf16 v[60:63],v[108:111],v[44:47],v[60:63]
v_mfma_f32_16x16x32_bf16 v[56:59],v[104:107],v[44:47],v[56:59]
ds_read_b64_tr_b16 v[40:41],v5 offset:61440
ds_read_b64_tr_b16 v[42:43],v5 offset:61952
s_waitcnt lgkmcnt(8)
v_mfma_f32_16x16x32_bf16 v[160:163],v[96:99],v[64:67],v[160:163]
ds_read_b64_tr_b16 v[44:45],v6 offset:61440
ds_read_b64_tr_b16 v[46:47],v6 offset:61952
v_mfma_f32_16x16x32_bf16 v[164:167],v[100:103],v[64:67],v[164:167]
s_add_u32 m0,s58,0
s_add_u32 s53,s84,0
buffer_load_dwordx4 v3,s[32:35],s53 offen lds
s_waitcnt lgkmcnt(8)
v_mfma_f32_16x16x32_bf16 v[172:175],v[100:103],v[68:71],v[172:175]
v_mfma_f32_16x16x32_bf16 v[168:171],v[96:99],v[68:71],v[168:171]
s_add_u32 m0,s58,1024
s_add_u32 s53,s84,8192
buffer_load_dwordx4 v3,s[32:35],s53 offen lds
ds_read_b64_tr_b16 v[64:65],v7 offset:61440
ds_read_b64_tr_b16 v[66:67],v7 offset:61952
s_waitcnt lgkmcnt(8)
v_mfma_f32_16x16x32_bf16 v[176:179],v[96:99],v[72:75],v[176:179]
ds_read_b64_tr_b16 v[68:69],v8 offset:61440
ds_read_b64_tr_b16 v[70:71],v8 offset:61952
v_mfma_f32_16x16x32_bf16 v[180:183],v[100:103],v[72:75],v[180:183]
s_waitcnt lgkmcnt(8)
v_mfma_f32_16x16x32_bf16 v[188:191],v[100:103],v[76:79],v[188:191]
v_mfma_f32_16x16x32_bf16 v[184:187],v[96:99],v[76:79],v[184:187]
v_add_u32 v5,0x10000,v5
ds_read_b64_tr_b16 v[72:73],v5 offset:0
ds_read_b64_tr_b16 v[74:75],v5 offset:512
s_setprio 1
s_waitcnt lgkmcnt(8)
v_mfma_f32_16x16x32_bf16 v[160:163],v[104:107],v[40:43],v[160:163]
v_add_u32 v6,0x10000,v6
ds_read_b64_tr_b16 v[76:77],v6 offset:0
ds_read_b64_tr_b16 v[78:79],v6 offset:512
v_mfma_f32_16x16x32_bf16 v[164:167],v[108:111],v[40:43],v[164:167]
s_waitcnt lgkmcnt(8)
v_mfma_f32_16x16x32_bf16 v[172:175],v[108:111],v[44:47],v[172:175]
v_mfma_f32_16x16x32_bf16 v[168:171],v[104:107],v[44:47],v[168:171]
v_add_u32 v7,0x10000,v7
ds_read_b64_tr_b16 v[40:41],v7 offset:0
ds_read_b64_tr_b16 v[42:43],v7 offset:512
s_waitcnt lgkmcnt(8)
v_mfma_f32_16x16x32_bf16 v[176:179],v[104:107],v[64:67],v[176:179]
v_add_u32 v8,0x10000,v8
ds_read_b64_tr_b16 v[44:45],v8 offset:0
ds_read_b64_tr_b16 v[46:47],v8 offset:512
v_mfma_f32_16x16x32_bf16 v[180:183],v[108:111],v[64:67],v[180:183]
s_waitcnt lgkmcnt(8)
v_mfma_f32_16x16x32_bf16 v[188:191],v[108:111],v[68:71],v[188:191]
v_mfma_f32_16x16x32_bf16 v[184:187],v[104:107],v[68:71],v[184:187]
s_waitcnt vmcnt(12)
ds_read_b128 v[120:123],v9 offset:2048
ds_read_b128 v[124:127],v9 offset:3072
ds_read_b64_tr_b16 v[64:65],v5 offset:4096
ds_read_b64_tr_b16 v[66:67],v5 offset:4608
s_waitcnt lgkmcnt(10)
v_mfma_f32_16x16x32_bf16 v[192:195],v[96:99],v[72:75],v[192:195]
ds_read_b64_tr_b16 v[68:69],v6 offset:4096
ds_read_b64_tr_b16 v[70:71],v6 offset:4608
v_mfma_f32_16x16x32_bf16 v[196:199],v[100:103],v[72:75],v[196:199]
s_waitcnt lgkmcnt(10)
v_mfma_f32_16x16x32_bf16 v[204:207],v[100:103],v[76:79],v[204:207]
v_mfma_f32_16x16x32_bf16 v[200:203],v[96:99],v[76:79],v[200:203]
ds_read_b64_tr_b16 v[72:73],v7 offset:4096
ds_read_b64_tr_b16 v[74:75],v7 offset:4608
s_waitcnt lgkmcnt(10)
v_mfma_f32_16x16x32_bf16 v[208:211],v[96:99],v[40:43],v[208:211]
ds_read_b64_tr_b16 v[76:77],v8 offset:4096
ds_read_b64_tr_b16 v[78:79],v8 offset:4608
v_mfma_f32_16x16x32_bf16 v[212:215],v[100:103],v[40:43],v[212:215]
s_waitcnt lgkmcnt(10)
v_mfma_f32_16x16x32_bf16 v[220:223],v[100:103],v[44:47],v[220:223]
v_mfma_f32_16x16x32_bf16 v[216:219],v[96:99],v[44:47],v[216:219]
ds_read_b64_tr_b16 v[40:41],v5 offset:8192
ds_read_b64_tr_b16 v[42:43],v5 offset:8704
s_waitcnt lgkmcnt(8)
v_mfma_f32_16x16x32_bf16 v[192:195],v[104:107],v[64:67],v[192:195]
ds_read_b64_tr_b16 v[44:45],v6 offset:8192
ds_read_b64_tr_b16 v[46:47],v6 offset:8704
v_mfma_f32_16x16x32_bf16 v[196:199],v[108:111],v[64:67],v[196:199]
s_waitcnt lgkmcnt(8)
v_mfma_f32_16x16x32_bf16 v[204:207],v[108:111],v[68:71],v[204:207]
v_mfma_f32_16x16x32_bf16 v[200:203],v[104:107],v[68:71],v[200:203]
s_add_u32 m0,s58,2048
s_add_u32 s53,s84,64
buffer_load_dwordx4 v3,s[32:35],s53 offen lds
ds_read_b64_tr_b16 v[64:65],v7 offset:8192
ds_read_b64_tr_b16 v[66:67],v7 offset:8704
s_setprio 0
s_waitcnt lgkmcnt(8)
v_mfma_f32_16x16x32_bf16 v[208:211],v[104:107],v[72:75],v[208:211]
ds_read_b64_tr_b16 v[68:69],v8 offset:8192
ds_read_b64_tr_b16 v[70:71],v8 offset:8704
v_mfma_f32_16x16x32_bf16 v[212:215],v[108:111],v[72:75],v[212:215]
s_add_u32 m0,s58,3072
s_add_u32 s53,s84,8256
buffer_load_dwordx4 v3,s[32:35],s53 offen lds
s_waitcnt lgkmcnt(8)
v_mfma_f32_16x16x32_bf16 v[220:223],v[108:111],v[76:79],v[220:223]
v_mfma_f32_16x16x32_bf16 v[216:219],v[104:107],v[76:79],v[216:219]
ds_read_b64_tr_b16 v[72:73],v5 offset:12288
ds_read_b64_tr_b16 v[74:75],v5 offset:12800
s_waitcnt lgkmcnt(8)
v_mfma_f32_16x16x32_bf16 v[224:227],v[96:99],v[40:43],v[224:227]
ds_read_b64_tr_b16 v[76:77],v6 offset:12288
ds_read_b64_tr_b16 v[78:79],v6 offset:12800
v_mfma_f32_16x16x32_bf16 v[228:231],v[100:103],v[40:43],v[228:231]
s_waitcnt lgkmcnt(8)
v_mfma_f32_16x16x32_bf16 v[236:239],v[100:103],v[44:47],v[236:239]
v_mfma_f32_16x16x32_bf16 v[232:235],v[96:99],v[44:47],v[232:235]
ds_read_b64_tr_b16 v[40:41],v7 offset:12288
ds_read_b64_tr_b16 v[42:43],v7 offset:12800
s_waitcnt lgkmcnt(8)
v_mfma_f32_16x16x32_bf16 v[240:243],v[96:99],v[64:67],v[240:243]
ds_read_b64_tr_b16 v[44:45],v8 offset:12288
ds_read_b64_tr_b16 v[46:47],v8 offset:12800
v_mfma_f32_16x16x32_bf16 v[244:247],v[100:103],v[64:67],v[244:247]
s_waitcnt lgkmcnt(8)
v_mfma_f32_16x16x32_bf16 v[252:255],v[100:103],v[68:71],v[252:255]
v_mfma_f32_16x16x32_bf16 v[248:251],v[96:99],v[68:71],v[248:251]
ds_read_b64_tr_b16 v[64:65],v5 offset:16384
ds_read_b64_tr_b16 v[66:67],v5 offset:16896
s_waitcnt lgkmcnt(8)
v_mfma_f32_16x16x32_bf16 v[224:227],v[104:107],v[72:75],v[224:227]
ds_read_b64_tr_b16 v[68:69],v6 offset:16384
ds_read_b64_tr_b16 v[70:71],v6 offset:16896
v_mfma_f32_16x16x32_bf16 v[228:231],v[108:111],v[72:75],v[228:231]
s_waitcnt vmcnt(9)
ds_read_b128 v[80:83],v9 offset:4096
ds_read_b128 v[84:87],v9 offset:5120
s_waitcnt lgkmcnt(10)
v_mfma_f32_16x16x32_bf16 v[236:239],v[108:111],v[76:79],v[236:239]
v_mfma_f32_16x16x32_bf16 v[232:235],v[104:107],v[76:79],v[232:235]
ds_read_b64_tr_b16 v[72:73],v7 offset:16384
ds_read_b64_tr_b16 v[74:75],v7 offset:16896
s_waitcnt lgkmcnt(10)
v_mfma_f32_16x16x32_bf16 v[240:243],v[104:107],v[40:43],v[240:243]
ds_read_b64_tr_b16 v[76:77],v8 offset:16384
ds_read_b64_tr_b16 v[78:79],v8 offset:16896
v_mfma_f32_16x16x32_bf16 v[244:247],v[108:111],v[40:43],v[244:247]
s_waitcnt lgkmcnt(10)
v_mfma_f32_16x16x32_bf16 v[252:255],v[108:111],v[44:47],v[252:255]
v_mfma_f32_16x16x32_bf16 v[248:251],v[104:107],v[44:47],v[248:251]
s_waitcnt vmcnt(5)
s_barrier
ds_read_b64_tr_b16 v[40:41],v5 offset:20480
ds_read_b64_tr_b16 v[42:43],v5 offset:20992
s_setprio 3
s_waitcnt lgkmcnt(10)
v_mfma_f32_16x16x32_bf16 v[128:131],v[112:115],v[64:67],v[128:131]
ds_read_b64_tr_b16 v[44:45],v6 offset:20480
ds_read_b64_tr_b16 v[46:47],v6 offset:20992
v_mfma_f32_16x16x32_bf16 v[132:135],v[116:119],v[64:67],v[132:135]
s_add_u32 m0,s60,106496
s_add_u32 s53,s75,256
buffer_load_dwordx4 v2,s[36:39],s53 offen lds
s_waitcnt lgkmcnt(10)
v_mfma_f32_16x16x32_bf16 v[140:143],v[116:119],v[68:71],v[140:143]
v_mfma_f32_16x16x32_bf16 v[136:139],v[112:115],v[68:71],v[136:139]
ds_read_b64_tr_b16 v[64:65],v7 offset:20480
ds_read_b64_tr_b16 v[66:67],v7 offset:20992
s_waitcnt lgkmcnt(8)
v_mfma_f32_16x16x32_bf16 v[144:147],v[112:115],v[72:75],v[144:147]
ds_read_b64_tr_b16 v[68:69],v8 offset:20480
ds_read_b64_tr_b16 v[70:71],v8 offset:20992
v_mfma_f32_16x16x32_bf16 v[148:151],v[116:119],v[72:75],v[148:151]
s_add_u32 m0,s58,4096
s_add_u32 s53,s85,0
buffer_load_dwordx4 v3,s[32:35],s53 offen lds
s_waitcnt lgkmcnt(8)
v_mfma_f32_16x16x32_bf16 v[156:159],v[116:119],v[76:79],v[156:159]
s_add_u32 m0,s60,114688
s_add_u32 s53,s75,384
buffer_load_dwordx4 v2,s[36:39],s53 offen lds
v_mfma_f32_16x16x32_bf16 v[152:155],v[112:115],v[76:79],v[152:155]
s_add_u32 m0,s58,5120
s_add_u32 s53,s85,8192
buffer_load_dwordx4 v3,s[32:35],s53 offen lds
ds_read_b64_tr_b16 v[72:73],v5 offset:24576
ds_read_b64_tr_b16 v[74:75],v5 offset:25088
s_waitcnt lgkmcnt(8)
v_mfma_f32_16x16x32_bf16 v[128:131],v[120:123],v[40:43],v[128:131]
ds_read_b64_tr_b16 v[76:77],v6 offset:24576
ds_read_b64_tr_b16 v[78:79],v6 offset:25088
v_mfma_f32_16x16x32_bf16 v[132:135],v[124:127],v[40:43],v[132:135]
s_waitcnt lgkmcnt(8)
v_mfma_f32_16x16x32_bf16 v[140:143],v[124:127],v[44:47],v[140:143]
v_mfma_f32_16x16x32_bf16 v[136:139],v[120:123],v[44:47],v[136:139]
ds_read_b64_tr_b16 v[40:41],v7 offset:24576
ds_read_b64_tr_b16 v[42:43],v7 offset:25088
s_waitcnt lgkmcnt(8)
v_mfma_f32_16x16x32_bf16 v[144:147],v[120:123],v[64:67],v[144:147]
ds_read_b64_tr_b16 v[44:45],v8 offset:24576
ds_read_b64_tr_b16 v[46:47],v8 offset:25088
v_mfma_f32_16x16x32_bf16 v[148:151],v[124:127],v[64:67],v[148:151]
s_add_u32 m0,s60,122880
s_add_u32 s53,s75,512
buffer_load_dwordx4 v2,s[36:39],s53 offen lds
s_waitcnt lgkmcnt(8)
v_mfma_f32_16x16x32_bf16 v[156:159],v[124:127],v[68:71],v[156:159]
v_mfma_f32_16x16x32_bf16 v[152:155],v[120:123],v[68:71],v[152:155]
ds_read_b64_tr_b16 v[64:65],v5 offset:28672
ds_read_b64_tr_b16 v[66:67],v5 offset:29184
s_waitcnt lgkmcnt(8)
v_mfma_f32_16x16x32_bf16 v[24:27],v[112:115],v[72:75],v[24:27]
ds_read_b64_tr_b16 v[68:69],v6 offset:28672
ds_read_b64_tr_b16 v[70:71],v6 offset:29184
v_mfma_f32_16x16x32_bf16 v[28:31],v[116:119],v[72:75],v[28:31]
s_waitcnt lgkmcnt(8)
v_mfma_f32_16x16x32_bf16 v[36:39],v[116:119],v[76:79],v[36:39]
s_add_u32 m0,s60,131072
s_add_u32 s53,s76,0
buffer_load_dwordx4 v2,s[36:39],s53 offen lds
v_mfma_f32_16x16x32_bf16 v[32:35],v[112:115],v[76:79],v[32:35]
ds_read_b128 v[88:91],v9 offset:6144
ds_read_b128 v[92:95],v9 offset:7168
ds_read_b64_tr_b16 v[72:73],v7 offset:28672
ds_read_b64_tr_b16 v[74:75],v7 offset:29184
s_setprio 2
s_waitcnt lgkmcnt(10)
v_mfma_f32_16x16x32_bf16 v[48:51],v[112:115],v[40:43],v[48:51]
ds_read_b64_tr_b16 v[76:77],v8 offset:28672
ds_read_b64_tr_b16 v[78:79],v8 offset:29184
v_mfma_f32_16x16x32_bf16 v[52:55],v[116:119],v[40:43],v[52:55]
s_waitcnt lgkmcnt(10)
v_mfma_f32_16x16x32_bf16 v[60:63],v[116:119],v[44:47],v[60:63]
v_mfma_f32_16x16x32_bf16 v[56:59],v[112:115],v[44:47],v[56:59]
v_add_u32 v5,0xffff0000,v5
ds_read_b64_tr_b16 v[40:41],v5 offset:0
ds_read_b64_tr_b16 v[42:43],v5 offset:512
s_waitcnt lgkmcnt(10)
v_mfma_f32_16x16x32_bf16 v[24:27],v[120:123],v[64:67],v[24:27]
v_add_u32 v6,0xffff0000,v6
ds_read_b64_tr_b16 v[44:45],v6 offset:0
ds_read_b64_tr_b16 v[46:47],v6 offset:512
v_mfma_f32_16x16x32_bf16 v[28:31],v[124:127],v[64:67],v[28:31]
s_add_u32 m0,s60,139264
s_add_u32 s53,s76,128
buffer_load_dwordx4 v2,s[36:39],s53 offen lds
s_waitcnt lgkmcnt(10)
v_mfma_f32_16x16x32_bf16 v[36:39],v[124:127],v[68:71],v[36:39]
v_mfma_f32_16x16x32_bf16 v[32:35],v[120:123],v[68:71],v[32:35]
v_add_u32 v7,0xffff0000,v7
ds_read_b64_tr_b16 v[64:65],v7 offset:0
ds_read_b64_tr_b16 v[66:67],v7 offset:512
s_waitcnt lgkmcnt(8)
v_mfma_f32_16x16x32_bf16 v[48:51],v[120:123],v[72:75],v[48:51]
v_add_u32 v8,0xffff0000,v8
ds_read_b64_tr_b16 v[68:69],v8 offset:0
ds_read_b64_tr_b16 v[70:71],v8 offset:512
v_mfma_f32_16x16x32_bf16 v[52:55],v[124:127],v[72:75],v[52:55]
s_waitcnt lgkmcnt(8)
v_mfma_f32_16x16x32_bf16 v[60:63],v[124:127],v[76:79],v[60:63]
v_mfma_f32_16x16x32_bf16 v[56:59],v[120:123],v[76:79],v[56:59]
s_add_u32 m0,s58,6144
s_add_u32 s53,s85,64
buffer_load_dwordx4 v3,s[32:35],s53 offen lds
ds_read_b64_tr_b16 v[72:73],v5 offset:4096
ds_read_b64_tr_b16 v[74:75],v5 offset:4608
s_waitcnt lgkmcnt(8)
v_mfma_f32_16x16x32_bf16 v[160:163],v[112:115],v[40:43],v[160:163]
ds_read_b64_tr_b16 v[76:77],v6 offset:4096
ds_read_b64_tr_b16 v[78:79],v6 offset:4608
v_mfma_f32_16x16x32_bf16 v[164:167],v[116:119],v[40:43],v[164:167]
s_add_u32 m0,s58,7168
s_add_u32 s53,s85,8256
buffer_load_dwordx4 v3,s[32:35],s53 offen lds
s_waitcnt lgkmcnt(8)
v_mfma_f32_16x16x32_bf16 v[172:175],v[116:119],v[44:47],v[172:175]
v_mfma_f32_16x16x32_bf16 v[168:171],v[112:115],v[44:47],v[168:171]
ds_read_b64_tr_b16 v[40:41],v7 offset:4096
ds_read_b64_tr_b16 v[42:43],v7 offset:4608
s_waitcnt lgkmcnt(8)
v_mfma_f32_16x16x32_bf16 v[176:179],v[112:115],v[64:67],v[176:179]
ds_read_b64_tr_b16 v[44:45],v8 offset:4096
ds_read_b64_tr_b16 v[46:47],v8 offset:4608
v_mfma_f32_16x16x32_bf16 v[180:183],v[116:119],v[64:67],v[180:183]
s_waitcnt lgkmcnt(8)
v_mfma_f32_16x16x32_bf16 v[188:191],v[116:119],v[68:71],v[188:191]
v_mfma_f32_16x16x32_bf16 v[184:187],v[112:115],v[68:71],v[184:187]
ds_read_b64_tr_b16 v[64:65],v5 offset:8192
ds_read_b64_tr_b16 v[66:67],v5 offset:8704
s_setprio 1
s_waitcnt lgkmcnt(8)
v_mfma_f32_16x16x32_bf16 v[160:163],v[120:123],v[72:75],v[160:163]
ds_read_b64_tr_b16 v[68:69],v6 offset:8192
ds_read_b64_tr_b16 v[70:71],v6 offset:8704
v_mfma_f32_16x16x32_bf16 v[164:167],v[124:127],v[72:75],v[164:167]
s_waitcnt lgkmcnt(8)
v_mfma_f32_16x16x32_bf16 v[172:175],v[124:127],v[76:79],v[172:175]
v_mfma_f32_16x16x32_bf16 v[168:171],v[120:123],v[76:79],v[168:171]
ds_read_b64_tr_b16 v[72:73],v7 offset:8192
ds_read_b64_tr_b16 v[74:75],v7 offset:8704
s_waitcnt lgkmcnt(8)
v_mfma_f32_16x16x32_bf16 v[176:179],v[120:123],v[40:43],v[176:179]
ds_read_b64_tr_b16 v[76:77],v8 offset:8192
ds_read_b64_tr_b16 v[78:79],v8 offset:8704
v_mfma_f32_16x16x32_bf16 v[180:183],v[124:127],v[40:43],v[180:183]
s_waitcnt vmcnt(11)
ds_read_b128 v[96:99],v9 offset:0
ds_read_b128 v[100:103],v9 offset:1024
s_waitcnt lgkmcnt(10)
v_mfma_f32_16x16x32_bf16 v[188:191],v[124:127],v[44:47],v[188:191]
v_mfma_f32_16x16x32_bf16 v[184:187],v[120:123],v[44:47],v[184:187]
ds_read_b64_tr_b16 v[40:41],v5 offset:12288
ds_read_b64_tr_b16 v[42:43],v5 offset:12800
s_waitcnt lgkmcnt(10)
v_mfma_f32_16x16x32_bf16 v[192:195],v[112:115],v[64:67],v[192:195]
ds_read_b64_tr_b16 v[44:45],v6 offset:12288
ds_read_b64_tr_b16 v[46:47],v6 offset:12800
v_mfma_f32_16x16x32_bf16 v[196:199],v[116:119],v[64:67],v[196:199]
s_waitcnt lgkmcnt(10)
v_mfma_f32_16x16x32_bf16 v[204:207],v[116:119],v[68:71],v[204:207]
v_mfma_f32_16x16x32_bf16 v[200:203],v[112:115],v[68:71],v[200:203]
ds_read_b64_tr_b16 v[64:65],v7 offset:12288
ds_read_b64_tr_b16 v[66:67],v7 offset:12800
s_waitcnt lgkmcnt(10)
v_mfma_f32_16x16x32_bf16 v[208:211],v[112:115],v[72:75],v[208:211]
ds_read_b64_tr_b16 v[68:69],v8 offset:12288
ds_read_b64_tr_b16 v[70:71],v8 offset:12800
v_mfma_f32_16x16x32_bf16 v[212:215],v[116:119],v[72:75],v[212:215]
s_waitcnt lgkmcnt(10)
v_mfma_f32_16x16x32_bf16 v[220:223],v[116:119],v[76:79],v[220:223]
v_mfma_f32_16x16x32_bf16 v[216:219],v[112:115],v[76:79],v[216:219]
ds_read_b64_tr_b16 v[72:73],v5 offset:16384
ds_read_b64_tr_b16 v[74:75],v5 offset:16896
s_waitcnt lgkmcnt(8)
v_mfma_f32_16x16x32_bf16 v[192:195],v[120:123],v[40:43],v[192:195]
ds_read_b64_tr_b16 v[76:77],v6 offset:16384
ds_read_b64_tr_b16 v[78:79],v6 offset:16896
v_mfma_f32_16x16x32_bf16 v[196:199],v[124:127],v[40:43],v[196:199]
s_add_u32 m0,s58,0
s_add_u32 s53,s86,0
buffer_load_dwordx4 v3,s[32:35],s53 offen lds
s_waitcnt lgkmcnt(8)
v_mfma_f32_16x16x32_bf16 v[204:207],v[124:127],v[44:47],v[204:207]
v_mfma_f32_16x16x32_bf16 v[200:203],v[120:123],v[44:47],v[200:203]
s_add_u32 m0,s58,1024
s_add_u32 s53,s86,8192
buffer_load_dwordx4 v3,s[32:35],s53 offen lds
ds_read_b64_tr_b16 v[40:41],v7 offset:16384
ds_read_b64_tr_b16 v[42:43],v7 offset:16896
s_setprio 0
s_waitcnt lgkmcnt(8)
v_mfma_f32_16x16x32_bf16 v[208:211],v[120:123],v[64:67],v[208:211]
ds_read_b64_tr_b16 v[44:45],v8 offset:16384
ds_read_b64_tr_b16 v[46:47],v8 offset:16896
v_mfma_f32_16x16x32_bf16 v[212:215],v[124:127],v[64:67],v[212:215]
s_waitcnt lgkmcnt(8)
v_mfma_f32_16x16x32_bf16 v[220:223],v[124:127],v[68:71],v[220:223]
v_mfma_f32_16x16x32_bf16 v[216:219],v[120:123],v[68:71],v[216:219]
ds_read_b64_tr_b16 v[64:65],v5 offset:20480
ds_read_b64_tr_b16 v[66:67],v5 offset:20992
s_waitcnt lgkmcnt(8)
v_mfma_f32_16x16x32_bf16 v[224:227],v[112:115],v[72:75],v[224:227]
ds_read_b64_tr_b16 v[68:69],v6 offset:20480
ds_read_b64_tr_b16 v[70:71],v6 offset:20992
v_mfma_f32_16x16x32_bf16 v[228:231],v[116:119],v[72:75],v[228:231]
s_waitcnt lgkmcnt(8)
v_mfma_f32_16x16x32_bf16 v[236:239],v[116:119],v[76:79],v[236:239]
v_mfma_f32_16x16x32_bf16 v[232:235],v[112:115],v[76:79],v[232:235]
ds_read_b64_tr_b16 v[72:73],v7 offset:20480
ds_read_b64_tr_b16 v[74:75],v7 offset:20992
s_waitcnt lgkmcnt(8)
v_mfma_f32_16x16x32_bf16 v[240:243],v[112:115],v[40:43],v[240:243]
ds_read_b64_tr_b16 v[76:77],v8 offset:20480
ds_read_b64_tr_b16 v[78:79],v8 offset:20992
v_mfma_f32_16x16x32_bf16 v[244:247],v[116:119],v[40:43],v[244:247]
s_waitcnt lgkmcnt(8)
v_mfma_f32_16x16x32_bf16 v[252:255],v[116:119],v[44:47],v[252:255]
v_mfma_f32_16x16x32_bf16 v[248:251],v[112:115],v[44:47],v[248:251]
s_waitcnt vmcnt(11)
ds_read_b128 v[104:107],v9 offset:2048
ds_read_b128 v[108:111],v9 offset:3072
ds_read_b64_tr_b16 v[40:41],v5 offset:24576
ds_read_b64_tr_b16 v[42:43],v5 offset:25088
s_waitcnt lgkmcnt(10)
v_mfma_f32_16x16x32_bf16 v[224:227],v[120:123],v[64:67],v[224:227]
ds_read_b64_tr_b16 v[44:45],v6 offset:24576
ds_read_b64_tr_b16 v[46:47],v6 offset:25088
v_mfma_f32_16x16x32_bf16 v[228:231],v[124:127],v[64:67],v[228:231]
s_waitcnt lgkmcnt(10)
v_mfma_f32_16x16x32_bf16 v[236:239],v[124:127],v[68:71],v[236:239]
v_mfma_f32_16x16x32_bf16 v[232:235],v[120:123],v[68:71],v[232:235]
ds_read_b64_tr_b16 v[64:65],v7 offset:24576
ds_read_b64_tr_b16 v[66:67],v7 offset:25088
s_waitcnt lgkmcnt(10)
v_mfma_f32_16x16x32_bf16 v[240:243],v[120:123],v[72:75],v[240:243]
ds_read_b64_tr_b16 v[68:69],v8 offset:24576
ds_read_b64_tr_b16 v[70:71],v8 offset:25088
v_mfma_f32_16x16x32_bf16 v[244:247],v[124:127],v[72:75],v[244:247]
s_waitcnt lgkmcnt(10)
v_mfma_f32_16x16x32_bf16 v[252:255],v[124:127],v[76:79],v[252:255]
v_mfma_f32_16x16x32_bf16 v[248:251],v[120:123],v[76:79],v[248:251]
s_waitcnt vmcnt(5)
s_barrier
ds_read_b64_tr_b16 v[72:73],v5 offset:28672
ds_read_b64_tr_b16 v[74:75],v5 offset:29184
s_setprio 3
s_waitcnt lgkmcnt(8)
v_mfma_f32_16x16x32_bf16 v[128:131],v[80:83],v[40:43],v[128:131]
ds_read_b64_tr_b16 v[76:77],v6 offset:28672
ds_read_b64_tr_b16 v[78:79],v6 offset:29184
v_mfma_f32_16x16x32_bf16 v[132:135],v[84:87],v[40:43],v[132:135]
s_add_u32 m0,s60,147456
s_add_u32 s53,s77,0
buffer_load_dwordx4 v2,s[36:39],s53 offen lds
s_waitcnt lgkmcnt(8)
v_mfma_f32_16x16x32_bf16 v[140:143],v[84:87],v[44:47],v[140:143]
v_mfma_f32_16x16x32_bf16 v[136:139],v[80:83],v[44:47],v[136:139]
s_add_u32 m0,s58,2048
s_add_u32 s53,s86,64
buffer_load_dwordx4 v3,s[32:35],s53 offen lds
ds_read_b64_tr_b16 v[40:41],v7 offset:28672
ds_read_b64_tr_b16 v[42:43],v7 offset:29184
s_waitcnt lgkmcnt(8)
v_mfma_f32_16x16x32_bf16 v[144:147],v[80:83],v[64:67],v[144:147]
s_add_u32 m0,s58,3072
s_add_u32 s53,s86,8256
buffer_load_dwordx4 v3,s[32:35],s53 offen lds
ds_read_b64_tr_b16 v[44:45],v8 offset:28672
ds_read_b64_tr_b16 v[46:47],v8 offset:29184
v_mfma_f32_16x16x32_bf16 v[148:151],v[84:87],v[64:67],v[148:151]
s_cmp_lg_u32 s50,0
s_cbranch_scc1 L_tag5
s_cmp_lg_u32 s101,0
s_cbranch_scc1 L_tag5
buffer_load_dword v14,off,s[92:95],0 sc1
L_tag5:
s_waitcnt lgkmcnt(8)
v_mfma_f32_16x16x32_bf16 v[156:159],v[84:87],v[68:71],v[156:159]
v_mfma_f32_16x16x32_bf16 v[152:155],v[80:83],v[68:71],v[152:155]
s_add_u32 m0,s60,155648
s_add_u32 s53,s78,0
buffer_load_dwordx4 v2,s[36:39],s53 offen lds
ds_read_b64_tr_b16 v[64:65],v5 offset:32768
ds_read_b64_tr_b16 v[66:67],v5 offset:33280
s_waitcnt lgkmcnt(8)
v_mfma_f32_16x16x32_bf16 v[128:131],v[88:91],v[72:75],v[128:131]
ds_read_b64_tr_b16 v[68:69],v6 offset:32768
ds_read_b64_tr_b16 v[70:71],v6 offset:33280
v_mfma_f32_16x16x32_bf16 v[132:135],v[92:95],v[72:75],v[132:135]
s_waitcnt lgkmcnt(8)
v_mfma_f32_16x16x32_bf16 v[140:143],v[92:95],v[76:79],v[140:143]
v_mfma_f32_16x16x32_bf16 v[136:139],v[88:91],v[76:79],v[136:139]
ds_read_b64_tr_b16 v[72:73],v7 offset:32768
ds_read_b64_tr_b16 v[74:75],v7 offset:33280
s_waitcnt lgkmcnt(8)
v_mfma_f32_16x16x32_bf16 v[144:147],v[88:91],v[40:43],v[144:147]
ds_read_b64_tr_b16 v[76:77],v8 offset:32768
ds_read_b64_tr_b16 v[78:79],v8 offset:33280
v_mfma_f32_16x16x32_bf16 v[148:151],v[92:95],v[40:43],v[148:151]
s_add_u32 m0,s60,65536
s_add_u32 s53,s79,0
buffer_load_dwordx4 v2,s[36:39],s53 offen lds
s_waitcnt lgkmcnt(8)
v_mfma_f32_16x16x32_bf16 v[156:159],v[92:95],v[44:47],v[156:159]
v_mfma_f32_16x16x32_bf16 v[152:155],v[88:91],v[44:47],v[152:155]
ds_read_b64_tr_b16 v[40:41],v5 offset:36864
ds_read_b64_tr_b16 v[42:43],v5 offset:37376
s_waitcnt lgkmcnt(8)
v_mfma_f32_16x16x32_bf16 v[24:27],v[80:83],v[64:67],v[24:27]
ds_read_b64_tr_b16 v[44:45],v6 offset:36864
ds_read_b64_tr_b16 v[46:47],v6 offset:37376
v_mfma_f32_16x16x32_bf16 v[28:31],v[84:87],v[64:67],v[28:31]
ds_read_b128 v[112:115],v9 offset:4096
ds_read_b128 v[116:119],v9 offset:5120
s_waitcnt lgkmcnt(10)
v_mfma_f32_16x16x32_bf16 v[36:39],v[84:87],v[68:71],v[36:39]
v_mfma_f32_16x16x32_bf16 v[32:35],v[80:83],v[68:71],v[32:35]
s_add_u32 m0,s60,73728
s_add_u32 s53,s77,128
buffer_load_dwordx4 v2,s[36:39],s53 offen lds
ds_read_b64_tr_b16 v[64:65],v7 offset:36864
ds_read_b64_tr_b16 v[66:67],v7 offset:37376
s_setprio 2
s_waitcnt lgkmcnt(10)
v_mfma_f32_16x16x32_bf16 v[48:51],v[80:83],v[72:75],v[48:51]
ds_read_b64_tr_b16 v[68:69],v8 offset:36864
ds_read_b64_tr_b16 v[70:71],v8 offset:37376
v_mfma_f32_16x16x32_bf16 v[52:55],v[84:87],v[72:75],v[52:55]
s_waitcnt lgkmcnt(10)
v_mfma_f32_16x16x32_bf16 v[60:63],v[84:87],v[76:79],v[60:63]
v_mfma_f32_16x16x32_bf16 v[56:59],v[80:83],v[76:79],v[56:59]
ds_read_b64_tr_b16 v[72:73],v5 offset:40960
ds_read_b64_tr_b16 v[74:75],v5 offset:41472
s_waitcnt lgkmcnt(10)
v_mfma_f32_16x16x32_bf16 v[24:27],v[88:91],v[40:43],v[24:27]
ds_read_b64_tr_b16 v[76:77],v6 offset:40960
ds_read_b64_tr_b16 v[78:79],v6 offset:41472
v_mfma_f32_16x16x32_bf16 v[28:31],v[92:95],v[40:43],v[28:31]
s_add_u32 m0,s60,81920
s_add_u32 s53,s78,128
buffer_load_dwordx4 v2,s[36:39],s53 offen lds
s_waitcnt lgkmcnt(10)
v_mfma_f32_16x16x32_bf16 v[36:39],v[92:95],v[44:47],v[36:39]
v_mfma_f32_16x16x32_bf16 v[32:35],v[88:91],v[44:47],v[32:35]
ds_read_b64_tr_b16 v[40:41],v7 offset:40960
ds_read_b64_tr_b16 v[42:43],v7 offset:41472
s_waitcnt lgkmcnt(8)
v_mfma_f32_16x16x32_bf16 v[48:51],v[88:91],v[64:67],v[48:51]
ds_read_b64_tr_b16 v[44:45],v8 offset:40960
ds_read_b64_tr_b16 v[46:47],v8 offset:41472
v_mfma_f32_16x16x32_bf16 v[52:55],v[92:95],v[64:67],v[52:55]
s_add_u32 m0,s58,4096
s_add_u32 s53,s87,0
buffer_load_dwordx4 v3,s[32:35],s53 offen lds
s_waitcnt lgkmcnt(8)
v_mfma_f32_16x16x32_bf16 v[60:63],v[92:95],v[68:71],v[60:63]
v_mfma_f32_16x16x32_bf16 v[56:59],v[88:91],v[68:71],v[56:59]
s_add_u32 m0,s58,5120
s_add_u32 s53,s87,8192
buffer_load_dwordx4 v3,s[32:35],s53 offen lds
ds_read_b64_tr_b16 v[64:65],v5 offset:45056
ds_read_b64_tr_b16 v[66:67],v5 offset:45568
s_waitcnt lgkmcnt(8)
v_mfma_f32_16x16x32_bf16 v[160:163],v[80:83],v[72:75],v[160:163]
ds_read_b64_tr_b16 v[68:69],v6 offset:45056
ds_read_b64_tr_b16 v[70:71],v6 offset:45568
v_mfma_f32_16x16x32_bf16 v[164:167],v[84:87],v[72:75],v[164:167]
s_waitcnt lgkmcnt(8)
v_mfma_f32_16x16x32_bf16 v[172:175],v[84:87],v[76:79],v[172:175]
v_mfma_f32_16x16x32_bf16 v[168:171],v[80:83],v[76:79],v[168:171]
ds_read_b64_tr_b16 v[72:73],v7 offset:45056
ds_read_b64_tr_b16 v[74:75],v7 offset:45568
s_waitcnt lgkmcnt(8)
v_mfma_f32_16x16x32_bf16 v[176:179],v[80:83],v[40:43],v[176:179]
ds_read_b64_tr_b16 v[76:77],v8 offset:45056
ds_read_b64_tr_b16 v[78:79],v8 offset:45568
v_mfma_f32_16x16x32_bf16 v[180:183],v[84:87],v[40:43],v[180:183]
s_waitcnt lgkmcnt(8)
v_mfma_f32_16x16x32_bf16 v[188:191],v[84:87],v[44:47],v[188:191]
v_mfma_f32_16x16x32_bf16 v[184:187],v[80:83],v[44:47],v[184:187]
ds_read_b64_tr_b16 v[40:41],v5 offset:49152
ds_read_b64_tr_b16 v[42:43],v5 offset:49664
s_setprio 1
s_waitcnt lgkmcnt(8)
v_mfma_f32_16x16x32_bf16 v[160:163],v[88:91],v[64:67],v[160:163]
ds_read_b64_tr_b16 v[44:45],v6 offset:49152
ds_read_b64_tr_b16 v[46:47],v6 offset:49664
v_mfma_f32_16x16x32_bf16 v[164:167],v[92:95],v[64:67],v[164:167]
s_waitcnt lgkmcnt(8)
v_mfma_f32_16x16x32_bf16 v[172:175],v[92:95],v[68:71],v[172:175]
v_mfma_f32_16x16x32_bf16 v[168:171],v[88:91],v[68:71],v[168:171]
s_waitcnt vmcnt(11)
ds_read_b128 v[120:123],v9 offset:6144
ds_read_b128 v[124:127],v9 offset:7168
ds_read_b64_tr_b16 v[64:65],v7 offset:49152
ds_read_b64_tr_b16 v[66:67],v7 offset:49664
s_waitcnt lgkmcnt(10)
v_mfma_f32_16x16x32_bf16 v[176:179],v[88:91],v[72:75],v[176:179]
ds_read_b64_tr_b16 v[68:69],v8 offset:49152
ds_read_b64_tr_b16 v[70:71],v8 offset:49664
v_mfma_f32_16x16x32_bf16 v[180:183],v[92:95],v[72:75],v[180:183]
s_mov_b64 s[44:45],s[8:9]
s_mov_b32 s46,4194304
v_and_b32 v22,7,v1
v_lshlrev_b32 v22,13,v22
v_bfe_u32 v23,v1,3,1
v_lshl_add_u32 v22,v23,7,v22
s_waitcnt lgkmcnt(10)
v_mfma_f32_16x16x32_bf16 v[188:191],v[92:95],v[76:79],v[188:191]
v_mfma_f32_16x16x32_bf16 v[184:187],v[88:91],v[76:79],v[184:187]
s_and_b32 s88,s2,7
s_lshl_b32 s88,s88,2
s_bfe_u32 s89,s2,0x20003
s_add_u32 s88,s88,s89
s_lshl_b32 s88,s88,8
s_lshr_b32 s89,s2,5
s_lshl_b32 s89,s89,3
s_add_u32 s89,s89,s50
s_lshl_b32 s89,s89,16
s_add_u32 s88,s88,s89
buffer_load_dword v22,v22,s[44:47],s88 offen
ds_read_b64_tr_b16 v[72:73],v5 offset:53248
ds_read_b64_tr_b16 v[74:75],v5 offset:53760
s_waitcnt lgkmcnt(10)
v_mfma_f32_16x16x32_bf16 v[192:195],v[80:83],v[40:43],v[192:195]
ds_read_b64_tr_b16 v[76:77],v6 offset:53248
ds_read_b64_tr_b16 v[78:79],v6 offset:53760
v_mfma_f32_16x16x32_bf16 v[196:199],v[84:87],v[40:43],v[196:199]
s_waitcnt lgkmcnt(10)
v_mfma_f32_16x16x32_bf16 v[204:207],v[84:87],v[44:47],v[204:207]
v_mfma_f32_16x16x32_bf16 v[200:203],v[80:83],v[44:47],v[200:203]
ds_read_b64_tr_b16 v[40:41],v7 offset:53248
ds_read_b64_tr_b16 v[42:43],v7 offset:53760
s_waitcnt lgkmcnt(8)
v_mfma_f32_16x16x32_bf16 v[208:211],v[80:83],v[64:67],v[208:211]
ds_read_b64_tr_b16 v[44:45],v8 offset:53248
ds_read_b64_tr_b16 v[46:47],v8 offset:53760
v_mfma_f32_16x16x32_bf16 v[212:215],v[84:87],v[64:67],v[212:215]
s_waitcnt lgkmcnt(8)
v_mfma_f32_16x16x32_bf16 v[220:223],v[84:87],v[68:71],v[220:223]
v_mfma_f32_16x16x32_bf16 v[216:219],v[80:83],v[68:71],v[216:219]
s_add_u32 m0,s58,6144
s_add_u32 s53,s87,64
buffer_load_dwordx4 v3,s[32:35],s53 offen lds
ds_read_b64_tr_b16 v[64:65],v5 offset:57344
ds_read_b64_tr_b16 v[66:67],v5 offset:57856
s_waitcnt lgkmcnt(8)
v_mfma_f32_16x16x32_bf16 v[192:195],v[88:91],v[72:75],v[192:195]
ds_read_b64_tr_b16 v[68:69],v6 offset:57344
ds_read_b64_tr_b16 v[70:71],v6 offset:57856
v_mfma_f32_16x16x32_bf16 v[196:199],v[92:95],v[72:75],v[196:199]
s_add_u32 m0,s58,7168
s_add_u32 s53,s87,8256
buffer_load_dwordx4 v3,s[32:35],s53 offen lds
s_waitcnt lgkmcnt(8)
v_mfma_f32_16x16x32_bf16 v[204:207],v[92:95],v[76:79],v[204:207]
v_mfma_f32_16x16x32_bf16 v[200:203],v[88:91],v[76:79],v[200:203]
ds_read_b64_tr_b16 v[72:73],v7 offset:57344
ds_read_b64_tr_b16 v[74:75],v7 offset:57856
s_setprio 0
s_waitcnt lgkmcnt(8)
v_mfma_f32_16x16x32_bf16 v[208:211],v[88:91],v[40:43],v[208:211]
ds_read_b64_tr_b16 v[76:77],v8 offset:57344
ds_read_b64_tr_b16 v[78:79],v8 offset:57856
v_mfma_f32_16x16x32_bf16 v[212:215],v[92:95],v[40:43],v[212:215]
s_waitcnt lgkmcnt(8)
v_mfma_f32_16x16x32_bf16 v[220:223],v[92:95],v[44:47],v[220:223]
v_mfma_f32_16x16x32_bf16 v[216:219],v[88:91],v[44:47],v[216:219]
ds_read_b64_tr_b16 v[40:41],v5 offset:61440
ds_read_b64_tr_b16 v[42:43],v5 offset:61952
s_waitcnt lgkmcnt(8)
v_mfma_f32_16x16x32_bf16 v[224:227],v[80:83],v[64:67],v[224:227]
ds_read_b64_tr_b16 v[44:45],v6 offset:61440
ds_read_b64_tr_b16 v[46:47],v6 offset:61952
v_mfma_f32_16x16x32_bf16 v[228:231],v[84:87],v[64:67],v[228:231]
s_waitcnt lgkmcnt(8)
v_mfma_f32_16x16x32_bf16 v[236:239],v[84:87],v[68:71],v[236:239]
v_mfma_f32_16x16x32_bf16 v[232:235],v[80:83],v[68:71],v[232:235]
ds_read_b64_tr_b16 v[64:65],v7 offset:61440
ds_read_b64_tr_b16 v[66:67],v7 offset:61952
s_waitcnt lgkmcnt(8)
v_mfma_f32_16x16x32_bf16 v[240:243],v[80:83],v[72:75],v[240:243]
ds_read_b64_tr_b16 v[68:69],v8 offset:61440
ds_read_b64_tr_b16 v[70:71],v8 offset:61952
v_mfma_f32_16x16x32_bf16 v[244:247],v[84:87],v[72:75],v[244:247]
s_waitcnt lgkmcnt(8)
v_mfma_f32_16x16x32_bf16 v[252:255],v[84:87],v[76:79],v[252:255]
v_mfma_f32_16x16x32_bf16 v[248:251],v[80:83],v[76:79],v[248:251]
v_add_u32 v5,0x10000,v5
ds_read_b64_tr_b16 v[72:73],v5 offset:0
ds_read_b64_tr_b16 v[74:75],v5 offset:512
s_waitcnt lgkmcnt(8)
v_mfma_f32_16x16x32_bf16 v[224:227],v[88:91],v[40:43],v[224:227]
v_add_u32 v6,0x10000,v6
ds_read_b64_tr_b16 v[76:77],v6 offset:0
ds_read_b64_tr_b16 v[78:79],v6 offset:512
v_mfma_f32_16x16x32_bf16 v[228:231],v[92:95],v[40:43],v[228:231]
s_waitcnt lgkmcnt(8)
v_mfma_f32_16x16x32_bf16 v[236:239],v[92:95],v[44:47],v[236:239]
v_mfma_f32_16x16x32_bf16 v[232:235],v[88:91],v[44:47],v[232:235]
v_add_u32 v7,0x10000,v7
ds_read_b64_tr_b16 v[40:41],v7 offset:0
ds_read_b64_tr_b16 v[42:43],v7 offset:512
s_waitcnt lgkmcnt(8)
v_mfma_f32_16x16x32_bf16 v[240:243],v[88:91],v[64:67],v[240:243]
v_add_u32 v8,0x10000,v8
ds_read_b64_tr_b16 v[44:45],v8 offset:0
ds_read_b64_tr_b16 v[46:47],v8 offset:512
v_mfma_f32_16x16x32_bf16 v[244:247],v[92:95],v[64:67],v[244:247]
s_waitcnt lgkmcnt(8)
v_mfma_f32_16x16x32_bf16 v[252:255],v[92:95],v[68:71],v[252:255]
v_mfma_f32_16x16x32_bf16 v[248:251],v[88:91],v[68:71],v[248:251]
s_waitcnt vmcnt(6)
s_barrier
ds_read_b64_tr_b16 v[64:65],v5 offset:4096
ds_read_b64_tr_b16 v[66:67],v5 offset:4608
s_setprio 3
s_waitcnt lgkmcnt(8)
v_mfma_f32_16x16x32_bf16 v[128:131],v[96:99],v[72:75],v[128:131]
s_add_u32 m0,s60,90112
s_add_u32 s53,s79,128
buffer_load_dwordx4 v2,s[36:39],s53 offen lds
ds_read_b64_tr_b16 v[68:69],v6 offset:4096
ds_read_b64_tr_b16 v[70:71],v6 offset:4608
v_mfma_f32_16x16x32_bf16 v[132:135],v[100:103],v[72:75],v[132:135]
ds_read_b128 v[80:83],v9 offset:0
ds_read_b128 v[84:87],v9 offset:1024
s_waitcnt lgkmcnt(10)
v_mfma_f32_16x16x32_bf16 v[140:143],v[100:103],v[76:79],v[140:143]
v_mfma_f32_16x16x32_bf16 v[136:139],v[96:99],v[76:79],v[136:139]
ds_read_b64_tr_b16 v[72:73],v7 offset:4096
ds_read_b64_tr_b16 v[74:75],v7 offset:4608
s_waitcnt lgkmcnt(10)
v_mfma_f32_16x16x32_bf16 v[144:147],v[96:99],v[40:43],v[144:147]
ds_read_b64_tr_b16 v[76:77],v8 offset:4096
ds_read_b64_tr_b16 v[78:79],v8 offset:4608
v_mfma_f32_16x16x32_bf16 v[148:151],v[100:103],v[40:43],v[148:151]
s_cmp_lg_u32 s50,0
s_cbranch_scc1 L_tag6
s_cmp_lg_u32 s101,0
s_cbranch_scc1 L_tag6
s_waitcnt vmcnt(10)
v_readfirstlane_b32 s96,v14
s_cmp_lg_u32 s96,0
s_cbranch_scc1 L_tag6
s_call_b64 s[66:67],L_tag_slow
L_tag6:
s_waitcnt lgkmcnt(10)
v_mfma_f32_16x16x32_bf16 v[156:159],v[100:103],v[44:47],v[156:159]
v_mfma_f32_16x16x32_bf16 v[152:155],v[96:99],v[44:47],v[152:155]
s_add_u32 m0,s60,98304
s_add_u32 s53,s77,256
buffer_load_dwordx4 v2,s[36:39],s53 offen lds
ds_read_b64_tr_b16 v[40:41],v5 offset:8192
ds_read_b64_tr_b16 v[42:43],v5 offset:8704
s_waitcnt lgkmcnt(10)
v_mfma_f32_16x16x32_bf16 v[128:131],v[104:107],v[64:67],v[128:131]
ds_read_b64_tr_b16 v[44:45],v6 offset:8192
ds_read_b64_tr_b16 v[46:47],v6 offset:8704
v_mfma_f32_16x16x32_bf16 v[132:135],v[108:111],v[64:67],v[132:135]
s_waitcnt lgkmcnt(10)
v_mfma_f32_16x16x32_bf16 v[140:143],v[108:111],v[68:71],v[140:143]
v_mfma_f32_16x16x32_bf16 v[136:139],v[104:107],v[68:71],v[136:139]
ds_read_b64_tr_b16 v[64:65],v7 offset:8192
ds_read_b64_tr_b16 v[66:67],v7 offset:8704
s_waitcnt lgkmcnt(8)
v_mfma_f32_16x16x32_bf16 v[144:147],v[104:107],v[72:75],v[144:147]
s_add_u32 m0,s60,106496
s_add_u32 s53,s78,256
buffer_load_dwordx4 v2,s[36:39],s53 offen lds
ds_read_b64_tr_b16 v[68:69],v8 offset:8192
ds_read_b64_tr_b16 v[70:71],v8 offset:8704
v_mfma_f32_16x16x32_bf16 v[148:151],v[108:111],v[72:75],v[148:151]
s_add_u32 m0,s58,0
s_add_u32 s53,s84,0
buffer_load_dwordx4 v3,s[32:35],s53 offen lds
s_waitcnt lgkmcnt(8)
v_mfma_f32_16x16x32_bf16 v[156:159],v[108:111],v[76:79],v[156:159]
ds_read_b128 v[88:91],v9 offset:2048
ds_read_b128 v[92:95],v9 offset:3072
v_mfma_f32_16x16x32_bf16 v[152:155],v[104:107],v[76:79],v[152:155]
s_add_u32 m0,s58,1024
s_add_u32 s53,s84,8192
buffer_load_dwordx4 v3,s[32:35],s53 offen lds
ds_read_b64_tr_b16 v[72:73],v5 offset:12288
ds_read_b64_tr_b16 v[74:75],v5 offset:12800
s_waitcnt lgkmcnt(10)
v_mfma_f32_16x16x32_bf16 v[24:27],v[96:99],v[40:43],v[24:27]
ds_read_b64_tr_b16 v[76:77],v6 offset:12288
ds_read_b64_tr_b16 v[78:79],v6 offset:12800
v_mfma_f32_16x16x32_bf16 v[28:31],v[100:103],v[40:43],v[28:31]
s_waitcnt lgkmcnt(10)
v_mfma_f32_16x16x32_bf16 v[36:39],v[100:103],v[44:47],v[36:39]
v_mfma_f32_16x16x32_bf16 v[32:35],v[96:99],v[44:47],v[32:35]
s_add_u32 m0,s60,114688
s_add_u32 s53,s79,256
buffer_load_dwordx4 v2,s[36:39],s53 offen lds
ds_read_b64_tr_b16 v[40:41],v7 offset:12288
ds_read_b64_tr_b16 v[42:43],v7 offset:12800
s_setprio 2
s_waitcnt lgkmcnt(10)
v_mfma_f32_16x16x32_bf16 v[48:51],v[96:99],v[64:67],v[48:51]
ds_read_b64_tr_b16 v[44:45],v8 offset:12288
ds_read_b64_tr_b16 v[46:47],v8 offset:12800
v_mfma_f32_16x16x32_bf16 v[52:55],v[100:103],v[64:67],v[52:55]
s_waitcnt lgkmcnt(10)
v_mfma_f32_16x16x32_bf16 v[60:63],v[100:103],v[68:71],v[60:63]
v_mfma_f32_16x16x32_bf16 v[56:59],v[96:99],v[68:71],v[56:59]
ds_read_b64_tr_b16 v[64:65],v5 offset:16384
ds_read_b64_tr_b16 v[66:67],v5 offset:16896
s_waitcnt lgkmcnt(8)
v_mfma_f32_16x16x32_bf16 v[24:27],v[104:107],v[72:75],v[24:27]
ds_read_b64_tr_b16 v[68:69],v6 offset:16384
ds_read_b64_tr_b16 v[70:71],v6 offset:16896
v_mfma_f32_16x16x32_bf16 v[28:31],v[108:111],v[72:75],v[28:31]
s_add_u32 m0,s60,122880
s_add_u32 s53,s76,256
buffer_load_dwordx4 v2,s[36:39],s53 offen lds
s_waitcnt lgkmcnt(8)
v_mfma_f32_16x16x32_bf16 v[36:39],v[108:111],v[76:79],v[36:39]
v_mfma_f32_16x16x32_bf16 v[32:35],v[104:107],v[76:79],v[32:35]
s_add_u32 m0,s58,2048
s_add_u32 s53,s84,64
buffer_load_dwordx4 v3,s[32:35],s53 offen lds
ds_read_b64_tr_b16 v[72:73],v7 offset:16384
ds_read_b64_tr_b16 v[74:75],v7 offset:16896
s_waitcnt lgkmcnt(8)
v_mfma_f32_16x16x32_bf16 v[48:51],v[104:107],v[40:43],v[48:51]
ds_read_b64_tr_b16 v[76:77],v8 offset:16384
ds_read_b64_tr_b16 v[78:79],v8 offset:16896
v_mfma_f32_16x16x32_bf16 v[52:55],v[108:111],v[40:43],v[52:55]
s_add_u32 m0,s58,3072
s_add_u32 s53,s84,8256
buffer_load_dwordx4 v3,s[32:35],s53 offen lds
s_waitcnt lgkmcnt(8)
v_mfma_f32_16x16x32_bf16 v[60:63],v[108:111],v[44:47],v[60:63]
v_mfma_f32_16x16x32_bf16 v[56:59],v[104:107],v[44:47],v[56:59]
ds_read_b64_tr_b16 v[40:41],v5 offset:20480
ds_read_b64_tr_b16 v[42:43],v5 offset:20992
s_waitcnt lgkmcnt(8)
v_mfma_f32_16x16x32_bf16 v[128:131],v[112:115],v[64:67],v[128:131]
ds_read_b64_tr_b16 v[44:45],v6 offset:20480
ds_read_b64_tr_b16 v[46:47],v6 offset:20992
v_mfma_f32_16x16x32_bf16 v[132:135],v[116:119],v[64:67],v[132:135]
s_waitcnt lgkmcnt(8)
v_mfma_f32_16x16x32_bf16 v[140:143],v[116:119],v[68:71],v[140:143]
v_mfma_f32_16x16x32_bf16 v[136:139],v[112:115],v[68:71],v[136:139]
ds_read_b64_tr_b16 v[64:65],v7 offset:20480
ds_read_b64_tr_b16 v[66:67],v7 offset:20992
s_waitcnt lgkmcnt(8)
v_mfma_f32_16x16x32_bf16 v[144:147],v[112:115],v[72:75],v[144:147]
ds_read_b64_tr_b16 v[68:69],v8 offset:20480
ds_read_b64_tr_b16 v[70:71],v8 offset:20992
v_mfma_f32_16x16x32_bf16 v[148:151],v[116:119],v[72:75],v[148:151]
s_waitcnt lgkmcnt(8)
v_mfma_f32_16x16x32_bf16 v[156:159],v[116:119],v[76:79],v[156:159]
v_mfma_f32_16x16x32_bf16 v[152:155],v[112:115],v[76:79],v[152:155]
ds_read_b64_tr_b16 v[72:73],v5 offset:24576
ds_read_b64_tr_b16 v[74:75],v5 offset:25088
s_setprio 1
s_waitcnt lgkmcnt(8)
v_mfma_f32_16x16x32_bf16 v[128:131],v[120:123],v[40:43],v[128:131]
ds_read_b64_tr_b16 v[76:77],v6 offset:24576
ds_read_b64_tr_b16 v[78:79],v6 offset:25088
v_mfma_f32_16x16x32_bf16 v[132:135],v[124:127],v[40:43],v[132:135]
s_waitcnt vmcnt(12)
ds_read_b128 v[96:99],v9 offset:4096
ds_read_b128 v[100:103],v9 offset:5120
s_waitcnt lgkmcnt(10)
v_mfma_f32_16x16x32_bf16 v[140:143],v[124:127],v[44:47],v[140:143]
v_mfma_f32_16x16x32_bf16 v[136:139],v[120:123],v[44:47],v[136:139]
ds_read_b64_tr_b16 v[40:41],v7 offset:24576
ds_read_b64_tr_b16 v[42:43],v7 offset:25088
s_waitcnt lgkmcnt(10)
v_mfma_f32_16x16x32_bf16 v[144:147],v[120:123],v[64:67],v[144:147]
ds_read_b64_tr_b16 v[44:45],v8 offset:24576
ds_read_b64_tr_b16 v[46:47],v8 offset:25088
v_mfma_f32_16x16x32_bf16 v[148:151],v[124:127],v[64:67],v[148:151]
s_waitcnt lgkmcnt(10)
v_mfma_f32_16x16x32_bf16 v[156:159],v[124:127],v[68:71],v[156:159]
v_mfma_f32_16x16x32_bf16 v[152:155],v[120:123],v[68:71],v[152:155]
ds_read_b64_tr_b16 v[64:65],v5 offset:28672
ds_read_b64_tr_b16 v[66:67],v5 offset:29184
s_waitcnt lgkmcnt(10)
v_mfma_f32_16x16x32_bf16 v[128:131],v[80:83],v[72:75],v[128:131]
ds_read_b64_tr_b16 v[68:69],v6 offset:28672
ds_read_b64_tr_b16 v[70:71],v6 offset:29184
v_mfma_f32_16x16x32_bf16 v[132:135],v[84:87],v[72:75],v[132:135]
s_waitcnt lgkmcnt(10)
v_mfma_f32_16x16x32_bf16 v[140:143],v[84:87],v[76:79],v[140:143]
v_mfma_f32_16x16x32_bf16 v[136:139],v[80:83],v[76:79],v[136:139]
ds_read_b64_tr_b16 v[72:73],v7 offset:28672
ds_read_b64_tr_b16 v[74:75],v7 offset:29184
s_waitcnt lgkmcnt(8)
v_mfma_f32_16x16x32_bf16 v[144:147],v[80:83],v[40:43],v[144:147]
ds_read_b64_tr_b16 v[76:77],v8 offset:28672
ds_read_b64_tr_b16 v[78:79],v8 offset:29184
v_mfma_f32_16x16x32_bf16 v[148:151],v[84:87],v[40:43],v[148:151]
s_waitcnt lgkmcnt(8)
v_mfma_f32_16x16x32_bf16 v[156:159],v[84:87],v[44:47],v[156:159]
v_mfma_f32_16x16x32_bf16 v[152:155],v[80:83],v[44:47],v[152:155]
v_add_u32 v5,0xffff0000,v5
ds_read_b64_tr_b16 v[40:41],v5 offset:0
ds_read_b64_tr_b16 v[42:43],v5 offset:512
s_waitcnt lgkmcnt(8)
v_mfma_f32_16x16x32_bf16 v[128:131],v[88:91],v[64:67],v[128:131]
v_add_u32 v6,0xffff0000,v6
ds_read_b64_tr_b16 v[44:45],v6 offset:0
ds_read_b64_tr_b16 v[46:47],v6 offset:512
v_mfma_f32_16x16x32_bf16 v[132:135],v[92:95],v[64:67],v[132:135]
s_waitcnt lgkmcnt(8)
v_mfma_f32_16x16x32_bf16 v[140:143],v[92:95],v[68:71],v[140:143]
v_mfma_f32_16x16x32_bf16 v[136:139],v[88:91],v[68:71],v[136:139]
v_add_u32 v7,0xffff0000,v7
ds_read_b64_tr_b16 v[64:65],v7 offset:0
ds_read_b64_tr_b16 v[66:67],v7 offset:512
s_setprio 0
s_waitcnt lgkmcnt(8)
v_mfma_f32_16x16x32_bf16 v[144:147],v[88:91],v[72:75],v[144:147]
v_add_u32 v8,0xffff0000,v8
ds_read_b64_tr_b16 v[68:69],v8 offset:0
ds_read_b64_tr_b16 v[70:71],v8 offset:512
v_mfma_f32_16x16x32_bf16 v[148:151],v[92:95],v[72:75],v[148:151]
s_waitcnt lgkmcnt(8)
v_mfma_f32_16x16x32_bf16 v[156:159],v[92:95],v[76:79],v[156:159]
v_mfma_f32_16x16x32_bf16 v[152:155],v[88:91],v[76:79],v[152:155]
ds_read_b64_tr_b16 v[72:73],v5 offset:4096
ds_read_b64_tr_b16 v[74:75],v5 offset:4608
s_waitcnt lgkmcnt(8)
v_mfma_f32_16x16x32_bf16 v[128:131],v[96:99],v[40:43],v[128:131]
ds_read_b64_tr_b16 v[76:77],v6 offset:4096
ds_read_b64_tr_b16 v[78:79],v6 offset:4608
v_mfma_f32_16x16x32_bf16 v[132:135],v[100:103],v[40:43],v[132:135]
s_waitcnt lgkmcnt(8)
v_mfma_f32_16x16x32_bf16 v[140:143],v[100:103],v[44:47],v[140:143]
v_mfma_f32_16x16x32_bf16 v[136:139],v[96:99],v[44:47],v[136:139]
s_waitcnt vmcnt(9)
ds_read_b128 v[104:107],v9 offset:6144
ds_read_b128 v[108:111],v9 offset:7168
ds_read_b64_tr_b16 v[40:41],v7 offset:4096
ds_read_b64_tr_b16 v[42:43],v7 offset:4608
s_waitcnt lgkmcnt(10)
v_mfma_f32_16x16x32_bf16 v[144:147],v[96:99],v[64:67],v[144:147]
ds_read_b64_tr_b16 v[44:45],v8 offset:4096
ds_read_b64_tr_b16 v[46:47],v8 offset:4608
v_mfma_f32_16x16x32_bf16 v[148:151],v[100:103],v[64:67],v[148:151]
s_waitcnt lgkmcnt(10)
v_mfma_f32_16x16x32_bf16 v[156:159],v[100:103],v[68:71],v[156:159]
v_mfma_f32_16x16x32_bf16 v[152:155],v[96:99],v[68:71],v[152:155]
ds_read_b64_tr_b16 v[64:65],v5 offset:8192
ds_read_b64_tr_b16 v[66:67],v5 offset:8704
s_waitcnt lgkmcnt(7)
v_mfma_f32_16x16x32_bf16 v[128:131],v[104:107],v[72:75],v[128:131]
ds_read_b64_tr_b16 v[68:69],v6 offset:8192
ds_read_b64_tr_b16 v[70:71],v6 offset:8704
s_waitcnt lgkmcnt(8)
v_mfma_f32_16x16x32_bf16 v[132:135],v[108:111],v[72:75],v[132:135]
v_mfma_f32_16x16x32_bf16 v[140:143],v[108:111],v[76:79],v[140:143]
v_mfma_f32_16x16x32_bf16 v[136:139],v[104:107],v[76:79],v[136:139]
ds_read_b64_tr_b16 v[72:73],v7 offset:8192
ds_read_b64_tr_b16 v[74:75],v7 offset:8704
s_waitcnt lgkmcnt(8)
v_mfma_f32_16x16x32_bf16 v[144:147],v[104:107],v[40:43],v[144:147]
ds_read_b64_tr_b16 v[76:77],v8 offset:8192
ds_read_b64_tr_b16 v[78:79],v8 offset:8704
v_mfma_f32_16x16x32_bf16 v[148:151],v[108:111],v[40:43],v[148:151]
s_waitcnt lgkmcnt(8)
v_mfma_f32_16x16x32_bf16 v[156:159],v[108:111],v[44:47],v[156:159]
v_mfma_f32_16x16x32_bf16 v[152:155],v[104:107],v[44:47],v[152:155]
s_waitcnt vmcnt(7)
s_barrier
ds_read_b64_tr_b16 v[40:41],v5 offset:12288
ds_read_b64_tr_b16 v[42:43],v5 offset:12800
s_setprio 3
s_waitcnt lgkmcnt(8)
v_mfma_f32_16x16x32_bf16 v[24:27],v[112:115],v[64:67],v[24:27]
ds_read_b64_tr_b16 v[44:45],v6 offset:12288
ds_read_b64_tr_b16 v[46:47],v6 offset:12800
v_mfma_f32_16x16x32_bf16 v[28:31],v[116:119],v[64:67],v[28:31]
s_add_u32 m0,s60,131072
s_add_u32 s53,s77,384
buffer_load_dwordx4 v2,s[36:39],s53 offen lds
s_waitcnt lgkmcnt(8)
v_mfma_f32_16x16x32_bf16 v[36:39],v[116:119],v[68:71],v[36:39]
v_mfma_f32_16x16x32_bf16 v[32:35],v[112:115],v[68:71],v[32:35]
s_add_u32 m0,s60,139264
s_add_u32 s53,s78,384
buffer_load_dwordx4 v2,s[36:39],s53 offen lds
ds_read_b64_tr_b16 v[64:65],v7 offset:12288
ds_read_b64_tr_b16 v[66:67],v7 offset:12800
s_waitcnt lgkmcnt(8)
v_mfma_f32_16x16x32_bf16 v[48:51],v[112:115],v[72:75],v[48:51]
s_add_u32 s54,s51,0
ds_read_b64_tr_b16 v[68:69],v8 offset:12288
ds_read_b64_tr_b16 v[70:71],v8 offset:12800
v_mfma_f32_16x16x32_bf16 v[52:55],v[116:119],v[72:75],v[52:55]
s_lshr_b32 s57,s54,1
s_waitcnt lgkmcnt(8)
v_mfma_f32_16x16x32_bf16 v[60:63],v[116:119],v[76:79],v[60:63]
s_add_u32 m0,s60,147456
s_add_u32 s53,s79,384
buffer_load_dwordx4 v2,s[36:39],s53 offen lds
v_mfma_f32_16x16x32_bf16 v[56:59],v[112:115],v[76:79],v[56:59]
s_lshl_b32 s57,s57,20
ds_read_b64_tr_b16 v[72:73],v5 offset:16384
ds_read_b64_tr_b16 v[74:75],v5 offset:16896
s_waitcnt lgkmcnt(8)
v_mfma_f32_16x16x32_bf16 v[24:27],v[120:123],v[40:43],v[24:27]
s_and_b32 s54,s54,1
ds_read_b64_tr_b16 v[76:77],v6 offset:16384
ds_read_b64_tr_b16 v[78:79],v6 offset:16896
v_mfma_f32_16x16x32_bf16 v[28:31],v[124:127],v[40:43],v[28:31]
s_lshl_b32 s54,s54,12
s_waitcnt lgkmcnt(8)
v_mfma_f32_16x16x32_bf16 v[36:39],v[124:127],v[44:47],v[36:39]
s_add_u32 m0,s60,155648
s_add_u32 s53,s76,384
buffer_load_dwordx4 v2,s[36:39],s53 offen lds
v_mfma_f32_16x16x32_bf16 v[32:35],v[120:123],v[44:47],v[32:35]
s_add_u32 s57,s57,s54
ds_read_b64_tr_b16 v[40:41],v7 offset:16384
ds_read_b64_tr_b16 v[42:43],v7 offset:16896
s_setprio 2
s_waitcnt lgkmcnt(8)
v_mfma_f32_16x16x32_bf16 v[48:51],v[120:123],v[64:67],v[48:51]
ds_read_b64_tr_b16 v[44:45],v8 offset:16384
ds_read_b64_tr_b16 v[46:47],v8 offset:16896
v_mfma_f32_16x16x32_bf16 v[52:55],v[124:127],v[64:67],v[52:55]
s_add_u32 s57,s57,16384
s_waitcnt lgkmcnt(8)
v_mfma_f32_16x16x32_bf16 v[60:63],v[124:127],v[68:71],v[60:63]
s_add_u32 m0,s60,65536
s_add_u32 s53,s77,512
buffer_load_dwordx4 v2,s[36:39],s53 offen lds
v_mfma_f32_16x16x32_bf16 v[56:59],v[120:123],v[68:71],v[56:59]
v_cvt_pk_bf16_f32 v128,v128,v129
v_cvt_pk_bf16_f32 v129,v130,v131
ds_read_b64_tr_b16 v[64:65],v5 offset:20480
ds_read_b64_tr_b16 v[66:67],v5 offset:20992
s_waitcnt lgkmcnt(8)
v_mfma_f32_16x16x32_bf16 v[24:27],v[80:83],v[72:75],v[24:27]
ds_read_b64_tr_b16 v[68:69],v6 offset:20480
ds_read_b64_tr_b16 v[70:71],v6 offset:20992
v_mfma_f32_16x16x32_bf16 v[28:31],v[84:87],v[72:75],v[28:31]
v_cvt_pk_bf16_f32 v130,v132,v133
s_waitcnt lgkmcnt(8)
v_mfma_f32_16x16x32_bf16 v[36:39],v[84:87],v[76:79],v[36:39]
v_mfma_f32_16x16x32_bf16 v[32:35],v[80:83],v[76:79],v[32:35]
v_cvt_pk_bf16_f32 v131,v134,v135
ds_read_b64_tr_b16 v[72:73],v7 offset:20480
ds_read_b64_tr_b16 v[74:75],v7 offset:20992
s_waitcnt lgkmcnt(8)
v_mfma_f32_16x16x32_bf16 v[48:51],v[80:83],v[40:43],v[48:51]
buffer_store_dwordx4 v[128:131],v4,s[40:43],s57 offen offset:0 sc1
ds_read_b64_tr_b16 v[76:77],v8 offset:20480
ds_read_b64_tr_b16 v[78:79],v8 offset:20992
v_mfma_f32_16x16x32_bf16 v[52:55],v[84:87],v[40:43],v[52:55]
v_cvt_pk_bf16_f32 v132,v136,v137
s_waitcnt lgkmcnt(8)
v_mfma_f32_16x16x32_bf16 v[60:63],v[84:87],v[44:47],v[60:63]
v_mfma_f32_16x16x32_bf16 v[56:59],v[80:83],v[44:47],v[56:59]
v_cvt_pk_bf16_f32 v133,v138,v139
ds_read_b64_tr_b16 v[40:41],v5 offset:24576
ds_read_b64_tr_b16 v[42:43],v5 offset:25088
s_setprio 1
s_waitcnt lgkmcnt(8)
v_mfma_f32_16x16x32_bf16 v[24:27],v[88:91],v[64:67],v[24:27]
ds_read_b64_tr_b16 v[44:45],v6 offset:24576
ds_read_b64_tr_b16 v[46:47],v6 offset:25088
v_mfma_f32_16x16x32_bf16 v[28:31],v[92:95],v[64:67],v[28:31]
v_cvt_pk_bf16_f32 v134,v140,v141
s_waitcnt lgkmcnt(8)
v_mfma_f32_16x16x32_bf16 v[36:39],v[92:95],v[68:71],v[36:39]
v_cvt_pk_bf16_f32 v135,v142,v143
v_mfma_f32_16x16x32_bf16 v[32:35],v[88:91],v[68:71],v[32:35]
buffer_store_dwordx4 v[132:135],v4,s[40:43],s57 offen offset:128 sc1
ds_read_b64_tr_b16 v[64:65],v7 offset:24576
ds_read_b64_tr_b16 v[66:67],v7 offset:25088
s_waitcnt lgkmcnt(8)
v_mfma_f32_16x16x32_bf16 v[48:51],v[88:91],v[72:75],v[48:51]
ds_read_b64_tr_b16 v[68:69],v8 offset:24576
ds_read_b64_tr_b16 v[70:71],v8 offset:25088
v_mfma_f32_16x16x32_bf16 v[52:55],v[92:95],v[72:75],v[52:55]
v_cvt_pk_bf16_f32 v144,v144,v145
s_waitcnt lgkmcnt(8)
v_mfma_f32_16x16x32_bf16 v[60:63],v[92:95],v[76:79],v[60:63]
v_mfma_f32_16x16x32_bf16 v[56:59],v[88:91],v[76:79],v[56:59]
v_cvt_pk_bf16_f32 v145,v146,v147
ds_read_b64_tr_b16 v[72:73],v5 offset:28672
ds_read_b64_tr_b16 v[74:75],v5 offset:29184
s_waitcnt lgkmcnt(8)
v_mfma_f32_16x16x32_bf16 v[24:27],v[96:99],v[40:43],v[24:27]
v_cvt_pk_bf16_f32 v146,v148,v149
ds_read_b64_tr_b16 v[76:77],v6 offset:28672
ds_read_b64_tr_b16 v[78:79],v6 offset:29184
v_mfma_f32_16x16x32_bf16 v[28:31],v[100:103],v[40:43],v[28:31]
v_cvt_pk_bf16_f32 v147,v150,v151
s_waitcnt lgkmcnt(8)
v_mfma_f32_16x16x32_bf16 v[36:39],v[100:103],v[44:47],v[36:39]
v_mfma_f32_16x16x32_bf16 v[32:35],v[96:99],v[44:47],v[32:35]
buffer_store_dwordx4 v[144:147],v4,s[40:43],s57 offen offset:2048 sc1
ds_read_b64_tr_b16 v[40:41],v7 offset:28672
ds_read_b64_tr_b16 v[42:43],v7 offset:29184
s_setprio 0
s_waitcnt lgkmcnt(8)
v_mfma_f32_16x16x32_bf16 v[48:51],v[96:99],v[64:67],v[48:51]
ds_read_b64_tr_b16 v[44:45],v8 offset:28672
ds_read_b64_tr_b16 v[46:47],v8 offset:29184
v_mfma_f32_16x16x32_bf16 v[52:55],v[100:103],v[64:67],v[52:55]
v_cvt_pk_bf16_f32 v148,v152,v153
s_waitcnt lgkmcnt(8)
v_mfma_f32_16x16x32_bf16 v[60:63],v[100:103],v[68:71],v[60:63]
v_cvt_pk_bf16_f32 v149,v154,v155
v_mfma_f32_16x16x32_bf16 v[56:59],v[96:99],v[68:71],v[56:59]
v_cvt_pk_bf16_f32 v150,v156,v157
ds_read_b64_tr_b16 v[64:65],v5 offset:32768
ds_read_b64_tr_b16 v[66:67],v5 offset:33280
s_waitcnt lgkmcnt(8)
v_mfma_f32_16x16x32_bf16 v[24:27],v[104:107],v[72:75],v[24:27]
ds_read_b64_tr_b16 v[68:69],v6 offset:32768
ds_read_b64_tr_b16 v[70:71],v6 offset:33280
v_mfma_f32_16x16x32_bf16 v[28:31],v[108:111],v[72:75],v[28:31]
v_cvt_pk_bf16_f32 v151,v158,v159
s_waitcnt lgkmcnt(8)
v_mfma_f32_16x16x32_bf16 v[36:39],v[108:111],v[76:79],v[36:39]
v_mfma_f32_16x16x32_bf16 v[32:35],v[104:107],v[76:79],v[32:35]
buffer_store_dwordx4 v[148:151],v4,s[40:43],s57 offen offset:2176 sc1
ds_read_b64_tr_b16 v[72:73],v7 offset:32768
ds_read_b64_tr_b16 v[74:75],v7 offset:33280
s_waitcnt lgkmcnt(8)
v_mfma_f32_16x16x32_bf16 v[48:51],v[104:107],v[40:43],v[48:51]
ds_read_b64_tr_b16 v[76:77],v8 offset:32768
ds_read_b64_tr_b16 v[78:79],v8 offset:33280
v_mfma_f32_16x16x32_bf16 v[52:55],v[108:111],v[40:43],v[52:55]
s_waitcnt lgkmcnt(8)
v_mfma_f32_16x16x32_bf16 v[60:63],v[108:111],v[44:47],v[60:63]
v_mfma_f32_16x16x32_bf16 v[56:59],v[104:107],v[44:47],v[56:59]
s_waitcnt vmcnt(8)
s_barrier
ds_read_b64_tr_b16 v[40:41],v5 offset:36864
ds_read_b64_tr_b16 v[42:43],v5 offset:37376
s_setprio 3
s_waitcnt lgkmcnt(8)
v_mfma_f32_16x16x32_bf16 v[160:163],v[112:115],v[64:67],v[160:163]
ds_read_b64_tr_b16 v[44:45],v6 offset:36864
ds_read_b64_tr_b16 v[46:47],v6 offset:37376
v_mfma_f32_16x16x32_bf16 v[164:167],v[116:119],v[64:67],v[164:167]
s_add_u32 m0,s60,73728
s_add_u32 s53,s78,512
buffer_load_dwordx4 v2,s[36:39],s53 offen lds
s_waitcnt lgkmcnt(8)
v_mfma_f32_16x16x32_bf16 v[172:175],v[116:119],v[68:71],v[172:175]
v_mfma_f32_16x16x32_bf16 v[168:171],v[112:115],v[68:71],v[168:171]
s_add_u32 m0,s60,81920
s_add_u32 s53,s79,512
buffer_load_dwordx4 v2,s[36:39],s53 offen lds
ds_read_b64_tr_b16 v[64:65],v7 offset:36864
ds_read_b64_tr_b16 v[66:67],v7 offset:37376
s_waitcnt lgkmcnt(8)
v_mfma_f32_16x16x32_bf16 v[176:179],v[112:115],v[72:75],v[176:179]
ds_read_b64_tr_b16 v[68:69],v8 offset:36864
ds_read_b64_tr_b16 v[70:71],v8 offset:37376
v_mfma_f32_16x16x32_bf16 v[180:183],v[116:119],v[72:75],v[180:183]
s_add_u32 s54,s51,1
s_waitcnt lgkmcnt(8)
v_mfma_f32_16x16x32_bf16 v[188:191],v[116:119],v[76:79],v[188:191]
s_add_u32 m0,s60,90112
s_add_u32 s53,s76,512
buffer_load_dwordx4 v2,s[36:39],s53 offen lds
v_mfma_f32_16x16x32_bf16 v[184:187],v[112:115],v[76:79],v[184:187]
s_lshr_b32 s57,s54,1
ds_read_b64_tr_b16 v[72:73],v5 offset:40960
ds_read_b64_tr_b16 v[74:75],v5 offset:41472
s_waitcnt lgkmcnt(8)
v_mfma_f32_16x16x32_bf16 v[160:163],v[120:123],v[40:43],v[160:163]
ds_read_b128 v[128:131],v9 offset:0
ds_read_b128 v[132:135],v9 offset:1024
ds_read_b64_tr_b16 v[76:77],v6 offset:40960
ds_read_b64_tr_b16 v[78:79],v6 offset:41472
v_mfma_f32_16x16x32_bf16 v[164:167],v[124:127],v[40:43],v[164:167]
v_mov_b32 v14,s96
v_min_u32 v23,47,v1
v_lshlrev_b32 v23,2,v23
s_and_b32 s88,s2,7
s_lshl_b32 s88,s88,8
s_add_u32 s88,s88,101787648
v_add_u32 v23,s88,v23
s_mov_b32 s7,0
s_cmp_lg_u32 s50,0
s_cbranch_scc1 L_xfp7
s_cmp_lg_u32 s3,s2
s_cbranch_scc1 L_xfp7
buffer_load_dword v14,v23,s[40:43],0 offen sc1
L_xfp7:
s_lshl_b32 s57,s57,20
s_waitcnt lgkmcnt(10)
v_mfma_f32_16x16x32_bf16 v[172:175],v[124:127],v[44:47],v[172:175]
s_mov_b64 s[76:77],s[8:9]
v_mfma_f32_16x16x32_bf16 v[168:171],v[120:123],v[44:47],v[168:171]
s_mov_b32 s78,4194304
s_and_b32 s54,s54,1
ds_read_b64_tr_b16 v[40:41],v7 offset:40960
ds_read_b64_tr_b16 v[42:43],v7 offset:41472
s_waitcnt lgkmcnt(10)
v_mfma_f32_16x16x32_bf16 v[176:179],v[120:123],v[64:67],v[176:179]
s_mov_b32 s79,0x20000
ds_read_b64_tr_b16 v[44:45],v8 offset:40960
ds_read_b64_tr_b16 v[46:47],v8 offset:41472
v_mfma_f32_16x16x32_bf16 v[180:183],v[124:127],v[64:67],v[180:183]
s_mov_b64 s[8:9],s[40:41]
s_lshl_b32 s54,s54,12
s_waitcnt lgkmcnt(10)
v_mfma_f32_16x16x32_bf16 v[188:191],v[124:127],v[68:71],v[188:191]
s_mov_b32 s10,268435456
v_mfma_f32_16x16x32_bf16 v[184:187],v[120:123],v[68:71],v[184:187]
s_mov_b32 s11,0x20000
s_add_u32 s57,s57,s54
ds_read_b64_tr_b16 v[64:65],v5 offset:45056
ds_read_b64_tr_b16 v[66:67],v5 offset:45568
s_setprio 2
s_waitcnt lgkmcnt(10)
v_mfma_f32_16x16x32_bf16 v[160:163],v[80:83],v[72:75],v[160:163]
s_mov_b64 s[12:13],s[14:15]
ds_read_b64_tr_b16 v[68:69],v6 offset:45056
ds_read_b64_tr_b16 v[70:71],v6 offset:45568
v_mfma_f32_16x16x32_bf16 v[164:167],v[84:87],v[72:75],v[164:167]
s_mov_b32 s14,4194304
s_add_u32 s57,s57,16384
s_waitcnt lgkmcnt(8)
v_mfma_f32_16x16x32_bf16 v[172:175],v[84:87],v[76:79],v[172:175]
s_mov_b32 s15,0x20000
v_mfma_f32_16x16x32_bf16 v[168:171],v[80:83],v[76:79],v[168:171]
s_mov_b32 s37,s18
v_cvt_pk_bf16_f32 v24,v24,v25
ds_read_b64_tr_b16 v[72:73],v7 offset:45056
ds_read_b64_tr_b16 v[74:75],v7 offset:45568
s_waitcnt lgkmcnt(8)
v_mfma_f32_16x16x32_bf16 v[176:179],v[80:83],v[40:43],v[176:179]
s_lshl_b32 s39,s16,11
ds_read_b64_tr_b16 v[76:77],v8 offset:45056
ds_read_b64_tr_b16 v[78:79],v8 offset:45568
v_mfma_f32_16x16x32_bf16 v[180:183],v[84:87],v[40:43],v[180:183]
s_lshl_b32 s29,s16,16
v_cvt_pk_bf16_f32 v25,v26,v27
s_waitcnt lgkmcnt(8)
v_mfma_f32_16x16x32_bf16 v[188:191],v[84:87],v[44:47],v[188:191]
s_lshl_b32 s26,s17,8
v_mfma_f32_16x16x32_bf16 v[184:187],v[80:83],v[44:47],v[184:187]
v_cvt_pk_bf16_f32 v26,v28,v29
ds_read_b64_tr_b16 v[40:41],v5 offset:49152
ds_read_b64_tr_b16 v[42:43],v5 offset:49664
s_waitcnt lgkmcnt(8)
v_mfma_f32_16x16x32_bf16 v[160:163],v[88:91],v[64:67],v[160:163]
ds_read_b128 v[136:139],v9 offset:2048
ds_read_b128 v[140:143],v9 offset:3072
s_add_u32 s29,s29,s26
ds_read_b64_tr_b16 v[44:45],v6 offset:49152
ds_read_b64_tr_b16 v[46:47],v6 offset:49664
v_mfma_f32_16x16x32_bf16 v[164:167],v[92:95],v[64:67],v[164:167]
s_lshl_b32 s24,s19,15
v_cvt_pk_bf16_f32 v27,v30,v31
s_waitcnt lgkmcnt(10)
v_mfma_f32_16x16x32_bf16 v[172:175],v[92:95],v[68:71],v[172:175]
s_add_u32 s24,s24,41943040
v_mfma_f32_16x16x32_bf16 v[168:171],v[88:91],v[68:71],v[168:171]
v_lshrrev_b32 v20,4,v1
buffer_store_dwordx4 v[24:27],v4,s[40:43],s57 offen offset:0 sc1
ds_read_b64_tr_b16 v[64:65],v7 offset:49152
ds_read_b64_tr_b16 v[66:67],v7 offset:49664
s_waitcnt lgkmcnt(10)
v_mfma_f32_16x16x32_bf16 v[176:179],v[88:91],v[72:75],v[176:179]
v_lshlrev_b32 v21,2,v20
ds_read_b64_tr_b16 v[68:69],v8 offset:49152
ds_read_b64_tr_b16 v[70:71],v8 offset:49664
v_mfma_f32_16x16x32_bf16 v[180:183],v[92:95],v[72:75],v[180:183]
v_and_b32 v10,15,v1
v_cvt_pk_bf16_f32 v28,v32,v33
s_waitcnt lgkmcnt(10)
v_mfma_f32_16x16x32_bf16 v[188:191],v[92:95],v[76:79],v[188:191]
v_xor_b32 v10,v10,v21
v_mfma_f32_16x16x32_bf16 v[184:187],v[88:91],v[76:79],v[184:187]
s_and_b32 s26,s16,1
v_cvt_pk_bf16_f32 v29,v34,v35
ds_read_b64_tr_b16 v[72:73],v5 offset:53248
ds_read_b64_tr_b16 v[74:75],v5 offset:53760
s_setprio 1
s_waitcnt lgkmcnt(10)
v_mfma_f32_16x16x32_bf16 v[160:163],v[96:99],v[40:43],v[160:163]
s_lshl_b32 s26,s26,1
ds_read_b64_tr_b16 v[76:77],v6 offset:53248
ds_read_b64_tr_b16 v[78:79],v6 offset:53760
v_mfma_f32_16x16x32_bf16 v[164:167],v[100:103],v[40:43],v[164:167]
v_xor_b32 v10,s26,v10
v_cvt_pk_bf16_f32 v30,v36,v37
s_waitcnt lgkmcnt(8)
v_mfma_f32_16x16x32_bf16 v[172:175],v[100:103],v[44:47],v[172:175]
v_lshlrev_b32 v10,4,v10
v_mfma_f32_16x16x32_bf16 v[168:171],v[96:99],v[44:47],v[168:171]
v_lshl_add_u32 v10,v20,13,v10
v_cvt_pk_bf16_f32 v31,v38,v39
ds_read_b64_tr_b16 v[40:41],v7 offset:53248
ds_read_b64_tr_b16 v[42:43],v7 offset:53760
s_waitcnt lgkmcnt(8)
v_mfma_f32_16x16x32_bf16 v[176:179],v[96:99],v[64:67],v[176:179]
v_lshlrev_b32 v2,4,v1
ds_read_b64_tr_b16 v[44:45],v8 offset:53248
ds_read_b64_tr_b16 v[46:47],v8 offset:53760
v_mfma_f32_16x16x32_bf16 v[180:183],v[100:103],v[64:67],v[180:183]
buffer_store_dwordx4 v[28:31],v4,s[40:43],s57 offen offset:128 sc1
s_waitcnt lgkmcnt(8)
v_mfma_f32_16x16x32_bf16 v[188:191],v[100:103],v[68:71],v[188:191]
s_add_u32 s26,s37,0
v_mfma_f32_16x16x32_bf16 v[184:187],v[96:99],v[68:71],v[184:187]
s_and_b32 s26,s26,7
v_cvt_pk_bf16_f32 v48,v48,v49
ds_read_b64_tr_b16 v[64:65],v5 offset:57344
ds_read_b64_tr_b16 v[66:67],v5 offset:57856
s_waitcnt lgkmcnt(8)
v_mfma_f32_16x16x32_bf16 v[160:163],v[104:107],v[72:75],v[160:163]
s_lshl_b32 s80,s26,19
ds_read_b64_tr_b16 v[68:69],v6 offset:57344
ds_read_b64_tr_b16 v[70:71],v6 offset:57856
v_mfma_f32_16x16x32_bf16 v[164:167],v[108:111],v[72:75],v[164:167]
s_add_u32 s80,s80,s29
v_cvt_pk_bf16_f32 v49,v50,v51
s_waitcnt lgkmcnt(8)
v_mfma_f32_16x16x32_bf16 v[172:175],v[108:111],v[76:79],v[172:175]
s_lshl_b32 s26,s26,12
v_mfma_f32_16x16x32_bf16 v[168:171],v[104:107],v[76:79],v[168:171]
s_add_u32 s88,s26,s24
v_cvt_pk_bf16_f32 v50,v52,v53
ds_read_b64_tr_b16 v[72:73],v7 offset:57344
ds_read_b64_tr_b16 v[74:75],v7 offset:57856
s_waitcnt lgkmcnt(8)
v_mfma_f32_16x16x32_bf16 v[176:179],v[104:107],v[40:43],v[176:179]
s_add_u32 s26,s37,1
ds_read_b64_tr_b16 v[76:77],v8 offset:57344
ds_read_b64_tr_b16 v[78:79],v8 offset:57856
v_mfma_f32_16x16x32_bf16 v[180:183],v[108:111],v[40:43],v[180:183]
s_and_b32 s26,s26,7
v_cvt_pk_bf16_f32 v51,v54,v55
s_waitcnt lgkmcnt(8)
v_mfma_f32_16x16x32_bf16 v[188:191],v[108:111],v[44:47],v[188:191]
s_lshl_b32 s81,s26,19
v_mfma_f32_16x16x32_bf16 v[184:187],v[104:107],v[44:47],v[184:187]
s_add_u32 s81,s81,s29
buffer_store_dwordx4 v[48:51],v4,s[40:43],s57 offen offset:2048 sc1
ds_read_b64_tr_b16 v[40:41],v5 offset:61440
ds_read_b64_tr_b16 v[42:43],v5 offset:61952
s_setprio 0
s_waitcnt lgkmcnt(8)
v_mfma_f32_16x16x32_bf16 v[160:163],v[128:131],v[64:67],v[160:163]
s_lshl_b32 s26,s26,12
ds_read_b64_tr_b16 v[44:45],v6 offset:61440
ds_read_b64_tr_b16 v[46:47],v6 offset:61952
v_mfma_f32_16x16x32_bf16 v[164:167],v[132:135],v[64:67],v[164:167]
s_add_u32 s89,s26,s24
v_cvt_pk_bf16_f32 v52,v56,v57
s_waitcnt lgkmcnt(8)
v_mfma_f32_16x16x32_bf16 v[172:175],v[132:135],v[68:71],v[172:175]
s_add_u32 s26,s37,2
v_mfma_f32_16x16x32_bf16 v[168:171],v[128:131],v[68:71],v[168:171]
v_cvt_pk_bf16_f32 v53,v58,v59
ds_read_b64_tr_b16 v[64:65],v7 offset:61440
ds_read_b64_tr_b16 v[66:67],v7 offset:61952
s_waitcnt lgkmcnt(8)
v_mfma_f32_16x16x32_bf16 v[176:179],v[128:131],v[72:75],v[176:179]
s_and_b32 s26,s26,7
ds_read_b64_tr_b16 v[68:69],v8 offset:61440
ds_read_b64_tr_b16 v[70:71],v8 offset:61952
v_mfma_f32_16x16x32_bf16 v[180:183],v[132:135],v[72:75],v[180:183]
s_lshl_b32 s82,s26,19
v_cvt_pk_bf16_f32 v54,v60,v61
s_waitcnt lgkmcnt(8)
v_mfma_f32_16x16x32_bf16 v[188:191],v[132:135],v[76:79],v[188:191]
s_add_u32 s82,s82,s29
v_mfma_f32_16x16x32_bf16 v[184:187],v[128:131],v[76:79],v[184:187]
s_lshl_b32 s26,s26,12
v_cvt_pk_bf16_f32 v55,v62,v63
v_add_u32 v5,0x10000,v5
ds_read_b64_tr_b16 v[72:73],v5 offset:0
ds_read_b64_tr_b16 v[74:75],v5 offset:512
s_waitcnt lgkmcnt(8)
v_mfma_f32_16x16x32_bf16 v[160:163],v[136:139],v[40:43],v[160:163]
s_add_u32 s90,s26,s24
v_add_u32 v6,0x10000,v6
ds_read_b64_tr_b16 v[76:77],v6 offset:0
ds_read_b64_tr_b16 v[78:79],v6 offset:512
v_mfma_f32_16x16x32_bf16 v[164:167],v[140:143],v[40:43],v[164:167]
s_add_u32 s26,s37,3
buffer_store_dwordx4 v[52:55],v4,s[40:43],s57 offen offset:2176 sc1
s_waitcnt lgkmcnt(8)
v_mfma_f32_16x16x32_bf16 v[172:175],v[140:143],v[44:47],v[172:175]
s_and_b32 s26,s26,7
v_mfma_f32_16x16x32_bf16 v[168:171],v[136:139],v[44:47],v[168:171]
s_lshl_b32 s83,s26,19
v_add_u32 v7,0x10000,v7
ds_read_b64_tr_b16 v[40:41],v7 offset:0
ds_read_b64_tr_b16 v[42:43],v7 offset:512
s_waitcnt lgkmcnt(8)
v_mfma_f32_16x16x32_bf16 v[176:179],v[136:139],v[64:67],v[176:179]
s_add_u32 s83,s83,s29
v_add_u32 v8,0x10000,v8
ds_read_b64_tr_b16 v[44:45],v8 offset:0
ds_read_b64_tr_b16 v[46:47],v8 offset:512
v_mfma_f32_16x16x32_bf16 v[180:183],v[140:143],v[64:67],v[180:183]
s_lshl_b32 s26,s26,12
s_waitcnt lgkmcnt(8)
v_mfma_f32_16x16x32_bf16 v[188:191],v[140:143],v[68:71],v[188:191]
v_mfma_f32_16x16x32_bf16 v[184:187],v[136:139],v[68:71],v[184:187]
s_add_u32 s91,s26,s24
s_waitcnt vmcnt(11)
s_cmp_lg_u32 s50,0
s_cbranch_scc1 L_xf_ok8
s_waitcnt vmcnt(4)
v_cmp_ne_u32 vcc,s96,v14
s_cbranch_vccnz L_xf_spin8
L_xf_ok8:
s_barrier
ds_read_b64_tr_b16 v[64:65],v5 offset:4096
ds_read_b64_tr_b16 v[66:67],v5 offset:4608
s_setprio 3
s_waitcnt lgkmcnt(8)
v_mfma_f32_16x16x32_bf16 v[192:195],v[112:115],v[72:75],v[192:195]
ds_read_b64_tr_b16 v[68:69],v6 offset:4096
ds_read_b64_tr_b16 v[70:71],v6 offset:4608
v_mfma_f32_16x16x32_bf16 v[196:199],v[116:119],v[72:75],v[196:199]
s_add_u32 m0,s39,0
s_add_u32 s26,s80,0
buffer_load_dwordx4 v10,s[76:79],s26 offen lds
s_waitcnt lgkmcnt(8)
v_mfma_f32_16x16x32_bf16 v[204:207],v[116:119],v[76:79],v[204:207]
v_mfma_f32_16x16x32_bf16 v[200:203],v[112:115],v[76:79],v[200:203]
ds_read_b64_tr_b16 v[72:73],v7 offset:4096
ds_read_b64_tr_b16 v[74:75],v7 offset:4608
s_waitcnt lgkmcnt(8)
v_mfma_f32_16x16x32_bf16 v[208:211],v[112:115],v[40:43],v[208:211]
s_add_u32 m0,s39,1024
s_add_u32 s26,s80,32768
buffer_load_dwordx4 v10,s[76:79],s26 offen lds
ds_read_b64_tr_b16 v[76:77],v8 offset:4096
ds_read_b64_tr_b16 v[78:79],v8 offset:4608
v_mfma_f32_16x16x32_bf16 v[212:215],v[116:119],v[40:43],v[212:215]
s_add_u32 s54,s51,2
s_waitcnt lgkmcnt(8)
v_mfma_f32_16x16x32_bf16 v[220:223],v[116:119],v[44:47],v[220:223]
v_mfma_f32_16x16x32_bf16 v[216:219],v[112:115],v[44:47],v[216:219]
s_lshr_b32 s57,s54,1
ds_read_b64_tr_b16 v[40:41],v5 offset:8192
ds_read_b64_tr_b16 v[42:43],v5 offset:8704
s_waitcnt lgkmcnt(8)
v_mfma_f32_16x16x32_bf16 v[192:195],v[120:123],v[64:67],v[192:195]
ds_read_b64_tr_b16 v[44:45],v6 offset:8192
ds_read_b64_tr_b16 v[46:47],v6 offset:8704
v_mfma_f32_16x16x32_bf16 v[196:199],v[124:127],v[64:67],v[196:199]
s_lshl_b32 s57,s57,20
s_waitcnt lgkmcnt(8)
v_mfma_f32_16x16x32_bf16 v[204:207],v[124:127],v[68:71],v[204:207]
buffer_load_dwordx4 v[24:27],v2,s[8:11],s88 offen offset:0 sc1
v_mfma_f32_16x16x32_bf16 v[200:203],v[120:123],v[68:71],v[200:203]
s_and_b32 s54,s54,1
ds_read_b64_tr_b16 v[64:65],v7 offset:8192
ds_read_b64_tr_b16 v[66:67],v7 offset:8704
s_waitcnt lgkmcnt(8)
v_mfma_f32_16x16x32_bf16 v[208:211],v[120:123],v[72:75],v[208:211]
ds_read_b64_tr_b16 v[68:69],v8 offset:8192
ds_read_b64_tr_b16 v[70:71],v8 offset:8704
v_mfma_f32_16x16x32_bf16 v[212:215],v[124:127],v[72:75],v[212:215]
s_lshl_b32 s54,s54,12
s_waitcnt lgkmcnt(8)
v_mfma_f32_16x16x32_bf16 v[220:223],v[124:127],v[76:79],v[220:223]
v_mfma_f32_16x16x32_bf16 v[216:219],v[120:123],v[76:79],v[216:219]
s_add_u32 s57,s57,s54
ds_read_b64_tr_b16 v[72:73],v5 offset:12288
ds_read_b64_tr_b16 v[74:75],v5 offset:12800
s_setprio 2
s_waitcnt lgkmcnt(8)
v_mfma_f32_16x16x32_bf16 v[192:195],v[80:83],v[40:43],v[192:195]
buffer_load_dwordx4 v[28:31],v2,s[8:11],s88 offen offset:1024 sc1
ds_read_b64_tr_b16 v[76:77],v6 offset:12288
ds_read_b64_tr_b16 v[78:79],v6 offset:12800
v_mfma_f32_16x16x32_bf16 v[196:199],v[84:87],v[40:43],v[196:199]
s_add_u32 s57,s57,16384
s_waitcnt lgkmcnt(8)
v_mfma_f32_16x16x32_bf16 v[204:207],v[84:87],v[44:47],v[204:207]
v_mfma_f32_16x16x32_bf16 v[200:203],v[80:83],v[44:47],v[200:203]
v_cvt_pk_bf16_f32 v160,v160,v161
ds_read_b64_tr_b16 v[40:41],v7 offset:12288
ds_read_b64_tr_b16 v[42:43],v7 offset:12800
s_waitcnt lgkmcnt(8)
v_mfma_f32_16x16x32_bf16 v[208:211],v[80:83],v[64:67],v[208:211]
ds_read_b64_tr_b16 v[44:45],v8 offset:12288
ds_read_b64_tr_b16 v[46:47],v8 offset:12800
v_mfma_f32_16x16x32_bf16 v[212:215],v[84:87],v[64:67],v[212:215]
v_cvt_pk_bf16_f32 v161,v162,v163
s_waitcnt lgkmcnt(8)
v_mfma_f32_16x16x32_bf16 v[220:223],v[84:87],v[68:71],v[220:223]
buffer_load_dwordx4 v[32:35],v2,s[8:11],s88 offen offset:2048 sc1
v_mfma_f32_16x16x32_bf16 v[216:219],v[80:83],v[68:71],v[216:219]
v_cvt_pk_bf16_f32 v162,v164,v165
ds_read_b64_tr_b16 v[64:65],v5 offset:16384
ds_read_b64_tr_b16 v[66:67],v5 offset:16896
s_waitcnt lgkmcnt(8)
v_mfma_f32_16x16x32_bf16 v[192:195],v[88:91],v[72:75],v[192:195]
ds_read_b64_tr_b16 v[68:69],v6 offset:16384
ds_read_b64_tr_b16 v[70:71],v6 offset:16896
v_mfma_f32_16x16x32_bf16 v[196:199],v[92:95],v[72:75],v[196:199]
v_cvt_pk_bf16_f32 v163,v166,v167
s_waitcnt lgkmcnt(8)
v_mfma_f32_16x16x32_bf16 v[204:207],v[92:95],v[76:79],v[204:207]
buffer_load_dwordx4 v[36:39],v2,s[8:11],s88 offen offset:3072 sc1
v_mfma_f32_16x16x32_bf16 v[200:203],v[88:91],v[76:79],v[200:203]
buffer_store_dwordx4 v[160:163],v4,s[40:43],s57 offen offset:0 sc1
ds_read_b64_tr_b16 v[72:73],v7 offset:16384
ds_read_b64_tr_b16 v[74:75],v7 offset:16896
s_waitcnt lgkmcnt(8)
v_mfma_f32_16x16x32_bf16 v[208:211],v[88:91],v[40:43],v[208:211]
ds_read_b64_tr_b16 v[76:77],v8 offset:16384
ds_read_b64_tr_b16 v[78:79],v8 offset:16896
v_mfma_f32_16x16x32_bf16 v[212:215],v[92:95],v[40:43],v[212:215]
v_cvt_pk_bf16_f32 v164,v168,v169
s_waitcnt lgkmcnt(8)
v_mfma_f32_16x16x32_bf16 v[220:223],v[92:95],v[44:47],v[220:223]
v_mfma_f32_16x16x32_bf16 v[216:219],v[88:91],v[44:47],v[216:219]
v_cvt_pk_bf16_f32 v165,v170,v171
ds_read_b64_tr_b16 v[40:41],v5 offset:20480
ds_read_b64_tr_b16 v[42:43],v5 offset:20992
s_setprio 1
s_waitcnt lgkmcnt(8)
v_mfma_f32_16x16x32_bf16 v[192:195],v[96:99],v[64:67],v[192:195]
s_add_u32 m0,s39,16384
s_add_u32 s26,s81,0
buffer_load_dwordx4 v10,s[76:79],s26 offen lds
ds_read_b64_tr_b16 v[44:45],v6 offset:20480
ds_read_b64_tr_b16 v[46:47],v6 offset:20992
v_mfma_f32_16x16x32_bf16 v[196:199],v[100:103],v[64:67],v[196:199]
v_cvt_pk_bf16_f32 v166,v172,v173
s_waitcnt lgkmcnt(8)
v_mfma_f32_16x16x32_bf16 v[204:207],v[100:103],v[68:71],v[204:207]
v_mfma_f32_16x16x32_bf16 v[200:203],v[96:99],v[68:71],v[200:203]
v_cvt_pk_bf16_f32 v167,v174,v175
ds_read_b64_tr_b16 v[64:65],v7 offset:20480
ds_read_b64_tr_b16 v[66:67],v7 offset:20992
s_waitcnt lgkmcnt(8)
v_mfma_f32_16x16x32_bf16 v[208:211],v[96:99],v[72:75],v[208:211]
ds_read_b64_tr_b16 v[68:69],v8 offset:20480
ds_read_b64_tr_b16 v[70:71],v8 offset:20992
v_mfma_f32_16x16x32_bf16 v[212:215],v[100:103],v[72:75],v[212:215]
buffer_store_dwordx4 v[164:167],v4,s[40:43],s57 offen offset:128 sc1
s_waitcnt lgkmcnt(8)
v_mfma_f32_16x16x32_bf16 v[220:223],v[100:103],v[76:79],v[220:223]
s_add_u32 m0,s39,17408
s_add_u32 s26,s81,32768
buffer_load_dwordx4 v10,s[76:79],s26 offen lds
v_mfma_f32_16x16x32_bf16 v[216:219],v[96:99],v[76:79],v[216:219]
v_cvt_pk_bf16_f32 v176,v176,v177
ds_read_b64_tr_b16 v[72:73],v5 offset:24576
ds_read_b64_tr_b16 v[74:75],v5 offset:25088
s_waitcnt lgkmcnt(8)
v_mfma_f32_16x16x32_bf16 v[192:195],v[104:107],v[40:43],v[192:195]
ds_read_b64_tr_b16 v[76:77],v6 offset:24576
ds_read_b64_tr_b16 v[78:79],v6 offset:25088
v_mfma_f32_16x16x32_bf16 v[196:199],v[108:111],v[40:43],v[196:199]
v_cvt_pk_bf16_f32 v177,v178,v179
s_waitcnt lgkmcnt(8)
v_mfma_f32_16x16x32_bf16 v[204:207],v[108:111],v[44:47],v[204:207]
v_mfma_f32_16x16x32_bf16 v[200:203],v[104:107],v[44:47],v[200:203]
v_cvt_pk_bf16_f32 v178,v180,v181
ds_read_b64_tr_b16 v[40:41],v7 offset:24576
ds_read_b64_tr_b16 v[42:43],v7 offset:25088
s_waitcnt lgkmcnt(8)
v_mfma_f32_16x16x32_bf16 v[208:211],v[104:107],v[64:67],v[208:211]
buffer_load_dwordx4 v[48:51],v2,s[8:11],s89 offen offset:0 sc1
ds_read_b64_tr_b16 v[44:45],v8 offset:24576
ds_read_b64_tr_b16 v[46:47],v8 offset:25088
v_mfma_f32_16x16x32_bf16 v[212:215],v[108:111],v[64:67],v[212:215]
v_cvt_pk_bf16_f32 v179,v182,v183
s_waitcnt lgkmcnt(8)
v_mfma_f32_16x16x32_bf16 v[220:223],v[108:111],v[68:71],v[220:223]
v_mfma_f32_16x16x32_bf16 v[216:219],v[104:107],v[68:71],v[216:219]
buffer_store_dwordx4 v[176:179],v4,s[40:43],s57 offen offset:2048 sc1
ds_read_b64_tr_b16 v[64:65],v5 offset:28672
ds_read_b64_tr_b16 v[66:67],v5 offset:29184
s_setprio 0
s_waitcnt lgkmcnt(8)
v_mfma_f32_16x16x32_bf16 v[192:195],v[128:131],v[72:75],v[192:195]
buffer_load_dwordx4 v[52:55],v2,s[8:11],s89 offen offset:1024 sc1
ds_read_b64_tr_b16 v[68:69],v6 offset:28672
ds_read_b64_tr_b16 v[70:71],v6 offset:29184
v_mfma_f32_16x16x32_bf16 v[196:199],v[132:135],v[72:75],v[196:199]
v_cvt_pk_bf16_f32 v180,v184,v185
s_waitcnt lgkmcnt(8)
v_mfma_f32_16x16x32_bf16 v[204:207],v[132:135],v[76:79],v[204:207]
v_mfma_f32_16x16x32_bf16 v[200:203],v[128:131],v[76:79],v[200:203]
v_cvt_pk_bf16_f32 v181,v186,v187
ds_read_b64_tr_b16 v[72:73],v7 offset:28672
ds_read_b64_tr_b16 v[74:75],v7 offset:29184
s_waitcnt lgkmcnt(8)
v_mfma_f32_16x16x32_bf16 v[208:211],v[128:131],v[40:43],v[208:211]
ds_read_b64_tr_b16 v[76:77],v8 offset:28672
ds_read_b64_tr_b16 v[78:79],v8 offset:29184
v_mfma_f32_16x16x32_bf16 v[212:215],v[132:135],v[40:43],v[212:215]
v_cvt_pk_bf16_f32 v182,v188,v189
s_waitcnt lgkmcnt(8)
v_mfma_f32_16x16x32_bf16 v[220:223],v[132:135],v[44:47],v[220:223]
buffer_load_dwordx4 v[56:59],v2,s[8:11],s89 offen offset:2048 sc1
v_mfma_f32_16x16x32_bf16 v[216:219],v[128:131],v[44:47],v[216:219]
v_cvt_pk_bf16_f32 v183,v190,v191
v_add_u32 v5,0xffff0000,v5
ds_read_b64_tr_b16 v[40:41],v5 offset:0
ds_read_b64_tr_b16 v[42:43],v5 offset:512
s_waitcnt lgkmcnt(8)
v_mfma_f32_16x16x32_bf16 v[192:195],v[136:139],v[64:67],v[192:195]
v_add_u32 v6,0xffff0000,v6
ds_read_b64_tr_b16 v[44:45],v6 offset:0
ds_read_b64_tr_b16 v[46:47],v6 offset:512
v_mfma_f32_16x16x32_bf16 v[196:199],v[140:143],v[64:67],v[196:199]
buffer_store_dwordx4 v[180:183],v4,s[40:43],s57 offen offset:2176 sc1
s_waitcnt lgkmcnt(8)
v_mfma_f32_16x16x32_bf16 v[204:207],v[140:143],v[68:71],v[204:207]
v_mfma_f32_16x16x32_bf16 v[200:203],v[136:139],v[68:71],v[200:203]
v_add_u32 v7,0xffff0000,v7
ds_read_b64_tr_b16 v[64:65],v7 offset:0
ds_read_b64_tr_b16 v[66:67],v7 offset:512
s_waitcnt lgkmcnt(8)
v_mfma_f32_16x16x32_bf16 v[208:211],v[136:139],v[72:75],v[208:211]
v_add_u32 v8,0xffff0000,v8
ds_read_b64_tr_b16 v[68:69],v8 offset:0
ds_read_b64_tr_b16 v[70:71],v8 offset:512
v_mfma_f32_16x16x32_bf16 v[212:215],v[140:143],v[72:75],v[212:215]
buffer_load_dwordx4 v[60:63],v2,s[8:11],s89 offen offset:3072 sc1
s_waitcnt lgkmcnt(8)
v_mfma_f32_16x16x32_bf16 v[220:223],v[140:143],v[76:79],v[220:223]
v_mfma_f32_16x16x32_bf16 v[216:219],v[136:139],v[76:79],v[216:219]
s_waitcnt vmcnt(20)
s_barrier
ds_read_b64_tr_b16 v[72:73],v5 offset:4096
ds_read_b64_tr_b16 v[74:75],v5 offset:4608
s_setprio 3
s_waitcnt lgkmcnt(8)
v_mfma_f32_16x16x32_bf16 v[224:227],v[112:115],v[40:43],v[224:227]
ds_read_b64_tr_b16 v[76:77],v6 offset:4096
ds_read_b64_tr_b16 v[78:79],v6 offset:4608
v_mfma_f32_16x16x32_bf16 v[228:231],v[116:119],v[40:43],v[228:231]
s_waitcnt lgkmcnt(8)
v_mfma_f32_16x16x32_bf16 v[236:239],v[116:119],v[44:47],v[236:239]
v_mfma_f32_16x16x32_bf16 v[232:235],v[112:115],v[44:47],v[232:235]
s_add_u32 m0,s39,32768
s_add_u32 s26,s82,0
buffer_load_dwordx4 v10,s[76:79],s26 offen lds
ds_read_b64_tr_b16 v[40:41],v7 offset:4096
ds_read_b64_tr_b16 v[42:43],v7 offset:4608
s_waitcnt lgkmcnt(8)
v_mfma_f32_16x16x32_bf16 v[240:243],v[112:115],v[64:67],v[240:243]
ds_read_b64_tr_b16 v[44:45],v8 offset:4096
ds_read_b64_tr_b16 v[46:47],v8 offset:4608
v_mfma_f32_16x16x32_bf16 v[244:247],v[116:119],v[64:67],v[244:247]
s_add_u32 s54,s51,3
s_waitcnt lgkmcnt(8)
v_mfma_f32_16x16x32_bf16 v[252:255],v[116:119],v[68:71],v[252:255]
s_add_u32 m0,s39,33792
s_add_u32 s26,s82,32768
buffer_load_dwordx4 v10,s[76:79],s26 offen lds
v_mfma_f32_16x16x32_bf16 v[248:251],v[112:115],v[68:71],v[248:251]
s_lshr_b32 s57,s54,1
ds_read_b64_tr_b16 v[64:65],v5 offset:8192
ds_read_b64_tr_b16 v[66:67],v5 offset:8704
s_waitcnt lgkmcnt(8)
v_mfma_f32_16x16x32_bf16 v[224:227],v[120:123],v[72:75],v[224:227]
ds_read_b64_tr_b16 v[68:69],v6 offset:8192
ds_read_b64_tr_b16 v[70:71],v6 offset:8704
v_mfma_f32_16x16x32_bf16 v[228:231],v[124:127],v[72:75],v[228:231]
s_lshl_b32 s57,s57,20
s_waitcnt lgkmcnt(8)
v_mfma_f32_16x16x32_bf16 v[236:239],v[124:127],v[76:79],v[236:239]
v_mfma_f32_16x16x32_bf16 v[232:235],v[120:123],v[76:79],v[232:235]
s_and_b32 s54,s54,1
ds_read_b64_tr_b16 v[72:73],v7 offset:8192
ds_read_b64_tr_b16 v[74:75],v7 offset:8704
s_waitcnt lgkmcnt(8)
v_mfma_f32_16x16x32_bf16 v[240:243],v[120:123],v[40:43],v[240:243]
s_add_u32 m0,s39,49152
s_add_u32 s26,s83,0
buffer_load_dwordx4 v10,s[76:79],s26 offen lds
ds_read_b64_tr_b16 v[76:77],v8 offset:8192
ds_read_b64_tr_b16 v[78:79],v8 offset:8704
v_mfma_f32_16x16x32_bf16 v[244:247],v[124:127],v[40:43],v[244:247]
s_lshl_b32 s54,s54,12
s_waitcnt lgkmcnt(8)
v_mfma_f32_16x16x32_bf16 v[252:255],v[124:127],v[44:47],v[252:255]
v_mfma_f32_16x16x32_bf16 v[248:251],v[120:123],v[44:47],v[248:251]
s_add_u32 s57,s57,s54
ds_read_b64_tr_b16 v[40:41],v5 offset:12288
ds_read_b64_tr_b16 v[42:43],v5 offset:12800
s_setprio 2
s_waitcnt lgkmcnt(8)
v_mfma_f32_16x16x32_bf16 v[224:227],v[80:83],v[64:67],v[224:227]
ds_read_b64_tr_b16 v[44:45],v6 offset:12288
ds_read_b64_tr_b16 v[46:47],v6 offset:12800
v_mfma_f32_16x16x32_bf16 v[228:231],v[84:87],v[64:67],v[228:231]
s_add_u32 s57,s57,16384
s_waitcnt lgkmcnt(8)
v_mfma_f32_16x16x32_bf16 v[236:239],v[84:87],v[68:71],v[236:239]
s_add_u32 m0,s39,50176
s_add_u32 s26,s83,32768
buffer_load_dwordx4 v10,s[76:79],s26 offen lds
v_mfma_f32_16x16x32_bf16 v[232:235],v[80:83],v[68:71],v[232:235]
v_cvt_pk_bf16_f32 v192,v192,v193
ds_read_b64_tr_b16 v[64:65],v7 offset:12288
ds_read_b64_tr_b16 v[66:67],v7 offset:12800
s_waitcnt lgkmcnt(8)
v_mfma_f32_16x16x32_bf16 v[240:243],v[80:83],v[72:75],v[240:243]
ds_read_b64_tr_b16 v[68:69],v8 offset:12288
ds_read_b64_tr_b16 v[70:71],v8 offset:12800
v_mfma_f32_16x16x32_bf16 v[244:247],v[84:87],v[72:75],v[244:247]
v_cvt_pk_bf16_f32 v193,v194,v195
s_waitcnt lgkmcnt(8)
v_mfma_f32_16x16x32_bf16 v[252:255],v[84:87],v[76:79],v[252:255]
v_mfma_f32_16x16x32_bf16 v[248:251],v[80:83],v[76:79],v[248:251]
v_cvt_pk_bf16_f32 v194,v196,v197
ds_read_b64_tr_b16 v[72:73],v5 offset:16384
ds_read_b64_tr_b16 v[74:75],v5 offset:16896
s_waitcnt lgkmcnt(8)
v_mfma_f32_16x16x32_bf16 v[224:227],v[88:91],v[40:43],v[224:227]
s_add_u32 s26,s37,4
s_and_b32 s26,s26,7
ds_read_b64_tr_b16 v[76:77],v6 offset:16384
ds_read_b64_tr_b16 v[78:79],v6 offset:16896
v_mfma_f32_16x16x32_bf16 v[228:231],v[92:95],v[40:43],v[228:231]
s_lshl_b32 s84,s26,19
v_cvt_pk_bf16_f32 v195,v198,v199
s_waitcnt lgkmcnt(8)
v_mfma_f32_16x16x32_bf16 v[236:239],v[92:95],v[44:47],v[236:239]
s_add_u32 s84,s84,s29
v_mfma_f32_16x16x32_bf16 v[232:235],v[88:91],v[44:47],v[232:235]
s_lshl_b32 s26,s26,12
buffer_store_dwordx4 v[192:195],v4,s[40:43],s57 offen offset:0 sc1
ds_read_b64_tr_b16 v[40:41],v7 offset:16384
ds_read_b64_tr_b16 v[42:43],v7 offset:16896
s_waitcnt lgkmcnt(8)
v_mfma_f32_16x16x32_bf16 v[240:243],v[88:91],v[64:67],v[240:243]
s_add_u32 s92,s26,s24
ds_read_b64_tr_b16 v[44:45],v8 offset:16384
ds_read_b64_tr_b16 v[46:47],v8 offset:16896
v_mfma_f32_16x16x32_bf16 v[244:247],v[92:95],v[64:67],v[244:247]
s_add_u32 s26,s37,5
v_cvt_pk_bf16_f32 v196,v200,v201
s_waitcnt lgkmcnt(8)
v_mfma_f32_16x16x32_bf16 v[252:255],v[92:95],v[68:71],v[252:255]
s_and_b32 s26,s26,7
v_mfma_f32_16x16x32_bf16 v[248:251],v[88:91],v[68:71],v[248:251]
s_lshl_b32 s85,s26,19
v_cvt_pk_bf16_f32 v197,v202,v203
ds_read_b64_tr_b16 v[64:65],v5 offset:20480
ds_read_b64_tr_b16 v[66:67],v5 offset:20992
s_setprio 1
s_waitcnt lgkmcnt(8)
v_mfma_f32_16x16x32_bf16 v[224:227],v[96:99],v[72:75],v[224:227]
s_add_u32 s85,s85,s29
ds_read_b64_tr_b16 v[68:69],v6 offset:20480
ds_read_b64_tr_b16 v[70:71],v6 offset:20992
v_mfma_f32_16x16x32_bf16 v[228:231],v[100:103],v[72:75],v[228:231]
s_lshl_b32 s26,s26,12
v_cvt_pk_bf16_f32 v198,v204,v205
s_waitcnt lgkmcnt(8)
v_mfma_f32_16x16x32_bf16 v[236:239],v[100:103],v[76:79],v[236:239]
s_add_u32 s93,s26,s24
v_mfma_f32_16x16x32_bf16 v[232:235],v[96:99],v[76:79],v[232:235]
s_add_u32 s26,s37,6
v_cvt_pk_bf16_f32 v199,v206,v207
ds_read_b64_tr_b16 v[72:73],v7 offset:20480
ds_read_b64_tr_b16 v[74:75],v7 offset:20992
s_waitcnt lgkmcnt(8)
v_mfma_f32_16x16x32_bf16 v[240:243],v[96:99],v[40:43],v[240:243]
s_and_b32 s26,s26,7
ds_read_b64_tr_b16 v[76:77],v8 offset:20480
ds_read_b64_tr_b16 v[78:79],v8 offset:20992
v_mfma_f32_16x16x32_bf16 v[244:247],v[100:103],v[40:43],v[244:247]
s_lshl_b32 s86,s26,19
buffer_store_dwordx4 v[196:199],v4,s[40:43],s57 offen offset:128 sc1
s_waitcnt lgkmcnt(8)
v_mfma_f32_16x16x32_bf16 v[252:255],v[100:103],v[44:47],v[252:255]
s_add_u32 s86,s86,s29
v_mfma_f32_16x16x32_bf16 v[248:251],v[96:99],v[44:47],v[248:251]
s_lshl_b32 s26,s26,12
v_cvt_pk_bf16_f32 v208,v208,v209
ds_read_b64_tr_b16 v[40:41],v5 offset:24576
ds_read_b64_tr_b16 v[42:43],v5 offset:25088
s_waitcnt lgkmcnt(8)
v_mfma_f32_16x16x32_bf16 v[224:227],v[104:107],v[64:67],v[224:227]
s_add_u32 s94,s26,s24
ds_read_b64_tr_b16 v[44:45],v6 offset:24576
ds_read_b64_tr_b16 v[46:47],v6 offset:25088
v_mfma_f32_16x16x32_bf16 v[228:231],v[108:111],v[64:67],v[228:231]
s_add_u32 s26,s37,7
v_cvt_pk_bf16_f32 v209,v210,v211
s_waitcnt lgkmcnt(8)
v_mfma_f32_16x16x32_bf16 v[236:239],v[108:111],v[68:71],v[236:239]
s_and_b32 s26,s26,7
v_mfma_f32_16x16x32_bf16 v[232:235],v[104:107],v[68:71],v[232:235]
s_lshl_b32 s87,s26,19
v_cvt_pk_bf16_f32 v210,v212,v213
ds_read_b64_tr_b16 v[64:65],v7 offset:24576
ds_read_b64_tr_b16 v[66:67],v7 offset:25088
s_waitcnt lgkmcnt(8)
v_mfma_f32_16x16x32_bf16 v[240:243],v[104:107],v[72:75],v[240:243]
s_add_u32 s87,s87,s29
ds_read_b64_tr_b16 v[68:69],v8 offset:24576
ds_read_b64_tr_b16 v[70:71],v8 offset:25088
v_mfma_f32_16x16x32_bf16 v[244:247],v[108:111],v[72:75],v[244:247]
s_lshl_b32 s26,s26,12
v_cvt_pk_bf16_f32 v211,v214,v215
s_waitcnt lgkmcnt(8)
v_mfma_f32_16x16x32_bf16 v[252:255],v[108:111],v[76:79],v[252:255]
s_add_u32 s95,s26,s24
v_mfma_f32_16x16x32_bf16 v[248:251],v[104:107],v[76:79],v[248:251]
s_lshl_b32 s26,s18,1
buffer_store_dwordx4 v[208:211],v4,s[40:43],s57 offen offset:2048 sc1
ds_read_b64_tr_b16 v[72:73],v5 offset:28672
ds_read_b64_tr_b16 v[74:75],v5 offset:29184
s_setprio 0
s_waitcnt lgkmcnt(8)
v_mfma_f32_16x16x32_bf16 v[224:227],v[128:131],v[40:43],v[224:227]
s_sub_u32 s22,31,s26
ds_read_b64_tr_b16 v[76:77],v6 offset:28672
ds_read_b64_tr_b16 v[78:79],v6 offset:29184
v_mfma_f32_16x16x32_bf16 v[228:231],v[132:135],v[40:43],v[228:231]
s_lshl_b32 s36,s17,20
v_cvt_pk_bf16_f32 v212,v216,v217
s_waitcnt lgkmcnt(8)
v_mfma_f32_16x16x32_bf16 v[236:239],v[132:135],v[44:47],v[236:239]
s_mov_b64 s[72:73],s[40:41]
v_mfma_f32_16x16x32_bf16 v[232:235],v[128:131],v[44:47],v[232:235]
s_mov_b32 s74,268435456
v_cvt_pk_bf16_f32 v213,v218,v219
ds_read_b64_tr_b16 v[40:41],v7 offset:28672
ds_read_b64_tr_b16 v[42:43],v7 offset:29184
s_waitcnt lgkmcnt(8)
v_mfma_f32_16x16x32_bf16 v[240:243],v[128:131],v[64:67],v[240:243]
s_mov_b32 s75,0x20000
ds_read_b64_tr_b16 v[44:45],v8 offset:28672
ds_read_b64_tr_b16 v[46:47],v8 offset:29184
v_mfma_f32_16x16x32_bf16 v[244:247],v[132:135],v[64:67],v[244:247]
s_mov_b32 s29,0
v_cvt_pk_bf16_f32 v214,v220,v221
s_waitcnt lgkmcnt(8)
v_mfma_f32_16x16x32_bf16 v[252:255],v[132:135],v[68:71],v[252:255]
s_mov_b32 s24,0
v_mfma_f32_16x16x32_bf16 v[248:251],v[128:131],v[68:71],v[248:251]
s_lshl_b32 s26,s16,13
v_cvt_pk_bf16_f32 v215,v222,v223
s_waitcnt lgkmcnt(6)
v_mfma_f32_16x16x32_bf16 v[224:227],v[136:139],v[72:75],v[224:227]
s_add_u32 s25,s36,s26
v_mfma_f32_16x16x32_bf16 v[228:231],v[140:143],v[72:75],v[228:231]
s_add_u32 s25,s25,16384
buffer_store_dwordx4 v[212:215],v4,s[40:43],s57 offen offset:2176 sc1
s_waitcnt lgkmcnt(4)
v_mfma_f32_16x16x32_bf16 v[236:239],v[140:143],v[76:79],v[236:239]
s_mov_b32 s23,32768
v_mfma_f32_16x16x32_bf16 v[232:235],v[136:139],v[76:79],v[232:235]
s_mov_b32 s21,0
s_waitcnt lgkmcnt(2)
v_mfma_f32_16x16x32_bf16 v[240:243],v[136:139],v[40:43],v[240:243]
s_sub_u32 s20,s19,1
v_mfma_f32_16x16x32_bf16 v[244:247],v[140:143],v[40:43],v[244:247]
s_max_i32 s20,s20,0
s_waitcnt lgkmcnt(0)
v_mfma_f32_16x16x32_bf16 v[252:255],v[140:143],v[44:47],v[252:255]
v_mfma_f32_16x16x32_bf16 v[248:251],v[136:139],v[44:47],v[248:251]
s_nop 1
s_add_u32 s54,s51,4
s_lshr_b32 s57,s54,1
s_lshl_b32 s57,s57,20
s_and_b32 s54,s54,1
s_lshl_b32 s54,s54,12
s_add_u32 s57,s57,s54
s_add_u32 s57,s57,16384
v_cvt_pk_bf16_f32 v224,v224,v225
v_cvt_pk_bf16_f32 v225,v226,v227
v_cvt_pk_bf16_f32 v226,v228,v229
v_cvt_pk_bf16_f32 v227,v230,v231
buffer_store_dwordx4 v[224:227],v4,s[40:43],s57 offen offset:0 sc1
v_cvt_pk_bf16_f32 v228,v232,v233
v_cvt_pk_bf16_f32 v229,v234,v235
v_cvt_pk_bf16_f32 v230,v236,v237
v_cvt_pk_bf16_f32 v231,v238,v239
buffer_store_dwordx4 v[228:231],v4,s[40:43],s57 offen offset:128 sc1
v_cvt_pk_bf16_f32 v240,v240,v241
v_cvt_pk_bf16_f32 v241,v242,v243
v_cvt_pk_bf16_f32 v242,v244,v245
v_cvt_pk_bf16_f32 v243,v246,v247
buffer_store_dwordx4 v[240:243],v4,s[40:43],s57 offen offset:2048 sc1
v_cvt_pk_bf16_f32 v244,v248,v249
v_cvt_pk_bf16_f32 v245,v250,v251
v_cvt_pk_bf16_f32 v246,v252,v253
v_cvt_pk_bf16_f32 v247,v254,v255
buffer_store_dwordx4 v[244:247],v4,s[40:43],s57 offen offset:2176 sc1
s_waitcnt vmcnt(8)
s_branch L_k1_end2
L_k1_p_bq:
s_and_b32 s53,s50,1
s_lshl_b32 s53,s53,4
v_xor_b32 v26,s53,v26
s_mov_b32 s38,1572864
s_sub_u32 s53,s49,26
s_mul_i32 s51,s53,4
s_min_u32 s51,s51,60
s_mul_i32 s54,s51,128
s_add_u32 s54,s54,0
s_mul_i32 s56,s50,24576
s_add_u32 s56,s56,s54
v_mul_u32_u24 v2,3072,v24
v_add_u32 v2,v2,v26
s_mov_b32 s52,4
s_lshl_b32 s68,s53,1
s_add_u32 s68,s68,s48
s_and_b32 s68,s68,7
s_waitcnt lgkmcnt(0)
s_mov_b64 s[32:33],s[4:5]
s_mov_b64 s[36:37],s[18:19]
s_mov_b64 s[40:41],s[28:29]
s_add_u32 s53,s68,0
s_and_b32 s53,s53,7
s_mul_i32 s72,s53,196608
s_add_u32 s72,s72,s56
s_lshl_b32 s53,s53,7
s_add_u32 s80,s55,s53
s_add_u32 m0,s60,65536
s_add_u32 s53,s72,0
buffer_load_dwordx4 v2,s[36:39],s53 offen lds
s_add_u32 m0,s58,0
s_add_u32 s53,s80,0
buffer_load_dwordx4 v3,s[32:35],s53 offen lds
s_add_u32 m0,s58,1024
s_add_u32 s53,s80,16384
buffer_load_dwordx4 v3,s[32:35],s53 offen lds
s_add_u32 m0,s58,2048
s_add_u32 s53,s80,64
buffer_load_dwordx4 v3,s[32:35],s53 offen lds
s_add_u32 m0,s58,3072
s_add_u32 s53,s80,16448
buffer_load_dwordx4 v3,s[32:35],s53 offen lds
s_add_u32 m0,s60,73728
s_add_u32 s53,s72,128
buffer_load_dwordx4 v2,s[36:39],s53 offen lds
s_add_u32 s53,s68,1
s_and_b32 s53,s53,7
s_mul_i32 s73,s53,196608
s_add_u32 s73,s73,s56
s_lshl_b32 s53,s53,7
s_add_u32 s81,s55,s53
s_add_u32 m0,s60,81920
s_add_u32 s53,s72,256
buffer_load_dwordx4 v2,s[36:39],s53 offen lds
v_lshrrev_b32 v66,4,v1
v_bfe_u32 v65,v1,2,2
v_lshl_add_u32 v64,v66,3,v65
v_lshlrev_b32 v64,7,v64
v_xor_b32 v66,v65,v66
v_bfe_u32 v65,v1,3,1
v_lshl_add_u32 v64,v65,6,v64
v_bfe_u32 v65,v1,4,1
v_lshl_add_u32 v64,v65,4,v64
v_bfe_u32 v65,v1,1,1
v_lshl_add_u32 v64,v65,5,v64
v_and_b32 v65,1,v1
v_lshl_add_u32 v64,v65,3,v64
v_add_u32 v5,65536,v64
v_xor_b32 v6,16,v5
v_xor_b32 v7,64,v5
v_xor_b32 v8,64,v6
v_and_b32 v64,15,v1
v_lshlrev_b32 v66,4,v66
v_lshl_add_u32 v64,v64,6,v66
v_add_u32 v9,s58,v64
s_lshr_b32 s54,s55,16
s_lshl_b32 s54,s54,15
s_bfe_u32 s57,s55,0x1000f
s_lshl_b32 s57,s57,13
s_add_u32 s54,s54,s57
v_lshrrev_b32 v4,4,v1
v_and_b32 v64,15,v1
v_lshlrev_b32 v64,4,v64
v_lshl_add_u32 v4,v4,9,v64
v_add_u32 v4,s54,v4
s_mov_b32 s61,0x3fb8aa3b
s_mov_b32 s71,0x3e0293ee
s_mov_b32 s62,0x358637bd
s_mov_b64 s[44:45],s[22:23]
s_mov_b32 s46,1024
s_lshl_b32 s53,s68,3
v_add_u32 v22,s53,v1
v_and_b32 v22,63,v22
v_lshlrev_b32 v22,4,v22
s_add_u32 m0,s60,155648
s_add_u32 s53,s60,155648
buffer_load_dwordx4 v22,s[44:47],0 offen lds
v_and_b32 v21,48,v1
s_nop 0
v_add_u32 v21,s53,v21
s_add_u32 m0,s60,90112
s_add_u32 s53,s72,384
buffer_load_dwordx4 v2,s[36:39],s53 offen lds
s_add_u32 m0,s58,4096
s_add_u32 s53,s81,0
buffer_load_dwordx4 v3,s[32:35],s53 offen lds
s_add_u32 m0,s58,5120
s_add_u32 s53,s81,16384
buffer_load_dwordx4 v3,s[32:35],s53 offen lds
s_add_u32 m0,s60,98304
s_add_u32 s53,s73,0
buffer_load_dwordx4 v2,s[36:39],s53 offen lds
s_add_u32 m0,s60,106496
s_add_u32 s53,s73,128
buffer_load_dwordx4 v2,s[36:39],s53 offen lds
s_add_u32 m0,s58,6144
s_add_u32 s53,s81,64
buffer_load_dwordx4 v3,s[32:35],s53 offen lds
s_add_u32 m0,s58,7168
s_add_u32 s53,s81,16448
buffer_load_dwordx4 v3,s[32:35],s53 offen lds
s_add_u32 m0,s60,114688
s_add_u32 s53,s73,256
buffer_load_dwordx4 v2,s[36:39],s53 offen lds
s_add_u32 m0,s60,122880
s_add_u32 s53,s73,384
buffer_load_dwordx4 v2,s[36:39],s53 offen lds
s_add_u32 s53,s68,2
s_and_b32 s53,s53,7
s_mul_i32 s74,s53,196608
s_add_u32 s74,s74,s56
s_lshl_b32 s53,s53,7
s_add_u32 s82,s55,s53
s_add_u32 s53,s68,3
s_and_b32 s53,s53,7
s_mul_i32 s75,s53,196608
s_add_u32 s75,s75,s56
s_lshl_b32 s53,s53,7
s_add_u32 s83,s55,s53
s_add_u32 s53,s68,4
s_and_b32 s53,s53,7
s_mul_i32 s76,s53,196608
s_add_u32 s76,s76,s56
s_lshl_b32 s53,s53,7
s_add_u32 s84,s55,s53
s_add_u32 s53,s68,5
s_and_b32 s53,s53,7
s_mul_i32 s77,s53,196608
s_add_u32 s77,s77,s56
s_lshl_b32 s53,s53,7
s_add_u32 s85,s55,s53
s_add_u32 s53,s68,6
s_and_b32 s53,s53,7
s_mul_i32 s78,s53,196608
s_add_u32 s78,s78,s56
s_lshl_b32 s53,s53,7
s_add_u32 s86,s55,s53
s_add_u32 s53,s68,7
s_and_b32 s53,s53,7
s_mul_i32 s79,s53,196608
s_add_u32 s79,s79,s56
s_lshl_b32 s53,s53,7
s_add_u32 s87,s55,s53
s_mov_b32 s16,s50
s_and_b32 s26,s98,7
s_lshr_b32 s27,s98,3
s_and_b32 s17,s27,3
s_lshl_b32 s26,s26,2
s_add_u32 s17,s17,s26
s_lshr_b32 s18,s27,2
s_lshl_b32 s26,s18,2
s_add_u32 s19,s26,s16
s_sub_u32 s27,67,s19
s_cmp_lt_u32 s16,4
s_cselect_b32 s19,s19,s27
s_cselect_b32 s28,1,0
s_waitcnt vmcnt(14)
ds_read_b128 v[80:83],v9 offset:0
ds_read_b128 v[84:87],v9 offset:1024
s_waitcnt vmcnt(12)
ds_read_b128 v[88:91],v9 offset:2048
ds_read_b128 v[92:95],v9 offset:3072
s_waitcnt vmcnt(10)
s_barrier
ds_read_b64_tr_b16 v[40:41],v5 offset:0
ds_read_b64_tr_b16 v[42:43],v5 offset:512
ds_read_b64_tr_b16 v[44:45],v6 offset:0
ds_read_b64_tr_b16 v[46:47],v6 offset:512
ds_read_b64_tr_b16 v[64:65],v7 offset:0
ds_read_b64_tr_b16 v[66:67],v7 offset:512
ds_read_b64_tr_b16 v[68:69],v8 offset:0
ds_read_b64_tr_b16 v[70:71],v8 offset:512
ds_read_b64_tr_b16 v[72:73],v5 offset:4096
ds_read_b64_tr_b16 v[74:75],v5 offset:4608
s_setprio 3
s_waitcnt lgkmcnt(8)
v_mfma_f32_16x16x32_bf16 v[24:27],v[40:43],v[80:83],1.0
s_add_u32 m0,s60,131072
s_add_u32 s53,s74,0
buffer_load_dwordx4 v2,s[36:39],s53 offen lds
ds_read_b64_tr_b16 v[76:77],v6 offset:4096
ds_read_b64_tr_b16 v[78:79],v6 offset:4608
v_mfma_f32_16x16x32_bf16 v[32:35],v[40:43],v[84:87],1.0
s_add_u32 m0,s58,0
s_add_u32 s53,s82,0
buffer_load_dwordx4 v3,s[32:35],s53 offen lds
s_waitcnt lgkmcnt(8)
v_mfma_f32_16x16x32_bf16 v[36:39],v[44:47],v[84:87],1.0
v_mfma_f32_16x16x32_bf16 v[28:31],v[44:47],v[80:83],1.0
s_add_u32 m0,s58,1024
s_add_u32 s53,s82,16384
buffer_load_dwordx4 v3,s[32:35],s53 offen lds
ds_read_b64_tr_b16 v[40:41],v7 offset:4096
ds_read_b64_tr_b16 v[42:43],v7 offset:4608
s_waitcnt lgkmcnt(8)
v_mfma_f32_16x16x32_bf16 v[48:51],v[64:67],v[80:83],1.0
s_add_u32 m0,s60,139264
s_add_u32 s53,s74,128
buffer_load_dwordx4 v2,s[36:39],s53 offen lds
ds_read_b64_tr_b16 v[44:45],v8 offset:4096
ds_read_b64_tr_b16 v[46:47],v8 offset:4608
v_mfma_f32_16x16x32_bf16 v[56:59],v[64:67],v[84:87],1.0
s_add_u32 m0,s58,2048
s_add_u32 s53,s82,64
buffer_load_dwordx4 v3,s[32:35],s53 offen lds
s_waitcnt lgkmcnt(8)
v_mfma_f32_16x16x32_bf16 v[60:63],v[68:71],v[84:87],1.0
v_mfma_f32_16x16x32_bf16 v[52:55],v[68:71],v[80:83],1.0
s_add_u32 m0,s58,3072
s_add_u32 s53,s82,16448
buffer_load_dwordx4 v3,s[32:35],s53 offen lds
ds_read_b64_tr_b16 v[64:65],v5 offset:8192
ds_read_b64_tr_b16 v[66:67],v5 offset:8704
s_setprio 2
s_waitcnt lgkmcnt(8)
v_mfma_f32_16x16x32_bf16 v[24:27],v[72:75],v[88:91],v[24:27]
ds_read_b64_tr_b16 v[68:69],v6 offset:8192
ds_read_b64_tr_b16 v[70:71],v6 offset:8704
v_mfma_f32_16x16x32_bf16 v[32:35],v[72:75],v[92:95],v[32:35]
s_add_u32 m0,s60,147456
s_add_u32 s53,s74,256
buffer_load_dwordx4 v2,s[36:39],s53 offen lds
s_waitcnt lgkmcnt(8)
v_mfma_f32_16x16x32_bf16 v[36:39],v[76:79],v[92:95],v[36:39]
v_mfma_f32_16x16x32_bf16 v[28:31],v[76:79],v[88:91],v[28:31]
ds_read_b64_tr_b16 v[72:73],v7 offset:8192
ds_read_b64_tr_b16 v[74:75],v7 offset:8704
s_waitcnt lgkmcnt(8)
v_mfma_f32_16x16x32_bf16 v[48:51],v[40:43],v[88:91],v[48:51]
ds_read_b64_tr_b16 v[76:77],v8 offset:8192
ds_read_b64_tr_b16 v[78:79],v8 offset:8704
v_mfma_f32_16x16x32_bf16 v[56:59],v[40:43],v[92:95],v[56:59]
s_waitcnt vmcnt(16)
ds_read_b128 v[16:19],v21 offset:0
s_waitcnt lgkmcnt(9)
v_mfma_f32_16x16x32_bf16 v[60:63],v[44:47],v[92:95],v[60:63]
v_mfma_f32_16x16x32_bf16 v[52:55],v[44:47],v[88:91],v[52:55]
ds_read_b64_tr_b16 v[40:41],v5 offset:12288
ds_read_b64_tr_b16 v[42:43],v5 offset:12800
s_setprio 1
s_waitcnt lgkmcnt(9)
v_mfma_f32_16x16x32_bf16 v[128:131],v[64:67],v[80:83],1.0
ds_read_b64_tr_b16 v[44:45],v6 offset:12288
ds_read_b64_tr_b16 v[46:47],v6 offset:12800
v_mfma_f32_16x16x32_bf16 v[136:139],v[64:67],v[84:87],1.0
s_waitcnt lgkmcnt(9)
v_mfma_f32_16x16x32_bf16 v[140:143],v[68:71],v[84:87],1.0
v_mfma_f32_16x16x32_bf16 v[132:135],v[68:71],v[80:83],1.0
ds_read_b64_tr_b16 v[64:65],v7 offset:12288
ds_read_b64_tr_b16 v[66:67],v7 offset:12800
s_waitcnt lgkmcnt(9)
v_mfma_f32_16x16x32_bf16 v[144:147],v[72:75],v[80:83],1.0
ds_read_b64_tr_b16 v[68:69],v8 offset:12288
ds_read_b64_tr_b16 v[70:71],v8 offset:12800
v_mfma_f32_16x16x32_bf16 v[152:155],v[72:75],v[84:87],1.0
s_waitcnt lgkmcnt(8)
v_mfma_f32_16x16x32_bf16 v[224:227],v[16:19],v[80:83],0
v_mfma_f32_16x16x32_bf16 v[156:159],v[76:79],v[84:87],1.0
v_mfma_f32_16x16x32_bf16 v[148:151],v[76:79],v[80:83],1.0
v_mfma_f32_16x16x32_bf16 v[228:231],v[16:19],v[84:87],0
ds_read_b64_tr_b16 v[72:73],v5 offset:16384
ds_read_b64_tr_b16 v[74:75],v5 offset:16896
s_setprio 0
s_waitcnt lgkmcnt(8)
v_mfma_f32_16x16x32_bf16 v[128:131],v[40:43],v[88:91],v[128:131]
ds_read_b64_tr_b16 v[76:77],v6 offset:16384
ds_read_b64_tr_b16 v[78:79],v6 offset:16896
v_mfma_f32_16x16x32_bf16 v[136:139],v[40:43],v[92:95],v[136:139]
s_waitcnt lgkmcnt(8)
v_mfma_f32_16x16x32_bf16 v[140:143],v[44:47],v[92:95],v[140:143]
v_mfma_f32_16x16x32_bf16 v[132:135],v[44:47],v[88:91],v[132:135]
ds_read_b64_tr_b16 v[40:41],v7 offset:16384
ds_read_b64_tr_b16 v[42:43],v7 offset:16896
s_waitcnt lgkmcnt(8)
v_mfma_f32_16x16x32_bf16 v[144:147],v[64:67],v[88:91],v[144:147]
ds_read_b64_tr_b16 v[44:45],v8 offset:16384
ds_read_b64_tr_b16 v[46:47],v8 offset:16896
v_mfma_f32_16x16x32_bf16 v[152:155],v[64:67],v[92:95],v[152:155]
s_waitcnt lgkmcnt(8)
v_mfma_f32_16x16x32_bf16 v[156:159],v[68:71],v[92:95],v[156:159]
v_mfma_f32_16x16x32_bf16 v[148:151],v[68:71],v[88:91],v[148:151]
s_waitcnt vmcnt(12)
s_barrier
ds_read_b64_tr_b16 v[64:65],v5 offset:20480
ds_read_b64_tr_b16 v[66:67],v5 offset:20992
s_setprio 3
s_waitcnt lgkmcnt(8)
v_mfma_f32_16x16x32_bf16 v[160:163],v[72:75],v[80:83],1.0
s_add_u32 m0,s60,65536
s_add_u32 s53,s74,384
buffer_load_dwordx4 v2,s[36:39],s53 offen lds
ds_read_b64_tr_b16 v[68:69],v6 offset:20480
ds_read_b64_tr_b16 v[70:71],v6 offset:20992
v_mfma_f32_16x16x32_bf16 v[168:171],v[72:75],v[84:87],1.0
ds_read_b128 v[10:13],v21 offset:64
s_waitcnt lgkmcnt(9)
v_mfma_f32_16x16x32_bf16 v[172:175],v[76:79],v[84:87],1.0
v_mfma_f32_16x16x32_bf16 v[164:167],v[76:79],v[80:83],1.0
ds_read_b64_tr_b16 v[72:73],v7 offset:20480
ds_read_b64_tr_b16 v[74:75],v7 offset:20992
s_waitcnt lgkmcnt(9)
v_mfma_f32_16x16x32_bf16 v[176:179],v[40:43],v[80:83],1.0
ds_read_b64_tr_b16 v[76:77],v8 offset:20480
ds_read_b64_tr_b16 v[78:79],v8 offset:20992
v_mfma_f32_16x16x32_bf16 v[184:187],v[40:43],v[84:87],1.0
ds_read_b128 v[96:99],v9 offset:4096
ds_read_b128 v[100:103],v9 offset:5120
s_waitcnt lgkmcnt(11)
v_mfma_f32_16x16x32_bf16 v[188:191],v[44:47],v[84:87],1.0
v_mfma_f32_16x16x32_bf16 v[180:183],v[44:47],v[80:83],1.0
s_add_u32 m0,s60,73728
s_add_u32 s53,s75,0
buffer_load_dwordx4 v2,s[36:39],s53 offen lds
ds_read_b64_tr_b16 v[40:41],v5 offset:24576
ds_read_b64_tr_b16 v[42:43],v5 offset:25088
s_setprio 2
s_waitcnt lgkmcnt(11)
v_mfma_f32_16x16x32_bf16 v[160:163],v[64:67],v[88:91],v[160:163]
v_lshlrev_b32 v23,4,v1
s_add_u32 s88,s68,0
s_and_b32 s88,s88,7
s_lshl_b32 s88,s88,12
s_add_u32 s88,s88,s55
s_add_u32 s88,s88,41943040
ds_read_b64_tr_b16 v[44:45],v6 offset:24576
ds_read_b64_tr_b16 v[46:47],v6 offset:25088
v_mfma_f32_16x16x32_bf16 v[168:171],v[64:67],v[92:95],v[168:171]
s_waitcnt lgkmcnt(10)
v_mfma_f32_16x16x32_bf16 v[224:227],v[10:13],v[88:91],v[224:227]
v_mfma_f32_16x16x32_bf16 v[172:175],v[68:71],v[92:95],v[172:175]
v_mfma_f32_16x16x32_bf16 v[164:167],v[68:71],v[88:91],v[164:167]
v_mfma_f32_16x16x32_bf16 v[228:231],v[10:13],v[92:95],v[228:231]
ds_read_b64_tr_b16 v[64:65],v7 offset:24576
ds_read_b64_tr_b16 v[66:67],v7 offset:25088
s_waitcnt lgkmcnt(10)
v_mfma_f32_16x16x32_bf16 v[176:179],v[72:75],v[88:91],v[176:179]
ds_read_b64_tr_b16 v[68:69],v8 offset:24576
ds_read_b64_tr_b16 v[70:71],v8 offset:25088
v_mfma_f32_16x16x32_bf16 v[184:187],v[72:75],v[92:95],v[184:187]
buffer_store_dwordx4 v[80:83],v23,s[40:43],s88 offen offset:0 sc1
s_waitcnt lgkmcnt(10)
v_mfma_f32_16x16x32_bf16 v[188:191],v[76:79],v[92:95],v[188:191]
v_mfma_f32_16x16x32_bf16 v[180:183],v[76:79],v[88:91],v[180:183]
ds_read_b64_tr_b16 v[72:73],v5 offset:28672
ds_read_b64_tr_b16 v[74:75],v5 offset:29184
s_setprio 1
s_waitcnt lgkmcnt(8)
v_mfma_f32_16x16x32_bf16 v[192:195],v[40:43],v[80:83],1.0
s_add_u32 m0,s58,4096
s_add_u32 s53,s83,0
buffer_load_dwordx4 v3,s[32:35],s53 offen lds
ds_read_b64_tr_b16 v[76:77],v6 offset:28672
ds_read_b64_tr_b16 v[78:79],v6 offset:29184
v_mfma_f32_16x16x32_bf16 v[200:203],v[40:43],v[84:87],1.0
buffer_store_dwordx4 v[84:87],v23,s[40:43],s88 offen offset:1024 sc1
s_waitcnt lgkmcnt(8)
v_mfma_f32_16x16x32_bf16 v[204:207],v[44:47],v[84:87],1.0
v_mfma_f32_16x16x32_bf16 v[196:199],v[44:47],v[80:83],1.0
s_add_u32 m0,s58,5120
s_add_u32 s53,s83,16384
buffer_load_dwordx4 v3,s[32:35],s53 offen lds
ds_read_b64_tr_b16 v[40:41],v7 offset:28672
ds_read_b64_tr_b16 v[42:43],v7 offset:29184
s_waitcnt lgkmcnt(8)
v_mfma_f32_16x16x32_bf16 v[208:211],v[64:67],v[80:83],1.0
ds_read_b64_tr_b16 v[44:45],v8 offset:28672
ds_read_b64_tr_b16 v[46:47],v8 offset:29184
v_mfma_f32_16x16x32_bf16 v[216:219],v[64:67],v[84:87],1.0
buffer_store_dwordx4 v[88:91],v23,s[40:43],s88 offen offset:2048 sc1
s_waitcnt lgkmcnt(8)
v_mfma_f32_16x16x32_bf16 v[220:223],v[68:71],v[84:87],1.0
v_mfma_f32_16x16x32_bf16 v[212:215],v[68:71],v[80:83],1.0
ds_read_b64_tr_b16 v[64:65],v5 offset:32768
ds_read_b64_tr_b16 v[66:67],v5 offset:33280
s_setprio 0
s_waitcnt lgkmcnt(8)
v_mfma_f32_16x16x32_bf16 v[192:195],v[72:75],v[88:91],v[192:195]
s_waitcnt vmcnt(16)
ds_read_b128 v[104:107],v9 offset:6144
ds_read_b128 v[108:111],v9 offset:7168
ds_read_b64_tr_b16 v[68:69],v6 offset:32768
ds_read_b64_tr_b16 v[70:71],v6 offset:33280
v_mfma_f32_16x16x32_bf16 v[200:203],v[72:75],v[92:95],v[200:203]
buffer_store_dwordx4 v[92:95],v23,s[40:43],s88 offen offset:3072 sc1
s_waitcnt lgkmcnt(10)
v_mfma_f32_16x16x32_bf16 v[204:207],v[76:79],v[92:95],v[204:207]
v_mfma_f32_16x16x32_bf16 v[196:199],v[76:79],v[88:91],v[196:199]
ds_read_b64_tr_b16 v[72:73],v7 offset:32768
ds_read_b64_tr_b16 v[74:75],v7 offset:33280
s_waitcnt lgkmcnt(10)
v_mfma_f32_16x16x32_bf16 v[208:211],v[40:43],v[88:91],v[208:211]
ds_read_b64_tr_b16 v[76:77],v8 offset:32768
ds_read_b64_tr_b16 v[78:79],v8 offset:33280
v_mfma_f32_16x16x32_bf16 v[216:219],v[40:43],v[92:95],v[216:219]
s_waitcnt lgkmcnt(10)
v_mfma_f32_16x16x32_bf16 v[220:223],v[44:47],v[92:95],v[220:223]
v_mfma_f32_16x16x32_bf16 v[212:215],v[44:47],v[88:91],v[212:215]
s_waitcnt vmcnt(14)
s_barrier
ds_read_b64_tr_b16 v[40:41],v5 offset:36864
ds_read_b64_tr_b16 v[42:43],v5 offset:37376
s_setprio 3
s_waitcnt lgkmcnt(10)
v_mfma_f32_16x16x32_bf16 v[24:27],v[64:67],v[96:99],v[24:27]
ds_read_b64_tr_b16 v[44:45],v6 offset:36864
ds_read_b64_tr_b16 v[46:47],v6 offset:37376
v_mfma_f32_16x16x32_bf16 v[32:35],v[64:67],v[100:103],v[32:35]
s_add_u32 m0,s60,81920
s_add_u32 s53,s75,128
buffer_load_dwordx4 v2,s[36:39],s53 offen lds
s_waitcnt lgkmcnt(8)
v_mfma_f32_16x16x32_bf16 v[36:39],v[68:71],v[100:103],v[36:39]
v_mfma_f32_16x16x32_bf16 v[28:31],v[68:71],v[96:99],v[28:31]
ds_read_b64_tr_b16 v[64:65],v7 offset:36864
ds_read_b64_tr_b16 v[66:67],v7 offset:37376
s_waitcnt lgkmcnt(8)
v_mfma_f32_16x16x32_bf16 v[48:51],v[72:75],v[96:99],v[48:51]
ds_read_b64_tr_b16 v[68:69],v8 offset:36864
ds_read_b64_tr_b16 v[70:71],v8 offset:37376
v_mfma_f32_16x16x32_bf16 v[56:59],v[72:75],v[100:103],v[56:59]
s_add_u32 m0,s58,6144
s_add_u32 s53,s83,64
buffer_load_dwordx4 v3,s[32:35],s53 offen lds
s_waitcnt lgkmcnt(8)
v_mfma_f32_16x16x32_bf16 v[60:63],v[76:79],v[100:103],v[60:63]
v_mfma_f32_16x16x32_bf16 v[52:55],v[76:79],v[96:99],v[52:55]
s_add_u32 m0,s58,7168
s_add_u32 s53,s83,16448
buffer_load_dwordx4 v3,s[32:35],s53 offen lds
ds_read_b64_tr_b16 v[72:73],v5 offset:40960
ds_read_b64_tr_b16 v[74:75],v5 offset:41472
s_waitcnt lgkmcnt(8)
v_mfma_f32_16x16x32_bf16 v[24:27],v[40:43],v[104:107],v[24:27]
ds_read_b64_tr_b16 v[76:77],v6 offset:40960
ds_read_b64_tr_b16 v[78:79],v6 offset:41472
v_mfma_f32_16x16x32_bf16 v[32:35],v[40:43],v[108:111],v[32:35]
s_waitcnt lgkmcnt(8)
v_mfma_f32_16x16x32_bf16 v[36:39],v[44:47],v[108:111],v[36:39]
v_mfma_f32_16x16x32_bf16 v[28:31],v[44:47],v[104:107],v[28:31]
ds_read_b64_tr_b16 v[40:41],v7 offset:40960
ds_read_b64_tr_b16 v[42:43],v7 offset:41472
s_waitcnt lgkmcnt(8)
v_mfma_f32_16x16x32_bf16 v[48:51],v[64:67],v[104:107],v[48:51]
s_add_u32 m0,s60,90112
s_add_u32 s53,s75,256
buffer_load_dwordx4 v2,s[36:39],s53 offen lds
ds_read_b64_tr_b16 v[44:45],v8 offset:40960
ds_read_b64_tr_b16 v[46:47],v8 offset:41472
v_mfma_f32_16x16x32_bf16 v[56:59],v[64:67],v[108:111],v[56:59]
s_waitcnt vmcnt(16)
ds_read_b128 v[112:115],v9 offset:0
ds_read_b128 v[116:119],v9 offset:1024
ds_read_b128 v[16:19],v21 offset:128
s_waitcnt lgkmcnt(11)
v_mfma_f32_16x16x32_bf16 v[60:63],v[68:71],v[108:111],v[60:63]
v_mfma_f32_16x16x32_bf16 v[52:55],v[68:71],v[104:107],v[52:55]
ds_read_b64_tr_b16 v[64:65],v5 offset:45056
ds_read_b64_tr_b16 v[66:67],v5 offset:45568
s_setprio 2
s_waitcnt lgkmcnt(11)
v_mfma_f32_16x16x32_bf16 v[128:131],v[72:75],v[96:99],v[128:131]
ds_read_b64_tr_b16 v[68:69],v6 offset:45056
ds_read_b64_tr_b16 v[70:71],v6 offset:45568
v_mfma_f32_16x16x32_bf16 v[136:139],v[72:75],v[100:103],v[136:139]
s_waitcnt lgkmcnt(11)
v_mfma_f32_16x16x32_bf16 v[140:143],v[76:79],v[100:103],v[140:143]
v_mfma_f32_16x16x32_bf16 v[132:135],v[76:79],v[96:99],v[132:135]
ds_read_b64_tr_b16 v[72:73],v7 offset:45056
ds_read_b64_tr_b16 v[74:75],v7 offset:45568
s_waitcnt lgkmcnt(11)
v_mfma_f32_16x16x32_bf16 v[144:147],v[40:43],v[96:99],v[144:147]
ds_read_b64_tr_b16 v[76:77],v8 offset:45056
ds_read_b64_tr_b16 v[78:79],v8 offset:45568
v_mfma_f32_16x16x32_bf16 v[152:155],v[40:43],v[100:103],v[152:155]
s_waitcnt lgkmcnt(8)
v_mfma_f32_16x16x32_bf16 v[224:227],v[16:19],v[96:99],v[224:227]
v_mfma_f32_16x16x32_bf16 v[156:159],v[44:47],v[100:103],v[156:159]
v_mfma_f32_16x16x32_bf16 v[148:151],v[44:47],v[96:99],v[148:151]
v_mfma_f32_16x16x32_bf16 v[228:231],v[16:19],v[100:103],v[228:231]
ds_read_b64_tr_b16 v[40:41],v5 offset:49152
ds_read_b64_tr_b16 v[42:43],v5 offset:49664
s_waitcnt lgkmcnt(8)
v_mfma_f32_16x16x32_bf16 v[128:131],v[64:67],v[104:107],v[128:131]
ds_read_b64_tr_b16 v[44:45],v6 offset:49152
ds_read_b64_tr_b16 v[46:47],v6 offset:49664
v_mfma_f32_16x16x32_bf16 v[136:139],v[64:67],v[108:111],v[136:139]
s_add_u32 m0,s58,0
s_add_u32 s53,s84,0
buffer_load_dwordx4 v3,s[32:35],s53 offen lds
s_waitcnt lgkmcnt(8)
v_mfma_f32_16x16x32_bf16 v[140:143],v[68:71],v[108:111],v[140:143]
v_mfma_f32_16x16x32_bf16 v[132:135],v[68:71],v[104:107],v[132:135]
s_add_u32 m0,s58,1024
s_add_u32 s53,s84,16384
buffer_load_dwordx4 v3,s[32:35],s53 offen lds
ds_read_b64_tr_b16 v[64:65],v7 offset:49152
ds_read_b64_tr_b16 v[66:67],v7 offset:49664
s_waitcnt lgkmcnt(8)
v_mfma_f32_16x16x32_bf16 v[144:147],v[72:75],v[104:107],v[144:147]
ds_read_b64_tr_b16 v[68:69],v8 offset:49152
ds_read_b64_tr_b16 v[70:71],v8 offset:49664
v_mfma_f32_16x16x32_bf16 v[152:155],v[72:75],v[108:111],v[152:155]
s_waitcnt lgkmcnt(8)
v_mfma_f32_16x16x32_bf16 v[156:159],v[76:79],v[108:111],v[156:159]
v_mfma_f32_16x16x32_bf16 v[148:151],v[76:79],v[104:107],v[148:151]
ds_read_b64_tr_b16 v[72:73],v5 offset:53248
ds_read_b64_tr_b16 v[74:75],v5 offset:53760
s_setprio 1
s_waitcnt lgkmcnt(8)
v_mfma_f32_16x16x32_bf16 v[160:163],v[40:43],v[96:99],v[160:163]
ds_read_b64_tr_b16 v[76:77],v6 offset:53248
ds_read_b64_tr_b16 v[78:79],v6 offset:53760
v_mfma_f32_16x16x32_bf16 v[168:171],v[40:43],v[100:103],v[168:171]
ds_read_b128 v[10:13],v21 offset:192
s_waitcnt lgkmcnt(9)
v_mfma_f32_16x16x32_bf16 v[172:175],v[44:47],v[100:103],v[172:175]
v_mfma_f32_16x16x32_bf16 v[164:167],v[44:47],v[96:99],v[164:167]
s_waitcnt vmcnt(15)
ds_read_b128 v[120:123],v9 offset:2048
ds_read_b128 v[124:127],v9 offset:3072
ds_read_b64_tr_b16 v[40:41],v7 offset:53248
ds_read_b64_tr_b16 v[42:43],v7 offset:53760
s_waitcnt lgkmcnt(11)
v_mfma_f32_16x16x32_bf16 v[176:179],v[64:67],v[96:99],v[176:179]
ds_read_b64_tr_b16 v[44:45],v8 offset:53248
ds_read_b64_tr_b16 v[46:47],v8 offset:53760
v_mfma_f32_16x16x32_bf16 v[184:187],v[64:67],v[100:103],v[184:187]
s_waitcnt lgkmcnt(11)
v_mfma_f32_16x16x32_bf16 v[188:191],v[68:71],v[100:103],v[188:191]
v_mfma_f32_16x16x32_bf16 v[180:183],v[68:71],v[96:99],v[180:183]
ds_read_b64_tr_b16 v[64:65],v5 offset:57344
ds_read_b64_tr_b16 v[66:67],v5 offset:57856
s_waitcnt lgkmcnt(11)
v_mfma_f32_16x16x32_bf16 v[160:163],v[72:75],v[104:107],v[160:163]
v_lshlrev_b32 v23,4,v1
s_add_u32 s88,s68,1
s_and_b32 s88,s88,7
s_lshl_b32 s88,s88,12
s_add_u32 s88,s88,s55
s_add_u32 s88,s88,41943040
ds_read_b64_tr_b16 v[68:69],v6 offset:57344
ds_read_b64_tr_b16 v[70:71],v6 offset:57856
v_mfma_f32_16x16x32_bf16 v[168:171],v[72:75],v[108:111],v[168:171]
s_waitcnt lgkmcnt(10)
v_mfma_f32_16x16x32_bf16 v[224:227],v[10:13],v[104:107],v[224:227]
v_mfma_f32_16x16x32_bf16 v[172:175],v[76:79],v[108:111],v[172:175]
v_mfma_f32_16x16x32_bf16 v[164:167],v[76:79],v[104:107],v[164:167]
v_mfma_f32_16x16x32_bf16 v[228:231],v[10:13],v[108:111],v[228:231]
ds_read_b64_tr_b16 v[72:73],v7 offset:57344
ds_read_b64_tr_b16 v[74:75],v7 offset:57856
s_waitcnt lgkmcnt(8)
v_mfma_f32_16x16x32_bf16 v[176:179],v[40:43],v[104:107],v[176:179]
ds_read_b64_tr_b16 v[76:77],v8 offset:57344
ds_read_b64_tr_b16 v[78:79],v8 offset:57856
v_mfma_f32_16x16x32_bf16 v[184:187],v[40:43],v[108:111],v[184:187]
buffer_store_dwordx4 v[96:99],v23,s[40:43],s88 offen offset:0 sc1
s_waitcnt lgkmcnt(8)
v_mfma_f32_16x16x32_bf16 v[188:191],v[44:47],v[108:111],v[188:191]
v_mfma_f32_16x16x32_bf16 v[180:183],v[44:47],v[104:107],v[180:183]
s_add_u32 m0,s58,2048
s_add_u32 s53,s84,64
buffer_load_dwordx4 v3,s[32:35],s53 offen lds
ds_read_b64_tr_b16 v[40:41],v5 offset:61440
ds_read_b64_tr_b16 v[42:43],v5 offset:61952
s_setprio 0
s_waitcnt lgkmcnt(8)
v_mfma_f32_16x16x32_bf16 v[192:195],v[64:67],v[96:99],v[192:195]
s_add_u32 m0,s58,3072
s_add_u32 s53,s84,16448
buffer_load_dwordx4 v3,s[32:35],s53 offen lds
ds_read_b64_tr_b16 v[44:45],v6 offset:61440
ds_read_b64_tr_b16 v[46:47],v6 offset:61952
v_mfma_f32_16x16x32_bf16 v[200:203],v[64:67],v[100:103],v[200:203]
buffer_store_dwordx4 v[100:103],v23,s[40:43],s88 offen offset:1024 sc1
s_waitcnt lgkmcnt(8)
v_mfma_f32_16x16x32_bf16 v[204:207],v[68:71],v[100:103],v[204:207]
v_mfma_f32_16x16x32_bf16 v[196:199],v[68:71],v[96:99],v[196:199]
ds_read_b64_tr_b16 v[64:65],v7 offset:61440
ds_read_b64_tr_b16 v[66:67],v7 offset:61952
s_waitcnt lgkmcnt(8)
v_mfma_f32_16x16x32_bf16 v[208:211],v[72:75],v[96:99],v[208:211]
ds_read_b64_tr_b16 v[68:69],v8 offset:61440
ds_read_b64_tr_b16 v[70:71],v8 offset:61952
v_mfma_f32_16x16x32_bf16 v[216:219],v[72:75],v[100:103],v[216:219]
buffer_store_dwordx4 v[104:107],v23,s[40:43],s88 offen offset:2048 sc1
s_waitcnt lgkmcnt(8)
v_mfma_f32_16x16x32_bf16 v[220:223],v[76:79],v[100:103],v[220:223]
v_mfma_f32_16x16x32_bf16 v[212:215],v[76:79],v[96:99],v[212:215]
s_waitcnt vmcnt(13)
ds_read_b128 v[240:243],v9 offset:4096
ds_read_b128 v[244:247],v9 offset:5120
v_add_u32 v5,0x10000,v5
ds_read_b64_tr_b16 v[72:73],v5 offset:0
ds_read_b64_tr_b16 v[74:75],v5 offset:512
s_waitcnt lgkmcnt(10)
v_mfma_f32_16x16x32_bf16 v[192:195],v[40:43],v[104:107],v[192:195]
v_add_u32 v6,0x10000,v6
ds_read_b64_tr_b16 v[76:77],v6 offset:0
ds_read_b64_tr_b16 v[78:79],v6 offset:512
v_mfma_f32_16x16x32_bf16 v[200:203],v[40:43],v[108:111],v[200:203]
buffer_store_dwordx4 v[108:111],v23,s[40:43],s88 offen offset:3072 sc1
s_waitcnt lgkmcnt(10)
v_mfma_f32_16x16x32_bf16 v[204:207],v[44:47],v[108:111],v[204:207]
v_mfma_f32_16x16x32_bf16 v[196:199],v[44:47],v[104:107],v[196:199]
v_add_u32 v7,0x10000,v7
ds_read_b64_tr_b16 v[40:41],v7 offset:0
ds_read_b64_tr_b16 v[42:43],v7 offset:512
s_waitcnt lgkmcnt(10)
v_mfma_f32_16x16x32_bf16 v[208:211],v[64:67],v[104:107],v[208:211]
v_add_u32 v8,0x10000,v8
ds_read_b64_tr_b16 v[44:45],v8 offset:0
ds_read_b64_tr_b16 v[46:47],v8 offset:512
v_mfma_f32_16x16x32_bf16 v[216:219],v[64:67],v[108:111],v[216:219]
s_waitcnt lgkmcnt(10)
v_mfma_f32_16x16x32_bf16 v[220:223],v[68:71],v[108:111],v[220:223]
v_mfma_f32_16x16x32_bf16 v[212:215],v[68:71],v[104:107],v[212:215]
s_barrier
ds_read_b64_tr_b16 v[64:65],v5 offset:4096
ds_read_b64_tr_b16 v[66:67],v5 offset:4608
s_setprio 3
s_waitcnt lgkmcnt(8)
v_mfma_f32_16x16x32_bf16 v[24:27],v[72:75],v[112:115],v[24:27]
ds_read_b64_tr_b16 v[68:69],v6 offset:4096
ds_read_b64_tr_b16 v[70:71],v6 offset:4608
v_mfma_f32_16x16x32_bf16 v[32:35],v[72:75],v[116:119],v[32:35]
s_add_u32 m0,s60,98304
s_add_u32 s53,s75,384
buffer_load_dwordx4 v2,s[36:39],s53 offen lds
s_waitcnt lgkmcnt(8)
v_mfma_f32_16x16x32_bf16 v[36:39],v[76:79],v[116:119],v[36:39]
v_mfma_f32_16x16x32_bf16 v[28:31],v[76:79],v[112:115],v[28:31]
s_add_u32 m0,s58,4096
s_add_u32 s53,s85,0
buffer_load_dwordx4 v3,s[32:35],s53 offen lds
ds_read_b64_tr_b16 v[72:73],v7 offset:4096
ds_read_b64_tr_b16 v[74:75],v7 offset:4608
s_waitcnt lgkmcnt(8)
v_mfma_f32_16x16x32_bf16 v[48:51],v[40:43],v[112:115],v[48:51]
s_add_u32 m0,s58,5120
s_add_u32 s53,s85,16384
buffer_load_dwordx4 v3,s[32:35],s53 offen lds
ds_read_b64_tr_b16 v[76:77],v8 offset:4096
ds_read_b64_tr_b16 v[78:79],v8 offset:4608
v_mfma_f32_16x16x32_bf16 v[56:59],v[40:43],v[116:119],v[56:59]
s_cmp_lg_u32 s50,0
s_cbranch_scc1 L_tag9
s_cmp_lg_u32 s101,0
s_cbranch_scc1 L_tag9
buffer_load_dword v14,off,s[92:95],0 sc1
L_tag9:
s_waitcnt lgkmcnt(8)
v_mfma_f32_16x16x32_bf16 v[60:63],v[44:47],v[116:119],v[60:63]
v_mfma_f32_16x16x32_bf16 v[52:55],v[44:47],v[112:115],v[52:55]
s_add_u32 m0,s60,106496
s_add_u32 s53,s76,0
buffer_load_dwordx4 v2,s[36:39],s53 offen lds
ds_read_b64_tr_b16 v[40:41],v5 offset:8192
ds_read_b64_tr_b16 v[42:43],v5 offset:8704
s_waitcnt lgkmcnt(8)
v_mfma_f32_16x16x32_bf16 v[24:27],v[64:67],v[120:123],v[24:27]
ds_read_b64_tr_b16 v[44:45],v6 offset:8192
ds_read_b64_tr_b16 v[46:47],v6 offset:8704
v_mfma_f32_16x16x32_bf16 v[32:35],v[64:67],v[124:127],v[32:35]
s_waitcnt lgkmcnt(8)
v_mfma_f32_16x16x32_bf16 v[36:39],v[68:71],v[124:127],v[36:39]
v_mfma_f32_16x16x32_bf16 v[28:31],v[68:71],v[120:123],v[28:31]
s_waitcnt vmcnt(13)
ds_read_b128 v[248:251],v9 offset:6144
ds_read_b128 v[252:255],v9 offset:7168
ds_read_b64_tr_b16 v[64:65],v7 offset:8192
ds_read_b64_tr_b16 v[66:67],v7 offset:8704
s_waitcnt lgkmcnt(10)
v_mfma_f32_16x16x32_bf16 v[48:51],v[72:75],v[120:123],v[48:51]
s_add_u32 m0,s60,114688
s_add_u32 s53,s77,0
buffer_load_dwordx4 v2,s[36:39],s53 offen lds
ds_read_b64_tr_b16 v[68:69],v8 offset:8192
ds_read_b64_tr_b16 v[70:71],v8 offset:8704
v_mfma_f32_16x16x32_bf16 v[56:59],v[72:75],v[124:127],v[56:59]
ds_read_b128 v[16:19],v21 offset:256
s_waitcnt lgkmcnt(11)
v_mfma_f32_16x16x32_bf16 v[60:63],v[76:79],v[124:127],v[60:63]
v_mfma_f32_16x16x32_bf16 v[52:55],v[76:79],v[120:123],v[52:55]
ds_read_b64_tr_b16 v[72:73],v5 offset:12288
ds_read_b64_tr_b16 v[74:75],v5 offset:12800
s_setprio 2
s_waitcnt lgkmcnt(11)
v_mfma_f32_16x16x32_bf16 v[128:131],v[40:43],v[112:115],v[128:131]
ds_read_b64_tr_b16 v[76:77],v6 offset:12288
ds_read_b64_tr_b16 v[78:79],v6 offset:12800
v_mfma_f32_16x16x32_bf16 v[136:139],v[40:43],v[116:119],v[136:139]
s_waitcnt lgkmcnt(11)
v_mfma_f32_16x16x32_bf16 v[140:143],v[44:47],v[116:119],v[140:143]
v_mfma_f32_16x16x32_bf16 v[132:135],v[44:47],v[112:115],v[132:135]
s_add_u32 m0,s60,122880
s_add_u32 s53,s78,0
buffer_load_dwordx4 v2,s[36:39],s53 offen lds
ds_read_b64_tr_b16 v[40:41],v7 offset:12288
ds_read_b64_tr_b16 v[42:43],v7 offset:12800
s_waitcnt lgkmcnt(9)
v_mfma_f32_16x16x32_bf16 v[144:147],v[64:67],v[112:115],v[144:147]
ds_read_b64_tr_b16 v[44:45],v8 offset:12288
ds_read_b64_tr_b16 v[46:47],v8 offset:12800
v_mfma_f32_16x16x32_bf16 v[152:155],v[64:67],v[116:119],v[152:155]
s_waitcnt lgkmcnt(8)
v_mfma_f32_16x16x32_bf16 v[224:227],v[16:19],v[112:115],v[224:227]
v_mfma_f32_16x16x32_bf16 v[156:159],v[68:71],v[116:119],v[156:159]
s_add_u32 m0,s58,6144
s_add_u32 s53,s85,64
buffer_load_dwordx4 v3,s[32:35],s53 offen lds
v_mfma_f32_16x16x32_bf16 v[148:151],v[68:71],v[112:115],v[148:151]
v_mfma_f32_16x16x32_bf16 v[228:231],v[16:19],v[116:119],v[228:231]
ds_read_b64_tr_b16 v[64:65],v5 offset:16384
ds_read_b64_tr_b16 v[66:67],v5 offset:16896
s_waitcnt lgkmcnt(8)
v_mfma_f32_16x16x32_bf16 v[128:131],v[72:75],v[120:123],v[128:131]
ds_read_b64_tr_b16 v[68:69],v6 offset:16384
ds_read_b64_tr_b16 v[70:71],v6 offset:16896
v_mfma_f32_16x16x32_bf16 v[136:139],v[72:75],v[124:127],v[136:139]
s_add_u32 m0,s58,7168
s_add_u32 s53,s85,16448
buffer_load_dwordx4 v3,s[32:35],s53 offen lds
s_waitcnt lgkmcnt(8)
v_mfma_f32_16x16x32_bf16 v[140:143],v[76:79],v[124:127],v[140:143]
v_mfma_f32_16x16x32_bf16 v[132:135],v[76:79],v[120:123],v[132:135]
ds_read_b64_tr_b16 v[72:73],v7 offset:16384
ds_read_b64_tr_b16 v[74:75],v7 offset:16896
s_waitcnt lgkmcnt(8)
v_mfma_f32_16x16x32_bf16 v[144:147],v[40:43],v[120:123],v[144:147]
ds_read_b64_tr_b16 v[76:77],v8 offset:16384
ds_read_b64_tr_b16 v[78:79],v8 offset:16896
v_mfma_f32_16x16x32_bf16 v[152:155],v[40:43],v[124:127],v[152:155]
s_waitcnt lgkmcnt(8)
v_mfma_f32_16x16x32_bf16 v[156:159],v[44:47],v[124:127],v[156:159]
v_mfma_f32_16x16x32_bf16 v[148:151],v[44:47],v[120:123],v[148:151]
ds_read_b64_tr_b16 v[40:41],v5 offset:20480
ds_read_b64_tr_b16 v[42:43],v5 offset:20992
s_setprio 1
s_waitcnt lgkmcnt(8)
v_mfma_f32_16x16x32_bf16 v[160:163],v[64:67],v[112:115],v[160:163]
s_waitcnt vmcnt(14)
ds_read_b128 v[80:83],v9 offset:0
ds_read_b128 v[84:87],v9 offset:1024
ds_read_b64_tr_b16 v[44:45],v6 offset:20480
ds_read_b64_tr_b16 v[46:47],v6 offset:20992
v_mfma_f32_16x16x32_bf16 v[168:171],v[64:67],v[116:119],v[168:171]
ds_read_b128 v[10:13],v21 offset:320
s_waitcnt lgkmcnt(11)
v_mfma_f32_16x16x32_bf16 v[172:175],v[68:71],v[116:119],v[172:175]
v_mfma_f32_16x16x32_bf16 v[164:167],v[68:71],v[112:115],v[164:167]
ds_read_b64_tr_b16 v[64:65],v7 offset:20480
ds_read_b64_tr_b16 v[66:67],v7 offset:20992
s_waitcnt lgkmcnt(11)
v_mfma_f32_16x16x32_bf16 v[176:179],v[72:75],v[112:115],v[176:179]
ds_read_b64_tr_b16 v[68:69],v8 offset:20480
ds_read_b64_tr_b16 v[70:71],v8 offset:20992
v_mfma_f32_16x16x32_bf16 v[184:187],v[72:75],v[116:119],v[184:187]
s_waitcnt lgkmcnt(11)
v_mfma_f32_16x16x32_bf16 v[188:191],v[76:79],v[116:119],v[188:191]
v_mfma_f32_16x16x32_bf16 v[180:183],v[76:79],v[112:115],v[180:183]
v_add_u32 v5,0xffff0000,v5
ds_read_b64_tr_b16 v[72:73],v5 offset:0
ds_read_b64_tr_b16 v[74:75],v5 offset:512
s_waitcnt lgkmcnt(11)
v_mfma_f32_16x16x32_bf16 v[160:163],v[40:43],v[120:123],v[160:163]
v_add_u32 v6,0xffff0000,v6
ds_read_b64_tr_b16 v[76:77],v6 offset:0
ds_read_b64_tr_b16 v[78:79],v6 offset:512
v_mfma_f32_16x16x32_bf16 v[168:171],v[40:43],v[124:127],v[168:171]
s_waitcnt lgkmcnt(8)
v_mfma_f32_16x16x32_bf16 v[224:227],v[10:13],v[120:123],v[224:227]
v_mfma_f32_16x16x32_bf16 v[172:175],v[44:47],v[124:127],v[172:175]
v_mfma_f32_16x16x32_bf16 v[164:167],v[44:47],v[120:123],v[164:167]
v_mfma_f32_16x16x32_bf16 v[228:231],v[10:13],v[124:127],v[228:231]
v_add_u32 v7,0xffff0000,v7
ds_read_b64_tr_b16 v[40:41],v7 offset:0
ds_read_b64_tr_b16 v[42:43],v7 offset:512
s_waitcnt lgkmcnt(8)
v_mfma_f32_16x16x32_bf16 v[176:179],v[64:67],v[120:123],v[176:179]
v_add_u32 v8,0xffff0000,v8
ds_read_b64_tr_b16 v[44:45],v8 offset:0
ds_read_b64_tr_b16 v[46:47],v8 offset:512
v_mfma_f32_16x16x32_bf16 v[184:187],v[64:67],v[124:127],v[184:187]
s_add_u32 m0,s58,0
s_add_u32 s53,s86,0
buffer_load_dwordx4 v3,s[32:35],s53 offen lds
s_waitcnt lgkmcnt(8)
v_mfma_f32_16x16x32_bf16 v[188:191],v[68:71],v[124:127],v[188:191]
v_mfma_f32_16x16x32_bf16 v[180:183],v[68:71],v[120:123],v[180:183]
s_add_u32 m0,s58,1024
s_add_u32 s53,s86,16384
buffer_load_dwordx4 v3,s[32:35],s53 offen lds
ds_read_b64_tr_b16 v[64:65],v5 offset:4096
ds_read_b64_tr_b16 v[66:67],v5 offset:4608
s_setprio 0
s_waitcnt lgkmcnt(8)
v_mfma_f32_16x16x32_bf16 v[192:195],v[72:75],v[112:115],v[192:195]
ds_read_b64_tr_b16 v[68:69],v6 offset:4096
ds_read_b64_tr_b16 v[70:71],v6 offset:4608
v_mfma_f32_16x16x32_bf16 v[200:203],v[72:75],v[116:119],v[200:203]
s_waitcnt lgkmcnt(8)
v_mfma_f32_16x16x32_bf16 v[204:207],v[76:79],v[116:119],v[204:207]
v_mfma_f32_16x16x32_bf16 v[196:199],v[76:79],v[112:115],v[196:199]
ds_read_b64_tr_b16 v[72:73],v7 offset:4096
ds_read_b64_tr_b16 v[74:75],v7 offset:4608
s_waitcnt lgkmcnt(8)
v_mfma_f32_16x16x32_bf16 v[208:211],v[40:43],v[112:115],v[208:211]
ds_read_b64_tr_b16 v[76:77],v8 offset:4096
ds_read_b64_tr_b16 v[78:79],v8 offset:4608
v_mfma_f32_16x16x32_bf16 v[216:219],v[40:43],v[116:119],v[216:219]
s_waitcnt vmcnt(13)
ds_read_b128 v[88:91],v9 offset:2048
ds_read_b128 v[92:95],v9 offset:3072
s_waitcnt lgkmcnt(10)
v_mfma_f32_16x16x32_bf16 v[220:223],v[44:47],v[116:119],v[220:223]
v_mfma_f32_16x16x32_bf16 v[212:215],v[44:47],v[112:115],v[212:215]
ds_read_b64_tr_b16 v[40:41],v5 offset:8192
ds_read_b64_tr_b16 v[42:43],v5 offset:8704
s_waitcnt lgkmcnt(10)
v_mfma_f32_16x16x32_bf16 v[192:195],v[64:67],v[120:123],v[192:195]
ds_read_b64_tr_b16 v[44:45],v6 offset:8192
ds_read_b64_tr_b16 v[46:47],v6 offset:8704
v_mfma_f32_16x16x32_bf16 v[200:203],v[64:67],v[124:127],v[200:203]
s_waitcnt lgkmcnt(10)
v_mfma_f32_16x16x32_bf16 v[204:207],v[68:71],v[124:127],v[204:207]
v_mfma_f32_16x16x32_bf16 v[196:199],v[68:71],v[120:123],v[196:199]
ds_read_b64_tr_b16 v[64:65],v7 offset:8192
ds_read_b64_tr_b16 v[66:67],v7 offset:8704
s_waitcnt lgkmcnt(10)
v_mfma_f32_16x16x32_bf16 v[208:211],v[72:75],v[120:123],v[208:211]
ds_read_b64_tr_b16 v[68:69],v8 offset:8192
ds_read_b64_tr_b16 v[70:71],v8 offset:8704
v_mfma_f32_16x16x32_bf16 v[216:219],v[72:75],v[124:127],v[216:219]
s_waitcnt lgkmcnt(10)
v_mfma_f32_16x16x32_bf16 v[220:223],v[76:79],v[124:127],v[220:223]
v_mfma_f32_16x16x32_bf16 v[212:215],v[76:79],v[120:123],v[212:215]
s_waitcnt vmcnt(6)
s_barrier
ds_read_b64_tr_b16 v[72:73],v5 offset:12288
ds_read_b64_tr_b16 v[74:75],v5 offset:12800
s_setprio 3
s_waitcnt lgkmcnt(8)
v_mfma_f32_16x16x32_bf16 v[24:27],v[40:43],v[240:243],v[24:27]
s_add_u32 m0,s60,131072
s_add_u32 s53,s79,0
buffer_load_dwordx4 v2,s[36:39],s53 offen lds
ds_read_b64_tr_b16 v[76:77],v6 offset:12288
ds_read_b64_tr_b16 v[78:79],v6 offset:12800
v_mfma_f32_16x16x32_bf16 v[32:35],v[40:43],v[244:247],v[32:35]
s_add_u32 m0,s58,2048
s_add_u32 s53,s86,64
buffer_load_dwordx4 v3,s[32:35],s53 offen lds
s_waitcnt lgkmcnt(8)
v_mfma_f32_16x16x32_bf16 v[36:39],v[44:47],v[244:247],v[36:39]
v_mfma_f32_16x16x32_bf16 v[28:31],v[44:47],v[240:243],v[28:31]
s_add_u32 m0,s58,3072
s_add_u32 s53,s86,16448
buffer_load_dwordx4 v3,s[32:35],s53 offen lds
ds_read_b64_tr_b16 v[40:41],v7 offset:12288
ds_read_b64_tr_b16 v[42:43],v7 offset:12800
s_waitcnt lgkmcnt(8)
v_mfma_f32_16x16x32_bf16 v[48:51],v[64:67],v[240:243],v[48:51]
ds_read_b64_tr_b16 v[44:45],v8 offset:12288
ds_read_b64_tr_b16 v[46:47],v8 offset:12800
v_mfma_f32_16x16x32_bf16 v[56:59],v[64:67],v[244:247],v[56:59]
s_cmp_lg_u32 s50,0
s_cbranch_scc1 L_tag10
s_cmp_lg_u32 s101,0
s_cbranch_scc1 L_tag10
s_waitcnt vmcnt(10)
v_readfirstlane_b32 s96,v14
s_cmp_lg_u32 s96,0
s_cbranch_scc1 L_tag10
s_call_b64 s[66:67],L_tag_slow
L_tag10:
s_waitcnt lgkmcnt(8)
v_mfma_f32_16x16x32_bf16 v[60:63],v[68:71],v[244:247],v[60:63]
s_add_u32 m0,s60,139264
s_add_u32 s53,s76,128
buffer_load_dwordx4 v2,s[36:39],s53 offen lds
v_mfma_f32_16x16x32_bf16 v[52:55],v[68:71],v[240:243],v[52:55]
s_cmp_lg_u32 s50,0
s_cbranch_scc1 L_sig1
s_and_b32 s88,s3,7
s_lshl_b32 s88,s88,2
s_bfe_u32 s89,s3,0x20003
s_add_u32 s88,s88,s89
v_lshlrev_b32 v23,8,v1
v_mov_b32 v14,s96
s_lshl_b32 s88,s88,5
s_add_u32 s88,s88,101786816
s_mov_b64 exec,0xff
s_lshr_b32 s89,s3,5
s_lshl_b32 s89,s89,2
s_add_u32 s88,s88,s89
buffer_store_dword v14,v23,s[40:43],s88 offen sc1
s_mov_b64 exec,-1
L_sig1:
ds_read_b64_tr_b16 v[64:65],v5 offset:16384
ds_read_b64_tr_b16 v[66:67],v5 offset:16896
s_waitcnt lgkmcnt(8)
v_mfma_f32_16x16x32_bf16 v[24:27],v[72:75],v[248:251],v[24:27]
ds_read_b64_tr_b16 v[68:69],v6 offset:16384
ds_read_b64_tr_b16 v[70:71],v6 offset:16896
v_mfma_f32_16x16x32_bf16 v[32:35],v[72:75],v[252:255],v[32:35]
s_waitcnt lgkmcnt(8)
v_mfma_f32_16x16x32_bf16 v[36:39],v[76:79],v[252:255],v[36:39]
v_mfma_f32_16x16x32_bf16 v[28:31],v[76:79],v[248:251],v[28:31]
ds_read_b128 v[96:99],v9 offset:4096
ds_read_b128 v[100:103],v9 offset:5120
ds_read_b64_tr_b16 v[72:73],v7 offset:16384
ds_read_b64_tr_b16 v[74:75],v7 offset:16896
s_waitcnt lgkmcnt(10)
v_mfma_f32_16x16x32_bf16 v[48:51],v[40:43],v[248:251],v[48:51]
s_add_u32 m0,s60,147456
s_add_u32 s53,s77,128
buffer_load_dwordx4 v2,s[36:39],s53 offen lds
ds_read_b64_tr_b16 v[76:77],v8 offset:16384
ds_read_b64_tr_b16 v[78:79],v8 offset:16896
v_mfma_f32_16x16x32_bf16 v[56:59],v[40:43],v[252:255],v[56:59]
ds_read_b128 v[16:19],v21 offset:384
s_waitcnt lgkmcnt(11)
v_mfma_f32_16x16x32_bf16 v[60:63],v[44:47],v[252:255],v[60:63]
v_mfma_f32_16x16x32_bf16 v[52:55],v[44:47],v[248:251],v[52:55]
ds_read_b64_tr_b16 v[40:41],v5 offset:20480
ds_read_b64_tr_b16 v[42:43],v5 offset:20992
s_setprio 2
s_waitcnt lgkmcnt(11)
v_mfma_f32_16x16x32_bf16 v[128:131],v[64:67],v[240:243],v[128:131]
ds_read_b64_tr_b16 v[44:45],v6 offset:20480
ds_read_b64_tr_b16 v[46:47],v6 offset:20992
v_mfma_f32_16x16x32_bf16 v[136:139],v[64:67],v[244:247],v[136:139]
s_waitcnt lgkmcnt(11)
v_mfma_f32_16x16x32_bf16 v[140:143],v[68:71],v[244:247],v[140:143]
v_mfma_f32_16x16x32_bf16 v[132:135],v[68:71],v[240:243],v[132:135]
s_add_u32 m0,s60,65536
s_add_u32 s53,s78,128
buffer_load_dwordx4 v2,s[36:39],s53 offen lds
ds_read_b64_tr_b16 v[64:65],v7 offset:20480
ds_read_b64_tr_b16 v[66:67],v7 offset:20992
s_waitcnt lgkmcnt(9)
v_mfma_f32_16x16x32_bf16 v[144:147],v[72:75],v[240:243],v[144:147]
ds_read_b64_tr_b16 v[68:69],v8 offset:20480
ds_read_b64_tr_b16 v[70:71],v8 offset:20992
v_mfma_f32_16x16x32_bf16 v[152:155],v[72:75],v[244:247],v[152:155]
s_waitcnt lgkmcnt(8)
v_mfma_f32_16x16x32_bf16 v[224:227],v[16:19],v[240:243],v[224:227]
v_mfma_f32_16x16x32_bf16 v[156:159],v[76:79],v[244:247],v[156:159]
s_add_u32 m0,s58,4096
s_add_u32 s53,s87,0
buffer_load_dwordx4 v3,s[32:35],s53 offen lds
v_mfma_f32_16x16x32_bf16 v[148:151],v[76:79],v[240:243],v[148:151]
v_mfma_f32_16x16x32_bf16 v[228:231],v[16:19],v[244:247],v[228:231]
ds_read_b64_tr_b16 v[72:73],v5 offset:24576
ds_read_b64_tr_b16 v[74:75],v5 offset:25088
s_waitcnt lgkmcnt(8)
v_mfma_f32_16x16x32_bf16 v[128:131],v[40:43],v[248:251],v[128:131]
ds_read_b64_tr_b16 v[76:77],v6 offset:24576
ds_read_b64_tr_b16 v[78:79],v6 offset:25088
v_mfma_f32_16x16x32_bf16 v[136:139],v[40:43],v[252:255],v[136:139]
s_add_u32 m0,s58,5120
s_add_u32 s53,s87,16384
buffer_load_dwordx4 v3,s[32:35],s53 offen lds
s_waitcnt lgkmcnt(8)
v_mfma_f32_16x16x32_bf16 v[140:143],v[44:47],v[252:255],v[140:143]
v_mfma_f32_16x16x32_bf16 v[132:135],v[44:47],v[248:251],v[132:135]
ds_read_b64_tr_b16 v[40:41],v7 offset:24576
ds_read_b64_tr_b16 v[42:43],v7 offset:25088
s_waitcnt lgkmcnt(8)
v_mfma_f32_16x16x32_bf16 v[144:147],v[64:67],v[248:251],v[144:147]
ds_read_b64_tr_b16 v[44:45],v8 offset:24576
ds_read_b64_tr_b16 v[46:47],v8 offset:25088
v_mfma_f32_16x16x32_bf16 v[152:155],v[64:67],v[252:255],v[152:155]
s_waitcnt lgkmcnt(8)
v_mfma_f32_16x16x32_bf16 v[156:159],v[68:71],v[252:255],v[156:159]
v_mfma_f32_16x16x32_bf16 v[148:151],v[68:71],v[248:251],v[148:151]
s_waitcnt vmcnt(10)
ds_read_b128 v[104:107],v9 offset:6144
ds_read_b128 v[108:111],v9 offset:7168
ds_read_b64_tr_b16 v[64:65],v5 offset:28672
ds_read_b64_tr_b16 v[66:67],v5 offset:29184
s_setprio 1
s_waitcnt lgkmcnt(10)
v_mfma_f32_16x16x32_bf16 v[160:163],v[72:75],v[240:243],v[160:163]
ds_read_b64_tr_b16 v[68:69],v6 offset:28672
ds_read_b64_tr_b16 v[70:71],v6 offset:29184
v_mfma_f32_16x16x32_bf16 v[168:171],v[72:75],v[244:247],v[168:171]
ds_read_b128 v[10:13],v21 offset:448
s_waitcnt lgkmcnt(11)
v_mfma_f32_16x16x32_bf16 v[172:175],v[76:79],v[244:247],v[172:175]
v_mfma_f32_16x16x32_bf16 v[164:167],v[76:79],v[240:243],v[164:167]
ds_read_b64_tr_b16 v[72:73],v7 offset:28672
ds_read_b64_tr_b16 v[74:75],v7 offset:29184
s_waitcnt lgkmcnt(11)
v_mfma_f32_16x16x32_bf16 v[176:179],v[40:43],v[240:243],v[176:179]
ds_read_b64_tr_b16 v[76:77],v8 offset:28672
ds_read_b64_tr_b16 v[78:79],v8 offset:29184
v_mfma_f32_16x16x32_bf16 v[184:187],v[40:43],v[244:247],v[184:187]
s_waitcnt lgkmcnt(11)
v_mfma_f32_16x16x32_bf16 v[188:191],v[44:47],v[244:247],v[188:191]
v_mfma_f32_16x16x32_bf16 v[180:183],v[44:47],v[240:243],v[180:183]
ds_read_b64_tr_b16 v[40:41],v5 offset:32768
ds_read_b64_tr_b16 v[42:43],v5 offset:33280
s_waitcnt lgkmcnt(9)
v_mfma_f32_16x16x32_bf16 v[160:163],v[64:67],v[248:251],v[160:163]
ds_read_b64_tr_b16 v[44:45],v6 offset:32768
ds_read_b64_tr_b16 v[46:47],v6 offset:33280
v_mfma_f32_16x16x32_bf16 v[168:171],v[64:67],v[252:255],v[168:171]
s_waitcnt lgkmcnt(8)
v_mfma_f32_16x16x32_bf16 v[224:227],v[10:13],v[248:251],v[224:227]
v_mfma_f32_16x16x32_bf16 v[172:175],v[68:71],v[252:255],v[172:175]
s_add_u32 m0,s58,6144
s_add_u32 s53,s87,64
buffer_load_dwordx4 v3,s[32:35],s53 offen lds
v_mfma_f32_16x16x32_bf16 v[164:167],v[68:71],v[248:251],v[164:167]
v_mfma_f32_16x16x32_bf16 v[228:231],v[10:13],v[252:255],v[228:231]
ds_read_b64_tr_b16 v[64:65],v7 offset:32768
ds_read_b64_tr_b16 v[66:67],v7 offset:33280
s_waitcnt lgkmcnt(8)
v_mfma_f32_16x16x32_bf16 v[176:179],v[72:75],v[248:251],v[176:179]
s_add_u32 m0,s58,7168
s_add_u32 s53,s87,16448
buffer_load_dwordx4 v3,s[32:35],s53 offen lds
ds_read_b64_tr_b16 v[68:69],v8 offset:32768
ds_read_b64_tr_b16 v[70:71],v8 offset:33280
v_mfma_f32_16x16x32_bf16 v[184:187],v[72:75],v[252:255],v[184:187]
s_mov_b64 s[44:45],s[8:9]
s_mov_b32 s46,4194304
v_and_b32 v22,7,v1
v_lshlrev_b32 v22,13,v22
v_bfe_u32 v23,v1,3,1
v_lshl_add_u32 v22,v23,7,v22
s_waitcnt lgkmcnt(8)
v_mfma_f32_16x16x32_bf16 v[188:191],v[76:79],v[252:255],v[188:191]
v_mfma_f32_16x16x32_bf16 v[180:183],v[76:79],v[248:251],v[180:183]
s_and_b32 s88,s2,7
s_lshl_b32 s88,s88,2
s_bfe_u32 s89,s2,0x20003
s_add_u32 s88,s88,s89
s_lshl_b32 s88,s88,8
s_lshr_b32 s89,s2,5
s_lshl_b32 s89,s89,3
s_add_u32 s89,s89,s50
s_lshl_b32 s89,s89,16
s_add_u32 s88,s88,s89
buffer_load_dword v22,v22,s[44:47],s88 offen
ds_read_b64_tr_b16 v[72:73],v5 offset:36864
ds_read_b64_tr_b16 v[74:75],v5 offset:37376
s_setprio 0
s_waitcnt lgkmcnt(8)
v_mfma_f32_16x16x32_bf16 v[192:195],v[40:43],v[240:243],v[192:195]
ds_read_b64_tr_b16 v[76:77],v6 offset:36864
ds_read_b64_tr_b16 v[78:79],v6 offset:37376
v_mfma_f32_16x16x32_bf16 v[200:203],v[40:43],v[244:247],v[200:203]
s_waitcnt lgkmcnt(8)
v_mfma_f32_16x16x32_bf16 v[204:207],v[44:47],v[244:247],v[204:207]
v_mfma_f32_16x16x32_bf16 v[196:199],v[44:47],v[240:243],v[196:199]
s_waitcnt vmcnt(11)
ds_read_b128 v[112:115],v9 offset:0
ds_read_b128 v[116:119],v9 offset:1024
ds_read_b64_tr_b16 v[40:41],v7 offset:36864
ds_read_b64_tr_b16 v[42:43],v7 offset:37376
s_waitcnt lgkmcnt(10)
v_mfma_f32_16x16x32_bf16 v[208:211],v[64:67],v[240:243],v[208:211]
ds_read_b64_tr_b16 v[44:45],v8 offset:36864
ds_read_b64_tr_b16 v[46:47],v8 offset:37376
v_mfma_f32_16x16x32_bf16 v[216:219],v[64:67],v[244:247],v[216:219]
s_waitcnt lgkmcnt(10)
v_mfma_f32_16x16x32_bf16 v[220:223],v[68:71],v[244:247],v[220:223]
v_mfma_f32_16x16x32_bf16 v[212:215],v[68:71],v[240:243],v[212:215]
ds_read_b64_tr_b16 v[64:65],v5 offset:40960
ds_read_b64_tr_b16 v[66:67],v5 offset:41472
s_waitcnt lgkmcnt(10)
v_mfma_f32_16x16x32_bf16 v[192:195],v[72:75],v[248:251],v[192:195]
ds_read_b64_tr_b16 v[68:69],v6 offset:40960
ds_read_b64_tr_b16 v[70:71],v6 offset:41472
v_mfma_f32_16x16x32_bf16 v[200:203],v[72:75],v[252:255],v[200:203]
s_waitcnt lgkmcnt(10)
v_mfma_f32_16x16x32_bf16 v[204:207],v[76:79],v[252:255],v[204:207]
v_mfma_f32_16x16x32_bf16 v[196:199],v[76:79],v[248:251],v[196:199]
ds_read_b64_tr_b16 v[72:73],v7 offset:40960
ds_read_b64_tr_b16 v[74:75],v7 offset:41472
s_waitcnt lgkmcnt(8)
v_mfma_f32_16x16x32_bf16 v[208:211],v[40:43],v[248:251],v[208:211]
ds_read_b64_tr_b16 v[76:77],v8 offset:40960
ds_read_b64_tr_b16 v[78:79],v8 offset:41472
v_mfma_f32_16x16x32_bf16 v[216:219],v[40:43],v[252:255],v[216:219]
s_waitcnt lgkmcnt(8)
v_mfma_f32_16x16x32_bf16 v[220:223],v[44:47],v[252:255],v[220:223]
v_mfma_f32_16x16x32_bf16 v[212:215],v[44:47],v[248:251],v[212:215]
s_waitcnt vmcnt(7)
s_barrier
ds_read_b64_tr_b16 v[40:41],v5 offset:45056
ds_read_b64_tr_b16 v[42:43],v5 offset:45568
s_setprio 3
s_waitcnt lgkmcnt(8)
v_mfma_f32_16x16x32_bf16 v[24:27],v[64:67],v[80:83],v[24:27]
ds_read_b64_tr_b16 v[44:45],v6 offset:45056
ds_read_b64_tr_b16 v[46:47],v6 offset:45568
v_mfma_f32_16x16x32_bf16 v[32:35],v[64:67],v[84:87],v[32:35]
s_add_u32 m0,s60,73728
s_add_u32 s53,s79,128
buffer_load_dwordx4 v2,s[36:39],s53 offen lds
s_waitcnt lgkmcnt(8)
v_mfma_f32_16x16x32_bf16 v[36:39],v[68:71],v[84:87],v[36:39]
v_mfma_f32_16x16x32_bf16 v[28:31],v[68:71],v[80:83],v[28:31]
ds_read_b64_tr_b16 v[64:65],v7 offset:45056
ds_read_b64_tr_b16 v[66:67],v7 offset:45568
s_waitcnt lgkmcnt(8)
v_mfma_f32_16x16x32_bf16 v[48:51],v[72:75],v[80:83],v[48:51]
ds_read_b64_tr_b16 v[68:69],v8 offset:45056
ds_read_b64_tr_b16 v[70:71],v8 offset:45568
v_mfma_f32_16x16x32_bf16 v[56:59],v[72:75],v[84:87],v[56:59]
s_waitcnt lgkmcnt(8)
v_mfma_f32_16x16x32_bf16 v[60:63],v[76:79],v[84:87],v[60:63]
v_mfma_f32_16x16x32_bf16 v[52:55],v[76:79],v[80:83],v[52:55]
s_add_u32 m0,s60,81920
s_add_u32 s53,s76,256
buffer_load_dwordx4 v2,s[36:39],s53 offen lds
ds_read_b64_tr_b16 v[72:73],v5 offset:49152
ds_read_b64_tr_b16 v[74:75],v5 offset:49664
s_waitcnt lgkmcnt(8)
v_mfma_f32_16x16x32_bf16 v[24:27],v[40:43],v[88:91],v[24:27]
ds_read_b64_tr_b16 v[76:77],v6 offset:49152
ds_read_b64_tr_b16 v[78:79],v6 offset:49664
v_mfma_f32_16x16x32_bf16 v[32:35],v[40:43],v[92:95],v[32:35]
ds_read_b128 v[120:123],v9 offset:2048
ds_read_b128 v[124:127],v9 offset:3072
s_waitcnt lgkmcnt(10)
v_mfma_f32_16x16x32_bf16 v[36:39],v[44:47],v[92:95],v[36:39]
v_mfma_f32_16x16x32_bf16 v[28:31],v[44:47],v[88:91],v[28:31]
ds_read_b64_tr_b16 v[40:41],v7 offset:49152
ds_read_b64_tr_b16 v[42:43],v7 offset:49664
s_waitcnt lgkmcnt(10)
v_mfma_f32_16x16x32_bf16 v[48:51],v[64:67],v[88:91],v[48:51]
ds_read_b64_tr_b16 v[44:45],v8 offset:49152
ds_read_b64_tr_b16 v[46:47],v8 offset:49664
v_mfma_f32_16x16x32_bf16 v[56:59],v[64:67],v[92:95],v[56:59]
s_add_u32 m0,s60,90112
s_add_u32 s53,s77,256
buffer_load_dwordx4 v2,s[36:39],s53 offen lds
s_waitcnt lgkmcnt(10)
v_mfma_f32_16x16x32_bf16 v[60:63],v[68:71],v[92:95],v[60:63]
v_mfma_f32_16x16x32_bf16 v[52:55],v[68:71],v[88:91],v[52:55]
ds_read_b64_tr_b16 v[64:65],v5 offset:53248
ds_read_b64_tr_b16 v[66:67],v5 offset:53760
s_setprio 2
s_waitcnt lgkmcnt(10)
v_mfma_f32_16x16x32_bf16 v[24:27],v[72:75],v[96:99],v[24:27]
ds_read_b64_tr_b16 v[68:69],v6 offset:53248
ds_read_b64_tr_b16 v[70:71],v6 offset:53760
v_mfma_f32_16x16x32_bf16 v[32:35],v[72:75],v[100:103],v[32:35]
ds_read_b128 v[16:19],v21 offset:512
s_waitcnt lgkmcnt(11)
v_mfma_f32_16x16x32_bf16 v[36:39],v[76:79],v[100:103],v[36:39]
v_mfma_f32_16x16x32_bf16 v[28:31],v[76:79],v[96:99],v[28:31]
s_add_u32 m0,s60,98304
s_add_u32 s53,s78,256
buffer_load_dwordx4 v2,s[36:39],s53 offen lds
ds_read_b64_tr_b16 v[72:73],v7 offset:53248
ds_read_b64_tr_b16 v[74:75],v7 offset:53760
s_waitcnt lgkmcnt(9)
v_mfma_f32_16x16x32_bf16 v[48:51],v[40:43],v[96:99],v[48:51]
ds_read_b64_tr_b16 v[76:77],v8 offset:53248
ds_read_b64_tr_b16 v[78:79],v8 offset:53760
v_mfma_f32_16x16x32_bf16 v[56:59],v[40:43],v[100:103],v[56:59]
s_waitcnt lgkmcnt(9)
v_mfma_f32_16x16x32_bf16 v[60:63],v[44:47],v[100:103],v[60:63]
v_mfma_f32_16x16x32_bf16 v[52:55],v[44:47],v[96:99],v[52:55]
ds_read_b64_tr_b16 v[40:41],v5 offset:57344
ds_read_b64_tr_b16 v[42:43],v5 offset:57856
s_waitcnt lgkmcnt(9)
v_mfma_f32_16x16x32_bf16 v[24:27],v[64:67],v[104:107],v[24:27]
ds_read_b64_tr_b16 v[44:45],v6 offset:57344
ds_read_b64_tr_b16 v[46:47],v6 offset:57856
v_mfma_f32_16x16x32_bf16 v[32:35],v[64:67],v[108:111],v[32:35]
s_waitcnt lgkmcnt(8)
v_mfma_f32_16x16x32_bf16 v[224:227],v[16:19],v[80:83],v[224:227]
v_mfma_f32_16x16x32_bf16 v[36:39],v[68:71],v[108:111],v[36:39]
v_mfma_f32_16x16x32_bf16 v[28:31],v[68:71],v[104:107],v[28:31]
v_mfma_f32_16x16x32_bf16 v[228:231],v[16:19],v[84:87],v[228:231]
ds_read_b64_tr_b16 v[64:65],v7 offset:57344
ds_read_b64_tr_b16 v[66:67],v7 offset:57856
s_waitcnt lgkmcnt(8)
v_mfma_f32_16x16x32_bf16 v[48:51],v[72:75],v[104:107],v[48:51]
s_waitcnt vmcnt(7)
ds_read_b128 v[240:243],v9 offset:4096
ds_read_b128 v[244:247],v9 offset:5120
ds_read_b64_tr_b16 v[68:69],v8 offset:57344
ds_read_b64_tr_b16 v[70:71],v8 offset:57856
v_mfma_f32_16x16x32_bf16 v[56:59],v[72:75],v[108:111],v[56:59]
ds_read_b128 v[10:13],v21 offset:576
s_waitcnt lgkmcnt(11)
v_mfma_f32_16x16x32_bf16 v[60:63],v[76:79],v[108:111],v[60:63]
v_mfma_f32_16x16x32_bf16 v[52:55],v[76:79],v[104:107],v[52:55]
ds_read_b64_tr_b16 v[72:73],v5 offset:61440
ds_read_b64_tr_b16 v[74:75],v5 offset:61952
s_setprio 1
s_waitcnt lgkmcnt(11)
v_mfma_f32_16x16x32_bf16 v[24:27],v[40:43],v[112:115],v[24:27]
ds_read_b64_tr_b16 v[76:77],v6 offset:61440
ds_read_b64_tr_b16 v[78:79],v6 offset:61952
v_mfma_f32_16x16x32_bf16 v[32:35],v[40:43],v[116:119],v[32:35]
s_waitcnt lgkmcnt(11)
v_mfma_f32_16x16x32_bf16 v[36:39],v[44:47],v[116:119],v[36:39]
v_mfma_f32_16x16x32_bf16 v[28:31],v[44:47],v[112:115],v[28:31]
ds_read_b64_tr_b16 v[40:41],v7 offset:61440
ds_read_b64_tr_b16 v[42:43],v7 offset:61952
s_waitcnt lgkmcnt(11)
v_mfma_f32_16x16x32_bf16 v[48:51],v[64:67],v[112:115],v[48:51]
ds_read_b64_tr_b16 v[44:45],v8 offset:61440
ds_read_b64_tr_b16 v[46:47],v8 offset:61952
v_mfma_f32_16x16x32_bf16 v[56:59],v[64:67],v[116:119],v[56:59]
s_waitcnt lgkmcnt(8)
v_mfma_f32_16x16x32_bf16 v[224:227],v[10:13],v[88:91],v[224:227]
v_mfma_f32_16x16x32_bf16 v[60:63],v[68:71],v[116:119],v[60:63]
v_mfma_f32_16x16x32_bf16 v[52:55],v[68:71],v[112:115],v[52:55]
v_mfma_f32_16x16x32_bf16 v[228:231],v[10:13],v[92:95],v[228:231]
v_add_u32 v5,0x10000,v5
ds_read_b64_tr_b16 v[64:65],v5 offset:0
ds_read_b64_tr_b16 v[66:67],v5 offset:512
s_waitcnt lgkmcnt(8)
v_mfma_f32_16x16x32_bf16 v[24:27],v[72:75],v[120:123],v[24:27]
v_add_u32 v6,0x10000,v6
ds_read_b64_tr_b16 v[68:69],v6 offset:0
ds_read_b64_tr_b16 v[70:71],v6 offset:512
v_mfma_f32_16x16x32_bf16 v[32:35],v[72:75],v[124:127],v[32:35]
ds_read_b128 v[16:19],v21 offset:640
s_waitcnt lgkmcnt(9)
v_mfma_f32_16x16x32_bf16 v[36:39],v[76:79],v[124:127],v[36:39]
v_mfma_f32_16x16x32_bf16 v[28:31],v[76:79],v[120:123],v[28:31]
v_add_u32 v7,0x10000,v7
ds_read_b64_tr_b16 v[72:73],v7 offset:0
ds_read_b64_tr_b16 v[74:75],v7 offset:512
s_waitcnt lgkmcnt(9)
v_mfma_f32_16x16x32_bf16 v[48:51],v[40:43],v[120:123],v[48:51]
v_add_u32 v8,0x10000,v8
ds_read_b64_tr_b16 v[76:77],v8 offset:0
ds_read_b64_tr_b16 v[78:79],v8 offset:512
v_mfma_f32_16x16x32_bf16 v[56:59],v[40:43],v[124:127],v[56:59]
s_waitcnt lgkmcnt(9)
v_mfma_f32_16x16x32_bf16 v[60:63],v[44:47],v[124:127],v[60:63]
v_mfma_f32_16x16x32_bf16 v[52:55],v[44:47],v[120:123],v[52:55]
ds_read_b64_tr_b16 v[40:41],v5 offset:4096
ds_read_b64_tr_b16 v[42:43],v5 offset:4608
s_setprio 0
s_waitcnt lgkmcnt(9)
v_mfma_f32_16x16x32_bf16 v[24:27],v[64:67],v[240:243],v[24:27]
ds_read_b64_tr_b16 v[44:45],v6 offset:4096
ds_read_b64_tr_b16 v[46:47],v6 offset:4608
v_mfma_f32_16x16x32_bf16 v[32:35],v[64:67],v[244:247],v[32:35]
s_waitcnt lgkmcnt(8)
v_mfma_f32_16x16x32_bf16 v[224:227],v[16:19],v[96:99],v[224:227]
v_mfma_f32_16x16x32_bf16 v[36:39],v[68:71],v[244:247],v[36:39]
s_waitcnt vmcnt(5)
ds_read_b128 v[248:251],v9 offset:6144
ds_read_b128 v[252:255],v9 offset:7168
v_mfma_f32_16x16x32_bf16 v[28:31],v[68:71],v[240:243],v[28:31]
v_mfma_f32_16x16x32_bf16 v[228:231],v[16:19],v[100:103],v[228:231]
ds_read_b64_tr_b16 v[64:65],v7 offset:4096
ds_read_b64_tr_b16 v[66:67],v7 offset:4608
s_waitcnt lgkmcnt(10)
v_mfma_f32_16x16x32_bf16 v[48:51],v[72:75],v[240:243],v[48:51]
ds_read_b64_tr_b16 v[68:69],v8 offset:4096
ds_read_b64_tr_b16 v[70:71],v8 offset:4608
v_mfma_f32_16x16x32_bf16 v[56:59],v[72:75],v[244:247],v[56:59]
ds_read_b128 v[10:13],v21 offset:704
s_waitcnt lgkmcnt(11)
v_mfma_f32_16x16x32_bf16 v[60:63],v[76:79],v[244:247],v[60:63]
v_mfma_f32_16x16x32_bf16 v[52:55],v[76:79],v[240:243],v[52:55]
ds_read_b64_tr_b16 v[72:73],v5 offset:8192
ds_read_b64_tr_b16 v[74:75],v5 offset:8704
s_waitcnt lgkmcnt(8)
v_mfma_f32_16x16x32_bf16 v[24:27],v[40:43],v[248:251],v[24:27]
ds_read_b64_tr_b16 v[76:77],v6 offset:8192
ds_read_b64_tr_b16 v[78:79],v6 offset:8704
s_waitcnt lgkmcnt(9)
v_mfma_f32_16x16x32_bf16 v[32:35],v[40:43],v[252:255],v[32:35]
v_mfma_f32_16x16x32_bf16 v[36:39],v[44:47],v[252:255],v[36:39]
v_mfma_f32_16x16x32_bf16 v[28:31],v[44:47],v[248:251],v[28:31]
ds_read_b64_tr_b16 v[40:41],v7 offset:8192
ds_read_b64_tr_b16 v[42:43],v7 offset:8704
s_waitcnt lgkmcnt(9)
v_mfma_f32_16x16x32_bf16 v[48:51],v[64:67],v[248:251],v[48:51]
ds_read_b64_tr_b16 v[44:45],v8 offset:8192
ds_read_b64_tr_b16 v[46:47],v8 offset:8704
v_mfma_f32_16x16x32_bf16 v[56:59],v[64:67],v[252:255],v[56:59]
s_waitcnt lgkmcnt(8)
v_mfma_f32_16x16x32_bf16 v[224:227],v[10:13],v[104:107],v[224:227]
v_mfma_f32_16x16x32_bf16 v[60:63],v[68:71],v[252:255],v[60:63]
v_mfma_f32_16x16x32_bf16 v[52:55],v[68:71],v[248:251],v[52:55]
v_mfma_f32_16x16x32_bf16 v[228:231],v[10:13],v[108:111],v[228:231]
s_waitcnt vmcnt(2)
s_barrier
ds_read_b64_tr_b16 v[64:65],v5 offset:12288
ds_read_b64_tr_b16 v[66:67],v5 offset:12800
s_setprio 3
s_waitcnt lgkmcnt(8)
v_mfma_f32_16x16x32_bf16 v[128:131],v[72:75],v[80:83],v[128:131]
s_add_u32 m0,s60,106496
s_add_u32 s53,s79,256
buffer_load_dwordx4 v2,s[36:39],s53 offen lds
ds_read_b64_tr_b16 v[68:69],v6 offset:12288
ds_read_b64_tr_b16 v[70:71],v6 offset:12800
v_mfma_f32_16x16x32_bf16 v[136:139],v[72:75],v[84:87],v[136:139]
ds_read_b128 v[16:19],v21 offset:768
s_waitcnt lgkmcnt(9)
v_mfma_f32_16x16x32_bf16 v[140:143],v[76:79],v[84:87],v[140:143]
v_mfma_f32_16x16x32_bf16 v[132:135],v[76:79],v[80:83],v[132:135]
ds_read_b64_tr_b16 v[72:73],v7 offset:12288
ds_read_b64_tr_b16 v[74:75],v7 offset:12800
s_waitcnt lgkmcnt(9)
v_mfma_f32_16x16x32_bf16 v[144:147],v[40:43],v[80:83],v[144:147]
s_add_u32 s54,s51,0
s_lshr_b32 s57,s54,1
s_lshl_b32 s57,s57,20
ds_read_b64_tr_b16 v[76:77],v8 offset:12288
ds_read_b64_tr_b16 v[78:79],v8 offset:12800
v_mfma_f32_16x16x32_bf16 v[152:155],v[40:43],v[84:87],v[152:155]
s_and_b32 s54,s54,1
s_lshl_b32 s54,s54,12
s_add_u32 s57,s57,s54
s_waitcnt lgkmcnt(9)
v_mfma_f32_16x16x32_bf16 v[156:159],v[44:47],v[84:87],v[156:159]
s_add_u32 m0,s60,114688
s_add_u32 s53,s76,384
buffer_load_dwordx4 v2,s[36:39],s53 offen lds
s_add_u32 s57,s57,33570816
v_fma_f32 v15,v24,s61,-s61
v_mfma_f32_16x16x32_bf16 v[148:151],v[44:47],v[80:83],v[148:151]
v_fma_f32 v22,v25,s61,-s61
v_exp_f32 v15,v15 clamp
v_exp_f32 v22,v22 clamp
ds_read_b64_tr_b16 v[40:41],v5 offset:16384
ds_read_b64_tr_b16 v[42:43],v5 offset:16896
s_waitcnt lgkmcnt(9)
v_mfma_f32_16x16x32_bf16 v[128:131],v[64:67],v[88:91],v[128:131]
s_waitcnt lgkmcnt(6)
v_mfma_f32_16x16x32_bf16 v[224:227],v[16:19],v[112:115],v[224:227]
v_max_f32 v24,v15,v24
v_max_f32 v25,v22,v25
ds_read_b64_tr_b16 v[44:45],v6 offset:16384
ds_read_b64_tr_b16 v[46:47],v6 offset:16896
v_mfma_f32_16x16x32_bf16 v[136:139],v[64:67],v[92:95],v[136:139]
v_add_f32 v24,s62,v24
v_add_f32 v25,s62,v25
v_cvt_pk_bf16_f32 v24,v24,v25
v_mfma_f32_16x16x32_bf16 v[140:143],v[68:71],v[92:95],v[140:143]
v_mfma_f32_16x16x32_bf16 v[228:231],v[16:19],v[116:119],v[228:231]
v_fma_f32 v15,v26,s61,-s61
v_fma_f32 v22,v27,s61,-s61
v_mfma_f32_16x16x32_bf16 v[132:135],v[68:71],v[88:91],v[132:135]
v_exp_f32 v15,v15 clamp
v_exp_f32 v22,v22 clamp
v_max_f32 v26,v15,v26
ds_read_b64_tr_b16 v[64:65],v7 offset:16384
ds_read_b64_tr_b16 v[66:67],v7 offset:16896
s_waitcnt lgkmcnt(8)
v_mfma_f32_16x16x32_bf16 v[144:147],v[72:75],v[88:91],v[144:147]
s_add_u32 m0,s60,122880
s_add_u32 s53,s77,384
buffer_load_dwordx4 v2,s[36:39],s53 offen lds
ds_read_b128 v[10:13],v21 offset:832
v_max_f32 v27,v22,v27
ds_read_b64_tr_b16 v[68:69],v8 offset:16384
ds_read_b64_tr_b16 v[70:71],v8 offset:16896
v_mfma_f32_16x16x32_bf16 v[152:155],v[72:75],v[92:95],v[152:155]
v_add_f32 v26,s62,v26
v_add_f32 v27,s62,v27
v_cvt_pk_bf16_f32 v25,v26,v27
v_fma_f32 v15,v28,s61,-s61
s_waitcnt lgkmcnt(9)
v_mfma_f32_16x16x32_bf16 v[156:159],v[76:79],v[92:95],v[156:159]
v_fma_f32 v22,v29,s61,-s61
v_exp_f32 v15,v15 clamp
v_mfma_f32_16x16x32_bf16 v[148:151],v[76:79],v[88:91],v[148:151]
v_exp_f32 v22,v22 clamp
v_max_f32 v28,v15,v28
v_max_f32 v29,v22,v29
ds_read_b64_tr_b16 v[72:73],v5 offset:20480
ds_read_b64_tr_b16 v[74:75],v5 offset:20992
s_setprio 2
s_waitcnt lgkmcnt(9)
v_mfma_f32_16x16x32_bf16 v[128:131],v[40:43],v[96:99],v[128:131]
v_add_f32 v28,s62,v28
v_add_f32 v29,s62,v29
v_cvt_pk_bf16_f32 v26,v28,v29
ds_read_b64_tr_b16 v[76:77],v6 offset:20480
ds_read_b64_tr_b16 v[78:79],v6 offset:20992
v_mfma_f32_16x16x32_bf16 v[136:139],v[40:43],v[100:103],v[136:139]
v_fma_f32 v15,v30,s61,-s61
v_fma_f32 v22,v31,s61,-s61
v_exp_f32 v15,v15 clamp
s_waitcnt lgkmcnt(9)
v_mfma_f32_16x16x32_bf16 v[140:143],v[44:47],v[100:103],v[140:143]
s_add_u32 m0,s60,131072
s_add_u32 s53,s78,384
buffer_load_dwordx4 v2,s[36:39],s53 offen lds
v_exp_f32 v22,v22 clamp
v_max_f32 v30,v15,v30
v_mfma_f32_16x16x32_bf16 v[132:135],v[44:47],v[96:99],v[132:135]
v_max_f32 v31,v22,v31
v_add_f32 v30,s62,v30
v_add_f32 v31,s62,v31
ds_read_b64_tr_b16 v[40:41],v7 offset:20480
ds_read_b64_tr_b16 v[42:43],v7 offset:20992
s_waitcnt lgkmcnt(9)
v_mfma_f32_16x16x32_bf16 v[144:147],v[64:67],v[96:99],v[144:147]
s_waitcnt lgkmcnt(8)
v_mfma_f32_16x16x32_bf16 v[224:227],v[10:13],v[120:123],v[224:227]
v_cvt_pk_bf16_f32 v27,v30,v31
buffer_store_dwordx4 v[24:27],v4,s[40:43],s57 offen offset:0 sc1
ds_read_b64_tr_b16 v[44:45],v8 offset:20480
ds_read_b64_tr_b16 v[46:47],v8 offset:20992
v_mfma_f32_16x16x32_bf16 v[152:155],v[64:67],v[100:103],v[152:155]
v_fma_f32 v15,v32,s61,-s61
v_fma_f32 v22,v33,s61,-s61
v_exp_f32 v15,v15 clamp
s_waitcnt lgkmcnt(8)
v_mfma_f32_16x16x32_bf16 v[156:159],v[68:71],v[100:103],v[156:159]
v_mfma_f32_16x16x32_bf16 v[228:231],v[10:13],v[124:127],v[228:231]
v_exp_f32 v22,v22 clamp
v_max_f32 v32,v15,v32
v_mfma_f32_16x16x32_bf16 v[148:151],v[68:71],v[96:99],v[148:151]
v_max_f32 v33,v22,v33
v_add_f32 v32,s62,v32
v_add_f32 v33,s62,v33
v_add_u32 v5,0xffff0000,v5
ds_read_b64_tr_b16 v[64:65],v5 offset:0
ds_read_b64_tr_b16 v[66:67],v5 offset:512
s_waitcnt lgkmcnt(8)
v_mfma_f32_16x16x32_bf16 v[128:131],v[72:75],v[104:107],v[128:131]
ds_read_b128 v[16:19],v21 offset:896
v_cvt_pk_bf16_f32 v28,v32,v33
v_fma_f32 v15,v34,s61,-s61
v_add_u32 v6,0xffff0000,v6
ds_read_b64_tr_b16 v[68:69],v6 offset:0
ds_read_b64_tr_b16 v[70:71],v6 offset:512
v_mfma_f32_16x16x32_bf16 v[136:139],v[72:75],v[108:111],v[136:139]
v_fma_f32 v22,v35,s61,-s61
v_exp_f32 v15,v15 clamp
v_exp_f32 v22,v22 clamp
s_waitcnt lgkmcnt(9)
v_mfma_f32_16x16x32_bf16 v[140:143],v[76:79],v[108:111],v[140:143]
v_max_f32 v34,v15,v34
v_max_f32 v35,v22,v35
v_mfma_f32_16x16x32_bf16 v[132:135],v[76:79],v[104:107],v[132:135]
v_add_f32 v34,s62,v34
v_add_f32 v35,s62,v35
v_cvt_pk_bf16_f32 v29,v34,v35
v_add_u32 v7,0xffff0000,v7
ds_read_b64_tr_b16 v[72:73],v7 offset:0
ds_read_b64_tr_b16 v[74:75],v7 offset:512
s_waitcnt lgkmcnt(9)
v_mfma_f32_16x16x32_bf16 v[144:147],v[40:43],v[104:107],v[144:147]
v_fma_f32 v15,v36,s61,-s61
v_fma_f32 v22,v37,s61,-s61
v_exp_f32 v15,v15 clamp
v_add_u32 v8,0xffff0000,v8
ds_read_b64_tr_b16 v[76:77],v8 offset:0
ds_read_b64_tr_b16 v[78:79],v8 offset:512
v_mfma_f32_16x16x32_bf16 v[152:155],v[40:43],v[108:111],v[152:155]
v_exp_f32 v22,v22 clamp
v_max_f32 v36,v15,v36
v_max_f32 v37,v22,v37
s_waitcnt lgkmcnt(9)
v_mfma_f32_16x16x32_bf16 v[156:159],v[44:47],v[108:111],v[156:159]
v_add_f32 v36,s62,v36
v_add_f32 v37,s62,v37
v_mfma_f32_16x16x32_bf16 v[148:151],v[44:47],v[104:107],v[148:151]
v_cvt_pk_bf16_f32 v30,v36,v37
v_fma_f32 v15,v38,s61,-s61
v_fma_f32 v22,v39,s61,-s61
ds_read_b64_tr_b16 v[40:41],v5 offset:4096
ds_read_b64_tr_b16 v[42:43],v5 offset:4608
s_setprio 1
s_waitcnt lgkmcnt(9)
v_mfma_f32_16x16x32_bf16 v[128:131],v[64:67],v[112:115],v[128:131]
s_waitcnt lgkmcnt(8)
v_mfma_f32_16x16x32_bf16 v[224:227],v[16:19],v[240:243],v[224:227]
v_exp_f32 v15,v15 clamp
v_exp_f32 v22,v22 clamp
ds_read_b64_tr_b16 v[44:45],v6 offset:4096
ds_read_b64_tr_b16 v[46:47],v6 offset:4608
v_mfma_f32_16x16x32_bf16 v[136:139],v[64:67],v[116:119],v[136:139]
v_max_f32 v38,v15,v38
v_max_f32 v39,v22,v39
v_add_f32 v38,s62,v38
s_waitcnt lgkmcnt(8)
v_mfma_f32_16x16x32_bf16 v[140:143],v[68:71],v[116:119],v[140:143]
v_mfma_f32_16x16x32_bf16 v[228:231],v[16:19],v[244:247],v[228:231]
v_add_f32 v39,s62,v39
v_cvt_pk_bf16_f32 v31,v38,v39
v_mfma_f32_16x16x32_bf16 v[132:135],v[68:71],v[112:115],v[132:135]
buffer_store_dwordx4 v[28:31],v4,s[40:43],s57 offen offset:256 sc1
v_fma_f32 v15,v48,s61,-s61
v_fma_f32 v22,v49,s61,-s61
ds_read_b64_tr_b16 v[64:65],v7 offset:4096
ds_read_b64_tr_b16 v[66:67],v7 offset:4608
s_waitcnt lgkmcnt(8)
v_mfma_f32_16x16x32_bf16 v[144:147],v[72:75],v[112:115],v[144:147]
ds_read_b128 v[10:13],v21 offset:960
v_exp_f32 v15,v15 clamp
v_exp_f32 v22,v22 clamp
ds_read_b64_tr_b16 v[68:69],v8 offset:4096
ds_read_b64_tr_b16 v[70:71],v8 offset:4608
v_mfma_f32_16x16x32_bf16 v[152:155],v[72:75],v[116:119],v[152:155]
v_max_f32 v48,v15,v48
v_max_f32 v49,v22,v49
v_add_f32 v48,s62,v48
s_waitcnt lgkmcnt(9)
v_mfma_f32_16x16x32_bf16 v[156:159],v[76:79],v[116:119],v[156:159]
v_add_f32 v49,s62,v49
v_cvt_pk_bf16_f32 v48,v48,v49
v_mfma_f32_16x16x32_bf16 v[148:151],v[76:79],v[112:115],v[148:151]
v_fma_f32 v15,v50,s61,-s61
v_fma_f32 v22,v51,s61,-s61
v_exp_f32 v15,v15 clamp
ds_read_b64_tr_b16 v[72:73],v5 offset:8192
ds_read_b64_tr_b16 v[74:75],v5 offset:8704
s_waitcnt lgkmcnt(9)
v_mfma_f32_16x16x32_bf16 v[128:131],v[40:43],v[120:123],v[128:131]
v_exp_f32 v22,v22 clamp
v_max_f32 v50,v15,v50
v_max_f32 v51,v22,v51
ds_read_b64_tr_b16 v[76:77],v6 offset:8192
ds_read_b64_tr_b16 v[78:79],v6 offset:8704
v_mfma_f32_16x16x32_bf16 v[136:139],v[40:43],v[124:127],v[136:139]
v_add_f32 v50,s62,v50
v_add_f32 v51,s62,v51
v_cvt_pk_bf16_f32 v49,v50,v51
s_waitcnt lgkmcnt(9)
v_mfma_f32_16x16x32_bf16 v[140:143],v[44:47],v[124:127],v[140:143]
v_fma_f32 v15,v52,s61,-s61
v_fma_f32 v22,v53,s61,-s61
v_mfma_f32_16x16x32_bf16 v[132:135],v[44:47],v[120:123],v[132:135]
v_exp_f32 v15,v15 clamp
v_exp_f32 v22,v22 clamp
v_max_f32 v52,v15,v52
ds_read_b64_tr_b16 v[40:41],v7 offset:8192
ds_read_b64_tr_b16 v[42:43],v7 offset:8704
s_waitcnt lgkmcnt(9)
v_mfma_f32_16x16x32_bf16 v[144:147],v[64:67],v[120:123],v[144:147]
s_waitcnt lgkmcnt(8)
v_mfma_f32_16x16x32_bf16 v[224:227],v[10:13],v[248:251],v[224:227]
v_max_f32 v53,v22,v53
v_add_f32 v52,s62,v52
ds_read_b64_tr_b16 v[44:45],v8 offset:8192
ds_read_b64_tr_b16 v[46:47],v8 offset:8704
v_mfma_f32_16x16x32_bf16 v[152:155],v[64:67],v[124:127],v[152:155]
v_add_f32 v53,s62,v53
v_cvt_pk_bf16_f32 v50,v52,v53
v_fma_f32 v15,v54,s61,-s61
s_waitcnt lgkmcnt(8)
v_mfma_f32_16x16x32_bf16 v[156:159],v[68:71],v[124:127],v[156:159]
v_mfma_f32_16x16x32_bf16 v[228:231],v[10:13],v[252:255],v[228:231]
v_fma_f32 v22,v55,s61,-s61
v_exp_f32 v15,v15 clamp
v_mfma_f32_16x16x32_bf16 v[148:151],v[68:71],v[120:123],v[148:151]
v_exp_f32 v22,v22 clamp
v_max_f32 v54,v15,v54
v_max_f32 v55,v22,v55
ds_read_b64_tr_b16 v[64:65],v5 offset:12288
ds_read_b64_tr_b16 v[66:67],v5 offset:12800
s_setprio 0
s_waitcnt lgkmcnt(8)
v_mfma_f32_16x16x32_bf16 v[128:131],v[72:75],v[240:243],v[128:131]
v_add_f32 v54,s62,v54
v_add_f32 v55,s62,v55
ds_read_b64_tr_b16 v[68:69],v6 offset:12288
ds_read_b64_tr_b16 v[70:71],v6 offset:12800
v_mfma_f32_16x16x32_bf16 v[136:139],v[72:75],v[244:247],v[136:139]
v_cvt_pk_bf16_f32 v51,v54,v55
buffer_store_dwordx4 v[48:51],v4,s[40:43],s57 offen offset:2048 sc1
v_fma_f32 v15,v56,s61,-s61
s_waitcnt lgkmcnt(8)
v_mfma_f32_16x16x32_bf16 v[140:143],v[76:79],v[244:247],v[140:143]
v_fma_f32 v22,v57,s61,-s61
v_exp_f32 v15,v15 clamp
v_mfma_f32_16x16x32_bf16 v[132:135],v[76:79],v[240:243],v[132:135]
v_exp_f32 v22,v22 clamp
v_max_f32 v56,v15,v56
v_max_f32 v57,v22,v57
ds_read_b64_tr_b16 v[72:73],v7 offset:12288
ds_read_b64_tr_b16 v[74:75],v7 offset:12800
s_waitcnt lgkmcnt(8)
v_mfma_f32_16x16x32_bf16 v[144:147],v[40:43],v[240:243],v[144:147]
v_add_f32 v56,s62,v56
v_add_f32 v57,s62,v57
v_cvt_pk_bf16_f32 v52,v56,v57
ds_read_b64_tr_b16 v[76:77],v8 offset:12288
ds_read_b64_tr_b16 v[78:79],v8 offset:12800
v_mfma_f32_16x16x32_bf16 v[152:155],v[40:43],v[244:247],v[152:155]
v_fma_f32 v15,v58,s61,-s61
v_fma_f32 v22,v59,s61,-s61
v_exp_f32 v15,v15 clamp
s_waitcnt lgkmcnt(8)
v_mfma_f32_16x16x32_bf16 v[156:159],v[44:47],v[244:247],v[156:159]
v_cmp_gt_u32 vcc,16,v1
v_and_b32 v21,31,v1
v_lshlrev_b32 v21,2,v21
v_cndmask_b32 v224,v228,v224,vcc
v_mul_f32 v224,s61,v224
v_exp_f32 v224,-v224
s_nop 0
v_add_f32 v224,1.0,v224
v_rcp_f32 v224,v224
s_lshr_b32 s53,s55,8
s_add_u32 s53,s53,101711872
s_cmp_lg_u32 s49,26
s_cbranch_scc1 L_k1_nogate
s_mov_b64 exec,0xffffffff
buffer_store_dword v224,v21,s[40:43],s53 offen sc1
s_mov_b64 exec,-1
L_k1_nogate:
v_exp_f32 v22,v22 clamp
v_max_f32 v58,v15,v58
v_mfma_f32_16x16x32_bf16 v[148:151],v[44:47],v[240:243],v[148:151]
v_max_f32 v59,v22,v59
v_add_f32 v58,s62,v58
v_add_f32 v59,s62,v59
ds_read_b64_tr_b16 v[40:41],v5 offset:16384
ds_read_b64_tr_b16 v[42:43],v5 offset:16896
s_waitcnt lgkmcnt(8)
v_mfma_f32_16x16x32_bf16 v[128:131],v[64:67],v[248:251],v[128:131]
v_cvt_pk_bf16_f32 v53,v58,v59
v_fma_f32 v15,v60,s61,-s61
ds_read_b64_tr_b16 v[44:45],v6 offset:16384
ds_read_b64_tr_b16 v[46:47],v6 offset:16896
v_mfma_f32_16x16x32_bf16 v[136:139],v[64:67],v[252:255],v[136:139]
v_fma_f32 v22,v61,s61,-s61
v_exp_f32 v15,v15 clamp
v_exp_f32 v22,v22 clamp
s_waitcnt lgkmcnt(8)
v_mfma_f32_16x16x32_bf16 v[140:143],v[68:71],v[252:255],v[140:143]
v_max_f32 v60,v15,v60
v_max_f32 v61,v22,v61
v_mfma_f32_16x16x32_bf16 v[132:135],v[68:71],v[248:251],v[132:135]
v_add_f32 v60,s62,v60
v_add_f32 v61,s62,v61
v_cvt_pk_bf16_f32 v54,v60,v61
ds_read_b64_tr_b16 v[64:65],v7 offset:16384
ds_read_b64_tr_b16 v[66:67],v7 offset:16896
s_waitcnt lgkmcnt(8)
v_mfma_f32_16x16x32_bf16 v[144:147],v[72:75],v[248:251],v[144:147]
v_fma_f32 v15,v62,s61,-s61
v_fma_f32 v22,v63,s61,-s61
ds_read_b64_tr_b16 v[68:69],v8 offset:16384
ds_read_b64_tr_b16 v[70:71],v8 offset:16896
v_mfma_f32_16x16x32_bf16 v[152:155],v[72:75],v[252:255],v[152:155]
v_exp_f32 v15,v15 clamp
v_exp_f32 v22,v22 clamp
v_max_f32 v62,v15,v62
s_waitcnt lgkmcnt(8)
v_mfma_f32_16x16x32_bf16 v[156:159],v[76:79],v[252:255],v[156:159]
v_max_f32 v63,v22,v63
v_add_f32 v62,s62,v62
v_mfma_f32_16x16x32_bf16 v[148:151],v[76:79],v[248:251],v[148:151]
v_add_f32 v63,s62,v63
v_cvt_pk_bf16_f32 v55,v62,v63
buffer_store_dwordx4 v[52:55],v4,s[40:43],s57 offen offset:2304 sc1
s_waitcnt vmcnt(6)
s_barrier
ds_read_b64_tr_b16 v[72:73],v5 offset:20480
ds_read_b64_tr_b16 v[74:75],v5 offset:20992
s_setprio 3
s_waitcnt lgkmcnt(8)
v_mfma_f32_16x16x32_bf16 v[160:163],v[40:43],v[80:83],v[160:163]
s_add_u32 m0,s60,139264
s_add_u32 s53,s79,384
buffer_load_dwordx4 v2,s[36:39],s53 offen lds
ds_read_b64_tr_b16 v[76:77],v6 offset:20480
ds_read_b64_tr_b16 v[78:79],v6 offset:20992
v_mfma_f32_16x16x32_bf16 v[168:171],v[40:43],v[84:87],v[168:171]
v_mov_b32 v14,s96
v_min_u32 v23,47,v1
v_lshlrev_b32 v23,2,v23
s_and_b32 s88,s2,7
s_lshl_b32 s88,s88,8
s_add_u32 s88,s88,101787648
v_add_u32 v23,s88,v23
s_mov_b32 s7,0
s_cmp_lg_u32 s50,0
s_cbranch_scc1 L_xfp11
s_cmp_lg_u32 s3,s2
s_cbranch_scc1 L_xfp11
buffer_load_dword v14,v23,s[40:43],0 offen sc1
L_xfp11:
s_waitcnt lgkmcnt(8)
v_mfma_f32_16x16x32_bf16 v[172:175],v[44:47],v[84:87],v[172:175]
s_mov_b64 s[76:77],s[8:9]
v_mfma_f32_16x16x32_bf16 v[164:167],v[44:47],v[80:83],v[164:167]
s_mov_b32 s78,4194304
s_mov_b32 s79,0x20000
ds_read_b64_tr_b16 v[40:41],v7 offset:20480
ds_read_b64_tr_b16 v[42:43],v7 offset:20992
s_waitcnt lgkmcnt(8)
v_mfma_f32_16x16x32_bf16 v[176:179],v[64:67],v[80:83],v[176:179]
s_mov_b64 s[8:9],s[40:41]
s_mov_b32 s10,268435456
s_add_u32 s54,s51,1
s_lshr_b32 s57,s54,1
ds_read_b64_tr_b16 v[44:45],v8 offset:20480
ds_read_b64_tr_b16 v[46:47],v8 offset:20992
v_mfma_f32_16x16x32_bf16 v[184:187],v[64:67],v[84:87],v[184:187]
s_lshl_b32 s57,s57,20
s_and_b32 s54,s54,1
s_lshl_b32 s54,s54,12
s_add_u32 s57,s57,s54
s_waitcnt lgkmcnt(8)
v_mfma_f32_16x16x32_bf16 v[188:191],v[68:71],v[84:87],v[188:191]
s_mov_b32 s11,0x20000
s_mov_b64 s[12:13],s[14:15]
s_mov_b32 s14,4194304
s_add_u32 s57,s57,33570816
v_mfma_f32_16x16x32_bf16 v[180:183],v[68:71],v[80:83],v[180:183]
v_fma_f32 v15,v128,s61,-s61
v_fma_f32 v22,v129,s61,-s61
v_exp_f32 v15,v15 clamp
v_exp_f32 v22,v22 clamp
ds_read_b64_tr_b16 v[64:65],v5 offset:24576
ds_read_b64_tr_b16 v[66:67],v5 offset:25088
s_waitcnt lgkmcnt(8)
v_mfma_f32_16x16x32_bf16 v[160:163],v[72:75],v[88:91],v[160:163]
s_mov_b32 s15,0x20000
s_mov_b32 s37,s18
v_max_f32 v128,v15,v128
ds_read_b64_tr_b16 v[68:69],v6 offset:24576
ds_read_b64_tr_b16 v[70:71],v6 offset:25088
v_mfma_f32_16x16x32_bf16 v[168:171],v[72:75],v[92:95],v[168:171]
v_max_f32 v129,v22,v129
v_add_f32 v128,s62,v128
v_add_f32 v129,s62,v129
v_cvt_pk_bf16_f32 v128,v128,v129
s_waitcnt lgkmcnt(8)
v_mfma_f32_16x16x32_bf16 v[172:175],v[76:79],v[92:95],v[172:175]
s_lshl_b32 s39,s16,11
s_lshl_b32 s29,s16,16
s_lshl_b32 s26,s17,8
v_fma_f32 v15,v130,s61,-s61
v_mfma_f32_16x16x32_bf16 v[164:167],v[76:79],v[88:91],v[164:167]
v_fma_f32 v22,v131,s61,-s61
v_exp_f32 v15,v15 clamp
v_exp_f32 v22,v22 clamp
v_max_f32 v130,v15,v130
ds_read_b64_tr_b16 v[72:73],v7 offset:24576
ds_read_b64_tr_b16 v[74:75],v7 offset:25088
s_waitcnt lgkmcnt(8)
v_mfma_f32_16x16x32_bf16 v[176:179],v[40:43],v[88:91],v[176:179]
s_add_u32 s29,s29,s26
s_lshl_b32 s24,s19,15
v_max_f32 v131,v22,v131
ds_read_b64_tr_b16 v[76:77],v8 offset:24576
ds_read_b64_tr_b16 v[78:79],v8 offset:25088
v_mfma_f32_16x16x32_bf16 v[184:187],v[40:43],v[92:95],v[184:187]
v_add_f32 v130,s62,v130
v_add_f32 v131,s62,v131
v_cvt_pk_bf16_f32 v129,v130,v131
v_fma_f32 v15,v132,s61,-s61
s_waitcnt lgkmcnt(8)
v_mfma_f32_16x16x32_bf16 v[188:191],v[44:47],v[92:95],v[188:191]
s_add_u32 s24,s24,41943040
v_lshrrev_b32 v20,4,v1
v_lshlrev_b32 v21,2,v20
v_fma_f32 v22,v133,s61,-s61
v_mfma_f32_16x16x32_bf16 v[180:183],v[44:47],v[88:91],v[180:183]
v_exp_f32 v15,v15 clamp
v_exp_f32 v22,v22 clamp
v_max_f32 v132,v15,v132
v_max_f32 v133,v22,v133
ds_read_b64_tr_b16 v[40:41],v5 offset:28672
ds_read_b64_tr_b16 v[42:43],v5 offset:29184
s_setprio 2
s_waitcnt lgkmcnt(8)
v_mfma_f32_16x16x32_bf16 v[160:163],v[64:67],v[96:99],v[160:163]
v_and_b32 v10,15,v1
v_xor_b32 v10,v10,v21
v_add_f32 v132,s62,v132
v_add_f32 v133,s62,v133
ds_read_b64_tr_b16 v[44:45],v6 offset:28672
ds_read_b64_tr_b16 v[46:47],v6 offset:29184
v_mfma_f32_16x16x32_bf16 v[168:171],v[64:67],v[100:103],v[168:171]
v_cvt_pk_bf16_f32 v130,v132,v133
v_fma_f32 v15,v134,s61,-s61
v_fma_f32 v22,v135,s61,-s61
v_exp_f32 v15,v15 clamp
s_waitcnt lgkmcnt(8)
v_mfma_f32_16x16x32_bf16 v[172:175],v[68:71],v[100:103],v[172:175]
s_and_b32 s26,s16,1
s_lshl_b32 s26,s26,1
v_xor_b32 v10,s26,v10
v_exp_f32 v22,v22 clamp
v_mfma_f32_16x16x32_bf16 v[164:167],v[68:71],v[96:99],v[164:167]
v_max_f32 v134,v15,v134
v_max_f32 v135,v22,v135
v_add_f32 v134,s62,v134
v_add_f32 v135,s62,v135
ds_read_b64_tr_b16 v[64:65],v7 offset:28672
ds_read_b64_tr_b16 v[66:67],v7 offset:29184
s_waitcnt lgkmcnt(8)
v_mfma_f32_16x16x32_bf16 v[176:179],v[72:75],v[96:99],v[176:179]
v_lshlrev_b32 v10,4,v10
v_lshl_add_u32 v10,v20,13,v10
v_cvt_pk_bf16_f32 v131,v134,v135
ds_read_b64_tr_b16 v[68:69],v8 offset:28672
ds_read_b64_tr_b16 v[70:71],v8 offset:29184
v_mfma_f32_16x16x32_bf16 v[184:187],v[72:75],v[100:103],v[184:187]
buffer_store_dwordx4 v[128:131],v4,s[40:43],s57 offen offset:0 sc1
v_fma_f32 v15,v136,s61,-s61
v_fma_f32 v22,v137,s61,-s61
v_exp_f32 v15,v15 clamp
s_waitcnt lgkmcnt(8)
v_mfma_f32_16x16x32_bf16 v[188:191],v[76:79],v[100:103],v[188:191]
v_lshlrev_b32 v2,4,v1
s_add_u32 s26,s37,0
s_and_b32 s26,s26,7
v_exp_f32 v22,v22 clamp
v_mfma_f32_16x16x32_bf16 v[180:183],v[76:79],v[96:99],v[180:183]
v_max_f32 v136,v15,v136
v_max_f32 v137,v22,v137
v_add_f32 v136,s62,v136
v_add_f32 v137,s62,v137
ds_read_b64_tr_b16 v[72:73],v5 offset:32768
ds_read_b64_tr_b16 v[74:75],v5 offset:33280
s_waitcnt lgkmcnt(8)
v_mfma_f32_16x16x32_bf16 v[160:163],v[40:43],v[104:107],v[160:163]
s_lshl_b32 s80,s26,19
s_add_u32 s80,s80,s29
v_cvt_pk_bf16_f32 v132,v136,v137
ds_read_b64_tr_b16 v[76:77],v6 offset:32768
ds_read_b64_tr_b16 v[78:79],v6 offset:33280
v_mfma_f32_16x16x32_bf16 v[168:171],v[40:43],v[108:111],v[168:171]
v_fma_f32 v15,v138,s61,-s61
v_fma_f32 v22,v139,s61,-s61
v_exp_f32 v15,v15 clamp
v_exp_f32 v22,v22 clamp
s_waitcnt lgkmcnt(8)
v_mfma_f32_16x16x32_bf16 v[172:175],v[44:47],v[108:111],v[172:175]
s_lshl_b32 s26,s26,12
s_add_u32 s88,s26,s24
s_add_u32 s26,s37,1
v_max_f32 v138,v15,v138
v_mfma_f32_16x16x32_bf16 v[164:167],v[44:47],v[104:107],v[164:167]
v_max_f32 v139,v22,v139
v_add_f32 v138,s62,v138
v_add_f32 v139,s62,v139
v_cvt_pk_bf16_f32 v133,v138,v139
ds_read_b64_tr_b16 v[40:41],v7 offset:32768
ds_read_b64_tr_b16 v[42:43],v7 offset:33280
s_waitcnt lgkmcnt(8)
v_mfma_f32_16x16x32_bf16 v[176:179],v[64:67],v[104:107],v[176:179]
s_and_b32 s26,s26,7
s_lshl_b32 s81,s26,19
v_fma_f32 v15,v140,s61,-s61
v_fma_f32 v22,v141,s61,-s61
ds_read_b64_tr_b16 v[44:45],v8 offset:32768
ds_read_b64_tr_b16 v[46:47],v8 offset:33280
v_mfma_f32_16x16x32_bf16 v[184:187],v[64:67],v[108:111],v[184:187]
v_exp_f32 v15,v15 clamp
v_exp_f32 v22,v22 clamp
v_max_f32 v140,v15,v140
v_max_f32 v141,v22,v141
s_waitcnt lgkmcnt(8)
v_mfma_f32_16x16x32_bf16 v[188:191],v[68:71],v[108:111],v[188:191]
s_add_u32 s81,s81,s29
s_lshl_b32 s26,s26,12
s_add_u32 s89,s26,s24
v_add_f32 v140,s62,v140
v_mfma_f32_16x16x32_bf16 v[180:183],v[68:71],v[104:107],v[180:183]
v_add_f32 v141,s62,v141
v_cvt_pk_bf16_f32 v134,v140,v141
v_fma_f32 v15,v142,s61,-s61
v_fma_f32 v22,v143,s61,-s61
ds_read_b64_tr_b16 v[64:65],v5 offset:36864
ds_read_b64_tr_b16 v[66:67],v5 offset:37376
s_setprio 1
s_waitcnt lgkmcnt(8)
v_mfma_f32_16x16x32_bf16 v[160:163],v[72:75],v[112:115],v[160:163]
s_add_u32 s26,s37,2
s_and_b32 s26,s26,7
v_exp_f32 v15,v15 clamp
ds_read_b64_tr_b16 v[68:69],v6 offset:36864
ds_read_b64_tr_b16 v[70:71],v6 offset:37376
v_mfma_f32_16x16x32_bf16 v[168:171],v[72:75],v[116:119],v[168:171]
v_exp_f32 v22,v22 clamp
v_max_f32 v142,v15,v142
v_max_f32 v143,v22,v143
v_add_f32 v142,s62,v142
s_waitcnt lgkmcnt(8)
v_mfma_f32_16x16x32_bf16 v[172:175],v[76:79],v[116:119],v[172:175]
s_lshl_b32 s82,s26,19
s_add_u32 s82,s82,s29
s_lshl_b32 s26,s26,12
v_add_f32 v143,s62,v143
v_mfma_f32_16x16x32_bf16 v[164:167],v[76:79],v[112:115],v[164:167]
v_cvt_pk_bf16_f32 v135,v142,v143
buffer_store_dwordx4 v[132:135],v4,s[40:43],s57 offen offset:256 sc1
v_fma_f32 v15,v144,s61,-s61
v_fma_f32 v22,v145,s61,-s61
ds_read_b64_tr_b16 v[72:73],v7 offset:36864
ds_read_b64_tr_b16 v[74:75],v7 offset:37376
s_waitcnt lgkmcnt(8)
v_mfma_f32_16x16x32_bf16 v[176:179],v[40:43],v[112:115],v[176:179]
s_add_u32 s90,s26,s24
s_add_u32 s26,s37,3
v_exp_f32 v15,v15 clamp
ds_read_b64_tr_b16 v[76:77],v8 offset:36864
ds_read_b64_tr_b16 v[78:79],v8 offset:37376
v_mfma_f32_16x16x32_bf16 v[184:187],v[40:43],v[116:119],v[184:187]
v_exp_f32 v22,v22 clamp
v_max_f32 v144,v15,v144
v_max_f32 v145,v22,v145
v_add_f32 v144,s62,v144
s_waitcnt lgkmcnt(8)
v_mfma_f32_16x16x32_bf16 v[188:191],v[44:47],v[116:119],v[188:191]
s_and_b32 s26,s26,7
s_lshl_b32 s83,s26,19
s_add_u32 s83,s83,s29
v_add_f32 v145,s62,v145
v_mfma_f32_16x16x32_bf16 v[180:183],v[44:47],v[112:115],v[180:183]
v_cvt_pk_bf16_f32 v144,v144,v145
v_fma_f32 v15,v146,s61,-s61
v_fma_f32 v22,v147,s61,-s61
v_exp_f32 v15,v15 clamp
ds_read_b64_tr_b16 v[40:41],v5 offset:40960
ds_read_b64_tr_b16 v[42:43],v5 offset:41472
s_waitcnt lgkmcnt(8)
v_mfma_f32_16x16x32_bf16 v[160:163],v[64:67],v[120:123],v[160:163]
s_lshl_b32 s26,s26,12
s_add_u32 s91,s26,s24
v_exp_f32 v22,v22 clamp
v_max_f32 v146,v15,v146
ds_read_b64_tr_b16 v[44:45],v6 offset:40960
ds_read_b64_tr_b16 v[46:47],v6 offset:41472
v_mfma_f32_16x16x32_bf16 v[168:171],v[64:67],v[124:127],v[168:171]
v_max_f32 v147,v22,v147
v_add_f32 v146,s62,v146
v_add_f32 v147,s62,v147
v_cvt_pk_bf16_f32 v145,v146,v147
s_waitcnt lgkmcnt(8)
v_mfma_f32_16x16x32_bf16 v[172:175],v[68:71],v[124:127],v[172:175]
s_add_u32 m0,s39,0
s_add_u32 s26,s80,0
buffer_load_dwordx4 v10,s[76:79],s26 offen lds
v_fma_f32 v15,v148,s61,-s61
v_fma_f32 v22,v149,s61,-s61
v_mfma_f32_16x16x32_bf16 v[164:167],v[68:71],v[120:123],v[164:167]
v_exp_f32 v15,v15 clamp
v_exp_f32 v22,v22 clamp
v_max_f32 v148,v15,v148
ds_read_b64_tr_b16 v[64:65],v7 offset:40960
ds_read_b64_tr_b16 v[66:67],v7 offset:41472
s_waitcnt lgkmcnt(8)
v_mfma_f32_16x16x32_bf16 v[176:179],v[72:75],v[120:123],v[176:179]
s_add_u32 m0,s39,1024
s_add_u32 s26,s80,32768
buffer_load_dwordx4 v10,s[76:79],s26 offen lds
v_max_f32 v149,v22,v149
v_add_f32 v148,s62,v148
ds_read_b64_tr_b16 v[68:69],v8 offset:40960
ds_read_b64_tr_b16 v[70:71],v8 offset:41472
v_mfma_f32_16x16x32_bf16 v[184:187],v[72:75],v[124:127],v[184:187]
v_add_f32 v149,s62,v149
v_cvt_pk_bf16_f32 v146,v148,v149
v_fma_f32 v15,v150,s61,-s61
s_waitcnt lgkmcnt(8)
v_mfma_f32_16x16x32_bf16 v[188:191],v[76:79],v[124:127],v[188:191]
v_fma_f32 v22,v151,s61,-s61
v_exp_f32 v15,v15 clamp
v_mfma_f32_16x16x32_bf16 v[180:183],v[76:79],v[120:123],v[180:183]
v_exp_f32 v22,v22 clamp
v_max_f32 v150,v15,v150
v_max_f32 v151,v22,v151
ds_read_b64_tr_b16 v[72:73],v5 offset:45056
ds_read_b64_tr_b16 v[74:75],v5 offset:45568
s_setprio 0
s_waitcnt lgkmcnt(8)
v_mfma_f32_16x16x32_bf16 v[160:163],v[40:43],v[240:243],v[160:163]
s_add_u32 m0,s39,16384
s_add_u32 s26,s81,0
buffer_load_dwordx4 v10,s[76:79],s26 offen lds
v_add_f32 v150,s62,v150
v_add_f32 v151,s62,v151
ds_read_b64_tr_b16 v[76:77],v6 offset:45056
ds_read_b64_tr_b16 v[78:79],v6 offset:45568
v_mfma_f32_16x16x32_bf16 v[168:171],v[40:43],v[244:247],v[168:171]
v_cvt_pk_bf16_f32 v147,v150,v151
buffer_store_dwordx4 v[144:147],v4,s[40:43],s57 offen offset:2048 sc1
v_fma_f32 v15,v152,s61,-s61
s_waitcnt lgkmcnt(8)
v_mfma_f32_16x16x32_bf16 v[172:175],v[44:47],v[244:247],v[172:175]
s_add_u32 m0,s39,17408
s_add_u32 s26,s81,32768
buffer_load_dwordx4 v10,s[76:79],s26 offen lds
v_fma_f32 v22,v153,s61,-s61
v_exp_f32 v15,v15 clamp
v_mfma_f32_16x16x32_bf16 v[164:167],v[44:47],v[240:243],v[164:167]
v_exp_f32 v22,v22 clamp
v_max_f32 v152,v15,v152
v_max_f32 v153,v22,v153
ds_read_b64_tr_b16 v[40:41],v7 offset:45056
ds_read_b64_tr_b16 v[42:43],v7 offset:45568
s_waitcnt lgkmcnt(8)
v_mfma_f32_16x16x32_bf16 v[176:179],v[64:67],v[240:243],v[176:179]
v_add_f32 v152,s62,v152
v_add_f32 v153,s62,v153
v_cvt_pk_bf16_f32 v148,v152,v153
ds_read_b64_tr_b16 v[44:45],v8 offset:45056
ds_read_b64_tr_b16 v[46:47],v8 offset:45568
v_mfma_f32_16x16x32_bf16 v[184:187],v[64:67],v[244:247],v[184:187]
v_fma_f32 v15,v154,s61,-s61
v_fma_f32 v22,v155,s61,-s61
v_exp_f32 v15,v15 clamp
s_waitcnt lgkmcnt(8)
v_mfma_f32_16x16x32_bf16 v[188:191],v[68:71],v[244:247],v[188:191]
v_exp_f32 v22,v22 clamp
v_max_f32 v154,v15,v154
v_mfma_f32_16x16x32_bf16 v[180:183],v[68:71],v[240:243],v[180:183]
v_max_f32 v155,v22,v155
v_add_f32 v154,s62,v154
v_add_f32 v155,s62,v155
ds_read_b64_tr_b16 v[64:65],v5 offset:49152
ds_read_b64_tr_b16 v[66:67],v5 offset:49664
s_waitcnt lgkmcnt(8)
v_mfma_f32_16x16x32_bf16 v[160:163],v[72:75],v[248:251],v[160:163]
v_cvt_pk_bf16_f32 v149,v154,v155
v_fma_f32 v15,v156,s61,-s61
ds_read_b64_tr_b16 v[68:69],v6 offset:49152
ds_read_b64_tr_b16 v[70:71],v6 offset:49664
v_mfma_f32_16x16x32_bf16 v[168:171],v[72:75],v[252:255],v[168:171]
v_fma_f32 v22,v157,s61,-s61
v_exp_f32 v15,v15 clamp
v_exp_f32 v22,v22 clamp
s_waitcnt lgkmcnt(8)
v_mfma_f32_16x16x32_bf16 v[172:175],v[76:79],v[252:255],v[172:175]
v_max_f32 v156,v15,v156
v_max_f32 v157,v22,v157
v_mfma_f32_16x16x32_bf16 v[164:167],v[76:79],v[248:251],v[164:167]
v_add_f32 v156,s62,v156
v_add_f32 v157,s62,v157
v_cvt_pk_bf16_f32 v150,v156,v157
ds_read_b64_tr_b16 v[72:73],v7 offset:49152
ds_read_b64_tr_b16 v[74:75],v7 offset:49664
s_waitcnt lgkmcnt(8)
v_mfma_f32_16x16x32_bf16 v[176:179],v[40:43],v[248:251],v[176:179]
v_fma_f32 v15,v158,s61,-s61
v_fma_f32 v22,v159,s61,-s61
ds_read_b64_tr_b16 v[76:77],v8 offset:49152
ds_read_b64_tr_b16 v[78:79],v8 offset:49664
v_mfma_f32_16x16x32_bf16 v[184:187],v[40:43],v[252:255],v[184:187]
v_exp_f32 v15,v15 clamp
v_exp_f32 v22,v22 clamp
v_max_f32 v158,v15,v158
s_waitcnt lgkmcnt(8)
v_mfma_f32_16x16x32_bf16 v[188:191],v[44:47],v[252:255],v[188:191]
v_max_f32 v159,v22,v159
v_add_f32 v158,s62,v158
v_mfma_f32_16x16x32_bf16 v[180:183],v[44:47],v[248:251],v[180:183]
v_add_f32 v159,s62,v159
v_cvt_pk_bf16_f32 v151,v158,v159
buffer_store_dwordx4 v[148:151],v4,s[40:43],s57 offen offset:2304 sc1
s_waitcnt vmcnt(8)
s_cmp_lg_u32 s50,0
s_cbranch_scc1 L_xf_ok12
s_waitcnt vmcnt(8)
v_cmp_ne_u32 vcc,s96,v14
s_cbranch_vccnz L_xf_spin12
L_xf_ok12:
s_barrier
ds_read_b64_tr_b16 v[40:41],v5 offset:53248
ds_read_b64_tr_b16 v[42:43],v5 offset:53760
s_setprio 3
s_waitcnt lgkmcnt(8)
v_mfma_f32_16x16x32_bf16 v[192:195],v[64:67],v[80:83],v[192:195]
ds_read_b64_tr_b16 v[44:45],v6 offset:53248
ds_read_b64_tr_b16 v[46:47],v6 offset:53760
v_mfma_f32_16x16x32_bf16 v[200:203],v[64:67],v[84:87],v[200:203]
buffer_load_dwordx4 v[24:27],v2,s[8:11],s88 offen offset:0 sc1
s_waitcnt lgkmcnt(8)
v_mfma_f32_16x16x32_bf16 v[204:207],v[68:71],v[84:87],v[204:207]
v_mfma_f32_16x16x32_bf16 v[196:199],v[68:71],v[80:83],v[196:199]
buffer_load_dwordx4 v[28:31],v2,s[8:11],s88 offen offset:1024 sc1
ds_read_b64_tr_b16 v[64:65],v7 offset:53248
ds_read_b64_tr_b16 v[66:67],v7 offset:53760
s_waitcnt lgkmcnt(8)
v_mfma_f32_16x16x32_bf16 v[208:211],v[72:75],v[80:83],v[208:211]
buffer_load_dwordx4 v[32:35],v2,s[8:11],s88 offen offset:2048 sc1
s_add_u32 s54,s51,2
s_lshr_b32 s57,s54,1
ds_read_b64_tr_b16 v[68:69],v8 offset:53248
ds_read_b64_tr_b16 v[70:71],v8 offset:53760
v_mfma_f32_16x16x32_bf16 v[216:219],v[72:75],v[84:87],v[216:219]
s_lshl_b32 s57,s57,20
s_and_b32 s54,s54,1
s_lshl_b32 s54,s54,12
s_add_u32 s57,s57,s54
s_waitcnt lgkmcnt(8)
v_mfma_f32_16x16x32_bf16 v[220:223],v[76:79],v[84:87],v[220:223]
buffer_load_dwordx4 v[36:39],v2,s[8:11],s88 offen offset:3072 sc1
s_add_u32 s57,s57,33570816
v_fma_f32 v15,v160,s61,-s61
v_mfma_f32_16x16x32_bf16 v[212:215],v[76:79],v[80:83],v[212:215]
v_fma_f32 v22,v161,s61,-s61
v_exp_f32 v15,v15 clamp
v_exp_f32 v22,v22 clamp
ds_read_b64_tr_b16 v[72:73],v5 offset:57344
ds_read_b64_tr_b16 v[74:75],v5 offset:57856
s_waitcnt lgkmcnt(8)
v_mfma_f32_16x16x32_bf16 v[192:195],v[40:43],v[88:91],v[192:195]
v_max_f32 v160,v15,v160
v_max_f32 v161,v22,v161
ds_read_b64_tr_b16 v[76:77],v6 offset:57344
ds_read_b64_tr_b16 v[78:79],v6 offset:57856
v_mfma_f32_16x16x32_bf16 v[200:203],v[40:43],v[92:95],v[200:203]
v_add_f32 v160,s62,v160
v_add_f32 v161,s62,v161
v_cvt_pk_bf16_f32 v160,v160,v161
s_waitcnt lgkmcnt(8)
v_mfma_f32_16x16x32_bf16 v[204:207],v[44:47],v[92:95],v[204:207]
buffer_load_dwordx4 v[48:51],v2,s[8:11],s89 offen offset:0 sc1
v_fma_f32 v15,v162,s61,-s61
v_fma_f32 v22,v163,s61,-s61
v_mfma_f32_16x16x32_bf16 v[196:199],v[44:47],v[88:91],v[196:199]
v_exp_f32 v15,v15 clamp
v_exp_f32 v22,v22 clamp
v_max_f32 v162,v15,v162
ds_read_b64_tr_b16 v[40:41],v7 offset:57344
ds_read_b64_tr_b16 v[42:43],v7 offset:57856
s_waitcnt lgkmcnt(8)
v_mfma_f32_16x16x32_bf16 v[208:211],v[64:67],v[88:91],v[208:211]
buffer_load_dwordx4 v[52:55],v2,s[8:11],s89 offen offset:1024 sc1
v_max_f32 v163,v22,v163
v_add_f32 v162,s62,v162
ds_read_b64_tr_b16 v[44:45],v8 offset:57344
ds_read_b64_tr_b16 v[46:47],v8 offset:57856
v_mfma_f32_16x16x32_bf16 v[216:219],v[64:67],v[92:95],v[216:219]
v_add_f32 v163,s62,v163
v_cvt_pk_bf16_f32 v161,v162,v163
v_fma_f32 v15,v164,s61,-s61
s_waitcnt lgkmcnt(8)
v_mfma_f32_16x16x32_bf16 v[220:223],v[68:71],v[92:95],v[220:223]
buffer_load_dwordx4 v[56:59],v2,s[8:11],s89 offen offset:2048 sc1
v_fma_f32 v22,v165,s61,-s61
v_exp_f32 v15,v15 clamp
v_mfma_f32_16x16x32_bf16 v[212:215],v[68:71],v[88:91],v[212:215]
v_exp_f32 v22,v22 clamp
v_max_f32 v164,v15,v164
v_max_f32 v165,v22,v165
ds_read_b64_tr_b16 v[64:65],v5 offset:61440
ds_read_b64_tr_b16 v[66:67],v5 offset:61952
s_setprio 2
s_waitcnt lgkmcnt(8)
v_mfma_f32_16x16x32_bf16 v[192:195],v[72:75],v[96:99],v[192:195]
buffer_load_dwordx4 v[60:63],v2,s[8:11],s89 offen offset:3072 sc1
v_add_f32 v164,s62,v164
v_add_f32 v165,s62,v165
ds_read_b64_tr_b16 v[68:69],v6 offset:61440
ds_read_b64_tr_b16 v[70:71],v6 offset:61952
v_mfma_f32_16x16x32_bf16 v[200:203],v[72:75],v[100:103],v[200:203]
v_cvt_pk_bf16_f32 v162,v164,v165
v_fma_f32 v15,v166,s61,-s61
v_fma_f32 v22,v167,s61,-s61
v_exp_f32 v15,v15 clamp
s_waitcnt lgkmcnt(8)
v_mfma_f32_16x16x32_bf16 v[204:207],v[76:79],v[100:103],v[204:207]
v_exp_f32 v22,v22 clamp
v_max_f32 v166,v15,v166
v_mfma_f32_16x16x32_bf16 v[196:199],v[76:79],v[96:99],v[196:199]
v_max_f32 v167,v22,v167
v_add_f32 v166,s62,v166
v_add_f32 v167,s62,v167
ds_read_b64_tr_b16 v[72:73],v7 offset:61440
ds_read_b64_tr_b16 v[74:75],v7 offset:61952
s_waitcnt lgkmcnt(8)
v_mfma_f32_16x16x32_bf16 v[208:211],v[40:43],v[96:99],v[208:211]
s_add_u32 m0,s39,32768
s_add_u32 s26,s82,0
buffer_load_dwordx4 v10,s[76:79],s26 offen lds
v_cvt_pk_bf16_f32 v163,v166,v167
buffer_store_dwordx4 v[160:163],v4,s[40:43],s57 offen offset:0 sc1
ds_read_b64_tr_b16 v[76:77],v8 offset:61440
ds_read_b64_tr_b16 v[78:79],v8 offset:61952
v_mfma_f32_16x16x32_bf16 v[216:219],v[40:43],v[100:103],v[216:219]
v_fma_f32 v15,v168,s61,-s61
v_fma_f32 v22,v169,s61,-s61
v_exp_f32 v15,v15 clamp
s_waitcnt lgkmcnt(8)
v_mfma_f32_16x16x32_bf16 v[220:223],v[44:47],v[100:103],v[220:223]
s_add_u32 m0,s39,33792
s_add_u32 s26,s82,32768
buffer_load_dwordx4 v10,s[76:79],s26 offen lds
v_exp_f32 v22,v22 clamp
v_max_f32 v168,v15,v168
v_mfma_f32_16x16x32_bf16 v[212:215],v[44:47],v[96:99],v[212:215]
v_max_f32 v169,v22,v169
v_add_f32 v168,s62,v168
v_add_f32 v169,s62,v169
v_add_u32 v5,0x10000,v5
ds_read_b64_tr_b16 v[40:41],v5 offset:0
ds_read_b64_tr_b16 v[42:43],v5 offset:512
s_waitcnt lgkmcnt(8)
v_mfma_f32_16x16x32_bf16 v[192:195],v[64:67],v[104:107],v[192:195]
v_cvt_pk_bf16_f32 v164,v168,v169
v_fma_f32 v15,v170,s61,-s61
v_add_u32 v6,0x10000,v6
ds_read_b64_tr_b16 v[44:45],v6 offset:0
ds_read_b64_tr_b16 v[46:47],v6 offset:512
v_mfma_f32_16x16x32_bf16 v[200:203],v[64:67],v[108:111],v[200:203]
v_fma_f32 v22,v171,s61,-s61
v_exp_f32 v15,v15 clamp
v_exp_f32 v22,v22 clamp
s_waitcnt lgkmcnt(8)
v_mfma_f32_16x16x32_bf16 v[204:207],v[68:71],v[108:111],v[204:207]
s_add_u32 m0,s39,49152
s_add_u32 s26,s83,0
buffer_load_dwordx4 v10,s[76:79],s26 offen lds
v_max_f32 v170,v15,v170
v_max_f32 v171,v22,v171
v_mfma_f32_16x16x32_bf16 v[196:199],v[68:71],v[104:107],v[196:199]
v_add_f32 v170,s62,v170
v_add_f32 v171,s62,v171
v_cvt_pk_bf16_f32 v165,v170,v171
v_add_u32 v7,0x10000,v7
ds_read_b64_tr_b16 v[64:65],v7 offset:0
ds_read_b64_tr_b16 v[66:67],v7 offset:512
s_waitcnt lgkmcnt(8)
v_mfma_f32_16x16x32_bf16 v[208:211],v[72:75],v[104:107],v[208:211]
s_add_u32 m0,s39,50176
s_add_u32 s26,s83,32768
buffer_load_dwordx4 v10,s[76:79],s26 offen lds
v_fma_f32 v15,v172,s61,-s61
v_fma_f32 v22,v173,s61,-s61
v_add_u32 v8,0x10000,v8
ds_read_b64_tr_b16 v[68:69],v8 offset:0
ds_read_b64_tr_b16 v[70:71],v8 offset:512
v_mfma_f32_16x16x32_bf16 v[216:219],v[72:75],v[108:111],v[216:219]
v_exp_f32 v15,v15 clamp
v_exp_f32 v22,v22 clamp
v_max_f32 v172,v15,v172
v_max_f32 v173,v22,v173
s_waitcnt lgkmcnt(8)
v_mfma_f32_16x16x32_bf16 v[220:223],v[76:79],v[108:111],v[220:223]
v_add_f32 v172,s62,v172
v_add_f32 v173,s62,v173
v_mfma_f32_16x16x32_bf16 v[212:215],v[76:79],v[104:107],v[212:215]
v_cvt_pk_bf16_f32 v166,v172,v173
v_fma_f32 v15,v174,s61,-s61
v_fma_f32 v22,v175,s61,-s61
ds_read_b64_tr_b16 v[72:73],v5 offset:4096
ds_read_b64_tr_b16 v[74:75],v5 offset:4608
s_setprio 1
s_waitcnt lgkmcnt(8)
v_mfma_f32_16x16x32_bf16 v[192:195],v[40:43],v[112:115],v[192:195]
s_add_u32 s26,s37,4
s_and_b32 s26,s26,7
s_lshl_b32 s84,s26,19
v_exp_f32 v15,v15 clamp
ds_read_b64_tr_b16 v[76:77],v6 offset:4096
ds_read_b64_tr_b16 v[78:79],v6 offset:4608
v_mfma_f32_16x16x32_bf16 v[200:203],v[40:43],v[116:119],v[200:203]
v_exp_f32 v22,v22 clamp
v_max_f32 v174,v15,v174
v_max_f32 v175,v22,v175
v_add_f32 v174,s62,v174
s_waitcnt lgkmcnt(8)
v_mfma_f32_16x16x32_bf16 v[204:207],v[44:47],v[116:119],v[204:207]
s_add_u32 s84,s84,s29
s_lshl_b32 s26,s26,12
s_add_u32 s92,s26,s24
v_add_f32 v175,s62,v175
v_mfma_f32_16x16x32_bf16 v[196:199],v[44:47],v[112:115],v[196:199]
v_cvt_pk_bf16_f32 v167,v174,v175
buffer_store_dwordx4 v[164:167],v4,s[40:43],s57 offen offset:256 sc1
v_fma_f32 v15,v176,s61,-s61
v_fma_f32 v22,v177,s61,-s61
ds_read_b64_tr_b16 v[40:41],v7 offset:4096
ds_read_b64_tr_b16 v[42:43],v7 offset:4608
s_waitcnt lgkmcnt(8)
v_mfma_f32_16x16x32_bf16 v[208:211],v[64:67],v[112:115],v[208:211]
s_add_u32 s26,s37,5
s_and_b32 s26,s26,7
v_exp_f32 v15,v15 clamp
ds_read_b64_tr_b16 v[44:45],v8 offset:4096
ds_read_b64_tr_b16 v[46:47],v8 offset:4608
v_mfma_f32_16x16x32_bf16 v[216:219],v[64:67],v[116:119],v[216:219]
v_exp_f32 v22,v22 clamp
v_max_f32 v176,v15,v176
v_max_f32 v177,v22,v177
v_add_f32 v176,s62,v176
s_waitcnt lgkmcnt(8)
v_mfma_f32_16x16x32_bf16 v[220:223],v[68:71],v[116:119],v[220:223]
s_lshl_b32 s85,s26,19
s_add_u32 s85,s85,s29
s_lshl_b32 s26,s26,12
v_add_f32 v177,s62,v177
v_mfma_f32_16x16x32_bf16 v[212:215],v[68:71],v[112:115],v[212:215]
v_cvt_pk_bf16_f32 v176,v176,v177
v_fma_f32 v15,v178,s61,-s61
v_fma_f32 v22,v179,s61,-s61
v_exp_f32 v15,v15 clamp
ds_read_b64_tr_b16 v[64:65],v5 offset:8192
ds_read_b64_tr_b16 v[66:67],v5 offset:8704
s_waitcnt lgkmcnt(8)
v_mfma_f32_16x16x32_bf16 v[192:195],v[72:75],v[120:123],v[192:195]
s_add_u32 s93,s26,s24
s_add_u32 s26,s37,6
v_exp_f32 v22,v22 clamp
v_max_f32 v178,v15,v178
ds_read_b64_tr_b16 v[68:69],v6 offset:8192
ds_read_b64_tr_b16 v[70:71],v6 offset:8704
v_mfma_f32_16x16x32_bf16 v[200:203],v[72:75],v[124:127],v[200:203]
v_max_f32 v179,v22,v179
v_add_f32 v178,s62,v178
v_add_f32 v179,s62,v179
v_cvt_pk_bf16_f32 v177,v178,v179
s_waitcnt lgkmcnt(8)
v_mfma_f32_16x16x32_bf16 v[204:207],v[76:79],v[124:127],v[204:207]
s_and_b32 s26,s26,7
s_lshl_b32 s86,s26,19
s_add_u32 s86,s86,s29
v_fma_f32 v15,v180,s61,-s61
v_mfma_f32_16x16x32_bf16 v[196:199],v[76:79],v[120:123],v[196:199]
v_fma_f32 v22,v181,s61,-s61
v_exp_f32 v15,v15 clamp
v_exp_f32 v22,v22 clamp
v_max_f32 v180,v15,v180
ds_read_b64_tr_b16 v[72:73],v7 offset:8192
ds_read_b64_tr_b16 v[74:75],v7 offset:8704
s_waitcnt lgkmcnt(8)
v_mfma_f32_16x16x32_bf16 v[208:211],v[40:43],v[120:123],v[208:211]
s_lshl_b32 s26,s26,12
s_add_u32 s94,s26,s24
s_add_u32 s26,s37,7
v_max_f32 v181,v22,v181
ds_read_b64_tr_b16 v[76:77],v8 offset:8192
ds_read_b64_tr_b16 v[78:79],v8 offset:8704
v_mfma_f32_16x16x32_bf16 v[216:219],v[40:43],v[124:127],v[216:219]
v_add_f32 v180,s62,v180
v_add_f32 v181,s62,v181
v_cvt_pk_bf16_f32 v178,v180,v181
v_fma_f32 v15,v182,s61,-s61
s_waitcnt lgkmcnt(8)
v_mfma_f32_16x16x32_bf16 v[220:223],v[44:47],v[124:127],v[220:223]
s_and_b32 s26,s26,7
s_lshl_b32 s87,s26,19
v_fma_f32 v22,v183,s61,-s61
v_mfma_f32_16x16x32_bf16 v[212:215],v[44:47],v[120:123],v[212:215]
v_exp_f32 v15,v15 clamp
v_exp_f32 v22,v22 clamp
v_max_f32 v182,v15,v182
v_max_f32 v183,v22,v183
ds_read_b64_tr_b16 v[40:41],v5 offset:12288
ds_read_b64_tr_b16 v[42:43],v5 offset:12800
s_setprio 0
s_waitcnt lgkmcnt(8)
v_mfma_f32_16x16x32_bf16 v[192:195],v[64:67],v[240:243],v[192:195]
s_add_u32 s87,s87,s29
s_lshl_b32 s26,s26,12
s_add_u32 s95,s26,s24
v_add_f32 v182,s62,v182
ds_read_b64_tr_b16 v[44:45],v6 offset:12288
ds_read_b64_tr_b16 v[46:47],v6 offset:12800
v_mfma_f32_16x16x32_bf16 v[200:203],v[64:67],v[244:247],v[200:203]
v_add_f32 v183,s62,v183
v_cvt_pk_bf16_f32 v179,v182,v183
buffer_store_dwordx4 v[176:179],v4,s[40:43],s57 offen offset:2048 sc1
v_fma_f32 v15,v184,s61,-s61
s_waitcnt lgkmcnt(8)
v_mfma_f32_16x16x32_bf16 v[204:207],v[68:71],v[244:247],v[204:207]
s_lshl_b32 s26,s18,1
s_sub_u32 s22,31,s26
v_fma_f32 v22,v185,s61,-s61
v_mfma_f32_16x16x32_bf16 v[196:199],v[68:71],v[240:243],v[196:199]
v_exp_f32 v15,v15 clamp
v_exp_f32 v22,v22 clamp
v_max_f32 v184,v15,v184
v_max_f32 v185,v22,v185
ds_read_b64_tr_b16 v[64:65],v7 offset:12288
ds_read_b64_tr_b16 v[66:67],v7 offset:12800
s_waitcnt lgkmcnt(8)
v_mfma_f32_16x16x32_bf16 v[208:211],v[72:75],v[240:243],v[208:211]
s_lshl_b32 s36,s17,20
s_mov_b64 s[72:73],s[40:41]
s_mov_b32 s74,268435456
v_add_f32 v184,s62,v184
ds_read_b64_tr_b16 v[68:69],v8 offset:12288
ds_read_b64_tr_b16 v[70:71],v8 offset:12800
v_mfma_f32_16x16x32_bf16 v[216:219],v[72:75],v[244:247],v[216:219]
v_add_f32 v185,s62,v185
v_cvt_pk_bf16_f32 v180,v184,v185
v_fma_f32 v15,v186,s61,-s61
v_fma_f32 v22,v187,s61,-s61
v_exp_f32 v15,v15 clamp
s_waitcnt lgkmcnt(8)
v_mfma_f32_16x16x32_bf16 v[220:223],v[76:79],v[244:247],v[220:223]
s_mov_b32 s75,0x20000
s_mov_b32 s29,0
s_mov_b32 s24,0
v_exp_f32 v22,v22 clamp
v_mfma_f32_16x16x32_bf16 v[212:215],v[76:79],v[240:243],v[212:215]
v_max_f32 v186,v15,v186
v_max_f32 v187,v22,v187
v_add_f32 v186,s62,v186
v_add_f32 v187,s62,v187
s_waitcnt lgkmcnt(6)
v_mfma_f32_16x16x32_bf16 v[192:195],v[40:43],v[248:251],v[192:195]
s_lshl_b32 s26,s16,13
s_add_u32 s25,s36,s26
v_cvt_pk_bf16_f32 v181,v186,v187
v_mfma_f32_16x16x32_bf16 v[200:203],v[40:43],v[252:255],v[200:203]
v_fma_f32 v15,v188,s61,-s61
v_fma_f32 v22,v189,s61,-s61
v_exp_f32 v15,v15 clamp
v_exp_f32 v22,v22 clamp
s_waitcnt lgkmcnt(4)
v_mfma_f32_16x16x32_bf16 v[204:207],v[44:47],v[252:255],v[204:207]
s_add_u32 s25,s25,16384
s_mov_b32 s23,32768
s_mov_b32 s21,0
v_max_f32 v188,v15,v188
v_mfma_f32_16x16x32_bf16 v[196:199],v[44:47],v[248:251],v[196:199]
v_max_f32 v189,v22,v189
v_add_f32 v188,s62,v188
v_add_f32 v189,s62,v189
v_cvt_pk_bf16_f32 v182,v188,v189
s_waitcnt lgkmcnt(2)
v_mfma_f32_16x16x32_bf16 v[208:211],v[64:67],v[248:251],v[208:211]
s_sub_u32 s20,s19,1
s_max_i32 s20,s20,0
v_fma_f32 v15,v190,s61,-s61
v_mfma_f32_16x16x32_bf16 v[216:219],v[64:67],v[252:255],v[216:219]
v_fma_f32 v22,v191,s61,-s61
v_exp_f32 v15,v15 clamp
v_exp_f32 v22,v22 clamp
v_max_f32 v190,v15,v190
s_waitcnt lgkmcnt(0)
v_mfma_f32_16x16x32_bf16 v[220:223],v[68:71],v[252:255],v[220:223]
v_max_f32 v191,v22,v191
v_add_f32 v190,s62,v190
v_mfma_f32_16x16x32_bf16 v[212:215],v[68:71],v[248:251],v[212:215]
v_add_f32 v191,s62,v191
v_cvt_pk_bf16_f32 v183,v190,v191
buffer_store_dwordx4 v[180:183],v4,s[40:43],s57 offen offset:2304 sc1
s_nop 1
s_add_u32 s54,s51,3
s_lshr_b32 s57,s54,1
s_lshl_b32 s57,s57,20
s_and_b32 s54,s54,1
s_lshl_b32 s54,s54,12
s_add_u32 s57,s57,s54
s_add_u32 s57,s57,33570816
v_fma_f32 v15,v192,s61,-s61
v_fma_f32 v22,v193,s61,-s61
v_exp_f32 v15,v15 clamp
v_exp_f32 v22,v22 clamp
v_max_f32 v192,v15,v192
v_max_f32 v193,v22,v193
v_add_f32 v192,s62,v192
v_add_f32 v193,s62,v193
v_cvt_pk_bf16_f32 v192,v192,v193
v_fma_f32 v15,v194,s61,-s61
v_fma_f32 v22,v195,s61,-s61
v_exp_f32 v15,v15 clamp
v_exp_f32 v22,v22 clamp
v_max_f32 v194,v15,v194
v_max_f32 v195,v22,v195
v_add_f32 v194,s62,v194
v_add_f32 v195,s62,v195
v_cvt_pk_bf16_f32 v193,v194,v195
v_fma_f32 v15,v196,s61,-s61
v_fma_f32 v22,v197,s61,-s61
v_exp_f32 v15,v15 clamp
v_exp_f32 v22,v22 clamp
v_max_f32 v196,v15,v196
v_max_f32 v197,v22,v197
v_add_f32 v196,s62,v196
v_add_f32 v197,s62,v197
v_cvt_pk_bf16_f32 v194,v196,v197
v_fma_f32 v15,v198,s61,-s61
v_fma_f32 v22,v199,s61,-s61
v_exp_f32 v15,v15 clamp
v_exp_f32 v22,v22 clamp
v_max_f32 v198,v15,v198
v_max_f32 v199,v22,v199
v_add_f32 v198,s62,v198
v_add_f32 v199,s62,v199
v_cvt_pk_bf16_f32 v195,v198,v199
buffer_store_dwordx4 v[192:195],v4,s[40:43],s57 offen offset:0 sc1
v_fma_f32 v15,v200,s61,-s61
v_fma_f32 v22,v201,s61,-s61
v_exp_f32 v15,v15 clamp
v_exp_f32 v22,v22 clamp
v_max_f32 v200,v15,v200
v_max_f32 v201,v22,v201
v_add_f32 v200,s62,v200
v_add_f32 v201,s62,v201
v_cvt_pk_bf16_f32 v196,v200,v201
v_fma_f32 v15,v202,s61,-s61
v_fma_f32 v22,v203,s61,-s61
v_exp_f32 v15,v15 clamp
v_exp_f32 v22,v22 clamp
v_max_f32 v202,v15,v202
v_max_f32 v203,v22,v203
v_add_f32 v202,s62,v202
v_add_f32 v203,s62,v203
v_cvt_pk_bf16_f32 v197,v202,v203
v_fma_f32 v15,v204,s61,-s61
v_fma_f32 v22,v205,s61,-s61
v_exp_f32 v15,v15 clamp
v_exp_f32 v22,v22 clamp
v_max_f32 v204,v15,v204
v_max_f32 v205,v22,v205
v_add_f32 v204,s62,v204
v_add_f32 v205,s62,v205
v_cvt_pk_bf16_f32 v198,v204,v205
v_fma_f32 v15,v206,s61,-s61
v_fma_f32 v22,v207,s61,-s61
v_exp_f32 v15,v15 clamp
v_exp_f32 v22,v22 clamp
v_max_f32 v206,v15,v206
v_max_f32 v207,v22,v207
v_add_f32 v206,s62,v206
v_add_f32 v207,s62,v207
v_cvt_pk_bf16_f32 v199,v206,v207
buffer_store_dwordx4 v[196:199],v4,s[40:43],s57 offen offset:256 sc1
v_fma_f32 v15,v208,s61,-s61
v_fma_f32 v22,v209,s61,-s61
v_exp_f32 v15,v15 clamp
v_exp_f32 v22,v22 clamp
v_max_f32 v208,v15,v208
v_max_f32 v209,v22,v209
v_add_f32 v208,s62,v208
v_add_f32 v209,s62,v209
v_cvt_pk_bf16_f32 v208,v208,v209
v_fma_f32 v15,v210,s61,-s61
v_fma_f32 v22,v211,s61,-s61
v_exp_f32 v15,v15 clamp
v_exp_f32 v22,v22 clamp
v_max_f32 v210,v15,v210
v_max_f32 v211,v22,v211
v_add_f32 v210,s62,v210
v_add_f32 v211,s62,v211
v_cvt_pk_bf16_f32 v209,v210,v211
v_fma_f32 v15,v212,s61,-s61
v_fma_f32 v22,v213,s61,-s61
v_exp_f32 v15,v15 clamp
v_exp_f32 v22,v22 clamp
v_max_f32 v212,v15,v212
v_max_f32 v213,v22,v213
v_add_f32 v212,s62,v212
v_add_f32 v213,s62,v213
v_cvt_pk_bf16_f32 v210,v212,v213
v_fma_f32 v15,v214,s61,-s61
v_fma_f32 v22,v215,s61,-s61
v_exp_f32 v15,v15 clamp
v_exp_f32 v22,v22 clamp
v_max_f32 v214,v15,v214
v_max_f32 v215,v22,v215
v_add_f32 v214,s62,v214
v_add_f32 v215,s62,v215
v_cvt_pk_bf16_f32 v211,v214,v215
buffer_store_dwordx4 v[208:211],v4,s[40:43],s57 offen offset:2048 sc1
v_fma_f32 v15,v216,s61,-s61
v_fma_f32 v22,v217,s61,-s61
v_exp_f32 v15,v15 clamp
v_exp_f32 v22,v22 clamp
v_max_f32 v216,v15,v216
v_max_f32 v217,v22,v217
v_add_f32 v216,s62,v216
v_add_f32 v217,s62,v217
v_cvt_pk_bf16_f32 v212,v216,v217
v_fma_f32 v15,v218,s61,-s61
v_fma_f32 v22,v219,s61,-s61
v_exp_f32 v15,v15 clamp
v_exp_f32 v22,v22 clamp
v_max_f32 v218,v15,v218
v_max_f32 v219,v22,v219
v_add_f32 v218,s62,v218
v_add_f32 v219,s62,v219
v_cvt_pk_bf16_f32 v213,v218,v219
v_fma_f32 v15,v220,s61,-s61
v_fma_f32 v22,v221,s61,-s61
v_exp_f32 v15,v15 clamp
v_exp_f32 v22,v22 clamp
v_max_f32 v220,v15,v220
v_max_f32 v221,v22,v221
v_add_f32 v220,s62,v220
v_add_f32 v221,s62,v221
v_cvt_pk_bf16_f32 v214,v220,v221
v_fma_f32 v15,v222,s61,-s61
v_fma_f32 v22,v223,s61,-s61
v_exp_f32 v15,v15 clamp
v_exp_f32 v22,v22 clamp
v_max_f32 v222,v15,v222
v_max_f32 v223,v22,v223
v_add_f32 v222,s62,v222
v_add_f32 v223,s62,v223
v_cvt_pk_bf16_f32 v215,v222,v223
buffer_store_dwordx4 v[212:215],v4,s[40:43],s57 offen offset:2304 sc1
s_waitcnt vmcnt(7)
s_branch L_k1_end2
L_k1_p_bkv:
s_and_b32 s53,s50,1
s_lshl_b32 s53,s53,5
v_xor_b32 v26,s53,v26
s_mov_b32 s38,1572864
s_sub_u32 s53,s49,28
s_mul_i32 s51,s53,4
s_min_u32 s51,s51,60
s_mul_i32 s54,s51,64
s_add_u32 s54,s54,1024
s_mul_i32 s56,s50,24576
s_add_u32 s56,s56,s54
v_mul_u32_u24 v2,3072,v24
v_add_u32 v2,v2,v26
s_mov_b32 s52,4
v_mul_u32_u24 v27,960,v27
v_add_u32 v2,v2,v27
s_add_u32 s68,s53,4
s_add_u32 s68,s68,s48
s_and_b32 s68,s68,7
s_waitcnt lgkmcnt(0)
s_mov_b64 s[32:33],s[4:5]
s_mov_b64 s[36:37],s[18:19]
s_mov_b64 s[40:41],s[28:29]
s_add_u32 s53,s68,0
s_and_b32 s53,s53,7
s_mul_i32 s72,s53,196608
s_add_u32 s72,s72,s56
s_lshl_b32 s53,s53,7
s_add_u32 s80,s55,s53
s_add_u32 m0,s60,98304
s_add_u32 s53,s72,0
buffer_load_dwordx4 v2,s[36:39],s53 offen lds
s_add_u32 m0,s58,0
s_add_u32 s53,s80,0
buffer_load_dwordx4 v3,s[32:35],s53 offen lds
s_add_u32 m0,s58,1024
s_add_u32 s53,s80,16384
buffer_load_dwordx4 v3,s[32:35],s53 offen lds
s_add_u32 m0,s58,2048
s_add_u32 s53,s80,64
buffer_load_dwordx4 v3,s[32:35],s53 offen lds
s_add_u32 m0,s58,3072
s_add_u32 s53,s80,16448
buffer_load_dwordx4 v3,s[32:35],s53 offen lds
s_add_u32 m0,s60,106496
s_add_u32 s53,s72,64
buffer_load_dwordx4 v2,s[36:39],s53 offen lds
s_add_u32 s53,s68,1
s_and_b32 s53,s53,7
s_mul_i32 s73,s53,196608
s_add_u32 s73,s73,s56
s_lshl_b32 s53,s53,7
s_add_u32 s81,s55,s53
s_add_u32 m0,s60,114688
s_add_u32 s53,s72,128
buffer_load_dwordx4 v2,s[36:39],s53 offen lds
v_lshrrev_b32 v66,4,v1
v_bfe_u32 v65,v1,2,2
v_lshl_add_u32 v64,v66,3,v65
v_lshlrev_b32 v64,7,v64
v_xor_b32 v66,v65,v66
v_bfe_u32 v65,v1,3,1
v_lshl_add_u32 v64,v65,6,v64
v_bfe_u32 v65,v1,4,1
v_lshl_add_u32 v64,v65,5,v64
v_and_b32 v65,3,v1
v_lshl_add_u32 v64,v65,3,v64
v_add_u32 v5,65536,v64
v_xor_b32 v6,32,v5
v_xor_b32 v7,64,v5
v_xor_b32 v8,64,v6
v_and_b32 v64,15,v1
v_lshlrev_b32 v66,4,v66
v_lshl_add_u32 v64,v64,6,v66
v_add_u32 v9,s58,v64
s_lshr_b32 s54,s55,16
s_lshl_b32 s54,s54,15
s_bfe_u32 s57,s55,0x1000f
s_lshl_b32 s57,s57,13
s_add_u32 s54,s54,s57
v_lshrrev_b32 v4,4,v1
v_and_b32 v64,15,v1
v_lshlrev_b32 v64,4,v64
v_lshl_add_u32 v4,v4,9,v64
v_add_u32 v4,s54,v4
s_mov_b32 s61,0x3fb8aa3b
s_mov_b32 s71,0x3e0293ee
s_mov_b32 s62,0x358637bd
s_add_u32 m0,s60,122880
s_add_u32 s53,s72,192
buffer_load_dwordx4 v2,s[36:39],s53 offen lds
s_add_u32 m0,s58,4096
s_add_u32 s53,s81,0
buffer_load_dwordx4 v3,s[32:35],s53 offen lds
s_add_u32 m0,s58,5120
s_add_u32 s53,s81,16384
buffer_load_dwordx4 v3,s[32:35],s53 offen lds
s_add_u32 m0,s60,131072
s_add_u32 s53,s73,0
buffer_load_dwordx4 v2,s[36:39],s53 offen lds
s_add_u32 m0,s60,139264
s_add_u32 s53,s73,64
buffer_load_dwordx4 v2,s[36:39],s53 offen lds
s_add_u32 m0,s58,6144
s_add_u32 s53,s81,64
buffer_load_dwordx4 v3,s[32:35],s53 offen lds
s_add_u32 m0,s58,7168
s_add_u32 s53,s81,16448
buffer_load_dwordx4 v3,s[32:35],s53 offen lds
s_add_u32 m0,s60,147456
s_add_u32 s53,s73,128
buffer_load_dwordx4 v2,s[36:39],s53 offen lds
s_add_u32 m0,s60,155648
s_add_u32 s53,s73,192
buffer_load_dwordx4 v2,s[36:39],s53 offen lds
s_add_u32 s53,s68,2
s_and_b32 s53,s53,7
s_mul_i32 s74,s53,196608
s_add_u32 s74,s74,s56
s_lshl_b32 s53,s53,7
s_add_u32 s82,s55,s53
s_add_u32 s53,s68,3
s_and_b32 s53,s53,7
s_mul_i32 s75,s53,196608
s_add_u32 s75,s75,s56
s_lshl_b32 s53,s53,7
s_add_u32 s83,s55,s53
s_add_u32 s53,s68,4
s_and_b32 s53,s53,7
s_mul_i32 s76,s53,196608
s_add_u32 s76,s76,s56
s_lshl_b32 s53,s53,7
s_add_u32 s84,s55,s53
s_add_u32 s53,s68,5
s_and_b32 s53,s53,7
s_mul_i32 s77,s53,196608
s_add_u32 s77,s77,s56
s_lshl_b32 s53,s53,7
s_add_u32 s85,s55,s53
s_add_u32 s53,s68,6
s_and_b32 s53,s53,7
s_mul_i32 s78,s53,196608
s_add_u32 s78,s78,s56
s_lshl_b32 s53,s53,7
s_add_u32 s86,s55,s53
s_add_u32 s53,s68,7
s_and_b32 s53,s53,7
s_mul_i32 s79,s53,196608
s_add_u32 s79,s79,s56
s_lshl_b32 s53,s53,7
s_add_u32 s87,s55,s53
s_mov_b32 s16,s50
s_and_b32 s26,s98,7
s_lshr_b32 s27,s98,3
s_and_b32 s17,s27,3
s_lshl_b32 s26,s26,2
s_add_u32 s17,s17,s26
s_lshr_b32 s18,s27,2
s_lshl_b32 s26,s18,2
s_add_u32 s19,s26,s16
s_sub_u32 s27,67,s19
s_cmp_lt_u32 s16,4
s_cselect_b32 s19,s19,s27
s_cselect_b32 s28,1,0
s_waitcnt vmcnt(13)
ds_read_b128 v[80:83],v9 offset:0
ds_read_b128 v[84:87],v9 offset:1024
s_waitcnt vmcnt(11)
ds_read_b128 v[88:91],v9 offset:2048
ds_read_b128 v[92:95],v9 offset:3072
s_waitcnt vmcnt(9)
s_barrier
ds_read_b64_tr_b16 v[40:41],v5 offset:32768
ds_read_b64_tr_b16 v[42:43],v5 offset:33280
ds_read_b64_tr_b16 v[44:45],v6 offset:32768
ds_read_b64_tr_b16 v[46:47],v6 offset:33280
ds_read_b64_tr_b16 v[64:65],v7 offset:32768
ds_read_b64_tr_b16 v[66:67],v7 offset:33280
ds_read_b64_tr_b16 v[68:69],v8 offset:32768
ds_read_b64_tr_b16 v[70:71],v8 offset:33280
ds_read_b64_tr_b16 v[72:73],v5 offset:36864
ds_read_b64_tr_b16 v[74:75],v5 offset:37376
s_setprio 3
s_waitcnt lgkmcnt(8)
v_mfma_f32_16x16x32_bf16 v[24:27],v[80:83],v[40:43],1.0
s_add_u32 m0,s60,65536
s_add_u32 s53,s74,0
buffer_load_dwordx4 v2,s[36:39],s53 offen lds
ds_read_b64_tr_b16 v[76:77],v6 offset:36864
ds_read_b64_tr_b16 v[78:79],v6 offset:37376
v_mfma_f32_16x16x32_bf16 v[28:31],v[84:87],v[40:43],1.0
s_add_u32 m0,s58,0
s_add_u32 s53,s82,0
buffer_load_dwordx4 v3,s[32:35],s53 offen lds
s_waitcnt lgkmcnt(8)
v_mfma_f32_16x16x32_bf16 v[36:39],v[84:87],v[44:47],1.0
s_add_u32 m0,s60,73728
s_add_u32 s53,s74,64
buffer_load_dwordx4 v2,s[36:39],s53 offen lds
v_mfma_f32_16x16x32_bf16 v[32:35],v[80:83],v[44:47],1.0
s_add_u32 m0,s58,1024
s_add_u32 s53,s82,16384
buffer_load_dwordx4 v3,s[32:35],s53 offen lds
ds_read_b64_tr_b16 v[40:41],v7 offset:36864
ds_read_b64_tr_b16 v[42:43],v7 offset:37376
s_waitcnt lgkmcnt(8)
v_mfma_f32_16x16x32_bf16 v[48:51],v[80:83],v[64:67],0
ds_read_b64_tr_b16 v[44:45],v8 offset:36864
ds_read_b64_tr_b16 v[46:47],v8 offset:37376
v_mfma_f32_16x16x32_bf16 v[52:55],v[84:87],v[64:67],0
s_add_u32 m0,s58,2048
s_add_u32 s53,s82,64
buffer_load_dwordx4 v3,s[32:35],s53 offen lds
s_waitcnt lgkmcnt(8)
v_mfma_f32_16x16x32_bf16 v[60:63],v[84:87],v[68:71],0
s_add_u32 m0,s60,81920
s_add_u32 s53,s74,128
buffer_load_dwordx4 v2,s[36:39],s53 offen lds
v_mfma_f32_16x16x32_bf16 v[56:59],v[80:83],v[68:71],0
s_add_u32 m0,s58,3072
s_add_u32 s53,s82,16448
buffer_load_dwordx4 v3,s[32:35],s53 offen lds
ds_read_b64_tr_b16 v[64:65],v5 offset:40960
ds_read_b64_tr_b16 v[66:67],v5 offset:41472
s_setprio 2
s_waitcnt lgkmcnt(8)
v_mfma_f32_16x16x32_bf16 v[24:27],v[88:91],v[72:75],v[24:27]
ds_read_b64_tr_b16 v[68:69],v6 offset:40960
ds_read_b64_tr_b16 v[70:71],v6 offset:41472
v_mfma_f32_16x16x32_bf16 v[28:31],v[92:95],v[72:75],v[28:31]
s_add_u32 m0,s60,90112
s_add_u32 s53,s74,192
buffer_load_dwordx4 v2,s[36:39],s53 offen lds
s_waitcnt lgkmcnt(8)
v_mfma_f32_16x16x32_bf16 v[36:39],v[92:95],v[76:79],v[36:39]
v_mfma_f32_16x16x32_bf16 v[32:35],v[88:91],v[76:79],v[32:35]
ds_read_b64_tr_b16 v[72:73],v7 offset:40960
ds_read_b64_tr_b16 v[74:75],v7 offset:41472
s_waitcnt lgkmcnt(8)
v_mfma_f32_16x16x32_bf16 v[48:51],v[88:91],v[40:43],v[48:51]
ds_read_b64_tr_b16 v[76:77],v8 offset:40960
ds_read_b64_tr_b16 v[78:79],v8 offset:41472
v_mfma_f32_16x16x32_bf16 v[52:55],v[92:95],v[40:43],v[52:55]
s_waitcnt lgkmcnt(8)
v_mfma_f32_16x16x32_bf16 v[60:63],v[92:95],v[44:47],v[60:63]
v_mfma_f32_16x16x32_bf16 v[56:59],v[88:91],v[44:47],v[56:59]
ds_read_b64_tr_b16 v[40:41],v5 offset:45056
ds_read_b64_tr_b16 v[42:43],v5 offset:45568
s_setprio 1
s_waitcnt lgkmcnt(8)
v_mfma_f32_16x16x32_bf16 v[128:131],v[80:83],v[64:67],1.0
ds_read_b64_tr_b16 v[44:45],v6 offset:45056
ds_read_b64_tr_b16 v[46:47],v6 offset:45568
v_mfma_f32_16x16x32_bf16 v[132:135],v[84:87],v[64:67],1.0
s_waitcnt lgkmcnt(8)
v_mfma_f32_16x16x32_bf16 v[140:143],v[84:87],v[68:71],1.0
v_mfma_f32_16x16x32_bf16 v[136:139],v[80:83],v[68:71],1.0
ds_read_b64_tr_b16 v[64:65],v7 offset:45056
ds_read_b64_tr_b16 v[66:67],v7 offset:45568
s_waitcnt lgkmcnt(8)
v_mfma_f32_16x16x32_bf16 v[144:147],v[80:83],v[72:75],0
ds_read_b64_tr_b16 v[68:69],v8 offset:45056
ds_read_b64_tr_b16 v[70:71],v8 offset:45568
v_mfma_f32_16x16x32_bf16 v[148:151],v[84:87],v[72:75],0
s_waitcnt lgkmcnt(8)
v_mfma_f32_16x16x32_bf16 v[156:159],v[84:87],v[76:79],0
v_mfma_f32_16x16x32_bf16 v[152:155],v[80:83],v[76:79],0
ds_read_b64_tr_b16 v[72:73],v5 offset:49152
ds_read_b64_tr_b16 v[74:75],v5 offset:49664
s_setprio 0
s_waitcnt lgkmcnt(8)
v_mfma_f32_16x16x32_bf16 v[128:131],v[88:91],v[40:43],v[128:131]
ds_read_b64_tr_b16 v[76:77],v6 offset:49152
ds_read_b64_tr_b16 v[78:79],v6 offset:49664
v_mfma_f32_16x16x32_bf16 v[132:135],v[92:95],v[40:43],v[132:135]
s_waitcnt lgkmcnt(8)
v_mfma_f32_16x16x32_bf16 v[140:143],v[92:95],v[44:47],v[140:143]
v_mfma_f32_16x16x32_bf16 v[136:139],v[88:91],v[44:47],v[136:139]
ds_read_b64_tr_b16 v[40:41],v7 offset:49152
ds_read_b64_tr_b16 v[42:43],v7 offset:49664
s_waitcnt lgkmcnt(8)
v_mfma_f32_16x16x32_bf16 v[144:147],v[88:91],v[64:67],v[144:147]
ds_read_b64_tr_b16 v[44:45],v8 offset:49152
ds_read_b64_tr_b16 v[46:47],v8 offset:49664
v_mfma_f32_16x16x32_bf16 v[148:151],v[92:95],v[64:67],v[148:151]
s_waitcnt lgkmcnt(8)
v_mfma_f32_16x16x32_bf16 v[156:159],v[92:95],v[68:71],v[156:159]
v_mfma_f32_16x16x32_bf16 v[152:155],v[88:91],v[68:71],v[152:155]
s_waitcnt vmcnt(13)
s_barrier
ds_read_b64_tr_b16 v[64:65],v5 offset:53248
ds_read_b64_tr_b16 v[66:67],v5 offset:53760
s_setprio 3
s_waitcnt lgkmcnt(8)
v_mfma_f32_16x16x32_bf16 v[160:163],v[80:83],v[72:75],1.0
ds_read_b64_tr_b16 v[68:69],v6 offset:53248
ds_read_b64_tr_b16 v[70:71],v6 offset:53760
v_mfma_f32_16x16x32_bf16 v[164:167],v[84:87],v[72:75],1.0
s_add_u32 m0,s60,98304
s_add_u32 s53,s75,0
buffer_load_dwordx4 v2,s[36:39],s53 offen lds
s_waitcnt lgkmcnt(8)
v_mfma_f32_16x16x32_bf16 v[172:175],v[84:87],v[76:79],1.0
v_mfma_f32_16x16x32_bf16 v[168:171],v[80:83],v[76:79],1.0
ds_read_b64_tr_b16 v[72:73],v7 offset:53248
ds_read_b64_tr_b16 v[74:75],v7 offset:53760
s_waitcnt lgkmcnt(8)
v_mfma_f32_16x16x32_bf16 v[176:179],v[80:83],v[40:43],0
ds_read_b64_tr_b16 v[76:77],v8 offset:53248
ds_read_b64_tr_b16 v[78:79],v8 offset:53760
v_mfma_f32_16x16x32_bf16 v[180:183],v[84:87],v[40:43],0
ds_read_b128 v[96:99],v9 offset:4096
ds_read_b128 v[100:103],v9 offset:5120
s_waitcnt lgkmcnt(10)
v_mfma_f32_16x16x32_bf16 v[188:191],v[84:87],v[44:47],0
v_mfma_f32_16x16x32_bf16 v[184:187],v[80:83],v[44:47],0
s_add_u32 m0,s60,106496
s_add_u32 s53,s75,64
buffer_load_dwordx4 v2,s[36:39],s53 offen lds
ds_read_b64_tr_b16 v[40:41],v5 offset:57344
ds_read_b64_tr_b16 v[42:43],v5 offset:57856
s_setprio 2
s_waitcnt lgkmcnt(10)
v_mfma_f32_16x16x32_bf16 v[160:163],v[88:91],v[64:67],v[160:163]
ds_read_b64_tr_b16 v[44:45],v6 offset:57344
ds_read_b64_tr_b16 v[46:47],v6 offset:57856
v_mfma_f32_16x16x32_bf16 v[164:167],v[92:95],v[64:67],v[164:167]
v_lshlrev_b32 v23,4,v1
s_add_u32 s88,s68,0
s_and_b32 s88,s88,7
s_lshl_b32 s88,s88,12
s_add_u32 s88,s88,s55
s_add_u32 s88,s88,41943040
s_waitcnt lgkmcnt(10)
v_mfma_f32_16x16x32_bf16 v[172:175],v[92:95],v[68:71],v[172:175]
v_mfma_f32_16x16x32_bf16 v[168:171],v[88:91],v[68:71],v[168:171]
ds_read_b64_tr_b16 v[64:65],v7 offset:57344
ds_read_b64_tr_b16 v[66:67],v7 offset:57856
s_waitcnt lgkmcnt(10)
v_mfma_f32_16x16x32_bf16 v[176:179],v[88:91],v[72:75],v[176:179]
ds_read_b64_tr_b16 v[68:69],v8 offset:57344
ds_read_b64_tr_b16 v[70:71],v8 offset:57856
v_mfma_f32_16x16x32_bf16 v[180:183],v[92:95],v[72:75],v[180:183]
buffer_store_dwordx4 v[80:83],v23,s[40:43],s88 offen offset:0 sc1
s_waitcnt lgkmcnt(10)
v_mfma_f32_16x16x32_bf16 v[188:191],v[92:95],v[76:79],v[188:191]
v_mfma_f32_16x16x32_bf16 v[184:187],v[88:91],v[76:79],v[184:187]
ds_read_b64_tr_b16 v[72:73],v5 offset:61440
ds_read_b64_tr_b16 v[74:75],v5 offset:61952
s_setprio 1
s_waitcnt lgkmcnt(8)
v_mfma_f32_16x16x32_bf16 v[192:195],v[80:83],v[40:43],1.0
s_add_u32 m0,s58,4096
s_add_u32 s53,s83,0
buffer_load_dwordx4 v3,s[32:35],s53 offen lds
ds_read_b64_tr_b16 v[76:77],v6 offset:61440
ds_read_b64_tr_b16 v[78:79],v6 offset:61952
v_mfma_f32_16x16x32_bf16 v[196:199],v[84:87],v[40:43],1.0
buffer_store_dwordx4 v[84:87],v23,s[40:43],s88 offen offset:1024 sc1
s_waitcnt lgkmcnt(8)
v_mfma_f32_16x16x32_bf16 v[204:207],v[84:87],v[44:47],1.0
v_mfma_f32_16x16x32_bf16 v[200:203],v[80:83],v[44:47],1.0
s_add_u32 m0,s58,5120
s_add_u32 s53,s83,16384
buffer_load_dwordx4 v3,s[32:35],s53 offen lds
ds_read_b64_tr_b16 v[40:41],v7 offset:61440
ds_read_b64_tr_b16 v[42:43],v7 offset:61952
s_waitcnt lgkmcnt(8)
v_mfma_f32_16x16x32_bf16 v[208:211],v[80:83],v[64:67],0
ds_read_b64_tr_b16 v[44:45],v8 offset:61440
ds_read_b64_tr_b16 v[46:47],v8 offset:61952
v_mfma_f32_16x16x32_bf16 v[212:215],v[84:87],v[64:67],0
buffer_store_dwordx4 v[88:91],v23,s[40:43],s88 offen offset:2048 sc1
s_waitcnt lgkmcnt(8)
v_mfma_f32_16x16x32_bf16 v[220:223],v[84:87],v[68:71],0
v_mfma_f32_16x16x32_bf16 v[216:219],v[80:83],v[68:71],0
v_add_u32 v5,0x10000,v5
ds_read_b64_tr_b16 v[64:65],v5 offset:0
ds_read_b64_tr_b16 v[66:67],v5 offset:512
s_setprio 0
s_waitcnt lgkmcnt(8)
v_mfma_f32_16x16x32_bf16 v[192:195],v[88:91],v[72:75],v[192:195]
s_waitcnt vmcnt(17)
ds_read_b128 v[104:107],v9 offset:6144
ds_read_b128 v[108:111],v9 offset:7168
v_add_u32 v6,0x10000,v6
ds_read_b64_tr_b16 v[68:69],v6 offset:0
ds_read_b64_tr_b16 v[70:71],v6 offset:512
v_mfma_f32_16x16x32_bf16 v[196:199],v[92:95],v[72:75],v[196:199]
buffer_store_dwordx4 v[92:95],v23,s[40:43],s88 offen offset:3072 sc1
s_waitcnt lgkmcnt(10)
v_mfma_f32_16x16x32_bf16 v[204:207],v[92:95],v[76:79],v[204:207]
v_mfma_f32_16x16x32_bf16 v[200:203],v[88:91],v[76:79],v[200:203]
v_add_u32 v7,0x10000,v7
ds_read_b64_tr_b16 v[72:73],v7 offset:0
ds_read_b64_tr_b16 v[74:75],v7 offset:512
s_waitcnt lgkmcnt(10)
v_mfma_f32_16x16x32_bf16 v[208:211],v[88:91],v[40:43],v[208:211]
v_add_u32 v8,0x10000,v8
ds_read_b64_tr_b16 v[76:77],v8 offset:0
ds_read_b64_tr_b16 v[78:79],v8 offset:512
v_mfma_f32_16x16x32_bf16 v[212:215],v[92:95],v[40:43],v[212:215]
s_waitcnt lgkmcnt(10)
v_mfma_f32_16x16x32_bf16 v[220:223],v[92:95],v[44:47],v[220:223]
v_mfma_f32_16x16x32_bf16 v[216:219],v[88:91],v[44:47],v[216:219]
s_waitcnt vmcnt(15)
s_barrier
ds_read_b64_tr_b16 v[40:41],v5 offset:4096
ds_read_b64_tr_b16 v[42:43],v5 offset:4608
s_setprio 3
s_waitcnt lgkmcnt(10)
v_mfma_f32_16x16x32_bf16 v[24:27],v[96:99],v[64:67],v[24:27]
ds_read_b64_tr_b16 v[44:45],v6 offset:4096
ds_read_b64_tr_b16 v[46:47],v6 offset:4608
v_mfma_f32_16x16x32_bf16 v[28:31],v[100:103],v[64:67],v[28:31]
s_add_u32 m0,s60,114688
s_add_u32 s53,s75,128
buffer_load_dwordx4 v2,s[36:39],s53 offen lds
s_waitcnt lgkmcnt(8)
v_mfma_f32_16x16x32_bf16 v[36:39],v[100:103],v[68:71],v[36:39]
v_mfma_f32_16x16x32_bf16 v[32:35],v[96:99],v[68:71],v[32:35]
ds_read_b64_tr_b16 v[64:65],v7 offset:4096
ds_read_b64_tr_b16 v[66:67],v7 offset:4608
s_waitcnt lgkmcnt(8)
v_mfma_f32_16x16x32_bf16 v[48:51],v[96:99],v[72:75],v[48:51]
ds_read_b64_tr_b16 v[68:69],v8 offset:4096
ds_read_b64_tr_b16 v[70:71],v8 offset:4608
v_mfma_f32_16x16x32_bf16 v[52:55],v[100:103],v[72:75],v[52:55]
s_add_u32 m0,s58,6144
s_add_u32 s53,s83,64
buffer_load_dwordx4 v3,s[32:35],s53 offen lds
s_waitcnt lgkmcnt(8)
v_mfma_f32_16x16x32_bf16 v[60:63],v[100:103],v[76:79],v[60:63]
v_mfma_f32_16x16x32_bf16 v[56:59],v[96:99],v[76:79],v[56:59]
s_add_u32 m0,s58,7168
s_add_u32 s53,s83,16448
buffer_load_dwordx4 v3,s[32:35],s53 offen lds
ds_read_b64_tr_b16 v[72:73],v5 offset:8192
ds_read_b64_tr_b16 v[74:75],v5 offset:8704
s_waitcnt lgkmcnt(8)
v_mfma_f32_16x16x32_bf16 v[24:27],v[104:107],v[40:43],v[24:27]
ds_read_b64_tr_b16 v[76:77],v6 offset:8192
ds_read_b64_tr_b16 v[78:79],v6 offset:8704
v_mfma_f32_16x16x32_bf16 v[28:31],v[108:111],v[40:43],v[28:31]
s_waitcnt lgkmcnt(8)
v_mfma_f32_16x16x32_bf16 v[36:39],v[108:111],v[44:47],v[36:39]
v_mfma_f32_16x16x32_bf16 v[32:35],v[104:107],v[44:47],v[32:35]
ds_read_b64_tr_b16 v[40:41],v7 offset:8192
ds_read_b64_tr_b16 v[42:43],v7 offset:8704
s_waitcnt lgkmcnt(8)
v_mfma_f32_16x16x32_bf16 v[48:51],v[104:107],v[64:67],v[48:51]
s_add_u32 m0,s60,122880
s_add_u32 s53,s75,192
buffer_load_dwordx4 v2,s[36:39],s53 offen lds
ds_read_b64_tr_b16 v[44:45],v8 offset:8192
ds_read_b64_tr_b16 v[46:47],v8 offset:8704
v_mfma_f32_16x16x32_bf16 v[52:55],v[108:111],v[64:67],v[52:55]
s_waitcnt vmcnt(16)
ds_read_b128 v[112:115],v9 offset:0
ds_read_b128 v[116:119],v9 offset:1024
s_waitcnt lgkmcnt(10)
v_mfma_f32_16x16x32_bf16 v[60:63],v[108:111],v[68:71],v[60:63]
v_mfma_f32_16x16x32_bf16 v[56:59],v[104:107],v[68:71],v[56:59]
ds_read_b64_tr_b16 v[64:65],v5 offset:12288
ds_read_b64_tr_b16 v[66:67],v5 offset:12800
s_setprio 2
s_waitcnt lgkmcnt(10)
v_mfma_f32_16x16x32_bf16 v[128:131],v[96:99],v[72:75],v[128:131]
ds_read_b64_tr_b16 v[68:69],v6 offset:12288
ds_read_b64_tr_b16 v[70:71],v6 offset:12800
v_mfma_f32_16x16x32_bf16 v[132:135],v[100:103],v[72:75],v[132:135]
s_waitcnt lgkmcnt(10)
v_mfma_f32_16x16x32_bf16 v[140:143],v[100:103],v[76:79],v[140:143]
v_mfma_f32_16x16x32_bf16 v[136:139],v[96:99],v[76:79],v[136:139]
ds_read_b64_tr_b16 v[72:73],v7 offset:12288
ds_read_b64_tr_b16 v[74:75],v7 offset:12800
s_waitcnt lgkmcnt(10)
v_mfma_f32_16x16x32_bf16 v[144:147],v[96:99],v[40:43],v[144:147]
ds_read_b64_tr_b16 v[76:77],v8 offset:12288
ds_read_b64_tr_b16 v[78:79],v8 offset:12800
v_mfma_f32_16x16x32_bf16 v[148:151],v[100:103],v[40:43],v[148:151]
s_waitcnt lgkmcnt(10)
v_mfma_f32_16x16x32_bf16 v[156:159],v[100:103],v[44:47],v[156:159]
v_mfma_f32_16x16x32_bf16 v[152:155],v[96:99],v[44:47],v[152:155]
ds_read_b64_tr_b16 v[40:41],v5 offset:16384
ds_read_b64_tr_b16 v[42:43],v5 offset:16896
s_waitcnt lgkmcnt(8)
v_mfma_f32_16x16x32_bf16 v[128:131],v[104:107],v[64:67],v[128:131]
ds_read_b64_tr_b16 v[44:45],v6 offset:16384
ds_read_b64_tr_b16 v[46:47],v6 offset:16896
v_mfma_f32_16x16x32_bf16 v[132:135],v[108:111],v[64:67],v[132:135]
s_add_u32 m0,s58,0
s_add_u32 s53,s84,0
buffer_load_dwordx4 v3,s[32:35],s53 offen lds
s_waitcnt lgkmcnt(8)
v_mfma_f32_16x16x32_bf16 v[140:143],v[108:111],v[68:71],v[140:143]
v_mfma_f32_16x16x32_bf16 v[136:139],v[104:107],v[68:71],v[136:139]
s_add_u32 m0,s58,1024
s_add_u32 s53,s84,16384
buffer_load_dwordx4 v3,s[32:35],s53 offen lds
ds_read_b64_tr_b16 v[64:65],v7 offset:16384
ds_read_b64_tr_b16 v[66:67],v7 offset:16896
s_waitcnt lgkmcnt(8)
v_mfma_f32_16x16x32_bf16 v[144:147],v[104:107],v[72:75],v[144:147]
ds_read_b64_tr_b16 v[68:69],v8 offset:16384
ds_read_b64_tr_b16 v[70:71],v8 offset:16896
v_mfma_f32_16x16x32_bf16 v[148:151],v[108:111],v[72:75],v[148:151]
s_waitcnt lgkmcnt(8)
v_mfma_f32_16x16x32_bf16 v[156:159],v[108:111],v[76:79],v[156:159]
v_mfma_f32_16x16x32_bf16 v[152:155],v[104:107],v[76:79],v[152:155]
ds_read_b64_tr_b16 v[72:73],v5 offset:20480
ds_read_b64_tr_b16 v[74:75],v5 offset:20992
s_setprio 1
s_waitcnt lgkmcnt(8)
v_mfma_f32_16x16x32_bf16 v[160:163],v[96:99],v[40:43],v[160:163]
ds_read_b64_tr_b16 v[76:77],v6 offset:20480
ds_read_b64_tr_b16 v[78:79],v6 offset:20992
v_mfma_f32_16x16x32_bf16 v[164:167],v[100:103],v[40:43],v[164:167]
s_waitcnt lgkmcnt(8)
v_mfma_f32_16x16x32_bf16 v[172:175],v[100:103],v[44:47],v[172:175]
v_mfma_f32_16x16x32_bf16 v[168:171],v[96:99],v[44:47],v[168:171]
s_waitcnt vmcnt(15)
ds_read_b128 v[120:123],v9 offset:2048
ds_read_b128 v[124:127],v9 offset:3072
ds_read_b64_tr_b16 v[40:41],v7 offset:20480
ds_read_b64_tr_b16 v[42:43],v7 offset:20992
s_waitcnt lgkmcnt(10)
v_mfma_f32_16x16x32_bf16 v[176:179],v[96:99],v[64:67],v[176:179]
ds_read_b64_tr_b16 v[44:45],v8 offset:20480
ds_read_b64_tr_b16 v[46:47],v8 offset:20992
v_mfma_f32_16x16x32_bf16 v[180:183],v[100:103],v[64:67],v[180:183]
s_waitcnt lgkmcnt(10)
v_mfma_f32_16x16x32_bf16 v[188:191],v[100:103],v[68:71],v[188:191]
v_mfma_f32_16x16x32_bf16 v[184:187],v[96:99],v[68:71],v[184:187]
ds_read_b64_tr_b16 v[64:65],v5 offset:24576
ds_read_b64_tr_b16 v[66:67],v5 offset:25088
s_waitcnt lgkmcnt(10)
v_mfma_f32_16x16x32_bf16 v[160:163],v[104:107],v[72:75],v[160:163]
ds_read_b64_tr_b16 v[68:69],v6 offset:24576
ds_read_b64_tr_b16 v[70:71],v6 offset:25088
v_mfma_f32_16x16x32_bf16 v[164:167],v[108:111],v[72:75],v[164:167]
s_waitcnt lgkmcnt(10)
v_mfma_f32_16x16x32_bf16 v[172:175],v[108:111],v[76:79],v[172:175]
v_mfma_f32_16x16x32_bf16 v[168:171],v[104:107],v[76:79],v[168:171]
ds_read_b64_tr_b16 v[72:73],v7 offset:24576
ds_read_b64_tr_b16 v[74:75],v7 offset:25088
s_waitcnt lgkmcnt(8)
v_mfma_f32_16x16x32_bf16 v[176:179],v[104:107],v[40:43],v[176:179]
ds_read_b64_tr_b16 v[76:77],v8 offset:24576
ds_read_b64_tr_b16 v[78:79],v8 offset:25088
v_mfma_f32_16x16x32_bf16 v[180:183],v[108:111],v[40:43],v[180:183]
s_waitcnt lgkmcnt(8)
v_mfma_f32_16x16x32_bf16 v[188:191],v[108:111],v[44:47],v[188:191]
v_mfma_f32_16x16x32_bf16 v[184:187],v[104:107],v[44:47],v[184:187]
s_add_u32 m0,s58,2048
s_add_u32 s53,s84,64
buffer_load_dwordx4 v3,s[32:35],s53 offen lds
ds_read_b64_tr_b16 v[40:41],v5 offset:28672
ds_read_b64_tr_b16 v[42:43],v5 offset:29184
s_setprio 0
s_waitcnt lgkmcnt(8)
v_mfma_f32_16x16x32_bf16 v[192:195],v[96:99],v[64:67],v[192:195]
ds_read_b64_tr_b16 v[44:45],v6 offset:28672
ds_read_b64_tr_b16 v[46:47],v6 offset:29184
v_mfma_f32_16x16x32_bf16 v[196:199],v[100:103],v[64:67],v[196:199]
s_add_u32 m0,s58,3072
s_add_u32 s53,s84,16448
buffer_load_dwordx4 v3,s[32:35],s53 offen lds
s_waitcnt lgkmcnt(8)
v_mfma_f32_16x16x32_bf16 v[204:207],v[100:103],v[68:71],v[204:207]
v_mfma_f32_16x16x32_bf16 v[200:203],v[96:99],v[68:71],v[200:203]
ds_read_b64_tr_b16 v[64:65],v7 offset:28672
ds_read_b64_tr_b16 v[66:67],v7 offset:29184
s_waitcnt lgkmcnt(8)
v_mfma_f32_16x16x32_bf16 v[208:211],v[96:99],v[72:75],v[208:211]
ds_read_b64_tr_b16 v[68:69],v8 offset:28672
ds_read_b64_tr_b16 v[70:71],v8 offset:29184
v_mfma_f32_16x16x32_bf16 v[212:215],v[100:103],v[72:75],v[212:215]
s_waitcnt lgkmcnt(8)
v_mfma_f32_16x16x32_bf16 v[220:223],v[100:103],v[76:79],v[220:223]
v_mfma_f32_16x16x32_bf16 v[216:219],v[96:99],v[76:79],v[216:219]
s_waitcnt vmcnt(10)
ds_read_b128 v[240:243],v9 offset:4096
ds_read_b128 v[244:247],v9 offset:5120
v_add_u32 v5,0xffff0000,v5
ds_read_b64_tr_b16 v[72:73],v5 offset:0
ds_read_b64_tr_b16 v[74:75],v5 offset:512
s_waitcnt lgkmcnt(10)
v_mfma_f32_16x16x32_bf16 v[192:195],v[104:107],v[40:43],v[192:195]
v_add_u32 v6,0xffff0000,v6
ds_read_b64_tr_b16 v[76:77],v6 offset:0
ds_read_b64_tr_b16 v[78:79],v6 offset:512
v_mfma_f32_16x16x32_bf16 v[196:199],v[108:111],v[40:43],v[196:199]
s_waitcnt lgkmcnt(10)
v_mfma_f32_16x16x32_bf16 v[204:207],v[108:111],v[44:47],v[204:207]
v_mfma_f32_16x16x32_bf16 v[200:203],v[104:107],v[44:47],v[200:203]
v_add_u32 v7,0xffff0000,v7
ds_read_b64_tr_b16 v[40:41],v7 offset:0
ds_read_b64_tr_b16 v[42:43],v7 offset:512
s_waitcnt lgkmcnt(10)
v_mfma_f32_16x16x32_bf16 v[208:211],v[104:107],v[64:67],v[208:211]
v_add_u32 v8,0xffff0000,v8
ds_read_b64_tr_b16 v[44:45],v8 offset:0
ds_read_b64_tr_b16 v[46:47],v8 offset:512
v_mfma_f32_16x16x32_bf16 v[212:215],v[108:111],v[64:67],v[212:215]
s_waitcnt lgkmcnt(10)
v_mfma_f32_16x16x32_bf16 v[220:223],v[108:111],v[68:71],v[220:223]
v_mfma_f32_16x16x32_bf16 v[216:219],v[104:107],v[68:71],v[216:219]
s_barrier
ds_read_b64_tr_b16 v[64:65],v5 offset:4096
ds_read_b64_tr_b16 v[66:67],v5 offset:4608
s_setprio 3
s_waitcnt lgkmcnt(8)
v_mfma_f32_16x16x32_bf16 v[24:27],v[112:115],v[72:75],v[24:27]
ds_read_b64_tr_b16 v[68:69],v6 offset:4096
ds_read_b64_tr_b16 v[70:71],v6 offset:4608
v_mfma_f32_16x16x32_bf16 v[28:31],v[116:119],v[72:75],v[28:31]
s_add_u32 m0,s60,131072
s_add_u32 s53,s76,0
buffer_load_dwordx4 v2,s[36:39],s53 offen lds
s_waitcnt lgkmcnt(8)
v_mfma_f32_16x16x32_bf16 v[36:39],v[116:119],v[76:79],v[36:39]
v_mfma_f32_16x16x32_bf16 v[32:35],v[112:115],v[76:79],v[32:35]
s_add_u32 m0,s58,4096
s_add_u32 s53,s85,0
buffer_load_dwordx4 v3,s[32:35],s53 offen lds
ds_read_b64_tr_b16 v[72:73],v7 offset:4096
ds_read_b64_tr_b16 v[74:75],v7 offset:4608
s_waitcnt lgkmcnt(8)
v_mfma_f32_16x16x32_bf16 v[48:51],v[112:115],v[40:43],v[48:51]
s_add_u32 m0,s58,5120
s_add_u32 s53,s85,16384
buffer_load_dwordx4 v3,s[32:35],s53 offen lds
ds_read_b64_tr_b16 v[76:77],v8 offset:4096
ds_read_b64_tr_b16 v[78:79],v8 offset:4608
v_mfma_f32_16x16x32_bf16 v[52:55],v[116:119],v[40:43],v[52:55]
s_cmp_lg_u32 s50,0
s_cbranch_scc1 L_tag13
s_cmp_lg_u32 s101,0
s_cbranch_scc1 L_tag13
buffer_load_dword v14,off,s[92:95],0 sc1
L_tag13:
s_waitcnt lgkmcnt(8)
v_mfma_f32_16x16x32_bf16 v[60:63],v[116:119],v[44:47],v[60:63]
v_mfma_f32_16x16x32_bf16 v[56:59],v[112:115],v[44:47],v[56:59]
s_add_u32 m0,s60,139264
s_add_u32 s53,s77,0
buffer_load_dwordx4 v2,s[36:39],s53 offen lds
ds_read_b64_tr_b16 v[40:41],v5 offset:8192
ds_read_b64_tr_b16 v[42:43],v5 offset:8704
s_waitcnt lgkmcnt(8)
v_mfma_f32_16x16x32_bf16 v[24:27],v[120:123],v[64:67],v[24:27]
ds_read_b64_tr_b16 v[44:45],v6 offset:8192
ds_read_b64_tr_b16 v[46:47],v6 offset:8704
v_mfma_f32_16x16x32_bf16 v[28:31],v[124:127],v[64:67],v[28:31]
s_waitcnt lgkmcnt(8)
v_mfma_f32_16x16x32_bf16 v[36:39],v[124:127],v[68:71],v[36:39]
v_mfma_f32_16x16x32_bf16 v[32:35],v[120:123],v[68:71],v[32:35]
s_waitcnt vmcnt(9)
ds_read_b128 v[248:251],v9 offset:6144
ds_read_b128 v[252:255],v9 offset:7168
ds_read_b64_tr_b16 v[64:65],v7 offset:8192
ds_read_b64_tr_b16 v[66:67],v7 offset:8704
s_waitcnt lgkmcnt(10)
v_mfma_f32_16x16x32_bf16 v[48:51],v[120:123],v[72:75],v[48:51]
ds_read_b64_tr_b16 v[68:69],v8 offset:8192
ds_read_b64_tr_b16 v[70:71],v8 offset:8704
v_mfma_f32_16x16x32_bf16 v[52:55],v[124:127],v[72:75],v[52:55]
s_add_u32 m0,s60,147456
s_add_u32 s53,s78,0
buffer_load_dwordx4 v2,s[36:39],s53 offen lds
s_waitcnt lgkmcnt(10)
v_mfma_f32_16x16x32_bf16 v[60:63],v[124:127],v[76:79],v[60:63]
v_mfma_f32_16x16x32_bf16 v[56:59],v[120:123],v[76:79],v[56:59]
ds_read_b64_tr_b16 v[72:73],v5 offset:12288
ds_read_b64_tr_b16 v[74:75],v5 offset:12800
s_setprio 2
s_waitcnt lgkmcnt(10)
v_mfma_f32_16x16x32_bf16 v[128:131],v[112:115],v[40:43],v[128:131]
ds_read_b64_tr_b16 v[76:77],v6 offset:12288
ds_read_b64_tr_b16 v[78:79],v6 offset:12800
v_mfma_f32_16x16x32_bf16 v[132:135],v[116:119],v[40:43],v[132:135]
s_waitcnt lgkmcnt(10)
v_mfma_f32_16x16x32_bf16 v[140:143],v[116:119],v[44:47],v[140:143]
v_mfma_f32_16x16x32_bf16 v[136:139],v[112:115],v[44:47],v[136:139]
s_add_u32 m0,s60,155648
s_add_u32 s53,s79,0
buffer_load_dwordx4 v2,s[36:39],s53 offen lds
ds_read_b64_tr_b16 v[40:41],v7 offset:12288
ds_read_b64_tr_b16 v[42:43],v7 offset:12800
s_waitcnt lgkmcnt(8)
v_mfma_f32_16x16x32_bf16 v[144:147],v[112:115],v[64:67],v[144:147]
ds_read_b64_tr_b16 v[44:45],v8 offset:12288
ds_read_b64_tr_b16 v[46:47],v8 offset:12800
v_mfma_f32_16x16x32_bf16 v[148:151],v[116:119],v[64:67],v[148:151]
s_waitcnt lgkmcnt(8)
v_mfma_f32_16x16x32_bf16 v[156:159],v[116:119],v[68:71],v[156:159]
v_mfma_f32_16x16x32_bf16 v[152:155],v[112:115],v[68:71],v[152:155]
s_add_u32 m0,s58,6144
s_add_u32 s53,s85,64
buffer_load_dwordx4 v3,s[32:35],s53 offen lds
ds_read_b64_tr_b16 v[64:65],v5 offset:16384
ds_read_b64_tr_b16 v[66:67],v5 offset:16896
s_waitcnt lgkmcnt(8)
v_mfma_f32_16x16x32_bf16 v[128:131],v[120:123],v[72:75],v[128:131]
ds_read_b64_tr_b16 v[68:69],v6 offset:16384
ds_read_b64_tr_b16 v[70:71],v6 offset:16896
v_mfma_f32_16x16x32_bf16 v[132:135],v[124:127],v[72:75],v[132:135]
s_add_u32 m0,s58,7168
s_add_u32 s53,s85,16448
buffer_load_dwordx4 v3,s[32:35],s53 offen lds
s_waitcnt lgkmcnt(8)
v_mfma_f32_16x16x32_bf16 v[140:143],v[124:127],v[76:79],v[140:143]
v_mfma_f32_16x16x32_bf16 v[136:139],v[120:123],v[76:79],v[136:139]
ds_read_b64_tr_b16 v[72:73],v7 offset:16384
ds_read_b64_tr_b16 v[74:75],v7 offset:16896
s_waitcnt lgkmcnt(8)
v_mfma_f32_16x16x32_bf16 v[144:147],v[120:123],v[40:43],v[144:147]
ds_read_b64_tr_b16 v[76:77],v8 offset:16384
ds_read_b64_tr_b16 v[78:79],v8 offset:16896
v_mfma_f32_16x16x32_bf16 v[148:151],v[124:127],v[40:43],v[148:151]
s_waitcnt lgkmcnt(8)
v_mfma_f32_16x16x32_bf16 v[156:159],v[124:127],v[44:47],v[156:159]
v_mfma_f32_16x16x32_bf16 v[152:155],v[120:123],v[44:47],v[152:155]
ds_read_b64_tr_b16 v[40:41],v5 offset:20480
ds_read_b64_tr_b16 v[42:43],v5 offset:20992
s_setprio 1
s_waitcnt lgkmcnt(8)
v_mfma_f32_16x16x32_bf16 v[160:163],v[112:115],v[64:67],v[160:163]
ds_read_b64_tr_b16 v[44:45],v6 offset:20480
ds_read_b64_tr_b16 v[46:47],v6 offset:20992
v_mfma_f32_16x16x32_bf16 v[164:167],v[116:119],v[64:67],v[164:167]
s_waitcnt vmcnt(10)
ds_read_b128 v[80:83],v9 offset:0
ds_read_b128 v[84:87],v9 offset:1024
s_waitcnt lgkmcnt(10)
v_mfma_f32_16x16x32_bf16 v[172:175],v[116:119],v[68:71],v[172:175]
v_mfma_f32_16x16x32_bf16 v[168:171],v[112:115],v[68:71],v[168:171]
ds_read_b64_tr_b16 v[64:65],v7 offset:20480
ds_read_b64_tr_b16 v[66:67],v7 offset:20992
s_waitcnt lgkmcnt(10)
v_mfma_f32_16x16x32_bf16 v[176:179],v[112:115],v[72:75],v[176:179]
ds_read_b64_tr_b16 v[68:69],v8 offset:20480
ds_read_b64_tr_b16 v[70:71],v8 offset:20992
v_mfma_f32_16x16x32_bf16 v[180:183],v[116:119],v[72:75],v[180:183]
s_waitcnt lgkmcnt(10)
v_mfma_f32_16x16x32_bf16 v[188:191],v[116:119],v[76:79],v[188:191]
v_mfma_f32_16x16x32_bf16 v[184:187],v[112:115],v[76:79],v[184:187]
ds_read_b64_tr_b16 v[72:73],v5 offset:24576
ds_read_b64_tr_b16 v[74:75],v5 offset:25088
s_waitcnt lgkmcnt(10)
v_mfma_f32_16x16x32_bf16 v[160:163],v[120:123],v[40:43],v[160:163]
ds_read_b64_tr_b16 v[76:77],v6 offset:24576
ds_read_b64_tr_b16 v[78:79],v6 offset:25088
v_mfma_f32_16x16x32_bf16 v[164:167],v[124:127],v[40:43],v[164:167]
s_waitcnt lgkmcnt(10)
v_mfma_f32_16x16x32_bf16 v[172:175],v[124:127],v[44:47],v[172:175]
v_mfma_f32_16x16x32_bf16 v[168:171],v[120:123],v[44:47],v[168:171]
ds_read_b64_tr_b16 v[40:41],v7 offset:24576
ds_read_b64_tr_b16 v[42:43],v7 offset:25088
s_waitcnt lgkmcnt(8)
v_mfma_f32_16x16x32_bf16 v[176:179],v[120:123],v[64:67],v[176:179]
ds_read_b64_tr_b16 v[44:45],v8 offset:24576
ds_read_b64_tr_b16 v[46:47],v8 offset:25088
v_mfma_f32_16x16x32_bf16 v[180:183],v[124:127],v[64:67],v[180:183]
s_add_u32 m0,s58,0
s_add_u32 s53,s86,0
buffer_load_dwordx4 v3,s[32:35],s53 offen lds
s_waitcnt lgkmcnt(8)
v_mfma_f32_16x16x32_bf16 v[188:191],v[124:127],v[68:71],v[188:191]
v_mfma_f32_16x16x32_bf16 v[184:187],v[120:123],v[68:71],v[184:187]
s_add_u32 m0,s58,1024
s_add_u32 s53,s86,16384
buffer_load_dwordx4 v3,s[32:35],s53 offen lds
ds_read_b64_tr_b16 v[64:65],v5 offset:28672
ds_read_b64_tr_b16 v[66:67],v5 offset:29184
s_setprio 0
s_waitcnt lgkmcnt(8)
v_mfma_f32_16x16x32_bf16 v[192:195],v[112:115],v[72:75],v[192:195]
ds_read_b64_tr_b16 v[68:69],v6 offset:28672
ds_read_b64_tr_b16 v[70:71],v6 offset:29184
v_mfma_f32_16x16x32_bf16 v[196:199],v[116:119],v[72:75],v[196:199]
s_waitcnt lgkmcnt(8)
v_mfma_f32_16x16x32_bf16 v[204:207],v[116:119],v[76:79],v[204:207]
v_mfma_f32_16x16x32_bf16 v[200:203],v[112:115],v[76:79],v[200:203]
ds_read_b64_tr_b16 v[72:73],v7 offset:28672
ds_read_b64_tr_b16 v[74:75],v7 offset:29184
s_waitcnt lgkmcnt(8)
v_mfma_f32_16x16x32_bf16 v[208:211],v[112:115],v[40:43],v[208:211]
ds_read_b64_tr_b16 v[76:77],v8 offset:28672
ds_read_b64_tr_b16 v[78:79],v8 offset:29184
v_mfma_f32_16x16x32_bf16 v[212:215],v[116:119],v[40:43],v[212:215]
s_waitcnt vmcnt(10)
ds_read_b128 v[88:91],v9 offset:2048
ds_read_b128 v[92:95],v9 offset:3072
s_waitcnt lgkmcnt(10)
v_mfma_f32_16x16x32_bf16 v[220:223],v[116:119],v[44:47],v[220:223]
v_mfma_f32_16x16x32_bf16 v[216:219],v[112:115],v[44:47],v[216:219]
ds_read_b64_tr_b16 v[40:41],v5 offset:32768
ds_read_b64_tr_b16 v[42:43],v5 offset:33280
s_waitcnt lgkmcnt(10)
v_mfma_f32_16x16x32_bf16 v[192:195],v[120:123],v[64:67],v[192:195]
ds_read_b64_tr_b16 v[44:45],v6 offset:32768
ds_read_b64_tr_b16 v[46:47],v6 offset:33280
v_mfma_f32_16x16x32_bf16 v[196:199],v[124:127],v[64:67],v[196:199]
s_waitcnt lgkmcnt(10)
v_mfma_f32_16x16x32_bf16 v[204:207],v[124:127],v[68:71],v[204:207]
v_mfma_f32_16x16x32_bf16 v[200:203],v[120:123],v[68:71],v[200:203]
ds_read_b64_tr_b16 v[64:65],v7 offset:32768
ds_read_b64_tr_b16 v[66:67],v7 offset:33280
s_waitcnt lgkmcnt(10)
v_mfma_f32_16x16x32_bf16 v[208:211],v[120:123],v[72:75],v[208:211]
ds_read_b64_tr_b16 v[68:69],v8 offset:32768
ds_read_b64_tr_b16 v[70:71],v8 offset:33280
v_mfma_f32_16x16x32_bf16 v[212:215],v[124:127],v[72:75],v[212:215]
s_waitcnt lgkmcnt(10)
v_mfma_f32_16x16x32_bf16 v[220:223],v[124:127],v[76:79],v[220:223]
v_mfma_f32_16x16x32_bf16 v[216:219],v[120:123],v[76:79],v[216:219]
s_waitcnt vmcnt(9)
s_barrier
ds_read_b64_tr_b16 v[72:73],v5 offset:36864
ds_read_b64_tr_b16 v[74:75],v5 offset:37376
s_setprio 3
s_waitcnt lgkmcnt(8)
v_mfma_f32_16x16x32_bf16 v[24:27],v[240:243],v[40:43],v[24:27]
s_add_u32 m0,s60,65536
s_add_u32 s53,s76,64
buffer_load_dwordx4 v2,s[36:39],s53 offen lds
ds_read_b64_tr_b16 v[76:77],v6 offset:36864
ds_read_b64_tr_b16 v[78:79],v6 offset:37376
v_mfma_f32_16x16x32_bf16 v[28:31],v[244:247],v[40:43],v[28:31]
s_add_u32 m0,s58,2048
s_add_u32 s53,s86,64
buffer_load_dwordx4 v3,s[32:35],s53 offen lds
s_waitcnt lgkmcnt(8)
v_mfma_f32_16x16x32_bf16 v[36:39],v[244:247],v[44:47],v[36:39]
v_mfma_f32_16x16x32_bf16 v[32:35],v[240:243],v[44:47],v[32:35]
s_add_u32 m0,s58,3072
s_add_u32 s53,s86,16448
buffer_load_dwordx4 v3,s[32:35],s53 offen lds
ds_read_b64_tr_b16 v[40:41],v7 offset:36864
ds_read_b64_tr_b16 v[42:43],v7 offset:37376
s_waitcnt lgkmcnt(8)
v_mfma_f32_16x16x32_bf16 v[48:51],v[240:243],v[64:67],v[48:51]
ds_read_b64_tr_b16 v[44:45],v8 offset:36864
ds_read_b64_tr_b16 v[46:47],v8 offset:37376
v_mfma_f32_16x16x32_bf16 v[52:55],v[244:247],v[64:67],v[52:55]
s_cmp_lg_u32 s50,0
s_cbranch_scc1 L_tag14
s_cmp_lg_u32 s101,0
s_cbranch_scc1 L_tag14
s_waitcnt vmcnt(10)
v_readfirstlane_b32 s96,v14
s_cmp_lg_u32 s96,0
s_cbranch_scc1 L_tag14
s_call_b64 s[66:67],L_tag_slow
L_tag14:
s_waitcnt lgkmcnt(8)
v_mfma_f32_16x16x32_bf16 v[60:63],v[244:247],v[68:71],v[60:63]
s_add_u32 m0,s60,73728
s_add_u32 s53,s77,64
buffer_load_dwordx4 v2,s[36:39],s53 offen lds
v_mfma_f32_16x16x32_bf16 v[56:59],v[240:243],v[68:71],v[56:59]
s_cmp_lg_u32 s50,0
s_cbranch_scc1 L_sig2
s_and_b32 s88,s3,7
s_lshl_b32 s88,s88,2
s_bfe_u32 s89,s3,0x20003
s_add_u32 s88,s88,s89
v_lshlrev_b32 v23,8,v1
v_mov_b32 v14,s96
s_lshl_b32 s88,s88,5
s_add_u32 s88,s88,101786816
s_mov_b64 exec,0xff
s_lshr_b32 s89,s3,5
s_lshl_b32 s89,s89,2
s_add_u32 s88,s88,s89
buffer_store_dword v14,v23,s[40:43],s88 offen sc1
s_mov_b64 exec,-1
L_sig2:
ds_read_b64_tr_b16 v[64:65],v5 offset:40960
ds_read_b64_tr_b16 v[66:67],v5 offset:41472
s_waitcnt lgkmcnt(8)
v_mfma_f32_16x16x32_bf16 v[24:27],v[248:251],v[72:75],v[24:27]
ds_read_b64_tr_b16 v[68:69],v6 offset:40960
ds_read_b64_tr_b16 v[70:71],v6 offset:41472
v_mfma_f32_16x16x32_bf16 v[28:31],v[252:255],v[72:75],v[28:31]
s_waitcnt lgkmcnt(8)
v_mfma_f32_16x16x32_bf16 v[36:39],v[252:255],v[76:79],v[36:39]
v_mfma_f32_16x16x32_bf16 v[32:35],v[248:251],v[76:79],v[32:35]
s_waitcnt vmcnt(11)
ds_read_b128 v[96:99],v9 offset:4096
ds_read_b128 v[100:103],v9 offset:5120
ds_read_b64_tr_b16 v[72:73],v7 offset:40960
ds_read_b64_tr_b16 v[74:75],v7 offset:41472
s_waitcnt lgkmcnt(10)
v_mfma_f32_16x16x32_bf16 v[48:51],v[248:251],v[40:43],v[48:51]
ds_read_b64_tr_b16 v[76:77],v8 offset:40960
ds_read_b64_tr_b16 v[78:79],v8 offset:41472
v_mfma_f32_16x16x32_bf16 v[52:55],v[252:255],v[40:43],v[52:55]
s_add_u32 m0,s60,81920
s_add_u32 s53,s78,64
buffer_load_dwordx4 v2,s[36:39],s53 offen lds
s_waitcnt lgkmcnt(10)
v_mfma_f32_16x16x32_bf16 v[60:63],v[252:255],v[44:47],v[60:63]
v_mfma_f32_16x16x32_bf16 v[56:59],v[248:251],v[44:47],v[56:59]
ds_read_b64_tr_b16 v[40:41],v5 offset:45056
ds_read_b64_tr_b16 v[42:43],v5 offset:45568
s_setprio 2
s_waitcnt lgkmcnt(10)
v_mfma_f32_16x16x32_bf16 v[128:131],v[240:243],v[64:67],v[128:131]
ds_read_b64_tr_b16 v[44:45],v6 offset:45056
ds_read_b64_tr_b16 v[46:47],v6 offset:45568
v_mfma_f32_16x16x32_bf16 v[132:135],v[244:247],v[64:67],v[132:135]
s_waitcnt lgkmcnt(10)
v_mfma_f32_16x16x32_bf16 v[140:143],v[244:247],v[68:71],v[140:143]
v_mfma_f32_16x16x32_bf16 v[136:139],v[240:243],v[68:71],v[136:139]
s_add_u32 m0,s60,90112
s_add_u32 s53,s79,64
buffer_load_dwordx4 v2,s[36:39],s53 offen lds
ds_read_b64_tr_b16 v[64:65],v7 offset:45056
ds_read_b64_tr_b16 v[66:67],v7 offset:45568
s_waitcnt lgkmcnt(8)
v_mfma_f32_16x16x32_bf16 v[144:147],v[240:243],v[72:75],v[144:147]
ds_read_b64_tr_b16 v[68:69],v8 offset:45056
ds_read_b64_tr_b16 v[70:71],v8 offset:45568
v_mfma_f32_16x16x32_bf16 v[148:151],v[244:247],v[72:75],v[148:151]
s_waitcnt lgkmcnt(8)
v_mfma_f32_16x16x32_bf16 v[156:159],v[244:247],v[76:79],v[156:159]
v_mfma_f32_16x16x32_bf16 v[152:155],v[240:243],v[76:79],v[152:155]
s_add_u32 m0,s58,4096
s_add_u32 s53,s87,0
buffer_load_dwordx4 v3,s[32:35],s53 offen lds
ds_read_b64_tr_b16 v[72:73],v5 offset:49152
ds_read_b64_tr_b16 v[74:75],v5 offset:49664
s_waitcnt lgkmcnt(8)
v_mfma_f32_16x16x32_bf16 v[128:131],v[248:251],v[40:43],v[128:131]
ds_read_b64_tr_b16 v[76:77],v6 offset:49152
ds_read_b64_tr_b16 v[78:79],v6 offset:49664
v_mfma_f32_16x16x32_bf16 v[132:135],v[252:255],v[40:43],v[132:135]
s_add_u32 m0,s58,5120
s_add_u32 s53,s87,16384
buffer_load_dwordx4 v3,s[32:35],s53 offen lds
s_waitcnt lgkmcnt(8)
v_mfma_f32_16x16x32_bf16 v[140:143],v[252:255],v[44:47],v[140:143]
v_mfma_f32_16x16x32_bf16 v[136:139],v[248:251],v[44:47],v[136:139]
ds_read_b64_tr_b16 v[40:41],v7 offset:49152
ds_read_b64_tr_b16 v[42:43],v7 offset:49664
s_waitcnt lgkmcnt(8)
v_mfma_f32_16x16x32_bf16 v[144:147],v[248:251],v[64:67],v[144:147]
ds_read_b64_tr_b16 v[44:45],v8 offset:49152
ds_read_b64_tr_b16 v[46:47],v8 offset:49664
v_mfma_f32_16x16x32_bf16 v[148:151],v[252:255],v[64:67],v[148:151]
s_waitcnt lgkmcnt(8)
v_mfma_f32_16x16x32_bf16 v[156:159],v[252:255],v[68:71],v[156:159]
v_mfma_f32_16x16x32_bf16 v[152:155],v[248:251],v[68:71],v[152:155]
s_waitcnt vmcnt(10)
ds_read_b128 v[104:107],v9 offset:6144
ds_read_b128 v[108:111],v9 offset:7168
ds_read_b64_tr_b16 v[64:65],v5 offset:53248
ds_read_b64_tr_b16 v[66:67],v5 offset:53760
s_setprio 1
s_waitcnt lgkmcnt(10)
v_mfma_f32_16x16x32_bf16 v[160:163],v[240:243],v[72:75],v[160:163]
ds_read_b64_tr_b16 v[68:69],v6 offset:53248
ds_read_b64_tr_b16 v[70:71],v6 offset:53760
v_mfma_f32_16x16x32_bf16 v[164:167],v[244:247],v[72:75],v[164:167]
s_waitcnt lgkmcnt(10)
v_mfma_f32_16x16x32_bf16 v[172:175],v[244:247],v[76:79],v[172:175]
v_mfma_f32_16x16x32_bf16 v[168:171],v[240:243],v[76:79],v[168:171]
ds_read_b64_tr_b16 v[72:73],v7 offset:53248
ds_read_b64_tr_b16 v[74:75],v7 offset:53760
s_waitcnt lgkmcnt(10)
v_mfma_f32_16x16x32_bf16 v[176:179],v[240:243],v[40:43],v[176:179]
ds_read_b64_tr_b16 v[76:77],v8 offset:53248
ds_read_b64_tr_b16 v[78:79],v8 offset:53760
v_mfma_f32_16x16x32_bf16 v[180:183],v[244:247],v[40:43],v[180:183]
s_waitcnt lgkmcnt(10)
v_mfma_f32_16x16x32_bf16 v[188:191],v[244:247],v[44:47],v[188:191]
v_mfma_f32_16x16x32_bf16 v[184:187],v[240:243],v[44:47],v[184:187]
ds_read_b64_tr_b16 v[40:41],v5 offset:57344
ds_read_b64_tr_b16 v[42:43],v5 offset:57856
s_waitcnt lgkmcnt(8)
v_mfma_f32_16x16x32_bf16 v[160:163],v[248:251],v[64:67],v[160:163]
ds_read_b64_tr_b16 v[44:45],v6 offset:57344
ds_read_b64_tr_b16 v[46:47],v6 offset:57856
v_mfma_f32_16x16x32_bf16 v[164:167],v[252:255],v[64:67],v[164:167]
s_waitcnt lgkmcnt(8)
v_mfma_f32_16x16x32_bf16 v[172:175],v[252:255],v[68:71],v[172:175]
v_mfma_f32_16x16x32_bf16 v[168:171],v[248:251],v[68:71],v[168:171]
s_add_u32 m0,s58,6144
s_add_u32 s53,s87,64
buffer_load_dwordx4 v3,s[32:35],s53 offen lds
ds_read_b64_tr_b16 v[64:65],v7 offset:57344
ds_read_b64_tr_b16 v[66:67],v7 offset:57856
s_waitcnt lgkmcnt(8)
v_mfma_f32_16x16x32_bf16 v[176:179],v[248:251],v[72:75],v[176:179]
s_add_u32 m0,s58,7168
s_add_u32 s53,s87,16448
buffer_load_dwordx4 v3,s[32:35],s53 offen lds
ds_read_b64_tr_b16 v[68:69],v8 offset:57344
ds_read_b64_tr_b16 v[70:71],v8 offset:57856
v_mfma_f32_16x16x32_bf16 v[180:183],v[252:255],v[72:75],v[180:183]
s_mov_b64 s[44:45],s[8:9]
s_mov_b32 s46,4194304
v_and_b32 v22,7,v1
v_lshlrev_b32 v22,13,v22
v_bfe_u32 v23,v1,3,1
v_lshl_add_u32 v22,v23,7,v22
s_waitcnt lgkmcnt(8)
v_mfma_f32_16x16x32_bf16 v[188:191],v[252:255],v[76:79],v[188:191]
v_mfma_f32_16x16x32_bf16 v[184:187],v[248:251],v[76:79],v[184:187]
s_and_b32 s88,s2,7
s_lshl_b32 s88,s88,2
s_bfe_u32 s89,s2,0x20003
s_add_u32 s88,s88,s89
s_lshl_b32 s88,s88,8
s_lshr_b32 s89,s2,5
s_lshl_b32 s89,s89,3
s_add_u32 s89,s89,s50
s_lshl_b32 s89,s89,16
s_add_u32 s88,s88,s89
buffer_load_dword v22,v22,s[44:47],s88 offen
ds_read_b64_tr_b16 v[72:73],v5 offset:61440
ds_read_b64_tr_b16 v[74:75],v5 offset:61952
s_setprio 0
s_waitcnt lgkmcnt(8)
v_mfma_f32_16x16x32_bf16 v[192:195],v[240:243],v[40:43],v[192:195]
ds_read_b64_tr_b16 v[76:77],v6 offset:61440
ds_read_b64_tr_b16 v[78:79],v6 offset:61952
v_mfma_f32_16x16x32_bf16 v[196:199],v[244:247],v[40:43],v[196:199]
s_waitcnt lgkmcnt(8)
v_mfma_f32_16x16x32_bf16 v[204:207],v[244:247],v[44:47],v[204:207]
v_mfma_f32_16x16x32_bf16 v[200:203],v[240:243],v[44:47],v[200:203]
s_waitcnt vmcnt(11)
ds_read_b128 v[112:115],v9 offset:0
ds_read_b128 v[116:119],v9 offset:1024
ds_read_b64_tr_b16 v[40:41],v7 offset:61440
ds_read_b64_tr_b16 v[42:43],v7 offset:61952
s_waitcnt lgkmcnt(10)
v_mfma_f32_16x16x32_bf16 v[208:211],v[240:243],v[64:67],v[208:211]
ds_read_b64_tr_b16 v[44:45],v8 offset:61440
ds_read_b64_tr_b16 v[46:47],v8 offset:61952
v_mfma_f32_16x16x32_bf16 v[212:215],v[244:247],v[64:67],v[212:215]
s_waitcnt lgkmcnt(10)
v_mfma_f32_16x16x32_bf16 v[220:223],v[244:247],v[68:71],v[220:223]
v_mfma_f32_16x16x32_bf16 v[216:219],v[240:243],v[68:71],v[216:219]
v_add_u32 v5,0x10000,v5
ds_read_b64_tr_b16 v[64:65],v5 offset:0
ds_read_b64_tr_b16 v[66:67],v5 offset:512
s_waitcnt lgkmcnt(10)
v_mfma_f32_16x16x32_bf16 v[192:195],v[248:251],v[72:75],v[192:195]
v_add_u32 v6,0x10000,v6
ds_read_b64_tr_b16 v[68:69],v6 offset:0
ds_read_b64_tr_b16 v[70:71],v6 offset:512
v_mfma_f32_16x16x32_bf16 v[196:199],v[252:255],v[72:75],v[196:199]
s_waitcnt lgkmcnt(10)
v_mfma_f32_16x16x32_bf16 v[204:207],v[252:255],v[76:79],v[204:207]
v_mfma_f32_16x16x32_bf16 v[200:203],v[248:251],v[76:79],v[200:203]
v_add_u32 v7,0x10000,v7
ds_read_b64_tr_b16 v[72:73],v7 offset:0
ds_read_b64_tr_b16 v[74:75],v7 offset:512
s_waitcnt lgkmcnt(8)
v_mfma_f32_16x16x32_bf16 v[208:211],v[248:251],v[40:43],v[208:211]
v_add_u32 v8,0x10000,v8
ds_read_b64_tr_b16 v[76:77],v8 offset:0
ds_read_b64_tr_b16 v[78:79],v8 offset:512
v_mfma_f32_16x16x32_bf16 v[212:215],v[252:255],v[40:43],v[212:215]
s_waitcnt lgkmcnt(8)
v_mfma_f32_16x16x32_bf16 v[220:223],v[252:255],v[44:47],v[220:223]
v_mfma_f32_16x16x32_bf16 v[216:219],v[248:251],v[44:47],v[216:219]
s_waitcnt vmcnt(10)
s_barrier
ds_read_b64_tr_b16 v[40:41],v5 offset:4096
ds_read_b64_tr_b16 v[42:43],v5 offset:4608
s_setprio 3
s_waitcnt lgkmcnt(8)
v_mfma_f32_16x16x32_bf16 v[24:27],v[80:83],v[64:67],v[24:27]
ds_read_b64_tr_b16 v[44:45],v6 offset:4096
ds_read_b64_tr_b16 v[46:47],v6 offset:4608
v_mfma_f32_16x16x32_bf16 v[28:31],v[84:87],v[64:67],v[28:31]
s_add_u32 m0,s60,98304
s_add_u32 s53,s76,128
buffer_load_dwordx4 v2,s[36:39],s53 offen lds
s_waitcnt lgkmcnt(8)
v_mfma_f32_16x16x32_bf16 v[36:39],v[84:87],v[68:71],v[36:39]
v_mfma_f32_16x16x32_bf16 v[32:35],v[80:83],v[68:71],v[32:35]
ds_read_b64_tr_b16 v[64:65],v7 offset:4096
ds_read_b64_tr_b16 v[66:67],v7 offset:4608
s_waitcnt lgkmcnt(8)
v_mfma_f32_16x16x32_bf16 v[48:51],v[80:83],v[72:75],v[48:51]
ds_read_b64_tr_b16 v[68:69],v8 offset:4096
ds_read_b64_tr_b16 v[70:71],v8 offset:4608
v_mfma_f32_16x16x32_bf16 v[52:55],v[84:87],v[72:75],v[52:55]
s_waitcnt lgkmcnt(8)
v_mfma_f32_16x16x32_bf16 v[60:63],v[84:87],v[76:79],v[60:63]
v_mfma_f32_16x16x32_bf16 v[56:59],v[80:83],v[76:79],v[56:59]
s_add_u32 m0,s60,106496
s_add_u32 s53,s77,128
buffer_load_dwordx4 v2,s[36:39],s53 offen lds
ds_read_b64_tr_b16 v[72:73],v5 offset:8192
ds_read_b64_tr_b16 v[74:75],v5 offset:8704
s_waitcnt lgkmcnt(8)
v_mfma_f32_16x16x32_bf16 v[24:27],v[88:91],v[40:43],v[24:27]
ds_read_b64_tr_b16 v[76:77],v6 offset:8192
ds_read_b64_tr_b16 v[78:79],v6 offset:8704
v_mfma_f32_16x16x32_bf16 v[28:31],v[92:95],v[40:43],v[28:31]
s_waitcnt vmcnt(10)
ds_read_b128 v[120:123],v9 offset:2048
ds_read_b128 v[124:127],v9 offset:3072
s_waitcnt lgkmcnt(10)
v_mfma_f32_16x16x32_bf16 v[36:39],v[92:95],v[44:47],v[36:39]
v_mfma_f32_16x16x32_bf16 v[32:35],v[88:91],v[44:47],v[32:35]
ds_read_b64_tr_b16 v[40:41],v7 offset:8192
ds_read_b64_tr_b16 v[42:43],v7 offset:8704
s_waitcnt lgkmcnt(10)
v_mfma_f32_16x16x32_bf16 v[48:51],v[88:91],v[64:67],v[48:51]
ds_read_b64_tr_b16 v[44:45],v8 offset:8192
ds_read_b64_tr_b16 v[46:47],v8 offset:8704
v_mfma_f32_16x16x32_bf16 v[52:55],v[92:95],v[64:67],v[52:55]
s_add_u32 m0,s60,114688
s_add_u32 s53,s78,128
buffer_load_dwordx4 v2,s[36:39],s53 offen lds
s_waitcnt lgkmcnt(10)
v_mfma_f32_16x16x32_bf16 v[60:63],v[92:95],v[68:71],v[60:63]
v_mfma_f32_16x16x32_bf16 v[56:59],v[88:91],v[68:71],v[56:59]
ds_read_b64_tr_b16 v[64:65],v5 offset:12288
ds_read_b64_tr_b16 v[66:67],v5 offset:12800
s_setprio 2
s_waitcnt lgkmcnt(10)
v_mfma_f32_16x16x32_bf16 v[24:27],v[96:99],v[72:75],v[24:27]
ds_read_b64_tr_b16 v[68:69],v6 offset:12288
ds_read_b64_tr_b16 v[70:71],v6 offset:12800
v_mfma_f32_16x16x32_bf16 v[28:31],v[100:103],v[72:75],v[28:31]
s_waitcnt lgkmcnt(10)
v_mfma_f32_16x16x32_bf16 v[36:39],v[100:103],v[76:79],v[36:39]
v_mfma_f32_16x16x32_bf16 v[32:35],v[96:99],v[76:79],v[32:35]
s_add_u32 m0,s60,122880
s_add_u32 s53,s79,128
buffer_load_dwordx4 v2,s[36:39],s53 offen lds
ds_read_b64_tr_b16 v[72:73],v7 offset:12288
ds_read_b64_tr_b16 v[74:75],v7 offset:12800
s_waitcnt lgkmcnt(8)
v_mfma_f32_16x16x32_bf16 v[48:51],v[96:99],v[40:43],v[48:51]
v_mov_b32 v16,0x3f803f80
ds_read_b64_tr_b16 v[76:77],v8 offset:12288
ds_read_b64_tr_b16 v[78:79],v8 offset:12800
v_mfma_f32_16x16x32_bf16 v[52:55],v[100:103],v[40:43],v[52:55]
v_mov_b32 v17,0x3f803f80
s_waitcnt lgkmcnt(8)
v_mfma_f32_16x16x32_bf16 v[60:63],v[100:103],v[44:47],v[60:63]
v_mov_b32 v18,0x3f803f80
v_mfma_f32_16x16x32_bf16 v[56:59],v[96:99],v[44:47],v[56:59]
v_mov_b32 v19,0x3f803f80
ds_read_b64_tr_b16 v[40:41],v5 offset:16384
ds_read_b64_tr_b16 v[42:43],v5 offset:16896
s_waitcnt lgkmcnt(8)
v_mfma_f32_16x16x32_bf16 v[24:27],v[104:107],v[64:67],v[24:27]
ds_read_b64_tr_b16 v[44:45],v6 offset:16384
ds_read_b64_tr_b16 v[46:47],v6 offset:16896
v_mfma_f32_16x16x32_bf16 v[28:31],v[108:111],v[64:67],v[28:31]
v_lshrrev_b32 v11,4,v1
s_waitcnt lgkmcnt(8)
v_mfma_f32_16x16x32_bf16 v[36:39],v[108:111],v[68:71],v[36:39]
v_and_b32 v12,15,v1
v_mfma_f32_16x16x32_bf16 v[32:35],v[104:107],v[68:71],v[32:35]
v_lshlrev_b32 v12,4,v12
ds_read_b64_tr_b16 v[64:65],v7 offset:16384
ds_read_b64_tr_b16 v[66:67],v7 offset:16896
s_waitcnt lgkmcnt(8)
v_mfma_f32_16x16x32_bf16 v[48:51],v[104:107],v[72:75],v[48:51]
s_waitcnt vmcnt(7)
ds_read_b128 v[240:243],v9 offset:4096
ds_read_b128 v[244:247],v9 offset:5120
ds_read_b64_tr_b16 v[68:69],v8 offset:16384
ds_read_b64_tr_b16 v[70:71],v8 offset:16896
v_mfma_f32_16x16x32_bf16 v[52:55],v[108:111],v[72:75],v[52:55]
v_lshl_add_u32 v11,v11,9,v12
s_add_u32 s88,s59,32768
v_add_u32 v11,s88,v11
s_waitcnt lgkmcnt(10)
v_mfma_f32_16x16x32_bf16 v[60:63],v[108:111],v[76:79],v[60:63]
v_mfma_f32_16x16x32_bf16 v[56:59],v[104:107],v[76:79],v[56:59]
s_lshl_b32 s88,s50,9
s_add_u32 s88,s88,32768
v_lshlrev_b32 v13,3,v1
v_add_u32 v13,s88,v13
ds_read_b64_tr_b16 v[72:73],v5 offset:20480
ds_read_b64_tr_b16 v[74:75],v5 offset:20992
s_setprio 1
s_waitcnt lgkmcnt(10)
v_mfma_f32_16x16x32_bf16 v[24:27],v[112:115],v[40:43],v[24:27]
ds_read_b64_tr_b16 v[76:77],v6 offset:20480
ds_read_b64_tr_b16 v[78:79],v6 offset:20992
v_mfma_f32_16x16x32_bf16 v[28:31],v[116:119],v[40:43],v[28:31]
s_waitcnt lgkmcnt(10)
v_mfma_f32_16x16x32_bf16 v[36:39],v[116:119],v[44:47],v[36:39]
v_mfma_f32_16x16x32_bf16 v[32:35],v[112:115],v[44:47],v[32:35]
ds_read_b64_tr_b16 v[40:41],v7 offset:20480
ds_read_b64_tr_b16 v[42:43],v7 offset:20992
s_waitcnt lgkmcnt(10)
v_mfma_f32_16x16x32_bf16 v[48:51],v[112:115],v[64:67],v[48:51]
ds_read_b64_tr_b16 v[44:45],v8 offset:20480
ds_read_b64_tr_b16 v[46:47],v8 offset:20992
v_mfma_f32_16x16x32_bf16 v[52:55],v[116:119],v[64:67],v[52:55]
s_waitcnt lgkmcnt(8)
v_mfma_f32_16x16x32_bf16 v[60:63],v[116:119],v[68:71],v[60:63]
v_mfma_f32_16x16x32_bf16 v[56:59],v[112:115],v[68:71],v[56:59]
ds_read_b64_tr_b16 v[64:65],v5 offset:24576
ds_read_b64_tr_b16 v[66:67],v5 offset:25088
s_waitcnt lgkmcnt(8)
v_mfma_f32_16x16x32_bf16 v[24:27],v[120:123],v[72:75],v[24:27]
ds_read_b64_tr_b16 v[68:69],v6 offset:24576
ds_read_b64_tr_b16 v[70:71],v6 offset:25088
v_mfma_f32_16x16x32_bf16 v[28:31],v[124:127],v[72:75],v[28:31]
s_waitcnt lgkmcnt(8)
v_mfma_f32_16x16x32_bf16 v[36:39],v[124:127],v[76:79],v[36:39]
v_mfma_f32_16x16x32_bf16 v[32:35],v[120:123],v[76:79],v[32:35]
ds_read_b64_tr_b16 v[72:73],v7 offset:24576
ds_read_b64_tr_b16 v[74:75],v7 offset:25088
s_waitcnt lgkmcnt(8)
v_mfma_f32_16x16x32_bf16 v[48:51],v[120:123],v[40:43],v[48:51]
ds_read_b64_tr_b16 v[76:77],v8 offset:24576
ds_read_b64_tr_b16 v[78:79],v8 offset:25088
v_mfma_f32_16x16x32_bf16 v[52:55],v[124:127],v[40:43],v[52:55]
s_waitcnt lgkmcnt(8)
v_mfma_f32_16x16x32_bf16 v[60:63],v[124:127],v[44:47],v[60:63]
v_mfma_f32_16x16x32_bf16 v[56:59],v[120:123],v[44:47],v[56:59]
ds_read_b64_tr_b16 v[40:41],v5 offset:28672
ds_read_b64_tr_b16 v[42:43],v5 offset:29184
s_setprio 0
s_waitcnt lgkmcnt(8)
v_mfma_f32_16x16x32_bf16 v[24:27],v[240:243],v[64:67],v[24:27]
ds_read_b64_tr_b16 v[44:45],v6 offset:28672
ds_read_b64_tr_b16 v[46:47],v6 offset:29184
v_mfma_f32_16x16x32_bf16 v[28:31],v[244:247],v[64:67],v[28:31]
s_waitcnt lgkmcnt(8)
v_mfma_f32_16x16x32_bf16 v[36:39],v[244:247],v[68:71],v[36:39]
v_mfma_f32_16x16x32_bf16 v[32:35],v[240:243],v[68:71],v[32:35]
s_waitcnt vmcnt(5)
ds_read_b128 v[248:251],v9 offset:6144
ds_read_b128 v[252:255],v9 offset:7168
ds_read_b64_tr_b16 v[64:65],v7 offset:28672
ds_read_b64_tr_b16 v[66:67],v7 offset:29184
s_waitcnt lgkmcnt(10)
v_mfma_f32_16x16x32_bf16 v[48:51],v[240:243],v[72:75],v[48:51]
ds_read_b64_tr_b16 v[68:69],v8 offset:28672
ds_read_b64_tr_b16 v[70:71],v8 offset:29184
v_mfma_f32_16x16x32_bf16 v[52:55],v[244:247],v[72:75],v[52:55]
s_waitcnt lgkmcnt(10)
v_mfma_f32_16x16x32_bf16 v[60:63],v[244:247],v[76:79],v[60:63]
v_mfma_f32_16x16x32_bf16 v[56:59],v[240:243],v[76:79],v[56:59]
v_add_u32 v5,0xffff0000,v5
ds_read_b64_tr_b16 v[72:73],v5 offset:0
ds_read_b64_tr_b16 v[74:75],v5 offset:512
s_waitcnt lgkmcnt(7)
v_mfma_f32_16x16x32_bf16 v[24:27],v[248:251],v[40:43],v[24:27]
v_add_u32 v6,0xffff0000,v6
ds_read_b64_tr_b16 v[76:77],v6 offset:0
ds_read_b64_tr_b16 v[78:79],v6 offset:512
s_waitcnt lgkmcnt(8)
v_mfma_f32_16x16x32_bf16 v[28:31],v[252:255],v[40:43],v[28:31]
v_mfma_f32_16x16x32_bf16 v[36:39],v[252:255],v[44:47],v[36:39]
v_mfma_f32_16x16x32_bf16 v[32:35],v[248:251],v[44:47],v[32:35]
v_add_u32 v7,0xffff0000,v7
ds_read_b64_tr_b16 v[40:41],v7 offset:0
ds_read_b64_tr_b16 v[42:43],v7 offset:512
s_waitcnt lgkmcnt(8)
v_mfma_f32_16x16x32_bf16 v[48:51],v[248:251],v[64:67],v[48:51]
v_add_u32 v8,0xffff0000,v8
ds_read_b64_tr_b16 v[44:45],v8 offset:0
ds_read_b64_tr_b16 v[46:47],v8 offset:512
v_mfma_f32_16x16x32_bf16 v[52:55],v[252:255],v[64:67],v[52:55]
s_waitcnt lgkmcnt(8)
v_mfma_f32_16x16x32_bf16 v[60:63],v[252:255],v[68:71],v[60:63]
v_mfma_f32_16x16x32_bf16 v[56:59],v[248:251],v[68:71],v[56:59]
s_waitcnt vmcnt(3)
s_barrier
ds_read_b64_tr_b16 v[64:65],v5 offset:4096
ds_read_b64_tr_b16 v[66:67],v5 offset:4608
s_setprio 3
s_waitcnt lgkmcnt(8)
v_mfma_f32_16x16x32_bf16 v[128:131],v[80:83],v[72:75],v[128:131]
ds_read_b64_tr_b16 v[68:69],v6 offset:4096
ds_read_b64_tr_b16 v[70:71],v6 offset:4608
v_mfma_f32_16x16x32_bf16 v[132:135],v[84:87],v[72:75],v[132:135]
s_add_u32 m0,s60,131072
s_add_u32 s53,s76,192
buffer_load_dwordx4 v2,s[36:39],s53 offen lds
s_waitcnt lgkmcnt(8)
v_mfma_f32_16x16x32_bf16 v[140:143],v[84:87],v[76:79],v[140:143]
v_mfma_f32_16x16x32_bf16 v[136:139],v[80:83],v[76:79],v[136:139]
s_add_u32 m0,s60,139264
s_add_u32 s53,s77,192
buffer_load_dwordx4 v2,s[36:39],s53 offen lds
ds_read_b64_tr_b16 v[72:73],v7 offset:4096
ds_read_b64_tr_b16 v[74:75],v7 offset:4608
s_waitcnt lgkmcnt(8)
v_mfma_f32_16x16x32_bf16 v[144:147],v[80:83],v[40:43],v[144:147]
v_cvt_pk_bf16_f32 v48,v48,v49
v_cvt_pk_bf16_f32 v49,v50,v51
ds_read_b64_tr_b16 v[76:77],v8 offset:4096
ds_read_b64_tr_b16 v[78:79],v8 offset:4608
v_mfma_f32_16x16x32_bf16 v[148:151],v[84:87],v[40:43],v[148:151]
v_cvt_pk_bf16_f32 v50,v52,v53
v_cvt_pk_bf16_f32 v51,v54,v55
s_waitcnt lgkmcnt(8)
v_mfma_f32_16x16x32_bf16 v[156:159],v[84:87],v[44:47],v[156:159]
s_add_u32 m0,s60,147456
s_add_u32 s53,s78,192
buffer_load_dwordx4 v2,s[36:39],s53 offen lds
v_cvt_pk_bf16_f32 v52,v56,v57
v_mfma_f32_16x16x32_bf16 v[152:155],v[80:83],v[44:47],v[152:155]
v_cvt_pk_bf16_f32 v53,v58,v59
v_cvt_pk_bf16_f32 v54,v60,v61
ds_read_b64_tr_b16 v[40:41],v5 offset:8192
ds_read_b64_tr_b16 v[42:43],v5 offset:8704
s_waitcnt lgkmcnt(8)
v_mfma_f32_16x16x32_bf16 v[128:131],v[88:91],v[64:67],v[128:131]
v_cvt_pk_bf16_f32 v55,v62,v63
ds_read_b64_tr_b16 v[44:45],v6 offset:8192
ds_read_b64_tr_b16 v[46:47],v6 offset:8704
v_mfma_f32_16x16x32_bf16 v[132:135],v[92:95],v[64:67],v[132:135]
v_fma_f32 v15,v24,s61,-s61
v_fma_f32 v22,v25,s61,-s61
s_waitcnt lgkmcnt(8)
v_mfma_f32_16x16x32_bf16 v[140:143],v[92:95],v[68:71],v[140:143]
s_add_u32 m0,s60,155648
s_add_u32 s53,s79,192
buffer_load_dwordx4 v2,s[36:39],s53 offen lds
v_exp_f32 v15,v15 clamp
v_mfma_f32_16x16x32_bf16 v[136:139],v[88:91],v[68:71],v[136:139]
v_exp_f32 v22,v22 clamp
v_max_f32 v24,v15,v24
ds_read_b64_tr_b16 v[64:65],v7 offset:8192
ds_read_b64_tr_b16 v[66:67],v7 offset:8704
s_waitcnt lgkmcnt(8)
v_mfma_f32_16x16x32_bf16 v[144:147],v[88:91],v[72:75],v[144:147]
v_max_f32 v25,v22,v25
v_add_f32 v24,s62,v24
ds_read_b64_tr_b16 v[68:69],v8 offset:8192
ds_read_b64_tr_b16 v[70:71],v8 offset:8704
v_mfma_f32_16x16x32_bf16 v[148:151],v[92:95],v[72:75],v[148:151]
v_add_f32 v25,s62,v25
v_cvt_pk_bf16_f32 v24,v24,v25
s_waitcnt lgkmcnt(8)
v_mfma_f32_16x16x32_bf16 v[156:159],v[92:95],v[76:79],v[156:159]
v_fma_f32 v15,v26,s61,-s61
v_mfma_f32_16x16x32_bf16 v[152:155],v[88:91],v[76:79],v[152:155]
v_fma_f32 v22,v27,s61,-s61
v_exp_f32 v15,v15 clamp
ds_read_b64_tr_b16 v[72:73],v5 offset:12288
ds_read_b64_tr_b16 v[74:75],v5 offset:12800
s_setprio 2
s_waitcnt lgkmcnt(8)
v_mfma_f32_16x16x32_bf16 v[128:131],v[96:99],v[40:43],v[128:131]
v_mov_b32 v14,s96
v_min_u32 v23,47,v1
v_lshlrev_b32 v23,2,v23
s_and_b32 s88,s2,7
s_lshl_b32 s88,s88,8
s_add_u32 s88,s88,101787648
v_add_u32 v23,s88,v23
s_mov_b32 s7,0
s_cmp_lg_u32 s50,0
s_cbranch_scc1 L_xfp15
s_cmp_lg_u32 s3,s2
s_cbranch_scc1 L_xfp15
buffer_load_dword v14,v23,s[40:43],0 offen sc1
L_xfp15:
v_exp_f32 v22,v22 clamp
ds_read_b64_tr_b16 v[76:77],v6 offset:12288
ds_read_b64_tr_b16 v[78:79],v6 offset:12800
v_mfma_f32_16x16x32_bf16 v[132:135],v[100:103],v[40:43],v[132:135]
v_max_f32 v26,v15,v26
v_max_f32 v27,v22,v27
s_waitcnt lgkmcnt(8)
v_mfma_f32_16x16x32_bf16 v[140:143],v[100:103],v[44:47],v[140:143]
s_mov_b64 s[76:77],s[8:9]
s_mov_b32 s78,4194304
s_mov_b32 s79,0x20000
v_mfma_f32_16x16x32_bf16 v[136:139],v[96:99],v[44:47],v[136:139]
v_add_f32 v26,s62,v26
v_add_f32 v27,s62,v27
v_cvt_pk_bf16_f32 v25,v26,v27
ds_read_b64_tr_b16 v[40:41],v7 offset:12288
ds_read_b64_tr_b16 v[42:43],v7 offset:12800
s_waitcnt lgkmcnt(8)
v_mfma_f32_16x16x32_bf16 v[144:147],v[96:99],v[64:67],v[144:147]
s_mov_b64 s[8:9],s[40:41]
s_mov_b32 s10,268435456
ds_read_b64_tr_b16 v[44:45],v8 offset:12288
ds_read_b64_tr_b16 v[46:47],v8 offset:12800
v_mfma_f32_16x16x32_bf16 v[148:151],v[100:103],v[64:67],v[148:151]
v_fma_f32 v15,v28,s61,-s61
v_fma_f32 v22,v29,s61,-s61
v_exp_f32 v15,v15 clamp
s_waitcnt lgkmcnt(8)
v_mfma_f32_16x16x32_bf16 v[156:159],v[100:103],v[68:71],v[156:159]
s_mov_b32 s11,0x20000
s_mov_b64 s[12:13],s[14:15]
s_mov_b32 s14,4194304
v_mfma_f32_16x16x32_bf16 v[152:155],v[96:99],v[68:71],v[152:155]
v_exp_f32 v22,v22 clamp
v_max_f32 v28,v15,v28
v_max_f32 v29,v22,v29
v_add_f32 v28,s62,v28
ds_read_b64_tr_b16 v[64:65],v5 offset:16384
ds_read_b64_tr_b16 v[66:67],v5 offset:16896
s_waitcnt lgkmcnt(8)
v_mfma_f32_16x16x32_bf16 v[128:131],v[104:107],v[72:75],v[128:131]
s_mov_b32 s15,0x20000
s_mov_b32 s37,s18
ds_read_b64_tr_b16 v[68:69],v6 offset:16384
ds_read_b64_tr_b16 v[70:71],v6 offset:16896
v_mfma_f32_16x16x32_bf16 v[132:135],v[108:111],v[72:75],v[132:135]
v_add_f32 v29,s62,v29
v_cvt_pk_bf16_f32 v26,v28,v29
v_fma_f32 v15,v30,s61,-s61
s_waitcnt lgkmcnt(8)
v_mfma_f32_16x16x32_bf16 v[140:143],v[108:111],v[76:79],v[140:143]
s_lshl_b32 s39,s16,11
s_lshl_b32 s29,s16,16
s_lshl_b32 s26,s17,8
v_mfma_f32_16x16x32_bf16 v[136:139],v[104:107],v[76:79],v[136:139]
v_fma_f32 v22,v31,s61,-s61
v_exp_f32 v15,v15 clamp
v_exp_f32 v22,v22 clamp
ds_read_b64_tr_b16 v[72:73],v7 offset:16384
ds_read_b64_tr_b16 v[74:75],v7 offset:16896
s_waitcnt lgkmcnt(8)
v_mfma_f32_16x16x32_bf16 v[144:147],v[104:107],v[40:43],v[144:147]
s_add_u32 s29,s29,s26
s_lshl_b32 s24,s19,15
ds_read_b64_tr_b16 v[76:77],v8 offset:16384
ds_read_b64_tr_b16 v[78:79],v8 offset:16896
v_mfma_f32_16x16x32_bf16 v[148:151],v[108:111],v[40:43],v[148:151]
v_max_f32 v30,v15,v30
v_max_f32 v31,v22,v31
v_add_f32 v30,s62,v30
s_waitcnt lgkmcnt(8)
v_mfma_f32_16x16x32_bf16 v[156:159],v[108:111],v[44:47],v[156:159]
s_add_u32 s24,s24,41943040
v_lshrrev_b32 v20,4,v1
v_lshlrev_b32 v21,2,v20
v_mfma_f32_16x16x32_bf16 v[152:155],v[104:107],v[44:47],v[152:155]
v_add_f32 v31,s62,v31
v_cvt_pk_bf16_f32 v27,v30,v31
v_fma_f32 v15,v32,s61,-s61
ds_read_b64_tr_b16 v[40:41],v5 offset:20480
ds_read_b64_tr_b16 v[42:43],v5 offset:20992
s_setprio 1
s_waitcnt lgkmcnt(8)
v_mfma_f32_16x16x32_bf16 v[128:131],v[112:115],v[64:67],v[128:131]
v_and_b32 v10,15,v1
v_xor_b32 v10,v10,v21
v_fma_f32 v22,v33,s61,-s61
ds_read_b64_tr_b16 v[44:45],v6 offset:20480
ds_read_b64_tr_b16 v[46:47],v6 offset:20992
v_mfma_f32_16x16x32_bf16 v[132:135],v[116:119],v[64:67],v[132:135]
v_exp_f32 v15,v15 clamp
v_exp_f32 v22,v22 clamp
v_max_f32 v32,v15,v32
s_waitcnt lgkmcnt(8)
v_mfma_f32_16x16x32_bf16 v[140:143],v[116:119],v[68:71],v[140:143]
s_and_b32 s26,s16,1
s_lshl_b32 s26,s26,1
v_xor_b32 v10,s26,v10
v_mfma_f32_16x16x32_bf16 v[136:139],v[112:115],v[68:71],v[136:139]
v_max_f32 v33,v22,v33
v_add_f32 v32,s62,v32
v_add_f32 v33,s62,v33
ds_read_b64_tr_b16 v[64:65],v7 offset:20480
ds_read_b64_tr_b16 v[66:67],v7 offset:20992
s_waitcnt lgkmcnt(8)
v_mfma_f32_16x16x32_bf16 v[144:147],v[112:115],v[72:75],v[144:147]
v_lshlrev_b32 v10,4,v10
v_lshl_add_u32 v10,v20,13,v10
ds_read_b64_tr_b16 v[68:69],v8 offset:20480
ds_read_b64_tr_b16 v[70:71],v8 offset:20992
v_mfma_f32_16x16x32_bf16 v[148:151],v[116:119],v[72:75],v[148:151]
v_cvt_pk_bf16_f32 v28,v32,v33
v_fma_f32 v15,v34,s61,-s61
v_fma_f32 v22,v35,s61,-s61
s_waitcnt lgkmcnt(8)
v_mfma_f32_16x16x32_bf16 v[156:159],v[116:119],v[76:79],v[156:159]
v_lshlrev_b32 v2,4,v1
s_add_u32 s26,s37,0
s_and_b32 s26,s26,7
v_mfma_f32_16x16x32_bf16 v[152:155],v[112:115],v[76:79],v[152:155]
v_exp_f32 v15,v15 clamp
v_exp_f32 v22,v22 clamp
v_max_f32 v34,v15,v34
ds_read_b64_tr_b16 v[72:73],v5 offset:24576
ds_read_b64_tr_b16 v[74:75],v5 offset:25088
s_waitcnt lgkmcnt(8)
v_mfma_f32_16x16x32_bf16 v[128:131],v[120:123],v[40:43],v[128:131]
s_lshl_b32 s80,s26,19
s_add_u32 s80,s80,s29
v_max_f32 v35,v22,v35
ds_read_b64_tr_b16 v[76:77],v6 offset:24576
ds_read_b64_tr_b16 v[78:79],v6 offset:25088
v_mfma_f32_16x16x32_bf16 v[132:135],v[124:127],v[40:43],v[132:135]
v_add_f32 v34,s62,v34
v_add_f32 v35,s62,v35
v_cvt_pk_bf16_f32 v29,v34,v35
s_waitcnt lgkmcnt(8)
v_mfma_f32_16x16x32_bf16 v[140:143],v[124:127],v[44:47],v[140:143]
s_lshl_b32 s26,s26,12
s_add_u32 s88,s26,s24
s_add_u32 s26,s37,1
v_mfma_f32_16x16x32_bf16 v[136:139],v[120:123],v[44:47],v[136:139]
v_mfma_f32_16x16x32_bf16 v[56:59],v[24:27],v[48:51],0
v_mfma_f32_16x16x32_bf16 v[60:63],v[24:27],v[16:19],0
v_fma_f32 v15,v36,s61,-s61
ds_read_b64_tr_b16 v[40:41],v7 offset:24576
ds_read_b64_tr_b16 v[42:43],v7 offset:25088
s_waitcnt lgkmcnt(8)
v_mfma_f32_16x16x32_bf16 v[144:147],v[120:123],v[64:67],v[144:147]
s_and_b32 s26,s26,7
s_lshl_b32 s81,s26,19
ds_read_b64_tr_b16 v[44:45],v8 offset:24576
ds_read_b64_tr_b16 v[46:47],v8 offset:25088
v_mfma_f32_16x16x32_bf16 v[148:151],v[124:127],v[64:67],v[148:151]
v_fma_f32 v22,v37,s61,-s61
v_exp_f32 v15,v15 clamp
v_exp_f32 v22,v22 clamp
s_waitcnt lgkmcnt(8)
v_mfma_f32_16x16x32_bf16 v[156:159],v[124:127],v[68:71],v[156:159]
s_add_u32 s81,s81,s29
s_lshl_b32 s26,s26,12
s_add_u32 s89,s26,s24
v_mfma_f32_16x16x32_bf16 v[152:155],v[120:123],v[68:71],v[152:155]
v_max_f32 v36,v15,v36
v_max_f32 v37,v22,v37
v_add_f32 v36,s62,v36
ds_read_b64_tr_b16 v[64:65],v5 offset:28672
ds_read_b64_tr_b16 v[66:67],v5 offset:29184
s_setprio 0
s_waitcnt lgkmcnt(8)
v_mfma_f32_16x16x32_bf16 v[128:131],v[240:243],v[72:75],v[128:131]
s_add_u32 s26,s37,2
s_and_b32 s26,s26,7
ds_read_b64_tr_b16 v[68:69],v6 offset:28672
ds_read_b64_tr_b16 v[70:71],v6 offset:29184
v_mfma_f32_16x16x32_bf16 v[132:135],v[244:247],v[72:75],v[132:135]
v_add_f32 v37,s62,v37
v_cvt_pk_bf16_f32 v30,v36,v37
v_fma_f32 v15,v38,s61,-s61
s_waitcnt lgkmcnt(8)
v_mfma_f32_16x16x32_bf16 v[140:143],v[244:247],v[76:79],v[140:143]
s_lshl_b32 s82,s26,19
s_add_u32 s82,s82,s29
s_lshl_b32 s26,s26,12
v_mfma_f32_16x16x32_bf16 v[136:139],v[240:243],v[76:79],v[136:139]
v_fma_f32 v22,v39,s61,-s61
v_exp_f32 v15,v15 clamp
v_exp_f32 v22,v22 clamp
v_max_f32 v38,v15,v38
ds_read_b64_tr_b16 v[72:73],v7 offset:28672
ds_read_b64_tr_b16 v[74:75],v7 offset:29184
s_waitcnt lgkmcnt(8)
v_mfma_f32_16x16x32_bf16 v[144:147],v[240:243],v[40:43],v[144:147]
s_add_u32 s90,s26,s24
s_add_u32 s26,s37,3
ds_read_b64_tr_b16 v[76:77],v8 offset:28672
ds_read_b64_tr_b16 v[78:79],v8 offset:29184
v_mfma_f32_16x16x32_bf16 v[148:151],v[244:247],v[40:43],v[148:151]
v_max_f32 v39,v22,v39
v_add_f32 v38,s62,v38
v_add_f32 v39,s62,v39
s_waitcnt lgkmcnt(8)
v_mfma_f32_16x16x32_bf16 v[156:159],v[244:247],v[44:47],v[156:159]
s_and_b32 s26,s26,7
s_lshl_b32 s83,s26,19
s_add_u32 s83,s83,s29
v_mfma_f32_16x16x32_bf16 v[152:155],v[240:243],v[44:47],v[152:155]
v_cvt_pk_bf16_f32 v31,v38,v39
s_nop 1
v_mfma_f32_16x16x32_bf16 v[32:35],v[28:31],v[52:55],0
ds_read_b64_tr_b16 v[40:41],v5 offset:32768
ds_read_b64_tr_b16 v[42:43],v5 offset:33280
s_waitcnt lgkmcnt(8)
v_mfma_f32_16x16x32_bf16 v[128:131],v[248:251],v[64:67],v[128:131]
s_lshl_b32 s26,s26,12
s_add_u32 s91,s26,s24
ds_read_b64_tr_b16 v[44:45],v6 offset:32768
ds_read_b64_tr_b16 v[46:47],v6 offset:33280
v_mfma_f32_16x16x32_bf16 v[132:135],v[252:255],v[64:67],v[132:135]
v_mfma_f32_16x16x32_bf16 v[36:39],v[28:31],v[16:19],0
ds_write_b128 v11,v[56:59] offset:0
ds_write_b128 v11,v[60:63] offset:256
s_waitcnt lgkmcnt(10)
v_mfma_f32_16x16x32_bf16 v[140:143],v[252:255],v[68:71],v[140:143]
s_add_u32 m0,s39,0
s_add_u32 s26,s80,0
buffer_load_dwordx4 v10,s[76:79],s26 offen lds
s_nop 5
v_mfma_f32_16x16x32_bf16 v[136:139],v[248:251],v[68:71],v[136:139]
ds_write_b128 v11,v[32:35] offset:2048
ds_write_b128 v11,v[36:39] offset:2304
ds_read_b64_tr_b16 v[64:65],v7 offset:32768
ds_read_b64_tr_b16 v[66:67],v7 offset:33280
s_waitcnt lgkmcnt(12)
v_mfma_f32_16x16x32_bf16 v[144:147],v[248:251],v[72:75],v[144:147]
ds_read_b64_tr_b16 v[68:69],v8 offset:32768
ds_read_b64_tr_b16 v[70:71],v8 offset:33280
v_mfma_f32_16x16x32_bf16 v[148:151],v[252:255],v[72:75],v[148:151]
s_add_u32 m0,s39,1024
s_add_u32 s26,s80,32768
buffer_load_dwordx4 v10,s[76:79],s26 offen lds
s_waitcnt lgkmcnt(12)
v_mfma_f32_16x16x32_bf16 v[156:159],v[252:255],v[76:79],v[156:159]
v_mfma_f32_16x16x32_bf16 v[152:155],v[248:251],v[76:79],v[152:155]
s_waitcnt vmcnt(5)
s_cmp_lg_u32 s50,0
s_cbranch_scc1 L_xf_ok16
s_waitcnt vmcnt(2)
v_cmp_ne_u32 vcc,s96,v14
s_cbranch_vccnz L_xf_spin16
L_xf_ok16:
s_waitcnt lgkmcnt(4)
s_barrier
ds_read_b64_tr_b16 v[72:73],v5 offset:36864
ds_read_b64_tr_b16 v[74:75],v5 offset:37376
s_setprio 3
v_mfma_f32_16x16x32_bf16 v[160:163],v[80:83],v[40:43],v[160:163]
ds_read_b64_tr_b16 v[76:77],v6 offset:36864
ds_read_b64_tr_b16 v[78:79],v6 offset:37376
v_mfma_f32_16x16x32_bf16 v[164:167],v[84:87],v[40:43],v[164:167]
s_add_u32 m0,s39,16384
s_add_u32 s26,s81,0
buffer_load_dwordx4 v10,s[76:79],s26 offen lds
v_mfma_f32_16x16x32_bf16 v[172:175],v[84:87],v[44:47],v[172:175]
v_mfma_f32_16x16x32_bf16 v[168:171],v[80:83],v[44:47],v[168:171]
s_add_u32 m0,s39,17408
s_add_u32 s26,s81,32768
buffer_load_dwordx4 v10,s[76:79],s26 offen lds
ds_read_b64_tr_b16 v[40:41],v7 offset:36864
ds_read_b64_tr_b16 v[42:43],v7 offset:37376
s_waitcnt lgkmcnt(8)
v_mfma_f32_16x16x32_bf16 v[176:179],v[80:83],v[64:67],v[176:179]
s_add_u32 s54,s51,0
s_lshl_b32 s57,s54,12
ds_read_b64_tr_b16 v[44:45],v8 offset:36864
ds_read_b64_tr_b16 v[46:47],v8 offset:37376
v_mfma_f32_16x16x32_bf16 v[180:183],v[84:87],v[64:67],v[180:183]
s_lshl_b32 s54,s48,16
s_add_u32 s57,s57,s54
s_add_u32 s57,s57,100663296
s_waitcnt lgkmcnt(8)
v_mfma_f32_16x16x32_bf16 v[188:191],v[84:87],v[68:71],v[188:191]
buffer_load_dwordx4 v[24:27],v2,s[8:11],s88 offen offset:0 sc1
ds_read_b64 v[224:225],v13 offset:0
v_mfma_f32_16x16x32_bf16 v[184:187],v[80:83],v[68:71],v[184:187]
ds_read_b64 v[226:227],v13 offset:4096
ds_read_b64 v[228:229],v13 offset:8192
ds_read_b64 v[230:231],v13 offset:12288
ds_read_b64_tr_b16 v[64:65],v5 offset:40960
ds_read_b64_tr_b16 v[66:67],v5 offset:41472
s_waitcnt lgkmcnt(12)
v_mfma_f32_16x16x32_bf16 v[160:163],v[88:91],v[72:75],v[160:163]
buffer_load_dwordx4 v[28:31],v2,s[8:11],s88 offen offset:1024 sc1
ds_read_b64 v[232:233],v13 offset:16384
ds_read_b64_tr_b16 v[68:69],v6 offset:40960
ds_read_b64_tr_b16 v[70:71],v6 offset:41472
v_mfma_f32_16x16x32_bf16 v[164:167],v[92:95],v[72:75],v[164:167]
s_waitcnt lgkmcnt(14)
ds_read_b64 v[234:235],v13 offset:20480
s_waitcnt lgkmcnt(14)
ds_read_b64 v[236:237],v13 offset:24576
s_waitcnt lgkmcnt(14)
ds_read_b64 v[238:239],v13 offset:28672
v_mfma_f32_16x16x32_bf16 v[172:175],v[92:95],v[76:79],v[172:175]
buffer_load_dwordx4 v[32:35],v2,s[8:11],s88 offen offset:2048 sc1
s_waitcnt lgkmcnt(10)
v_add_f32 v224,v224,v226
v_mfma_f32_16x16x32_bf16 v[168:171],v[88:91],v[76:79],v[168:171]
v_add_f32 v225,v225,v227
s_waitcnt lgkmcnt(9)
v_add_f32 v224,v224,v228
v_add_f32 v225,v225,v229
ds_read_b64_tr_b16 v[72:73],v7 offset:40960
ds_read_b64_tr_b16 v[74:75],v7 offset:41472
v_mfma_f32_16x16x32_bf16 v[176:179],v[88:91],v[40:43],v[176:179]
buffer_load_dwordx4 v[36:39],v2,s[8:11],s88 offen offset:3072 sc1
s_waitcnt lgkmcnt(10)
v_add_f32 v224,v224,v230
v_add_f32 v225,v225,v231
ds_read_b64_tr_b16 v[76:77],v8 offset:40960
ds_read_b64_tr_b16 v[78:79],v8 offset:41472
v_mfma_f32_16x16x32_bf16 v[180:183],v[92:95],v[40:43],v[180:183]
s_waitcnt lgkmcnt(9)
v_add_f32 v224,v224,v232
v_add_f32 v225,v225,v233
s_waitcnt lgkmcnt(6)
v_add_f32 v224,v224,v234
v_mfma_f32_16x16x32_bf16 v[188:191],v[92:95],v[44:47],v[188:191]
v_add_f32 v225,v225,v235
s_waitcnt lgkmcnt(5)
v_add_f32 v224,v224,v236
v_mfma_f32_16x16x32_bf16 v[184:187],v[88:91],v[44:47],v[184:187]
v_add_f32 v225,v225,v237
s_waitcnt lgkmcnt(4)
v_add_f32 v224,v224,v238
ds_read_b64_tr_b16 v[40:41],v5 offset:45056
ds_read_b64_tr_b16 v[42:43],v5 offset:45568
s_setprio 2
v_mfma_f32_16x16x32_bf16 v[160:163],v[96:99],v[64:67],v[160:163]
buffer_load_dwordx4 v[48:51],v2,s[8:11],s89 offen offset:0 sc1
v_add_f32 v225,v225,v239
ds_read_b64_tr_b16 v[44:45],v6 offset:45056
ds_read_b64_tr_b16 v[46:47],v6 offset:45568
v_mfma_f32_16x16x32_bf16 v[164:167],v[100:103],v[64:67],v[164:167]
v_subrev_u32 v226,32768,v13
buffer_store_dwordx2 v[224:225],v226,s[40:43],s57 offen sc1
v_cvt_pk_bf16_f32 v144,v144,v145
v_mfma_f32_16x16x32_bf16 v[172:175],v[100:103],v[68:71],v[172:175]
buffer_load_dwordx4 v[52:55],v2,s[8:11],s89 offen offset:1024 sc1
v_cvt_pk_bf16_f32 v145,v146,v147
v_mfma_f32_16x16x32_bf16 v[168:171],v[96:99],v[68:71],v[168:171]
v_cvt_pk_bf16_f32 v146,v148,v149
v_cvt_pk_bf16_f32 v147,v150,v151
v_cvt_pk_bf16_f32 v148,v152,v153
ds_read_b64_tr_b16 v[64:65],v7 offset:45056
ds_read_b64_tr_b16 v[66:67],v7 offset:45568
s_waitcnt lgkmcnt(8)
v_mfma_f32_16x16x32_bf16 v[176:179],v[96:99],v[72:75],v[176:179]
buffer_load_dwordx4 v[56:59],v2,s[8:11],s89 offen offset:2048 sc1
v_cvt_pk_bf16_f32 v149,v154,v155
v_cvt_pk_bf16_f32 v150,v156,v157
ds_read_b64_tr_b16 v[68:69],v8 offset:45056
ds_read_b64_tr_b16 v[70:71],v8 offset:45568
v_mfma_f32_16x16x32_bf16 v[180:183],v[100:103],v[72:75],v[180:183]
v_cvt_pk_bf16_f32 v151,v158,v159
v_fma_f32 v15,v128,s61,-s61
v_fma_f32 v22,v129,s61,-s61
s_waitcnt lgkmcnt(8)
v_mfma_f32_16x16x32_bf16 v[188:191],v[100:103],v[76:79],v[188:191]
buffer_load_dwordx4 v[60:63],v2,s[8:11],s89 offen offset:3072 sc1
v_exp_f32 v15,v15 clamp
v_mfma_f32_16x16x32_bf16 v[184:187],v[96:99],v[76:79],v[184:187]
v_exp_f32 v22,v22 clamp
v_max_f32 v128,v15,v128
v_max_f32 v129,v22,v129
ds_read_b64_tr_b16 v[72:73],v5 offset:49152
ds_read_b64_tr_b16 v[74:75],v5 offset:49664
s_waitcnt lgkmcnt(8)
v_mfma_f32_16x16x32_bf16 v[160:163],v[104:107],v[40:43],v[160:163]
v_add_f32 v128,s62,v128
v_add_f32 v129,s62,v129
ds_read_b64_tr_b16 v[76:77],v6 offset:49152
ds_read_b64_tr_b16 v[78:79],v6 offset:49664
v_mfma_f32_16x16x32_bf16 v[164:167],v[108:111],v[40:43],v[164:167]
v_cvt_pk_bf16_f32 v128,v128,v129
v_fma_f32 v15,v130,s61,-s61
s_waitcnt lgkmcnt(8)
v_mfma_f32_16x16x32_bf16 v[172:175],v[108:111],v[44:47],v[172:175]
v_fma_f32 v22,v131,s61,-s61
v_exp_f32 v15,v15 clamp
v_mfma_f32_16x16x32_bf16 v[168:171],v[104:107],v[44:47],v[168:171]
v_exp_f32 v22,v22 clamp
v_max_f32 v130,v15,v130
ds_read_b64_tr_b16 v[40:41],v7 offset:49152
ds_read_b64_tr_b16 v[42:43],v7 offset:49664
s_waitcnt lgkmcnt(8)
v_mfma_f32_16x16x32_bf16 v[176:179],v[104:107],v[64:67],v[176:179]
v_max_f32 v131,v22,v131
v_add_f32 v130,s62,v130
ds_read_b64_tr_b16 v[44:45],v8 offset:49152
ds_read_b64_tr_b16 v[46:47],v8 offset:49664
v_mfma_f32_16x16x32_bf16 v[180:183],v[108:111],v[64:67],v[180:183]
v_add_f32 v131,s62,v131
v_cvt_pk_bf16_f32 v129,v130,v131
v_fma_f32 v15,v132,s61,-s61
s_waitcnt lgkmcnt(8)
v_mfma_f32_16x16x32_bf16 v[188:191],v[108:111],v[68:71],v[188:191]
v_fma_f32 v22,v133,s61,-s61
v_exp_f32 v15,v15 clamp
v_mfma_f32_16x16x32_bf16 v[184:187],v[104:107],v[68:71],v[184:187]
v_exp_f32 v22,v22 clamp
v_max_f32 v132,v15,v132
ds_read_b64_tr_b16 v[64:65],v5 offset:53248
ds_read_b64_tr_b16 v[66:67],v5 offset:53760
s_setprio 1
s_waitcnt lgkmcnt(8)
v_mfma_f32_16x16x32_bf16 v[160:163],v[112:115],v[72:75],v[160:163]
v_max_f32 v133,v22,v133
v_add_f32 v132,s62,v132
ds_read_b64_tr_b16 v[68:69],v6 offset:53248
ds_read_b64_tr_b16 v[70:71],v6 offset:53760
v_mfma_f32_16x16x32_bf16 v[164:167],v[116:119],v[72:75],v[164:167]
v_add_f32 v133,s62,v133
v_cvt_pk_bf16_f32 v130,v132,v133
s_waitcnt lgkmcnt(8)
v_mfma_f32_16x16x32_bf16 v[172:175],v[116:119],v[76:79],v[172:175]
v_fma_f32 v15,v134,s61,-s61
v_fma_f32 v22,v135,s61,-s61
v_mfma_f32_16x16x32_bf16 v[168:171],v[112:115],v[76:79],v[168:171]
v_exp_f32 v15,v15 clamp
v_exp_f32 v22,v22 clamp
ds_read_b64_tr_b16 v[72:73],v7 offset:53248
ds_read_b64_tr_b16 v[74:75],v7 offset:53760
s_waitcnt lgkmcnt(8)
v_mfma_f32_16x16x32_bf16 v[176:179],v[112:115],v[40:43],v[176:179]
v_max_f32 v134,v15,v134
v_max_f32 v135,v22,v135
ds_read_b64_tr_b16 v[76:77],v8 offset:53248
ds_read_b64_tr_b16 v[78:79],v8 offset:53760
v_mfma_f32_16x16x32_bf16 v[180:183],v[116:119],v[40:43],v[180:183]
v_add_f32 v134,s62,v134
v_add_f32 v135,s62,v135
v_cvt_pk_bf16_f32 v131,v134,v135
s_waitcnt lgkmcnt(8)
v_mfma_f32_16x16x32_bf16 v[188:191],v[116:119],v[44:47],v[188:191]
s_add_u32 s26,s37,4
s_and_b32 s26,s26,7
v_fma_f32 v15,v136,s61,-s61
v_mfma_f32_16x16x32_bf16 v[184:187],v[112:115],v[44:47],v[184:187]
v_fma_f32 v22,v137,s61,-s61
v_exp_f32 v15,v15 clamp
v_exp_f32 v22,v22 clamp
ds_read_b64_tr_b16 v[40:41],v5 offset:57344
ds_read_b64_tr_b16 v[42:43],v5 offset:57856
s_waitcnt lgkmcnt(8)
v_mfma_f32_16x16x32_bf16 v[160:163],v[120:123],v[64:67],v[160:163]
s_lshl_b32 s84,s26,19
v_max_f32 v136,v15,v136
ds_read_b64_tr_b16 v[44:45],v6 offset:57344
ds_read_b64_tr_b16 v[46:47],v6 offset:57856
v_mfma_f32_16x16x32_bf16 v[164:167],v[124:127],v[64:67],v[164:167]
v_max_f32 v137,v22,v137
v_add_f32 v136,s62,v136
v_add_f32 v137,s62,v137
s_waitcnt lgkmcnt(8)
v_mfma_f32_16x16x32_bf16 v[172:175],v[124:127],v[68:71],v[172:175]
s_add_u32 s84,s84,s29
s_lshl_b32 s26,s26,12
v_cvt_pk_bf16_f32 v132,v136,v137
v_mfma_f32_16x16x32_bf16 v[168:171],v[120:123],v[68:71],v[168:171]
v_fma_f32 v15,v138,s61,-s61
v_fma_f32 v22,v139,s61,-s61
v_exp_f32 v15,v15 clamp
ds_read_b64_tr_b16 v[64:65],v7 offset:57344
ds_read_b64_tr_b16 v[66:67],v7 offset:57856
s_waitcnt lgkmcnt(8)
v_mfma_f32_16x16x32_bf16 v[176:179],v[120:123],v[72:75],v[176:179]
s_add_u32 s92,s26,s24
v_exp_f32 v22,v22 clamp
v_max_f32 v138,v15,v138
ds_read_b64_tr_b16 v[68:69],v8 offset:57344
ds_read_b64_tr_b16 v[70:71],v8 offset:57856
v_mfma_f32_16x16x32_bf16 v[180:183],v[124:127],v[72:75],v[180:183]
v_max_f32 v139,v22,v139
v_add_f32 v138,s62,v138
v_add_f32 v139,s62,v139
s_waitcnt lgkmcnt(8)
v_mfma_f32_16x16x32_bf16 v[188:191],v[124:127],v[76:79],v[188:191]
s_add_u32 s26,s37,5
v_cvt_pk_bf16_f32 v133,v138,v139
v_mfma_f32_16x16x32_bf16 v[184:187],v[120:123],v[76:79],v[184:187]
v_mfma_f32_16x16x32_bf16 v[152:155],v[128:131],v[144:147],0
v_mfma_f32_16x16x32_bf16 v[156:159],v[128:131],v[16:19],0
v_fma_f32 v15,v140,s61,-s61
ds_read_b64_tr_b16 v[72:73],v5 offset:61440
ds_read_b64_tr_b16 v[74:75],v5 offset:61952
s_setprio 0
s_waitcnt lgkmcnt(8)
v_mfma_f32_16x16x32_bf16 v[160:163],v[240:243],v[40:43],v[160:163]
s_and_b32 s26,s26,7
s_lshl_b32 s85,s26,19
v_fma_f32 v22,v141,s61,-s61
ds_read_b64_tr_b16 v[76:77],v6 offset:61440
ds_read_b64_tr_b16 v[78:79],v6 offset:61952
v_mfma_f32_16x16x32_bf16 v[164:167],v[244:247],v[40:43],v[164:167]
v_exp_f32 v15,v15 clamp
v_exp_f32 v22,v22 clamp
v_max_f32 v140,v15,v140
s_waitcnt lgkmcnt(8)
v_mfma_f32_16x16x32_bf16 v[172:175],v[244:247],v[44:47],v[172:175]
s_add_u32 s85,s85,s29
v_max_f32 v141,v22,v141
v_mfma_f32_16x16x32_bf16 v[168:171],v[240:243],v[44:47],v[168:171]
v_add_f32 v140,s62,v140
v_add_f32 v141,s62,v141
v_cvt_pk_bf16_f32 v134,v140,v141
ds_read_b64_tr_b16 v[40:41],v7 offset:61440
ds_read_b64_tr_b16 v[42:43],v7 offset:61952
s_waitcnt lgkmcnt(8)
v_mfma_f32_16x16x32_bf16 v[176:179],v[240:243],v[64:67],v[176:179]
s_lshl_b32 s26,s26,12
s_add_u32 s93,s26,s24
v_fma_f32 v15,v142,s61,-s61
ds_read_b64_tr_b16 v[44:45],v8 offset:61440
ds_read_b64_tr_b16 v[46:47],v8 offset:61952
v_mfma_f32_16x16x32_bf16 v[180:183],v[244:247],v[64:67],v[180:183]
v_fma_f32 v22,v143,s61,-s61
v_exp_f32 v15,v15 clamp
v_exp_f32 v22,v22 clamp
v_max_f32 v142,v15,v142
s_waitcnt lgkmcnt(8)
v_mfma_f32_16x16x32_bf16 v[188:191],v[244:247],v[68:71],v[188:191]
s_add_u32 s26,s37,6
v_max_f32 v143,v22,v143
v_mfma_f32_16x16x32_bf16 v[184:187],v[240:243],v[68:71],v[184:187]
v_add_f32 v142,s62,v142
v_add_f32 v143,s62,v143
v_cvt_pk_bf16_f32 v135,v142,v143
v_add_u32 v5,0x10000,v5
ds_read_b64_tr_b16 v[64:65],v5 offset:0
ds_read_b64_tr_b16 v[66:67],v5 offset:512
s_waitcnt lgkmcnt(8)
v_mfma_f32_16x16x32_bf16 v[160:163],v[248:251],v[72:75],v[160:163]
s_and_b32 s26,s26,7
s_nop 1
v_add_u32 v6,0x10000,v6
ds_read_b64_tr_b16 v[68:69],v6 offset:0
ds_read_b64_tr_b16 v[70:71],v6 offset:512
v_mfma_f32_16x16x32_bf16 v[164:167],v[252:255],v[72:75],v[164:167]
v_mfma_f32_16x16x32_bf16 v[136:139],v[132:135],v[148:151],0
v_mfma_f32_16x16x32_bf16 v[140:143],v[132:135],v[16:19],0
ds_write_b128 v11,v[152:155] offset:32768
s_waitcnt lgkmcnt(9)
v_mfma_f32_16x16x32_bf16 v[172:175],v[252:255],v[76:79],v[172:175]
s_lshl_b32 s86,s26,19
s_add_u32 s86,s86,s29
ds_write_b128 v11,v[156:159] offset:33024
v_mfma_f32_16x16x32_bf16 v[168:171],v[248:251],v[76:79],v[168:171]
s_nop 5
ds_write_b128 v11,v[136:139] offset:34816
ds_write_b128 v11,v[140:143] offset:35072
v_add_u32 v7,0x10000,v7
ds_read_b64_tr_b16 v[72:73],v7 offset:0
ds_read_b64_tr_b16 v[74:75],v7 offset:512
s_waitcnt lgkmcnt(12)
v_mfma_f32_16x16x32_bf16 v[176:179],v[248:251],v[40:43],v[176:179]
v_add_u32 v8,0x10000,v8
ds_read_b64_tr_b16 v[76:77],v8 offset:0
ds_read_b64_tr_b16 v[78:79],v8 offset:512
v_mfma_f32_16x16x32_bf16 v[180:183],v[252:255],v[40:43],v[180:183]
s_lshl_b32 s26,s26,12
s_waitcnt lgkmcnt(12)
v_mfma_f32_16x16x32_bf16 v[188:191],v[252:255],v[44:47],v[188:191]
s_add_u32 s94,s26,s24
v_mfma_f32_16x16x32_bf16 v[184:187],v[248:251],v[44:47],v[184:187]
s_add_u32 s26,s37,7
s_waitcnt vmcnt(13)
s_waitcnt lgkmcnt(4)
s_barrier
ds_read_b64_tr_b16 v[40:41],v5 offset:4096
ds_read_b64_tr_b16 v[42:43],v5 offset:4608
s_setprio 3
v_mfma_f32_16x16x32_bf16 v[192:195],v[80:83],v[64:67],v[192:195]
ds_read_b64_tr_b16 v[44:45],v6 offset:4096
ds_read_b64_tr_b16 v[46:47],v6 offset:4608
v_mfma_f32_16x16x32_bf16 v[196:199],v[84:87],v[64:67],v[196:199]
s_and_b32 s26,s26,7
v_mfma_f32_16x16x32_bf16 v[204:207],v[84:87],v[68:71],v[204:207]
v_mfma_f32_16x16x32_bf16 v[200:203],v[80:83],v[68:71],v[200:203]
s_lshl_b32 s87,s26,19
ds_read_b64_tr_b16 v[64:65],v7 offset:4096
ds_read_b64_tr_b16 v[66:67],v7 offset:4608
s_waitcnt lgkmcnt(8)
v_mfma_f32_16x16x32_bf16 v[208:211],v[80:83],v[72:75],v[208:211]
s_add_u32 s87,s87,s29
s_lshl_b32 s26,s26,12
s_add_u32 s54,s51,1
ds_read_b64_tr_b16 v[68:69],v8 offset:4096
ds_read_b64_tr_b16 v[70:71],v8 offset:4608
v_mfma_f32_16x16x32_bf16 v[212:215],v[84:87],v[72:75],v[212:215]
s_lshl_b32 s57,s54,12
s_lshl_b32 s54,s48,16
s_add_u32 s57,s57,s54
s_add_u32 s57,s57,100663296
s_waitcnt lgkmcnt(8)
v_mfma_f32_16x16x32_bf16 v[220:223],v[84:87],v[76:79],v[220:223]
s_add_u32 s95,s26,s24
ds_read_b64 v[224:225],v13 offset:32768
v_mfma_f32_16x16x32_bf16 v[216:219],v[80:83],v[76:79],v[216:219]
ds_read_b64 v[226:227],v13 offset:36864
ds_read_b64 v[228:229],v13 offset:40960
ds_read_b64 v[230:231],v13 offset:45056
ds_read_b64_tr_b16 v[72:73],v5 offset:8192
ds_read_b64_tr_b16 v[74:75],v5 offset:8704
s_waitcnt lgkmcnt(12)
v_mfma_f32_16x16x32_bf16 v[192:195],v[88:91],v[40:43],v[192:195]
s_lshl_b32 s26,s18,1
s_sub_u32 s22,31,s26
ds_read_b64 v[232:233],v13 offset:49152
ds_read_b64_tr_b16 v[76:77],v6 offset:8192
ds_read_b64_tr_b16 v[78:79],v6 offset:8704
v_mfma_f32_16x16x32_bf16 v[196:199],v[92:95],v[40:43],v[196:199]
s_waitcnt lgkmcnt(14)
ds_read_b64 v[234:235],v13 offset:53248
s_waitcnt lgkmcnt(14)
ds_read_b64 v[236:237],v13 offset:57344
s_waitcnt lgkmcnt(14)
ds_read_b64 v[238:239],v13 offset:61440
v_mfma_f32_16x16x32_bf16 v[204:207],v[92:95],v[44:47],v[204:207]
s_lshl_b32 s36,s17,20
s_waitcnt lgkmcnt(10)
v_add_f32 v224,v224,v226
v_mfma_f32_16x16x32_bf16 v[200:203],v[88:91],v[44:47],v[200:203]
v_add_f32 v225,v225,v227
s_waitcnt lgkmcnt(9)
v_add_f32 v224,v224,v228
v_add_f32 v225,v225,v229
ds_read_b64_tr_b16 v[40:41],v7 offset:8192
ds_read_b64_tr_b16 v[42:43],v7 offset:8704
v_mfma_f32_16x16x32_bf16 v[208:211],v[88:91],v[64:67],v[208:211]
s_mov_b64 s[72:73],s[40:41]
s_waitcnt lgkmcnt(10)
v_add_f32 v224,v224,v230
v_add_f32 v225,v225,v231
ds_read_b64_tr_b16 v[44:45],v8 offset:8192
ds_read_b64_tr_b16 v[46:47],v8 offset:8704
v_mfma_f32_16x16x32_bf16 v[212:215],v[92:95],v[64:67],v[212:215]
s_waitcnt lgkmcnt(9)
v_add_f32 v224,v224,v232
v_add_f32 v225,v225,v233
s_waitcnt lgkmcnt(6)
v_add_f32 v224,v224,v234
v_mfma_f32_16x16x32_bf16 v[220:223],v[92:95],v[68:71],v[220:223]
s_mov_b32 s74,268435456
s_mov_b32 s75,0x20000
v_add_f32 v225,v225,v235
v_mfma_f32_16x16x32_bf16 v[216:219],v[88:91],v[68:71],v[216:219]
s_waitcnt lgkmcnt(5)
v_add_f32 v224,v224,v236
v_add_f32 v225,v225,v237
s_waitcnt lgkmcnt(4)
v_add_f32 v224,v224,v238
ds_read_b64_tr_b16 v[64:65],v5 offset:12288
ds_read_b64_tr_b16 v[66:67],v5 offset:12800
s_setprio 2
v_mfma_f32_16x16x32_bf16 v[192:195],v[96:99],v[72:75],v[192:195]
s_mov_b32 s29,0
v_add_f32 v225,v225,v239
ds_read_b64_tr_b16 v[68:69],v6 offset:12288
ds_read_b64_tr_b16 v[70:71],v6 offset:12800
v_mfma_f32_16x16x32_bf16 v[196:199],v[100:103],v[72:75],v[196:199]
v_subrev_u32 v226,32768,v13
buffer_store_dwordx2 v[224:225],v226,s[40:43],s57 offen sc1
v_cvt_pk_bf16_f32 v176,v176,v177
v_mfma_f32_16x16x32_bf16 v[204:207],v[100:103],v[76:79],v[204:207]
s_mov_b32 s24,0
s_lshl_b32 s26,s16,13
v_cvt_pk_bf16_f32 v177,v178,v179
v_mfma_f32_16x16x32_bf16 v[200:203],v[96:99],v[76:79],v[200:203]
v_cvt_pk_bf16_f32 v178,v180,v181
v_cvt_pk_bf16_f32 v179,v182,v183
v_cvt_pk_bf16_f32 v180,v184,v185
ds_read_b64_tr_b16 v[72:73],v7 offset:12288
ds_read_b64_tr_b16 v[74:75],v7 offset:12800
s_waitcnt lgkmcnt(8)
v_mfma_f32_16x16x32_bf16 v[208:211],v[96:99],v[40:43],v[208:211]
s_add_u32 s25,s36,s26
v_cvt_pk_bf16_f32 v181,v186,v187
v_cvt_pk_bf16_f32 v182,v188,v189
ds_read_b64_tr_b16 v[76:77],v8 offset:12288
ds_read_b64_tr_b16 v[78:79],v8 offset:12800
v_mfma_f32_16x16x32_bf16 v[212:215],v[100:103],v[40:43],v[212:215]
v_cvt_pk_bf16_f32 v183,v190,v191
v_fma_f32 v15,v160,s61,-s61
v_fma_f32 v22,v161,s61,-s61
s_waitcnt lgkmcnt(8)
v_mfma_f32_16x16x32_bf16 v[220:223],v[100:103],v[44:47],v[220:223]
s_add_u32 s25,s25,16384
v_exp_f32 v15,v15 clamp
v_mfma_f32_16x16x32_bf16 v[216:219],v[96:99],v[44:47],v[216:219]
v_exp_f32 v22,v22 clamp
v_max_f32 v160,v15,v160
v_max_f32 v161,v22,v161
ds_read_b64_tr_b16 v[40:41],v5 offset:16384
ds_read_b64_tr_b16 v[42:43],v5 offset:16896
s_waitcnt lgkmcnt(8)
v_mfma_f32_16x16x32_bf16 v[192:195],v[104:107],v[64:67],v[192:195]
s_mov_b32 s23,32768
s_mov_b32 s21,0
v_add_f32 v160,s62,v160
ds_read_b64_tr_b16 v[44:45],v6 offset:16384
ds_read_b64_tr_b16 v[46:47],v6 offset:16896
v_mfma_f32_16x16x32_bf16 v[196:199],v[108:111],v[64:67],v[196:199]
v_add_f32 v161,s62,v161
v_cvt_pk_bf16_f32 v160,v160,v161
v_fma_f32 v15,v162,s61,-s61
s_waitcnt lgkmcnt(8)
v_mfma_f32_16x16x32_bf16 v[204:207],v[108:111],v[68:71],v[204:207]
s_sub_u32 s20,s19,1
v_fma_f32 v22,v163,s61,-s61
v_mfma_f32_16x16x32_bf16 v[200:203],v[104:107],v[68:71],v[200:203]
v_exp_f32 v15,v15 clamp
v_exp_f32 v22,v22 clamp
v_max_f32 v162,v15,v162
ds_read_b64_tr_b16 v[64:65],v7 offset:16384
ds_read_b64_tr_b16 v[66:67],v7 offset:16896
s_waitcnt lgkmcnt(8)
v_mfma_f32_16x16x32_bf16 v[208:211],v[104:107],v[72:75],v[208:211]
s_max_i32 s20,s20,0
v_max_f32 v163,v22,v163
v_add_f32 v162,s62,v162
ds_read_b64_tr_b16 v[68:69],v8 offset:16384
ds_read_b64_tr_b16 v[70:71],v8 offset:16896
v_mfma_f32_16x16x32_bf16 v[212:215],v[108:111],v[72:75],v[212:215]
v_add_f32 v163,s62,v163
v_cvt_pk_bf16_f32 v161,v162,v163
v_fma_f32 v15,v164,s61,-s61
s_waitcnt lgkmcnt(8)
v_mfma_f32_16x16x32_bf16 v[220:223],v[108:111],v[76:79],v[220:223]
v_fma_f32 v22,v165,s61,-s61
v_exp_f32 v15,v15 clamp
v_mfma_f32_16x16x32_bf16 v[216:219],v[104:107],v[76:79],v[216:219]
v_exp_f32 v22,v22 clamp
v_max_f32 v164,v15,v164
ds_read_b64_tr_b16 v[72:73],v5 offset:20480
ds_read_b64_tr_b16 v[74:75],v5 offset:20992
s_setprio 1
s_waitcnt lgkmcnt(8)
v_mfma_f32_16x16x32_bf16 v[192:195],v[112:115],v[40:43],v[192:195]
v_max_f32 v165,v22,v165
v_add_f32 v164,s62,v164
ds_read_b64_tr_b16 v[76:77],v6 offset:20480
ds_read_b64_tr_b16 v[78:79],v6 offset:20992
v_mfma_f32_16x16x32_bf16 v[196:199],v[116:119],v[40:43],v[196:199]
v_add_f32 v165,s62,v165
v_cvt_pk_bf16_f32 v162,v164,v165
s_waitcnt lgkmcnt(8)
v_mfma_f32_16x16x32_bf16 v[204:207],v[116:119],v[44:47],v[204:207]
v_fma_f32 v15,v166,s61,-s61
v_fma_f32 v22,v167,s61,-s61
v_mfma_f32_16x16x32_bf16 v[200:203],v[112:115],v[44:47],v[200:203]
v_exp_f32 v15,v15 clamp
v_exp_f32 v22,v22 clamp
ds_read_b64_tr_b16 v[40:41],v7 offset:20480
ds_read_b64_tr_b16 v[42:43],v7 offset:20992
s_waitcnt lgkmcnt(8)
v_mfma_f32_16x16x32_bf16 v[208:211],v[112:115],v[64:67],v[208:211]
v_max_f32 v166,v15,v166
v_max_f32 v167,v22,v167
ds_read_b64_tr_b16 v[44:45],v8 offset:20480
ds_read_b64_tr_b16 v[46:47],v8 offset:20992
v_mfma_f32_16x16x32_bf16 v[212:215],v[116:119],v[64:67],v[212:215]
v_add_f32 v166,s62,v166
v_add_f32 v167,s62,v167
v_cvt_pk_bf16_f32 v163,v166,v167
s_waitcnt lgkmcnt(8)
v_mfma_f32_16x16x32_bf16 v[220:223],v[116:119],v[68:71],v[220:223]
v_fma_f32 v15,v168,s61,-s61
v_fma_f32 v22,v169,s61,-s61
v_mfma_f32_16x16x32_bf16 v[216:219],v[112:115],v[68:71],v[216:219]
v_exp_f32 v15,v15 clamp
v_exp_f32 v22,v22 clamp
ds_read_b64_tr_b16 v[64:65],v5 offset:24576
ds_read_b64_tr_b16 v[66:67],v5 offset:25088
s_waitcnt lgkmcnt(8)
v_mfma_f32_16x16x32_bf16 v[192:195],v[120:123],v[72:75],v[192:195]
v_max_f32 v168,v15,v168
v_max_f32 v169,v22,v169
ds_read_b64_tr_b16 v[68:69],v6 offset:24576
ds_read_b64_tr_b16 v[70:71],v6 offset:25088
v_mfma_f32_16x16x32_bf16 v[196:199],v[124:127],v[72:75],v[196:199]
v_add_f32 v168,s62,v168
v_add_f32 v169,s62,v169
s_waitcnt lgkmcnt(8)
v_mfma_f32_16x16x32_bf16 v[204:207],v[124:127],v[76:79],v[204:207]
v_cvt_pk_bf16_f32 v164,v168,v169
v_fma_f32 v15,v170,s61,-s61
v_mfma_f32_16x16x32_bf16 v[200:203],v[120:123],v[76:79],v[200:203]
v_fma_f32 v22,v171,s61,-s61
v_exp_f32 v15,v15 clamp
ds_read_b64_tr_b16 v[72:73],v7 offset:24576
ds_read_b64_tr_b16 v[74:75],v7 offset:25088
s_waitcnt lgkmcnt(8)
v_mfma_f32_16x16x32_bf16 v[208:211],v[120:123],v[40:43],v[208:211]
v_exp_f32 v22,v22 clamp
v_max_f32 v170,v15,v170
ds_read_b64_tr_b16 v[76:77],v8 offset:24576
ds_read_b64_tr_b16 v[78:79],v8 offset:25088
v_mfma_f32_16x16x32_bf16 v[212:215],v[124:127],v[40:43],v[212:215]
v_max_f32 v171,v22,v171
v_add_f32 v170,s62,v170
v_add_f32 v171,s62,v171
s_waitcnt lgkmcnt(8)
v_mfma_f32_16x16x32_bf16 v[220:223],v[124:127],v[44:47],v[220:223]
v_cvt_pk_bf16_f32 v165,v170,v171
v_mfma_f32_16x16x32_bf16 v[184:187],v[160:163],v[176:179],0
v_mfma_f32_16x16x32_bf16 v[216:219],v[120:123],v[44:47],v[216:219]
v_mfma_f32_16x16x32_bf16 v[188:191],v[160:163],v[16:19],0
v_fma_f32 v15,v172,s61,-s61
ds_read_b64_tr_b16 v[40:41],v5 offset:28672
ds_read_b64_tr_b16 v[42:43],v5 offset:29184
s_setprio 0
s_waitcnt lgkmcnt(8)
v_mfma_f32_16x16x32_bf16 v[192:195],v[240:243],v[64:67],v[192:195]
v_fma_f32 v22,v173,s61,-s61
v_exp_f32 v15,v15 clamp
ds_read_b64_tr_b16 v[44:45],v6 offset:28672
ds_read_b64_tr_b16 v[46:47],v6 offset:29184
v_mfma_f32_16x16x32_bf16 v[196:199],v[244:247],v[64:67],v[196:199]
v_exp_f32 v22,v22 clamp
v_max_f32 v172,v15,v172
s_waitcnt lgkmcnt(8)
v_mfma_f32_16x16x32_bf16 v[204:207],v[244:247],v[68:71],v[204:207]
v_max_f32 v173,v22,v173
v_add_f32 v172,s62,v172
v_mfma_f32_16x16x32_bf16 v[200:203],v[240:243],v[68:71],v[200:203]
v_add_f32 v173,s62,v173
v_cvt_pk_bf16_f32 v166,v172,v173
ds_read_b64_tr_b16 v[64:65],v7 offset:28672
ds_read_b64_tr_b16 v[66:67],v7 offset:29184
s_waitcnt lgkmcnt(8)
v_mfma_f32_16x16x32_bf16 v[208:211],v[240:243],v[72:75],v[208:211]
v_fma_f32 v15,v174,s61,-s61
v_fma_f32 v22,v175,s61,-s61
ds_read_b64_tr_b16 v[68:69],v8 offset:28672
ds_read_b64_tr_b16 v[70:71],v8 offset:29184
v_mfma_f32_16x16x32_bf16 v[212:215],v[244:247],v[72:75],v[212:215]
v_exp_f32 v15,v15 clamp
v_exp_f32 v22,v22 clamp
v_max_f32 v174,v15,v174
s_waitcnt lgkmcnt(8)
v_mfma_f32_16x16x32_bf16 v[220:223],v[244:247],v[76:79],v[220:223]
v_max_f32 v175,v22,v175
v_add_f32 v174,s62,v174
v_mfma_f32_16x16x32_bf16 v[216:219],v[240:243],v[76:79],v[216:219]
v_add_f32 v175,s62,v175
v_cvt_pk_bf16_f32 v167,v174,v175
s_waitcnt lgkmcnt(6)
v_mfma_f32_16x16x32_bf16 v[192:195],v[248:251],v[40:43],v[192:195]
s_nop 1
v_mfma_f32_16x16x32_bf16 v[168:171],v[164:167],v[180:183],0
v_mfma_f32_16x16x32_bf16 v[196:199],v[252:255],v[40:43],v[196:199]
v_mfma_f32_16x16x32_bf16 v[172:175],v[164:167],v[16:19],0
ds_write_b128 v11,v[184:187] offset:0
s_waitcnt lgkmcnt(5)
v_mfma_f32_16x16x32_bf16 v[204:207],v[252:255],v[44:47],v[204:207]
ds_write_b128 v11,v[188:191] offset:256
s_nop 5
v_mfma_f32_16x16x32_bf16 v[200:203],v[248:251],v[44:47],v[200:203]
ds_write_b128 v11,v[168:171] offset:2048
ds_write_b128 v11,v[172:175] offset:2304
s_waitcnt lgkmcnt(6)
v_mfma_f32_16x16x32_bf16 v[208:211],v[248:251],v[64:67],v[208:211]
v_mfma_f32_16x16x32_bf16 v[212:215],v[252:255],v[64:67],v[212:215]
s_waitcnt lgkmcnt(4)
v_mfma_f32_16x16x32_bf16 v[220:223],v[252:255],v[68:71],v[220:223]
v_mfma_f32_16x16x32_bf16 v[216:219],v[248:251],v[68:71],v[216:219]
s_waitcnt lgkmcnt(0)
s_barrier
s_add_u32 s54,s51,2
s_lshl_b32 s57,s54,12
s_lshl_b32 s54,s48,16
s_add_u32 s57,s57,s54
s_add_u32 s57,s57,100663296
ds_read_b64 v[224:225],v13 offset:0
ds_read_b64 v[226:227],v13 offset:4096
ds_read_b64 v[228:229],v13 offset:8192
ds_read_b64 v[230:231],v13 offset:12288
ds_read_b64 v[232:233],v13 offset:16384
ds_read_b64 v[234:235],v13 offset:20480
ds_read_b64 v[236:237],v13 offset:24576
ds_read_b64 v[238:239],v13 offset:28672
s_waitcnt lgkmcnt(6)
v_add_f32 v224,v224,v226
v_add_f32 v225,v225,v227
s_waitcnt lgkmcnt(5)
v_add_f32 v224,v224,v228
v_add_f32 v225,v225,v229
s_waitcnt lgkmcnt(4)
v_add_f32 v224,v224,v230
v_add_f32 v225,v225,v231
s_waitcnt lgkmcnt(3)
v_add_f32 v224,v224,v232
v_add_f32 v225,v225,v233
s_waitcnt lgkmcnt(2)
v_add_f32 v224,v224,v234
v_add_f32 v225,v225,v235
s_waitcnt lgkmcnt(1)
v_add_f32 v224,v224,v236
v_add_f32 v225,v225,v237
s_waitcnt lgkmcnt(0)
v_add_f32 v224,v224,v238
v_add_f32 v225,v225,v239
v_subrev_u32 v226,32768,v13
buffer_store_dwordx2 v[224:225],v226,s[40:43],s57 offen sc1
v_cvt_pk_bf16_f32 v208,v208,v209
v_cvt_pk_bf16_f32 v209,v210,v211
v_cvt_pk_bf16_f32 v210,v212,v213
v_cvt_pk_bf16_f32 v211,v214,v215
v_cvt_pk_bf16_f32 v212,v216,v217
v_cvt_pk_bf16_f32 v213,v218,v219
v_cvt_pk_bf16_f32 v214,v220,v221
v_cvt_pk_bf16_f32 v215,v222,v223
v_fma_f32 v15,v192,s61,-s61
v_fma_f32 v22,v193,s61,-s61
v_exp_f32 v15,v15 clamp
v_exp_f32 v22,v22 clamp
v_max_f32 v192,v15,v192
v_max_f32 v193,v22,v193
v_add_f32 v192,s62,v192
v_add_f32 v193,s62,v193
v_cvt_pk_bf16_f32 v192,v192,v193
v_fma_f32 v15,v194,s61,-s61
v_fma_f32 v22,v195,s61,-s61
v_exp_f32 v15,v15 clamp
v_exp_f32 v22,v22 clamp
v_max_f32 v194,v15,v194
v_max_f32 v195,v22,v195
v_add_f32 v194,s62,v194
v_add_f32 v195,s62,v195
v_cvt_pk_bf16_f32 v193,v194,v195
v_fma_f32 v15,v196,s61,-s61
v_fma_f32 v22,v197,s61,-s61
v_exp_f32 v15,v15 clamp
v_exp_f32 v22,v22 clamp
v_max_f32 v196,v15,v196
v_max_f32 v197,v22,v197
v_add_f32 v196,s62,v196
v_add_f32 v197,s62,v197
v_cvt_pk_bf16_f32 v194,v196,v197
v_fma_f32 v15,v198,s61,-s61
v_fma_f32 v22,v199,s61,-s61
v_exp_f32 v15,v15 clamp
v_exp_f32 v22,v22 clamp
v_max_f32 v198,v15,v198
v_max_f32 v199,v22,v199
v_add_f32 v198,s62,v198
v_add_f32 v199,s62,v199
v_cvt_pk_bf16_f32 v195,v198,v199
v_fma_f32 v15,v200,s61,-s61
v_fma_f32 v22,v201,s61,-s61
v_exp_f32 v15,v15 clamp
v_exp_f32 v22,v22 clamp
v_max_f32 v200,v15,v200
v_max_f32 v201,v22,v201
v_add_f32 v200,s62,v200
v_add_f32 v201,s62,v201
v_cvt_pk_bf16_f32 v196,v200,v201
v_fma_f32 v15,v202,s61,-s61
v_fma_f32 v22,v203,s61,-s61
v_exp_f32 v15,v15 clamp
v_exp_f32 v22,v22 clamp
v_max_f32 v202,v15,v202
v_max_f32 v203,v22,v203
v_add_f32 v202,s62,v202
v_add_f32 v203,s62,v203
v_cvt_pk_bf16_f32 v197,v202,v203
v_mfma_f32_16x16x32_bf16 v[216:219],v[192:195],v[208:211],0
v_mfma_f32_16x16x32_bf16 v[220:223],v[192:195],v[16:19],0
v_fma_f32 v15,v204,s61,-s61
v_fma_f32 v22,v205,s61,-s61
v_exp_f32 v15,v15 clamp
v_exp_f32 v22,v22 clamp
v_max_f32 v204,v15,v204
v_max_f32 v205,v22,v205
v_add_f32 v204,s62,v204
v_add_f32 v205,s62,v205
v_cvt_pk_bf16_f32 v198,v204,v205
v_fma_f32 v15,v206,s61,-s61
v_fma_f32 v22,v207,s61,-s61
v_exp_f32 v15,v15 clamp
v_exp_f32 v22,v22 clamp
v_max_f32 v206,v15,v206
v_max_f32 v207,v22,v207
v_add_f32 v206,s62,v206
v_add_f32 v207,s62,v207
v_cvt_pk_bf16_f32 v199,v206,v207
s_nop 1
v_mfma_f32_16x16x32_bf16 v[200:203],v[196:199],v[212:215],0
v_mfma_f32_16x16x32_bf16 v[204:207],v[196:199],v[16:19],0
ds_write_b128 v11,v[216:219] offset:32768
ds_write_b128 v11,v[220:223] offset:33024
s_nop 5
ds_write_b128 v11,v[200:203] offset:34816
ds_write_b128 v11,v[204:207] offset:35072
s_waitcnt lgkmcnt(0)
s_barrier
s_add_u32 m0,s39,32768
s_add_u32 s26,s82,0
buffer_load_dwordx4 v10,s[76:79],s26 offen lds
s_add_u32 m0,s39,33792
s_add_u32 s26,s82,32768
buffer_load_dwordx4 v10,s[76:79],s26 offen lds
s_add_u32 m0,s39,49152
s_add_u32 s26,s83,0
buffer_load_dwordx4 v10,s[76:79],s26 offen lds
s_add_u32 m0,s39,50176
s_add_u32 s26,s83,32768
buffer_load_dwordx4 v10,s[76:79],s26 offen lds
s_add_u32 s54,s51,3
s_lshl_b32 s57,s54,12
s_lshl_b32 s54,s48,16
s_add_u32 s57,s57,s54
s_add_u32 s57,s57,100663296
ds_read_b64 v[160:161],v13 offset:32768
ds_read_b64 v[162:163],v13 offset:36864
ds_read_b64 v[164:165],v13 offset:40960
ds_read_b64 v[166:167],v13 offset:45056
ds_read_b64 v[168:169],v13 offset:49152
ds_read_b64 v[170:171],v13 offset:53248
ds_read_b64 v[172:173],v13 offset:57344
ds_read_b64 v[174:175],v13 offset:61440
s_waitcnt lgkmcnt(6)
v_add_f32 v160,v160,v162
v_add_f32 v161,v161,v163
s_waitcnt lgkmcnt(5)
v_add_f32 v160,v160,v164
v_add_f32 v161,v161,v165
s_waitcnt lgkmcnt(4)
v_add_f32 v160,v160,v166
v_add_f32 v161,v161,v167
s_waitcnt lgkmcnt(3)
v_add_f32 v160,v160,v168
v_add_f32 v161,v161,v169
s_waitcnt lgkmcnt(2)
v_add_f32 v160,v160,v170
v_add_f32 v161,v161,v171
s_waitcnt lgkmcnt(1)
v_add_f32 v160,v160,v172
v_add_f32 v161,v161,v173
s_waitcnt lgkmcnt(0)
v_add_f32 v160,v160,v174
v_add_f32 v161,v161,v175
v_subrev_u32 v162,32768,v13
buffer_store_dwordx2 v[160:161],v162,s[40:43],s57 offen sc1
s_waitcnt vmcnt(1)
s_branch L_k1_end2
L_k1_p_v4:
s_and_b32 s53,s50,1
s_lshl_b32 s53,s53,4
v_xor_b32 v26,s53,v26
v_lshrrev_b32 v28,5,v1
v_lshl_add_u32 v3,v28,13,v3
s_mov_b32 s38,4194304
s_sub_u32 s53,s49,13
s_mul_i32 s51,s53,5
s_min_u32 s51,s51,60
s_mul_i32 s54,s51,128
s_add_u32 s54,s54,0
s_mul_i32 s56,s50,65536
s_add_u32 s56,s56,s54
v_mul_u32_u24 v2,8192,v24
v_add_u32 v2,v2,v26
s_mov_b32 s52,4
s_waitcnt lgkmcnt(0)
s_mov_b64 s[32:33],s[6:7]
s_mov_b64 s[36:37],s[12:13]
s_mov_b64 s[40:41],s[28:29]
s_add_u32 s53,s68,0
s_and_b32 s53,s53,7
s_mul_i32 s72,s53,524288
s_add_u32 s72,s72,s56
s_lshl_b32 s53,s53,7
s_add_u32 s80,s55,s53
s_add_u32 m0,s60,65536
s_add_u32 s53,s72,0
buffer_load_dwordx4 v2,s[36:39],s53 offen lds
s_add_u32 m0,s58,0
s_add_u32 s53,s80,0
buffer_load_dwordx4 v3,s[32:35],s53 offen lds
s_add_u32 m0,s58,1024
s_add_u32 s53,s80,8192
buffer_load_dwordx4 v3,s[32:35],s53 offen lds
s_add_u32 m0,s58,2048
s_add_u32 s53,s80,64
buffer_load_dwordx4 v3,s[32:35],s53 offen lds
s_add_u32 m0,s58,3072
s_add_u32 s53,s80,8256
buffer_load_dwordx4 v3,s[32:35],s53 offen lds
s_add_u32 m0,s60,73728
s_add_u32 s53,s72,128
buffer_load_dwordx4 v2,s[36:39],s53 offen lds
s_cmp_lg_u32 s50,0
s_cbranch_scc1 L_tag17
s_cmp_lg_u32 s101,0
s_cbranch_scc1 L_tag17
s_cmp_lg_u32 s52,4
s_cbranch_scc1 L_tag17
v_lshrrev_b32 v14,1,v1
v_lshlrev_b32 v14,8,v14
v_and_b32 v15,1,v1
v_lshl_add_u32 v14,v15,4,v14
v_add_u32 v14,101777408,v14
v_lshlrev_b32 v15,4,v1
v_add_u32 v15,101785600,v15
buffer_load_dwordx4 v[192:195],v14,s[40:43],0 offen offset:0 sc1
s_mov_b32 s97,0
buffer_load_dwordx4 v[196:199],v15,s[40:43],s97 offen offset:0 sc1
buffer_load_dwordx4 v[200:203],v15,s[40:43],s97 offen offset:1024 sc1
buffer_load_dwordx4 v[204:207],v15,s[40:43],s97 offen offset:2048 sc1
buffer_load_dwordx4 v[208:211],v15,s[40:43],s97 offen offset:3072 sc1
s_mov_b32 s97,4096
buffer_load_dwordx4 v[212:215],v15,s[40:43],s97 offen offset:0 sc1
buffer_load_dwordx4 v[216:219],v15,s[40:43],s97 offen offset:1024 sc1
buffer_load_dwordx4 v[220:223],v15,s[40:43],s97 offen offset:2048 sc1
buffer_load_dwordx4 v[224:227],v15,s[40:43],s97 offen offset:3072 sc1
s_mov_b32 s97,8192
buffer_load_dwordx4 v[228:231],v15,s[40:43],s97 offen offset:0 sc1
buffer_load_dwordx4 v[232:235],v15,s[40:43],s97 offen offset:1024 sc1
buffer_load_dwordx4 v[236:239],v15,s[40:43],s97 offen offset:2048 sc1
buffer_load_dwordx4 v[240:243],v15,s[40:43],s97 offen offset:3072 sc1
s_mov_b32 s97,12288
buffer_load_dwordx4 v[244:247],v15,s[40:43],s97 offen offset:0 sc1
buffer_load_dwordx4 v[248:251],v15,s[40:43],s97 offen offset:1024 sc1
buffer_load_dwordx4 v[252:255],v14,s[40:43],0 offen offset:128 sc1
L_tag17:
s_add_u32 s53,s68,1
s_and_b32 s53,s53,7
s_mul_i32 s73,s53,524288
s_add_u32 s73,s73,s56
s_lshl_b32 s53,s53,7
s_add_u32 s81,s55,s53
s_add_u32 m0,s60,81920
s_add_u32 s53,s72,256
buffer_load_dwordx4 v2,s[36:39],s53 offen lds
v_lshrrev_b32 v66,4,v1
v_bfe_u32 v65,v1,2,2
v_lshl_add_u32 v64,v66,3,v65
v_lshlrev_b32 v64,7,v64
v_xor_b32 v66,v65,v66
v_bfe_u32 v65,v1,3,1
v_lshl_add_u32 v64,v65,6,v64
v_bfe_u32 v65,v1,4,1
v_lshl_add_u32 v64,v65,4,v64
v_bfe_u32 v65,v1,1,1
v_lshl_add_u32 v64,v65,5,v64
v_and_b32 v65,1,v1
v_lshl_add_u32 v64,v65,3,v64
v_add_u32 v5,65536,v64
v_xor_b32 v6,16,v5
v_xor_b32 v7,64,v5
v_xor_b32 v8,64,v6
v_and_b32 v64,15,v1
v_lshlrev_b32 v66,4,v66
v_lshl_add_u32 v64,v64,6,v66
v_add_u32 v9,s58,v64
s_lshr_b32 s54,s55,16
s_lshl_b32 s54,s54,15
s_bfe_u32 s57,s55,0x1000f
s_lshl_b32 s57,s57,13
s_add_u32 s54,s54,s57
v_lshrrev_b32 v4,4,v1
v_and_b32 v64,15,v1
v_lshlrev_b32 v64,4,v64
v_lshl_add_u32 v4,v4,9,v64
v_and_b32 v64,8,v1
v_lshl_add_u32 v4,v64,4,v4
v_add_u32 v4,s54,v4
s_mov_b32 s61,0x3fb8aa3b
s_mov_b32 s71,0x3e0293ee
s_mov_b32 s62,0x358637bd
s_add_u32 m0,s60,90112
s_add_u32 s53,s72,384
buffer_load_dwordx4 v2,s[36:39],s53 offen lds
s_add_u32 m0,s58,4096
s_add_u32 s53,s81,0
buffer_load_dwordx4 v3,s[32:35],s53 offen lds
s_add_u32 m0,s58,5120
s_add_u32 s53,s81,8192
buffer_load_dwordx4 v3,s[32:35],s53 offen lds
s_add_u32 m0,s60,98304
s_add_u32 s53,s73,0
buffer_load_dwordx4 v2,s[36:39],s53 offen lds
s_add_u32 m0,s60,106496
s_add_u32 s53,s73,128
buffer_load_dwordx4 v2,s[36:39],s53 offen lds
s_add_u32 m0,s58,6144
s_add_u32 s53,s81,64
buffer_load_dwordx4 v3,s[32:35],s53 offen lds
s_add_u32 m0,s58,7168
s_add_u32 s53,s81,8256
buffer_load_dwordx4 v3,s[32:35],s53 offen lds
s_add_u32 m0,s60,114688
s_add_u32 s53,s73,256
buffer_load_dwordx4 v2,s[36:39],s53 offen lds
s_add_u32 m0,s60,122880
s_add_u32 s53,s73,384
buffer_load_dwordx4 v2,s[36:39],s53 offen lds
s_add_u32 s53,s68,2
s_and_b32 s53,s53,7
s_mul_i32 s74,s53,524288
s_add_u32 s74,s74,s56
s_lshl_b32 s53,s53,7
s_add_u32 s82,s55,s53
s_add_u32 s53,s68,3
s_and_b32 s53,s53,7
s_mul_i32 s75,s53,524288
s_add_u32 s75,s75,s56
s_lshl_b32 s53,s53,7
s_add_u32 s83,s55,s53
s_add_u32 s53,s68,4
s_and_b32 s53,s53,7
s_mul_i32 s76,s53,524288
s_add_u32 s76,s76,s56
s_lshl_b32 s53,s53,7
s_add_u32 s84,s55,s53
s_add_u32 s53,s68,5
s_and_b32 s53,s53,7
s_mul_i32 s77,s53,524288
s_add_u32 s77,s77,s56
s_lshl_b32 s53,s53,7
s_add_u32 s85,s55,s53
s_add_u32 s53,s68,6
s_and_b32 s53,s53,7
s_mul_i32 s78,s53,524288
s_add_u32 s78,s78,s56
s_lshl_b32 s53,s53,7
s_add_u32 s86,s55,s53
s_add_u32 s53,s68,7
s_and_b32 s53,s53,7
s_mul_i32 s79,s53,524288
s_add_u32 s79,s79,s56
s_lshl_b32 s53,s53,7
s_add_u32 s87,s55,s53
s_mov_b32 s16,s50
s_and_b32 s26,s98,7
s_lshr_b32 s27,s98,3
s_and_b32 s17,s27,3
s_lshl_b32 s26,s26,2
s_add_u32 s17,s17,s26
s_lshr_b32 s18,s27,2
s_lshl_b32 s26,s18,2
s_add_u32 s19,s26,s16
s_sub_u32 s27,67,s19
s_cmp_lt_u32 s16,4
s_cselect_b32 s19,s19,s27
s_cselect_b32 s28,1,0
s_waitcnt vmcnt(13)
ds_read_b128 v[80:83],v9 offset:0
ds_read_b128 v[84:87],v9 offset:1024
s_waitcnt vmcnt(11)
ds_read_b128 v[88:91],v9 offset:2048
ds_read_b128 v[92:95],v9 offset:3072
s_waitcnt vmcnt(9)
s_barrier
ds_read_b64_tr_b16 v[40:41],v5 offset:0
ds_read_b64_tr_b16 v[42:43],v5 offset:512
ds_read_b64_tr_b16 v[44:45],v6 offset:0
ds_read_b64_tr_b16 v[46:47],v6 offset:512
ds_read_b64_tr_b16 v[64:65],v7 offset:0
ds_read_b64_tr_b16 v[66:67],v7 offset:512
ds_read_b64_tr_b16 v[68:69],v8 offset:0
ds_read_b64_tr_b16 v[70:71],v8 offset:512
ds_read_b64_tr_b16 v[72:73],v5 offset:4096
ds_read_b64_tr_b16 v[74:75],v5 offset:4608
s_setprio 3
s_waitcnt lgkmcnt(8)
v_mfma_f32_16x16x32_bf16 v[24:27],v[80:83],v[40:43],0
s_add_u32 m0,s60,131072
s_add_u32 s53,s74,0
buffer_load_dwordx4 v2,s[36:39],s53 offen lds
ds_read_b64_tr_b16 v[76:77],v6 offset:4096
ds_read_b64_tr_b16 v[78:79],v6 offset:4608
v_mfma_f32_16x16x32_bf16 v[28:31],v[84:87],v[40:43],0
s_add_u32 m0,s58,0
s_add_u32 s53,s82,0
buffer_load_dwordx4 v3,s[32:35],s53 offen lds
s_waitcnt lgkmcnt(8)
v_mfma_f32_16x16x32_bf16 v[36:39],v[84:87],v[44:47],0
s_add_u32 m0,s60,139264
s_add_u32 s53,s74,128
buffer_load_dwordx4 v2,s[36:39],s53 offen lds
v_mfma_f32_16x16x32_bf16 v[32:35],v[80:83],v[44:47],0
s_add_u32 m0,s58,1024
s_add_u32 s53,s82,8192
buffer_load_dwordx4 v3,s[32:35],s53 offen lds
ds_read_b64_tr_b16 v[40:41],v7 offset:4096
ds_read_b64_tr_b16 v[42:43],v7 offset:4608
s_waitcnt lgkmcnt(8)
v_mfma_f32_16x16x32_bf16 v[48:51],v[80:83],v[64:67],0
ds_read_b64_tr_b16 v[44:45],v8 offset:4096
ds_read_b64_tr_b16 v[46:47],v8 offset:4608
v_mfma_f32_16x16x32_bf16 v[52:55],v[84:87],v[64:67],0
s_add_u32 m0,s58,2048
s_add_u32 s53,s82,64
buffer_load_dwordx4 v3,s[32:35],s53 offen lds
s_waitcnt lgkmcnt(8)
v_mfma_f32_16x16x32_bf16 v[60:63],v[84:87],v[68:71],0
s_add_u32 m0,s60,147456
s_add_u32 s53,s74,256
buffer_load_dwordx4 v2,s[36:39],s53 offen lds
v_mfma_f32_16x16x32_bf16 v[56:59],v[80:83],v[68:71],0
s_add_u32 m0,s58,3072
s_add_u32 s53,s82,8256
buffer_load_dwordx4 v3,s[32:35],s53 offen lds
ds_read_b64_tr_b16 v[64:65],v5 offset:8192
ds_read_b64_tr_b16 v[66:67],v5 offset:8704
s_setprio 2
s_waitcnt lgkmcnt(8)
v_mfma_f32_16x16x32_bf16 v[24:27],v[88:91],v[72:75],v[24:27]
ds_read_b64_tr_b16 v[68:69],v6 offset:8192
ds_read_b64_tr_b16 v[70:71],v6 offset:8704
v_mfma_f32_16x16x32_bf16 v[28:31],v[92:95],v[72:75],v[28:31]
s_add_u32 m0,s60,155648
s_add_u32 s53,s74,384
buffer_load_dwordx4 v2,s[36:39],s53 offen lds
s_waitcnt lgkmcnt(8)
v_mfma_f32_16x16x32_bf16 v[36:39],v[92:95],v[76:79],v[36:39]
v_mfma_f32_16x16x32_bf16 v[32:35],v[88:91],v[76:79],v[32:35]
ds_read_b64_tr_b16 v[72:73],v7 offset:8192
ds_read_b64_tr_b16 v[74:75],v7 offset:8704
s_waitcnt lgkmcnt(8)
v_mfma_f32_16x16x32_bf16 v[48:51],v[88:91],v[40:43],v[48:51]
ds_read_b64_tr_b16 v[76:77],v8 offset:8192
ds_read_b64_tr_b16 v[78:79],v8 offset:8704
v_mfma_f32_16x16x32_bf16 v[52:55],v[92:95],v[40:43],v[52:55]
s_waitcnt lgkmcnt(8)
v_mfma_f32_16x16x32_bf16 v[60:63],v[92:95],v[44:47],v[60:63]
v_mfma_f32_16x16x32_bf16 v[56:59],v[88:91],v[44:47],v[56:59]
ds_read_b64_tr_b16 v[40:41],v5 offset:12288
ds_read_b64_tr_b16 v[42:43],v5 offset:12800
s_setprio 1
s_waitcnt lgkmcnt(8)
v_mfma_f32_16x16x32_bf16 v[128:131],v[80:83],v[64:67],0
ds_read_b64_tr_b16 v[44:45],v6 offset:12288
ds_read_b64_tr_b16 v[46:47],v6 offset:12800
v_mfma_f32_16x16x32_bf16 v[132:135],v[84:87],v[64:67],0
s_waitcnt lgkmcnt(8)
v_mfma_f32_16x16x32_bf16 v[140:143],v[84:87],v[68:71],0
v_mfma_f32_16x16x32_bf16 v[136:139],v[80:83],v[68:71],0
ds_read_b64_tr_b16 v[64:65],v7 offset:12288
ds_read_b64_tr_b16 v[66:67],v7 offset:12800
s_waitcnt lgkmcnt(8)
v_mfma_f32_16x16x32_bf16 v[144:147],v[80:83],v[72:75],0
ds_read_b64_tr_b16 v[68:69],v8 offset:12288
ds_read_b64_tr_b16 v[70:71],v8 offset:12800
v_mfma_f32_16x16x32_bf16 v[148:151],v[84:87],v[72:75],0
s_waitcnt lgkmcnt(8)
v_mfma_f32_16x16x32_bf16 v[156:159],v[84:87],v[76:79],0
v_mfma_f32_16x16x32_bf16 v[152:155],v[80:83],v[76:79],0
ds_read_b64_tr_b16 v[72:73],v5 offset:16384
ds_read_b64_tr_b16 v[74:75],v5 offset:16896
s_setprio 0
s_waitcnt lgkmcnt(8)
v_mfma_f32_16x16x32_bf16 v[128:131],v[88:91],v[40:43],v[128:131]
ds_read_b64_tr_b16 v[76:77],v6 offset:16384
ds_read_b64_tr_b16 v[78:79],v6 offset:16896
v_mfma_f32_16x16x32_bf16 v[132:135],v[92:95],v[40:43],v[132:135]
s_waitcnt lgkmcnt(8)
v_mfma_f32_16x16x32_bf16 v[140:143],v[92:95],v[44:47],v[140:143]
v_mfma_f32_16x16x32_bf16 v[136:139],v[88:91],v[44:47],v[136:139]
ds_read_b64_tr_b16 v[40:41],v7 offset:16384
ds_read_b64_tr_b16 v[42:43],v7 offset:16896
s_waitcnt lgkmcnt(8)
v_mfma_f32_16x16x32_bf16 v[144:147],v[88:91],v[64:67],v[144:147]
ds_read_b64_tr_b16 v[44:45],v8 offset:16384
ds_read_b64_tr_b16 v[46:47],v8 offset:16896
v_mfma_f32_16x16x32_bf16 v[148:151],v[92:95],v[64:67],v[148:151]
s_cmp_lg_u32 s50,0
s_cbranch_scc1 L_tag18
s_cmp_lg_u32 s101,0
s_cbranch_scc1 L_tag18
s_cmp_lg_u32 s52,4
s_cbranch_scc1 L_tag18
s_waitcnt vmcnt(18)
L_tagn18:
s_add_u32 s96,s96,1
v_cmp_eq_u32 vcc,s96,v192
s_cbranch_vccnz L_tagn18
v_cmp_eq_u32 vcc,s96,v193
s_cbranch_vccnz L_tagn18
v_cmp_eq_u32 vcc,s96,v194
s_cbranch_vccnz L_tagn18
v_cmp_eq_u32 vcc,s96,v195
s_cbranch_vccnz L_tagn18
v_cmp_eq_u32 vcc,s96,v196
s_cbranch_vccnz L_tagn18
v_cmp_eq_u32 vcc,s96,v197
s_cbranch_vccnz L_tagn18
v_cmp_eq_u32 vcc,s96,v198
s_cbranch_vccnz L_tagn18
v_cmp_eq_u32 vcc,s96,v199
s_cbranch_vccnz L_tagn18
v_cmp_eq_u32 vcc,s96,v200
s_cbranch_vccnz L_tagn18
v_cmp_eq_u32 vcc,s96,v201
s_cbranch_vccnz L_tagn18
v_cmp_eq_u32 vcc,s96,v202
s_cbranch_vccnz L_tagn18
v_cmp_eq_u32 vcc,s96,v203
s_cbranch_vccnz L_tagn18
v_cmp_eq_u32 vcc,s96,v204
s_cbranch_vccnz L_tagn18
v_cmp_eq_u32 vcc,s96,v205
s_cbranch_vccnz L_tagn18
v_cmp_eq_u32 vcc,s96,v206
s_cbranch_vccnz L_tagn18
v_cmp_eq_u32 vcc,s96,v207
s_cbranch_vccnz L_tagn18
v_cmp_eq_u32 vcc,s96,v208
s_cbranch_vccnz L_tagn18
v_cmp_eq_u32 vcc,s96,v209
s_cbranch_vccnz L_tagn18
v_cmp_eq_u32 vcc,s96,v210
s_cbranch_vccnz L_tagn18
v_cmp_eq_u32 vcc,s96,v211
s_cbranch_vccnz L_tagn18
v_cmp_eq_u32 vcc,s96,v212
s_cbranch_vccnz L_tagn18
v_cmp_eq_u32 vcc,s96,v213
s_cbranch_vccnz L_tagn18
v_cmp_eq_u32 vcc,s96,v214
s_cbranch_vccnz L_tagn18
v_cmp_eq_u32 vcc,s96,v215
s_cbranch_vccnz L_tagn18
v_cmp_eq_u32 vcc,s96,v216
s_cbranch_vccnz L_tagn18
v_cmp_eq_u32 vcc,s96,v217
s_cbranch_vccnz L_tagn18
v_cmp_eq_u32 vcc,s96,v218
s_cbranch_vccnz L_tagn18
v_cmp_eq_u32 vcc,s96,v219
s_cbranch_vccnz L_tagn18
v_cmp_eq_u32 vcc,s96,v220
s_cbranch_vccnz L_tagn18
v_cmp_eq_u32 vcc,s96,v221
s_cbranch_vccnz L_tagn18
v_cmp_eq_u32 vcc,s96,v222
s_cbranch_vccnz L_tagn18
v_cmp_eq_u32 vcc,s96,v223
s_cbranch_vccnz L_tagn18
v_cmp_eq_u32 vcc,s96,v224
s_cbranch_vccnz L_tagn18
v_cmp_eq_u32 vcc,s96,v225
s_cbranch_vccnz L_tagn18
v_cmp_eq_u32 vcc,s96,v226
s_cbranch_vccnz L_tagn18
v_cmp_eq_u32 vcc,s96,v227
s_cbranch_vccnz L_tagn18
v_cmp_eq_u32 vcc,s96,v228
s_cbranch_vccnz L_tagn18
v_cmp_eq_u32 vcc,s96,v229
s_cbranch_vccnz L_tagn18
v_cmp_eq_u32 vcc,s96,v230
s_cbranch_vccnz L_tagn18
v_cmp_eq_u32 vcc,s96,v231
s_cbranch_vccnz L_tagn18
v_cmp_eq_u32 vcc,s96,v232
s_cbranch_vccnz L_tagn18
v_cmp_eq_u32 vcc,s96,v233
s_cbranch_vccnz L_tagn18
v_cmp_eq_u32 vcc,s96,v234
s_cbranch_vccnz L_tagn18
v_cmp_eq_u32 vcc,s96,v235
s_cbranch_vccnz L_tagn18
v_cmp_eq_u32 vcc,s96,v236
s_cbranch_vccnz L_tagn18
v_cmp_eq_u32 vcc,s96,v237
s_cbranch_vccnz L_tagn18
v_cmp_eq_u32 vcc,s96,v238
s_cbranch_vccnz L_tagn18
v_cmp_eq_u32 vcc,s96,v239
s_cbranch_vccnz L_tagn18
v_cmp_eq_u32 vcc,s96,v240
s_cbranch_vccnz L_tagn18
v_cmp_eq_u32 vcc,s96,v241
s_cbranch_vccnz L_tagn18
v_cmp_eq_u32 vcc,s96,v242
s_cbranch_vccnz L_tagn18
v_cmp_eq_u32 vcc,s96,v243
s_cbranch_vccnz L_tagn18
v_cmp_eq_u32 vcc,s96,v244
s_cbranch_vccnz L_tagn18
v_cmp_eq_u32 vcc,s96,v245
s_cbranch_vccnz L_tagn18
v_cmp_eq_u32 vcc,s96,v246
s_cbranch_vccnz L_tagn18
v_cmp_eq_u32 vcc,s96,v247
s_cbranch_vccnz L_tagn18
v_cmp_eq_u32 vcc,s96,v248
s_cbranch_vccnz L_tagn18
v_cmp_eq_u32 vcc,s96,v249
s_cbranch_vccnz L_tagn18
v_cmp_eq_u32 vcc,s96,v250
s_cbranch_vccnz L_tagn18
v_cmp_eq_u32 vcc,s96,v251
s_cbranch_vccnz L_tagn18
v_cmp_eq_u32 vcc,s96,v252
s_cbranch_vccnz L_tagn18
v_cmp_eq_u32 vcc,s96,v253
s_cbranch_vccnz L_tagn18
v_cmp_eq_u32 vcc,s96,v254
s_cbranch_vccnz L_tagn18
v_cmp_eq_u32 vcc,s96,v255
s_cbranch_vccnz L_tagn18
v_mov_b32 v14,s96
v_mov_b32 v15,0
s_mov_b64 exec,1
buffer_atomic_cmpswap v[14:15],off,s[92:95],0 sc0 sc1
s_mov_b64 exec,-1
L_tag18:
s_waitcnt lgkmcnt(8)
v_mfma_f32_16x16x32_bf16 v[156:159],v[92:95],v[68:71],v[156:159]
v_mfma_f32_16x16x32_bf16 v[152:155],v[88:91],v[68:71],v[152:155]
s_waitcnt vmcnt(13)
s_barrier
ds_read_b64_tr_b16 v[64:65],v5 offset:20480
ds_read_b64_tr_b16 v[66:67],v5 offset:20992
s_setprio 3
s_waitcnt lgkmcnt(8)
v_mfma_f32_16x16x32_bf16 v[160:163],v[80:83],v[72:75],0
ds_read_b64_tr_b16 v[68:69],v6 offset:20480
ds_read_b64_tr_b16 v[70:71],v6 offset:20992
v_mfma_f32_16x16x32_bf16 v[164:167],v[84:87],v[72:75],0
s_add_u32 m0,s60,65536
s_add_u32 s53,s75,0
buffer_load_dwordx4 v2,s[36:39],s53 offen lds
s_waitcnt lgkmcnt(8)
v_mfma_f32_16x16x32_bf16 v[172:175],v[84:87],v[76:79],0
v_mfma_f32_16x16x32_bf16 v[168:171],v[80:83],v[76:79],0
ds_read_b64_tr_b16 v[72:73],v7 offset:20480
ds_read_b64_tr_b16 v[74:75],v7 offset:20992
s_waitcnt lgkmcnt(8)
v_mfma_f32_16x16x32_bf16 v[176:179],v[80:83],v[40:43],0
ds_read_b64_tr_b16 v[76:77],v8 offset:20480
ds_read_b64_tr_b16 v[78:79],v8 offset:20992
v_mfma_f32_16x16x32_bf16 v[180:183],v[84:87],v[40:43],0
ds_read_b128 v[96:99],v9 offset:4096
ds_read_b128 v[100:103],v9 offset:5120
s_waitcnt lgkmcnt(10)
v_mfma_f32_16x16x32_bf16 v[188:191],v[84:87],v[44:47],0
v_mfma_f32_16x16x32_bf16 v[184:187],v[80:83],v[44:47],0
s_add_u32 m0,s60,73728
s_add_u32 s53,s75,128
buffer_load_dwordx4 v2,s[36:39],s53 offen lds
ds_read_b64_tr_b16 v[40:41],v5 offset:24576
ds_read_b64_tr_b16 v[42:43],v5 offset:25088
s_setprio 2
s_waitcnt lgkmcnt(10)
v_mfma_f32_16x16x32_bf16 v[160:163],v[88:91],v[64:67],v[160:163]
ds_read_b64_tr_b16 v[44:45],v6 offset:24576
ds_read_b64_tr_b16 v[46:47],v6 offset:25088
v_mfma_f32_16x16x32_bf16 v[164:167],v[92:95],v[64:67],v[164:167]
s_waitcnt lgkmcnt(10)
v_mfma_f32_16x16x32_bf16 v[172:175],v[92:95],v[68:71],v[172:175]
v_mfma_f32_16x16x32_bf16 v[168:171],v[88:91],v[68:71],v[168:171]
ds_read_b64_tr_b16 v[64:65],v7 offset:24576
ds_read_b64_tr_b16 v[66:67],v7 offset:25088
s_waitcnt lgkmcnt(10)
v_mfma_f32_16x16x32_bf16 v[176:179],v[88:91],v[72:75],v[176:179]
ds_read_b64_tr_b16 v[68:69],v8 offset:24576
ds_read_b64_tr_b16 v[70:71],v8 offset:25088
v_mfma_f32_16x16x32_bf16 v[180:183],v[92:95],v[72:75],v[180:183]
s_waitcnt lgkmcnt(10)
v_mfma_f32_16x16x32_bf16 v[188:191],v[92:95],v[76:79],v[188:191]
v_mfma_f32_16x16x32_bf16 v[184:187],v[88:91],v[76:79],v[184:187]
ds_read_b64_tr_b16 v[72:73],v5 offset:28672
ds_read_b64_tr_b16 v[74:75],v5 offset:29184
s_setprio 1
s_waitcnt lgkmcnt(8)
v_mfma_f32_16x16x32_bf16 v[192:195],v[80:83],v[40:43],0
ds_read_b64_tr_b16 v[76:77],v6 offset:28672
ds_read_b64_tr_b16 v[78:79],v6 offset:29184
v_mfma_f32_16x16x32_bf16 v[196:199],v[84:87],v[40:43],0
s_add_u32 m0,s58,4096
s_add_u32 s53,s83,0
buffer_load_dwordx4 v3,s[32:35],s53 offen lds
s_waitcnt lgkmcnt(8)
v_mfma_f32_16x16x32_bf16 v[204:207],v[84:87],v[44:47],0
v_mfma_f32_16x16x32_bf16 v[200:203],v[80:83],v[44:47],0
s_add_u32 m0,s58,5120
s_add_u32 s53,s83,8192
buffer_load_dwordx4 v3,s[32:35],s53 offen lds
ds_read_b64_tr_b16 v[40:41],v7 offset:28672
ds_read_b64_tr_b16 v[42:43],v7 offset:29184
s_waitcnt lgkmcnt(8)
v_mfma_f32_16x16x32_bf16 v[208:211],v[80:83],v[64:67],0
ds_read_b64_tr_b16 v[44:45],v8 offset:28672
ds_read_b64_tr_b16 v[46:47],v8 offset:29184
v_mfma_f32_16x16x32_bf16 v[212:215],v[84:87],v[64:67],0
s_waitcnt lgkmcnt(8)
v_mfma_f32_16x16x32_bf16 v[220:223],v[84:87],v[68:71],0
v_mfma_f32_16x16x32_bf16 v[216:219],v[80:83],v[68:71],0
ds_read_b64_tr_b16 v[64:65],v5 offset:32768
ds_read_b64_tr_b16 v[66:67],v5 offset:33280
s_setprio 0
s_waitcnt lgkmcnt(8)
v_mfma_f32_16x16x32_bf16 v[192:195],v[88:91],v[72:75],v[192:195]
ds_read_b64_tr_b16 v[68:69],v6 offset:32768
ds_read_b64_tr_b16 v[70:71],v6 offset:33280
v_mfma_f32_16x16x32_bf16 v[196:199],v[92:95],v[72:75],v[196:199]
s_waitcnt vmcnt(14)
ds_read_b128 v[104:107],v9 offset:6144
ds_read_b128 v[108:111],v9 offset:7168
s_waitcnt lgkmcnt(10)
v_mfma_f32_16x16x32_bf16 v[204:207],v[92:95],v[76:79],v[204:207]
v_mfma_f32_16x16x32_bf16 v[200:203],v[88:91],v[76:79],v[200:203]
ds_read_b64_tr_b16 v[72:73],v7 offset:32768
ds_read_b64_tr_b16 v[74:75],v7 offset:33280
s_waitcnt lgkmcnt(10)
v_mfma_f32_16x16x32_bf16 v[208:211],v[88:91],v[40:43],v[208:211]
ds_read_b64_tr_b16 v[76:77],v8 offset:32768
ds_read_b64_tr_b16 v[78:79],v8 offset:33280
v_mfma_f32_16x16x32_bf16 v[212:215],v[92:95],v[40:43],v[212:215]
s_waitcnt lgkmcnt(10)
v_mfma_f32_16x16x32_bf16 v[220:223],v[92:95],v[44:47],v[220:223]
v_mfma_f32_16x16x32_bf16 v[216:219],v[88:91],v[44:47],v[216:219]
s_waitcnt vmcnt(11)
s_barrier
ds_read_b64_tr_b16 v[40:41],v5 offset:36864
ds_read_b64_tr_b16 v[42:43],v5 offset:37376
s_setprio 3
s_waitcnt lgkmcnt(10)
v_mfma_f32_16x16x32_bf16 v[24:27],v[96:99],v[64:67],v[24:27]
ds_read_b64_tr_b16 v[44:45],v6 offset:36864
ds_read_b64_tr_b16 v[46:47],v6 offset:37376
v_mfma_f32_16x16x32_bf16 v[28:31],v[100:103],v[64:67],v[28:31]
s_add_u32 m0,s60,81920
s_add_u32 s53,s75,256
buffer_load_dwordx4 v2,s[36:39],s53 offen lds
s_waitcnt lgkmcnt(10)
v_mfma_f32_16x16x32_bf16 v[36:39],v[100:103],v[68:71],v[36:39]
v_mfma_f32_16x16x32_bf16 v[32:35],v[96:99],v[68:71],v[32:35]
ds_read_b64_tr_b16 v[64:65],v7 offset:36864
ds_read_b64_tr_b16 v[66:67],v7 offset:37376
s_waitcnt lgkmcnt(8)
v_mfma_f32_16x16x32_bf16 v[48:51],v[96:99],v[72:75],v[48:51]
ds_read_b64_tr_b16 v[68:69],v8 offset:36864
ds_read_b64_tr_b16 v[70:71],v8 offset:37376
v_mfma_f32_16x16x32_bf16 v[52:55],v[100:103],v[72:75],v[52:55]
s_add_u32 m0,s58,6144
s_add_u32 s53,s83,64
buffer_load_dwordx4 v3,s[32:35],s53 offen lds
s_waitcnt lgkmcnt(8)
v_mfma_f32_16x16x32_bf16 v[60:63],v[100:103],v[76:79],v[60:63]
v_mfma_f32_16x16x32_bf16 v[56:59],v[96:99],v[76:79],v[56:59]
s_add_u32 m0,s58,7168
s_add_u32 s53,s83,8256
buffer_load_dwordx4 v3,s[32:35],s53 offen lds
ds_read_b64_tr_b16 v[72:73],v5 offset:40960
ds_read_b64_tr_b16 v[74:75],v5 offset:41472
s_waitcnt lgkmcnt(8)
v_mfma_f32_16x16x32_bf16 v[24:27],v[104:107],v[40:43],v[24:27]
ds_read_b64_tr_b16 v[76:77],v6 offset:40960
ds_read_b64_tr_b16 v[78:79],v6 offset:41472
v_mfma_f32_16x16x32_bf16 v[28:31],v[108:111],v[40:43],v[28:31]
s_waitcnt lgkmcnt(8)
v_mfma_f32_16x16x32_bf16 v[36:39],v[108:111],v[44:47],v[36:39]
v_mfma_f32_16x16x32_bf16 v[32:35],v[104:107],v[44:47],v[32:35]
ds_read_b64_tr_b16 v[40:41],v7 offset:40960
ds_read_b64_tr_b16 v[42:43],v7 offset:41472
s_waitcnt lgkmcnt(8)
v_mfma_f32_16x16x32_bf16 v[48:51],v[104:107],v[64:67],v[48:51]
s_add_u32 m0,s60,90112
s_add_u32 s53,s75,384
buffer_load_dwordx4 v2,s[36:39],s53 offen lds
ds_read_b64_tr_b16 v[44:45],v8 offset:40960
ds_read_b64_tr_b16 v[46:47],v8 offset:41472
v_mfma_f32_16x16x32_bf16 v[52:55],v[108:111],v[64:67],v[52:55]
s_waitcnt vmcnt(12)
ds_read_b128 v[112:115],v9 offset:0
ds_read_b128 v[116:119],v9 offset:1024
s_waitcnt lgkmcnt(10)
v_mfma_f32_16x16x32_bf16 v[60:63],v[108:111],v[68:71],v[60:63]
v_mfma_f32_16x16x32_bf16 v[56:59],v[104:107],v[68:71],v[56:59]
ds_read_b64_tr_b16 v[64:65],v5 offset:45056
ds_read_b64_tr_b16 v[66:67],v5 offset:45568
s_setprio 2
s_waitcnt lgkmcnt(10)
v_mfma_f32_16x16x32_bf16 v[128:131],v[96:99],v[72:75],v[128:131]
ds_read_b64_tr_b16 v[68:69],v6 offset:45056
ds_read_b64_tr_b16 v[70:71],v6 offset:45568
v_mfma_f32_16x16x32_bf16 v[132:135],v[100:103],v[72:75],v[132:135]
s_waitcnt lgkmcnt(10)
v_mfma_f32_16x16x32_bf16 v[140:143],v[100:103],v[76:79],v[140:143]
v_mfma_f32_16x16x32_bf16 v[136:139],v[96:99],v[76:79],v[136:139]
ds_read_b64_tr_b16 v[72:73],v7 offset:45056
ds_read_b64_tr_b16 v[74:75],v7 offset:45568
s_waitcnt lgkmcnt(10)
v_mfma_f32_16x16x32_bf16 v[144:147],v[96:99],v[40:43],v[144:147]
ds_read_b64_tr_b16 v[76:77],v8 offset:45056
ds_read_b64_tr_b16 v[78:79],v8 offset:45568
v_mfma_f32_16x16x32_bf16 v[148:151],v[100:103],v[40:43],v[148:151]
s_waitcnt lgkmcnt(10)
v_mfma_f32_16x16x32_bf16 v[156:159],v[100:103],v[44:47],v[156:159]
v_mfma_f32_16x16x32_bf16 v[152:155],v[96:99],v[44:47],v[152:155]
ds_read_b64_tr_b16 v[40:41],v5 offset:49152
ds_read_b64_tr_b16 v[42:43],v5 offset:49664
s_waitcnt lgkmcnt(8)
v_mfma_f32_16x16x32_bf16 v[128:131],v[104:107],v[64:67],v[128:131]
ds_read_b64_tr_b16 v[44:45],v6 offset:49152
ds_read_b64_tr_b16 v[46:47],v6 offset:49664
v_mfma_f32_16x16x32_bf16 v[132:135],v[108:111],v[64:67],v[132:135]
s_add_u32 m0,s58,0
s_add_u32 s53,s84,0
buffer_load_dwordx4 v3,s[32:35],s53 offen lds
s_waitcnt lgkmcnt(8)
v_mfma_f32_16x16x32_bf16 v[140:143],v[108:111],v[68:71],v[140:143]
v_mfma_f32_16x16x32_bf16 v[136:139],v[104:107],v[68:71],v[136:139]
s_add_u32 m0,s58,1024
s_add_u32 s53,s84,8192
buffer_load_dwordx4 v3,s[32:35],s53 offen lds
ds_read_b64_tr_b16 v[64:65],v7 offset:49152
ds_read_b64_tr_b16 v[66:67],v7 offset:49664
s_waitcnt lgkmcnt(8)
v_mfma_f32_16x16x32_bf16 v[144:147],v[104:107],v[72:75],v[144:147]
ds_read_b64_tr_b16 v[68:69],v8 offset:49152
ds_read_b64_tr_b16 v[70:71],v8 offset:49664
v_mfma_f32_16x16x32_bf16 v[148:151],v[108:111],v[72:75],v[148:151]
s_waitcnt lgkmcnt(8)
v_mfma_f32_16x16x32_bf16 v[156:159],v[108:111],v[76:79],v[156:159]
v_mfma_f32_16x16x32_bf16 v[152:155],v[104:107],v[76:79],v[152:155]
ds_read_b64_tr_b16 v[72:73],v5 offset:53248
ds_read_b64_tr_b16 v[74:75],v5 offset:53760
s_setprio 1
s_waitcnt lgkmcnt(8)
v_mfma_f32_16x16x32_bf16 v[160:163],v[96:99],v[40:43],v[160:163]
ds_read_b64_tr_b16 v[76:77],v6 offset:53248
ds_read_b64_tr_b16 v[78:79],v6 offset:53760
v_mfma_f32_16x16x32_bf16 v[164:167],v[100:103],v[40:43],v[164:167]
s_waitcnt lgkmcnt(8)
v_mfma_f32_16x16x32_bf16 v[172:175],v[100:103],v[44:47],v[172:175]
v_mfma_f32_16x16x32_bf16 v[168:171],v[96:99],v[44:47],v[168:171]
s_waitcnt vmcnt(11)
ds_read_b128 v[120:123],v9 offset:2048
ds_read_b128 v[124:127],v9 offset:3072
ds_read_b64_tr_b16 v[40:41],v7 offset:53248
ds_read_b64_tr_b16 v[42:43],v7 offset:53760
s_waitcnt lgkmcnt(10)
v_mfma_f32_16x16x32_bf16 v[176:179],v[96:99],v[64:67],v[176:179]
ds_read_b64_tr_b16 v[44:45],v8 offset:53248
ds_read_b64_tr_b16 v[46:47],v8 offset:53760
v_mfma_f32_16x16x32_bf16 v[180:183],v[100:103],v[64:67],v[180:183]
s_waitcnt lgkmcnt(10)
v_mfma_f32_16x16x32_bf16 v[188:191],v[100:103],v[68:71],v[188:191]
v_mfma_f32_16x16x32_bf16 v[184:187],v[96:99],v[68:71],v[184:187]
ds_read_b64_tr_b16 v[64:65],v5 offset:57344
ds_read_b64_tr_b16 v[66:67],v5 offset:57856
s_waitcnt lgkmcnt(10)
v_mfma_f32_16x16x32_bf16 v[160:163],v[104:107],v[72:75],v[160:163]
ds_read_b64_tr_b16 v[68:69],v6 offset:57344
ds_read_b64_tr_b16 v[70:71],v6 offset:57856
v_mfma_f32_16x16x32_bf16 v[164:167],v[108:111],v[72:75],v[164:167]
s_waitcnt lgkmcnt(10)
v_mfma_f32_16x16x32_bf16 v[172:175],v[108:111],v[76:79],v[172:175]
v_mfma_f32_16x16x32_bf16 v[168:171],v[104:107],v[76:79],v[168:171]
ds_read_b64_tr_b16 v[72:73],v7 offset:57344
ds_read_b64_tr_b16 v[74:75],v7 offset:57856
s_waitcnt lgkmcnt(8)
v_mfma_f32_16x16x32_bf16 v[176:179],v[104:107],v[40:43],v[176:179]
ds_read_b64_tr_b16 v[76:77],v8 offset:57344
ds_read_b64_tr_b16 v[78:79],v8 offset:57856
v_mfma_f32_16x16x32_bf16 v[180:183],v[108:111],v[40:43],v[180:183]
s_waitcnt lgkmcnt(8)
v_mfma_f32_16x16x32_bf16 v[188:191],v[108:111],v[44:47],v[188:191]
v_mfma_f32_16x16x32_bf16 v[184:187],v[104:107],v[44:47],v[184:187]
s_add_u32 m0,s58,2048
s_add_u32 s53,s84,64
buffer_load_dwordx4 v3,s[32:35],s53 offen lds
ds_read_b64_tr_b16 v[40:41],v5 offset:61440
ds_read_b64_tr_b16 v[42:43],v5 offset:61952
s_setprio 0
s_waitcnt lgkmcnt(8)
v_mfma_f32_16x16x32_bf16 v[192:195],v[96:99],v[64:67],v[192:195]
ds_read_b64_tr_b16 v[44:45],v6 offset:61440
ds_read_b64_tr_b16 v[46:47],v6 offset:61952
v_mfma_f32_16x16x32_bf16 v[196:199],v[100:103],v[64:67],v[196:199]
s_add_u32 m0,s58,3072
s_add_u32 s53,s84,8256
buffer_load_dwordx4 v3,s[32:35],s53 offen lds
s_waitcnt lgkmcnt(8)
v_mfma_f32_16x16x32_bf16 v[204:207],v[100:103],v[68:71],v[204:207]
v_mfma_f32_16x16x32_bf16 v[200:203],v[96:99],v[68:71],v[200:203]
ds_read_b64_tr_b16 v[64:65],v7 offset:61440
ds_read_b64_tr_b16 v[66:67],v7 offset:61952
s_waitcnt lgkmcnt(8)
v_mfma_f32_16x16x32_bf16 v[208:211],v[96:99],v[72:75],v[208:211]
ds_read_b64_tr_b16 v[68:69],v8 offset:61440
ds_read_b64_tr_b16 v[70:71],v8 offset:61952
v_mfma_f32_16x16x32_bf16 v[212:215],v[100:103],v[72:75],v[212:215]
s_waitcnt lgkmcnt(8)
v_mfma_f32_16x16x32_bf16 v[220:223],v[100:103],v[76:79],v[220:223]
v_mfma_f32_16x16x32_bf16 v[216:219],v[96:99],v[76:79],v[216:219]
s_waitcnt vmcnt(8)
ds_read_b128 v[240:243],v9 offset:4096
ds_read_b128 v[244:247],v9 offset:5120
v_add_u32 v5,0x10000,v5
ds_read_b64_tr_b16 v[72:73],v5 offset:0
ds_read_b64_tr_b16 v[74:75],v5 offset:512
s_waitcnt lgkmcnt(10)
v_mfma_f32_16x16x32_bf16 v[192:195],v[104:107],v[40:43],v[192:195]
v_add_u32 v6,0x10000,v6
ds_read_b64_tr_b16 v[76:77],v6 offset:0
ds_read_b64_tr_b16 v[78:79],v6 offset:512
v_mfma_f32_16x16x32_bf16 v[196:199],v[108:111],v[40:43],v[196:199]
s_waitcnt lgkmcnt(10)
v_mfma_f32_16x16x32_bf16 v[204:207],v[108:111],v[44:47],v[204:207]
v_mfma_f32_16x16x32_bf16 v[200:203],v[104:107],v[44:47],v[200:203]
v_add_u32 v7,0x10000,v7
ds_read_b64_tr_b16 v[40:41],v7 offset:0
ds_read_b64_tr_b16 v[42:43],v7 offset:512
s_waitcnt lgkmcnt(10)
v_mfma_f32_16x16x32_bf16 v[208:211],v[104:107],v[64:67],v[208:211]
v_add_u32 v8,0x10000,v8
ds_read_b64_tr_b16 v[44:45],v8 offset:0
ds_read_b64_tr_b16 v[46:47],v8 offset:512
v_mfma_f32_16x16x32_bf16 v[212:215],v[108:111],v[64:67],v[212:215]
s_waitcnt lgkmcnt(10)
v_mfma_f32_16x16x32_bf16 v[220:223],v[108:111],v[68:71],v[220:223]
v_mfma_f32_16x16x32_bf16 v[216:219],v[104:107],v[68:71],v[216:219]
s_barrier
ds_read_b64_tr_b16 v[64:65],v5 offset:4096
ds_read_b64_tr_b16 v[66:67],v5 offset:4608
s_setprio 3
s_waitcnt lgkmcnt(8)
v_mfma_f32_16x16x32_bf16 v[24:27],v[112:115],v[72:75],v[24:27]
ds_read_b64_tr_b16 v[68:69],v6 offset:4096
ds_read_b64_tr_b16 v[70:71],v6 offset:4608
v_mfma_f32_16x16x32_bf16 v[28:31],v[116:119],v[72:75],v[28:31]
s_add_u32 m0,s60,98304
s_add_u32 s53,s76,0
buffer_load_dwordx4 v2,s[36:39],s53 offen lds
s_waitcnt lgkmcnt(8)
v_mfma_f32_16x16x32_bf16 v[36:39],v[116:119],v[76:79],v[36:39]
v_mfma_f32_16x16x32_bf16 v[32:35],v[112:115],v[76:79],v[32:35]
s_add_u32 m0,s58,4096
s_add_u32 s53,s85,0
buffer_load_dwordx4 v3,s[32:35],s53 offen lds
ds_read_b64_tr_b16 v[72:73],v7 offset:4096
ds_read_b64_tr_b16 v[74:75],v7 offset:4608
s_waitcnt lgkmcnt(8)
v_mfma_f32_16x16x32_bf16 v[48:51],v[112:115],v[40:43],v[48:51]
ds_read_b64_tr_b16 v[76:77],v8 offset:4096
ds_read_b64_tr_b16 v[78:79],v8 offset:4608
v_mfma_f32_16x16x32_bf16 v[52:55],v[116:119],v[40:43],v[52:55]
s_add_u32 m0,s58,5120
s_add_u32 s53,s85,8192
buffer_load_dwordx4 v3,s[32:35],s53 offen lds
s_waitcnt lgkmcnt(8)
v_mfma_f32_16x16x32_bf16 v[60:63],v[116:119],v[44:47],v[60:63]
v_mfma_f32_16x16x32_bf16 v[56:59],v[112:115],v[44:47],v[56:59]
s_add_u32 m0,s60,106496
s_add_u32 s53,s77,0
buffer_load_dwordx4 v2,s[36:39],s53 offen lds
ds_read_b64_tr_b16 v[40:41],v5 offset:8192
ds_read_b64_tr_b16 v[42:43],v5 offset:8704
s_waitcnt lgkmcnt(8)
v_mfma_f32_16x16x32_bf16 v[24:27],v[120:123],v[64:67],v[24:27]
ds_read_b64_tr_b16 v[44:45],v6 offset:8192
ds_read_b64_tr_b16 v[46:47],v6 offset:8704
v_mfma_f32_16x16x32_bf16 v[28:31],v[124:127],v[64:67],v[28:31]
s_waitcnt lgkmcnt(8)
v_mfma_f32_16x16x32_bf16 v[36:39],v[124:127],v[68:71],v[36:39]
v_mfma_f32_16x16x32_bf16 v[32:35],v[120:123],v[68:71],v[32:35]
s_waitcnt vmcnt(9)
ds_read_b128 v[248:251],v9 offset:6144
ds_read_b128 v[252:255],v9 offset:7168
ds_read_b64_tr_b16 v[64:65],v7 offset:8192
ds_read_b64_tr_b16 v[66:67],v7 offset:8704
s_waitcnt lgkmcnt(10)
v_mfma_f32_16x16x32_bf16 v[48:51],v[120:123],v[72:75],v[48:51]
ds_read_b64_tr_b16 v[68:69],v8 offset:8192
ds_read_b64_tr_b16 v[70:71],v8 offset:8704
v_mfma_f32_16x16x32_bf16 v[52:55],v[124:127],v[72:75],v[52:55]
s_add_u32 m0,s60,114688
s_add_u32 s53,s78,0
buffer_load_dwordx4 v2,s[36:39],s53 offen lds
s_waitcnt lgkmcnt(10)
v_mfma_f32_16x16x32_bf16 v[60:63],v[124:127],v[76:79],v[60:63]
v_mfma_f32_16x16x32_bf16 v[56:59],v[120:123],v[76:79],v[56:59]
ds_read_b64_tr_b16 v[72:73],v5 offset:12288
ds_read_b64_tr_b16 v[74:75],v5 offset:12800
s_setprio 2
s_waitcnt lgkmcnt(10)
v_mfma_f32_16x16x32_bf16 v[128:131],v[112:115],v[40:43],v[128:131]
ds_read_b64_tr_b16 v[76:77],v6 offset:12288
ds_read_b64_tr_b16 v[78:79],v6 offset:12800
v_mfma_f32_16x16x32_bf16 v[132:135],v[116:119],v[40:43],v[132:135]
s_waitcnt lgkmcnt(10)
v_mfma_f32_16x16x32_bf16 v[140:143],v[116:119],v[44:47],v[140:143]
v_mfma_f32_16x16x32_bf16 v[136:139],v[112:115],v[44:47],v[136:139]
s_add_u32 m0,s60,122880
s_add_u32 s53,s79,0
buffer_load_dwordx4 v2,s[36:39],s53 offen lds
ds_read_b64_tr_b16 v[40:41],v7 offset:12288
ds_read_b64_tr_b16 v[42:43],v7 offset:12800
s_waitcnt lgkmcnt(8)
v_mfma_f32_16x16x32_bf16 v[144:147],v[112:115],v[64:67],v[144:147]
ds_read_b64_tr_b16 v[44:45],v8 offset:12288
ds_read_b64_tr_b16 v[46:47],v8 offset:12800
v_mfma_f32_16x16x32_bf16 v[148:151],v[116:119],v[64:67],v[148:151]
s_waitcnt lgkmcnt(8)
v_mfma_f32_16x16x32_bf16 v[156:159],v[116:119],v[68:71],v[156:159]
v_mfma_f32_16x16x32_bf16 v[152:155],v[112:115],v[68:71],v[152:155]
s_add_u32 m0,s58,6144
s_add_u32 s53,s85,64
buffer_load_dwordx4 v3,s[32:35],s53 offen lds
ds_read_b64_tr_b16 v[64:65],v5 offset:16384
ds_read_b64_tr_b16 v[66:67],v5 offset:16896
s_waitcnt lgkmcnt(8)
v_mfma_f32_16x16x32_bf16 v[128:131],v[120:123],v[72:75],v[128:131]
ds_read_b64_tr_b16 v[68:69],v6 offset:16384
ds_read_b64_tr_b16 v[70:71],v6 offset:16896
v_mfma_f32_16x16x32_bf16 v[132:135],v[124:127],v[72:75],v[132:135]
s_add_u32 m0,s58,7168
s_add_u32 s53,s85,8256
buffer_load_dwordx4 v3,s[32:35],s53 offen lds
s_waitcnt lgkmcnt(8)
v_mfma_f32_16x16x32_bf16 v[140:143],v[124:127],v[76:79],v[140:143]
v_mfma_f32_16x16x32_bf16 v[136:139],v[120:123],v[76:79],v[136:139]
ds_read_b64_tr_b16 v[72:73],v7 offset:16384
ds_read_b64_tr_b16 v[74:75],v7 offset:16896
s_waitcnt lgkmcnt(8)
v_mfma_f32_16x16x32_bf16 v[144:147],v[120:123],v[40:43],v[144:147]
ds_read_b64_tr_b16 v[76:77],v8 offset:16384
ds_read_b64_tr_b16 v[78:79],v8 offset:16896
v_mfma_f32_16x16x32_bf16 v[148:151],v[124:127],v[40:43],v[148:151]
s_waitcnt lgkmcnt(8)
v_mfma_f32_16x16x32_bf16 v[156:159],v[124:127],v[44:47],v[156:159]
v_mfma_f32_16x16x32_bf16 v[152:155],v[120:123],v[44:47],v[152:155]
ds_read_b64_tr_b16 v[40:41],v5 offset:20480
ds_read_b64_tr_b16 v[42:43],v5 offset:20992
s_setprio 1
s_waitcnt lgkmcnt(8)
v_mfma_f32_16x16x32_bf16 v[160:163],v[112:115],v[64:67],v[160:163]
ds_read_b64_tr_b16 v[44:45],v6 offset:20480
ds_read_b64_tr_b16 v[46:47],v6 offset:20992
v_mfma_f32_16x16x32_bf16 v[164:167],v[116:119],v[64:67],v[164:167]
s_waitcnt vmcnt(10)
ds_read_b128 v[80:83],v9 offset:0
ds_read_b128 v[84:87],v9 offset:1024
s_waitcnt lgkmcnt(10)
v_mfma_f32_16x16x32_bf16 v[172:175],v[116:119],v[68:71],v[172:175]
v_mfma_f32_16x16x32_bf16 v[168:171],v[112:115],v[68:71],v[168:171]
ds_read_b64_tr_b16 v[64:65],v7 offset:20480
ds_read_b64_tr_b16 v[66:67],v7 offset:20992
s_waitcnt lgkmcnt(10)
v_mfma_f32_16x16x32_bf16 v[176:179],v[112:115],v[72:75],v[176:179]
ds_read_b64_tr_b16 v[68:69],v8 offset:20480
ds_read_b64_tr_b16 v[70:71],v8 offset:20992
v_mfma_f32_16x16x32_bf16 v[180:183],v[116:119],v[72:75],v[180:183]
s_waitcnt lgkmcnt(10)
v_mfma_f32_16x16x32_bf16 v[188:191],v[116:119],v[76:79],v[188:191]
v_mfma_f32_16x16x32_bf16 v[184:187],v[112:115],v[76:79],v[184:187]
ds_read_b64_tr_b16 v[72:73],v5 offset:24576
ds_read_b64_tr_b16 v[74:75],v5 offset:25088
s_waitcnt lgkmcnt(10)
v_mfma_f32_16x16x32_bf16 v[160:163],v[120:123],v[40:43],v[160:163]
ds_read_b64_tr_b16 v[76:77],v6 offset:24576
ds_read_b64_tr_b16 v[78:79],v6 offset:25088
v_mfma_f32_16x16x32_bf16 v[164:167],v[124:127],v[40:43],v[164:167]
s_waitcnt lgkmcnt(10)
v_mfma_f32_16x16x32_bf16 v[172:175],v[124:127],v[44:47],v[172:175]
v_mfma_f32_16x16x32_bf16 v[168:171],v[120:123],v[44:47],v[168:171]
ds_read_b64_tr_b16 v[40:41],v7 offset:24576
ds_read_b64_tr_b16 v[42:43],v7 offset:25088
s_waitcnt lgkmcnt(8)
v_mfma_f32_16x16x32_bf16 v[176:179],v[120:123],v[64:67],v[176:179]
ds_read_b64_tr_b16 v[44:45],v8 offset:24576
ds_read_b64_tr_b16 v[46:47],v8 offset:25088
v_mfma_f32_16x16x32_bf16 v[180:183],v[124:127],v[64:67],v[180:183]
s_add_u32 m0,s58,0
s_add_u32 s53,s86,0
buffer_load_dwordx4 v3,s[32:35],s53 offen lds
s_waitcnt lgkmcnt(8)
v_mfma_f32_16x16x32_bf16 v[188:191],v[124:127],v[68:71],v[188:191]
v_mfma_f32_16x16x32_bf16 v[184:187],v[120:123],v[68:71],v[184:187]
s_add_u32 m0,s58,1024
s_add_u32 s53,s86,8192
buffer_load_dwordx4 v3,s[32:35],s53 offen lds
ds_read_b64_tr_b16 v[64:65],v5 offset:28672
ds_read_b64_tr_b16 v[66:67],v5 offset:29184
s_setprio 0
s_waitcnt lgkmcnt(8)
v_mfma_f32_16x16x32_bf16 v[192:195],v[112:115],v[72:75],v[192:195]
ds_read_b64_tr_b16 v[68:69],v6 offset:28672
ds_read_b64_tr_b16 v[70:71],v6 offset:29184
v_mfma_f32_16x16x32_bf16 v[196:199],v[116:119],v[72:75],v[196:199]
s_waitcnt lgkmcnt(8)
v_mfma_f32_16x16x32_bf16 v[204:207],v[116:119],v[76:79],v[204:207]
v_mfma_f32_16x16x32_bf16 v[200:203],v[112:115],v[76:79],v[200:203]
ds_read_b64_tr_b16 v[72:73],v7 offset:28672
ds_read_b64_tr_b16 v[74:75],v7 offset:29184
s_waitcnt lgkmcnt(8)
v_mfma_f32_16x16x32_bf16 v[208:211],v[112:115],v[40:43],v[208:211]
ds_read_b64_tr_b16 v[76:77],v8 offset:28672
ds_read_b64_tr_b16 v[78:79],v8 offset:29184
v_mfma_f32_16x16x32_bf16 v[212:215],v[116:119],v[40:43],v[212:215]
s_waitcnt vmcnt(10)
ds_read_b128 v[88:91],v9 offset:2048
ds_read_b128 v[92:95],v9 offset:3072
s_waitcnt lgkmcnt(10)
v_mfma_f32_16x16x32_bf16 v[220:223],v[116:119],v[44:47],v[220:223]
v_mfma_f32_16x16x32_bf16 v[216:219],v[112:115],v[44:47],v[216:219]
v_add_u32 v5,0xffff0000,v5
ds_read_b64_tr_b16 v[40:41],v5 offset:0
ds_read_b64_tr_b16 v[42:43],v5 offset:512
s_waitcnt lgkmcnt(10)
v_mfma_f32_16x16x32_bf16 v[192:195],v[120:123],v[64:67],v[192:195]
v_add_u32 v6,0xffff0000,v6
ds_read_b64_tr_b16 v[44:45],v6 offset:0
ds_read_b64_tr_b16 v[46:47],v6 offset:512
v_mfma_f32_16x16x32_bf16 v[196:199],v[124:127],v[64:67],v[196:199]
s_waitcnt lgkmcnt(10)
v_mfma_f32_16x16x32_bf16 v[204:207],v[124:127],v[68:71],v[204:207]
v_mfma_f32_16x16x32_bf16 v[200:203],v[120:123],v[68:71],v[200:203]
v_add_u32 v7,0xffff0000,v7
ds_read_b64_tr_b16 v[64:65],v7 offset:0
ds_read_b64_tr_b16 v[66:67],v7 offset:512
s_waitcnt lgkmcnt(10)
v_mfma_f32_16x16x32_bf16 v[208:211],v[120:123],v[72:75],v[208:211]
v_add_u32 v8,0xffff0000,v8
ds_read_b64_tr_b16 v[68:69],v8 offset:0
ds_read_b64_tr_b16 v[70:71],v8 offset:512
v_mfma_f32_16x16x32_bf16 v[212:215],v[124:127],v[72:75],v[212:215]
s_waitcnt lgkmcnt(10)
v_mfma_f32_16x16x32_bf16 v[220:223],v[124:127],v[76:79],v[220:223]
v_mfma_f32_16x16x32_bf16 v[216:219],v[120:123],v[76:79],v[216:219]
s_waitcnt vmcnt(9)
s_barrier
ds_read_b64_tr_b16 v[72:73],v5 offset:4096
ds_read_b64_tr_b16 v[74:75],v5 offset:4608
s_setprio 3
s_waitcnt lgkmcnt(8)
v_mfma_f32_16x16x32_bf16 v[24:27],v[240:243],v[40:43],v[24:27]
s_add_u32 m0,s60,131072
s_add_u32 s53,s76,128
buffer_load_dwordx4 v2,s[36:39],s53 offen lds
ds_read_b64_tr_b16 v[76:77],v6 offset:4096
ds_read_b64_tr_b16 v[78:79],v6 offset:4608
v_mfma_f32_16x16x32_bf16 v[28:31],v[244:247],v[40:43],v[28:31]
s_add_u32 m0,s58,2048
s_add_u32 s53,s86,64
buffer_load_dwordx4 v3,s[32:35],s53 offen lds
s_waitcnt lgkmcnt(8)
v_mfma_f32_16x16x32_bf16 v[36:39],v[244:247],v[44:47],v[36:39]
v_mfma_f32_16x16x32_bf16 v[32:35],v[240:243],v[44:47],v[32:35]
s_add_u32 m0,s58,3072
s_add_u32 s53,s86,8256
buffer_load_dwordx4 v3,s[32:35],s53 offen lds
ds_read_b64_tr_b16 v[40:41],v7 offset:4096
ds_read_b64_tr_b16 v[42:43],v7 offset:4608
s_waitcnt lgkmcnt(8)
v_mfma_f32_16x16x32_bf16 v[48:51],v[240:243],v[64:67],v[48:51]
ds_read_b64_tr_b16 v[44:45],v8 offset:4096
ds_read_b64_tr_b16 v[46:47],v8 offset:4608
v_mfma_f32_16x16x32_bf16 v[52:55],v[244:247],v[64:67],v[52:55]
s_cmp_lg_u32 s50,0
s_cbranch_scc1 L_tag19
s_cmp_lg_u32 s101,0
s_cbranch_scc1 L_tag19
buffer_load_dword v14,off,s[92:95],0 sc1
L_tag19:
s_waitcnt lgkmcnt(8)
v_mfma_f32_16x16x32_bf16 v[60:63],v[244:247],v[68:71],v[60:63]
v_mfma_f32_16x16x32_bf16 v[56:59],v[240:243],v[68:71],v[56:59]
s_add_u32 m0,s60,139264
s_add_u32 s53,s77,128
buffer_load_dwordx4 v2,s[36:39],s53 offen lds
ds_read_b64_tr_b16 v[64:65],v5 offset:8192
ds_read_b64_tr_b16 v[66:67],v5 offset:8704
s_waitcnt lgkmcnt(8)
v_mfma_f32_16x16x32_bf16 v[24:27],v[248:251],v[72:75],v[24:27]
ds_read_b64_tr_b16 v[68:69],v6 offset:8192
ds_read_b64_tr_b16 v[70:71],v6 offset:8704
v_mfma_f32_16x16x32_bf16 v[28:31],v[252:255],v[72:75],v[28:31]
s_waitcnt lgkmcnt(8)
v_mfma_f32_16x16x32_bf16 v[36:39],v[252:255],v[76:79],v[36:39]
v_mfma_f32_16x16x32_bf16 v[32:35],v[248:251],v[76:79],v[32:35]
s_waitcnt vmcnt(11)
ds_read_b128 v[96:99],v9 offset:4096
ds_read_b128 v[100:103],v9 offset:5120
ds_read_b64_tr_b16 v[72:73],v7 offset:8192
ds_read_b64_tr_b16 v[74:75],v7 offset:8704
s_waitcnt lgkmcnt(10)
v_mfma_f32_16x16x32_bf16 v[48:51],v[248:251],v[40:43],v[48:51]
ds_read_b64_tr_b16 v[76:77],v8 offset:8192
ds_read_b64_tr_b16 v[78:79],v8 offset:8704
v_mfma_f32_16x16x32_bf16 v[52:55],v[252:255],v[40:43],v[52:55]
s_add_u32 m0,s60,147456
s_add_u32 s53,s78,128
buffer_load_dwordx4 v2,s[36:39],s53 offen lds
s_waitcnt lgkmcnt(10)
v_mfma_f32_16x16x32_bf16 v[60:63],v[252:255],v[44:47],v[60:63]
v_mfma_f32_16x16x32_bf16 v[56:59],v[248:251],v[44:47],v[56:59]
ds_read_b64_tr_b16 v[40:41],v5 offset:12288
ds_read_b64_tr_b16 v[42:43],v5 offset:12800
s_setprio 2
s_waitcnt lgkmcnt(10)
v_mfma_f32_16x16x32_bf16 v[128:131],v[240:243],v[64:67],v[128:131]
ds_read_b64_tr_b16 v[44:45],v6 offset:12288
ds_read_b64_tr_b16 v[46:47],v6 offset:12800
v_mfma_f32_16x16x32_bf16 v[132:135],v[244:247],v[64:67],v[132:135]
s_waitcnt lgkmcnt(10)
v_mfma_f32_16x16x32_bf16 v[140:143],v[244:247],v[68:71],v[140:143]
v_mfma_f32_16x16x32_bf16 v[136:139],v[240:243],v[68:71],v[136:139]
s_add_u32 m0,s60,155648
s_add_u32 s53,s79,128
buffer_load_dwordx4 v2,s[36:39],s53 offen lds
ds_read_b64_tr_b16 v[64:65],v7 offset:12288
ds_read_b64_tr_b16 v[66:67],v7 offset:12800
s_waitcnt lgkmcnt(8)
v_mfma_f32_16x16x32_bf16 v[144:147],v[240:243],v[72:75],v[144:147]
ds_read_b64_tr_b16 v[68:69],v8 offset:12288
ds_read_b64_tr_b16 v[70:71],v8 offset:12800
v_mfma_f32_16x16x32_bf16 v[148:151],v[244:247],v[72:75],v[148:151]
s_waitcnt lgkmcnt(8)
v_mfma_f32_16x16x32_bf16 v[156:159],v[244:247],v[76:79],v[156:159]
v_mfma_f32_16x16x32_bf16 v[152:155],v[240:243],v[76:79],v[152:155]
s_add_u32 m0,s58,4096
s_add_u32 s53,s87,0
buffer_load_dwordx4 v3,s[32:35],s53 offen lds
ds_read_b64_tr_b16 v[72:73],v5 offset:16384
ds_read_b64_tr_b16 v[74:75],v5 offset:16896
s_waitcnt lgkmcnt(8)
v_mfma_f32_16x16x32_bf16 v[128:131],v[248:251],v[40:43],v[128:131]
ds_read_b64_tr_b16 v[76:77],v6 offset:16384
ds_read_b64_tr_b16 v[78:79],v6 offset:16896
v_mfma_f32_16x16x32_bf16 v[132:135],v[252:255],v[40:43],v[132:135]
s_add_u32 m0,s58,5120
s_add_u32 s53,s87,8192
buffer_load_dwordx4 v3,s[32:35],s53 offen lds
s_waitcnt lgkmcnt(8)
v_mfma_f32_16x16x32_bf16 v[140:143],v[252:255],v[44:47],v[140:143]
v_mfma_f32_16x16x32_bf16 v[136:139],v[248:251],v[44:47],v[136:139]
ds_read_b64_tr_b16 v[40:41],v7 offset:16384
ds_read_b64_tr_b16 v[42:43],v7 offset:16896
s_waitcnt lgkmcnt(8)
v_mfma_f32_16x16x32_bf16 v[144:147],v[248:251],v[64:67],v[144:147]
ds_read_b64_tr_b16 v[44:45],v8 offset:16384
ds_read_b64_tr_b16 v[46:47],v8 offset:16896
v_mfma_f32_16x16x32_bf16 v[148:151],v[252:255],v[64:67],v[148:151]
s_waitcnt lgkmcnt(8)
v_mfma_f32_16x16x32_bf16 v[156:159],v[252:255],v[68:71],v[156:159]
v_mfma_f32_16x16x32_bf16 v[152:155],v[248:251],v[68:71],v[152:155]
s_waitcnt vmcnt(10)
ds_read_b128 v[104:107],v9 offset:6144
ds_read_b128 v[108:111],v9 offset:7168
ds_read_b64_tr_b16 v[64:65],v5 offset:20480
ds_read_b64_tr_b16 v[66:67],v5 offset:20992
s_setprio 1
s_waitcnt lgkmcnt(10)
v_mfma_f32_16x16x32_bf16 v[160:163],v[240:243],v[72:75],v[160:163]
ds_read_b64_tr_b16 v[68:69],v6 offset:20480
ds_read_b64_tr_b16 v[70:71],v6 offset:20992
v_mfma_f32_16x16x32_bf16 v[164:167],v[244:247],v[72:75],v[164:167]
s_waitcnt lgkmcnt(10)
v_mfma_f32_16x16x32_bf16 v[172:175],v[244:247],v[76:79],v[172:175]
v_mfma_f32_16x16x32_bf16 v[168:171],v[240:243],v[76:79],v[168:171]
ds_read_b64_tr_b16 v[72:73],v7 offset:20480
ds_read_b64_tr_b16 v[74:75],v7 offset:20992
s_waitcnt lgkmcnt(10)
v_mfma_f32_16x16x32_bf16 v[176:179],v[240:243],v[40:43],v[176:179]
ds_read_b64_tr_b16 v[76:77],v8 offset:20480
ds_read_b64_tr_b16 v[78:79],v8 offset:20992
v_mfma_f32_16x16x32_bf16 v[180:183],v[244:247],v[40:43],v[180:183]
s_waitcnt lgkmcnt(10)
v_mfma_f32_16x16x32_bf16 v[188:191],v[244:247],v[44:47],v[188:191]
v_mfma_f32_16x16x32_bf16 v[184:187],v[240:243],v[44:47],v[184:187]
ds_read_b64_tr_b16 v[40:41],v5 offset:24576
ds_read_b64_tr_b16 v[42:43],v5 offset:25088
s_waitcnt lgkmcnt(8)
v_mfma_f32_16x16x32_bf16 v[160:163],v[248:251],v[64:67],v[160:163]
ds_read_b64_tr_b16 v[44:45],v6 offset:24576
ds_read_b64_tr_b16 v[46:47],v6 offset:25088
v_mfma_f32_16x16x32_bf16 v[164:167],v[252:255],v[64:67],v[164:167]
s_waitcnt lgkmcnt(8)
v_mfma_f32_16x16x32_bf16 v[172:175],v[252:255],v[68:71],v[172:175]
v_mfma_f32_16x16x32_bf16 v[168:171],v[248:251],v[68:71],v[168:171]
s_add_u32 m0,s58,6144
s_add_u32 s53,s87,64
buffer_load_dwordx4 v3,s[32:35],s53 offen lds
ds_read_b64_tr_b16 v[64:65],v7 offset:24576
ds_read_b64_tr_b16 v[66:67],v7 offset:25088
s_waitcnt lgkmcnt(8)
v_mfma_f32_16x16x32_bf16 v[176:179],v[248:251],v[72:75],v[176:179]
s_add_u32 m0,s58,7168
s_add_u32 s53,s87,8256
buffer_load_dwordx4 v3,s[32:35],s53 offen lds
ds_read_b64_tr_b16 v[68:69],v8 offset:24576
ds_read_b64_tr_b16 v[70:71],v8 offset:25088
v_mfma_f32_16x16x32_bf16 v[180:183],v[252:255],v[72:75],v[180:183]
s_mov_b64 s[44:45],s[8:9]
s_mov_b32 s46,4194304
v_and_b32 v22,7,v1
v_lshlrev_b32 v22,13,v22
v_bfe_u32 v23,v1,3,1
v_lshl_add_u32 v22,v23,7,v22
s_waitcnt lgkmcnt(8)
v_mfma_f32_16x16x32_bf16 v[188:191],v[252:255],v[76:79],v[188:191]
v_mfma_f32_16x16x32_bf16 v[184:187],v[248:251],v[76:79],v[184:187]
s_and_b32 s88,s2,7
s_lshl_b32 s88,s88,2
s_bfe_u32 s89,s2,0x20003
s_add_u32 s88,s88,s89
s_lshl_b32 s88,s88,8
s_lshr_b32 s89,s2,5
s_lshl_b32 s89,s89,3
s_add_u32 s89,s89,s50
s_lshl_b32 s89,s89,16
s_add_u32 s88,s88,s89
buffer_load_dword v22,v22,s[44:47],s88 offen
ds_read_b64_tr_b16 v[72:73],v5 offset:28672
ds_read_b64_tr_b16 v[74:75],v5 offset:29184
s_setprio 0
s_waitcnt lgkmcnt(8)
v_mfma_f32_16x16x32_bf16 v[192:195],v[240:243],v[40:43],v[192:195]
ds_read_b64_tr_b16 v[76:77],v6 offset:28672
ds_read_b64_tr_b16 v[78:79],v6 offset:29184
v_mfma_f32_16x16x32_bf16 v[196:199],v[244:247],v[40:43],v[196:199]
s_waitcnt lgkmcnt(8)
v_mfma_f32_16x16x32_bf16 v[204:207],v[244:247],v[44:47],v[204:207]
v_mfma_f32_16x16x32_bf16 v[200:203],v[240:243],v[44:47],v[200:203]
s_waitcnt vmcnt(11)
ds_read_b128 v[112:115],v9 offset:0
ds_read_b128 v[116:119],v9 offset:1024
ds_read_b64_tr_b16 v[40:41],v7 offset:28672
ds_read_b64_tr_b16 v[42:43],v7 offset:29184
s_waitcnt lgkmcnt(10)
v_mfma_f32_16x16x32_bf16 v[208:211],v[240:243],v[64:67],v[208:211]
ds_read_b64_tr_b16 v[44:45],v8 offset:28672
ds_read_b64_tr_b16 v[46:47],v8 offset:29184
v_mfma_f32_16x16x32_bf16 v[212:215],v[244:247],v[64:67],v[212:215]
s_waitcnt lgkmcnt(10)
v_mfma_f32_16x16x32_bf16 v[220:223],v[244:247],v[68:71],v[220:223]
v_mfma_f32_16x16x32_bf16 v[216:219],v[240:243],v[68:71],v[216:219]
ds_read_b64_tr_b16 v[64:65],v5 offset:32768
ds_read_b64_tr_b16 v[66:67],v5 offset:33280
s_waitcnt lgkmcnt(10)
v_mfma_f32_16x16x32_bf16 v[192:195],v[248:251],v[72:75],v[192:195]
ds_read_b64_tr_b16 v[68:69],v6 offset:32768
ds_read_b64_tr_b16 v[70:71],v6 offset:33280
v_mfma_f32_16x16x32_bf16 v[196:199],v[252:255],v[72:75],v[196:199]
s_waitcnt lgkmcnt(10)
v_mfma_f32_16x16x32_bf16 v[204:207],v[252:255],v[76:79],v[204:207]
v_mfma_f32_16x16x32_bf16 v[200:203],v[248:251],v[76:79],v[200:203]
ds_read_b64_tr_b16 v[72:73],v7 offset:32768
ds_read_b64_tr_b16 v[74:75],v7 offset:33280
s_waitcnt lgkmcnt(8)
v_mfma_f32_16x16x32_bf16 v[208:211],v[248:251],v[40:43],v[208:211]
ds_read_b64_tr_b16 v[76:77],v8 offset:32768
ds_read_b64_tr_b16 v[78:79],v8 offset:33280
v_mfma_f32_16x16x32_bf16 v[212:215],v[252:255],v[40:43],v[212:215]
s_waitcnt lgkmcnt(8)
v_mfma_f32_16x16x32_bf16 v[220:223],v[252:255],v[44:47],v[220:223]
v_mfma_f32_16x16x32_bf16 v[216:219],v[248:251],v[44:47],v[216:219]
s_waitcnt vmcnt(10)
s_barrier
ds_read_b64_tr_b16 v[40:41],v5 offset:36864
ds_read_b64_tr_b16 v[42:43],v5 offset:37376
s_setprio 3
s_waitcnt lgkmcnt(8)
v_mfma_f32_16x16x32_bf16 v[24:27],v[80:83],v[64:67],v[24:27]
ds_read_b64_tr_b16 v[44:45],v6 offset:36864
ds_read_b64_tr_b16 v[46:47],v6 offset:37376
v_mfma_f32_16x16x32_bf16 v[28:31],v[84:87],v[64:67],v[28:31]
s_add_u32 m0,s60,65536
s_add_u32 s53,s76,256
buffer_load_dwordx4 v2,s[36:39],s53 offen lds
s_waitcnt lgkmcnt(8)
v_mfma_f32_16x16x32_bf16 v[36:39],v[84:87],v[68:71],v[36:39]
v_mfma_f32_16x16x32_bf16 v[32:35],v[80:83],v[68:71],v[32:35]
ds_read_b64_tr_b16 v[64:65],v7 offset:36864
ds_read_b64_tr_b16 v[66:67],v7 offset:37376
s_waitcnt lgkmcnt(8)
v_mfma_f32_16x16x32_bf16 v[48:51],v[80:83],v[72:75],v[48:51]
ds_read_b64_tr_b16 v[68:69],v8 offset:36864
ds_read_b64_tr_b16 v[70:71],v8 offset:37376
v_mfma_f32_16x16x32_bf16 v[52:55],v[84:87],v[72:75],v[52:55]
s_cmp_lg_u32 s50,0
s_cbranch_scc1 L_tag20
s_cmp_lg_u32 s101,0
s_cbranch_scc1 L_tag20
s_waitcnt vmcnt(9)
v_readfirstlane_b32 s96,v14
s_cmp_lg_u32 s96,0
s_cbranch_scc1 L_tag20
s_call_b64 s[66:67],L_tag_slow
L_tag20:
s_waitcnt lgkmcnt(8)
v_mfma_f32_16x16x32_bf16 v[60:63],v[84:87],v[76:79],v[60:63]
v_mfma_f32_16x16x32_bf16 v[56:59],v[80:83],v[76:79],v[56:59]
s_add_u32 m0,s60,73728
s_add_u32 s53,s77,256
buffer_load_dwordx4 v2,s[36:39],s53 offen lds
ds_read_b64_tr_b16 v[72:73],v5 offset:40960
ds_read_b64_tr_b16 v[74:75],v5 offset:41472
s_waitcnt lgkmcnt(8)
v_mfma_f32_16x16x32_bf16 v[24:27],v[88:91],v[40:43],v[24:27]
ds_read_b64_tr_b16 v[76:77],v6 offset:40960
ds_read_b64_tr_b16 v[78:79],v6 offset:41472
v_mfma_f32_16x16x32_bf16 v[28:31],v[92:95],v[40:43],v[28:31]
s_waitcnt vmcnt(10)
ds_read_b128 v[120:123],v9 offset:2048
ds_read_b128 v[124:127],v9 offset:3072
s_waitcnt lgkmcnt(10)
v_mfma_f32_16x16x32_bf16 v[36:39],v[92:95],v[44:47],v[36:39]
v_mfma_f32_16x16x32_bf16 v[32:35],v[88:91],v[44:47],v[32:35]
ds_read_b64_tr_b16 v[40:41],v7 offset:40960
ds_read_b64_tr_b16 v[42:43],v7 offset:41472
s_waitcnt lgkmcnt(10)
v_mfma_f32_16x16x32_bf16 v[48:51],v[88:91],v[64:67],v[48:51]
ds_read_b64_tr_b16 v[44:45],v8 offset:40960
ds_read_b64_tr_b16 v[46:47],v8 offset:41472
v_mfma_f32_16x16x32_bf16 v[52:55],v[92:95],v[64:67],v[52:55]
s_add_u32 m0,s60,81920
s_add_u32 s53,s78,256
buffer_load_dwordx4 v2,s[36:39],s53 offen lds
s_waitcnt lgkmcnt(10)
v_mfma_f32_16x16x32_bf16 v[60:63],v[92:95],v[68:71],v[60:63]
v_mfma_f32_16x16x32_bf16 v[56:59],v[88:91],v[68:71],v[56:59]
ds_read_b64_tr_b16 v[64:65],v5 offset:45056
ds_read_b64_tr_b16 v[66:67],v5 offset:45568
s_setprio 2
s_waitcnt lgkmcnt(10)
v_mfma_f32_16x16x32_bf16 v[24:27],v[96:99],v[72:75],v[24:27]
ds_read_b64_tr_b16 v[68:69],v6 offset:45056
ds_read_b64_tr_b16 v[70:71],v6 offset:45568
v_mfma_f32_16x16x32_bf16 v[28:31],v[100:103],v[72:75],v[28:31]
s_waitcnt lgkmcnt(10)
v_mfma_f32_16x16x32_bf16 v[36:39],v[100:103],v[76:79],v[36:39]
v_mfma_f32_16x16x32_bf16 v[32:35],v[96:99],v[76:79],v[32:35]
s_add_u32 m0,s60,90112
s_add_u32 s53,s79,256
buffer_load_dwordx4 v2,s[36:39],s53 offen lds
ds_read_b64_tr_b16 v[72:73],v7 offset:45056
ds_read_b64_tr_b16 v[74:75],v7 offset:45568
s_waitcnt lgkmcnt(8)
v_mfma_f32_16x16x32_bf16 v[48:51],v[96:99],v[40:43],v[48:51]
ds_read_b64_tr_b16 v[76:77],v8 offset:45056
ds_read_b64_tr_b16 v[78:79],v8 offset:45568
v_mfma_f32_16x16x32_bf16 v[52:55],v[100:103],v[40:43],v[52:55]
s_waitcnt lgkmcnt(8)
v_mfma_f32_16x16x32_bf16 v[60:63],v[100:103],v[44:47],v[60:63]
v_mfma_f32_16x16x32_bf16 v[56:59],v[96:99],v[44:47],v[56:59]
ds_read_b64_tr_b16 v[40:41],v5 offset:49152
ds_read_b64_tr_b16 v[42:43],v5 offset:49664
s_waitcnt lgkmcnt(8)
v_mfma_f32_16x16x32_bf16 v[24:27],v[104:107],v[64:67],v[24:27]
ds_read_b64_tr_b16 v[44:45],v6 offset:49152
ds_read_b64_tr_b16 v[46:47],v6 offset:49664
v_mfma_f32_16x16x32_bf16 v[28:31],v[108:111],v[64:67],v[28:31]
s_waitcnt lgkmcnt(8)
v_mfma_f32_16x16x32_bf16 v[36:39],v[108:111],v[68:71],v[36:39]
v_mfma_f32_16x16x32_bf16 v[32:35],v[104:107],v[68:71],v[32:35]
ds_read_b64_tr_b16 v[64:65],v7 offset:49152
ds_read_b64_tr_b16 v[66:67],v7 offset:49664
s_waitcnt lgkmcnt(8)
v_mfma_f32_16x16x32_bf16 v[48:51],v[104:107],v[72:75],v[48:51]
ds_read_b64_tr_b16 v[68:69],v8 offset:49152
ds_read_b64_tr_b16 v[70:71],v8 offset:49664
v_mfma_f32_16x16x32_bf16 v[52:55],v[108:111],v[72:75],v[52:55]
s_waitcnt vmcnt(7)
ds_read_b128 v[240:243],v9 offset:4096
ds_read_b128 v[244:247],v9 offset:5120
s_waitcnt lgkmcnt(10)
v_mfma_f32_16x16x32_bf16 v[60:63],v[108:111],v[76:79],v[60:63]
v_mfma_f32_16x16x32_bf16 v[56:59],v[104:107],v[76:79],v[56:59]
ds_read_b64_tr_b16 v[72:73],v5 offset:53248
ds_read_b64_tr_b16 v[74:75],v5 offset:53760
s_setprio 1
s_waitcnt lgkmcnt(10)
v_mfma_f32_16x16x32_bf16 v[24:27],v[112:115],v[40:43],v[24:27]
ds_read_b64_tr_b16 v[76:77],v6 offset:53248
ds_read_b64_tr_b16 v[78:79],v6 offset:53760
v_mfma_f32_16x16x32_bf16 v[28:31],v[116:119],v[40:43],v[28:31]
s_waitcnt lgkmcnt(10)
v_mfma_f32_16x16x32_bf16 v[36:39],v[116:119],v[44:47],v[36:39]
v_mfma_f32_16x16x32_bf16 v[32:35],v[112:115],v[44:47],v[32:35]
ds_read_b64_tr_b16 v[40:41],v7 offset:53248
ds_read_b64_tr_b16 v[42:43],v7 offset:53760
s_waitcnt lgkmcnt(10)
v_mfma_f32_16x16x32_bf16 v[48:51],v[112:115],v[64:67],v[48:51]
ds_read_b64_tr_b16 v[44:45],v8 offset:53248
ds_read_b64_tr_b16 v[46:47],v8 offset:53760
v_mfma_f32_16x16x32_bf16 v[52:55],v[116:119],v[64:67],v[52:55]
s_waitcnt lgkmcnt(10)
v_mfma_f32_16x16x32_bf16 v[60:63],v[116:119],v[68:71],v[60:63]
v_mfma_f32_16x16x32_bf16 v[56:59],v[112:115],v[68:71],v[56:59]
ds_read_b64_tr_b16 v[64:65],v5 offset:57344
ds_read_b64_tr_b16 v[66:67],v5 offset:57856
s_waitcnt lgkmcnt(8)
v_mfma_f32_16x16x32_bf16 v[24:27],v[120:123],v[72:75],v[24:27]
ds_read_b64_tr_b16 v[68:69],v6 offset:57344
ds_read_b64_tr_b16 v[70:71],v6 offset:57856
v_mfma_f32_16x16x32_bf16 v[28:31],v[124:127],v[72:75],v[28:31]
s_waitcnt lgkmcnt(8)
v_mfma_f32_16x16x32_bf16 v[36:39],v[124:127],v[76:79],v[36:39]
v_mfma_f32_16x16x32_bf16 v[32:35],v[120:123],v[76:79],v[32:35]
ds_read_b64_tr_b16 v[72:73],v7 offset:57344
ds_read_b64_tr_b16 v[74:75],v7 offset:57856
s_waitcnt lgkmcnt(8)
v_mfma_f32_16x16x32_bf16 v[48:51],v[120:123],v[40:43],v[48:51]
ds_read_b64_tr_b16 v[76:77],v8 offset:57344
ds_read_b64_tr_b16 v[78:79],v8 offset:57856
v_mfma_f32_16x16x32_bf16 v[52:55],v[124:127],v[40:43],v[52:55]
s_waitcnt lgkmcnt(8)
v_mfma_f32_16x16x32_bf16 v[60:63],v[124:127],v[44:47],v[60:63]
v_mfma_f32_16x16x32_bf16 v[56:59],v[120:123],v[44:47],v[56:59]
ds_read_b64_tr_b16 v[40:41],v5 offset:61440
ds_read_b64_tr_b16 v[42:43],v5 offset:61952
s_setprio 0
s_waitcnt lgkmcnt(8)
v_mfma_f32_16x16x32_bf16 v[24:27],v[240:243],v[64:67],v[24:27]
ds_read_b64_tr_b16 v[44:45],v6 offset:61440
ds_read_b64_tr_b16 v[46:47],v6 offset:61952
v_mfma_f32_16x16x32_bf16 v[28:31],v[244:247],v[64:67],v[28:31]
s_waitcnt lgkmcnt(8)
v_mfma_f32_16x16x32_bf16 v[36:39],v[244:247],v[68:71],v[36:39]
v_mfma_f32_16x16x32_bf16 v[32:35],v[240:243],v[68:71],v[32:35]
s_waitcnt vmcnt(5)
ds_read_b128 v[248:251],v9 offset:6144
ds_read_b128 v[252:255],v9 offset:7168
ds_read_b64_tr_b16 v[64:65],v7 offset:61440
ds_read_b64_tr_b16 v[66:67],v7 offset:61952
s_waitcnt lgkmcnt(10)
v_mfma_f32_16x16x32_bf16 v[48:51],v[240:243],v[72:75],v[48:51]
ds_read_b64_tr_b16 v[68:69],v8 offset:61440
ds_read_b64_tr_b16 v[70:71],v8 offset:61952
v_mfma_f32_16x16x32_bf16 v[52:55],v[244:247],v[72:75],v[52:55]
s_waitcnt lgkmcnt(10)
v_mfma_f32_16x16x32_bf16 v[60:63],v[244:247],v[76:79],v[60:63]
v_mfma_f32_16x16x32_bf16 v[56:59],v[240:243],v[76:79],v[56:59]
v_add_u32 v5,0x10000,v5
ds_read_b64_tr_b16 v[72:73],v5 offset:0
ds_read_b64_tr_b16 v[74:75],v5 offset:512
s_waitcnt lgkmcnt(7)
v_mfma_f32_16x16x32_bf16 v[24:27],v[248:251],v[40:43],v[24:27]
v_add_u32 v6,0x10000,v6
ds_read_b64_tr_b16 v[76:77],v6 offset:0
ds_read_b64_tr_b16 v[78:79],v6 offset:512
s_waitcnt lgkmcnt(8)
v_mfma_f32_16x16x32_bf16 v[28:31],v[252:255],v[40:43],v[28:31]
v_mfma_f32_16x16x32_bf16 v[36:39],v[252:255],v[44:47],v[36:39]
v_mfma_f32_16x16x32_bf16 v[32:35],v[248:251],v[44:47],v[32:35]
v_add_u32 v7,0x10000,v7
ds_read_b64_tr_b16 v[40:41],v7 offset:0
ds_read_b64_tr_b16 v[42:43],v7 offset:512
s_waitcnt lgkmcnt(8)
v_mfma_f32_16x16x32_bf16 v[48:51],v[248:251],v[64:67],v[48:51]
v_add_u32 v8,0x10000,v8
ds_read_b64_tr_b16 v[44:45],v8 offset:0
ds_read_b64_tr_b16 v[46:47],v8 offset:512
v_mfma_f32_16x16x32_bf16 v[52:55],v[252:255],v[64:67],v[52:55]
s_waitcnt lgkmcnt(8)
v_mfma_f32_16x16x32_bf16 v[60:63],v[252:255],v[68:71],v[60:63]
v_mfma_f32_16x16x32_bf16 v[56:59],v[248:251],v[68:71],v[56:59]
s_waitcnt vmcnt(3)
s_barrier
ds_read_b64_tr_b16 v[64:65],v5 offset:4096
ds_read_b64_tr_b16 v[66:67],v5 offset:4608
s_setprio 3
s_waitcnt lgkmcnt(8)
v_mfma_f32_16x16x32_bf16 v[128:131],v[80:83],v[72:75],v[128:131]
ds_read_b64_tr_b16 v[68:69],v6 offset:4096
ds_read_b64_tr_b16 v[70:71],v6 offset:4608
v_mfma_f32_16x16x32_bf16 v[132:135],v[84:87],v[72:75],v[132:135]
s_add_u32 m0,s60,98304
s_add_u32 s53,s76,384
buffer_load_dwordx4 v2,s[36:39],s53 offen lds
s_waitcnt lgkmcnt(8)
v_mfma_f32_16x16x32_bf16 v[140:143],v[84:87],v[76:79],v[140:143]
v_mfma_f32_16x16x32_bf16 v[136:139],v[80:83],v[76:79],v[136:139]
s_add_u32 m0,s60,106496
s_add_u32 s53,s77,384
buffer_load_dwordx4 v2,s[36:39],s53 offen lds
ds_read_b64_tr_b16 v[72:73],v7 offset:4096
ds_read_b64_tr_b16 v[74:75],v7 offset:4608
s_waitcnt lgkmcnt(8)
v_mfma_f32_16x16x32_bf16 v[144:147],v[80:83],v[40:43],v[144:147]
ds_read_b64_tr_b16 v[76:77],v8 offset:4096
ds_read_b64_tr_b16 v[78:79],v8 offset:4608
v_mfma_f32_16x16x32_bf16 v[148:151],v[84:87],v[40:43],v[148:151]
s_add_u32 s54,s51,0
s_waitcnt lgkmcnt(8)
v_mfma_f32_16x16x32_bf16 v[156:159],v[84:87],v[44:47],v[156:159]
s_add_u32 m0,s60,114688
s_add_u32 s53,s78,384
buffer_load_dwordx4 v2,s[36:39],s53 offen lds
v_mfma_f32_16x16x32_bf16 v[152:155],v[80:83],v[44:47],v[152:155]
s_lshr_b32 s57,s54,1
ds_read_b64_tr_b16 v[40:41],v5 offset:8192
ds_read_b64_tr_b16 v[42:43],v5 offset:8704
s_waitcnt lgkmcnt(8)
v_mfma_f32_16x16x32_bf16 v[128:131],v[88:91],v[64:67],v[128:131]
ds_read_b64_tr_b16 v[44:45],v6 offset:8192
ds_read_b64_tr_b16 v[46:47],v6 offset:8704
v_mfma_f32_16x16x32_bf16 v[132:135],v[92:95],v[64:67],v[132:135]
s_lshl_b32 s57,s57,20
s_waitcnt lgkmcnt(8)
v_mfma_f32_16x16x32_bf16 v[140:143],v[92:95],v[68:71],v[140:143]
s_add_u32 m0,s60,122880
s_add_u32 s53,s79,384
buffer_load_dwordx4 v2,s[36:39],s53 offen lds
v_mfma_f32_16x16x32_bf16 v[136:139],v[88:91],v[68:71],v[136:139]
s_and_b32 s54,s54,1
ds_read_b64_tr_b16 v[64:65],v7 offset:8192
ds_read_b64_tr_b16 v[66:67],v7 offset:8704
s_waitcnt lgkmcnt(8)
v_mfma_f32_16x16x32_bf16 v[144:147],v[88:91],v[72:75],v[144:147]
ds_read_b64_tr_b16 v[68:69],v8 offset:8192
ds_read_b64_tr_b16 v[70:71],v8 offset:8704
v_mfma_f32_16x16x32_bf16 v[148:151],v[92:95],v[72:75],v[148:151]
s_lshl_b32 s54,s54,12
s_waitcnt lgkmcnt(8)
v_mfma_f32_16x16x32_bf16 v[156:159],v[92:95],v[76:79],v[156:159]
v_mfma_f32_16x16x32_bf16 v[152:155],v[88:91],v[76:79],v[152:155]
s_add_u32 s57,s57,s54
ds_read_b64_tr_b16 v[72:73],v5 offset:12288
ds_read_b64_tr_b16 v[74:75],v5 offset:12800
s_setprio 2
s_waitcnt lgkmcnt(8)
v_mfma_f32_16x16x32_bf16 v[128:131],v[96:99],v[40:43],v[128:131]
v_mov_b32 v14,s96
v_min_u32 v23,47,v1
v_lshlrev_b32 v23,2,v23
s_and_b32 s88,s2,7
s_lshl_b32 s88,s88,8
s_add_u32 s88,s88,101787648
v_add_u32 v23,s88,v23
s_mov_b32 s7,0
s_cmp_lg_u32 s50,0
s_cbranch_scc1 L_xfp21
s_cmp_lg_u32 s3,s2
s_cbranch_scc1 L_xfp21
buffer_load_dword v14,v23,s[40:43],0 offen sc1
L_xfp21:
ds_read_b64_tr_b16 v[76:77],v6 offset:12288
ds_read_b64_tr_b16 v[78:79],v6 offset:12800
v_mfma_f32_16x16x32_bf16 v[132:135],v[100:103],v[40:43],v[132:135]
s_add_u32 s57,s57,16384
s_waitcnt lgkmcnt(8)
v_mfma_f32_16x16x32_bf16 v[140:143],v[100:103],v[44:47],v[140:143]
s_mov_b64 s[76:77],s[8:9]
s_mov_b32 s78,4194304
v_mfma_f32_16x16x32_bf16 v[136:139],v[96:99],v[44:47],v[136:139]
s_mov_b32 s79,0x20000
v_cvt_pk_bf16_f32 v24,v24,v25
ds_read_b64_tr_b16 v[40:41],v7 offset:12288
ds_read_b64_tr_b16 v[42:43],v7 offset:12800
s_waitcnt lgkmcnt(8)
v_mfma_f32_16x16x32_bf16 v[144:147],v[96:99],v[64:67],v[144:147]
s_mov_b64 s[8:9],s[40:41]
ds_read_b64_tr_b16 v[44:45],v8 offset:12288
ds_read_b64_tr_b16 v[46:47],v8 offset:12800
v_mfma_f32_16x16x32_bf16 v[148:151],v[100:103],v[64:67],v[148:151]
s_mov_b32 s10,268435456
v_cvt_pk_bf16_f32 v25,v26,v27
s_waitcnt lgkmcnt(8)
v_mfma_f32_16x16x32_bf16 v[156:159],v[100:103],v[68:71],v[156:159]
s_mov_b32 s11,0x20000
s_mov_b64 s[12:13],s[14:15]
v_mfma_f32_16x16x32_bf16 v[152:155],v[96:99],v[68:71],v[152:155]
s_mov_b32 s14,4194304
v_cvt_pk_bf16_f32 v26,v28,v29
ds_read_b64_tr_b16 v[64:65],v5 offset:16384
ds_read_b64_tr_b16 v[66:67],v5 offset:16896
s_waitcnt lgkmcnt(8)
v_mfma_f32_16x16x32_bf16 v[128:131],v[104:107],v[72:75],v[128:131]
s_mov_b32 s15,0x20000
ds_read_b64_tr_b16 v[68:69],v6 offset:16384
ds_read_b64_tr_b16 v[70:71],v6 offset:16896
v_mfma_f32_16x16x32_bf16 v[132:135],v[108:111],v[72:75],v[132:135]
s_mov_b32 s37,s18
v_cvt_pk_bf16_f32 v27,v30,v31
s_waitcnt lgkmcnt(8)
v_mfma_f32_16x16x32_bf16 v[140:143],v[108:111],v[76:79],v[140:143]
s_lshl_b32 s39,s16,11
s_lshl_b32 s29,s16,16
v_mfma_f32_16x16x32_bf16 v[136:139],v[104:107],v[76:79],v[136:139]
s_lshl_b32 s26,s17,8
buffer_store_dwordx4 v[24:27],v4,s[40:43],s57 offen offset:0 sc1
ds_read_b64_tr_b16 v[72:73],v7 offset:16384
ds_read_b64_tr_b16 v[74:75],v7 offset:16896
s_waitcnt lgkmcnt(8)
v_mfma_f32_16x16x32_bf16 v[144:147],v[104:107],v[40:43],v[144:147]
s_add_u32 s29,s29,s26
ds_read_b64_tr_b16 v[76:77],v8 offset:16384
ds_read_b64_tr_b16 v[78:79],v8 offset:16896
v_mfma_f32_16x16x32_bf16 v[148:151],v[108:111],v[40:43],v[148:151]
s_lshl_b32 s24,s19,15
v_cvt_pk_bf16_f32 v28,v32,v33
s_waitcnt lgkmcnt(8)
v_mfma_f32_16x16x32_bf16 v[156:159],v[108:111],v[44:47],v[156:159]
s_add_u32 s24,s24,41943040
v_lshrrev_b32 v20,4,v1
v_mfma_f32_16x16x32_bf16 v[152:155],v[104:107],v[44:47],v[152:155]
v_lshlrev_b32 v21,2,v20
v_cvt_pk_bf16_f32 v29,v34,v35
ds_read_b64_tr_b16 v[40:41],v5 offset:20480
ds_read_b64_tr_b16 v[42:43],v5 offset:20992
s_setprio 1
s_waitcnt lgkmcnt(8)
v_mfma_f32_16x16x32_bf16 v[128:131],v[112:115],v[64:67],v[128:131]
v_and_b32 v10,15,v1
ds_read_b64_tr_b16 v[44:45],v6 offset:20480
ds_read_b64_tr_b16 v[46:47],v6 offset:20992
v_mfma_f32_16x16x32_bf16 v[132:135],v[116:119],v[64:67],v[132:135]
v_xor_b32 v10,v10,v21
v_cvt_pk_bf16_f32 v30,v36,v37
s_waitcnt lgkmcnt(8)
v_mfma_f32_16x16x32_bf16 v[140:143],v[116:119],v[68:71],v[140:143]
s_and_b32 s26,s16,1
s_lshl_b32 s26,s26,1
v_mfma_f32_16x16x32_bf16 v[136:139],v[112:115],v[68:71],v[136:139]
v_xor_b32 v10,s26,v10
v_cvt_pk_bf16_f32 v31,v38,v39
ds_read_b64_tr_b16 v[64:65],v7 offset:20480
ds_read_b64_tr_b16 v[66:67],v7 offset:20992
s_waitcnt lgkmcnt(8)
v_mfma_f32_16x16x32_bf16 v[144:147],v[112:115],v[72:75],v[144:147]
v_lshlrev_b32 v10,4,v10
ds_read_b64_tr_b16 v[68:69],v8 offset:20480
ds_read_b64_tr_b16 v[70:71],v8 offset:20992
v_mfma_f32_16x16x32_bf16 v[148:151],v[116:119],v[72:75],v[148:151]
v_lshl_add_u32 v10,v20,13,v10
buffer_store_dwordx4 v[28:31],v4,s[40:43],s57 offen offset:128 sc1
s_waitcnt lgkmcnt(8)
v_mfma_f32_16x16x32_bf16 v[156:159],v[116:119],v[76:79],v[156:159]
v_lshlrev_b32 v2,4,v1
s_add_u32 s26,s37,0
v_mfma_f32_16x16x32_bf16 v[152:155],v[112:115],v[76:79],v[152:155]
s_and_b32 s26,s26,7
v_cvt_pk_bf16_f32 v48,v48,v49
ds_read_b64_tr_b16 v[72:73],v5 offset:24576
ds_read_b64_tr_b16 v[74:75],v5 offset:25088
s_waitcnt lgkmcnt(8)
v_mfma_f32_16x16x32_bf16 v[128:131],v[120:123],v[40:43],v[128:131]
s_lshl_b32 s80,s26,19
ds_read_b64_tr_b16 v[76:77],v6 offset:24576
ds_read_b64_tr_b16 v[78:79],v6 offset:25088
v_mfma_f32_16x16x32_bf16 v[132:135],v[124:127],v[40:43],v[132:135]
s_add_u32 s80,s80,s29
v_cvt_pk_bf16_f32 v49,v50,v51
s_waitcnt lgkmcnt(8)
v_mfma_f32_16x16x32_bf16 v[140:143],v[124:127],v[44:47],v[140:143]
s_lshl_b32 s26,s26,12
s_add_u32 s88,s26,s24
v_mfma_f32_16x16x32_bf16 v[136:139],v[120:123],v[44:47],v[136:139]
s_add_u32 s26,s37,1
v_cvt_pk_bf16_f32 v50,v52,v53
ds_read_b64_tr_b16 v[40:41],v7 offset:24576
ds_read_b64_tr_b16 v[42:43],v7 offset:25088
s_waitcnt lgkmcnt(8)
v_mfma_f32_16x16x32_bf16 v[144:147],v[120:123],v[64:67],v[144:147]
s_and_b32 s26,s26,7
ds_read_b64_tr_b16 v[44:45],v8 offset:24576
ds_read_b64_tr_b16 v[46:47],v8 offset:25088
v_mfma_f32_16x16x32_bf16 v[148:151],v[124:127],v[64:67],v[148:151]
s_lshl_b32 s81,s26,19
v_cvt_pk_bf16_f32 v51,v54,v55
s_waitcnt lgkmcnt(8)
v_mfma_f32_16x16x32_bf16 v[156:159],v[124:127],v[68:71],v[156:159]
s_add_u32 s81,s81,s29
s_lshl_b32 s26,s26,12
v_mfma_f32_16x16x32_bf16 v[152:155],v[120:123],v[68:71],v[152:155]
s_add_u32 s89,s26,s24
buffer_store_dwordx4 v[48:51],v4,s[40:43],s57 offen offset:2048 sc1
ds_read_b64_tr_b16 v[64:65],v5 offset:28672
ds_read_b64_tr_b16 v[66:67],v5 offset:29184
s_setprio 0
s_waitcnt lgkmcnt(8)
v_mfma_f32_16x16x32_bf16 v[128:131],v[240:243],v[72:75],v[128:131]
s_add_u32 s26,s37,2
ds_read_b64_tr_b16 v[68:69],v6 offset:28672
ds_read_b64_tr_b16 v[70:71],v6 offset:29184
v_mfma_f32_16x16x32_bf16 v[132:135],v[244:247],v[72:75],v[132:135]
s_and_b32 s26,s26,7
v_cvt_pk_bf16_f32 v52,v56,v57
s_waitcnt lgkmcnt(8)
v_mfma_f32_16x16x32_bf16 v[140:143],v[244:247],v[76:79],v[140:143]
s_lshl_b32 s82,s26,19
s_add_u32 s82,s82,s29
v_mfma_f32_16x16x32_bf16 v[136:139],v[240:243],v[76:79],v[136:139]
s_lshl_b32 s26,s26,12
v_cvt_pk_bf16_f32 v53,v58,v59
ds_read_b64_tr_b16 v[72:73],v7 offset:28672
ds_read_b64_tr_b16 v[74:75],v7 offset:29184
s_waitcnt lgkmcnt(8)
v_mfma_f32_16x16x32_bf16 v[144:147],v[240:243],v[40:43],v[144:147]
s_add_u32 s90,s26,s24
ds_read_b64_tr_b16 v[76:77],v8 offset:28672
ds_read_b64_tr_b16 v[78:79],v8 offset:29184
v_mfma_f32_16x16x32_bf16 v[148:151],v[244:247],v[40:43],v[148:151]
s_add_u32 s26,s37,3
v_cvt_pk_bf16_f32 v54,v60,v61
s_waitcnt lgkmcnt(8)
v_mfma_f32_16x16x32_bf16 v[156:159],v[244:247],v[44:47],v[156:159]
s_and_b32 s26,s26,7
s_lshl_b32 s83,s26,19
v_mfma_f32_16x16x32_bf16 v[152:155],v[240:243],v[44:47],v[152:155]
s_add_u32 s83,s83,s29
v_cvt_pk_bf16_f32 v55,v62,v63
v_add_u32 v5,0xffff0000,v5
ds_read_b64_tr_b16 v[40:41],v5 offset:0
ds_read_b64_tr_b16 v[42:43],v5 offset:512
s_waitcnt lgkmcnt(8)
v_mfma_f32_16x16x32_bf16 v[128:131],v[248:251],v[64:67],v[128:131]
s_lshl_b32 s26,s26,12
v_add_u32 v6,0xffff0000,v6
ds_read_b64_tr_b16 v[44:45],v6 offset:0
ds_read_b64_tr_b16 v[46:47],v6 offset:512
v_mfma_f32_16x16x32_bf16 v[132:135],v[252:255],v[64:67],v[132:135]
s_add_u32 s91,s26,s24
buffer_store_dwordx4 v[52:55],v4,s[40:43],s57 offen offset:2176 sc1
s_waitcnt lgkmcnt(8)
v_mfma_f32_16x16x32_bf16 v[140:143],v[252:255],v[68:71],v[140:143]
v_mfma_f32_16x16x32_bf16 v[136:139],v[248:251],v[68:71],v[136:139]
s_add_u32 m0,s39,0
s_add_u32 s26,s80,0
buffer_load_dwordx4 v10,s[76:79],s26 offen lds
v_add_u32 v7,0xffff0000,v7
ds_read_b64_tr_b16 v[64:65],v7 offset:0
ds_read_b64_tr_b16 v[66:67],v7 offset:512
s_waitcnt lgkmcnt(8)
v_mfma_f32_16x16x32_bf16 v[144:147],v[248:251],v[72:75],v[144:147]
v_add_u32 v8,0xffff0000,v8
ds_read_b64_tr_b16 v[68:69],v8 offset:0
ds_read_b64_tr_b16 v[70:71],v8 offset:512
v_mfma_f32_16x16x32_bf16 v[148:151],v[252:255],v[72:75],v[148:151]
s_add_u32 m0,s39,1024
s_add_u32 s26,s80,32768
buffer_load_dwordx4 v10,s[76:79],s26 offen lds
s_waitcnt lgkmcnt(8)
v_mfma_f32_16x16x32_bf16 v[156:159],v[252:255],v[76:79],v[156:159]
v_mfma_f32_16x16x32_bf16 v[152:155],v[248:251],v[76:79],v[152:155]
s_waitcnt vmcnt(6)
s_cmp_lg_u32 s50,0
s_cbranch_scc1 L_xf_ok22
s_waitcnt vmcnt(6)
v_cmp_ne_u32 vcc,s96,v14
s_cbranch_vccnz L_xf_spin22
L_xf_ok22:
s_barrier
ds_read_b64_tr_b16 v[72:73],v5 offset:4096
ds_read_b64_tr_b16 v[74:75],v5 offset:4608
s_setprio 3
s_waitcnt lgkmcnt(8)
v_mfma_f32_16x16x32_bf16 v[160:163],v[80:83],v[40:43],v[160:163]
ds_read_b64_tr_b16 v[76:77],v6 offset:4096
ds_read_b64_tr_b16 v[78:79],v6 offset:4608
v_mfma_f32_16x16x32_bf16 v[164:167],v[84:87],v[40:43],v[164:167]
s_add_u32 m0,s39,16384
s_add_u32 s26,s81,0
buffer_load_dwordx4 v10,s[76:79],s26 offen lds
s_waitcnt lgkmcnt(8)
v_mfma_f32_16x16x32_bf16 v[172:175],v[84:87],v[44:47],v[172:175]
v_mfma_f32_16x16x32_bf16 v[168:171],v[80:83],v[44:47],v[168:171]
s_add_u32 m0,s39,17408
s_add_u32 s26,s81,32768
buffer_load_dwordx4 v10,s[76:79],s26 offen lds
ds_read_b64_tr_b16 v[40:41],v7 offset:4096
ds_read_b64_tr_b16 v[42:43],v7 offset:4608
s_waitcnt lgkmcnt(8)
v_mfma_f32_16x16x32_bf16 v[176:179],v[80:83],v[64:67],v[176:179]
ds_read_b64_tr_b16 v[44:45],v8 offset:4096
ds_read_b64_tr_b16 v[46:47],v8 offset:4608
v_mfma_f32_16x16x32_bf16 v[180:183],v[84:87],v[64:67],v[180:183]
s_add_u32 s54,s51,1
s_waitcnt lgkmcnt(8)
v_mfma_f32_16x16x32_bf16 v[188:191],v[84:87],v[68:71],v[188:191]
buffer_load_dwordx4 v[24:27],v2,s[8:11],s88 offen offset:0 sc1
v_mfma_f32_16x16x32_bf16 v[184:187],v[80:83],v[68:71],v[184:187]
s_lshr_b32 s57,s54,1
ds_read_b64_tr_b16 v[64:65],v5 offset:8192
ds_read_b64_tr_b16 v[66:67],v5 offset:8704
s_waitcnt lgkmcnt(8)
v_mfma_f32_16x16x32_bf16 v[160:163],v[88:91],v[72:75],v[160:163]
buffer_load_dwordx4 v[28:31],v2,s[8:11],s88 offen offset:1024 sc1
ds_read_b64_tr_b16 v[68:69],v6 offset:8192
ds_read_b64_tr_b16 v[70:71],v6 offset:8704
v_mfma_f32_16x16x32_bf16 v[164:167],v[92:95],v[72:75],v[164:167]
s_lshl_b32 s57,s57,20
s_waitcnt lgkmcnt(8)
v_mfma_f32_16x16x32_bf16 v[172:175],v[92:95],v[76:79],v[172:175]
buffer_load_dwordx4 v[32:35],v2,s[8:11],s88 offen offset:2048 sc1
v_mfma_f32_16x16x32_bf16 v[168:171],v[88:91],v[76:79],v[168:171]
s_and_b32 s54,s54,1
ds_read_b64_tr_b16 v[72:73],v7 offset:8192
ds_read_b64_tr_b16 v[74:75],v7 offset:8704
s_waitcnt lgkmcnt(8)
v_mfma_f32_16x16x32_bf16 v[176:179],v[88:91],v[40:43],v[176:179]
buffer_load_dwordx4 v[36:39],v2,s[8:11],s88 offen offset:3072 sc1
ds_read_b64_tr_b16 v[76:77],v8 offset:8192
ds_read_b64_tr_b16 v[78:79],v8 offset:8704
v_mfma_f32_16x16x32_bf16 v[180:183],v[92:95],v[40:43],v[180:183]
s_lshl_b32 s54,s54,12
s_waitcnt lgkmcnt(8)
v_mfma_f32_16x16x32_bf16 v[188:191],v[92:95],v[44:47],v[188:191]
v_mfma_f32_16x16x32_bf16 v[184:187],v[88:91],v[44:47],v[184:187]
s_add_u32 s57,s57,s54
ds_read_b64_tr_b16 v[40:41],v5 offset:12288
ds_read_b64_tr_b16 v[42:43],v5 offset:12800
s_waitcnt lgkmcnt(8)
v_mfma_f32_16x16x32_bf16 v[160:163],v[96:99],v[64:67],v[160:163]
buffer_load_dwordx4 v[48:51],v2,s[8:11],s89 offen offset:0 sc1
ds_read_b64_tr_b16 v[44:45],v6 offset:12288
ds_read_b64_tr_b16 v[46:47],v6 offset:12800
v_mfma_f32_16x16x32_bf16 v[164:167],v[100:103],v[64:67],v[164:167]
s_add_u32 s57,s57,16384
s_waitcnt lgkmcnt(8)
v_mfma_f32_16x16x32_bf16 v[172:175],v[100:103],v[68:71],v[172:175]
buffer_load_dwordx4 v[52:55],v2,s[8:11],s89 offen offset:1024 sc1
v_mfma_f32_16x16x32_bf16 v[168:171],v[96:99],v[68:71],v[168:171]
v_cvt_pk_bf16_f32 v128,v128,v129
ds_read_b64_tr_b16 v[64:65],v7 offset:12288
ds_read_b64_tr_b16 v[66:67],v7 offset:12800
s_waitcnt lgkmcnt(8)
v_mfma_f32_16x16x32_bf16 v[176:179],v[96:99],v[72:75],v[176:179]
buffer_load_dwordx4 v[56:59],v2,s[8:11],s89 offen offset:2048 sc1
ds_read_b64_tr_b16 v[68:69],v8 offset:12288
ds_read_b64_tr_b16 v[70:71],v8 offset:12800
v_mfma_f32_16x16x32_bf16 v[180:183],v[100:103],v[72:75],v[180:183]
v_cvt_pk_bf16_f32 v129,v130,v131
s_waitcnt lgkmcnt(8)
v_mfma_f32_16x16x32_bf16 v[188:191],v[100:103],v[76:79],v[188:191]
buffer_load_dwordx4 v[60:63],v2,s[8:11],s89 offen offset:3072 sc1
v_mfma_f32_16x16x32_bf16 v[184:187],v[96:99],v[76:79],v[184:187]
v_cvt_pk_bf16_f32 v130,v132,v133
ds_read_b64_tr_b16 v[72:73],v5 offset:16384
ds_read_b64_tr_b16 v[74:75],v5 offset:16896
s_waitcnt lgkmcnt(8)
v_mfma_f32_16x16x32_bf16 v[160:163],v[104:107],v[40:43],v[160:163]
ds_read_b64_tr_b16 v[76:77],v6 offset:16384
ds_read_b64_tr_b16 v[78:79],v6 offset:16896
v_mfma_f32_16x16x32_bf16 v[164:167],v[108:111],v[40:43],v[164:167]
v_cvt_pk_bf16_f32 v131,v134,v135
s_waitcnt lgkmcnt(8)
v_mfma_f32_16x16x32_bf16 v[172:175],v[108:111],v[44:47],v[172:175]
s_add_u32 m0,s39,32768
s_add_u32 s26,s82,0
buffer_load_dwordx4 v10,s[76:79],s26 offen lds
v_mfma_f32_16x16x32_bf16 v[168:171],v[104:107],v[44:47],v[168:171]
buffer_store_dwordx4 v[128:131],v4,s[40:43],s57 offen offset:0 sc1
ds_read_b64_tr_b16 v[40:41],v7 offset:16384
ds_read_b64_tr_b16 v[42:43],v7 offset:16896
s_waitcnt lgkmcnt(8)
v_mfma_f32_16x16x32_bf16 v[176:179],v[104:107],v[64:67],v[176:179]
s_add_u32 m0,s39,33792
s_add_u32 s26,s82,32768
buffer_load_dwordx4 v10,s[76:79],s26 offen lds
ds_read_b64_tr_b16 v[44:45],v8 offset:16384
ds_read_b64_tr_b16 v[46:47],v8 offset:16896
v_mfma_f32_16x16x32_bf16 v[180:183],v[108:111],v[64:67],v[180:183]
v_cvt_pk_bf16_f32 v132,v136,v137
s_waitcnt lgkmcnt(8)
v_mfma_f32_16x16x32_bf16 v[188:191],v[108:111],v[68:71],v[188:191]
v_mfma_f32_16x16x32_bf16 v[184:187],v[104:107],v[68:71],v[184:187]
v_cvt_pk_bf16_f32 v133,v138,v139
ds_read_b64_tr_b16 v[64:65],v5 offset:20480
ds_read_b64_tr_b16 v[66:67],v5 offset:20992
s_setprio 2
s_waitcnt lgkmcnt(8)
v_mfma_f32_16x16x32_bf16 v[160:163],v[112:115],v[72:75],v[160:163]
s_add_u32 m0,s39,49152
s_add_u32 s26,s83,0
buffer_load_dwordx4 v10,s[76:79],s26 offen lds
ds_read_b64_tr_b16 v[68:69],v6 offset:20480
ds_read_b64_tr_b16 v[70:71],v6 offset:20992
v_mfma_f32_16x16x32_bf16 v[164:167],v[116:119],v[72:75],v[164:167]
v_cvt_pk_bf16_f32 v134,v140,v141
s_waitcnt lgkmcnt(8)
v_mfma_f32_16x16x32_bf16 v[172:175],v[116:119],v[76:79],v[172:175]
s_add_u32 m0,s39,50176
s_add_u32 s26,s83,32768
buffer_load_dwordx4 v10,s[76:79],s26 offen lds
v_mfma_f32_16x16x32_bf16 v[168:171],v[112:115],v[76:79],v[168:171]
v_cvt_pk_bf16_f32 v135,v142,v143
ds_read_b64_tr_b16 v[72:73],v7 offset:20480
ds_read_b64_tr_b16 v[74:75],v7 offset:20992
s_waitcnt lgkmcnt(8)
v_mfma_f32_16x16x32_bf16 v[176:179],v[112:115],v[40:43],v[176:179]
ds_read_b64_tr_b16 v[76:77],v8 offset:20480
ds_read_b64_tr_b16 v[78:79],v8 offset:20992
v_mfma_f32_16x16x32_bf16 v[180:183],v[116:119],v[40:43],v[180:183]
buffer_store_dwordx4 v[132:135],v4,s[40:43],s57 offen offset:128 sc1
s_waitcnt lgkmcnt(8)
v_mfma_f32_16x16x32_bf16 v[188:191],v[116:119],v[44:47],v[188:191]
s_add_u32 s26,s37,4
v_mfma_f32_16x16x32_bf16 v[184:187],v[112:115],v[44:47],v[184:187]
s_and_b32 s26,s26,7
v_cvt_pk_bf16_f32 v144,v144,v145
ds_read_b64_tr_b16 v[40:41],v5 offset:24576
ds_read_b64_tr_b16 v[42:43],v5 offset:25088
s_waitcnt lgkmcnt(8)
v_mfma_f32_16x16x32_bf16 v[160:163],v[120:123],v[64:67],v[160:163]
s_lshl_b32 s84,s26,19
ds_read_b64_tr_b16 v[44:45],v6 offset:24576
ds_read_b64_tr_b16 v[46:47],v6 offset:25088
v_mfma_f32_16x16x32_bf16 v[164:167],v[124:127],v[64:67],v[164:167]
v_cvt_pk_bf16_f32 v145,v146,v147
s_waitcnt lgkmcnt(8)
v_mfma_f32_16x16x32_bf16 v[172:175],v[124:127],v[68:71],v[172:175]
s_add_u32 s84,s84,s29
v_mfma_f32_16x16x32_bf16 v[168:171],v[120:123],v[68:71],v[168:171]
s_lshl_b32 s26,s26,12
v_cvt_pk_bf16_f32 v146,v148,v149
ds_read_b64_tr_b16 v[64:65],v7 offset:24576
ds_read_b64_tr_b16 v[66:67],v7 offset:25088
s_waitcnt lgkmcnt(8)
v_mfma_f32_16x16x32_bf16 v[176:179],v[120:123],v[72:75],v[176:179]
s_add_u32 s92,s26,s24
ds_read_b64_tr_b16 v[68:69],v8 offset:24576
ds_read_b64_tr_b16 v[70:71],v8 offset:25088
v_mfma_f32_16x16x32_bf16 v[180:183],v[124:127],v[72:75],v[180:183]
v_cvt_pk_bf16_f32 v147,v150,v151
s_waitcnt lgkmcnt(8)
v_mfma_f32_16x16x32_bf16 v[188:191],v[124:127],v[76:79],v[188:191]
s_add_u32 s26,s37,5
v_mfma_f32_16x16x32_bf16 v[184:187],v[120:123],v[76:79],v[184:187]
buffer_store_dwordx4 v[144:147],v4,s[40:43],s57 offen offset:2048 sc1
ds_read_b64_tr_b16 v[72:73],v5 offset:28672
ds_read_b64_tr_b16 v[74:75],v5 offset:29184
s_waitcnt lgkmcnt(8)
v_mfma_f32_16x16x32_bf16 v[160:163],v[240:243],v[40:43],v[160:163]
s_and_b32 s26,s26,7
ds_read_b64_tr_b16 v[76:77],v6 offset:28672
ds_read_b64_tr_b16 v[78:79],v6 offset:29184
v_mfma_f32_16x16x32_bf16 v[164:167],v[244:247],v[40:43],v[164:167]
s_lshl_b32 s85,s26,19
v_cvt_pk_bf16_f32 v148,v152,v153
s_waitcnt lgkmcnt(8)
v_mfma_f32_16x16x32_bf16 v[172:175],v[244:247],v[44:47],v[172:175]
s_add_u32 s85,s85,s29
v_mfma_f32_16x16x32_bf16 v[168:171],v[240:243],v[44:47],v[168:171]
v_cvt_pk_bf16_f32 v149,v154,v155
ds_read_b64_tr_b16 v[40:41],v7 offset:28672
ds_read_b64_tr_b16 v[42:43],v7 offset:29184
s_waitcnt lgkmcnt(8)
v_mfma_f32_16x16x32_bf16 v[176:179],v[240:243],v[64:67],v[176:179]
s_lshl_b32 s26,s26,12
ds_read_b64_tr_b16 v[44:45],v8 offset:28672
ds_read_b64_tr_b16 v[46:47],v8 offset:29184
v_mfma_f32_16x16x32_bf16 v[180:183],v[244:247],v[64:67],v[180:183]
s_add_u32 s93,s26,s24
v_cvt_pk_bf16_f32 v150,v156,v157
s_waitcnt lgkmcnt(8)
v_mfma_f32_16x16x32_bf16 v[188:191],v[244:247],v[68:71],v[188:191]
s_add_u32 s26,s37,6
v_mfma_f32_16x16x32_bf16 v[184:187],v[240:243],v[68:71],v[184:187]
v_cvt_pk_bf16_f32 v151,v158,v159
ds_read_b64_tr_b16 v[64:65],v5 offset:32768
ds_read_b64_tr_b16 v[66:67],v5 offset:33280
s_waitcnt lgkmcnt(8)
v_mfma_f32_16x16x32_bf16 v[160:163],v[248:251],v[72:75],v[160:163]
s_and_b32 s26,s26,7
ds_read_b64_tr_b16 v[68:69],v6 offset:32768
ds_read_b64_tr_b16 v[70:71],v6 offset:33280
v_mfma_f32_16x16x32_bf16 v[164:167],v[252:255],v[72:75],v[164:167]
buffer_store_dwordx4 v[148:151],v4,s[40:43],s57 offen offset:2176 sc1
s_waitcnt lgkmcnt(8)
v_mfma_f32_16x16x32_bf16 v[172:175],v[252:255],v[76:79],v[172:175]
s_lshl_b32 s86,s26,19
v_mfma_f32_16x16x32_bf16 v[168:171],v[248:251],v[76:79],v[168:171]
s_add_u32 s86,s86,s29
ds_read_b64_tr_b16 v[72:73],v7 offset:32768
ds_read_b64_tr_b16 v[74:75],v7 offset:33280
s_waitcnt lgkmcnt(8)
v_mfma_f32_16x16x32_bf16 v[176:179],v[248:251],v[40:43],v[176:179]
ds_read_b64_tr_b16 v[76:77],v8 offset:32768
ds_read_b64_tr_b16 v[78:79],v8 offset:33280
v_mfma_f32_16x16x32_bf16 v[180:183],v[252:255],v[40:43],v[180:183]
s_lshl_b32 s26,s26,12
s_waitcnt lgkmcnt(8)
v_mfma_f32_16x16x32_bf16 v[188:191],v[252:255],v[44:47],v[188:191]
s_add_u32 s94,s26,s24
v_mfma_f32_16x16x32_bf16 v[184:187],v[248:251],v[44:47],v[184:187]
s_add_u32 s26,s37,7
ds_read_b64_tr_b16 v[40:41],v5 offset:36864
ds_read_b64_tr_b16 v[42:43],v5 offset:37376
s_setprio 1
s_waitcnt lgkmcnt(8)
v_mfma_f32_16x16x32_bf16 v[192:195],v[80:83],v[64:67],v[192:195]
ds_read_b64_tr_b16 v[44:45],v6 offset:36864
ds_read_b64_tr_b16 v[46:47],v6 offset:37376
v_mfma_f32_16x16x32_bf16 v[196:199],v[84:87],v[64:67],v[196:199]
s_and_b32 s26,s26,7
s_waitcnt lgkmcnt(8)
v_mfma_f32_16x16x32_bf16 v[204:207],v[84:87],v[68:71],v[204:207]
v_mfma_f32_16x16x32_bf16 v[200:203],v[80:83],v[68:71],v[200:203]
s_lshl_b32 s87,s26,19
ds_read_b64_tr_b16 v[64:65],v7 offset:36864
ds_read_b64_tr_b16 v[66:67],v7 offset:37376
s_waitcnt lgkmcnt(8)
v_mfma_f32_16x16x32_bf16 v[208:211],v[80:83],v[72:75],v[208:211]
s_add_u32 s87,s87,s29
ds_read_b64_tr_b16 v[68:69],v8 offset:36864
ds_read_b64_tr_b16 v[70:71],v8 offset:37376
v_mfma_f32_16x16x32_bf16 v[212:215],v[84:87],v[72:75],v[212:215]
s_lshl_b32 s26,s26,12
s_add_u32 s54,s51,2
s_waitcnt lgkmcnt(8)
v_mfma_f32_16x16x32_bf16 v[220:223],v[84:87],v[76:79],v[220:223]
s_add_u32 s95,s26,s24
v_mfma_f32_16x16x32_bf16 v[216:219],v[80:83],v[76:79],v[216:219]
s_lshr_b32 s57,s54,1
ds_read_b64_tr_b16 v[72:73],v5 offset:40960
ds_read_b64_tr_b16 v[74:75],v5 offset:41472
s_waitcnt lgkmcnt(8)
v_mfma_f32_16x16x32_bf16 v[192:195],v[88:91],v[40:43],v[192:195]
s_lshl_b32 s26,s18,1
ds_read_b64_tr_b16 v[76:77],v6 offset:40960
ds_read_b64_tr_b16 v[78:79],v6 offset:41472
v_mfma_f32_16x16x32_bf16 v[196:199],v[92:95],v[40:43],v[196:199]
s_sub_u32 s22,31,s26
s_lshl_b32 s57,s57,20
s_waitcnt lgkmcnt(8)
v_mfma_f32_16x16x32_bf16 v[204:207],v[92:95],v[44:47],v[204:207]
s_lshl_b32 s36,s17,20
v_mfma_f32_16x16x32_bf16 v[200:203],v[88:91],v[44:47],v[200:203]
s_and_b32 s54,s54,1
ds_read_b64_tr_b16 v[40:41],v7 offset:40960
ds_read_b64_tr_b16 v[42:43],v7 offset:41472
s_waitcnt lgkmcnt(8)
v_mfma_f32_16x16x32_bf16 v[208:211],v[88:91],v[64:67],v[208:211]
s_mov_b64 s[72:73],s[40:41]
ds_read_b64_tr_b16 v[44:45],v8 offset:40960
ds_read_b64_tr_b16 v[46:47],v8 offset:41472
v_mfma_f32_16x16x32_bf16 v[212:215],v[92:95],v[64:67],v[212:215]
s_lshl_b32 s54,s54,12
s_waitcnt lgkmcnt(8)
v_mfma_f32_16x16x32_bf16 v[220:223],v[92:95],v[68:71],v[220:223]
s_mov_b32 s74,268435456
v_mfma_f32_16x16x32_bf16 v[216:219],v[88:91],v[68:71],v[216:219]
s_mov_b32 s75,0x20000
s_add_u32 s57,s57,s54
ds_read_b64_tr_b16 v[64:65],v5 offset:45056
ds_read_b64_tr_b16 v[66:67],v5 offset:45568
s_waitcnt lgkmcnt(8)
v_mfma_f32_16x16x32_bf16 v[192:195],v[96:99],v[72:75],v[192:195]
s_mov_b32 s29,0
ds_read_b64_tr_b16 v[68:69],v6 offset:45056
ds_read_b64_tr_b16 v[70:71],v6 offset:45568
v_mfma_f32_16x16x32_bf16 v[196:199],v[100:103],v[72:75],v[196:199]
s_add_u32 s57,s57,16384
s_waitcnt lgkmcnt(8)
v_mfma_f32_16x16x32_bf16 v[204:207],v[100:103],v[76:79],v[204:207]
s_mov_b32 s24,0
v_mfma_f32_16x16x32_bf16 v[200:203],v[96:99],v[76:79],v[200:203]
s_lshl_b32 s26,s16,13
v_cvt_pk_bf16_f32 v160,v160,v161
ds_read_b64_tr_b16 v[72:73],v7 offset:45056
ds_read_b64_tr_b16 v[74:75],v7 offset:45568
s_waitcnt lgkmcnt(8)
v_mfma_f32_16x16x32_bf16 v[208:211],v[96:99],v[40:43],v[208:211]
s_add_u32 s25,s36,s26
ds_read_b64_tr_b16 v[76:77],v8 offset:45056
ds_read_b64_tr_b16 v[78:79],v8 offset:45568
v_mfma_f32_16x16x32_bf16 v[212:215],v[100:103],v[40:43],v[212:215]
v_cvt_pk_bf16_f32 v161,v162,v163
s_waitcnt lgkmcnt(8)
v_mfma_f32_16x16x32_bf16 v[220:223],v[100:103],v[44:47],v[220:223]
s_add_u32 s25,s25,16384
v_mfma_f32_16x16x32_bf16 v[216:219],v[96:99],v[44:47],v[216:219]
v_cvt_pk_bf16_f32 v162,v164,v165
ds_read_b64_tr_b16 v[40:41],v5 offset:49152
ds_read_b64_tr_b16 v[42:43],v5 offset:49664
s_waitcnt lgkmcnt(8)
v_mfma_f32_16x16x32_bf16 v[192:195],v[104:107],v[64:67],v[192:195]
s_mov_b32 s23,32768
ds_read_b64_tr_b16 v[44:45],v6 offset:49152
ds_read_b64_tr_b16 v[46:47],v6 offset:49664
v_mfma_f32_16x16x32_bf16 v[196:199],v[108:111],v[64:67],v[196:199]
s_mov_b32 s21,0
v_cvt_pk_bf16_f32 v163,v166,v167
s_waitcnt lgkmcnt(8)
v_mfma_f32_16x16x32_bf16 v[204:207],v[108:111],v[68:71],v[204:207]
s_sub_u32 s20,s19,1
v_mfma_f32_16x16x32_bf16 v[200:203],v[104:107],v[68:71],v[200:203]
buffer_store_dwordx4 v[160:163],v4,s[40:43],s57 offen offset:0 sc1
ds_read_b64_tr_b16 v[64:65],v7 offset:49152
ds_read_b64_tr_b16 v[66:67],v7 offset:49664
s_waitcnt lgkmcnt(8)
v_mfma_f32_16x16x32_bf16 v[208:211],v[104:107],v[72:75],v[208:211]
s_max_i32 s20,s20,0
ds_read_b64_tr_b16 v[68:69],v8 offset:49152
ds_read_b64_tr_b16 v[70:71],v8 offset:49664
v_mfma_f32_16x16x32_bf16 v[212:215],v[108:111],v[72:75],v[212:215]
v_cvt_pk_bf16_f32 v164,v168,v169
s_waitcnt lgkmcnt(8)
v_mfma_f32_16x16x32_bf16 v[220:223],v[108:111],v[76:79],v[220:223]
v_mfma_f32_16x16x32_bf16 v[216:219],v[104:107],v[76:79],v[216:219]
v_cvt_pk_bf16_f32 v165,v170,v171
ds_read_b64_tr_b16 v[72:73],v5 offset:53248
ds_read_b64_tr_b16 v[74:75],v5 offset:53760
s_setprio 0
s_waitcnt lgkmcnt(8)
v_mfma_f32_16x16x32_bf16 v[192:195],v[112:115],v[40:43],v[192:195]
ds_read_b64_tr_b16 v[76:77],v6 offset:53248
ds_read_b64_tr_b16 v[78:79],v6 offset:53760
v_mfma_f32_16x16x32_bf16 v[196:199],v[116:119],v[40:43],v[196:199]
v_cvt_pk_bf16_f32 v166,v172,v173
s_waitcnt lgkmcnt(8)
v_mfma_f32_16x16x32_bf16 v[204:207],v[116:119],v[44:47],v[204:207]
v_mfma_f32_16x16x32_bf16 v[200:203],v[112:115],v[44:47],v[200:203]
v_cvt_pk_bf16_f32 v167,v174,v175
ds_read_b64_tr_b16 v[40:41],v7 offset:53248
ds_read_b64_tr_b16 v[42:43],v7 offset:53760
s_waitcnt lgkmcnt(8)
v_mfma_f32_16x16x32_bf16 v[208:211],v[112:115],v[64:67],v[208:211]
ds_read_b64_tr_b16 v[44:45],v8 offset:53248
ds_read_b64_tr_b16 v[46:47],v8 offset:53760
v_mfma_f32_16x16x32_bf16 v[212:215],v[116:119],v[64:67],v[212:215]
buffer_store_dwordx4 v[164:167],v4,s[40:43],s57 offen offset:128 sc1
s_waitcnt lgkmcnt(8)
v_mfma_f32_16x16x32_bf16 v[220:223],v[116:119],v[68:71],v[220:223]
v_mfma_f32_16x16x32_bf16 v[216:219],v[112:115],v[68:71],v[216:219]
v_cvt_pk_bf16_f32 v176,v176,v177
ds_read_b64_tr_b16 v[64:65],v5 offset:57344
ds_read_b64_tr_b16 v[66:67],v5 offset:57856
s_waitcnt lgkmcnt(8)
v_mfma_f32_16x16x32_bf16 v[192:195],v[120:123],v[72:75],v[192:195]
ds_read_b64_tr_b16 v[68:69],v6 offset:57344
ds_read_b64_tr_b16 v[70:71],v6 offset:57856
v_mfma_f32_16x16x32_bf16 v[196:199],v[124:127],v[72:75],v[196:199]
v_cvt_pk_bf16_f32 v177,v178,v179
s_waitcnt lgkmcnt(8)
v_mfma_f32_16x16x32_bf16 v[204:207],v[124:127],v[76:79],v[204:207]
v_mfma_f32_16x16x32_bf16 v[200:203],v[120:123],v[76:79],v[200:203]
v_cvt_pk_bf16_f32 v178,v180,v181
ds_read_b64_tr_b16 v[72:73],v7 offset:57344
ds_read_b64_tr_b16 v[74:75],v7 offset:57856
s_waitcnt lgkmcnt(8)
v_mfma_f32_16x16x32_bf16 v[208:211],v[120:123],v[40:43],v[208:211]
ds_read_b64_tr_b16 v[76:77],v8 offset:57344
ds_read_b64_tr_b16 v[78:79],v8 offset:57856
v_mfma_f32_16x16x32_bf16 v[212:215],v[124:127],v[40:43],v[212:215]
v_cvt_pk_bf16_f32 v179,v182,v183
s_waitcnt lgkmcnt(8)
v_mfma_f32_16x16x32_bf16 v[220:223],v[124:127],v[44:47],v[220:223]
v_mfma_f32_16x16x32_bf16 v[216:219],v[120:123],v[44:47],v[216:219]
buffer_store_dwordx4 v[176:179],v4,s[40:43],s57 offen offset:2048 sc1
ds_read_b64_tr_b16 v[40:41],v5 offset:61440
ds_read_b64_tr_b16 v[42:43],v5 offset:61952
s_waitcnt lgkmcnt(8)
v_mfma_f32_16x16x32_bf16 v[192:195],v[240:243],v[64:67],v[192:195]
ds_read_b64_tr_b16 v[44:45],v6 offset:61440
ds_read_b64_tr_b16 v[46:47],v6 offset:61952
v_mfma_f32_16x16x32_bf16 v[196:199],v[244:247],v[64:67],v[196:199]
v_cvt_pk_bf16_f32 v180,v184,v185
s_waitcnt lgkmcnt(8)
v_mfma_f32_16x16x32_bf16 v[204:207],v[244:247],v[68:71],v[204:207]
v_mfma_f32_16x16x32_bf16 v[200:203],v[240:243],v[68:71],v[200:203]
v_cvt_pk_bf16_f32 v181,v186,v187
ds_read_b64_tr_b16 v[64:65],v7 offset:61440
ds_read_b64_tr_b16 v[66:67],v7 offset:61952
s_waitcnt lgkmcnt(8)
v_mfma_f32_16x16x32_bf16 v[208:211],v[240:243],v[72:75],v[208:211]
ds_read_b64_tr_b16 v[68:69],v8 offset:61440
ds_read_b64_tr_b16 v[70:71],v8 offset:61952
v_mfma_f32_16x16x32_bf16 v[212:215],v[244:247],v[72:75],v[212:215]
v_cvt_pk_bf16_f32 v182,v188,v189
s_waitcnt lgkmcnt(8)
v_mfma_f32_16x16x32_bf16 v[220:223],v[244:247],v[76:79],v[220:223]
v_mfma_f32_16x16x32_bf16 v[216:219],v[240:243],v[76:79],v[216:219]
v_cvt_pk_bf16_f32 v183,v190,v191
s_waitcnt lgkmcnt(6)
v_mfma_f32_16x16x32_bf16 v[192:195],v[248:251],v[40:43],v[192:195]
v_mfma_f32_16x16x32_bf16 v[196:199],v[252:255],v[40:43],v[196:199]
buffer_store_dwordx4 v[180:183],v4,s[40:43],s57 offen offset:2176 sc1
s_waitcnt lgkmcnt(4)
v_mfma_f32_16x16x32_bf16 v[204:207],v[252:255],v[44:47],v[204:207]
v_mfma_f32_16x16x32_bf16 v[200:203],v[248:251],v[44:47],v[200:203]
s_waitcnt lgkmcnt(2)
v_mfma_f32_16x16x32_bf16 v[208:211],v[248:251],v[64:67],v[208:211]
v_mfma_f32_16x16x32_bf16 v[212:215],v[252:255],v[64:67],v[212:215]
s_waitcnt lgkmcnt(0)
v_mfma_f32_16x16x32_bf16 v[220:223],v[252:255],v[68:71],v[220:223]
v_mfma_f32_16x16x32_bf16 v[216:219],v[248:251],v[68:71],v[216:219]
s_nop 1
s_add_u32 s54,s51,3
s_lshr_b32 s57,s54,1
s_lshl_b32 s57,s57,20
s_and_b32 s54,s54,1
s_lshl_b32 s54,s54,12
s_add_u32 s57,s57,s54
s_add_u32 s57,s57,16384
v_cvt_pk_bf16_f32 v192,v192,v193
v_cvt_pk_bf16_f32 v193,v194,v195
v_cvt_pk_bf16_f32 v194,v196,v197
v_cvt_pk_bf16_f32 v195,v198,v199
buffer_store_dwordx4 v[192:195],v4,s[40:43],s57 offen offset:0 sc1
v_cvt_pk_bf16_f32 v196,v200,v201
v_cvt_pk_bf16_f32 v197,v202,v203
v_cvt_pk_bf16_f32 v198,v204,v205
v_cvt_pk_bf16_f32 v199,v206,v207
buffer_store_dwordx4 v[196:199],v4,s[40:43],s57 offen offset:128 sc1
v_cvt_pk_bf16_f32 v208,v208,v209
v_cvt_pk_bf16_f32 v209,v210,v211
v_cvt_pk_bf16_f32 v210,v212,v213
v_cvt_pk_bf16_f32 v211,v214,v215
buffer_store_dwordx4 v[208:211],v4,s[40:43],s57 offen offset:2048 sc1
v_cvt_pk_bf16_f32 v212,v216,v217
v_cvt_pk_bf16_f32 v213,v218,v219
v_cvt_pk_bf16_f32 v214,v220,v221
v_cvt_pk_bf16_f32 v215,v222,v223
buffer_store_dwordx4 v[212:215],v4,s[40:43],s57 offen offset:2176 sc1
s_waitcnt vmcnt(11)
s_branch L_k1_end2
L_k1_tramp:
s_branch L_k1_entry
L_k1_end2:
s_cmp_lg_u32 s3,s2
s_cbranch_scc1 L_help_done
L_k2_late:
v_lshrrev_b32 v17,4,v1
v_bfe_u32 v18,v1,2,2
v_lshl_add_u32 v19,v17,3,v18
v_lshlrev_b32 v19,8,v19
v_lshl_add_u32 v19,v18,6,v19
v_bfe_u32 v18,v1,4,1
v_lshl_add_u32 v19,v18,5,v19
v_and_b32 v18,1,v1
v_lshl_add_u32 v19,v18,4,v19
v_and_b32 v18,2,v1
v_lshl_add_u32 v40,v18,2,v19
v_xor_b32 v41,32,v40
v_xor_b32 v42,64,v40
v_xor_b32 v43,96,v40
v_xor_b32 v248,128,v40
v_xor_b32 v249,160,v40
v_xor_b32 v250,192,v40
v_xor_b32 v251,224,v40

s_cmp_eq_u32 s28,0
s_cbranch_scc1 L_k2_q1
s_barrier
ds_read_b64_tr_b16 v[192:193],v40 offset:0
ds_read_b64_tr_b16 v[194:195],v40 offset:1024
ds_read_b64_tr_b16 v[196:197],v41 offset:0
ds_read_b64_tr_b16 v[198:199],v41 offset:1024
ds_read_b64_tr_b16 v[200:201],v42 offset:0
ds_read_b64_tr_b16 v[202:203],v42 offset:1024
ds_read_b64_tr_b16 v[204:205],v43 offset:0
ds_read_b64_tr_b16 v[206:207],v43 offset:1024
ds_read_b64_tr_b16 v[208:209],v248 offset:0
ds_read_b64_tr_b16 v[210:211],v248 offset:1024
s_setprio 3
s_waitcnt lgkmcnt(8)
v_mfma_f32_16x16x32_bf16 v[128:131],v[192:195],v[24:27],0
ds_read_b64_tr_b16 v[212:213],v249 offset:0
ds_read_b64_tr_b16 v[214:215],v249 offset:1024
v_mfma_f32_16x16x32_bf16 v[132:135],v[192:195],v[28:31],0
s_add_u32 m0,s39,65536
s_add_u32 s26,s84,0
buffer_load_dwordx4 v10,s[76:79],s26 offen lds
s_waitcnt lgkmcnt(8)
v_mfma_f32_16x16x32_bf16 v[140:143],v[196:199],v[28:31],0
s_add_u32 m0,s39,66560
s_add_u32 s26,s84,32768
buffer_load_dwordx4 v10,s[76:79],s26 offen lds
v_mfma_f32_16x16x32_bf16 v[136:139],v[196:199],v[24:27],0
v_mov_b32 v14,131072
v_mov_b32 v15,0
ds_write_b32 v14,v15
ds_read_b64_tr_b16 v[216:217],v250 offset:0
ds_read_b64_tr_b16 v[218:219],v250 offset:1024
s_waitcnt lgkmcnt(9)
v_mfma_f32_16x16x32_bf16 v[144:147],v[200:203],v[24:27],0
buffer_load_dwordx4 v[232:235],v2,s[8:11],s90 offen offset:0 sc1
ds_read_b64_tr_b16 v[220:221],v251 offset:0
ds_read_b64_tr_b16 v[222:223],v251 offset:1024
v_mfma_f32_16x16x32_bf16 v[148:151],v[200:203],v[28:31],0
v_bfe_u32 v16,v1,3,1
s_lshl_b32 s26,s17,1
v_add_u32 v16,s26,v16
v_mul_u32_u24 v16,205,v16
v_lshrrev_b32 v16,10,v16
v_bfe_u32 v17,v1,4,1
v_mul_u32_u24 v17,13,v17
v_add_u32 v16,v16,v17
v_lshlrev_b32 v16,8,v16
v_add_u32 v16,101777408,v16
s_waitcnt lgkmcnt(9)
v_mfma_f32_16x16x32_bf16 v[156:159],v[204:207],v[28:31],0
buffer_load_dwordx4 v[236:239],v2,s[8:11],s90 offen offset:1024 sc1
v_mfma_f32_16x16x32_bf16 v[152:155],v[204:207],v[24:27],0
s_and_b32 s26,s2,7
s_lshl_b32 s26,s26,8
s_add_u32 s26,s26,101785600
v_mov_b32 v17,s26
v_cmp_gt_u32 vcc,32,v1
v_min_u32 v253,47,v1
v_lshl_add_u32 v253,v253,2,v17
v_cndmask_b32 v16,v17,v16,vcc
v_and_b32 v17,7,v1
v_lshl_add_u32 v4,v17,2,v16
ds_read_b64_tr_b16 v[224:225],v40 offset:8192
ds_read_b64_tr_b16 v[226:227],v40 offset:9216
s_waitcnt lgkmcnt(9)
v_mfma_f32_16x16x32_bf16 v[160:163],v[208:211],v[24:27],0
ds_read_b64_tr_b16 v[228:229],v41 offset:8192
ds_read_b64_tr_b16 v[230:231],v41 offset:9216
v_mfma_f32_16x16x32_bf16 v[164:167],v[208:211],v[28:31],0
v_and_b32 v16,31,v1
s_waitcnt lgkmcnt(9)
v_mfma_f32_16x16x32_bf16 v[172:175],v[212:215],v[28:31],0
buffer_load_dwordx4 v[240:243],v2,s[8:11],s90 offen offset:2048 sc1
v_mfma_f32_16x16x32_bf16 v[168:171],v[212:215],v[24:27],0
v_lshlrev_b32 v252,2,v16
ds_read_b64_tr_b16 v[192:193],v42 offset:8192
ds_read_b64_tr_b16 v[194:195],v42 offset:9216
s_waitcnt lgkmcnt(8)
v_mfma_f32_16x16x32_bf16 v[176:179],v[216:219],v[24:27],0
buffer_load_dwordx4 v[244:247],v2,s[8:11],s90 offen offset:3072 sc1
ds_read_b64_tr_b16 v[196:197],v43 offset:8192
ds_read_b64_tr_b16 v[198:199],v43 offset:9216
v_mfma_f32_16x16x32_bf16 v[180:183],v[216:219],v[28:31],0
v_lshrrev_b32 v17,5,v1
s_waitcnt lgkmcnt(8)
v_mfma_f32_16x16x32_bf16 v[188:191],v[220:223],v[28:31],0
s_add_u32 m0,s39,81920
s_add_u32 s26,s85,0
buffer_load_dwordx4 v10,s[76:79],s26 offen lds
v_mfma_f32_16x16x32_bf16 v[184:187],v[220:223],v[24:27],0
v_lshlrev_b32 v17,2,v17
ds_read_b64_tr_b16 v[200:201],v248 offset:8192
ds_read_b64_tr_b16 v[202:203],v248 offset:9216
s_setprio 2
s_waitcnt lgkmcnt(8)
v_mfma_f32_16x16x32_bf16 v[128:131],v[224:227],v[32:35],v[128:131]
s_add_u32 m0,s39,82944
s_add_u32 s26,s85,32768
buffer_load_dwordx4 v10,s[76:79],s26 offen lds
ds_read_b64_tr_b16 v[204:205],v249 offset:8192
ds_read_b64_tr_b16 v[206:207],v249 offset:9216
v_mfma_f32_16x16x32_bf16 v[132:135],v[224:227],v[36:39],v[132:135]
v_sub_u32 v16,v16,v17
s_waitcnt lgkmcnt(8)
v_mfma_f32_16x16x32_bf16 v[140:143],v[228:231],v[36:39],v[140:143]
v_mfma_f32_16x16x32_bf16 v[136:139],v[228:231],v[32:35],v[136:139]
v_mov_b32 v9,0xf149f2ca
ds_read_b64_tr_b16 v[208:209],v250 offset:8192
ds_read_b64_tr_b16 v[210:211],v250 offset:9216
s_waitcnt lgkmcnt(8)
v_mfma_f32_16x16x32_bf16 v[144:147],v[192:195],v[32:35],v[144:147]
ds_read_b64_tr_b16 v[212:213],v251 offset:8192
ds_read_b64_tr_b16 v[214:215],v251 offset:9216
v_mfma_f32_16x16x32_bf16 v[148:151],v[192:195],v[36:39],v[148:151]
v_mov_b32 v13,0x4b800000
s_waitcnt lgkmcnt(8)
v_mfma_f32_16x16x32_bf16 v[156:159],v[196:199],v[36:39],v[156:159]
v_mfma_f32_16x16x32_bf16 v[152:155],v[196:199],v[32:35],v[152:155]
v_mov_b32 v7,0
ds_read_b64_tr_b16 v[216:217],v40 offset:16384
ds_read_b64_tr_b16 v[218:219],v40 offset:17408
s_waitcnt lgkmcnt(8)
v_mfma_f32_16x16x32_bf16 v[160:163],v[200:203],v[32:35],v[160:163]
ds_read_b64_tr_b16 v[220:221],v41 offset:16384
ds_read_b64_tr_b16 v[222:223],v41 offset:17408
v_mfma_f32_16x16x32_bf16 v[164:167],v[200:203],v[36:39],v[164:167]
v_add_u32 v3,131072,v2
s_waitcnt lgkmcnt(8)
v_mfma_f32_16x16x32_bf16 v[172:175],v[204:207],v[36:39],v[172:175]
v_mfma_f32_16x16x32_bf16 v[168:171],v[204:207],v[32:35],v[168:171]
v_cmp_gt_i32 s[40:41],0,v16
ds_read_b64_tr_b16 v[224:225],v42 offset:16384
ds_read_b64_tr_b16 v[226:227],v42 offset:17408
s_waitcnt lgkmcnt(8)
v_mfma_f32_16x16x32_bf16 v[176:179],v[208:211],v[32:35],v[176:179]
ds_read_b64_tr_b16 v[228:229],v43 offset:16384
ds_read_b64_tr_b16 v[230:231],v43 offset:17408
v_mfma_f32_16x16x32_bf16 v[180:183],v[208:211],v[36:39],v[180:183]
v_cmp_gt_i32 s[42:43],1,v16
s_waitcnt lgkmcnt(8)
v_mfma_f32_16x16x32_bf16 v[188:191],v[212:215],v[36:39],v[188:191]
v_mfma_f32_16x16x32_bf16 v[184:187],v[212:215],v[32:35],v[184:187]
ds_read_b64_tr_b16 v[192:193],v248 offset:16384
ds_read_b64_tr_b16 v[194:195],v248 offset:17408
s_setprio 1
s_waitcnt lgkmcnt(8)
s_waitcnt vmcnt(11)
v_mfma_f32_16x16x32_bf16 v[128:131],v[216:219],v[48:51],v[128:131]
ds_read_b64_tr_b16 v[196:197],v249 offset:16384
ds_read_b64_tr_b16 v[198:199],v249 offset:17408
s_waitcnt vmcnt(10)
v_mfma_f32_16x16x32_bf16 v[132:135],v[216:219],v[52:55],v[132:135]
buffer_load_dwordx4 v[24:27],v2,s[8:11],s91 offen offset:0 sc1
s_waitcnt lgkmcnt(8)
v_mfma_f32_16x16x32_bf16 v[140:143],v[220:223],v[52:55],v[140:143]
buffer_load_dwordx4 v[28:31],v2,s[8:11],s91 offen offset:1024 sc1
v_mfma_f32_16x16x32_bf16 v[136:139],v[220:223],v[48:51],v[136:139]
v_cmp_gt_i32 s[44:45],2,v16
v_cmp_gt_i32 s[46:47],3,v16
ds_read_b64_tr_b16 v[200:201],v250 offset:16384
ds_read_b64_tr_b16 v[202:203],v250 offset:17408
s_waitcnt lgkmcnt(8)
v_mfma_f32_16x16x32_bf16 v[144:147],v[224:227],v[48:51],v[144:147]
v_cmp_gt_i32 s[48:49],8,v16
ds_read_b64_tr_b16 v[204:205],v251 offset:16384
ds_read_b64_tr_b16 v[206:207],v251 offset:17408
v_mfma_f32_16x16x32_bf16 v[148:151],v[224:227],v[52:55],v[148:151]
v_cmp_gt_i32 s[50:51],9,v16
s_waitcnt lgkmcnt(8)
v_mfma_f32_16x16x32_bf16 v[156:159],v[228:231],v[52:55],v[156:159]
buffer_load_dwordx4 v[32:35],v2,s[8:11],s91 offen offset:2048 sc1
v_mfma_f32_16x16x32_bf16 v[152:155],v[228:231],v[48:51],v[152:155]
v_cmp_gt_i32 s[52:53],10,v16
v_cmp_gt_i32 s[54:55],11,v16
ds_read_b64_tr_b16 v[208:209],v40 offset:24576
ds_read_b64_tr_b16 v[210:211],v40 offset:25600
s_waitcnt lgkmcnt(8)
v_mfma_f32_16x16x32_bf16 v[160:163],v[192:195],v[48:51],v[160:163]
v_cmp_gt_i32 s[56:57],16,v16
ds_read_b64_tr_b16 v[212:213],v41 offset:24576
ds_read_b64_tr_b16 v[214:215],v41 offset:25600
v_mfma_f32_16x16x32_bf16 v[164:167],v[192:195],v[52:55],v[164:167]
v_cmp_gt_i32 s[58:59],17,v16
s_waitcnt lgkmcnt(8)
v_mfma_f32_16x16x32_bf16 v[172:175],v[196:199],v[52:55],v[172:175]
buffer_load_dwordx4 v[36:39],v2,s[8:11],s91 offen offset:3072 sc1
v_mfma_f32_16x16x32_bf16 v[168:171],v[196:199],v[48:51],v[168:171]
v_cmp_gt_i32 s[60:61],18,v16
v_cmp_gt_i32 s[62:63],19,v16
ds_read_b64_tr_b16 v[216:217],v42 offset:24576
ds_read_b64_tr_b16 v[218:219],v42 offset:25600
s_waitcnt lgkmcnt(8)
v_mfma_f32_16x16x32_bf16 v[176:179],v[200:203],v[48:51],v[176:179]
s_add_u32 m0,s39,98304
s_add_u32 s26,s86,0
buffer_load_dwordx4 v10,s[76:79],s26 offen lds
ds_read_b64_tr_b16 v[220:221],v43 offset:24576
ds_read_b64_tr_b16 v[222:223],v43 offset:25600
v_mfma_f32_16x16x32_bf16 v[180:183],v[200:203],v[52:55],v[180:183]
v_cmp_gt_i32 s[64:65],24,v16
v_cmp_gt_i32 s[66:67],25,v16
s_waitcnt lgkmcnt(8)
v_mfma_f32_16x16x32_bf16 v[188:191],v[204:207],v[52:55],v[188:191]
v_cmp_gt_i32 s[68:69],26,v16
v_mfma_f32_16x16x32_bf16 v[184:187],v[204:207],v[48:51],v[184:187]
v_cmp_gt_i32 s[70:71],27,v16
ds_read_b64_tr_b16 v[224:225],v248 offset:24576
ds_read_b64_tr_b16 v[226:227],v248 offset:25600
s_setprio 0
s_waitcnt lgkmcnt(8)
s_waitcnt vmcnt(14)
v_mfma_f32_16x16x32_bf16 v[128:131],v[208:211],v[56:59],v[128:131]
s_add_u32 m0,s39,99328
s_add_u32 s26,s86,32768
buffer_load_dwordx4 v10,s[76:79],s26 offen lds
ds_read_b64_tr_b16 v[228:229],v249 offset:24576
ds_read_b64_tr_b16 v[230:231],v249 offset:25600
s_waitcnt vmcnt(14)
v_mfma_f32_16x16x32_bf16 v[132:135],v[208:211],v[60:63],v[132:135]
s_and_b32 s26,s2,7
s_lshl_b32 s33,s26,19
s_bfe_u32 s27,s2,0x20003
s_mul_i32 s27,s27,131328
s_add_u32 s33,s33,s27
s_and_b32 s27,s16,3
s_lshl_b32 s27,s27,15
s_add_u32 s33,s33,s27
s_lshl_b32 s26,s26,4
v_and_b32 v254,3,v1
v_lshl_add_u32 v254,v254,2,s26
s_lshr_b32 s6,s2,5
s_lshl_b32 s6,s6,2
s_add_u32 s6,s6,s16
s_sub_u32 s27,67,s6
s_cmp_lt_u32 s16,4
s_cselect_b32 s6,s6,s27
s_lshl_b32 s26,s6,7
s_add_u32 s26,s26,101789696
v_add_u32 v254,s26,v254
s_sub_u32 s27,63,s6
s_min_u32 s27,s27,s6
s_lshr_b32 s27,s27,1
s_lshl_b32 s27,s27,7
s_add_u32 s27,s27,101797888
s_sub_u32 s27,s27,s26
v_bfe_u32 v16,v1,2,1
v_mad_u32_u24 v254,v16,s27,v254
s_waitcnt lgkmcnt(8)
v_mfma_f32_16x16x32_bf16 v[140:143],v[212:215],v[60:63],v[140:143]
v_lshrrev_b32 v255,4,v1
v_lshlrev_b32 v16,2,v255
v_and_b32 v17,15,v1
v_xor_b32 v16,v16,v17
v_lshlrev_b32 v16,4,v16
v_lshl_add_u32 v255,v255,10,v16
v_mfma_f32_16x16x32_bf16 v[136:139],v[212:215],v[56:59],v[136:139]
v_mov_b32 v64,0
ds_read_b64_tr_b16 v[192:193],v250 offset:24576
ds_read_b64_tr_b16 v[194:195],v250 offset:25600
s_waitcnt lgkmcnt(8)
v_mfma_f32_16x16x32_bf16 v[144:147],v[216:219],v[56:59],v[144:147]
v_mov_b32 v65,0
ds_read_b64_tr_b16 v[196:197],v251 offset:24576
ds_read_b64_tr_b16 v[198:199],v251 offset:25600
v_mfma_f32_16x16x32_bf16 v[148:151],v[216:219],v[60:63],v[148:151]
v_mov_b32 v66,0
s_waitcnt lgkmcnt(8)
v_mfma_f32_16x16x32_bf16 v[156:159],v[220:223],v[60:63],v[156:159]
v_mov_b32 v67,0
v_mfma_f32_16x16x32_bf16 v[152:155],v[220:223],v[56:59],v[152:155]
v_mov_b32 v68,0
ds_read_b64_tr_b16 v[200:201],v40 offset:32768
ds_read_b64_tr_b16 v[202:203],v40 offset:33792
s_waitcnt lgkmcnt(8)
v_mfma_f32_16x16x32_bf16 v[160:163],v[224:227],v[56:59],v[160:163]
v_mov_b32 v69,0
ds_read_b64_tr_b16 v[204:205],v41 offset:32768
ds_read_b64_tr_b16 v[206:207],v41 offset:33792
v_mfma_f32_16x16x32_bf16 v[164:167],v[224:227],v[60:63],v[164:167]
v_mov_b32 v70,0
s_waitcnt lgkmcnt(8)
v_mfma_f32_16x16x32_bf16 v[172:175],v[228:231],v[60:63],v[172:175]
v_mov_b32 v71,0
v_mfma_f32_16x16x32_bf16 v[168:171],v[228:231],v[56:59],v[168:171]
v_mov_b32 v72,0
ds_read_b64_tr_b16 v[208:209],v42 offset:32768
ds_read_b64_tr_b16 v[210:211],v42 offset:33792
s_waitcnt lgkmcnt(8)
v_mfma_f32_16x16x32_bf16 v[176:179],v[192:195],v[56:59],v[176:179]
v_mov_b32 v73,0
ds_read_b64_tr_b16 v[212:213],v43 offset:32768
ds_read_b64_tr_b16 v[214:215],v43 offset:33792
v_mfma_f32_16x16x32_bf16 v[180:183],v[192:195],v[60:63],v[180:183]
v_mov_b32 v74,0
s_waitcnt lgkmcnt(8)
v_mfma_f32_16x16x32_bf16 v[188:191],v[196:199],v[60:63],v[188:191]
v_mov_b32 v75,0
v_mfma_f32_16x16x32_bf16 v[184:187],v[196:199],v[56:59],v[184:187]
v_mov_b32 v76,0
s_waitcnt vmcnt(6)
s_barrier
ds_read_b64_tr_b16 v[216:217],v248 offset:32768
ds_read_b64_tr_b16 v[218:219],v248 offset:33792
s_setprio 3
s_waitcnt lgkmcnt(8)
v_mfma_f32_16x16x32_bf16 v[128:131],v[200:203],v[232:235],v[128:131]
ds_read_b64_tr_b16 v[220:221],v249 offset:32768
ds_read_b64_tr_b16 v[222:223],v249 offset:33792
v_mfma_f32_16x16x32_bf16 v[132:135],v[200:203],v[236:239],v[132:135]
s_cmp_lg_u32 s16,0
s_cbranch_scc1 L_sig3
s_and_b32 s26,s3,7
s_lshl_b32 s26,s26,2
s_bfe_u32 s27,s3,0x20003
s_add_u32 s26,s26,s27
v_lshlrev_b32 v18,8,v1
v_mov_b32 v15,s96
s_cmp_lt_u32 s26,26
s_cselect_b32 s27,8,5
s_lshl_b32 s26,s26,s27
s_cmp_eq_u32 s27,8
s_cselect_b32 s27,0,7360
s_cselect_b64 exec,1,0xff
s_add_u32 s26,s26,s27
s_add_u32 s26,s26,101777408
s_lshr_b32 s27,s3,5
s_lshl_b32 s27,s27,2
s_add_u32 s26,s26,s27
buffer_store_dword v15,v18,s[8:11],s26 offen sc1
s_mov_b64 exec,-1
L_sig3:
s_waitcnt lgkmcnt(8)
v_mfma_f32_16x16x32_bf16 v[140:143],v[204:207],v[236:239],v[140:143]
buffer_load_dwordx4 v[48:51],v2,s[8:11],s92 offen offset:0 sc1
v_mfma_f32_16x16x32_bf16 v[136:139],v[204:207],v[232:235],v[136:139]
v_mov_b32 v77,0
v_mov_b32 v78,0
ds_read_b64_tr_b16 v[224:225],v250 offset:32768
ds_read_b64_tr_b16 v[226:227],v250 offset:33792
s_waitcnt lgkmcnt(8)
v_mfma_f32_16x16x32_bf16 v[144:147],v[208:211],v[232:235],v[144:147]
buffer_load_dwordx4 v[52:55],v2,s[8:11],s92 offen offset:1024 sc1
ds_read_b64_tr_b16 v[228:229],v251 offset:32768
ds_read_b64_tr_b16 v[230:231],v251 offset:33792
v_mfma_f32_16x16x32_bf16 v[148:151],v[208:211],v[236:239],v[148:151]
v_mov_b32 v79,0
v_mov_b32 v80,0
s_waitcnt lgkmcnt(8)
v_mfma_f32_16x16x32_bf16 v[156:159],v[212:215],v[236:239],v[156:159]
buffer_load_dwordx4 v[56:59],v2,s[8:11],s92 offen offset:2048 sc1
v_mfma_f32_16x16x32_bf16 v[152:155],v[212:215],v[232:235],v[152:155]
v_mov_b32 v81,0
v_mov_b32 v82,0
ds_read_b64_tr_b16 v[192:193],v40 offset:40960
ds_read_b64_tr_b16 v[194:195],v40 offset:41984
s_waitcnt lgkmcnt(8)
v_mfma_f32_16x16x32_bf16 v[160:163],v[216:219],v[232:235],v[160:163]
v_mov_b32 v83,0
ds_read_b64_tr_b16 v[196:197],v41 offset:40960
ds_read_b64_tr_b16 v[198:199],v41 offset:41984
v_mfma_f32_16x16x32_bf16 v[164:167],v[216:219],v[236:239],v[164:167]
v_mov_b32 v84,0
s_waitcnt lgkmcnt(8)
v_mfma_f32_16x16x32_bf16 v[172:175],v[220:223],v[236:239],v[172:175]
buffer_load_dwordx4 v[60:63],v2,s[8:11],s92 offen offset:3072 sc1
v_mfma_f32_16x16x32_bf16 v[168:171],v[220:223],v[232:235],v[168:171]
v_mov_b32 v85,0
v_mov_b32 v86,0
ds_read_b64_tr_b16 v[200:201],v42 offset:40960
ds_read_b64_tr_b16 v[202:203],v42 offset:41984
s_waitcnt lgkmcnt(8)
v_mfma_f32_16x16x32_bf16 v[176:179],v[224:227],v[232:235],v[176:179]
s_add_u32 m0,s39,114688
s_add_u32 s26,s87,0
buffer_load_dwordx4 v10,s[76:79],s26 offen lds
ds_read_b64_tr_b16 v[204:205],v43 offset:40960
ds_read_b64_tr_b16 v[206:207],v43 offset:41984
v_mfma_f32_16x16x32_bf16 v[180:183],v[224:227],v[236:239],v[180:183]
v_mov_b32 v87,0
v_mov_b32 v88,0
s_waitcnt lgkmcnt(8)
v_mfma_f32_16x16x32_bf16 v[188:191],v[228:231],v[236:239],v[188:191]
s_add_u32 m0,s39,115712
s_add_u32 s26,s87,32768
buffer_load_dwordx4 v10,s[76:79],s26 offen lds
v_mfma_f32_16x16x32_bf16 v[184:187],v[228:231],v[232:235],v[184:187]
v_mov_b32 v89,0
v_mov_b32 v90,0
ds_read_b64_tr_b16 v[208:209],v248 offset:40960
ds_read_b64_tr_b16 v[210:211],v248 offset:41984
s_waitcnt lgkmcnt(8)
v_mfma_f32_16x16x32_bf16 v[128:131],v[192:195],v[240:243],v[128:131]
s_cmp_lg_u32 s16,0
s_cbranch_scc1 L_k2_ntb
v_mov_b32 v15,s96
ds_write_b32 v14,v15 offset:4
L_k2_ntb:
ds_read_b64_tr_b16 v[212:213],v249 offset:40960
ds_read_b64_tr_b16 v[214:215],v249 offset:41984
v_mfma_f32_16x16x32_bf16 v[132:135],v[192:195],v[244:247],v[132:135]
v_mov_b32 v91,0
v_mov_b32 v92,0
s_waitcnt lgkmcnt(8)
v_mfma_f32_16x16x32_bf16 v[140:143],v[196:199],v[244:247],v[140:143]
v_mov_b32 v93,0
v_mfma_f32_16x16x32_bf16 v[136:139],v[196:199],v[240:243],v[136:139]
v_mov_b32 v94,0
ds_read_b64_tr_b16 v[216:217],v250 offset:40960
ds_read_b64_tr_b16 v[218:219],v250 offset:41984
s_waitcnt lgkmcnt(8)
v_mfma_f32_16x16x32_bf16 v[144:147],v[200:203],v[240:243],v[144:147]
v_mov_b32 v95,0
ds_read_b64_tr_b16 v[220:221],v251 offset:40960
ds_read_b64_tr_b16 v[222:223],v251 offset:41984
v_mfma_f32_16x16x32_bf16 v[148:151],v[200:203],v[244:247],v[148:151]
v_mov_b32 v96,0
s_waitcnt lgkmcnt(8)
v_mfma_f32_16x16x32_bf16 v[156:159],v[204:207],v[244:247],v[156:159]
v_mov_b32 v97,0
v_mfma_f32_16x16x32_bf16 v[152:155],v[204:207],v[240:243],v[152:155]
v_mov_b32 v98,0
ds_read_b64_tr_b16 v[224:225],v40 offset:49152
ds_read_b64_tr_b16 v[226:227],v40 offset:50176
s_setprio 2
s_waitcnt lgkmcnt(8)
v_mfma_f32_16x16x32_bf16 v[160:163],v[208:211],v[240:243],v[160:163]
v_mov_b32 v99,0
ds_read_b64_tr_b16 v[228:229],v41 offset:49152
ds_read_b64_tr_b16 v[230:231],v41 offset:50176
v_mfma_f32_16x16x32_bf16 v[164:167],v[208:211],v[244:247],v[164:167]
v_mov_b32 v100,0
s_waitcnt lgkmcnt(8)
v_mfma_f32_16x16x32_bf16 v[172:175],v[212:215],v[244:247],v[172:175]
v_mov_b32 v101,0
v_mfma_f32_16x16x32_bf16 v[168:171],v[212:215],v[240:243],v[168:171]
v_mov_b32 v102,0
ds_read_b64_tr_b16 v[192:193],v42 offset:49152
ds_read_b64_tr_b16 v[194:195],v42 offset:50176
s_waitcnt lgkmcnt(8)
v_mfma_f32_16x16x32_bf16 v[176:179],v[216:219],v[240:243],v[176:179]
v_mov_b32 v103,0
ds_read_b64_tr_b16 v[196:197],v43 offset:49152
ds_read_b64_tr_b16 v[198:199],v43 offset:50176
v_mfma_f32_16x16x32_bf16 v[180:183],v[216:219],v[244:247],v[180:183]
v_mov_b32 v104,0
s_waitcnt lgkmcnt(8)
v_mfma_f32_16x16x32_bf16 v[188:191],v[220:223],v[244:247],v[188:191]
v_mov_b32 v105,0
v_mfma_f32_16x16x32_bf16 v[184:187],v[220:223],v[240:243],v[184:187]
v_mov_b32 v106,0
ds_read_b64_tr_b16 v[200:201],v248 offset:49152
ds_read_b64_tr_b16 v[202:203],v248 offset:50176
s_waitcnt lgkmcnt(8)
s_waitcnt vmcnt(11)
v_mfma_f32_16x16x32_bf16 v[128:131],v[224:227],v[24:27],v[128:131]
ds_read_b64_tr_b16 v[204:205],v249 offset:49152
ds_read_b64_tr_b16 v[206:207],v249 offset:50176
s_waitcnt vmcnt(10)
v_mfma_f32_16x16x32_bf16 v[132:135],v[224:227],v[28:31],v[132:135]
buffer_load_dwordx4 v[232:235],v2,s[8:11],s93 offen offset:0 sc1
s_waitcnt lgkmcnt(8)
v_mfma_f32_16x16x32_bf16 v[140:143],v[228:231],v[28:31],v[140:143]
v_mov_b32 v107,0
v_mfma_f32_16x16x32_bf16 v[136:139],v[228:231],v[24:27],v[136:139]
v_mov_b32 v108,0
ds_read_b64_tr_b16 v[208:209],v250 offset:49152
ds_read_b64_tr_b16 v[210:211],v250 offset:50176
s_waitcnt lgkmcnt(8)
v_mfma_f32_16x16x32_bf16 v[144:147],v[192:195],v[24:27],v[144:147]
buffer_load_dwordx4 v[236:239],v2,s[8:11],s93 offen offset:1024 sc1
ds_read_b64_tr_b16 v[212:213],v251 offset:49152
ds_read_b64_tr_b16 v[214:215],v251 offset:50176
v_mfma_f32_16x16x32_bf16 v[148:151],v[192:195],v[28:31],v[148:151]
v_mov_b32 v109,0
s_waitcnt lgkmcnt(8)
v_mfma_f32_16x16x32_bf16 v[156:159],v[196:199],v[28:31],v[156:159]
v_mov_b32 v110,0
v_mfma_f32_16x16x32_bf16 v[152:155],v[196:199],v[24:27],v[152:155]
v_mov_b32 v111,0
ds_read_b64_tr_b16 v[216:217],v40 offset:57344
ds_read_b64_tr_b16 v[218:219],v40 offset:58368
s_waitcnt lgkmcnt(8)
v_mfma_f32_16x16x32_bf16 v[160:163],v[200:203],v[24:27],v[160:163]
ds_read_b64_tr_b16 v[220:221],v41 offset:57344
ds_read_b64_tr_b16 v[222:223],v41 offset:58368
v_mfma_f32_16x16x32_bf16 v[164:167],v[200:203],v[28:31],v[164:167]
v_mov_b32 v112,0
s_waitcnt lgkmcnt(8)
v_mfma_f32_16x16x32_bf16 v[172:175],v[204:207],v[28:31],v[172:175]
buffer_load_dwordx4 v[240:243],v2,s[8:11],s93 offen offset:2048 sc1
v_mfma_f32_16x16x32_bf16 v[168:171],v[204:207],v[24:27],v[168:171]
v_mov_b32 v113,0
ds_read_b64_tr_b16 v[224:225],v42 offset:57344
ds_read_b64_tr_b16 v[226:227],v42 offset:58368
s_waitcnt lgkmcnt(8)
v_mfma_f32_16x16x32_bf16 v[176:179],v[208:211],v[24:27],v[176:179]
v_mov_b32 v114,0
ds_read_b64_tr_b16 v[228:229],v43 offset:57344
ds_read_b64_tr_b16 v[230:231],v43 offset:58368
v_mfma_f32_16x16x32_bf16 v[180:183],v[208:211],v[28:31],v[180:183]
v_mov_b32 v115,0
s_waitcnt lgkmcnt(8)
v_mfma_f32_16x16x32_bf16 v[188:191],v[212:215],v[28:31],v[188:191]
buffer_load_dwordx4 v[244:247],v2,s[8:11],s93 offen offset:3072 sc1
v_mfma_f32_16x16x32_bf16 v[184:187],v[212:215],v[24:27],v[184:187]
v_mov_b32 v116,0
ds_read_b64_tr_b16 v[192:193],v248 offset:57344
ds_read_b64_tr_b16 v[194:195],v248 offset:58368
s_setprio 1
s_waitcnt lgkmcnt(8)
s_waitcnt vmcnt(13)
v_mfma_f32_16x16x32_bf16 v[128:131],v[216:219],v[32:35],v[128:131]
v_mov_b32 v117,0
ds_read_b64_tr_b16 v[196:197],v249 offset:57344
ds_read_b64_tr_b16 v[198:199],v249 offset:58368
s_waitcnt vmcnt(12)
v_mfma_f32_16x16x32_bf16 v[132:135],v[216:219],v[36:39],v[132:135]
v_mov_b32 v118,0
s_waitcnt lgkmcnt(8)
v_mfma_f32_16x16x32_bf16 v[140:143],v[220:223],v[36:39],v[140:143]
v_mfma_f32_16x16x32_bf16 v[136:139],v[220:223],v[32:35],v[136:139]
v_mov_b32 v119,0
ds_read_b64_tr_b16 v[200:201],v250 offset:57344
ds_read_b64_tr_b16 v[202:203],v250 offset:58368
s_waitcnt lgkmcnt(8)
v_mfma_f32_16x16x32_bf16 v[144:147],v[224:227],v[32:35],v[144:147]
ds_read_b64_tr_b16 v[204:205],v251 offset:57344
ds_read_b64_tr_b16 v[206:207],v251 offset:58368
v_mfma_f32_16x16x32_bf16 v[148:151],v[224:227],v[36:39],v[148:151]
v_mov_b32 v120,0
s_waitcnt lgkmcnt(8)
v_mfma_f32_16x16x32_bf16 v[156:159],v[228:231],v[36:39],v[156:159]
v_mov_b32 v121,0
v_mfma_f32_16x16x32_bf16 v[152:155],v[228:231],v[32:35],v[152:155]
v_mov_b32 v122,0
v_add_u32 v40,65536,v40
v_add_u32 v41,65536,v41
ds_read_b64_tr_b16 v[208:209],v40 offset:0
ds_read_b64_tr_b16 v[210:211],v40 offset:1024
s_waitcnt lgkmcnt(8)
v_mfma_f32_16x16x32_bf16 v[160:163],v[192:195],v[32:35],v[160:163]
ds_read_b64_tr_b16 v[212:213],v41 offset:0
ds_read_b64_tr_b16 v[214:215],v41 offset:1024
v_mfma_f32_16x16x32_bf16 v[164:167],v[192:195],v[36:39],v[164:167]
v_mov_b32 v123,0
s_waitcnt lgkmcnt(8)
v_mfma_f32_16x16x32_bf16 v[172:175],v[196:199],v[36:39],v[172:175]
v_mov_b32 v124,0
v_mfma_f32_16x16x32_bf16 v[168:171],v[196:199],v[32:35],v[168:171]
v_mov_b32 v125,0
v_add_u32 v42,65536,v42
v_add_u32 v43,65536,v43
ds_read_b64_tr_b16 v[216:217],v42 offset:0
ds_read_b64_tr_b16 v[218:219],v42 offset:1024
s_waitcnt lgkmcnt(8)
v_mfma_f32_16x16x32_bf16 v[176:179],v[200:203],v[32:35],v[176:179]
ds_read_b64_tr_b16 v[220:221],v43 offset:0
ds_read_b64_tr_b16 v[222:223],v43 offset:1024
v_mfma_f32_16x16x32_bf16 v[180:183],v[200:203],v[36:39],v[180:183]
v_mov_b32 v126,0
s_waitcnt lgkmcnt(8)
v_mfma_f32_16x16x32_bf16 v[188:191],v[204:207],v[36:39],v[188:191]
v_mfma_f32_16x16x32_bf16 v[184:187],v[204:207],v[32:35],v[184:187]
v_mov_b32 v127,0
v_add_u32 v248,65536,v248
v_add_u32 v249,65536,v249
ds_read_b64_tr_b16 v[224:225],v248 offset:0
ds_read_b64_tr_b16 v[226:227],v248 offset:1024
s_waitcnt lgkmcnt(8)
s_waitcnt vmcnt(9)
v_mfma_f32_16x16x32_bf16 v[128:131],v[208:211],v[48:51],v[128:131]
ds_read_b64_tr_b16 v[228:229],v249 offset:0
ds_read_b64_tr_b16 v[230:231],v249 offset:1024
s_waitcnt vmcnt(8)
v_mfma_f32_16x16x32_bf16 v[132:135],v[208:211],v[52:55],v[132:135]
s_cmp_lg_u32 s16,0
s_cbranch_scc1 L_k2_np1
buffer_load_dword v15,v4,s[8:11],0 offen sc1
L_k2_np1:
s_waitcnt lgkmcnt(8)
v_mfma_f32_16x16x32_bf16 v[140:143],v[212:215],v[52:55],v[140:143]
v_mfma_f32_16x16x32_bf16 v[136:139],v[212:215],v[48:51],v[136:139]
v_add_u32 v250,65536,v250
v_add_u32 v251,65536,v251
ds_read_b64_tr_b16 v[192:193],v250 offset:0
ds_read_b64_tr_b16 v[194:195],v250 offset:1024
s_waitcnt lgkmcnt(8)
v_mfma_f32_16x16x32_bf16 v[144:147],v[216:219],v[48:51],v[144:147]
ds_read_b64_tr_b16 v[196:197],v251 offset:0
ds_read_b64_tr_b16 v[198:199],v251 offset:1024
v_mfma_f32_16x16x32_bf16 v[148:151],v[216:219],v[52:55],v[148:151]
buffer_load_dwordx4 v[24:27],v2,s[8:11],s94 offen offset:0 sc1
s_waitcnt lgkmcnt(8)
v_mfma_f32_16x16x32_bf16 v[156:159],v[220:223],v[52:55],v[156:159]
v_mfma_f32_16x16x32_bf16 v[152:155],v[220:223],v[48:51],v[152:155]
ds_read_b64_tr_b16 v[200:201],v40 offset:8192
ds_read_b64_tr_b16 v[202:203],v40 offset:9216
s_setprio 0
s_waitcnt lgkmcnt(8)
v_mfma_f32_16x16x32_bf16 v[160:163],v[224:227],v[48:51],v[160:163]
ds_read_b64_tr_b16 v[204:205],v41 offset:8192
ds_read_b64_tr_b16 v[206:207],v41 offset:9216
v_mfma_f32_16x16x32_bf16 v[164:167],v[224:227],v[52:55],v[164:167]
buffer_load_dwordx4 v[28:31],v2,s[8:11],s94 offen offset:1024 sc1
s_waitcnt lgkmcnt(8)
v_mfma_f32_16x16x32_bf16 v[172:175],v[228:231],v[52:55],v[172:175]
v_mfma_f32_16x16x32_bf16 v[168:171],v[228:231],v[48:51],v[168:171]
ds_read_b64_tr_b16 v[208:209],v42 offset:8192
ds_read_b64_tr_b16 v[210:211],v42 offset:9216
s_waitcnt lgkmcnt(8)
v_mfma_f32_16x16x32_bf16 v[176:179],v[192:195],v[48:51],v[176:179]
ds_read_b64_tr_b16 v[212:213],v43 offset:8192
ds_read_b64_tr_b16 v[214:215],v43 offset:9216
v_mfma_f32_16x16x32_bf16 v[180:183],v[192:195],v[52:55],v[180:183]
buffer_load_dwordx4 v[32:35],v2,s[8:11],s94 offen offset:2048 sc1
s_waitcnt lgkmcnt(8)
v_mfma_f32_16x16x32_bf16 v[188:191],v[196:199],v[52:55],v[188:191]
v_mfma_f32_16x16x32_bf16 v[184:187],v[196:199],v[48:51],v[184:187]
ds_read_b64_tr_b16 v[216:217],v248 offset:8192
ds_read_b64_tr_b16 v[218:219],v248 offset:9216
s_waitcnt lgkmcnt(8)
s_waitcnt vmcnt(10)
v_mfma_f32_16x16x32_bf16 v[128:131],v[200:203],v[56:59],v[128:131]
ds_read_b64_tr_b16 v[220:221],v249 offset:8192
ds_read_b64_tr_b16 v[222:223],v249 offset:9216
s_waitcnt vmcnt(9)
v_mfma_f32_16x16x32_bf16 v[132:135],v[200:203],v[60:63],v[132:135]
buffer_load_dwordx4 v[36:39],v2,s[8:11],s94 offen offset:3072 sc1
s_waitcnt lgkmcnt(8)
v_mfma_f32_16x16x32_bf16 v[140:143],v[204:207],v[60:63],v[140:143]
v_mfma_f32_16x16x32_bf16 v[136:139],v[204:207],v[56:59],v[136:139]
ds_read_b64_tr_b16 v[224:225],v250 offset:8192
ds_read_b64_tr_b16 v[226:227],v250 offset:9216
s_waitcnt lgkmcnt(8)
v_mfma_f32_16x16x32_bf16 v[144:147],v[208:211],v[56:59],v[144:147]
ds_read_b64_tr_b16 v[228:229],v251 offset:8192
ds_read_b64_tr_b16 v[230:231],v251 offset:9216
v_mfma_f32_16x16x32_bf16 v[148:151],v[208:211],v[60:63],v[148:151]
s_waitcnt lgkmcnt(8)
v_mfma_f32_16x16x32_bf16 v[156:159],v[212:215],v[60:63],v[156:159]
v_mfma_f32_16x16x32_bf16 v[152:155],v[212:215],v[56:59],v[152:155]
ds_read_b64_tr_b16 v[192:193],v40 offset:16384
ds_read_b64_tr_b16 v[194:195],v40 offset:17408
s_waitcnt lgkmcnt(8)
v_mfma_f32_16x16x32_bf16 v[160:163],v[216:219],v[56:59],v[160:163]
ds_read_b64_tr_b16 v[196:197],v41 offset:16384
ds_read_b64_tr_b16 v[198:199],v41 offset:17408
v_mfma_f32_16x16x32_bf16 v[164:167],v[216:219],v[60:63],v[164:167]
s_waitcnt lgkmcnt(8)
v_mfma_f32_16x16x32_bf16 v[172:175],v[220:223],v[60:63],v[172:175]
v_mfma_f32_16x16x32_bf16 v[168:171],v[220:223],v[56:59],v[168:171]
ds_read_b64_tr_b16 v[200:201],v42 offset:16384
ds_read_b64_tr_b16 v[202:203],v42 offset:17408
s_waitcnt lgkmcnt(8)
v_mfma_f32_16x16x32_bf16 v[176:179],v[224:227],v[56:59],v[176:179]
ds_read_b64_tr_b16 v[204:205],v43 offset:16384
ds_read_b64_tr_b16 v[206:207],v43 offset:17408
v_mfma_f32_16x16x32_bf16 v[180:183],v[224:227],v[60:63],v[180:183]
s_waitcnt lgkmcnt(8)
v_mfma_f32_16x16x32_bf16 v[188:191],v[228:231],v[60:63],v[188:191]
v_mfma_f32_16x16x32_bf16 v[184:187],v[228:231],v[56:59],v[184:187]
s_waitcnt vmcnt(8)
s_cmp_lg_u32 s16,0
s_cbranch_scc1 L_k2_spin1_back
s_waitcnt vmcnt(4)
v_cmp_ne_u32 vcc,s96,v15
s_cbranch_vccnz L_k2_spin1
L_k2_spin1_back:
s_barrier
ds_read_b64_tr_b16 v[208:209],v248 offset:16384
ds_read_b64_tr_b16 v[210:211],v248 offset:17408
s_setprio 3
s_waitcnt lgkmcnt(8)
s_waitcnt vmcnt(7)
v_mfma_f32_16x16x32_bf16 v[128:131],v[192:195],v[232:235],v[128:131]
ds_read_b64_tr_b16 v[212:213],v249 offset:16384
ds_read_b64_tr_b16 v[214:215],v249 offset:17408
s_waitcnt vmcnt(6)
v_mfma_f32_16x16x32_bf16 v[132:135],v[192:195],v[236:239],v[132:135]
buffer_load_dwordx4 v[48:51],v2,s[8:11],s95 offen offset:0 sc1
s_waitcnt lgkmcnt(8)
v_mfma_f32_16x16x32_bf16 v[140:143],v[196:199],v[236:239],v[140:143]
v_mfma_f32_16x16x32_bf16 v[136:139],v[196:199],v[232:235],v[136:139]
buffer_load_dwordx4 v[52:55],v2,s[8:11],s95 offen offset:1024 sc1
ds_read_b64_tr_b16 v[216:217],v250 offset:16384
ds_read_b64_tr_b16 v[218:219],v250 offset:17408
s_waitcnt lgkmcnt(8)
v_mfma_f32_16x16x32_bf16 v[144:147],v[200:203],v[232:235],v[144:147]
ds_read_b64_tr_b16 v[220:221],v251 offset:16384
ds_read_b64_tr_b16 v[222:223],v251 offset:17408
v_mfma_f32_16x16x32_bf16 v[148:151],v[200:203],v[236:239],v[148:151]
buffer_load_dwordx4 v[56:59],v2,s[8:11],s95 offen offset:2048 sc1
s_waitcnt lgkmcnt(8)
v_mfma_f32_16x16x32_bf16 v[156:159],v[204:207],v[236:239],v[156:159]
v_mfma_f32_16x16x32_bf16 v[152:155],v[204:207],v[232:235],v[152:155]
ds_read_b64_tr_b16 v[224:225],v40 offset:24576
ds_read_b64_tr_b16 v[226:227],v40 offset:25600
s_waitcnt lgkmcnt(8)
v_mfma_f32_16x16x32_bf16 v[160:163],v[208:211],v[232:235],v[160:163]
ds_read_b64_tr_b16 v[228:229],v41 offset:24576
ds_read_b64_tr_b16 v[230:231],v41 offset:25600
v_mfma_f32_16x16x32_bf16 v[164:167],v[208:211],v[236:239],v[164:167]
buffer_load_dwordx4 v[60:63],v2,s[8:11],s95 offen offset:3072 sc1
s_waitcnt lgkmcnt(8)
v_mfma_f32_16x16x32_bf16 v[172:175],v[212:215],v[236:239],v[172:175]
v_mfma_f32_16x16x32_bf16 v[168:171],v[212:215],v[232:235],v[168:171]
s_lshl_b32 s26,s19,7
s_add_u32 s26,s26,101711872
buffer_load_dword v8,v252,s[8:11],s26 offen sc1
ds_read_b64_tr_b16 v[192:193],v42 offset:24576
ds_read_b64_tr_b16 v[194:195],v42 offset:25600
s_waitcnt lgkmcnt(8)
v_mfma_f32_16x16x32_bf16 v[176:179],v[216:219],v[232:235],v[176:179]
ds_read_b64_tr_b16 v[196:197],v43 offset:24576
ds_read_b64_tr_b16 v[198:199],v43 offset:25600
v_mfma_f32_16x16x32_bf16 v[180:183],v[216:219],v[236:239],v[180:183]
s_waitcnt lgkmcnt(8)
v_mfma_f32_16x16x32_bf16 v[188:191],v[220:223],v[236:239],v[188:191]
v_mfma_f32_16x16x32_bf16 v[184:187],v[220:223],v[232:235],v[184:187]
s_add_u32 m0,s39,s39
s_add_u32 m0,m0,147456
s_lshl_b32 s26,s16,12
s_add_u32 s26,s26,s36
buffer_load_dwordx4 v2,s[8:11],s26 offen offset:0 sc1 lds
buffer_load_dwordx4 v2,s[8:11],s26 offen offset:1024 sc1 lds
buffer_load_dwordx4 v2,s[8:11],s26 offen offset:2048 sc1 lds
buffer_load_dwordx4 v2,s[8:11],s26 offen offset:3072 sc1 lds
ds_read_b64_tr_b16 v[200:201],v248 offset:24576
ds_read_b64_tr_b16 v[202:203],v248 offset:25600
s_setprio 2
s_waitcnt lgkmcnt(8)
s_waitcnt vmcnt(14)
v_mfma_f32_16x16x32_bf16 v[128:131],v[224:227],v[240:243],v[128:131]
ds_read_b64_tr_b16 v[204:205],v249 offset:24576
ds_read_b64_tr_b16 v[206:207],v249 offset:25600
s_waitcnt vmcnt(13)
v_mfma_f32_16x16x32_bf16 v[132:135],v[224:227],v[244:247],v[132:135]
s_lshl_b32 s26,s16,13
s_add_u32 m0,s24,s26
s_add_u32 s27,s25,4096
buffer_load_dwordx4 v2,s[72:75],s25 offen sc1 lds
buffer_load_dwordx4 v2,s[72:75],s25 offen offset:1024 sc1 lds
buffer_load_dwordx4 v2,s[72:75],s25 offen offset:2048 sc1 lds
buffer_load_dwordx4 v2,s[72:75],s25 offen offset:3072 sc1 lds
s_add_u32 m0,m0,4096
s_add_u32 s25,s25,32768
buffer_load_dwordx4 v2,s[72:75],s27 offen sc1 lds
buffer_load_dwordx4 v2,s[72:75],s27 offen offset:1024 sc1 lds
buffer_load_dwordx4 v2,s[72:75],s27 offen offset:2048 sc1 lds
buffer_load_dwordx4 v2,s[72:75],s27 offen offset:3072 sc1 lds
s_add_u32 s29,s29,1
s_add_u32 s24,s24,32768
s_cmp_eq_u32 s24,163840
s_cselect_b32 s24,0,s24
s_waitcnt lgkmcnt(8)
v_mfma_f32_16x16x32_bf16 v[140:143],v[228:231],v[244:247],v[140:143]
v_mfma_f32_16x16x32_bf16 v[136:139],v[228:231],v[240:243],v[136:139]
ds_read_b64_tr_b16 v[208:209],v250 offset:24576
ds_read_b64_tr_b16 v[210:211],v250 offset:25600
s_waitcnt lgkmcnt(8)
v_mfma_f32_16x16x32_bf16 v[144:147],v[192:195],v[240:243],v[144:147]
ds_read_b64_tr_b16 v[212:213],v251 offset:24576
ds_read_b64_tr_b16 v[214:215],v251 offset:25600
v_mfma_f32_16x16x32_bf16 v[148:151],v[192:195],v[244:247],v[148:151]
s_waitcnt lgkmcnt(8)
v_mfma_f32_16x16x32_bf16 v[156:159],v[196:199],v[244:247],v[156:159]
v_mfma_f32_16x16x32_bf16 v[152:155],v[196:199],v[240:243],v[152:155]
ds_read_b64_tr_b16 v[216:217],v40 offset:32768
ds_read_b64_tr_b16 v[218:219],v40 offset:33792
s_waitcnt lgkmcnt(8)
v_mfma_f32_16x16x32_bf16 v[160:163],v[200:203],v[240:243],v[160:163]
ds_read_b64_tr_b16 v[220:221],v41 offset:32768
ds_read_b64_tr_b16 v[222:223],v41 offset:33792
v_mfma_f32_16x16x32_bf16 v[164:167],v[200:203],v[244:247],v[164:167]
s_waitcnt lgkmcnt(8)
v_mfma_f32_16x16x32_bf16 v[172:175],v[204:207],v[244:247],v[172:175]
v_mfma_f32_16x16x32_bf16 v[168:171],v[204:207],v[240:243],v[168:171]
ds_read_b64_tr_b16 v[224:225],v42 offset:32768
ds_read_b64_tr_b16 v[226:227],v42 offset:33792
s_waitcnt lgkmcnt(8)
v_mfma_f32_16x16x32_bf16 v[176:179],v[208:211],v[240:243],v[176:179]
ds_read_b64_tr_b16 v[228:229],v43 offset:32768
ds_read_b64_tr_b16 v[230:231],v43 offset:33792
v_mfma_f32_16x16x32_bf16 v[180:183],v[208:211],v[244:247],v[180:183]
s_waitcnt lgkmcnt(8)
v_mfma_f32_16x16x32_bf16 v[188:191],v[212:215],v[244:247],v[188:191]
v_mfma_f32_16x16x32_bf16 v[184:187],v[212:215],v[240:243],v[184:187]
ds_read_b64_tr_b16 v[192:193],v248 offset:32768
ds_read_b64_tr_b16 v[194:195],v248 offset:33792
s_setprio 1
s_waitcnt lgkmcnt(8)
s_waitcnt vmcnt(20)
v_mfma_f32_16x16x32_bf16 v[128:131],v[216:219],v[24:27],v[128:131]
ds_read_b64_tr_b16 v[196:197],v249 offset:32768
ds_read_b64_tr_b16 v[198:199],v249 offset:33792
s_waitcnt vmcnt(19)
v_mfma_f32_16x16x32_bf16 v[132:135],v[216:219],v[28:31],v[132:135]
s_lshl_b32 s26,s16,13
s_add_u32 m0,s24,s26
s_add_u32 s27,s25,4096
buffer_load_dwordx4 v2,s[72:75],s25 offen sc1 lds
buffer_load_dwordx4 v2,s[72:75],s25 offen offset:1024 sc1 lds
buffer_load_dwordx4 v2,s[72:75],s25 offen offset:2048 sc1 lds
buffer_load_dwordx4 v2,s[72:75],s25 offen offset:3072 sc1 lds
s_add_u32 m0,m0,4096
s_add_u32 s25,s25,32768
buffer_load_dwordx4 v2,s[72:75],s27 offen sc1 lds
buffer_load_dwordx4 v2,s[72:75],s27 offen offset:1024 sc1 lds
buffer_load_dwordx4 v2,s[72:75],s27 offen offset:2048 sc1 lds
buffer_load_dwordx4 v2,s[72:75],s27 offen offset:3072 sc1 lds
s_add_u32 s29,s29,1
s_add_u32 s24,s24,32768
s_cmp_eq_u32 s24,163840
s_cselect_b32 s24,0,s24
s_waitcnt lgkmcnt(8)
v_mfma_f32_16x16x32_bf16 v[140:143],v[220:223],v[28:31],v[140:143]
v_mfma_f32_16x16x32_bf16 v[136:139],v[220:223],v[24:27],v[136:139]
ds_read_b64_tr_b16 v[200:201],v250 offset:32768
ds_read_b64_tr_b16 v[202:203],v250 offset:33792
s_waitcnt lgkmcnt(8)
v_mfma_f32_16x16x32_bf16 v[144:147],v[224:227],v[24:27],v[144:147]
ds_read_b64_tr_b16 v[204:205],v251 offset:32768
ds_read_b64_tr_b16 v[206:207],v251 offset:33792
v_mfma_f32_16x16x32_bf16 v[148:151],v[224:227],v[28:31],v[148:151]
v_bfe_u32 v16,v1,2,2
s_waitcnt lgkmcnt(8)
v_mfma_f32_16x16x32_bf16 v[156:159],v[228:231],v[28:31],v[156:159]
v_mfma_f32_16x16x32_bf16 v[152:155],v[228:231],v[24:27],v[152:155]
v_lshrrev_b32 v17,5,v1
ds_read_b64_tr_b16 v[208:209],v40 offset:40960
ds_read_b64_tr_b16 v[210:211],v40 offset:41984
s_waitcnt lgkmcnt(8)
v_mfma_f32_16x16x32_bf16 v[160:163],v[192:195],v[24:27],v[160:163]
ds_read_b64_tr_b16 v[212:213],v41 offset:40960
ds_read_b64_tr_b16 v[214:215],v41 offset:41984
v_mfma_f32_16x16x32_bf16 v[164:167],v[192:195],v[28:31],v[164:167]
v_lshl_add_u32 v247,v17,2,v16
s_waitcnt lgkmcnt(8)
v_mfma_f32_16x16x32_bf16 v[172:175],v[196:199],v[28:31],v[172:175]
v_mfma_f32_16x16x32_bf16 v[168:171],v[196:199],v[24:27],v[168:171]
v_lshlrev_b32 v246,9,v17
ds_read_b64_tr_b16 v[216:217],v42 offset:40960
ds_read_b64_tr_b16 v[218:219],v42 offset:41984
s_waitcnt lgkmcnt(8)
v_mfma_f32_16x16x32_bf16 v[176:179],v[200:203],v[24:27],v[176:179]
ds_read_b64_tr_b16 v[220:221],v43 offset:40960
ds_read_b64_tr_b16 v[222:223],v43 offset:41984
v_mfma_f32_16x16x32_bf16 v[180:183],v[200:203],v[28:31],v[180:183]
v_and_b32 v17,16,v1
s_waitcnt lgkmcnt(8)
v_mfma_f32_16x16x32_bf16 v[188:191],v[204:207],v[28:31],v[188:191]
v_mfma_f32_16x16x32_bf16 v[184:187],v[204:207],v[24:27],v[184:187]
v_add_u32 v247,v17,v247
ds_read_b64_tr_b16 v[224:225],v248 offset:40960
ds_read_b64_tr_b16 v[226:227],v248 offset:41984
s_setprio 0
s_waitcnt lgkmcnt(8)
s_waitcnt vmcnt(26)
v_mfma_f32_16x16x32_bf16 v[128:131],v[208:211],v[32:35],v[128:131]
ds_read_b64_tr_b16 v[228:229],v249 offset:40960
ds_read_b64_tr_b16 v[230:231],v249 offset:41984
s_waitcnt vmcnt(25)
v_mfma_f32_16x16x32_bf16 v[132:135],v[208:211],v[36:39],v[132:135]
v_lshlrev_b32 v247,8,v247
s_waitcnt lgkmcnt(8)
v_mfma_f32_16x16x32_bf16 v[140:143],v[212:215],v[36:39],v[140:143]
v_mfma_f32_16x16x32_bf16 v[136:139],v[212:215],v[32:35],v[136:139]
v_lshl_add_u32 v247,v16,6,v247
ds_read_b64_tr_b16 v[192:193],v250 offset:40960
ds_read_b64_tr_b16 v[194:195],v250 offset:41984
s_waitcnt lgkmcnt(8)
v_mfma_f32_16x16x32_bf16 v[144:147],v[216:219],v[32:35],v[144:147]
ds_read_b64_tr_b16 v[196:197],v251 offset:40960
ds_read_b64_tr_b16 v[198:199],v251 offset:41984
v_mfma_f32_16x16x32_bf16 v[148:151],v[216:219],v[36:39],v[148:151]
v_lshl_add_u32 v247,v17,1,v247
s_waitcnt lgkmcnt(8)
v_mfma_f32_16x16x32_bf16 v[156:159],v[220:223],v[36:39],v[156:159]
v_mfma_f32_16x16x32_bf16 v[152:155],v[220:223],v[32:35],v[152:155]
v_lshl_add_u32 v246,v17,6,v246
ds_read_b64_tr_b16 v[200:201],v40 offset:49152
ds_read_b64_tr_b16 v[202:203],v40 offset:50176
s_waitcnt lgkmcnt(8)
v_mfma_f32_16x16x32_bf16 v[160:163],v[224:227],v[32:35],v[160:163]
ds_read_b64_tr_b16 v[204:205],v41 offset:49152
ds_read_b64_tr_b16 v[206:207],v41 offset:50176
v_mfma_f32_16x16x32_bf16 v[164:167],v[224:227],v[36:39],v[164:167]
v_and_b32 v16,3,v1
s_waitcnt lgkmcnt(8)
v_mfma_f32_16x16x32_bf16 v[172:175],v[228:231],v[36:39],v[172:175]
v_mfma_f32_16x16x32_bf16 v[168:171],v[228:231],v[32:35],v[168:171]
v_lshl_add_u32 v247,v16,3,v247
ds_read_b64_tr_b16 v[208:209],v40 offset:57344
ds_read_b64_tr_b16 v[210:211],v40 offset:58368
s_waitcnt lgkmcnt(8)
v_mfma_f32_16x16x32_bf16 v[176:179],v[192:195],v[32:35],v[176:179]
ds_read_b64_tr_b16 v[212:213],v41 offset:57344
ds_read_b64_tr_b16 v[214:215],v41 offset:58368
v_mfma_f32_16x16x32_bf16 v[180:183],v[192:195],v[36:39],v[180:183]
v_and_b32 v16,15,v1
s_waitcnt lgkmcnt(8)
v_mfma_f32_16x16x32_bf16 v[188:191],v[196:199],v[36:39],v[188:191]
v_mfma_f32_16x16x32_bf16 v[184:187],v[196:199],v[32:35],v[184:187]
v_lshl_add_u32 v246,v16,4,v246
s_barrier
ds_read_b64_tr_b16 v[216:217],v42 offset:49152
ds_read_b64_tr_b16 v[218:219],v42 offset:50176
s_setprio 3
s_waitcnt lgkmcnt(8)
s_waitcnt vmcnt(24)
v_mfma_f32_16x16x32_bf16 v[128:131],v[200:203],v[48:51],v[128:131]
ds_read_b64_tr_b16 v[220:221],v43 offset:49152
ds_read_b64_tr_b16 v[222:223],v43 offset:50176
s_waitcnt vmcnt(23)
v_mfma_f32_16x16x32_bf16 v[132:135],v[200:203],v[52:55],v[132:135]
s_cmp_lg_u32 s16,0
s_cbranch_scc1 L_k2_np2
buffer_load_dword v15,v253,s[8:11],0 offen sc1
L_k2_np2:
s_waitcnt lgkmcnt(8)
v_mfma_f32_16x16x32_bf16 v[140:143],v[204:207],v[52:55],v[140:143]
v_mfma_f32_16x16x32_bf16 v[136:139],v[204:207],v[48:51],v[136:139]
ds_read_b64_tr_b16 v[224:225],v42 offset:57344
ds_read_b64_tr_b16 v[226:227],v42 offset:58368
s_waitcnt lgkmcnt(8)
s_waitcnt vmcnt(22)
v_mfma_f32_16x16x32_bf16 v[128:131],v[208:211],v[56:59],v[128:131]
ds_read_b64_tr_b16 v[228:229],v43 offset:57344
ds_read_b64_tr_b16 v[230:231],v43 offset:58368
s_waitcnt vmcnt(21)
v_mfma_f32_16x16x32_bf16 v[132:135],v[208:211],v[60:63],v[132:135]
s_waitcnt lgkmcnt(8)
v_mfma_f32_16x16x32_bf16 v[140:143],v[212:215],v[60:63],v[140:143]
v_mfma_f32_16x16x32_bf16 v[136:139],v[212:215],v[56:59],v[136:139]
ds_read_b64_tr_b16 v[192:193],v248 offset:49152
ds_read_b64_tr_b16 v[194:195],v248 offset:50176
s_setprio 2
s_waitcnt lgkmcnt(8)
v_mfma_f32_16x16x32_bf16 v[144:147],v[216:219],v[48:51],v[144:147]
ds_read_b64_tr_b16 v[196:197],v249 offset:49152
ds_read_b64_tr_b16 v[198:199],v249 offset:50176
v_mfma_f32_16x16x32_bf16 v[148:151],v[216:219],v[52:55],v[148:151]
s_waitcnt lgkmcnt(8)
v_mfma_f32_16x16x32_bf16 v[156:159],v[220:223],v[52:55],v[156:159]
v_mfma_f32_16x16x32_bf16 v[152:155],v[220:223],v[48:51],v[152:155]
s_lshl_b32 s26,s16,13
s_add_u32 m0,s24,s26
s_add_u32 s27,s25,4096
buffer_load_dwordx4 v2,s[72:75],s25 offen sc1 lds
buffer_load_dwordx4 v2,s[72:75],s25 offen offset:1024 sc1 lds
buffer_load_dwordx4 v2,s[72:75],s25 offen offset:2048 sc1 lds
buffer_load_dwordx4 v2,s[72:75],s25 offen offset:3072 sc1 lds
s_add_u32 m0,m0,4096
s_add_u32 s25,s25,32768
buffer_load_dwordx4 v2,s[72:75],s27 offen sc1 lds
buffer_load_dwordx4 v2,s[72:75],s27 offen offset:1024 sc1 lds
buffer_load_dwordx4 v2,s[72:75],s27 offen offset:2048 sc1 lds
buffer_load_dwordx4 v2,s[72:75],s27 offen offset:3072 sc1 lds
s_add_u32 s29,s29,1
s_add_u32 s24,s24,32768
s_cmp_eq_u32 s24,163840
s_cselect_b32 s24,0,s24
ds_read_b64_tr_b16 v[200:201],v248 offset:57344
ds_read_b64_tr_b16 v[202:203],v248 offset:58368
s_waitcnt lgkmcnt(8)
v_mfma_f32_16x16x32_bf16 v[144:147],v[224:227],v[56:59],v[144:147]
ds_read_b64_tr_b16 v[204:205],v249 offset:57344
ds_read_b64_tr_b16 v[206:207],v249 offset:58368
v_mfma_f32_16x16x32_bf16 v[148:151],v[224:227],v[60:63],v[148:151]
s_waitcnt lgkmcnt(8)
v_mfma_f32_16x16x32_bf16 v[156:159],v[228:231],v[60:63],v[156:159]
v_mfma_f32_16x16x32_bf16 v[152:155],v[228:231],v[56:59],v[152:155]
ds_read_b64_tr_b16 v[208:209],v250 offset:49152
ds_read_b64_tr_b16 v[210:211],v250 offset:50176
s_setprio 1
s_waitcnt lgkmcnt(8)
v_mfma_f32_16x16x32_bf16 v[160:163],v[192:195],v[48:51],v[160:163]
ds_read_b64_tr_b16 v[212:213],v251 offset:49152
ds_read_b64_tr_b16 v[214:215],v251 offset:50176
v_mfma_f32_16x16x32_bf16 v[164:167],v[192:195],v[52:55],v[164:167]
s_waitcnt lgkmcnt(8)
v_mfma_f32_16x16x32_bf16 v[172:175],v[196:199],v[52:55],v[172:175]
v_cvt_pk_bf16_f32 v32,v128,v129
v_cvt_pk_bf16_f32 v33,v130,v131
v_mfma_f32_16x16x32_bf16 v[168:171],v[196:199],v[48:51],v[168:171]
v_cvt_pk_bf16_f32 v34,v132,v133
v_cvt_pk_bf16_f32 v35,v134,v135
ds_read_b64_tr_b16 v[216:217],v250 offset:57344
ds_read_b64_tr_b16 v[218:219],v250 offset:58368
s_waitcnt lgkmcnt(8)
v_mfma_f32_16x16x32_bf16 v[160:163],v[200:203],v[56:59],v[160:163]
v_cvt_pk_bf16_f32 v36,v136,v137
v_cvt_pk_bf16_f32 v37,v138,v139
ds_read_b64_tr_b16 v[220:221],v251 offset:57344
ds_read_b64_tr_b16 v[222:223],v251 offset:58368
v_mfma_f32_16x16x32_bf16 v[164:167],v[200:203],v[60:63],v[164:167]
v_cvt_pk_bf16_f32 v38,v140,v141
v_cvt_pk_bf16_f32 v39,v142,v143
s_waitcnt lgkmcnt(8)
v_mfma_f32_16x16x32_bf16 v[172:175],v[204:207],v[60:63],v[172:175]
v_permlane16_swap_b32 v32,v34
v_mfma_f32_16x16x32_bf16 v[168:171],v[204:207],v[56:59],v[168:171]
v_permlane16_swap_b32 v33,v35
v_cvt_pk_bf16_f32 v40,v144,v145
s_setprio 0
s_waitcnt lgkmcnt(6)
v_mfma_f32_16x16x32_bf16 v[176:179],v[208:211],v[48:51],v[176:179]
v_cvt_pk_bf16_f32 v41,v146,v147
v_cvt_pk_bf16_f32 v42,v148,v149
v_mfma_f32_16x16x32_bf16 v[180:183],v[208:211],v[52:55],v[180:183]
v_cvt_pk_bf16_f32 v43,v150,v151
v_permlane16_swap_b32 v36,v38
s_waitcnt lgkmcnt(4)
v_mfma_f32_16x16x32_bf16 v[188:191],v[212:215],v[52:55],v[188:191]
v_permlane16_swap_b32 v37,v39
v_mfma_f32_16x16x32_bf16 v[184:187],v[212:215],v[48:51],v[184:187]
v_cvt_pk_bf16_f32 v44,v152,v153
v_cvt_pk_bf16_f32 v45,v154,v155
s_waitcnt lgkmcnt(2)
v_mfma_f32_16x16x32_bf16 v[176:179],v[216:219],v[56:59],v[176:179]
v_cvt_pk_bf16_f32 v46,v156,v157
v_cvt_pk_bf16_f32 v47,v158,v159
v_mfma_f32_16x16x32_bf16 v[180:183],v[216:219],v[60:63],v[180:183]
v_permlane16_swap_b32 v40,v42
v_permlane16_swap_b32 v41,v43
s_waitcnt lgkmcnt(0)
v_mfma_f32_16x16x32_bf16 v[188:191],v[220:223],v[60:63],v[188:191]
s_nop 0
v_mfma_f32_16x16x32_bf16 v[184:187],v[220:223],v[56:59],v[184:187]
v_permlane16_swap_b32 v44,v46
v_permlane16_swap_b32 v45,v47
s_waitcnt vmcnt(24)
s_cmp_lg_u32 s16,0
s_cbranch_scc1 L_k2_spin2_back
s_waitcnt vmcnt(8)
v_cmp_ne_u32 vcc,s96,v15
s_cbranch_vccnz L_k2_spin2
L_k2_spin2_back:
s_cmp_lg_u32 s7,0
s_cbranch_scc1 L_k2_setaba
L_k2_setab_backa:
s_barrier
s_lshl_b32 s26,s16,13
s_add_u32 m0,s24,s26
s_add_u32 s27,s25,4096
buffer_load_dwordx4 v2,s[72:75],s25 offen sc1 lds
buffer_load_dwordx4 v2,s[72:75],s25 offen offset:1024 sc1 lds
buffer_load_dwordx4 v2,s[72:75],s25 offen offset:2048 sc1 lds
buffer_load_dwordx4 v2,s[72:75],s25 offen offset:3072 sc1 lds
s_add_u32 m0,m0,4096
s_add_u32 s25,s25,32768
buffer_load_dwordx4 v2,s[72:75],s27 offen sc1 lds
buffer_load_dwordx4 v2,s[72:75],s27 offen offset:1024 sc1 lds
buffer_load_dwordx4 v2,s[72:75],s27 offen offset:2048 sc1 lds
buffer_load_dwordx4 v2,s[72:75],s27 offen offset:3072 sc1 lds
s_add_u32 s29,s29,1
s_add_u32 s24,s24,32768
s_cmp_eq_u32 s24,163840
s_cselect_b32 s24,0,s24
s_branch L_k2_qd
L_k2_q1:
s_barrier
ds_read_b64_tr_b16 v[192:193],v40 offset:0
ds_read_b64_tr_b16 v[194:195],v40 offset:1024
ds_read_b64_tr_b16 v[196:197],v41 offset:0
ds_read_b64_tr_b16 v[198:199],v41 offset:1024
ds_read_b64_tr_b16 v[200:201],v42 offset:0
ds_read_b64_tr_b16 v[202:203],v42 offset:1024
ds_read_b64_tr_b16 v[204:205],v43 offset:0
ds_read_b64_tr_b16 v[206:207],v43 offset:1024
ds_read_b64_tr_b16 v[208:209],v248 offset:0
ds_read_b64_tr_b16 v[210:211],v248 offset:1024
s_setprio 3
s_waitcnt lgkmcnt(8)
v_mfma_f32_16x16x32_bf16 v[128:131],v[192:195],v[24:27],0
ds_read_b64_tr_b16 v[212:213],v249 offset:0
ds_read_b64_tr_b16 v[214:215],v249 offset:1024
v_mfma_f32_16x16x32_bf16 v[132:135],v[192:195],v[28:31],0
s_add_u32 m0,s39,65536
s_add_u32 s26,s84,0
buffer_load_dwordx4 v10,s[76:79],s26 offen lds
s_waitcnt lgkmcnt(8)
v_mfma_f32_16x16x32_bf16 v[140:143],v[196:199],v[28:31],0
s_add_u32 m0,s39,66560
s_add_u32 s26,s84,32768
buffer_load_dwordx4 v10,s[76:79],s26 offen lds
v_mfma_f32_16x16x32_bf16 v[136:139],v[196:199],v[24:27],0
v_mov_b32 v14,131072
v_mov_b32 v15,0
ds_write_b32 v14,v15
ds_read_b64_tr_b16 v[216:217],v250 offset:0
ds_read_b64_tr_b16 v[218:219],v250 offset:1024
s_waitcnt lgkmcnt(9)
v_mfma_f32_16x16x32_bf16 v[144:147],v[200:203],v[24:27],0
buffer_load_dwordx4 v[232:235],v2,s[8:11],s90 offen offset:0 sc1
ds_read_b64_tr_b16 v[220:221],v251 offset:0
ds_read_b64_tr_b16 v[222:223],v251 offset:1024
v_mfma_f32_16x16x32_bf16 v[148:151],v[200:203],v[28:31],0
v_bfe_u32 v16,v1,3,1
s_lshl_b32 s26,s17,1
v_add_u32 v16,s26,v16
v_mul_u32_u24 v16,205,v16
v_lshrrev_b32 v16,10,v16
v_bfe_u32 v17,v1,4,1
v_mul_u32_u24 v17,13,v17
v_add_u32 v16,v16,v17
v_lshlrev_b32 v16,8,v16
v_add_u32 v16,101777408,v16
s_waitcnt lgkmcnt(9)
v_mfma_f32_16x16x32_bf16 v[156:159],v[204:207],v[28:31],0
buffer_load_dwordx4 v[236:239],v2,s[8:11],s90 offen offset:1024 sc1
v_mfma_f32_16x16x32_bf16 v[152:155],v[204:207],v[24:27],0
s_and_b32 s26,s2,7
s_lshl_b32 s26,s26,8
s_add_u32 s26,s26,101785600
v_mov_b32 v17,s26
v_cmp_gt_u32 vcc,32,v1
v_min_u32 v253,47,v1
v_lshl_add_u32 v253,v253,2,v17
v_cndmask_b32 v16,v17,v16,vcc
v_and_b32 v17,7,v1
v_lshl_add_u32 v4,v17,2,v16
ds_read_b64_tr_b16 v[224:225],v40 offset:8192
ds_read_b64_tr_b16 v[226:227],v40 offset:9216
s_waitcnt lgkmcnt(9)
v_mfma_f32_16x16x32_bf16 v[160:163],v[208:211],v[24:27],0
ds_read_b64_tr_b16 v[228:229],v41 offset:8192
ds_read_b64_tr_b16 v[230:231],v41 offset:9216
v_mfma_f32_16x16x32_bf16 v[164:167],v[208:211],v[28:31],0
v_and_b32 v16,31,v1
s_waitcnt lgkmcnt(9)
v_mfma_f32_16x16x32_bf16 v[172:175],v[212:215],v[28:31],0
buffer_load_dwordx4 v[240:243],v2,s[8:11],s90 offen offset:2048 sc1
v_mfma_f32_16x16x32_bf16 v[168:171],v[212:215],v[24:27],0
v_lshlrev_b32 v252,2,v16
ds_read_b64_tr_b16 v[192:193],v42 offset:8192
ds_read_b64_tr_b16 v[194:195],v42 offset:9216
s_waitcnt lgkmcnt(8)
v_mfma_f32_16x16x32_bf16 v[176:179],v[216:219],v[24:27],0
buffer_load_dwordx4 v[244:247],v2,s[8:11],s90 offen offset:3072 sc1
ds_read_b64_tr_b16 v[196:197],v43 offset:8192
ds_read_b64_tr_b16 v[198:199],v43 offset:9216
v_mfma_f32_16x16x32_bf16 v[180:183],v[216:219],v[28:31],0
v_lshrrev_b32 v17,5,v1
s_waitcnt lgkmcnt(8)
v_mfma_f32_16x16x32_bf16 v[188:191],v[220:223],v[28:31],0
s_add_u32 m0,s39,81920
s_add_u32 s26,s85,0
buffer_load_dwordx4 v10,s[76:79],s26 offen lds
v_mfma_f32_16x16x32_bf16 v[184:187],v[220:223],v[24:27],0
v_lshlrev_b32 v17,2,v17
ds_read_b64_tr_b16 v[200:201],v248 offset:8192
ds_read_b64_tr_b16 v[202:203],v248 offset:9216
s_setprio 2
s_waitcnt lgkmcnt(8)
v_mfma_f32_16x16x32_bf16 v[128:131],v[224:227],v[32:35],v[128:131]
s_add_u32 m0,s39,82944
s_add_u32 s26,s85,32768
buffer_load_dwordx4 v10,s[76:79],s26 offen lds
ds_read_b64_tr_b16 v[204:205],v249 offset:8192
ds_read_b64_tr_b16 v[206:207],v249 offset:9216
v_mfma_f32_16x16x32_bf16 v[132:135],v[224:227],v[36:39],v[132:135]
v_sub_u32 v16,v16,v17
s_waitcnt lgkmcnt(8)
v_mfma_f32_16x16x32_bf16 v[140:143],v[228:231],v[36:39],v[140:143]
v_mfma_f32_16x16x32_bf16 v[136:139],v[228:231],v[32:35],v[136:139]
v_mov_b32 v9,0xf149f2ca
ds_read_b64_tr_b16 v[208:209],v250 offset:8192
ds_read_b64_tr_b16 v[210:211],v250 offset:9216
s_waitcnt lgkmcnt(8)
v_mfma_f32_16x16x32_bf16 v[144:147],v[192:195],v[32:35],v[144:147]
ds_read_b64_tr_b16 v[212:213],v251 offset:8192
ds_read_b64_tr_b16 v[214:215],v251 offset:9216
v_mfma_f32_16x16x32_bf16 v[148:151],v[192:195],v[36:39],v[148:151]
v_mov_b32 v13,0x4b800000
s_waitcnt lgkmcnt(8)
v_mfma_f32_16x16x32_bf16 v[156:159],v[196:199],v[36:39],v[156:159]
v_mfma_f32_16x16x32_bf16 v[152:155],v[196:199],v[32:35],v[152:155]
v_mov_b32 v7,0
ds_read_b64_tr_b16 v[216:217],v40 offset:16384
ds_read_b64_tr_b16 v[218:219],v40 offset:17408
s_waitcnt lgkmcnt(8)
v_mfma_f32_16x16x32_bf16 v[160:163],v[200:203],v[32:35],v[160:163]
ds_read_b64_tr_b16 v[220:221],v41 offset:16384
ds_read_b64_tr_b16 v[222:223],v41 offset:17408
v_mfma_f32_16x16x32_bf16 v[164:167],v[200:203],v[36:39],v[164:167]
v_add_u32 v3,131072,v2
s_waitcnt lgkmcnt(8)
v_mfma_f32_16x16x32_bf16 v[172:175],v[204:207],v[36:39],v[172:175]
v_mfma_f32_16x16x32_bf16 v[168:171],v[204:207],v[32:35],v[168:171]
v_cmp_gt_i32 s[40:41],0,v16
ds_read_b64_tr_b16 v[224:225],v42 offset:16384
ds_read_b64_tr_b16 v[226:227],v42 offset:17408
s_waitcnt lgkmcnt(8)
v_mfma_f32_16x16x32_bf16 v[176:179],v[208:211],v[32:35],v[176:179]
ds_read_b64_tr_b16 v[228:229],v43 offset:16384
ds_read_b64_tr_b16 v[230:231],v43 offset:17408
v_mfma_f32_16x16x32_bf16 v[180:183],v[208:211],v[36:39],v[180:183]
v_cmp_gt_i32 s[42:43],1,v16
s_waitcnt lgkmcnt(8)
v_mfma_f32_16x16x32_bf16 v[188:191],v[212:215],v[36:39],v[188:191]
v_mfma_f32_16x16x32_bf16 v[184:187],v[212:215],v[32:35],v[184:187]
ds_read_b64_tr_b16 v[192:193],v248 offset:16384
ds_read_b64_tr_b16 v[194:195],v248 offset:17408
s_setprio 1
s_waitcnt lgkmcnt(8)
s_waitcnt vmcnt(11)
v_mfma_f32_16x16x32_bf16 v[128:131],v[216:219],v[48:51],v[128:131]
ds_read_b64_tr_b16 v[196:197],v249 offset:16384
ds_read_b64_tr_b16 v[198:199],v249 offset:17408
s_waitcnt vmcnt(10)
v_mfma_f32_16x16x32_bf16 v[132:135],v[216:219],v[52:55],v[132:135]
buffer_load_dwordx4 v[24:27],v2,s[8:11],s91 offen offset:0 sc1
s_waitcnt lgkmcnt(8)
v_mfma_f32_16x16x32_bf16 v[140:143],v[220:223],v[52:55],v[140:143]
buffer_load_dwordx4 v[28:31],v2,s[8:11],s91 offen offset:1024 sc1
v_mfma_f32_16x16x32_bf16 v[136:139],v[220:223],v[48:51],v[136:139]
v_cmp_gt_i32 s[44:45],2,v16
v_cmp_gt_i32 s[46:47],3,v16
ds_read_b64_tr_b16 v[200:201],v250 offset:16384
ds_read_b64_tr_b16 v[202:203],v250 offset:17408
s_waitcnt lgkmcnt(8)
v_mfma_f32_16x16x32_bf16 v[144:147],v[224:227],v[48:51],v[144:147]
v_cmp_gt_i32 s[48:49],8,v16
ds_read_b64_tr_b16 v[204:205],v251 offset:16384
ds_read_b64_tr_b16 v[206:207],v251 offset:17408
v_mfma_f32_16x16x32_bf16 v[148:151],v[224:227],v[52:55],v[148:151]
v_cmp_gt_i32 s[50:51],9,v16
s_waitcnt lgkmcnt(8)
v_mfma_f32_16x16x32_bf16 v[156:159],v[228:231],v[52:55],v[156:159]
buffer_load_dwordx4 v[32:35],v2,s[8:11],s91 offen offset:2048 sc1
v_mfma_f32_16x16x32_bf16 v[152:155],v[228:231],v[48:51],v[152:155]
v_cmp_gt_i32 s[52:53],10,v16
v_cmp_gt_i32 s[54:55],11,v16
ds_read_b64_tr_b16 v[208:209],v40 offset:24576
ds_read_b64_tr_b16 v[210:211],v40 offset:25600
s_waitcnt lgkmcnt(8)
v_mfma_f32_16x16x32_bf16 v[160:163],v[192:195],v[48:51],v[160:163]
v_cmp_gt_i32 s[56:57],16,v16
ds_read_b64_tr_b16 v[212:213],v41 offset:24576
ds_read_b64_tr_b16 v[214:215],v41 offset:25600
v_mfma_f32_16x16x32_bf16 v[164:167],v[192:195],v[52:55],v[164:167]
v_cmp_gt_i32 s[58:59],17,v16
s_waitcnt lgkmcnt(8)
v_mfma_f32_16x16x32_bf16 v[172:175],v[196:199],v[52:55],v[172:175]
buffer_load_dwordx4 v[36:39],v2,s[8:11],s91 offen offset:3072 sc1
v_mfma_f32_16x16x32_bf16 v[168:171],v[196:199],v[48:51],v[168:171]
v_cmp_gt_i32 s[60:61],18,v16
v_cmp_gt_i32 s[62:63],19,v16
ds_read_b64_tr_b16 v[216:217],v42 offset:24576
ds_read_b64_tr_b16 v[218:219],v42 offset:25600
s_waitcnt lgkmcnt(8)
v_mfma_f32_16x16x32_bf16 v[176:179],v[200:203],v[48:51],v[176:179]
s_add_u32 m0,s39,98304
s_add_u32 s26,s86,0
buffer_load_dwordx4 v10,s[76:79],s26 offen lds
ds_read_b64_tr_b16 v[220:221],v43 offset:24576
ds_read_b64_tr_b16 v[222:223],v43 offset:25600
v_mfma_f32_16x16x32_bf16 v[180:183],v[200:203],v[52:55],v[180:183]
v_cmp_gt_i32 s[64:65],24,v16
v_cmp_gt_i32 s[66:67],25,v16
s_waitcnt lgkmcnt(8)
v_mfma_f32_16x16x32_bf16 v[188:191],v[204:207],v[52:55],v[188:191]
v_cmp_gt_i32 s[68:69],26,v16
v_mfma_f32_16x16x32_bf16 v[184:187],v[204:207],v[48:51],v[184:187]
v_cmp_gt_i32 s[70:71],27,v16
ds_read_b64_tr_b16 v[224:225],v248 offset:24576
ds_read_b64_tr_b16 v[226:227],v248 offset:25600
s_setprio 0
s_waitcnt lgkmcnt(8)
s_waitcnt vmcnt(14)
v_mfma_f32_16x16x32_bf16 v[128:131],v[208:211],v[56:59],v[128:131]
s_add_u32 m0,s39,99328
s_add_u32 s26,s86,32768
buffer_load_dwordx4 v10,s[76:79],s26 offen lds
ds_read_b64_tr_b16 v[228:229],v249 offset:24576
ds_read_b64_tr_b16 v[230:231],v249 offset:25600
s_waitcnt vmcnt(14)
v_mfma_f32_16x16x32_bf16 v[132:135],v[208:211],v[60:63],v[132:135]
s_and_b32 s26,s2,7
s_lshl_b32 s33,s26,19
s_bfe_u32 s27,s2,0x20003
s_mul_i32 s27,s27,131328
s_add_u32 s33,s33,s27
s_and_b32 s27,s16,3
s_lshl_b32 s27,s27,15
s_add_u32 s33,s33,s27
s_lshl_b32 s26,s26,4
v_and_b32 v254,3,v1
v_lshl_add_u32 v254,v254,2,s26
s_lshr_b32 s6,s2,5
s_lshl_b32 s6,s6,2
s_add_u32 s6,s6,s16
s_sub_u32 s27,67,s6
s_cmp_lt_u32 s16,4
s_cselect_b32 s6,s6,s27
s_lshl_b32 s26,s6,7
s_add_u32 s26,s26,101789696
v_add_u32 v254,s26,v254
s_sub_u32 s27,63,s6
s_min_u32 s27,s27,s6
s_lshr_b32 s27,s27,1
s_lshl_b32 s27,s27,7
s_add_u32 s27,s27,101797888
s_sub_u32 s27,s27,s26
v_bfe_u32 v16,v1,2,1
v_mad_u32_u24 v254,v16,s27,v254
s_waitcnt lgkmcnt(8)
v_mfma_f32_16x16x32_bf16 v[140:143],v[212:215],v[60:63],v[140:143]
v_lshrrev_b32 v255,4,v1
v_lshlrev_b32 v16,2,v255
v_and_b32 v17,15,v1
v_xor_b32 v16,v16,v17
v_lshlrev_b32 v16,4,v16
v_lshl_add_u32 v255,v255,10,v16
v_mfma_f32_16x16x32_bf16 v[136:139],v[212:215],v[56:59],v[136:139]
v_mov_b32 v64,0
ds_read_b64_tr_b16 v[192:193],v250 offset:24576
ds_read_b64_tr_b16 v[194:195],v250 offset:25600
s_waitcnt lgkmcnt(8)
v_mfma_f32_16x16x32_bf16 v[144:147],v[216:219],v[56:59],v[144:147]
v_mov_b32 v65,0
ds_read_b64_tr_b16 v[196:197],v251 offset:24576
ds_read_b64_tr_b16 v[198:199],v251 offset:25600
v_mfma_f32_16x16x32_bf16 v[148:151],v[216:219],v[60:63],v[148:151]
v_mov_b32 v66,0
s_waitcnt lgkmcnt(8)
v_mfma_f32_16x16x32_bf16 v[156:159],v[220:223],v[60:63],v[156:159]
v_mov_b32 v67,0
v_mfma_f32_16x16x32_bf16 v[152:155],v[220:223],v[56:59],v[152:155]
v_mov_b32 v68,0
ds_read_b64_tr_b16 v[200:201],v40 offset:32768
ds_read_b64_tr_b16 v[202:203],v40 offset:33792
s_waitcnt lgkmcnt(8)
v_mfma_f32_16x16x32_bf16 v[160:163],v[224:227],v[56:59],v[160:163]
v_mov_b32 v69,0
ds_read_b64_tr_b16 v[204:205],v41 offset:32768
ds_read_b64_tr_b16 v[206:207],v41 offset:33792
v_mfma_f32_16x16x32_bf16 v[164:167],v[224:227],v[60:63],v[164:167]
v_mov_b32 v70,0
s_waitcnt lgkmcnt(8)
v_mfma_f32_16x16x32_bf16 v[172:175],v[228:231],v[60:63],v[172:175]
v_mov_b32 v71,0
v_mfma_f32_16x16x32_bf16 v[168:171],v[228:231],v[56:59],v[168:171]
v_mov_b32 v72,0
ds_read_b64_tr_b16 v[208:209],v42 offset:32768
ds_read_b64_tr_b16 v[210:211],v42 offset:33792
s_waitcnt lgkmcnt(8)
v_mfma_f32_16x16x32_bf16 v[176:179],v[192:195],v[56:59],v[176:179]
v_mov_b32 v73,0
ds_read_b64_tr_b16 v[212:213],v43 offset:32768
ds_read_b64_tr_b16 v[214:215],v43 offset:33792
v_mfma_f32_16x16x32_bf16 v[180:183],v[192:195],v[60:63],v[180:183]
v_mov_b32 v74,0
s_waitcnt lgkmcnt(8)
v_mfma_f32_16x16x32_bf16 v[188:191],v[196:199],v[60:63],v[188:191]
v_mov_b32 v75,0
v_mfma_f32_16x16x32_bf16 v[184:187],v[196:199],v[56:59],v[184:187]
v_mov_b32 v76,0
s_waitcnt vmcnt(6)
s_barrier
ds_read_b64_tr_b16 v[216:217],v248 offset:32768
ds_read_b64_tr_b16 v[218:219],v248 offset:33792
s_setprio 3
s_waitcnt lgkmcnt(8)
v_mfma_f32_16x16x32_bf16 v[128:131],v[200:203],v[232:235],v[128:131]
ds_read_b64_tr_b16 v[220:221],v249 offset:32768
ds_read_b64_tr_b16 v[222:223],v249 offset:33792
v_mfma_f32_16x16x32_bf16 v[132:135],v[200:203],v[236:239],v[132:135]
buffer_load_dwordx4 v[48:51],v2,s[8:11],s92 offen offset:0 sc1
s_waitcnt lgkmcnt(8)
v_mfma_f32_16x16x32_bf16 v[140:143],v[204:207],v[236:239],v[140:143]
buffer_load_dwordx4 v[52:55],v2,s[8:11],s92 offen offset:1024 sc1
v_mfma_f32_16x16x32_bf16 v[136:139],v[204:207],v[232:235],v[136:139]
v_mov_b32 v77,0
v_mov_b32 v78,0
ds_read_b64_tr_b16 v[224:225],v250 offset:32768
ds_read_b64_tr_b16 v[226:227],v250 offset:33792
s_waitcnt lgkmcnt(8)
v_mfma_f32_16x16x32_bf16 v[144:147],v[208:211],v[232:235],v[144:147]
v_mov_b32 v79,0
ds_read_b64_tr_b16 v[228:229],v251 offset:32768
ds_read_b64_tr_b16 v[230:231],v251 offset:33792
v_mfma_f32_16x16x32_bf16 v[148:151],v[208:211],v[236:239],v[148:151]
v_mov_b32 v80,0
s_waitcnt lgkmcnt(8)
v_mfma_f32_16x16x32_bf16 v[156:159],v[212:215],v[236:239],v[156:159]
buffer_load_dwordx4 v[56:59],v2,s[8:11],s92 offen offset:2048 sc1
v_mfma_f32_16x16x32_bf16 v[152:155],v[212:215],v[232:235],v[152:155]
v_mov_b32 v81,0
v_mov_b32 v82,0
ds_read_b64_tr_b16 v[192:193],v40 offset:40960
ds_read_b64_tr_b16 v[194:195],v40 offset:41984
s_waitcnt lgkmcnt(8)
v_mfma_f32_16x16x32_bf16 v[160:163],v[216:219],v[232:235],v[160:163]
v_mov_b32 v83,0
ds_read_b64_tr_b16 v[196:197],v41 offset:40960
ds_read_b64_tr_b16 v[198:199],v41 offset:41984
v_mfma_f32_16x16x32_bf16 v[164:167],v[216:219],v[236:239],v[164:167]
v_mov_b32 v84,0
s_waitcnt lgkmcnt(8)
v_mfma_f32_16x16x32_bf16 v[172:175],v[220:223],v[236:239],v[172:175]
buffer_load_dwordx4 v[60:63],v2,s[8:11],s92 offen offset:3072 sc1
v_mfma_f32_16x16x32_bf16 v[168:171],v[220:223],v[232:235],v[168:171]
v_mov_b32 v85,0
v_mov_b32 v86,0
ds_read_b64_tr_b16 v[200:201],v42 offset:40960
ds_read_b64_tr_b16 v[202:203],v42 offset:41984
s_waitcnt lgkmcnt(8)
v_mfma_f32_16x16x32_bf16 v[176:179],v[224:227],v[232:235],v[176:179]
s_add_u32 m0,s39,114688
s_add_u32 s26,s87,0
buffer_load_dwordx4 v10,s[76:79],s26 offen lds
ds_read_b64_tr_b16 v[204:205],v43 offset:40960
ds_read_b64_tr_b16 v[206:207],v43 offset:41984
v_mfma_f32_16x16x32_bf16 v[180:183],v[224:227],v[236:239],v[180:183]
v_mov_b32 v87,0
v_mov_b32 v88,0
s_waitcnt lgkmcnt(8)
v_mfma_f32_16x16x32_bf16 v[188:191],v[228:231],v[236:239],v[188:191]
v_mov_b32 v89,0
v_mfma_f32_16x16x32_bf16 v[184:187],v[228:231],v[232:235],v[184:187]
v_mov_b32 v90,0
ds_read_b64_tr_b16 v[208:209],v248 offset:40960
ds_read_b64_tr_b16 v[210:211],v248 offset:41984
s_waitcnt lgkmcnt(8)
v_mfma_f32_16x16x32_bf16 v[128:131],v[192:195],v[240:243],v[128:131]
s_add_u32 m0,s39,115712
s_add_u32 s26,s87,32768
buffer_load_dwordx4 v10,s[76:79],s26 offen lds
ds_read_b64_tr_b16 v[212:213],v249 offset:40960
ds_read_b64_tr_b16 v[214:215],v249 offset:41984
v_mfma_f32_16x16x32_bf16 v[132:135],v[192:195],v[244:247],v[132:135]
v_mov_b32 v91,0
v_mov_b32 v92,0
s_waitcnt lgkmcnt(8)
v_mfma_f32_16x16x32_bf16 v[140:143],v[196:199],v[244:247],v[140:143]
v_mov_b32 v93,0
v_mfma_f32_16x16x32_bf16 v[136:139],v[196:199],v[240:243],v[136:139]
v_mov_b32 v94,0
ds_read_b64_tr_b16 v[216:217],v250 offset:40960
ds_read_b64_tr_b16 v[218:219],v250 offset:41984
s_waitcnt lgkmcnt(8)
v_mfma_f32_16x16x32_bf16 v[144:147],v[200:203],v[240:243],v[144:147]
v_mov_b32 v95,0
ds_read_b64_tr_b16 v[220:221],v251 offset:40960
ds_read_b64_tr_b16 v[222:223],v251 offset:41984
v_mfma_f32_16x16x32_bf16 v[148:151],v[200:203],v[244:247],v[148:151]
v_mov_b32 v96,0
s_waitcnt lgkmcnt(8)
v_mfma_f32_16x16x32_bf16 v[156:159],v[204:207],v[244:247],v[156:159]
v_mov_b32 v97,0
v_mfma_f32_16x16x32_bf16 v[152:155],v[204:207],v[240:243],v[152:155]
v_mov_b32 v98,0
ds_read_b64_tr_b16 v[224:225],v40 offset:49152
ds_read_b64_tr_b16 v[226:227],v40 offset:50176
s_setprio 2
s_waitcnt lgkmcnt(8)
v_mfma_f32_16x16x32_bf16 v[160:163],v[208:211],v[240:243],v[160:163]
v_mov_b32 v99,0
ds_read_b64_tr_b16 v[228:229],v41 offset:49152
ds_read_b64_tr_b16 v[230:231],v41 offset:50176
v_mfma_f32_16x16x32_bf16 v[164:167],v[208:211],v[244:247],v[164:167]
v_mov_b32 v100,0
s_waitcnt lgkmcnt(8)
v_mfma_f32_16x16x32_bf16 v[172:175],v[212:215],v[244:247],v[172:175]
v_mov_b32 v101,0
v_mfma_f32_16x16x32_bf16 v[168:171],v[212:215],v[240:243],v[168:171]
v_mov_b32 v102,0
ds_read_b64_tr_b16 v[192:193],v42 offset:49152
ds_read_b64_tr_b16 v[194:195],v42 offset:50176
s_waitcnt lgkmcnt(8)
v_mfma_f32_16x16x32_bf16 v[176:179],v[216:219],v[240:243],v[176:179]
v_mov_b32 v103,0
ds_read_b64_tr_b16 v[196:197],v43 offset:49152
ds_read_b64_tr_b16 v[198:199],v43 offset:50176
v_mfma_f32_16x16x32_bf16 v[180:183],v[216:219],v[244:247],v[180:183]
v_mov_b32 v104,0
s_waitcnt lgkmcnt(8)
v_mfma_f32_16x16x32_bf16 v[188:191],v[220:223],v[244:247],v[188:191]
v_mov_b32 v105,0
v_mfma_f32_16x16x32_bf16 v[184:187],v[220:223],v[240:243],v[184:187]
v_mov_b32 v106,0
ds_read_b64_tr_b16 v[200:201],v248 offset:49152
ds_read_b64_tr_b16 v[202:203],v248 offset:50176
s_waitcnt lgkmcnt(8)
s_waitcnt vmcnt(11)
v_mfma_f32_16x16x32_bf16 v[128:131],v[224:227],v[24:27],v[128:131]
ds_read_b64_tr_b16 v[204:205],v249 offset:49152
ds_read_b64_tr_b16 v[206:207],v249 offset:50176
s_waitcnt vmcnt(10)
v_mfma_f32_16x16x32_bf16 v[132:135],v[224:227],v[28:31],v[132:135]
buffer_load_dwordx4 v[232:235],v2,s[8:11],s93 offen offset:0 sc1
s_waitcnt lgkmcnt(8)
v_mfma_f32_16x16x32_bf16 v[140:143],v[228:231],v[28:31],v[140:143]
v_mov_b32 v107,0
v_mfma_f32_16x16x32_bf16 v[136:139],v[228:231],v[24:27],v[136:139]
v_mov_b32 v108,0
ds_read_b64_tr_b16 v[208:209],v250 offset:49152
ds_read_b64_tr_b16 v[210:211],v250 offset:50176
s_waitcnt lgkmcnt(8)
v_mfma_f32_16x16x32_bf16 v[144:147],v[192:195],v[24:27],v[144:147]
buffer_load_dwordx4 v[236:239],v2,s[8:11],s93 offen offset:1024 sc1
ds_read_b64_tr_b16 v[212:213],v251 offset:49152
ds_read_b64_tr_b16 v[214:215],v251 offset:50176
v_mfma_f32_16x16x32_bf16 v[148:151],v[192:195],v[28:31],v[148:151]
v_mov_b32 v109,0
s_waitcnt lgkmcnt(8)
v_mfma_f32_16x16x32_bf16 v[156:159],v[196:199],v[28:31],v[156:159]
v_mov_b32 v110,0
v_mfma_f32_16x16x32_bf16 v[152:155],v[196:199],v[24:27],v[152:155]
v_mov_b32 v111,0
ds_read_b64_tr_b16 v[216:217],v40 offset:57344
ds_read_b64_tr_b16 v[218:219],v40 offset:58368
s_waitcnt lgkmcnt(8)
v_mfma_f32_16x16x32_bf16 v[160:163],v[200:203],v[24:27],v[160:163]
ds_read_b64_tr_b16 v[220:221],v41 offset:57344
ds_read_b64_tr_b16 v[222:223],v41 offset:58368
v_mfma_f32_16x16x32_bf16 v[164:167],v[200:203],v[28:31],v[164:167]
v_mov_b32 v112,0
s_waitcnt lgkmcnt(8)
v_mfma_f32_16x16x32_bf16 v[172:175],v[204:207],v[28:31],v[172:175]
buffer_load_dwordx4 v[240:243],v2,s[8:11],s93 offen offset:2048 sc1
v_mfma_f32_16x16x32_bf16 v[168:171],v[204:207],v[24:27],v[168:171]
v_mov_b32 v113,0
ds_read_b64_tr_b16 v[224:225],v42 offset:57344
ds_read_b64_tr_b16 v[226:227],v42 offset:58368
s_waitcnt lgkmcnt(8)
v_mfma_f32_16x16x32_bf16 v[176:179],v[208:211],v[24:27],v[176:179]
v_mov_b32 v114,0
ds_read_b64_tr_b16 v[228:229],v43 offset:57344
ds_read_b64_tr_b16 v[230:231],v43 offset:58368
v_mfma_f32_16x16x32_bf16 v[180:183],v[208:211],v[28:31],v[180:183]
v_mov_b32 v115,0
s_waitcnt lgkmcnt(8)
v_mfma_f32_16x16x32_bf16 v[188:191],v[212:215],v[28:31],v[188:191]
buffer_load_dwordx4 v[244:247],v2,s[8:11],s93 offen offset:3072 sc1
v_mfma_f32_16x16x32_bf16 v[184:187],v[212:215],v[24:27],v[184:187]
v_mov_b32 v116,0
ds_read_b64_tr_b16 v[192:193],v248 offset:57344
ds_read_b64_tr_b16 v[194:195],v248 offset:58368
s_setprio 1
s_waitcnt lgkmcnt(8)
s_waitcnt vmcnt(13)
v_mfma_f32_16x16x32_bf16 v[128:131],v[216:219],v[32:35],v[128:131]
v_mov_b32 v117,0
ds_read_b64_tr_b16 v[196:197],v249 offset:57344
ds_read_b64_tr_b16 v[198:199],v249 offset:58368
s_waitcnt vmcnt(12)
v_mfma_f32_16x16x32_bf16 v[132:135],v[216:219],v[36:39],v[132:135]
v_mov_b32 v118,0
s_waitcnt lgkmcnt(8)
v_mfma_f32_16x16x32_bf16 v[140:143],v[220:223],v[36:39],v[140:143]
v_mfma_f32_16x16x32_bf16 v[136:139],v[220:223],v[32:35],v[136:139]
v_mov_b32 v119,0
ds_read_b64_tr_b16 v[200:201],v250 offset:57344
ds_read_b64_tr_b16 v[202:203],v250 offset:58368
s_waitcnt lgkmcnt(8)
v_mfma_f32_16x16x32_bf16 v[144:147],v[224:227],v[32:35],v[144:147]
ds_read_b64_tr_b16 v[204:205],v251 offset:57344
ds_read_b64_tr_b16 v[206:207],v251 offset:58368
v_mfma_f32_16x16x32_bf16 v[148:151],v[224:227],v[36:39],v[148:151]
v_mov_b32 v120,0
s_waitcnt lgkmcnt(8)
v_mfma_f32_16x16x32_bf16 v[156:159],v[228:231],v[36:39],v[156:159]
v_mov_b32 v121,0
v_mfma_f32_16x16x32_bf16 v[152:155],v[228:231],v[32:35],v[152:155]
v_mov_b32 v122,0
v_add_u32 v40,65536,v40
v_add_u32 v41,65536,v41
ds_read_b64_tr_b16 v[208:209],v40 offset:0
ds_read_b64_tr_b16 v[210:211],v40 offset:1024
s_waitcnt lgkmcnt(8)
v_mfma_f32_16x16x32_bf16 v[160:163],v[192:195],v[32:35],v[160:163]
ds_read_b64_tr_b16 v[212:213],v41 offset:0
ds_read_b64_tr_b16 v[214:215],v41 offset:1024
v_mfma_f32_16x16x32_bf16 v[164:167],v[192:195],v[36:39],v[164:167]
v_mov_b32 v123,0
s_waitcnt lgkmcnt(8)
v_mfma_f32_16x16x32_bf16 v[172:175],v[196:199],v[36:39],v[172:175]
v_mov_b32 v124,0
v_mfma_f32_16x16x32_bf16 v[168:171],v[196:199],v[32:35],v[168:171]
v_mov_b32 v125,0
v_add_u32 v42,65536,v42
v_add_u32 v43,65536,v43
ds_read_b64_tr_b16 v[216:217],v42 offset:0
ds_read_b64_tr_b16 v[218:219],v42 offset:1024
s_waitcnt lgkmcnt(8)
v_mfma_f32_16x16x32_bf16 v[176:179],v[200:203],v[32:35],v[176:179]
ds_read_b64_tr_b16 v[220:221],v43 offset:0
ds_read_b64_tr_b16 v[222:223],v43 offset:1024
v_mfma_f32_16x16x32_bf16 v[180:183],v[200:203],v[36:39],v[180:183]
v_mov_b32 v126,0
s_waitcnt lgkmcnt(8)
v_mfma_f32_16x16x32_bf16 v[188:191],v[204:207],v[36:39],v[188:191]
v_mfma_f32_16x16x32_bf16 v[184:187],v[204:207],v[32:35],v[184:187]
v_mov_b32 v127,0
v_add_u32 v248,65536,v248
v_add_u32 v249,65536,v249
ds_read_b64_tr_b16 v[224:225],v248 offset:0
ds_read_b64_tr_b16 v[226:227],v248 offset:1024
s_waitcnt lgkmcnt(8)
s_waitcnt vmcnt(9)
v_mfma_f32_16x16x32_bf16 v[128:131],v[208:211],v[48:51],v[128:131]
ds_read_b64_tr_b16 v[228:229],v249 offset:0
ds_read_b64_tr_b16 v[230:231],v249 offset:1024
s_waitcnt vmcnt(8)
v_mfma_f32_16x16x32_bf16 v[132:135],v[208:211],v[52:55],v[132:135]
buffer_load_dwordx4 v[24:27],v2,s[8:11],s94 offen offset:0 sc1
s_waitcnt lgkmcnt(8)
v_mfma_f32_16x16x32_bf16 v[140:143],v[212:215],v[52:55],v[140:143]
v_mfma_f32_16x16x32_bf16 v[136:139],v[212:215],v[48:51],v[136:139]
v_add_u32 v250,65536,v250
v_add_u32 v251,65536,v251
ds_read_b64_tr_b16 v[192:193],v250 offset:0
ds_read_b64_tr_b16 v[194:195],v250 offset:1024
s_waitcnt lgkmcnt(8)
v_mfma_f32_16x16x32_bf16 v[144:147],v[216:219],v[48:51],v[144:147]
ds_read_b64_tr_b16 v[196:197],v251 offset:0
ds_read_b64_tr_b16 v[198:199],v251 offset:1024
v_mfma_f32_16x16x32_bf16 v[148:151],v[216:219],v[52:55],v[148:151]
buffer_load_dwordx4 v[28:31],v2,s[8:11],s94 offen offset:1024 sc1
s_waitcnt lgkmcnt(8)
v_mfma_f32_16x16x32_bf16 v[156:159],v[220:223],v[52:55],v[156:159]
v_mfma_f32_16x16x32_bf16 v[152:155],v[220:223],v[48:51],v[152:155]
ds_read_b64_tr_b16 v[200:201],v40 offset:8192
ds_read_b64_tr_b16 v[202:203],v40 offset:9216
s_setprio 0
s_waitcnt lgkmcnt(8)
v_mfma_f32_16x16x32_bf16 v[160:163],v[224:227],v[48:51],v[160:163]
ds_read_b64_tr_b16 v[204:205],v41 offset:8192
ds_read_b64_tr_b16 v[206:207],v41 offset:9216
v_mfma_f32_16x16x32_bf16 v[164:167],v[224:227],v[52:55],v[164:167]
s_waitcnt lgkmcnt(8)
v_mfma_f32_16x16x32_bf16 v[172:175],v[228:231],v[52:55],v[172:175]
v_mfma_f32_16x16x32_bf16 v[168:171],v[228:231],v[48:51],v[168:171]
buffer_load_dwordx4 v[32:35],v2,s[8:11],s94 offen offset:2048 sc1
ds_read_b64_tr_b16 v[208:209],v42 offset:8192
ds_read_b64_tr_b16 v[210:211],v42 offset:9216
s_waitcnt lgkmcnt(8)
v_mfma_f32_16x16x32_bf16 v[176:179],v[192:195],v[48:51],v[176:179]
ds_read_b64_tr_b16 v[212:213],v43 offset:8192
ds_read_b64_tr_b16 v[214:215],v43 offset:9216
v_mfma_f32_16x16x32_bf16 v[180:183],v[192:195],v[52:55],v[180:183]
s_waitcnt lgkmcnt(8)
v_mfma_f32_16x16x32_bf16 v[188:191],v[196:199],v[52:55],v[188:191]
v_mfma_f32_16x16x32_bf16 v[184:187],v[196:199],v[48:51],v[184:187]
buffer_load_dwordx4 v[36:39],v2,s[8:11],s94 offen offset:3072 sc1
ds_read_b64_tr_b16 v[216:217],v248 offset:8192
ds_read_b64_tr_b16 v[218:219],v248 offset:9216
s_waitcnt lgkmcnt(8)
s_waitcnt vmcnt(11)
v_mfma_f32_16x16x32_bf16 v[128:131],v[200:203],v[56:59],v[128:131]
ds_read_b64_tr_b16 v[220:221],v249 offset:8192
ds_read_b64_tr_b16 v[222:223],v249 offset:9216
s_waitcnt vmcnt(10)
v_mfma_f32_16x16x32_bf16 v[132:135],v[200:203],v[60:63],v[132:135]
s_waitcnt lgkmcnt(8)
v_mfma_f32_16x16x32_bf16 v[140:143],v[204:207],v[60:63],v[140:143]
v_mfma_f32_16x16x32_bf16 v[136:139],v[204:207],v[56:59],v[136:139]
ds_read_b64_tr_b16 v[224:225],v250 offset:8192
ds_read_b64_tr_b16 v[226:227],v250 offset:9216
s_waitcnt lgkmcnt(8)
v_mfma_f32_16x16x32_bf16 v[144:147],v[208:211],v[56:59],v[144:147]
ds_read_b64_tr_b16 v[228:229],v251 offset:8192
ds_read_b64_tr_b16 v[230:231],v251 offset:9216
v_mfma_f32_16x16x32_bf16 v[148:151],v[208:211],v[60:63],v[148:151]
s_waitcnt lgkmcnt(8)
v_mfma_f32_16x16x32_bf16 v[156:159],v[212:215],v[60:63],v[156:159]
v_mfma_f32_16x16x32_bf16 v[152:155],v[212:215],v[56:59],v[152:155]
ds_read_b64_tr_b16 v[192:193],v40 offset:16384
ds_read_b64_tr_b16 v[194:195],v40 offset:17408
s_waitcnt lgkmcnt(8)
v_mfma_f32_16x16x32_bf16 v[160:163],v[216:219],v[56:59],v[160:163]
ds_read_b64_tr_b16 v[196:197],v41 offset:16384
ds_read_b64_tr_b16 v[198:199],v41 offset:17408
v_mfma_f32_16x16x32_bf16 v[164:167],v[216:219],v[60:63],v[164:167]
s_waitcnt lgkmcnt(8)
v_mfma_f32_16x16x32_bf16 v[172:175],v[220:223],v[60:63],v[172:175]
v_mfma_f32_16x16x32_bf16 v[168:171],v[220:223],v[56:59],v[168:171]
ds_read_b64_tr_b16 v[200:201],v42 offset:16384
ds_read_b64_tr_b16 v[202:203],v42 offset:17408
s_waitcnt lgkmcnt(8)
v_mfma_f32_16x16x32_bf16 v[176:179],v[224:227],v[56:59],v[176:179]
ds_read_b64_tr_b16 v[204:205],v43 offset:16384
ds_read_b64_tr_b16 v[206:207],v43 offset:17408
v_mfma_f32_16x16x32_bf16 v[180:183],v[224:227],v[60:63],v[180:183]
s_waitcnt lgkmcnt(8)
v_mfma_f32_16x16x32_bf16 v[188:191],v[228:231],v[60:63],v[188:191]
v_mfma_f32_16x16x32_bf16 v[184:187],v[228:231],v[56:59],v[184:187]
s_waitcnt vmcnt(8)
s_barrier
ds_read_b64_tr_b16 v[208:209],v248 offset:16384
ds_read_b64_tr_b16 v[210:211],v248 offset:17408
s_setprio 3
s_waitcnt lgkmcnt(8)
s_waitcnt vmcnt(7)
v_mfma_f32_16x16x32_bf16 v[128:131],v[192:195],v[232:235],v[128:131]
ds_read_b64_tr_b16 v[212:213],v249 offset:16384
ds_read_b64_tr_b16 v[214:215],v249 offset:17408
s_waitcnt vmcnt(6)
v_mfma_f32_16x16x32_bf16 v[132:135],v[192:195],v[236:239],v[132:135]
buffer_load_dwordx4 v[48:51],v2,s[8:11],s95 offen offset:0 sc1
s_waitcnt lgkmcnt(8)
v_mfma_f32_16x16x32_bf16 v[140:143],v[196:199],v[236:239],v[140:143]
v_mfma_f32_16x16x32_bf16 v[136:139],v[196:199],v[232:235],v[136:139]
ds_read_b64_tr_b16 v[216:217],v250 offset:16384
ds_read_b64_tr_b16 v[218:219],v250 offset:17408
s_waitcnt lgkmcnt(8)
v_mfma_f32_16x16x32_bf16 v[144:147],v[200:203],v[232:235],v[144:147]
ds_read_b64_tr_b16 v[220:221],v251 offset:16384
ds_read_b64_tr_b16 v[222:223],v251 offset:17408
v_mfma_f32_16x16x32_bf16 v[148:151],v[200:203],v[236:239],v[148:151]
buffer_load_dwordx4 v[52:55],v2,s[8:11],s95 offen offset:1024 sc1
s_waitcnt lgkmcnt(8)
v_mfma_f32_16x16x32_bf16 v[156:159],v[204:207],v[236:239],v[156:159]
v_mfma_f32_16x16x32_bf16 v[152:155],v[204:207],v[232:235],v[152:155]
ds_read_b64_tr_b16 v[224:225],v40 offset:24576
ds_read_b64_tr_b16 v[226:227],v40 offset:25600
s_waitcnt lgkmcnt(8)
v_mfma_f32_16x16x32_bf16 v[160:163],v[208:211],v[232:235],v[160:163]
ds_read_b64_tr_b16 v[228:229],v41 offset:24576
ds_read_b64_tr_b16 v[230:231],v41 offset:25600
v_mfma_f32_16x16x32_bf16 v[164:167],v[208:211],v[236:239],v[164:167]
s_waitcnt lgkmcnt(8)
v_mfma_f32_16x16x32_bf16 v[172:175],v[212:215],v[236:239],v[172:175]
v_mfma_f32_16x16x32_bf16 v[168:171],v[212:215],v[232:235],v[168:171]
buffer_load_dwordx4 v[56:59],v2,s[8:11],s95 offen offset:2048 sc1
ds_read_b64_tr_b16 v[192:193],v42 offset:24576
ds_read_b64_tr_b16 v[194:195],v42 offset:25600
s_waitcnt lgkmcnt(8)
v_mfma_f32_16x16x32_bf16 v[176:179],v[216:219],v[232:235],v[176:179]
ds_read_b64_tr_b16 v[196:197],v43 offset:24576
ds_read_b64_tr_b16 v[198:199],v43 offset:25600
v_mfma_f32_16x16x32_bf16 v[180:183],v[216:219],v[236:239],v[180:183]
s_waitcnt lgkmcnt(8)
v_mfma_f32_16x16x32_bf16 v[188:191],v[220:223],v[236:239],v[188:191]
v_mfma_f32_16x16x32_bf16 v[184:187],v[220:223],v[232:235],v[184:187]
buffer_load_dwordx4 v[60:63],v2,s[8:11],s95 offen offset:3072 sc1
ds_read_b64_tr_b16 v[200:201],v248 offset:24576
ds_read_b64_tr_b16 v[202:203],v248 offset:25600
s_setprio 2
s_waitcnt lgkmcnt(8)
s_waitcnt vmcnt(9)
v_mfma_f32_16x16x32_bf16 v[128:131],v[224:227],v[240:243],v[128:131]
ds_read_b64_tr_b16 v[204:205],v249 offset:24576
ds_read_b64_tr_b16 v[206:207],v249 offset:25600
s_waitcnt vmcnt(8)
v_mfma_f32_16x16x32_bf16 v[132:135],v[224:227],v[244:247],v[132:135]
s_waitcnt lgkmcnt(8)
v_mfma_f32_16x16x32_bf16 v[140:143],v[228:231],v[244:247],v[140:143]
v_mfma_f32_16x16x32_bf16 v[136:139],v[228:231],v[240:243],v[136:139]
ds_read_b64_tr_b16 v[208:209],v250 offset:24576
ds_read_b64_tr_b16 v[210:211],v250 offset:25600
s_waitcnt lgkmcnt(8)
v_mfma_f32_16x16x32_bf16 v[144:147],v[192:195],v[240:243],v[144:147]
ds_read_b64_tr_b16 v[212:213],v251 offset:24576
ds_read_b64_tr_b16 v[214:215],v251 offset:25600
v_mfma_f32_16x16x32_bf16 v[148:151],v[192:195],v[244:247],v[148:151]
s_waitcnt lgkmcnt(8)
v_mfma_f32_16x16x32_bf16 v[156:159],v[196:199],v[244:247],v[156:159]
v_mfma_f32_16x16x32_bf16 v[152:155],v[196:199],v[240:243],v[152:155]
ds_read_b64_tr_b16 v[216:217],v40 offset:32768
ds_read_b64_tr_b16 v[218:219],v40 offset:33792
s_waitcnt lgkmcnt(8)
v_mfma_f32_16x16x32_bf16 v[160:163],v[200:203],v[240:243],v[160:163]
ds_read_b64_tr_b16 v[220:221],v41 offset:32768
ds_read_b64_tr_b16 v[222:223],v41 offset:33792
v_mfma_f32_16x16x32_bf16 v[164:167],v[200:203],v[244:247],v[164:167]
s_waitcnt lgkmcnt(8)
v_mfma_f32_16x16x32_bf16 v[172:175],v[204:207],v[244:247],v[172:175]
v_mfma_f32_16x16x32_bf16 v[168:171],v[204:207],v[240:243],v[168:171]
ds_read_b64_tr_b16 v[224:225],v42 offset:32768
ds_read_b64_tr_b16 v[226:227],v42 offset:33792
s_waitcnt lgkmcnt(8)
v_mfma_f32_16x16x32_bf16 v[176:179],v[208:211],v[240:243],v[176:179]
ds_read_b64_tr_b16 v[228:229],v43 offset:32768
ds_read_b64_tr_b16 v[230:231],v43 offset:33792
v_mfma_f32_16x16x32_bf16 v[180:183],v[208:211],v[244:247],v[180:183]
s_waitcnt lgkmcnt(8)
v_mfma_f32_16x16x32_bf16 v[188:191],v[212:215],v[244:247],v[188:191]
v_mfma_f32_16x16x32_bf16 v[184:187],v[212:215],v[240:243],v[184:187]
ds_read_b64_tr_b16 v[192:193],v248 offset:32768
ds_read_b64_tr_b16 v[194:195],v248 offset:33792
s_setprio 1
s_waitcnt lgkmcnt(8)
s_waitcnt vmcnt(7)
v_mfma_f32_16x16x32_bf16 v[128:131],v[216:219],v[24:27],v[128:131]
ds_read_b64_tr_b16 v[196:197],v249 offset:32768
ds_read_b64_tr_b16 v[198:199],v249 offset:33792
s_waitcnt vmcnt(6)
v_mfma_f32_16x16x32_bf16 v[132:135],v[216:219],v[28:31],v[132:135]
s_waitcnt lgkmcnt(8)
v_mfma_f32_16x16x32_bf16 v[140:143],v[220:223],v[28:31],v[140:143]
v_mfma_f32_16x16x32_bf16 v[136:139],v[220:223],v[24:27],v[136:139]
ds_read_b64_tr_b16 v[200:201],v250 offset:32768
ds_read_b64_tr_b16 v[202:203],v250 offset:33792
s_waitcnt lgkmcnt(8)
v_mfma_f32_16x16x32_bf16 v[144:147],v[224:227],v[24:27],v[144:147]
ds_read_b64_tr_b16 v[204:205],v251 offset:32768
ds_read_b64_tr_b16 v[206:207],v251 offset:33792
v_mfma_f32_16x16x32_bf16 v[148:151],v[224:227],v[28:31],v[148:151]
v_bfe_u32 v16,v1,2,2
s_waitcnt lgkmcnt(8)
v_mfma_f32_16x16x32_bf16 v[156:159],v[228:231],v[28:31],v[156:159]
v_mfma_f32_16x16x32_bf16 v[152:155],v[228:231],v[24:27],v[152:155]
v_lshrrev_b32 v17,5,v1
ds_read_b64_tr_b16 v[208:209],v40 offset:40960
ds_read_b64_tr_b16 v[210:211],v40 offset:41984
s_waitcnt lgkmcnt(8)
v_mfma_f32_16x16x32_bf16 v[160:163],v[192:195],v[24:27],v[160:163]
ds_read_b64_tr_b16 v[212:213],v41 offset:40960
ds_read_b64_tr_b16 v[214:215],v41 offset:41984
v_mfma_f32_16x16x32_bf16 v[164:167],v[192:195],v[28:31],v[164:167]
v_lshl_add_u32 v247,v17,2,v16
s_waitcnt lgkmcnt(8)
v_mfma_f32_16x16x32_bf16 v[172:175],v[196:199],v[28:31],v[172:175]
v_mfma_f32_16x16x32_bf16 v[168:171],v[196:199],v[24:27],v[168:171]
v_lshlrev_b32 v246,9,v17
ds_read_b64_tr_b16 v[216:217],v42 offset:40960
ds_read_b64_tr_b16 v[218:219],v42 offset:41984
s_waitcnt lgkmcnt(8)
v_mfma_f32_16x16x32_bf16 v[176:179],v[200:203],v[24:27],v[176:179]
ds_read_b64_tr_b16 v[220:221],v43 offset:40960
ds_read_b64_tr_b16 v[222:223],v43 offset:41984
v_mfma_f32_16x16x32_bf16 v[180:183],v[200:203],v[28:31],v[180:183]
v_and_b32 v17,16,v1
s_waitcnt lgkmcnt(8)
v_mfma_f32_16x16x32_bf16 v[188:191],v[204:207],v[28:31],v[188:191]
v_mfma_f32_16x16x32_bf16 v[184:187],v[204:207],v[24:27],v[184:187]
v_add_u32 v247,v17,v247
ds_read_b64_tr_b16 v[224:225],v248 offset:40960
ds_read_b64_tr_b16 v[226:227],v248 offset:41984
s_setprio 0
s_waitcnt lgkmcnt(8)
s_waitcnt vmcnt(5)
v_mfma_f32_16x16x32_bf16 v[128:131],v[208:211],v[32:35],v[128:131]
ds_read_b64_tr_b16 v[228:229],v249 offset:40960
ds_read_b64_tr_b16 v[230:231],v249 offset:41984
s_waitcnt vmcnt(4)
v_mfma_f32_16x16x32_bf16 v[132:135],v[208:211],v[36:39],v[132:135]
v_lshlrev_b32 v247,8,v247
s_waitcnt lgkmcnt(8)
v_mfma_f32_16x16x32_bf16 v[140:143],v[212:215],v[36:39],v[140:143]
v_mfma_f32_16x16x32_bf16 v[136:139],v[212:215],v[32:35],v[136:139]
v_lshl_add_u32 v247,v16,6,v247
ds_read_b64_tr_b16 v[192:193],v250 offset:40960
ds_read_b64_tr_b16 v[194:195],v250 offset:41984
s_waitcnt lgkmcnt(8)
v_mfma_f32_16x16x32_bf16 v[144:147],v[216:219],v[32:35],v[144:147]
ds_read_b64_tr_b16 v[196:197],v251 offset:40960
ds_read_b64_tr_b16 v[198:199],v251 offset:41984
v_mfma_f32_16x16x32_bf16 v[148:151],v[216:219],v[36:39],v[148:151]
v_lshl_add_u32 v247,v17,1,v247
s_waitcnt lgkmcnt(8)
v_mfma_f32_16x16x32_bf16 v[156:159],v[220:223],v[36:39],v[156:159]
v_mfma_f32_16x16x32_bf16 v[152:155],v[220:223],v[32:35],v[152:155]
v_lshl_add_u32 v246,v17,6,v246
ds_read_b64_tr_b16 v[200:201],v40 offset:49152
ds_read_b64_tr_b16 v[202:203],v40 offset:50176
s_waitcnt lgkmcnt(8)
v_mfma_f32_16x16x32_bf16 v[160:163],v[224:227],v[32:35],v[160:163]
ds_read_b64_tr_b16 v[204:205],v41 offset:49152
ds_read_b64_tr_b16 v[206:207],v41 offset:50176
v_mfma_f32_16x16x32_bf16 v[164:167],v[224:227],v[36:39],v[164:167]
v_and_b32 v16,3,v1
s_waitcnt lgkmcnt(8)
v_mfma_f32_16x16x32_bf16 v[172:175],v[228:231],v[36:39],v[172:175]
v_mfma_f32_16x16x32_bf16 v[168:171],v[228:231],v[32:35],v[168:171]
v_lshl_add_u32 v247,v16,3,v247
ds_read_b64_tr_b16 v[208:209],v40 offset:57344
ds_read_b64_tr_b16 v[210:211],v40 offset:58368
s_waitcnt lgkmcnt(8)
v_mfma_f32_16x16x32_bf16 v[176:179],v[192:195],v[32:35],v[176:179]
ds_read_b64_tr_b16 v[212:213],v41 offset:57344
ds_read_b64_tr_b16 v[214:215],v41 offset:58368
v_mfma_f32_16x16x32_bf16 v[180:183],v[192:195],v[36:39],v[180:183]
v_and_b32 v16,15,v1
s_waitcnt lgkmcnt(8)
v_mfma_f32_16x16x32_bf16 v[188:191],v[196:199],v[36:39],v[188:191]
v_mfma_f32_16x16x32_bf16 v[184:187],v[196:199],v[32:35],v[184:187]
v_lshl_add_u32 v246,v16,4,v246
s_barrier
ds_read_b64_tr_b16 v[216:217],v42 offset:49152
ds_read_b64_tr_b16 v[218:219],v42 offset:50176
s_setprio 3
s_waitcnt lgkmcnt(8)
s_waitcnt vmcnt(3)
v_mfma_f32_16x16x32_bf16 v[128:131],v[200:203],v[48:51],v[128:131]
ds_read_b64_tr_b16 v[220:221],v43 offset:49152
ds_read_b64_tr_b16 v[222:223],v43 offset:50176
s_waitcnt vmcnt(2)
v_mfma_f32_16x16x32_bf16 v[132:135],v[200:203],v[52:55],v[132:135]
s_waitcnt lgkmcnt(8)
v_mfma_f32_16x16x32_bf16 v[140:143],v[204:207],v[52:55],v[140:143]
v_mfma_f32_16x16x32_bf16 v[136:139],v[204:207],v[48:51],v[136:139]
ds_read_b64_tr_b16 v[224:225],v42 offset:57344
ds_read_b64_tr_b16 v[226:227],v42 offset:58368
s_waitcnt lgkmcnt(8)
s_waitcnt vmcnt(1)
v_mfma_f32_16x16x32_bf16 v[128:131],v[208:211],v[56:59],v[128:131]
ds_read_b64_tr_b16 v[228:229],v43 offset:57344
ds_read_b64_tr_b16 v[230:231],v43 offset:58368
s_waitcnt vmcnt(0)
v_mfma_f32_16x16x32_bf16 v[132:135],v[208:211],v[60:63],v[132:135]
s_waitcnt lgkmcnt(8)
v_mfma_f32_16x16x32_bf16 v[140:143],v[212:215],v[60:63],v[140:143]
v_mfma_f32_16x16x32_bf16 v[136:139],v[212:215],v[56:59],v[136:139]
ds_read_b64_tr_b16 v[192:193],v248 offset:49152
ds_read_b64_tr_b16 v[194:195],v248 offset:50176
s_setprio 2
s_waitcnt lgkmcnt(8)
v_mfma_f32_16x16x32_bf16 v[144:147],v[216:219],v[48:51],v[144:147]
ds_read_b64_tr_b16 v[196:197],v249 offset:49152
ds_read_b64_tr_b16 v[198:199],v249 offset:50176
v_mfma_f32_16x16x32_bf16 v[148:151],v[216:219],v[52:55],v[148:151]
s_waitcnt lgkmcnt(8)
v_mfma_f32_16x16x32_bf16 v[156:159],v[220:223],v[52:55],v[156:159]
v_mfma_f32_16x16x32_bf16 v[152:155],v[220:223],v[48:51],v[152:155]
ds_read_b64_tr_b16 v[200:201],v248 offset:57344
ds_read_b64_tr_b16 v[202:203],v248 offset:58368
s_waitcnt lgkmcnt(8)
v_mfma_f32_16x16x32_bf16 v[144:147],v[224:227],v[56:59],v[144:147]
ds_read_b64_tr_b16 v[204:205],v249 offset:57344
ds_read_b64_tr_b16 v[206:207],v249 offset:58368
v_mfma_f32_16x16x32_bf16 v[148:151],v[224:227],v[60:63],v[148:151]
s_waitcnt lgkmcnt(8)
v_mfma_f32_16x16x32_bf16 v[156:159],v[228:231],v[60:63],v[156:159]
v_mfma_f32_16x16x32_bf16 v[152:155],v[228:231],v[56:59],v[152:155]
ds_read_b64_tr_b16 v[208:209],v250 offset:49152
ds_read_b64_tr_b16 v[210:211],v250 offset:50176
s_setprio 1
s_waitcnt lgkmcnt(8)
v_mfma_f32_16x16x32_bf16 v[160:163],v[192:195],v[48:51],v[160:163]
ds_read_b64_tr_b16 v[212:213],v251 offset:49152
ds_read_b64_tr_b16 v[214:215],v251 offset:50176
v_mfma_f32_16x16x32_bf16 v[164:167],v[192:195],v[52:55],v[164:167]
s_waitcnt lgkmcnt(8)
v_mfma_f32_16x16x32_bf16 v[172:175],v[196:199],v[52:55],v[172:175]
v_cvt_pk_bf16_f32 v32,v128,v129
v_cvt_pk_bf16_f32 v33,v130,v131
v_mfma_f32_16x16x32_bf16 v[168:171],v[196:199],v[48:51],v[168:171]
v_cvt_pk_bf16_f32 v34,v132,v133
v_cvt_pk_bf16_f32 v35,v134,v135
ds_read_b64_tr_b16 v[216:217],v250 offset:57344
ds_read_b64_tr_b16 v[218:219],v250 offset:58368
s_waitcnt lgkmcnt(8)
v_mfma_f32_16x16x32_bf16 v[160:163],v[200:203],v[56:59],v[160:163]
v_cvt_pk_bf16_f32 v36,v136,v137
v_cvt_pk_bf16_f32 v37,v138,v139
ds_read_b64_tr_b16 v[220:221],v251 offset:57344
ds_read_b64_tr_b16 v[222:223],v251 offset:58368
v_mfma_f32_16x16x32_bf16 v[164:167],v[200:203],v[60:63],v[164:167]
v_cvt_pk_bf16_f32 v38,v140,v141
v_cvt_pk_bf16_f32 v39,v142,v143
s_waitcnt lgkmcnt(8)
v_mfma_f32_16x16x32_bf16 v[172:175],v[204:207],v[60:63],v[172:175]
v_permlane16_swap_b32 v32,v34
v_mfma_f32_16x16x32_bf16 v[168:171],v[204:207],v[56:59],v[168:171]
v_permlane16_swap_b32 v33,v35
v_cvt_pk_bf16_f32 v40,v144,v145
s_setprio 0
s_waitcnt lgkmcnt(6)
v_mfma_f32_16x16x32_bf16 v[176:179],v[208:211],v[48:51],v[176:179]
v_cvt_pk_bf16_f32 v41,v146,v147
v_cvt_pk_bf16_f32 v42,v148,v149
v_mfma_f32_16x16x32_bf16 v[180:183],v[208:211],v[52:55],v[180:183]
v_cvt_pk_bf16_f32 v43,v150,v151
v_permlane16_swap_b32 v36,v38
s_waitcnt lgkmcnt(4)
v_mfma_f32_16x16x32_bf16 v[188:191],v[212:215],v[52:55],v[188:191]
v_permlane16_swap_b32 v37,v39
v_mfma_f32_16x16x32_bf16 v[184:187],v[212:215],v[48:51],v[184:187]
v_cvt_pk_bf16_f32 v44,v152,v153
v_cvt_pk_bf16_f32 v45,v154,v155
s_waitcnt lgkmcnt(2)
v_mfma_f32_16x16x32_bf16 v[176:179],v[216:219],v[56:59],v[176:179]
v_cvt_pk_bf16_f32 v46,v156,v157
v_cvt_pk_bf16_f32 v47,v158,v159
v_mfma_f32_16x16x32_bf16 v[180:183],v[216:219],v[60:63],v[180:183]
v_permlane16_swap_b32 v40,v42
v_permlane16_swap_b32 v41,v43
s_waitcnt lgkmcnt(0)
v_mfma_f32_16x16x32_bf16 v[188:191],v[220:223],v[60:63],v[188:191]
s_nop 0
v_mfma_f32_16x16x32_bf16 v[184:187],v[220:223],v[56:59],v[184:187]
v_permlane16_swap_b32 v44,v46
v_permlane16_swap_b32 v45,v47
s_cmp_lg_u32 s7,0
s_cbranch_scc1 L_k2_setabb
L_k2_setab_backb:
s_barrier
s_lshl_b32 s26,s19,7
s_add_u32 s26,s26,101711872
buffer_load_dword v8,v252,s[8:11],s26 offen sc1
L_k2_qd:
ds_read_b64 v[14:15],v14
ds_read_b128 v[192:195],v3 offset:16384
ds_read_b128 v[196:199],v3 offset:17408
ds_read_b128 v[200:203],v3 offset:18432
ds_read_b128 v[204:207],v3 offset:19456
ds_read_b128 v[208:211],v3 offset:20480
ds_read_b128 v[212:215],v3 offset:21504
ds_read_b128 v[216:219],v3 offset:22528
ds_read_b128 v[220:223],v3 offset:23552
s_nop 1
v_cvt_pk_bf16_f32 v48,v160,v161
v_cvt_pk_bf16_f32 v49,v162,v163
v_cvt_pk_bf16_f32 v50,v164,v165
v_cvt_pk_bf16_f32 v51,v166,v167
s_waitcnt lgkmcnt(7)
v_mfma_f32_32x32x16_bf16 v[128:143],v[192:195],v[32:35],0
ds_read_b128 v[192:195],v3 offset:24576
v_cvt_pk_bf16_f32 v52,v168,v169
v_cvt_pk_bf16_f32 v53,v170,v171
v_cvt_pk_bf16_f32 v54,v172,v173
v_cvt_pk_bf16_f32 v55,v174,v175
v_permlane16_swap_b32 v48,v50
v_permlane16_swap_b32 v49,v51
s_waitcnt lgkmcnt(7)
v_mfma_f32_32x32x16_bf16 v[128:143],v[196:199],v[36:39],v[128:143]
ds_read_b128 v[196:199],v3 offset:25600
v_cvt_pk_bf16_f32 v56,v176,v177
v_cvt_pk_bf16_f32 v57,v178,v179
v_cvt_pk_bf16_f32 v58,v180,v181
v_cvt_pk_bf16_f32 v59,v182,v183
v_permlane16_swap_b32 v52,v54
v_permlane16_swap_b32 v53,v55
s_waitcnt lgkmcnt(7)
v_mfma_f32_32x32x16_bf16 v[128:143],v[200:203],v[40:43],v[128:143]
ds_read_b128 v[200:203],v3 offset:26624
v_cvt_pk_bf16_f32 v60,v184,v185
v_cvt_pk_bf16_f32 v61,v186,v187
v_cvt_pk_bf16_f32 v62,v188,v189
v_cvt_pk_bf16_f32 v63,v190,v191
v_permlane16_swap_b32 v56,v58
v_permlane16_swap_b32 v57,v59
s_waitcnt lgkmcnt(7)
v_mfma_f32_32x32x16_bf16 v[128:143],v[204:207],v[44:47],v[128:143]
ds_read_b128 v[204:207],v3 offset:27648
v_permlane16_swap_b32 v60,v62
v_permlane16_swap_b32 v61,v63
s_waitcnt lgkmcnt(7)
v_mfma_f32_32x32x16_bf16 v[128:143],v[208:211],v[48:51],v[128:143]
ds_read_b128 v[208:211],v3 offset:28672
s_waitcnt lgkmcnt(7)
v_mfma_f32_32x32x16_bf16 v[128:143],v[212:215],v[52:55],v[128:143]
ds_read_b128 v[212:215],v3 offset:29696
s_waitcnt lgkmcnt(7)
v_mfma_f32_32x32x16_bf16 v[128:143],v[216:219],v[56:59],v[128:143]
ds_read_b128 v[216:219],v3 offset:30720
s_waitcnt lgkmcnt(7)
v_mfma_f32_32x32x16_bf16 v[128:143],v[220:223],v[60:63],v[128:143]
ds_read_b128 v[220:223],v3 offset:31744
s_waitcnt lgkmcnt(7)
v_mfma_f32_32x32x16_bf16 v[144:159],v[192:195],v[32:35],0
s_waitcnt lgkmcnt(6)
v_mfma_f32_32x32x16_bf16 v[144:159],v[196:199],v[36:39],v[144:159]
s_nop 7
s_nop 1
s_cmp_lg_u32 s19,0
s_cbranch_scc1 L_k2_nomask0
v_cndmask_b32 v128,v128,v9,s[40:41]
v_cndmask_b32 v129,v129,v9,s[42:43]
v_cndmask_b32 v130,v130,v9,s[44:45]
v_cndmask_b32 v131,v131,v9,s[46:47]
v_cndmask_b32 v132,v132,v9,s[48:49]
v_cndmask_b32 v133,v133,v9,s[50:51]
v_cndmask_b32 v134,v134,v9,s[52:53]
v_cndmask_b32 v135,v135,v9,s[54:55]
v_cndmask_b32 v136,v136,v9,s[56:57]
v_cndmask_b32 v137,v137,v9,s[58:59]
v_cndmask_b32 v138,v138,v9,s[60:61]
v_cndmask_b32 v139,v139,v9,s[62:63]
v_cndmask_b32 v140,v140,v9,s[64:65]
v_cndmask_b32 v141,v141,v9,s[66:67]
v_cndmask_b32 v142,v142,v9,s[68:69]
v_cndmask_b32 v143,v143,v9,s[70:71]
L_k2_nomask0:
s_waitcnt lgkmcnt(5)
v_mfma_f32_32x32x16_bf16 v[144:159],v[200:203],v[40:43],v[144:159]
v_max3_f32 v10,v128,v129,v130
v_max3_f32 v10,v10,v131,v132
v_max3_f32 v10,v10,v133,v134
v_max3_f32 v10,v10,v135,v136
v_max3_f32 v10,v10,v137,v138
v_max3_f32 v10,v10,v139,v140
v_max3_f32 v10,v10,v141,v142
v_max_f32 v10,v10,v143
s_waitcnt lgkmcnt(4)
v_mfma_f32_32x32x16_bf16 v[144:159],v[204:207],v[44:47],v[144:159]
v_mov_b32 v11,v10
s_nop 1
v_permlane32_swap_b32 v10,v11
v_max_f32 v10,v10,v11
v_sub_f32 v128,v128,v10
v_sub_f32 v129,v129,v10
v_sub_f32 v130,v130,v10
s_waitcnt lgkmcnt(3)
v_mfma_f32_32x32x16_bf16 v[144:159],v[208:211],v[48:51],v[144:159]
v_sub_f32 v131,v131,v10
v_sub_f32 v132,v132,v10
v_sub_f32 v133,v133,v10
v_sub_f32 v134,v134,v10
v_sub_f32 v135,v135,v10
v_sub_f32 v136,v136,v10
v_sub_f32 v137,v137,v10
s_waitcnt lgkmcnt(2)
v_mfma_f32_32x32x16_bf16 v[144:159],v[212:215],v[52:55],v[144:159]
v_sub_f32 v138,v138,v10
v_sub_f32 v139,v139,v10
v_sub_f32 v140,v140,v10
v_sub_f32 v141,v141,v10
v_sub_f32 v142,v142,v10
v_sub_f32 v143,v143,v10
v_sub_f32 v160,0,v10
v_sub_f32 v161,0,v10
s_waitcnt lgkmcnt(1)
v_mfma_f32_32x32x16_bf16 v[144:159],v[216:219],v[56:59],v[144:159]
v_sub_f32 v162,0,v10
v_sub_f32 v163,0,v10
v_sub_f32 v164,0,v10
v_sub_f32 v165,0,v10
v_sub_f32 v166,0,v10
v_sub_f32 v167,0,v10
v_sub_f32 v168,0,v10
s_waitcnt lgkmcnt(0)
v_mfma_f32_32x32x16_bf16 v[144:159],v[220:223],v[60:63],v[144:159]
v_sub_f32 v169,0,v10
v_sub_f32 v170,0,v10
v_sub_f32 v171,0,v10
v_sub_f32 v172,0,v10
v_sub_f32 v173,0,v10
v_sub_f32 v174,0,v10
v_sub_f32 v175,0,v10
v_exp_f32 v16,v128
v_exp_f32 v17,v129
v_add_f32 v6,v7,v16
v_exp_f32 v18,v130
v_add_f32 v6,v6,v17
v_cvt_pk_bf16_f32 v176,v16,v17
v_exp_f32 v19,v131
v_add_f32 v6,v6,v18
v_exp_f32 v20,v132
v_add_f32 v6,v6,v19
v_cvt_pk_bf16_f32 v177,v18,v19
v_exp_f32 v21,v133
v_add_f32 v6,v6,v20
v_exp_f32 v22,v134
v_add_f32 v6,v6,v21
v_cvt_pk_bf16_f32 v178,v20,v21
v_exp_f32 v23,v135
v_add_f32 v6,v6,v22
v_exp_f32 v16,v136
v_add_f32 v6,v6,v23
v_cvt_pk_bf16_f32 v179,v22,v23
v_exp_f32 v17,v137
v_add_f32 v6,v6,v16
v_exp_f32 v18,v138
v_sub_f32 v144,v144,v10
v_sub_f32 v145,v145,v10
v_sub_f32 v146,v146,v10
v_sub_f32 v147,v147,v10
v_sub_f32 v148,v148,v10
v_sub_f32 v149,v149,v10
v_sub_f32 v150,v150,v10
v_sub_f32 v151,v151,v10
v_sub_f32 v152,v152,v10
v_sub_f32 v153,v153,v10
v_sub_f32 v154,v154,v10
v_sub_f32 v155,v155,v10
v_sub_f32 v156,v156,v10
v_sub_f32 v157,v157,v10
v_sub_f32 v158,v158,v10
v_sub_f32 v159,v159,v10
v_add_f32 v6,v6,v17
v_cvt_pk_bf16_f32 v180,v16,v17
v_exp_f32 v19,v139
v_add_f32 v6,v6,v18
v_exp_f32 v20,v140
v_add_f32 v6,v6,v19
v_cvt_pk_bf16_f32 v181,v18,v19
v_exp_f32 v21,v141
v_add_f32 v6,v6,v20
v_exp_f32 v22,v142
v_add_f32 v6,v6,v21
v_cvt_pk_bf16_f32 v182,v20,v21
v_exp_f32 v23,v143
v_add_f32 v6,v6,v22
v_add_f32 v6,v6,v23
v_cvt_pk_bf16_f32 v183,v22,v23
v_cmp_nle_f32 vcc,v6,v13
v_readfirstlane_b32 s96,v15
v_cmp_ne_u32 vcc,0,v14
s_cbranch_vccnz L_k2_abort
L_k2_abort_back:
v_mov_b32 v3,v2
s_cmp_eq_u32 s28,0
s_cbranch_scc1 L_k2_nb5
s_waitcnt vmcnt(16)
s_barrier
s_cmp_le_u32 s29,s22
s_cbranch_scc0 L_lda_st6
s_lshl_b32 s26,s16,13
s_add_u32 m0,s24,s26
s_add_u32 s27,s25,4096
buffer_load_dwordx4 v2,s[72:75],s25 offen sc1 lds
buffer_load_dwordx4 v2,s[72:75],s25 offen offset:1024 sc1 lds
buffer_load_dwordx4 v2,s[72:75],s25 offen offset:2048 sc1 lds
buffer_load_dwordx4 v2,s[72:75],s25 offen offset:3072 sc1 lds
s_add_u32 m0,m0,4096
s_add_u32 s25,s25,32768
buffer_load_dwordx4 v2,s[72:75],s27 offen sc1 lds
buffer_load_dwordx4 v2,s[72:75],s27 offen offset:1024 sc1 lds
buffer_load_dwordx4 v2,s[72:75],s27 offen offset:2048 sc1 lds
buffer_load_dwordx4 v2,s[72:75],s27 offen offset:3072 sc1 lds
s_add_u32 s29,s29,1
s_add_u32 s24,s24,32768
s_cmp_eq_u32 s24,163840
s_cselect_b32 s24,0,s24
L_lda_bk6:
s_branch L_k2_nbd5
L_k2_nb5:
s_barrier
L_k2_nbd5:
s_cmp_eq_u32 s19,0
s_cbranch_scc1 L_k2_tailB0
ds_read_b128 v[192:195],v3 offset:16384
ds_read_b128 v[196:199],v3 offset:17408
ds_read_b128 v[200:203],v3 offset:18432
ds_read_b128 v[204:207],v3 offset:19456
ds_read_b128 v[208:211],v3 offset:20480
ds_read_b128 v[212:215],v3 offset:21504
s_cmp_eq_u32 s28,0
s_cbranch_scc1 L_k2_entb
s_branch L_k2_bodya
.p2align 6
L_k2_stepa:
s_waitcnt vmcnt(16)
s_barrier
s_cmp_le_u32 s29,s22
s_cbranch_scc0 L_lda_st11
s_lshl_b32 s26,s16,13
s_add_u32 m0,s24,s26
s_add_u32 s27,s25,4096
buffer_load_dwordx4 v2,s[72:75],s25 offen sc1 lds
buffer_load_dwordx4 v2,s[72:75],s25 offen offset:1024 sc1 lds
buffer_load_dwordx4 v2,s[72:75],s25 offen offset:2048 sc1 lds
buffer_load_dwordx4 v2,s[72:75],s25 offen offset:3072 sc1 lds
s_add_u32 m0,m0,4096
s_add_u32 s25,s25,32768
buffer_load_dwordx4 v2,s[72:75],s27 offen sc1 lds
buffer_load_dwordx4 v2,s[72:75],s27 offen offset:1024 sc1 lds
buffer_load_dwordx4 v2,s[72:75],s27 offen offset:2048 sc1 lds
buffer_load_dwordx4 v2,s[72:75],s27 offen offset:3072 sc1 lds
s_add_u32 s29,s29,1
s_add_u32 s24,s24,32768
s_cmp_eq_u32 s24,163840
s_cselect_b32 s24,0,s24
L_lda_bk11:
s_add_u32 s21,s21,1
L_k2_bodya:
s_sub_u32 s20,s20,1
s_cbranch_scc1 L_k2_tail0
s_waitcnt lgkmcnt(4)
v_mfma_f32_32x32x16_bf16 v[128:143],v[192:195],v[32:35],v[160:175]
ds_read_b128 v[216:219],v3 offset:22528
v_exp_f32 v16,v144
v_exp_f32 v17,v145
v_add_f32 v7,v6,v16
v_mfma_f32_32x32x16_bf16 v[128:143],v[196:199],v[36:39],v[128:143]
ds_read_b128 v[220:223],v3 offset:23552
v_exp_f32 v18,v146
v_add_f32 v7,v7,v17
v_cvt_pk_bf16_f32 v184,v16,v17
s_waitcnt lgkmcnt(4)
v_mfma_f32_32x32x16_bf16 v[128:143],v[200:203],v[40:43],v[128:143]
ds_read_b128 v[192:195],v3 offset:0
v_exp_f32 v19,v147
v_add_f32 v7,v7,v18
v_exp_f32 v20,v148
v_mfma_f32_32x32x16_bf16 v[128:143],v[204:207],v[44:47],v[128:143]
ds_read_b128 v[196:199],v3 offset:2048
v_add_f32 v7,v7,v19
v_cvt_pk_bf16_f32 v185,v18,v19
v_exp_f32 v21,v149
s_waitcnt lgkmcnt(4)
v_mfma_f32_32x32x16_bf16 v[128:143],v[208:211],v[48:51],v[128:143]
ds_read_b128 v[200:203],v3 offset:4096
v_add_f32 v7,v7,v20
v_exp_f32 v22,v150
v_add_f32 v7,v7,v21
v_cvt_pk_bf16_f32 v186,v20,v21
v_mfma_f32_32x32x16_bf16 v[128:143],v[212:215],v[52:55],v[128:143]
ds_read_b128 v[204:207],v3 offset:6144
v_exp_f32 v23,v151
v_add_f32 v7,v7,v22
s_waitcnt lgkmcnt(4)
v_mfma_f32_32x32x16_bf16 v[128:143],v[216:219],v[56:59],v[128:143]
ds_read_b128 v[208:211],v3 offset:1024
v_exp_f32 v16,v152
v_add_f32 v7,v7,v23
v_cvt_pk_bf16_f32 v187,v22,v23
v_mfma_f32_32x32x16_bf16 v[128:143],v[220:223],v[60:63],v[128:143]
ds_read_b128 v[212:215],v3 offset:3072
v_exp_f32 v17,v153
v_add_f32 v7,v7,v16
s_waitcnt lgkmcnt(4)
v_mfma_f32_32x32x16_bf16 v[64:79],v[192:195],v[176:179],v[64:79]
ds_read_b128 v[216:219],v3 offset:5120
v_exp_f32 v18,v154
v_add_f32 v7,v7,v17
v_cvt_pk_bf16_f32 v188,v16,v17
v_mfma_f32_32x32x16_bf16 v[80:95],v[196:199],v[176:179],v[80:95]
ds_read_b128 v[220:223],v3 offset:7168
v_exp_f32 v19,v155
v_add_f32 v7,v7,v18
s_waitcnt lgkmcnt(4)
v_mfma_f32_32x32x16_bf16 v[96:111],v[200:203],v[176:179],v[96:111]
ds_read_b128 v[192:195],v3 offset:24576
v_exp_f32 v20,v156
v_add_f32 v7,v7,v19
v_cvt_pk_bf16_f32 v189,v18,v19
v_mfma_f32_32x32x16_bf16 v[112:127],v[204:207],v[176:179],v[112:127]
ds_read_b128 v[196:199],v3 offset:25600
v_exp_f32 v21,v157
v_add_f32 v7,v7,v20
s_waitcnt lgkmcnt(4)
v_mfma_f32_32x32x16_bf16 v[64:79],v[208:211],v[180:183],v[64:79]
ds_read_b128 v[200:203],v3 offset:26624
v_exp_f32 v22,v158
v_add_f32 v7,v7,v21
v_cvt_pk_bf16_f32 v190,v20,v21
v_mfma_f32_32x32x16_bf16 v[80:95],v[212:215],v[180:183],v[80:95]
ds_read_b128 v[204:207],v3 offset:27648
v_exp_f32 v23,v159
v_add_f32 v7,v7,v22
v_add_f32 v7,v7,v23
s_waitcnt lgkmcnt(4)
v_mfma_f32_32x32x16_bf16 v[96:111],v[216:219],v[180:183],v[96:111]
ds_read_b128 v[208:211],v3 offset:28672
s_sub_u32 s20,s20,1
v_cvt_pk_bf16_f32 v191,v22,v23
v_cmp_nle_f32 vcc,v7,v13
v_mfma_f32_32x32x16_bf16 v[112:127],v[220:223],v[180:183],v[112:127]
ds_read_b128 v[212:215],v3 offset:29696
s_cbranch_vccnz L_k2_stub7
L_k2_back7:
s_cbranch_scc1 L_k2_tail1
s_waitcnt lgkmcnt(4)
v_mfma_f32_32x32x16_bf16 v[144:159],v[192:195],v[32:35],v[160:175]
ds_read_b128 v[216:219],v3 offset:30720
v_exp_f32 v16,v128
v_exp_f32 v17,v129
v_add_f32 v6,v7,v16
v_mfma_f32_32x32x16_bf16 v[144:159],v[196:199],v[36:39],v[144:159]
ds_read_b128 v[220:223],v3 offset:31744
v_exp_f32 v18,v130
v_add_f32 v6,v6,v17
v_cvt_pk_bf16_f32 v176,v16,v17
s_waitcnt lgkmcnt(4)
v_mfma_f32_32x32x16_bf16 v[144:159],v[200:203],v[40:43],v[144:159]
ds_read_b128 v[192:195],v3 offset:8192
v_exp_f32 v19,v131
v_add_f32 v6,v6,v18
v_exp_f32 v20,v132
v_mfma_f32_32x32x16_bf16 v[144:159],v[204:207],v[44:47],v[144:159]
ds_read_b128 v[196:199],v3 offset:10240
v_add_f32 v6,v6,v19
v_cvt_pk_bf16_f32 v177,v18,v19
v_exp_f32 v21,v133
s_waitcnt lgkmcnt(4)
v_mfma_f32_32x32x16_bf16 v[144:159],v[208:211],v[48:51],v[144:159]
ds_read_b128 v[200:203],v3 offset:12288
v_add_f32 v6,v6,v20
v_exp_f32 v22,v134
v_add_f32 v6,v6,v21
v_cvt_pk_bf16_f32 v178,v20,v21
v_mfma_f32_32x32x16_bf16 v[144:159],v[212:215],v[52:55],v[144:159]
ds_read_b128 v[204:207],v3 offset:14336
v_exp_f32 v23,v135
v_add_f32 v6,v6,v22
s_waitcnt lgkmcnt(4)
v_mfma_f32_32x32x16_bf16 v[144:159],v[216:219],v[56:59],v[144:159]
ds_read_b128 v[208:211],v3 offset:9216
v_exp_f32 v16,v136
v_add_f32 v6,v6,v23
v_cvt_pk_bf16_f32 v179,v22,v23
v_mfma_f32_32x32x16_bf16 v[144:159],v[220:223],v[60:63],v[144:159]
ds_read_b128 v[212:215],v3 offset:11264
v_exp_f32 v17,v137
v_add_f32 v6,v6,v16
s_waitcnt lgkmcnt(4)
v_mfma_f32_32x32x16_bf16 v[64:79],v[192:195],v[184:187],v[64:79]
ds_read_b128 v[216:219],v3 offset:13312
v_exp_f32 v18,v138
v_add_f32 v6,v6,v17
v_cvt_pk_bf16_f32 v180,v16,v17
v_mfma_f32_32x32x16_bf16 v[80:95],v[196:199],v[184:187],v[80:95]
ds_read_b128 v[220:223],v3 offset:15360
v_exp_f32 v19,v139
v_add_f32 v6,v6,v18
s_waitcnt lgkmcnt(4)
v_mfma_f32_32x32x16_bf16 v[96:111],v[200:203],v[184:187],v[96:111]
v_add_u32 v3,s23,v2
ds_read_b128 v[192:195],v3 offset:16384
v_exp_f32 v20,v140
v_add_f32 v6,v6,v19
v_cvt_pk_bf16_f32 v181,v18,v19
v_mfma_f32_32x32x16_bf16 v[112:127],v[204:207],v[184:187],v[112:127]
ds_read_b128 v[196:199],v3 offset:17408
s_add_u32 s23,s23,32768
v_exp_f32 v21,v141
v_add_f32 v6,v6,v20
s_waitcnt lgkmcnt(4)
v_mfma_f32_32x32x16_bf16 v[64:79],v[208:211],v[188:191],v[64:79]
ds_read_b128 v[200:203],v3 offset:18432
s_cmp_eq_u32 s23,163840
v_exp_f32 v22,v142
v_add_f32 v6,v6,v21
v_cvt_pk_bf16_f32 v182,v20,v21
v_mfma_f32_32x32x16_bf16 v[80:95],v[212:215],v[188:191],v[80:95]
ds_read_b128 v[204:207],v3 offset:19456
s_cselect_b32 s23,0,s23
v_exp_f32 v23,v143
v_add_f32 v6,v6,v22
s_waitcnt lgkmcnt(4)
v_mfma_f32_32x32x16_bf16 v[96:111],v[216:219],v[188:191],v[96:111]
ds_read_b128 v[208:211],v3 offset:20480
v_add_f32 v6,v6,v23
v_cvt_pk_bf16_f32 v183,v22,v23
v_cmp_nle_f32 vcc,v6,v13
v_mfma_f32_32x32x16_bf16 v[112:127],v[220:223],v[188:191],v[112:127]
ds_read_b128 v[212:215],v3 offset:21504
s_cbranch_vccnz L_k2_stub8
L_k2_back8:
s_branch L_k2_stepa
L_k2_entb:
s_waitcnt vmcnt(0)
s_cmp_lt_u32 s2,128
s_cbranch_scc1 L_k2_nowot
s_and_b32 s4,s2,7
s_lshl_b32 s26,s4,19
s_bfe_u32 s27,s2,0x40003
s_lshl_b32 s27,s27,15
s_add_u32 s26,s26,s27
s_and_b32 s27,s16,3
s_lshl_b32 s27,s27,13
s_add_u32 s26,s26,s27
v_lshlrev_b32 v24,7,v1
buffer_load_dword v25,v24,s[12:15],s26 offen
s_cmp_lt_u32 s2,192
s_cbranch_scc1 L_k2_nowot
s_cmp_lg_u32 s16,4
s_cbranch_scc1 L_k2_nowot
s_load_dwordx2 s[80:81],s[0:1],64
s_mov_b32 s82,524288
s_mov_b32 s83,0x20000
s_lshl_b32 s26,s4,16
s_bfe_u32 s27,s2,0x30003
s_lshl_b32 s27,s27,13
s_add_u32 s26,s26,s27
s_waitcnt lgkmcnt(0)
buffer_load_dword v26,v24,s[80:83],s26 offen
L_k2_nowot:
s_sub_u32 s20,s20,1
s_branch L_k2_bodyb
.p2align 6
L_k2_stepb:
s_barrier
L_k2_bodyb:
s_cbranch_scc1 L_k2_tail0
s_waitcnt lgkmcnt(4)
v_mfma_f32_32x32x16_bf16 v[128:143],v[192:195],v[32:35],v[160:175]
ds_read_b128 v[216:219],v3 offset:22528
v_exp_f32 v16,v144
v_exp_f32 v17,v145
v_add_f32 v7,v6,v16
v_mfma_f32_32x32x16_bf16 v[128:143],v[196:199],v[36:39],v[128:143]
ds_read_b128 v[220:223],v3 offset:23552
v_exp_f32 v18,v146
v_add_f32 v7,v7,v17
v_cvt_pk_bf16_f32 v184,v16,v17
s_waitcnt lgkmcnt(4)
v_mfma_f32_32x32x16_bf16 v[128:143],v[200:203],v[40:43],v[128:143]
ds_read_b128 v[192:195],v3 offset:0
v_exp_f32 v19,v147
v_add_f32 v7,v7,v18
v_exp_f32 v20,v148
v_mfma_f32_32x32x16_bf16 v[128:143],v[204:207],v[44:47],v[128:143]
ds_read_b128 v[196:199],v3 offset:2048
v_add_f32 v7,v7,v19
v_cvt_pk_bf16_f32 v185,v18,v19
v_exp_f32 v21,v149
s_waitcnt lgkmcnt(4)
v_mfma_f32_32x32x16_bf16 v[128:143],v[208:211],v[48:51],v[128:143]
ds_read_b128 v[200:203],v3 offset:4096
v_add_f32 v7,v7,v20
v_exp_f32 v22,v150
v_add_f32 v7,v7,v21
v_cvt_pk_bf16_f32 v186,v20,v21
v_mfma_f32_32x32x16_bf16 v[128:143],v[212:215],v[52:55],v[128:143]
ds_read_b128 v[204:207],v3 offset:6144
v_exp_f32 v23,v151
v_add_f32 v7,v7,v22
s_waitcnt lgkmcnt(4)
v_mfma_f32_32x32x16_bf16 v[128:143],v[216:219],v[56:59],v[128:143]
ds_read_b128 v[208:211],v3 offset:1024
v_exp_f32 v16,v152
v_add_f32 v7,v7,v23
v_cvt_pk_bf16_f32 v187,v22,v23
v_mfma_f32_32x32x16_bf16 v[128:143],v[220:223],v[60:63],v[128:143]
ds_read_b128 v[212:215],v3 offset:3072
v_exp_f32 v17,v153
v_add_f32 v7,v7,v16
s_waitcnt lgkmcnt(4)
v_mfma_f32_32x32x16_bf16 v[64:79],v[192:195],v[176:179],v[64:79]
ds_read_b128 v[216:219],v3 offset:5120
v_exp_f32 v18,v154
v_add_f32 v7,v7,v17
v_cvt_pk_bf16_f32 v188,v16,v17
v_mfma_f32_32x32x16_bf16 v[80:95],v[196:199],v[176:179],v[80:95]
ds_read_b128 v[220:223],v3 offset:7168
v_exp_f32 v19,v155
v_add_f32 v7,v7,v18
s_waitcnt lgkmcnt(4)
v_mfma_f32_32x32x16_bf16 v[96:111],v[200:203],v[176:179],v[96:111]
ds_read_b128 v[192:195],v3 offset:24576
v_exp_f32 v20,v156
v_add_f32 v7,v7,v19
v_cvt_pk_bf16_f32 v189,v18,v19
v_mfma_f32_32x32x16_bf16 v[112:127],v[204:207],v[176:179],v[112:127]
ds_read_b128 v[196:199],v3 offset:25600
v_exp_f32 v21,v157
v_add_f32 v7,v7,v20
s_waitcnt lgkmcnt(4)
v_mfma_f32_32x32x16_bf16 v[64:79],v[208:211],v[180:183],v[64:79]
ds_read_b128 v[200:203],v3 offset:26624
v_exp_f32 v22,v158
v_add_f32 v7,v7,v21
v_cvt_pk_bf16_f32 v190,v20,v21
v_mfma_f32_32x32x16_bf16 v[80:95],v[212:215],v[180:183],v[80:95]
ds_read_b128 v[204:207],v3 offset:27648
v_exp_f32 v23,v159
v_add_f32 v7,v7,v22
v_add_f32 v7,v7,v23
s_waitcnt lgkmcnt(4)
v_mfma_f32_32x32x16_bf16 v[96:111],v[216:219],v[180:183],v[96:111]
ds_read_b128 v[208:211],v3 offset:28672
s_sub_u32 s20,s20,1
v_cvt_pk_bf16_f32 v191,v22,v23
v_cmp_nle_f32 vcc,v7,v13
v_mfma_f32_32x32x16_bf16 v[112:127],v[220:223],v[180:183],v[112:127]
ds_read_b128 v[212:215],v3 offset:29696
s_cbranch_vccnz L_k2_stub9
L_k2_back9:
s_cbranch_scc1 L_k2_tail1
s_waitcnt lgkmcnt(4)
v_mfma_f32_32x32x16_bf16 v[144:159],v[192:195],v[32:35],v[160:175]
ds_read_b128 v[216:219],v3 offset:30720
v_exp_f32 v16,v128
v_exp_f32 v17,v129
v_add_f32 v6,v7,v16
v_mfma_f32_32x32x16_bf16 v[144:159],v[196:199],v[36:39],v[144:159]
ds_read_b128 v[220:223],v3 offset:31744
v_exp_f32 v18,v130
v_add_f32 v6,v6,v17
v_cvt_pk_bf16_f32 v176,v16,v17
s_waitcnt lgkmcnt(4)
v_mfma_f32_32x32x16_bf16 v[144:159],v[200:203],v[40:43],v[144:159]
ds_read_b128 v[192:195],v3 offset:8192
v_exp_f32 v19,v131
v_add_f32 v6,v6,v18
v_exp_f32 v20,v132
v_mfma_f32_32x32x16_bf16 v[144:159],v[204:207],v[44:47],v[144:159]
ds_read_b128 v[196:199],v3 offset:10240
v_add_f32 v6,v6,v19
v_cvt_pk_bf16_f32 v177,v18,v19
v_exp_f32 v21,v133
s_waitcnt lgkmcnt(4)
v_mfma_f32_32x32x16_bf16 v[144:159],v[208:211],v[48:51],v[144:159]
ds_read_b128 v[200:203],v3 offset:12288
v_add_f32 v6,v6,v20
v_exp_f32 v22,v134
v_add_f32 v6,v6,v21
v_cvt_pk_bf16_f32 v178,v20,v21
v_mfma_f32_32x32x16_bf16 v[144:159],v[212:215],v[52:55],v[144:159]
ds_read_b128 v[204:207],v3 offset:14336
v_exp_f32 v23,v135
v_add_f32 v6,v6,v22
s_waitcnt lgkmcnt(4)
v_mfma_f32_32x32x16_bf16 v[144:159],v[216:219],v[56:59],v[144:159]
ds_read_b128 v[208:211],v3 offset:9216
v_exp_f32 v16,v136
v_add_f32 v6,v6,v23
v_cvt_pk_bf16_f32 v179,v22,v23
v_mfma_f32_32x32x16_bf16 v[144:159],v[220:223],v[60:63],v[144:159]
ds_read_b128 v[212:215],v3 offset:11264
v_exp_f32 v17,v137
v_add_f32 v6,v6,v16
s_waitcnt lgkmcnt(4)
v_mfma_f32_32x32x16_bf16 v[64:79],v[192:195],v[184:187],v[64:79]
ds_read_b128 v[216:219],v3 offset:13312
v_exp_f32 v18,v138
v_add_f32 v6,v6,v17
v_cvt_pk_bf16_f32 v180,v16,v17
v_mfma_f32_32x32x16_bf16 v[80:95],v[196:199],v[184:187],v[80:95]
ds_read_b128 v[220:223],v3 offset:15360
v_exp_f32 v19,v139
v_add_f32 v6,v6,v18
s_waitcnt lgkmcnt(4)
v_mfma_f32_32x32x16_bf16 v[96:111],v[200:203],v[184:187],v[96:111]
v_add_u32 v3,s23,v2
ds_read_b128 v[192:195],v3 offset:16384
v_exp_f32 v20,v140
v_add_f32 v6,v6,v19
v_cvt_pk_bf16_f32 v181,v18,v19
v_mfma_f32_32x32x16_bf16 v[112:127],v[204:207],v[184:187],v[112:127]
ds_read_b128 v[196:199],v3 offset:17408
s_add_u32 s23,s23,32768
v_exp_f32 v21,v141
v_add_f32 v6,v6,v20
s_waitcnt lgkmcnt(4)
v_mfma_f32_32x32x16_bf16 v[64:79],v[208:211],v[188:191],v[64:79]
ds_read_b128 v[200:203],v3 offset:18432
s_cmp_eq_u32 s23,163840
v_exp_f32 v22,v142
v_add_f32 v6,v6,v21
v_cvt_pk_bf16_f32 v182,v20,v21
v_mfma_f32_32x32x16_bf16 v[80:95],v[212:215],v[188:191],v[80:95]
ds_read_b128 v[204:207],v3 offset:19456
s_cselect_b32 s23,0,s23
v_exp_f32 v23,v143
v_add_f32 v6,v6,v22
s_waitcnt lgkmcnt(4)
v_mfma_f32_32x32x16_bf16 v[96:111],v[216:219],v[188:191],v[96:111]
ds_read_b128 v[208:211],v3 offset:20480
s_sub_u32 s20,s20,1
v_add_f32 v6,v6,v23
v_cvt_pk_bf16_f32 v183,v22,v23
v_cmp_nle_f32 vcc,v6,v13
v_mfma_f32_32x32x16_bf16 v[112:127],v[220:223],v[188:191],v[112:127]
ds_read_b128 v[212:215],v3 offset:21504
s_cbranch_vccnz L_k2_stub10
L_k2_back10:
s_branch L_k2_stepb
L_k2_tail0:
s_waitcnt lgkmcnt(0)
ds_read_b128 v[192:195],v3 offset:0
ds_read_b128 v[196:199],v3 offset:2048
ds_read_b128 v[200:203],v3 offset:4096
ds_read_b128 v[204:207],v3 offset:6144
ds_read_b128 v[208:211],v3 offset:1024
ds_read_b128 v[212:215],v3 offset:3072
ds_read_b128 v[216:219],v3 offset:5120
ds_read_b128 v[220:223],v3 offset:7168
v_cndmask_b32 v144,v144,v9,s[40:41]
v_cndmask_b32 v145,v145,v9,s[42:43]
v_cndmask_b32 v146,v146,v9,s[44:45]
v_cndmask_b32 v147,v147,v9,s[46:47]
v_cndmask_b32 v148,v148,v9,s[48:49]
v_cndmask_b32 v149,v149,v9,s[50:51]
v_cndmask_b32 v150,v150,v9,s[52:53]
v_cndmask_b32 v151,v151,v9,s[54:55]
v_cndmask_b32 v152,v152,v9,s[56:57]
v_cndmask_b32 v153,v153,v9,s[58:59]
v_cndmask_b32 v154,v154,v9,s[60:61]
v_cndmask_b32 v155,v155,v9,s[62:63]
v_cndmask_b32 v156,v156,v9,s[64:65]
v_cndmask_b32 v157,v157,v9,s[66:67]
v_cndmask_b32 v158,v158,v9,s[68:69]
v_cndmask_b32 v159,v159,v9,s[70:71]
v_exp_f32 v16,v144
v_exp_f32 v17,v145
v_add_f32 v7,v6,v16
v_exp_f32 v18,v146
s_waitcnt lgkmcnt(7)
v_mfma_f32_32x32x16_bf16 v[64:79],v[192:195],v[176:179],v[64:79]
v_add_f32 v7,v7,v17
v_cvt_pk_bf16_f32 v184,v16,v17
v_exp_f32 v19,v147
v_add_f32 v7,v7,v18
v_exp_f32 v20,v148
s_waitcnt lgkmcnt(6)
v_mfma_f32_32x32x16_bf16 v[80:95],v[196:199],v[176:179],v[80:95]
v_add_f32 v7,v7,v19
v_cvt_pk_bf16_f32 v185,v18,v19
v_exp_f32 v21,v149
v_add_f32 v7,v7,v20
v_exp_f32 v22,v150
s_waitcnt lgkmcnt(5)
v_mfma_f32_32x32x16_bf16 v[96:111],v[200:203],v[176:179],v[96:111]
v_add_f32 v7,v7,v21
v_cvt_pk_bf16_f32 v186,v20,v21
v_exp_f32 v23,v151
v_add_f32 v7,v7,v22
s_waitcnt lgkmcnt(4)
v_mfma_f32_32x32x16_bf16 v[112:127],v[204:207],v[176:179],v[112:127]
v_exp_f32 v16,v152
v_add_f32 v7,v7,v23
v_cvt_pk_bf16_f32 v187,v22,v23
v_exp_f32 v17,v153
v_add_f32 v7,v7,v16
s_waitcnt lgkmcnt(3)
v_mfma_f32_32x32x16_bf16 v[64:79],v[208:211],v[180:183],v[64:79]
v_exp_f32 v18,v154
v_add_f32 v7,v7,v17
v_cvt_pk_bf16_f32 v188,v16,v17
v_exp_f32 v19,v155
v_add_f32 v7,v7,v18
s_waitcnt lgkmcnt(2)
v_mfma_f32_32x32x16_bf16 v[80:95],v[212:215],v[180:183],v[80:95]
v_exp_f32 v20,v156
v_add_f32 v7,v7,v19
v_cvt_pk_bf16_f32 v189,v18,v19
v_exp_f32 v21,v157
s_waitcnt lgkmcnt(1)
v_mfma_f32_32x32x16_bf16 v[96:111],v[216:219],v[180:183],v[96:111]
v_add_f32 v7,v7,v20
v_exp_f32 v22,v158
v_add_f32 v7,v7,v21
v_cvt_pk_bf16_f32 v190,v20,v21
v_exp_f32 v23,v159
s_waitcnt lgkmcnt(0)
v_mfma_f32_32x32x16_bf16 v[112:127],v[220:223],v[180:183],v[112:127]
v_add_f32 v7,v7,v22
v_add_f32 v7,v7,v23
v_cvt_pk_bf16_f32 v191,v22,v23
v_cmp_nle_f32 vcc,v7,v13
s_cbranch_vccnz L_k2_stub12
L_k2_back12:
v_mov_b32 v5,v7
ds_read_b128 v[192:195],v3 offset:8192
ds_read_b128 v[196:199],v3 offset:10240
ds_read_b128 v[200:203],v3 offset:12288
ds_read_b128 v[204:207],v3 offset:14336
ds_read_b128 v[208:211],v3 offset:9216
ds_read_b128 v[212:215],v3 offset:11264
ds_read_b128 v[216:219],v3 offset:13312
ds_read_b128 v[220:223],v3 offset:15360
s_waitcnt lgkmcnt(7)
v_mfma_f32_32x32x16_bf16 v[64:79],v[192:195],v[184:187],v[64:79]
s_waitcnt lgkmcnt(6)
v_mfma_f32_32x32x16_bf16 v[80:95],v[196:199],v[184:187],v[80:95]
s_waitcnt lgkmcnt(5)
v_mfma_f32_32x32x16_bf16 v[96:111],v[200:203],v[184:187],v[96:111]
s_waitcnt lgkmcnt(4)
v_mfma_f32_32x32x16_bf16 v[112:127],v[204:207],v[184:187],v[112:127]
s_waitcnt lgkmcnt(3)
v_mfma_f32_32x32x16_bf16 v[64:79],v[208:211],v[188:191],v[64:79]
s_waitcnt lgkmcnt(2)
v_mfma_f32_32x32x16_bf16 v[80:95],v[212:215],v[188:191],v[80:95]
s_waitcnt lgkmcnt(1)
v_mfma_f32_32x32x16_bf16 v[96:111],v[216:219],v[188:191],v[96:111]
s_waitcnt lgkmcnt(0)
v_mfma_f32_32x32x16_bf16 v[112:127],v[220:223],v[188:191],v[112:127]
s_branch L_k2_epi
L_k2_tail1:
s_waitcnt lgkmcnt(0)
ds_read_b128 v[192:195],v3 offset:8192
ds_read_b128 v[196:199],v3 offset:10240
ds_read_b128 v[200:203],v3 offset:12288
ds_read_b128 v[204:207],v3 offset:14336
ds_read_b128 v[208:211],v3 offset:9216
ds_read_b128 v[212:215],v3 offset:11264
ds_read_b128 v[216:219],v3 offset:13312
ds_read_b128 v[220:223],v3 offset:15360
v_cndmask_b32 v128,v128,v9,s[40:41]
v_cndmask_b32 v129,v129,v9,s[42:43]
v_cndmask_b32 v130,v130,v9,s[44:45]
v_cndmask_b32 v131,v131,v9,s[46:47]
v_cndmask_b32 v132,v132,v9,s[48:49]
v_cndmask_b32 v133,v133,v9,s[50:51]
v_cndmask_b32 v134,v134,v9,s[52:53]
v_cndmask_b32 v135,v135,v9,s[54:55]
v_cndmask_b32 v136,v136,v9,s[56:57]
v_cndmask_b32 v137,v137,v9,s[58:59]
v_cndmask_b32 v138,v138,v9,s[60:61]
v_cndmask_b32 v139,v139,v9,s[62:63]
v_cndmask_b32 v140,v140,v9,s[64:65]
v_cndmask_b32 v141,v141,v9,s[66:67]
v_cndmask_b32 v142,v142,v9,s[68:69]
v_cndmask_b32 v143,v143,v9,s[70:71]
v_exp_f32 v16,v128
v_exp_f32 v17,v129
v_add_f32 v6,v7,v16
v_exp_f32 v18,v130
s_waitcnt lgkmcnt(7)
v_mfma_f32_32x32x16_bf16 v[64:79],v[192:195],v[184:187],v[64:79]
v_add_f32 v6,v6,v17
v_cvt_pk_bf16_f32 v176,v16,v17
v_exp_f32 v19,v131
v_add_f32 v6,v6,v18
v_exp_f32 v20,v132
s_waitcnt lgkmcnt(6)
v_mfma_f32_32x32x16_bf16 v[80:95],v[196:199],v[184:187],v[80:95]
v_add_f32 v6,v6,v19
v_cvt_pk_bf16_f32 v177,v18,v19
v_exp_f32 v21,v133
v_add_f32 v6,v6,v20
v_exp_f32 v22,v134
s_waitcnt lgkmcnt(5)
v_mfma_f32_32x32x16_bf16 v[96:111],v[200:203],v[184:187],v[96:111]
v_add_f32 v6,v6,v21
v_cvt_pk_bf16_f32 v178,v20,v21
v_exp_f32 v23,v135
v_add_f32 v6,v6,v22
s_waitcnt lgkmcnt(4)
v_mfma_f32_32x32x16_bf16 v[112:127],v[204:207],v[184:187],v[112:127]
v_exp_f32 v16,v136
v_add_f32 v6,v6,v23
v_cvt_pk_bf16_f32 v179,v22,v23
v_exp_f32 v17,v137
v_add_f32 v6,v6,v16
s_waitcnt lgkmcnt(3)
v_mfma_f32_32x32x16_bf16 v[64:79],v[208:211],v[188:191],v[64:79]
v_exp_f32 v18,v138
v_add_f32 v6,v6,v17
v_cvt_pk_bf16_f32 v180,v16,v17
v_exp_f32 v19,v139
v_add_f32 v6,v6,v18
s_waitcnt lgkmcnt(2)
v_mfma_f32_32x32x16_bf16 v[80:95],v[212:215],v[188:191],v[80:95]
v_exp_f32 v20,v140
v_add_f32 v6,v6,v19
v_cvt_pk_bf16_f32 v181,v18,v19
v_exp_f32 v21,v141
s_waitcnt lgkmcnt(1)
v_mfma_f32_32x32x16_bf16 v[96:111],v[216:219],v[188:191],v[96:111]
v_add_f32 v6,v6,v20
v_exp_f32 v22,v142
v_add_f32 v6,v6,v21
v_cvt_pk_bf16_f32 v182,v20,v21
v_exp_f32 v23,v143
s_waitcnt lgkmcnt(0)
v_mfma_f32_32x32x16_bf16 v[112:127],v[220:223],v[188:191],v[112:127]
v_add_f32 v6,v6,v22
v_add_f32 v6,v6,v23
v_cvt_pk_bf16_f32 v183,v22,v23
v_cmp_nle_f32 vcc,v6,v13
s_cbranch_vccnz L_k2_stub13
L_k2_back13:
v_add_u32 v3,s23,v2
s_add_u32 s21,s21,1
s_cmp_eq_u32 s28,0
s_cbranch_scc1 L_k2_nb14
s_waitcnt vmcnt(16)
s_barrier
s_cmp_le_u32 s29,s22
s_cbranch_scc0 L_lda_st15
s_lshl_b32 s26,s16,13
s_add_u32 m0,s24,s26
s_add_u32 s27,s25,4096
buffer_load_dwordx4 v2,s[72:75],s25 offen sc1 lds
buffer_load_dwordx4 v2,s[72:75],s25 offen offset:1024 sc1 lds
buffer_load_dwordx4 v2,s[72:75],s25 offen offset:2048 sc1 lds
buffer_load_dwordx4 v2,s[72:75],s25 offen offset:3072 sc1 lds
s_add_u32 m0,m0,4096
s_add_u32 s25,s25,32768
buffer_load_dwordx4 v2,s[72:75],s27 offen sc1 lds
buffer_load_dwordx4 v2,s[72:75],s27 offen offset:1024 sc1 lds
buffer_load_dwordx4 v2,s[72:75],s27 offen offset:2048 sc1 lds
buffer_load_dwordx4 v2,s[72:75],s27 offen offset:3072 sc1 lds
s_add_u32 s29,s29,1
s_add_u32 s24,s24,32768
s_cmp_eq_u32 s24,163840
s_cselect_b32 s24,0,s24
L_lda_bk15:
s_branch L_k2_nbd14
L_k2_nb14:
s_barrier
L_k2_nbd14:
L_k2_tailB0:
v_mov_b32 v5,v6
ds_read_b128 v[192:195],v3 offset:0
ds_read_b128 v[196:199],v3 offset:2048
ds_read_b128 v[200:203],v3 offset:4096
ds_read_b128 v[204:207],v3 offset:6144
ds_read_b128 v[208:211],v3 offset:1024
ds_read_b128 v[212:215],v3 offset:3072
ds_read_b128 v[216:219],v3 offset:5120
ds_read_b128 v[220:223],v3 offset:7168
s_waitcnt lgkmcnt(7)
v_mfma_f32_32x32x16_bf16 v[64:79],v[192:195],v[176:179],v[64:79]
s_waitcnt lgkmcnt(6)
v_mfma_f32_32x32x16_bf16 v[80:95],v[196:199],v[176:179],v[80:95]
s_waitcnt lgkmcnt(5)
v_mfma_f32_32x32x16_bf16 v[96:111],v[200:203],v[176:179],v[96:111]
s_waitcnt lgkmcnt(4)
v_mfma_f32_32x32x16_bf16 v[112:127],v[204:207],v[176:179],v[112:127]
s_waitcnt lgkmcnt(3)
v_mfma_f32_32x32x16_bf16 v[64:79],v[208:211],v[180:183],v[64:79]
s_waitcnt lgkmcnt(2)
v_mfma_f32_32x32x16_bf16 v[80:95],v[212:215],v[180:183],v[80:95]
s_waitcnt lgkmcnt(1)
v_mfma_f32_32x32x16_bf16 v[96:111],v[216:219],v[180:183],v[96:111]
s_waitcnt lgkmcnt(0)
v_mfma_f32_32x32x16_bf16 v[112:127],v[220:223],v[180:183],v[112:127]
L_k2_epi:
s_setprio 2
s_load_dwordx2 s[40:41],s[0:1],80
s_load_dwordx2 s[44:45],s[0:1],64
s_lshl_b32 s38,s19,5
s_add_u32 s38,s38,s17
s_lshl_b32 s38,s38,2
s_add_u32 s38,s38,101789696
s_cmp_lt_u32 s16,6
s_cbranch_scc1 L_k2_epi0
s_barrier
L_k2_epi0:
v_mov_b32 v11,v5
s_nop 1
v_permlane32_swap_b32 v5,v11
v_add_f32 v5,v5,v11
v_rcp_f32 v5,v5
s_mul_i32 s26,s19,294912
s_lshl_b32 s27,s17,13
s_add_u32 s26,s26,s27
s_add_u32 s26,s26,67108864
s_add_u32 s27,s26,4096
v_mul_f32 v12,v5,v8
s_nop 3
v_pk_mul_f32 v[64:65],v[64:65],v[12:13] op_sel_hi:[1,0]
v_cvt_pk_bf16_f32 v64,v64,v65
v_pk_mul_f32 v[66:67],v[66:67],v[12:13] op_sel_hi:[1,0]
v_cvt_pk_bf16_f32 v65,v66,v67
v_pk_mul_f32 v[68:69],v[68:69],v[12:13] op_sel_hi:[1,0]
v_cvt_pk_bf16_f32 v66,v68,v69
v_pk_mul_f32 v[70:71],v[70:71],v[12:13] op_sel_hi:[1,0]
v_cvt_pk_bf16_f32 v67,v70,v71
buffer_store_dwordx4 v[64:67],v2,s[8:11],s26 offen offset:0 sc1
v_pk_mul_f32 v[72:73],v[72:73],v[12:13] op_sel_hi:[1,0]
v_cvt_pk_bf16_f32 v68,v72,v73
v_pk_mul_f32 v[74:75],v[74:75],v[12:13] op_sel_hi:[1,0]
v_cvt_pk_bf16_f32 v69,v74,v75
v_pk_mul_f32 v[76:77],v[76:77],v[12:13] op_sel_hi:[1,0]
v_cvt_pk_bf16_f32 v70,v76,v77
v_pk_mul_f32 v[78:79],v[78:79],v[12:13] op_sel_hi:[1,0]
v_cvt_pk_bf16_f32 v71,v78,v79
buffer_store_dwordx4 v[68:71],v2,s[8:11],s26 offen offset:1024 sc1
v_pk_mul_f32 v[80:81],v[80:81],v[12:13] op_sel_hi:[1,0]
v_cvt_pk_bf16_f32 v80,v80,v81
v_pk_mul_f32 v[82:83],v[82:83],v[12:13] op_sel_hi:[1,0]
v_cvt_pk_bf16_f32 v81,v82,v83
v_pk_mul_f32 v[84:85],v[84:85],v[12:13] op_sel_hi:[1,0]
v_cvt_pk_bf16_f32 v82,v84,v85
v_permlane16_swap_b32 v64,v68
v_pk_mul_f32 v[86:87],v[86:87],v[12:13] op_sel_hi:[1,0]
v_cvt_pk_bf16_f32 v83,v86,v87
buffer_store_dwordx4 v[80:83],v2,s[8:11],s26 offen offset:2048 sc1
v_permlane16_swap_b32 v65,v69
v_pk_mul_f32 v[88:89],v[88:89],v[12:13] op_sel_hi:[1,0]
v_cvt_pk_bf16_f32 v84,v88,v89
v_permlane16_swap_b32 v66,v70
v_pk_mul_f32 v[90:91],v[90:91],v[12:13] op_sel_hi:[1,0]
v_cvt_pk_bf16_f32 v85,v90,v91
v_permlane16_swap_b32 v67,v71
v_pk_mul_f32 v[92:93],v[92:93],v[12:13] op_sel_hi:[1,0]
v_cvt_pk_bf16_f32 v86,v92,v93
v_pk_mul_f32 v[94:95],v[94:95],v[12:13] op_sel_hi:[1,0]
v_cvt_pk_bf16_f32 v87,v94,v95
buffer_store_dwordx4 v[84:87],v2,s[8:11],s26 offen offset:3072 sc1
v_pk_mul_f32 v[96:97],v[96:97],v[12:13] op_sel_hi:[1,0]
v_cvt_pk_bf16_f32 v96,v96,v97
v_pk_mul_f32 v[98:99],v[98:99],v[12:13] op_sel_hi:[1,0]
v_cvt_pk_bf16_f32 v97,v98,v99
v_pk_mul_f32 v[100:101],v[100:101],v[12:13] op_sel_hi:[1,0]
v_cvt_pk_bf16_f32 v98,v100,v101
v_permlane16_swap_b32 v80,v84
v_pk_mul_f32 v[102:103],v[102:103],v[12:13] op_sel_hi:[1,0]
v_cvt_pk_bf16_f32 v99,v102,v103
buffer_store_dwordx4 v[96:99],v2,s[8:11],s27 offen offset:0 sc1
v_permlane16_swap_b32 v81,v85
v_pk_mul_f32 v[104:105],v[104:105],v[12:13] op_sel_hi:[1,0]
v_cvt_pk_bf16_f32 v100,v104,v105
v_permlane16_swap_b32 v82,v86
v_pk_mul_f32 v[106:107],v[106:107],v[12:13] op_sel_hi:[1,0]
v_cvt_pk_bf16_f32 v101,v106,v107
v_permlane16_swap_b32 v83,v87
v_pk_mul_f32 v[108:109],v[108:109],v[12:13] op_sel_hi:[1,0]
v_cvt_pk_bf16_f32 v102,v108,v109
v_pk_mul_f32 v[110:111],v[110:111],v[12:13] op_sel_hi:[1,0]
v_cvt_pk_bf16_f32 v103,v110,v111
buffer_store_dwordx4 v[100:103],v2,s[8:11],s27 offen offset:1024 sc1
v_pk_mul_f32 v[112:113],v[112:113],v[12:13] op_sel_hi:[1,0]
v_cvt_pk_bf16_f32 v112,v112,v113
v_pk_mul_f32 v[114:115],v[114:115],v[12:13] op_sel_hi:[1,0]
v_cvt_pk_bf16_f32 v113,v114,v115
v_pk_mul_f32 v[116:117],v[116:117],v[12:13] op_sel_hi:[1,0]
v_cvt_pk_bf16_f32 v114,v116,v117
v_permlane16_swap_b32 v96,v100
v_pk_mul_f32 v[118:119],v[118:119],v[12:13] op_sel_hi:[1,0]
v_cvt_pk_bf16_f32 v115,v118,v119
buffer_store_dwordx4 v[112:115],v2,s[8:11],s27 offen offset:2048 sc1
v_permlane16_swap_b32 v97,v101
v_pk_mul_f32 v[120:121],v[120:121],v[12:13] op_sel_hi:[1,0]
v_cvt_pk_bf16_f32 v116,v120,v121
v_permlane16_swap_b32 v98,v102
v_pk_mul_f32 v[122:123],v[122:123],v[12:13] op_sel_hi:[1,0]
v_cvt_pk_bf16_f32 v117,v122,v123
v_permlane16_swap_b32 v99,v103
v_pk_mul_f32 v[124:125],v[124:125],v[12:13] op_sel_hi:[1,0]
v_cvt_pk_bf16_f32 v118,v124,v125
v_pk_mul_f32 v[126:127],v[126:127],v[12:13] op_sel_hi:[1,0]
v_cvt_pk_bf16_f32 v119,v126,v127
buffer_store_dwordx4 v[116:119],v2,s[8:11],s27 offen offset:3072 sc1
s_nop 1
v_permlane16_swap_b32 v112,v116
v_permlane16_swap_b32 v113,v117
v_permlane16_swap_b32 v114,v118
v_permlane16_swap_b32 v115,v119
s_cmp_lg_u32 s28,0
s_cbranch_scc1 L_k2_epig0
s_lshl_b32 s57,s18,2
s_lshr_b32 s57,0x30241302,s57
s_and_b32 s57,s57,7
s_lshl_b32 s48,s57,15
s_and_b32 s53,s99,7
s_lshl_b32 s58,s53,5
v_xor_b32 v3,s58,v247
s_branch L_k2_fin
L_k2_epig0:
s_setprio 0
s_lshl_b32 s57,s18,2
s_lshr_b32 s57,0x30241302,s57
s_and_b32 s57,s57,7
s_lshl_b32 s48,s57,15
s_and_b32 s53,s99,7
s_lshl_b32 s58,s53,5
v_xor_b32 v3,s58,v247
s_add_u32 s49,s48,32768
s_cmp_eq_u32 s49,163840
s_cselect_b32 s49,0,s49
s_add_u32 s50,s49,32768
s_cmp_eq_u32 s50,163840
s_cselect_b32 s50,0,s50
s_add_u32 s51,s50,32768
s_cmp_eq_u32 s51,163840
s_cselect_b32 s51,0,s51
s_add_u32 s52,s51,32768
s_cmp_eq_u32 s52,163840
s_cselect_b32 s52,0,s52
s_mul_i32 s54,s6,294912
s_add_u32 s54,s54,67108864
s_lshl_b32 s58,s53,12
s_add_u32 s55,s54,s58
s_add_u32 s55,s55,262144
s_lshl_b32 s58,s53,15
s_add_u32 s54,s54,s58
s_bfe_u32 s57,s99,0x20003
s_lshl_b32 s58,s57,13
s_add_u32 s54,s54,s58
s_lshl_b32 s60,s6,15
s_lshl_b32 s57,s57,8
s_add_u32 s60,s60,s57
s_lshl_b32 s58,s53,5
s_add_u32 s60,s60,s58
v_and_b32 v12,7,v1
v_lshlrev_b32 v7,2,v12
s_lshr_b32 s59,s99,3
s_lshl_b32 s59,s59,6
s_add_u32 s59,s59,s53
s_lshl_b32 s59,s59,2
v_xor_b32 v253,s59,v7
v_add_u32 v253,101777536,v253
v_add_u32 v7,s52,v7
v_lshrrev_b32 v13,5,v1
v_lshlrev_b32 v13,4,v13
v_and_b32 v252,31,v1
v_lshl_add_u32 v252,v252,10,v13
s_add_u32 s59,s59,101777536
s_lshl_b32 s56,s99,16
s_lshl_b32 s58,s16,10
s_add_u32 s56,s56,s58
s_mov_b32 s42,2097152
s_mov_b32 s43,0x20000
s_mov_b32 s46,524288
s_mov_b32 s47,0x20000
s_cmp_ge_u32 s16,2
s_cbranch_scc1 L_k2_reld
s_add_u32 s21,s21,1
s_waitcnt vmcnt(24)
s_barrier
s_cmp_le_u32 s29,s22
s_cbranch_scc0 L_lda_st16
s_lshl_b32 s26,s16,13
s_add_u32 m0,s24,s26
s_add_u32 s27,s25,4096
buffer_load_dwordx4 v2,s[72:75],s25 offen sc1 lds
buffer_load_dwordx4 v2,s[72:75],s25 offen offset:1024 sc1 lds
buffer_load_dwordx4 v2,s[72:75],s25 offen offset:2048 sc1 lds
buffer_load_dwordx4 v2,s[72:75],s25 offen offset:3072 sc1 lds
s_add_u32 m0,m0,4096
s_add_u32 s25,s25,32768
buffer_load_dwordx4 v2,s[72:75],s27 offen sc1 lds
buffer_load_dwordx4 v2,s[72:75],s27 offen offset:1024 sc1 lds
buffer_load_dwordx4 v2,s[72:75],s27 offen offset:2048 sc1 lds
buffer_load_dwordx4 v2,s[72:75],s27 offen offset:3072 sc1 lds
s_add_u32 s29,s29,1
s_add_u32 s24,s24,32768
s_cmp_eq_u32 s24,163840
s_cselect_b32 s24,0,s24
L_lda_bk16:
s_add_u32 s21,s21,1
s_waitcnt vmcnt(24)
s_barrier
s_cmp_le_u32 s29,s22
s_cbranch_scc0 L_lda_st17
s_lshl_b32 s26,s16,13
s_add_u32 m0,s24,s26
s_add_u32 s27,s25,4096
buffer_load_dwordx4 v2,s[72:75],s25 offen sc1 lds
buffer_load_dwordx4 v2,s[72:75],s25 offen offset:1024 sc1 lds
buffer_load_dwordx4 v2,s[72:75],s25 offen offset:2048 sc1 lds
buffer_load_dwordx4 v2,s[72:75],s25 offen offset:3072 sc1 lds
s_add_u32 m0,m0,4096
s_add_u32 s25,s25,32768
buffer_load_dwordx4 v2,s[72:75],s27 offen sc1 lds
buffer_load_dwordx4 v2,s[72:75],s27 offen offset:1024 sc1 lds
buffer_load_dwordx4 v2,s[72:75],s27 offen offset:2048 sc1 lds
buffer_load_dwordx4 v2,s[72:75],s27 offen offset:3072 sc1 lds
s_add_u32 s29,s29,1
s_add_u32 s24,s24,32768
s_cmp_eq_u32 s24,163840
s_cselect_b32 s24,0,s24
L_lda_bk17:
s_waitcnt vmcnt(16)
v_mov_b32 v4,s96
s_mov_b64 exec,1
buffer_store_dword v4,off,s[8:11],s38 sc1
s_mov_b64 exec,-1
s_branch L_k2_ldent
L_k2_reld:
s_add_u32 s20,s19,s16
s_sub_u32 s20,s20,4
s_lshl_b32 s37,s17,11
s_add_u32 s37,s37,100663296
buffer_load_dwordx4 v[160:163],v2,s[8:11],s37 offen offset:0 sc1
buffer_load_dwordx4 v[164:167],v2,s[8:11],s37 offen offset:1024 sc1
s_add_u32 s37,s37,65536
buffer_load_dwordx4 v[168:171],v2,s[8:11],s37 offen offset:0 sc1
buffer_load_dwordx4 v[172:175],v2,s[8:11],s37 offen offset:1024 sc1
s_add_u32 s37,s37,65536
buffer_load_dwordx4 v[176:179],v2,s[8:11],s37 offen offset:0 sc1
buffer_load_dwordx4 v[180:183],v2,s[8:11],s37 offen offset:1024 sc1
s_add_u32 s37,s37,65536
buffer_load_dwordx4 v[184:187],v2,s[8:11],s37 offen offset:0 sc1
buffer_load_dwordx4 v[188:191],v2,s[8:11],s37 offen offset:1024 sc1
s_add_u32 s37,s37,65536
buffer_load_dwordx4 v[192:195],v2,s[8:11],s37 offen offset:0 sc1
buffer_load_dwordx4 v[196:199],v2,s[8:11],s37 offen offset:1024 sc1
s_add_u32 s37,s37,65536
buffer_load_dwordx4 v[200:203],v2,s[8:11],s37 offen offset:0 sc1
buffer_load_dwordx4 v[204:207],v2,s[8:11],s37 offen offset:1024 sc1
s_add_u32 s37,s37,65536
buffer_load_dwordx4 v[208:211],v2,s[8:11],s37 offen offset:0 sc1
buffer_load_dwordx4 v[212:215],v2,s[8:11],s37 offen offset:1024 sc1
s_add_u32 s37,s37,65536
buffer_load_dwordx4 v[216:219],v2,s[8:11],s37 offen offset:0 sc1
buffer_load_dwordx4 v[220:223],v2,s[8:11],s37 offen offset:1024 sc1
s_add_u32 s37,s37,65536
v_and_b32 v17,31,v1
v_lshlrev_b32 v17,2,v17
s_lshr_b32 s37,s17,3
s_lshl_b32 s37,s37,20
s_and_b32 s26,s17,7
s_lshl_b32 s26,s26,10
s_add_u32 s37,s37,s26
s_add_u32 s37,s37,33570816
s_mov_b32 s27,s20
s_lshl_b32 s26,s27,14
s_add_u32 s26,s26,s37
buffer_load_dwordx4 v[224:227],v2,s[8:11],s26 offen sc1
s_add_u32 s26,s26,8192
buffer_load_dwordx4 v[228:231],v2,s[8:11],s26 offen sc1
s_lshl_b32 s26,s27,7
s_add_u32 s26,s26,101711872
buffer_load_dword v18,v17,s[8:11],s26 offen sc1
buffer_load_dword v19,v17,s[8:11],s26 offen offset:128 sc1
s_sub_u32 s27,62,s20
s_lshl_b32 s26,s27,14
s_add_u32 s26,s26,s37
buffer_load_dwordx4 v[232:235],v2,s[8:11],s26 offen sc1
s_add_u32 s26,s26,8192
buffer_load_dwordx4 v[236:239],v2,s[8:11],s26 offen sc1
s_lshl_b32 s26,s27,7
s_add_u32 s26,s26,101711872
buffer_load_dword v20,v17,s[8:11],s26 offen sc1
buffer_load_dword v21,v17,s[8:11],s26 offen offset:128 sc1
s_add_u32 s21,s21,1
s_waitcnt vmcnt(48)
s_barrier
s_cmp_le_u32 s29,s22
s_cbranch_scc0 L_lda_st18
s_lshl_b32 s26,s16,13
s_add_u32 m0,s24,s26
s_add_u32 s27,s25,4096
buffer_load_dwordx4 v2,s[72:75],s25 offen sc1 lds
buffer_load_dwordx4 v2,s[72:75],s25 offen offset:1024 sc1 lds
buffer_load_dwordx4 v2,s[72:75],s25 offen offset:2048 sc1 lds
buffer_load_dwordx4 v2,s[72:75],s25 offen offset:3072 sc1 lds
s_add_u32 m0,m0,4096
s_add_u32 s25,s25,32768
buffer_load_dwordx4 v2,s[72:75],s27 offen sc1 lds
buffer_load_dwordx4 v2,s[72:75],s27 offen offset:1024 sc1 lds
buffer_load_dwordx4 v2,s[72:75],s27 offen offset:2048 sc1 lds
buffer_load_dwordx4 v2,s[72:75],s27 offen offset:3072 sc1 lds
s_add_u32 s29,s29,1
s_add_u32 s24,s24,32768
s_cmp_eq_u32 s24,163840
s_cselect_b32 s24,0,s24
L_lda_bk18:
s_add_u32 s21,s21,1
s_waitcnt vmcnt(48)
s_barrier
s_cmp_le_u32 s29,s22
s_cbranch_scc0 L_lda_st19
s_lshl_b32 s26,s16,13
s_add_u32 m0,s24,s26
s_add_u32 s27,s25,4096
buffer_load_dwordx4 v2,s[72:75],s25 offen sc1 lds
buffer_load_dwordx4 v2,s[72:75],s25 offen offset:1024 sc1 lds
buffer_load_dwordx4 v2,s[72:75],s25 offen offset:2048 sc1 lds
buffer_load_dwordx4 v2,s[72:75],s25 offen offset:3072 sc1 lds
s_add_u32 m0,m0,4096
s_add_u32 s25,s25,32768
buffer_load_dwordx4 v2,s[72:75],s27 offen sc1 lds
buffer_load_dwordx4 v2,s[72:75],s27 offen offset:1024 sc1 lds
buffer_load_dwordx4 v2,s[72:75],s27 offen offset:2048 sc1 lds
buffer_load_dwordx4 v2,s[72:75],s27 offen offset:3072 sc1 lds
s_add_u32 s29,s29,1
s_add_u32 s24,s24,32768
s_cmp_eq_u32 s24,163840
s_cselect_b32 s24,0,s24
L_lda_bk19:
s_waitcnt vmcnt(40)
v_mov_b32 v4,s96
s_mov_b64 exec,1
buffer_store_dword v4,off,s[8:11],s38 sc1
s_mov_b64 exec,-1
L_k2_ldent:
s_mov_b32 s23,1
s_mov_b32 s5,0
s_add_u32 s39,s21,1
s_add_u32 s26,s21,2
s_cmp_lt_u32 s26,s22
s_cselect_b32 s39,s39,-1
s_cmp_eq_u32 s98,s2
s_cselect_b32 s39,s39,-1
L_k2_ldloop:
s_add_u32 s21,s21,1
s_cmp_ge_u32 s21,s22
s_cbranch_scc1 L_k2_ldlast
s_cmp_lg_u32 s23,0
s_mov_b32 s23,0
s_cbranch_scc1 L_k2_ldbar
s_waitcnt vmcnt(16)
L_k2_ldbar:
s_barrier
s_cmp_le_u32 s29,s22
s_cbranch_scc0 L_lda_st20
s_lshl_b32 s26,s16,13
s_add_u32 m0,s24,s26
s_add_u32 s27,s25,4096
buffer_load_dwordx4 v2,s[72:75],s25 offen sc1 lds
buffer_load_dwordx4 v2,s[72:75],s25 offen offset:1024 sc1 lds
buffer_load_dwordx4 v2,s[72:75],s25 offen offset:2048 sc1 lds
buffer_load_dwordx4 v2,s[72:75],s25 offen offset:3072 sc1 lds
s_add_u32 m0,m0,4096
s_add_u32 s25,s25,32768
buffer_load_dwordx4 v2,s[72:75],s27 offen sc1 lds
buffer_load_dwordx4 v2,s[72:75],s27 offen offset:1024 sc1 lds
buffer_load_dwordx4 v2,s[72:75],s27 offen offset:2048 sc1 lds
buffer_load_dwordx4 v2,s[72:75],s27 offen offset:3072 sc1 lds
s_add_u32 s29,s29,1
s_add_u32 s24,s24,32768
s_cmp_eq_u32 s24,163840
s_cselect_b32 s24,0,s24
L_lda_bk20:
s_cmp_lg_u32 s21,s39
s_cbranch_scc1 L_k2_ldloop
s_cmp_lg_u32 s5,0
s_cbranch_scc1 L_k2_ojp
s_cmp_lt_u32 s16,2
s_cbranch_scc1 L_k2_ojp
s_lshl_b32 s38,s18,1
s_add_u32 s38,s38,s16
s_lshl_b32 s38,s38,5
s_add_u32 s38,s38,s17
s_lshl_b32 s38,s38,2
s_add_u32 s38,s38,101797632
s_waitcnt vmcnt(24)
v_add_f32 v160,v160,v168
v_add_f32 v161,v161,v169
v_add_f32 v162,v162,v170
v_add_f32 v163,v163,v171
v_add_f32 v164,v164,v172
v_add_f32 v165,v165,v173
v_add_f32 v166,v166,v174
v_add_f32 v167,v167,v175
v_add_f32 v160,v160,v176
v_add_f32 v161,v161,v177
v_add_f32 v162,v162,v178
v_add_f32 v163,v163,v179
v_add_f32 v164,v164,v180
v_add_f32 v165,v165,v181
v_add_f32 v166,v166,v182
v_add_f32 v167,v167,v183
v_add_f32 v160,v160,v184
v_add_f32 v161,v161,v185
v_add_f32 v162,v162,v186
v_add_f32 v163,v163,v187
v_add_f32 v164,v164,v188
v_add_f32 v165,v165,v189
v_add_f32 v166,v166,v190
v_add_f32 v167,v167,v191
v_add_f32 v160,v160,v192
v_add_f32 v161,v161,v193
v_add_f32 v162,v162,v194
v_add_f32 v163,v163,v195
v_add_f32 v164,v164,v196
v_add_f32 v165,v165,v197
v_add_f32 v166,v166,v198
v_add_f32 v167,v167,v199
v_add_f32 v160,v160,v200
v_add_f32 v161,v161,v201
v_add_f32 v162,v162,v202
v_add_f32 v163,v163,v203
v_add_f32 v164,v164,v204
v_add_f32 v165,v165,v205
v_add_f32 v166,v166,v206
v_add_f32 v167,v167,v207
v_add_f32 v160,v160,v208
v_add_f32 v161,v161,v209
v_add_f32 v162,v162,v210
v_add_f32 v163,v163,v211
v_add_f32 v164,v164,v212
v_add_f32 v165,v165,v213
v_add_f32 v166,v166,v214
v_add_f32 v167,v167,v215
v_add_f32 v160,v160,v216
v_add_f32 v161,v161,v217
v_add_f32 v162,v162,v218
v_add_f32 v163,v163,v219
v_add_f32 v164,v164,v220
v_add_f32 v165,v165,v221
v_add_f32 v166,v166,v222
v_add_f32 v167,v167,v223
v_cvt_pk_bf16_f32 v240,v160,v161
v_cvt_pk_bf16_f32 v241,v162,v163
v_cvt_pk_bf16_f32 v242,v164,v165
v_cvt_pk_bf16_f32 v243,v166,v167
s_nop 1
v_mfma_f32_32x32x16_bf16 v[160:175],v[240:243],v[224:227],0
v_mfma_f32_32x32x16_bf16 v[176:191],v[240:243],v[228:231],0
v_mfma_f32_32x32x16_bf16 v[192:207],v[240:243],v[232:235],0
v_mfma_f32_32x32x16_bf16 v[208:223],v[240:243],v[236:239],0
s_lshl_b32 s27,s17,10
s_add_u32 s27,s27,67371008
s_mul_i32 s26,s20,294912
s_add_u32 s26,s26,s27
s_sub_u32 s20,62,s20
s_mul_i32 s20,s20,294912
s_add_u32 s27,s27,s20
v_sub_f32 v18,1.0,v18
v_sub_f32 v19,1.0,v19
v_sub_f32 v20,1.0,v20
v_sub_f32 v21,1.0,v21
v_add_f32 v168,0x358637bd,v168
v_rcp_f32 v168,v168
s_nop 0
v_mul_f32 v168,v168,v18
v_mul_f32 v160,v168,v160
v_mul_f32 v161,v168,v161
v_mul_f32 v162,v168,v162
v_mul_f32 v163,v168,v163
v_mul_f32 v164,v168,v164
v_mul_f32 v165,v168,v165
v_mul_f32 v166,v168,v166
v_mul_f32 v167,v168,v167
v_cvt_pk_bf16_f32 v160,v160,v161
v_cvt_pk_bf16_f32 v161,v162,v163
v_cvt_pk_bf16_f32 v162,v164,v165
v_cvt_pk_bf16_f32 v163,v166,v167
buffer_store_dwordx4 v[160:163],v2,s[8:11],s26 offen sc1
s_add_u32 s26,s26,294912
v_add_f32 v184,0x358637bd,v184
v_rcp_f32 v184,v184
s_nop 0
v_mul_f32 v184,v184,v19
v_mul_f32 v176,v184,v176
v_mul_f32 v177,v184,v177
v_mul_f32 v178,v184,v178
v_mul_f32 v179,v184,v179
v_mul_f32 v180,v184,v180
v_mul_f32 v181,v184,v181
v_mul_f32 v182,v184,v182
v_mul_f32 v183,v184,v183
v_cvt_pk_bf16_f32 v176,v176,v177
v_cvt_pk_bf16_f32 v177,v178,v179
v_cvt_pk_bf16_f32 v178,v180,v181
v_cvt_pk_bf16_f32 v179,v182,v183
buffer_store_dwordx4 v[176:179],v2,s[8:11],s26 offen sc1
v_add_f32 v200,0x358637bd,v200
v_rcp_f32 v200,v200
s_nop 0
v_mul_f32 v200,v200,v20
v_mul_f32 v192,v200,v192
v_mul_f32 v193,v200,v193
v_mul_f32 v194,v200,v194
v_mul_f32 v195,v200,v195
v_mul_f32 v196,v200,v196
v_mul_f32 v197,v200,v197
v_mul_f32 v198,v200,v198
v_mul_f32 v199,v200,v199
v_cvt_pk_bf16_f32 v192,v192,v193
v_cvt_pk_bf16_f32 v193,v194,v195
v_cvt_pk_bf16_f32 v194,v196,v197
v_cvt_pk_bf16_f32 v195,v198,v199
buffer_store_dwordx4 v[192:195],v2,s[8:11],s27 offen sc1
s_add_u32 s27,s27,294912
s_nop 0
v_add_f32 v216,0x358637bd,v216
v_rcp_f32 v216,v216
s_nop 0
v_mul_f32 v216,v216,v21
v_mul_f32 v208,v216,v208
v_mul_f32 v209,v216,v209
v_mul_f32 v210,v216,v210
v_mul_f32 v211,v216,v211
v_mul_f32 v212,v216,v212
v_mul_f32 v213,v216,v213
v_mul_f32 v214,v216,v214
v_mul_f32 v215,v216,v215
v_cvt_pk_bf16_f32 v208,v208,v209
v_cvt_pk_bf16_f32 v209,v210,v211
v_cvt_pk_bf16_f32 v210,v212,v213
v_cvt_pk_bf16_f32 v211,v214,v215
buffer_store_dwordx4 v[208:211],v2,s[8:11],s27 offen sc1
L_k2_ojp:
buffer_load_dword v244,v254,s[8:11],0 offen sc1
s_add_u32 s21,s21,1
s_waitcnt vmcnt(17)
s_barrier
s_cmp_le_u32 s29,s22
s_cbranch_scc0 L_lda_st21
s_lshl_b32 s26,s16,13
s_add_u32 m0,s24,s26
s_add_u32 s27,s25,4096
buffer_load_dwordx4 v2,s[72:75],s25 offen sc1 lds
buffer_load_dwordx4 v2,s[72:75],s25 offen offset:1024 sc1 lds
buffer_load_dwordx4 v2,s[72:75],s25 offen offset:2048 sc1 lds
buffer_load_dwordx4 v2,s[72:75],s25 offen offset:3072 sc1 lds
s_add_u32 m0,m0,4096
s_add_u32 s25,s25,32768
buffer_load_dwordx4 v2,s[72:75],s27 offen sc1 lds
buffer_load_dwordx4 v2,s[72:75],s27 offen offset:1024 sc1 lds
buffer_load_dwordx4 v2,s[72:75],s27 offen offset:2048 sc1 lds
buffer_load_dwordx4 v2,s[72:75],s27 offen offset:3072 sc1 lds
s_add_u32 s29,s29,1
s_add_u32 s24,s24,32768
s_cmp_eq_u32 s24,163840
s_cselect_b32 s24,0,s24
L_lda_bk21:
s_waitcnt vmcnt(8)
v_mov_b32 v4,s96
s_mov_b64 exec,1
buffer_store_dword v4,off,s[8:11],s38 sc1
s_mov_b64 exec,-1
s_mov_b32 s5,1
s_add_u32 s39,s21,1
s_add_u32 s26,s21,3
s_cmp_lt_u32 s26,s22
s_cselect_b32 s39,s39,-1
s_add_u32 s26,s21,1
s_cmp_ge_u32 s26,s22
s_cbranch_scc1 L_k2_ldloop
v_cmp_ne_u32 vcc,s96,v244
s_and_b32 s4,vcc_lo,0x0f0f0f0f
s_cbranch_scc1 L_k2_ldloop
s_xor_b32 s58,s54,8192
buffer_load_dwordx4 v[32:35],v246,s[8:11],s58 offen offset:0 sc1
buffer_load_dwordx4 v[36:39],v246,s[8:11],s58 offen offset:256 sc1
buffer_load_dwordx4 v[40:43],v246,s[8:11],s58 offen offset:2048 sc1
buffer_load_dwordx4 v[44:47],v246,s[8:11],s58 offen offset:2304 sc1
s_xor_b32 s58,s54,12288
buffer_load_dwordx4 v[48:51],v246,s[8:11],s58 offen offset:0 sc1
buffer_load_dwordx4 v[52:55],v246,s[8:11],s58 offen offset:256 sc1
buffer_load_dwordx4 v[56:59],v246,s[8:11],s58 offen offset:2048 sc1
buffer_load_dwordx4 v[60:63],v246,s[8:11],s58 offen offset:2304 sc1
s_xor_b32 s58,s54,16384
buffer_load_dwordx4 v[72:75],v246,s[8:11],s58 offen offset:0 sc1
buffer_load_dwordx4 v[76:79],v246,s[8:11],s58 offen offset:256 sc1
buffer_load_dwordx4 v[88:91],v246,s[8:11],s58 offen offset:2048 sc1
buffer_load_dwordx4 v[92:95],v246,s[8:11],s58 offen offset:2304 sc1
s_add_u32 s21,s21,1
s_barrier
s_cmp_le_u32 s29,s22
s_cbranch_scc0 L_lda_st22
s_lshl_b32 s26,s16,13
s_add_u32 m0,s24,s26
s_add_u32 s27,s25,4096
buffer_load_dwordx4 v2,s[72:75],s25 offen sc1 lds
buffer_load_dwordx4 v2,s[72:75],s25 offen offset:1024 sc1 lds
buffer_load_dwordx4 v2,s[72:75],s25 offen offset:2048 sc1 lds
buffer_load_dwordx4 v2,s[72:75],s25 offen offset:3072 sc1 lds
s_add_u32 m0,m0,4096
s_add_u32 s25,s25,32768
buffer_load_dwordx4 v2,s[72:75],s27 offen sc1 lds
buffer_load_dwordx4 v2,s[72:75],s27 offen offset:1024 sc1 lds
buffer_load_dwordx4 v2,s[72:75],s27 offen offset:2048 sc1 lds
buffer_load_dwordx4 v2,s[72:75],s27 offen offset:3072 sc1 lds
s_add_u32 s29,s29,1
s_add_u32 s24,s24,32768
s_cmp_eq_u32 s24,163840
s_cselect_b32 s24,0,s24
L_lda_bk22:
s_xor_b32 s58,s54,20480
buffer_load_dwordx4 v[104:107],v246,s[8:11],s58 offen offset:0 sc1
buffer_load_dwordx4 v[108:111],v246,s[8:11],s58 offen offset:256 sc1
buffer_load_dwordx4 v[120:123],v246,s[8:11],s58 offen offset:2048 sc1
buffer_load_dwordx4 v[124:127],v246,s[8:11],s58 offen offset:2304 sc1
s_xor_b32 s58,s54,24576
buffer_load_dwordx4 v[128:131],v246,s[8:11],s58 offen offset:0 sc1
buffer_load_dwordx4 v[132:135],v246,s[8:11],s58 offen offset:256 sc1
buffer_load_dwordx4 v[136:139],v246,s[8:11],s58 offen offset:2048 sc1
buffer_load_dwordx4 v[140:143],v246,s[8:11],s58 offen offset:2304 sc1
s_xor_b32 s58,s54,28672
buffer_load_dwordx4 v[144:147],v246,s[8:11],s58 offen offset:0 sc1
buffer_load_dwordx4 v[148:151],v246,s[8:11],s58 offen offset:256 sc1
buffer_load_dwordx4 v[152:155],v246,s[8:11],s58 offen offset:2048 sc1
buffer_load_dwordx4 v[156:159],v246,s[8:11],s58 offen offset:2304 sc1
s_mov_b32 s23,2
s_mov_b32 s5,2
s_mov_b32 s39,-1
s_branch L_k2_ldloop
L_k2_ldlast:
s_cmp_gt_u32 s21,s22
s_cbranch_scc1 L_k2_ojob
s_cmp_eq_u32 s23,2
s_cbranch_scc1 L_k2_ldl0
s_waitcnt vmcnt(8)
s_cmp_lg_u32 s5,2
s_cbranch_scc1 L_k2_ldbar
s_barrier
s_branch L_p3_g0
L_k2_ldl0:
s_waitcnt vmcnt(32)
s_barrier
s_waitcnt vmcnt(0)
s_branch L_p3_g0
L_k2_ojob:
s_lshl_b32 s57,s16,12
s_add_u32 s57,s57,s52
s_add_u32 m0,s57,16384
s_lshl_b32 s57,s53,2
s_add_u32 s57,s57,s16
s_lshl_b32 s57,s57,14
s_and_b32 s58,s33,0x3ff
s_add_u32 s57,s57,s58
s_and_b32 s58,s16,1
s_lshl_b32 s58,s58,5
v_xor_b32 v255,s58,v255
s_waitcnt lgkmcnt(0)
buffer_load_dwordx4 v255,s[44:47],s57 offen lds
s_add_u32 m0,m0,1024
s_add_u32 s57,s57,4096
buffer_load_dwordx4 v255,s[44:47],s57 offen lds
s_add_u32 m0,m0,1024
s_add_u32 s57,s57,4096
buffer_load_dwordx4 v255,s[44:47],s57 offen lds
s_add_u32 m0,m0,1024
s_add_u32 s57,s57,4096
buffer_load_dwordx4 v255,s[44:47],s57 offen lds
v_xor_b32 v255,s58,v255
s_cmp_eq_u32 s5,1
s_cbranch_scc1 L_k2_oje
s_cmp_lt_u32 s16,2
s_cbranch_scc1 L_k2_oje
s_lshl_b32 s38,s18,1
s_add_u32 s38,s38,s16
s_lshl_b32 s38,s38,5
s_add_u32 s38,s38,s17
s_lshl_b32 s38,s38,2
s_add_u32 s38,s38,101797632
s_waitcnt vmcnt(20)
v_add_f32 v160,v160,v168
v_add_f32 v161,v161,v169
v_add_f32 v162,v162,v170
v_add_f32 v163,v163,v171
v_add_f32 v164,v164,v172
v_add_f32 v165,v165,v173
v_add_f32 v166,v166,v174
v_add_f32 v167,v167,v175
v_add_f32 v160,v160,v176
v_add_f32 v161,v161,v177
v_add_f32 v162,v162,v178
v_add_f32 v163,v163,v179
v_add_f32 v164,v164,v180
v_add_f32 v165,v165,v181
v_add_f32 v166,v166,v182
v_add_f32 v167,v167,v183
v_add_f32 v160,v160,v184
v_add_f32 v161,v161,v185
v_add_f32 v162,v162,v186
v_add_f32 v163,v163,v187
v_add_f32 v164,v164,v188
v_add_f32 v165,v165,v189
v_add_f32 v166,v166,v190
v_add_f32 v167,v167,v191
v_add_f32 v160,v160,v192
v_add_f32 v161,v161,v193
v_add_f32 v162,v162,v194
v_add_f32 v163,v163,v195
v_add_f32 v164,v164,v196
v_add_f32 v165,v165,v197
v_add_f32 v166,v166,v198
v_add_f32 v167,v167,v199
v_add_f32 v160,v160,v200
v_add_f32 v161,v161,v201
v_add_f32 v162,v162,v202
v_add_f32 v163,v163,v203
v_add_f32 v164,v164,v204
v_add_f32 v165,v165,v205
v_add_f32 v166,v166,v206
v_add_f32 v167,v167,v207
v_add_f32 v160,v160,v208
v_add_f32 v161,v161,v209
v_add_f32 v162,v162,v210
v_add_f32 v163,v163,v211
v_add_f32 v164,v164,v212
v_add_f32 v165,v165,v213
v_add_f32 v166,v166,v214
v_add_f32 v167,v167,v215
v_add_f32 v160,v160,v216
v_add_f32 v161,v161,v217
v_add_f32 v162,v162,v218
v_add_f32 v163,v163,v219
v_add_f32 v164,v164,v220
v_add_f32 v165,v165,v221
v_add_f32 v166,v166,v222
v_add_f32 v167,v167,v223
v_cvt_pk_bf16_f32 v240,v160,v161
v_cvt_pk_bf16_f32 v241,v162,v163
v_cvt_pk_bf16_f32 v242,v164,v165
v_cvt_pk_bf16_f32 v243,v166,v167
s_nop 1
v_mfma_f32_32x32x16_bf16 v[160:175],v[240:243],v[224:227],0
v_mfma_f32_32x32x16_bf16 v[176:191],v[240:243],v[228:231],0
v_mfma_f32_32x32x16_bf16 v[192:207],v[240:243],v[232:235],0
v_mfma_f32_32x32x16_bf16 v[208:223],v[240:243],v[236:239],0
s_lshl_b32 s27,s17,10
s_add_u32 s27,s27,67371008
s_mul_i32 s26,s20,294912
s_add_u32 s26,s26,s27
s_sub_u32 s20,62,s20
s_mul_i32 s20,s20,294912
s_add_u32 s27,s27,s20
v_sub_f32 v18,1.0,v18
v_sub_f32 v19,1.0,v19
v_sub_f32 v20,1.0,v20
v_sub_f32 v21,1.0,v21
v_add_f32 v168,0x358637bd,v168
v_rcp_f32 v168,v168
s_nop 0
v_mul_f32 v168,v168,v18
v_mul_f32 v160,v168,v160
v_mul_f32 v161,v168,v161
v_mul_f32 v162,v168,v162
v_mul_f32 v163,v168,v163
v_mul_f32 v164,v168,v164
v_mul_f32 v165,v168,v165
v_mul_f32 v166,v168,v166
v_mul_f32 v167,v168,v167
v_cvt_pk_bf16_f32 v160,v160,v161
v_cvt_pk_bf16_f32 v161,v162,v163
v_cvt_pk_bf16_f32 v162,v164,v165
v_cvt_pk_bf16_f32 v163,v166,v167
buffer_store_dwordx4 v[160:163],v2,s[8:11],s26 offen sc1
s_add_u32 s26,s26,294912
v_add_f32 v184,0x358637bd,v184
v_rcp_f32 v184,v184
s_nop 0
v_mul_f32 v184,v184,v19
v_mul_f32 v176,v184,v176
v_mul_f32 v177,v184,v177
v_mul_f32 v178,v184,v178
v_mul_f32 v179,v184,v179
v_mul_f32 v180,v184,v180
v_mul_f32 v181,v184,v181
v_mul_f32 v182,v184,v182
v_mul_f32 v183,v184,v183
v_cvt_pk_bf16_f32 v176,v176,v177
v_cvt_pk_bf16_f32 v177,v178,v179
v_cvt_pk_bf16_f32 v178,v180,v181
v_cvt_pk_bf16_f32 v179,v182,v183
buffer_store_dwordx4 v[176:179],v2,s[8:11],s26 offen sc1
v_add_f32 v200,0x358637bd,v200
v_rcp_f32 v200,v200
s_nop 0
v_mul_f32 v200,v200,v20
v_mul_f32 v192,v200,v192
v_mul_f32 v193,v200,v193
v_mul_f32 v194,v200,v194
v_mul_f32 v195,v200,v195
v_mul_f32 v196,v200,v196
v_mul_f32 v197,v200,v197
v_mul_f32 v198,v200,v198
v_mul_f32 v199,v200,v199
v_cvt_pk_bf16_f32 v192,v192,v193
v_cvt_pk_bf16_f32 v193,v194,v195
v_cvt_pk_bf16_f32 v194,v196,v197
v_cvt_pk_bf16_f32 v195,v198,v199
buffer_store_dwordx4 v[192:195],v2,s[8:11],s27 offen sc1
s_add_u32 s27,s27,294912
s_nop 0
v_add_f32 v216,0x358637bd,v216
v_rcp_f32 v216,v216
s_nop 0
v_mul_f32 v216,v216,v21
v_mul_f32 v208,v216,v208
v_mul_f32 v209,v216,v209
v_mul_f32 v210,v216,v210
v_mul_f32 v211,v216,v211
v_mul_f32 v212,v216,v212
v_mul_f32 v213,v216,v213
v_mul_f32 v214,v216,v214
v_mul_f32 v215,v216,v215
v_cvt_pk_bf16_f32 v208,v208,v209
v_cvt_pk_bf16_f32 v209,v210,v211
v_cvt_pk_bf16_f32 v210,v212,v213
v_cvt_pk_bf16_f32 v211,v214,v215
buffer_store_dwordx4 v[208:211],v2,s[8:11],s27 offen sc1
s_waitcnt vmcnt(4)
s_branch L_k2_fin
L_k2_oje:
s_waitcnt vmcnt(0)
L_k2_fin:
s_barrier
s_cmp_lg_u32 s98,s2
s_cbranch_scc1 L_p3_foreign
s_cmp_lg_u32 s28,0
s_cbranch_scc1 L_p3_mid
L_p3_join:
s_waitcnt lgkmcnt(0)
v_add_u32 v8,s48,v3
v_xor_b32 v9,32,v8
ds_read_b64_tr_b16 v[16:17],v8 offset:0
ds_read_b64_tr_b16 v[18:19],v8 offset:2048
ds_read_b64_tr_b16 v[20:21],v9 offset:0
ds_read_b64_tr_b16 v[22:23],v9 offset:2048
v_xor_b32 v10,64,v8
v_xor_b32 v11,96,v8
ds_read_b64_tr_b16 v[24:25],v10 offset:0
ds_read_b64_tr_b16 v[26:27],v10 offset:2048
ds_read_b64_tr_b16 v[28:29],v11 offset:0
ds_read_b64_tr_b16 v[30:31],v11 offset:2048
v_xor_b32 v240,128,v8
v_xor_b32 v241,160,v8
ds_read_b64_tr_b16 v[224:225],v240 offset:0
ds_read_b64_tr_b16 v[226:227],v240 offset:2048
s_waitcnt lgkmcnt(8)
v_mfma_f32_16x16x32_bf16 v[160:163],v[16:19],v[64:67],0
ds_read_b64_tr_b16 v[228:229],v241 offset:0
v_mfma_f32_16x16x32_bf16 v[164:167],v[16:19],v[68:71],0
ds_read_b64_tr_b16 v[230:231],v241 offset:2048
s_add_u32 s49,s48,32768
s_cmp_eq_u32 s49,163840
s_cselect_b32 s49,0,s49
s_waitcnt lgkmcnt(8)
v_mfma_f32_16x16x32_bf16 v[172:175],v[20:23],v[68:71],0
v_mfma_f32_16x16x32_bf16 v[168:171],v[20:23],v[64:67],0
s_add_u32 s50,s49,32768
s_cmp_eq_u32 s50,163840
s_cselect_b32 s50,0,s50
v_xor_b32 v242,192,v8
v_xor_b32 v243,224,v8
ds_read_b64_tr_b16 v[232:233],v242 offset:0
ds_read_b64_tr_b16 v[234:235],v242 offset:2048
s_waitcnt lgkmcnt(8)
v_mfma_f32_16x16x32_bf16 v[176:179],v[24:27],v[64:67],0
ds_read_b64_tr_b16 v[236:237],v243 offset:0
v_mfma_f32_16x16x32_bf16 v[180:183],v[24:27],v[68:71],0
ds_read_b64_tr_b16 v[238:239],v243 offset:2048
s_add_u32 s51,s50,32768
s_cmp_eq_u32 s51,163840
s_cselect_b32 s51,0,s51
s_waitcnt lgkmcnt(8)
v_mfma_f32_16x16x32_bf16 v[188:191],v[28:31],v[68:71],0
v_mfma_f32_16x16x32_bf16 v[184:187],v[28:31],v[64:67],0
s_add_u32 s52,s51,32768
s_cmp_eq_u32 s52,163840
s_cselect_b32 s52,0,s52
ds_read_b64_tr_b16 v[16:17],v8 offset:8192
ds_read_b64_tr_b16 v[18:19],v8 offset:10240
s_waitcnt lgkmcnt(8)
v_mfma_f32_16x16x32_bf16 v[192:195],v[224:227],v[64:67],0
ds_read_b64_tr_b16 v[20:21],v9 offset:8192
v_mfma_f32_16x16x32_bf16 v[196:199],v[224:227],v[68:71],0
ds_read_b64_tr_b16 v[22:23],v9 offset:10240
s_mul_i32 s54,s6,294912
s_add_u32 s54,s54,67108864
s_lshl_b32 s58,s53,12
s_add_u32 s55,s54,s58
s_add_u32 s55,s55,262144
s_waitcnt lgkmcnt(8)
v_mfma_f32_16x16x32_bf16 v[204:207],v[228:231],v[68:71],0
v_mfma_f32_16x16x32_bf16 v[200:203],v[228:231],v[64:67],0
s_lshl_b32 s58,s53,15
s_add_u32 s54,s54,s58
s_bfe_u32 s57,s99,0x20003
s_lshl_b32 s58,s57,13
s_add_u32 s54,s54,s58
s_lshl_b32 s60,s6,15
s_lshl_b32 s57,s57,8
s_add_u32 s60,s60,s57
ds_read_b64_tr_b16 v[24:25],v10 offset:8192
ds_read_b64_tr_b16 v[26:27],v10 offset:10240
s_waitcnt lgkmcnt(8)
v_mfma_f32_16x16x32_bf16 v[208:211],v[232:235],v[64:67],0
ds_read_b64_tr_b16 v[28:29],v11 offset:8192
v_mfma_f32_16x16x32_bf16 v[212:215],v[232:235],v[68:71],0
ds_read_b64_tr_b16 v[30:31],v11 offset:10240
s_lshl_b32 s58,s53,5
s_add_u32 s60,s60,s58
v_and_b32 v12,7,v1
v_lshlrev_b32 v7,2,v12
s_waitcnt lgkmcnt(8)
v_mfma_f32_16x16x32_bf16 v[220:223],v[236:239],v[68:71],0
v_mfma_f32_16x16x32_bf16 v[216:219],v[236:239],v[64:67],0
s_lshr_b32 s59,s99,3
s_lshl_b32 s59,s59,6
s_add_u32 s59,s59,s53
s_lshl_b32 s59,s59,2
v_xor_b32 v253,s59,v7
v_add_u32 v253,101777536,v253
v_add_u32 v7,s52,v7
ds_read_b64_tr_b16 v[224:225],v240 offset:8192
ds_read_b64_tr_b16 v[226:227],v240 offset:10240
s_waitcnt lgkmcnt(8)
v_mfma_f32_16x16x32_bf16 v[160:163],v[16:19],v[80:83],v[160:163]
ds_read_b64_tr_b16 v[228:229],v241 offset:8192
v_mfma_f32_16x16x32_bf16 v[164:167],v[16:19],v[84:87],v[164:167]
ds_read_b64_tr_b16 v[230:231],v241 offset:10240
v_lshrrev_b32 v13,5,v1
v_lshlrev_b32 v13,4,v13
v_and_b32 v252,31,v1
v_lshl_add_u32 v252,v252,10,v13
s_waitcnt lgkmcnt(8)
v_mfma_f32_16x16x32_bf16 v[172:175],v[20:23],v[84:87],v[172:175]
v_mfma_f32_16x16x32_bf16 v[168:171],v[20:23],v[80:83],v[168:171]
s_add_u32 s59,s59,101777536
s_lshl_b32 s56,s99,16
s_lshl_b32 s58,s16,10
s_add_u32 s56,s56,s58
ds_read_b64_tr_b16 v[232:233],v242 offset:8192
ds_read_b64_tr_b16 v[234:235],v242 offset:10240
s_waitcnt lgkmcnt(8)
v_mfma_f32_16x16x32_bf16 v[176:179],v[24:27],v[80:83],v[176:179]
ds_read_b64_tr_b16 v[236:237],v243 offset:8192
v_mfma_f32_16x16x32_bf16 v[180:183],v[24:27],v[84:87],v[180:183]
ds_read_b64_tr_b16 v[238:239],v243 offset:10240
s_mov_b32 s42,2097152
s_mov_b32 s43,0x20000
s_mov_b32 s46,524288
s_mov_b32 s47,0x20000
s_waitcnt lgkmcnt(8)
v_mfma_f32_16x16x32_bf16 v[188:191],v[28:31],v[84:87],v[188:191]
v_mfma_f32_16x16x32_bf16 v[184:187],v[28:31],v[80:83],v[184:187]
ds_read_b64_tr_b16 v[16:17],v8 offset:16384
ds_read_b64_tr_b16 v[18:19],v8 offset:18432
s_waitcnt lgkmcnt(8)
v_mfma_f32_16x16x32_bf16 v[192:195],v[224:227],v[80:83],v[192:195]
ds_read_b64_tr_b16 v[20:21],v9 offset:16384
v_mfma_f32_16x16x32_bf16 v[196:199],v[224:227],v[84:87],v[196:199]
ds_read_b64_tr_b16 v[22:23],v9 offset:18432
s_waitcnt lgkmcnt(8)
v_mfma_f32_16x16x32_bf16 v[204:207],v[228:231],v[84:87],v[204:207]
v_mfma_f32_16x16x32_bf16 v[200:203],v[228:231],v[80:83],v[200:203]
ds_read_b64_tr_b16 v[24:25],v10 offset:16384
ds_read_b64_tr_b16 v[26:27],v10 offset:18432
s_waitcnt lgkmcnt(8)
v_mfma_f32_16x16x32_bf16 v[208:211],v[232:235],v[80:83],v[208:211]
ds_read_b64_tr_b16 v[28:29],v11 offset:16384
v_mfma_f32_16x16x32_bf16 v[212:215],v[232:235],v[84:87],v[212:215]
ds_read_b64_tr_b16 v[30:31],v11 offset:18432
s_waitcnt lgkmcnt(8)
v_mfma_f32_16x16x32_bf16 v[220:223],v[236:239],v[84:87],v[220:223]
v_mfma_f32_16x16x32_bf16 v[216:219],v[236:239],v[80:83],v[216:219]
ds_read_b64_tr_b16 v[224:225],v240 offset:16384
ds_read_b64_tr_b16 v[226:227],v240 offset:18432
s_waitcnt lgkmcnt(8)
v_mfma_f32_16x16x32_bf16 v[160:163],v[16:19],v[96:99],v[160:163]
ds_read_b64_tr_b16 v[228:229],v241 offset:16384
v_mfma_f32_16x16x32_bf16 v[164:167],v[16:19],v[100:103],v[164:167]
ds_read_b64_tr_b16 v[230:231],v241 offset:18432
s_waitcnt lgkmcnt(8)
v_mfma_f32_16x16x32_bf16 v[172:175],v[20:23],v[100:103],v[172:175]
v_mfma_f32_16x16x32_bf16 v[168:171],v[20:23],v[96:99],v[168:171]
ds_read_b64_tr_b16 v[232:233],v242 offset:16384
ds_read_b64_tr_b16 v[234:235],v242 offset:18432
s_waitcnt lgkmcnt(8)
v_mfma_f32_16x16x32_bf16 v[176:179],v[24:27],v[96:99],v[176:179]
ds_read_b64_tr_b16 v[236:237],v243 offset:16384
v_mfma_f32_16x16x32_bf16 v[180:183],v[24:27],v[100:103],v[180:183]
ds_read_b64_tr_b16 v[238:239],v243 offset:18432
s_waitcnt lgkmcnt(8)
v_mfma_f32_16x16x32_bf16 v[188:191],v[28:31],v[100:103],v[188:191]
v_mfma_f32_16x16x32_bf16 v[184:187],v[28:31],v[96:99],v[184:187]
ds_read_b64_tr_b16 v[16:17],v8 offset:24576
ds_read_b64_tr_b16 v[18:19],v8 offset:26624
s_waitcnt lgkmcnt(8)
v_mfma_f32_16x16x32_bf16 v[192:195],v[224:227],v[96:99],v[192:195]
ds_read_b64_tr_b16 v[20:21],v9 offset:24576
v_mfma_f32_16x16x32_bf16 v[196:199],v[224:227],v[100:103],v[196:199]
ds_read_b64_tr_b16 v[22:23],v9 offset:26624
s_waitcnt lgkmcnt(8)
v_mfma_f32_16x16x32_bf16 v[204:207],v[228:231],v[100:103],v[204:207]
v_mfma_f32_16x16x32_bf16 v[200:203],v[228:231],v[96:99],v[200:203]
ds_read_b64_tr_b16 v[24:25],v10 offset:24576
ds_read_b64_tr_b16 v[26:27],v10 offset:26624
s_waitcnt lgkmcnt(8)
v_mfma_f32_16x16x32_bf16 v[208:211],v[232:235],v[96:99],v[208:211]
ds_read_b64_tr_b16 v[28:29],v11 offset:24576
v_mfma_f32_16x16x32_bf16 v[212:215],v[232:235],v[100:103],v[212:215]
ds_read_b64_tr_b16 v[30:31],v11 offset:26624
s_waitcnt lgkmcnt(8)
v_mfma_f32_16x16x32_bf16 v[220:223],v[236:239],v[100:103],v[220:223]
v_mfma_f32_16x16x32_bf16 v[216:219],v[236:239],v[96:99],v[216:219]
s_waitcnt vmcnt(0)
v_mov_b32 v4,s96
s_mov_b64 exec,1
buffer_store_dword v4,off,s[8:11],s38 sc1
s_mov_b64 exec,-1
ds_read_b64_tr_b16 v[224:225],v240 offset:24576
ds_read_b64_tr_b16 v[226:227],v240 offset:26624
s_waitcnt lgkmcnt(8)
v_mfma_f32_16x16x32_bf16 v[160:163],v[16:19],v[112:115],v[160:163]
ds_read_b64_tr_b16 v[228:229],v241 offset:24576
v_mfma_f32_16x16x32_bf16 v[164:167],v[16:19],v[116:119],v[164:167]
ds_read_b64_tr_b16 v[230:231],v241 offset:26624
s_waitcnt lgkmcnt(8)
v_mfma_f32_16x16x32_bf16 v[172:175],v[20:23],v[116:119],v[172:175]
v_mfma_f32_16x16x32_bf16 v[168:171],v[20:23],v[112:115],v[168:171]
ds_read_b64_tr_b16 v[232:233],v242 offset:24576
ds_read_b64_tr_b16 v[234:235],v242 offset:26624
s_waitcnt lgkmcnt(8)
v_mfma_f32_16x16x32_bf16 v[176:179],v[24:27],v[112:115],v[176:179]
ds_read_b64_tr_b16 v[236:237],v243 offset:24576
v_mfma_f32_16x16x32_bf16 v[180:183],v[24:27],v[116:119],v[180:183]
ds_read_b64_tr_b16 v[238:239],v243 offset:26624
s_waitcnt lgkmcnt(8)
v_mfma_f32_16x16x32_bf16 v[188:191],v[28:31],v[116:119],v[188:191]
v_mfma_f32_16x16x32_bf16 v[184:187],v[28:31],v[112:115],v[184:187]
buffer_load_dword v244,v254,s[8:11],0 offen sc1
v_add_u32 v12,s49,v3
v_add_u32 v8,s49,v3
v_xor_b32 v9,32,v12
ds_read_b64_tr_b16 v[16:17],v8 offset:0
ds_read_b64_tr_b16 v[18:19],v8 offset:2048
s_waitcnt lgkmcnt(8)
v_mfma_f32_16x16x32_bf16 v[192:195],v[224:227],v[112:115],v[192:195]
ds_read_b64_tr_b16 v[20:21],v9 offset:0
v_mfma_f32_16x16x32_bf16 v[196:199],v[224:227],v[116:119],v[196:199]
ds_read_b64_tr_b16 v[22:23],v9 offset:2048
s_waitcnt lgkmcnt(8)
v_mfma_f32_16x16x32_bf16 v[204:207],v[228:231],v[116:119],v[204:207]
v_mfma_f32_16x16x32_bf16 v[200:203],v[228:231],v[112:115],v[200:203]
v_xor_b32 v10,64,v12
v_xor_b32 v11,96,v12
ds_read_b64_tr_b16 v[24:25],v10 offset:0
ds_read_b64_tr_b16 v[26:27],v10 offset:2048
s_waitcnt lgkmcnt(8)
v_mfma_f32_16x16x32_bf16 v[208:211],v[232:235],v[112:115],v[208:211]
ds_read_b64_tr_b16 v[28:29],v11 offset:0
v_mfma_f32_16x16x32_bf16 v[212:215],v[232:235],v[116:119],v[212:215]
ds_read_b64_tr_b16 v[30:31],v11 offset:2048
s_waitcnt lgkmcnt(8)
v_mfma_f32_16x16x32_bf16 v[220:223],v[236:239],v[116:119],v[220:223]
v_mfma_f32_16x16x32_bf16 v[216:219],v[236:239],v[112:115],v[216:219]
s_waitcnt vmcnt(0)
v_cmp_ne_u32 vcc,s96,v244
s_and_b32 s4,vcc_lo,0xf0f0f0f
s_cbranch_scc1 L_p3_spin
L_p3_spin_back:
s_xor_b32 s58,s54,8192
buffer_load_dwordx4 v[32:35],v246,s[8:11],s58 offen offset:0 sc1
buffer_load_dwordx4 v[36:39],v246,s[8:11],s58 offen offset:256 sc1
buffer_load_dwordx4 v[40:43],v246,s[8:11],s58 offen offset:2048 sc1
buffer_load_dwordx4 v[44:47],v246,s[8:11],s58 offen offset:2304 sc1
s_xor_b32 s58,s54,12288
buffer_load_dwordx4 v[48:51],v246,s[8:11],s58 offen offset:0 sc1
buffer_load_dwordx4 v[52:55],v246,s[8:11],s58 offen offset:256 sc1
buffer_load_dwordx4 v[56:59],v246,s[8:11],s58 offen offset:2048 sc1
buffer_load_dwordx4 v[60:63],v246,s[8:11],s58 offen offset:2304 sc1
v_xor_b32 v240,128,v12
v_xor_b32 v241,160,v12
ds_read_b64_tr_b16 v[224:225],v240 offset:0
ds_read_b64_tr_b16 v[226:227],v240 offset:2048
s_xor_b32 s58,s54,16384
buffer_load_dwordx4 v[72:75],v246,s[8:11],s58 offen offset:0 sc1
s_waitcnt lgkmcnt(8)
s_waitcnt vmcnt(8)
v_mfma_f32_16x16x32_bf16 v[160:163],v[16:19],v[32:35],v[160:163]
ds_read_b64_tr_b16 v[228:229],v241 offset:0
s_waitcnt vmcnt(7)
v_mfma_f32_16x16x32_bf16 v[164:167],v[16:19],v[36:39],v[164:167]
ds_read_b64_tr_b16 v[230:231],v241 offset:2048
s_waitcnt lgkmcnt(8)
v_mfma_f32_16x16x32_bf16 v[172:175],v[20:23],v[36:39],v[172:175]
v_mfma_f32_16x16x32_bf16 v[168:171],v[20:23],v[32:35],v[168:171]
v_xor_b32 v242,192,v12
v_xor_b32 v243,224,v12
ds_read_b64_tr_b16 v[232:233],v242 offset:0
ds_read_b64_tr_b16 v[234:235],v242 offset:2048
buffer_load_dwordx4 v[76:79],v246,s[8:11],s58 offen offset:256 sc1
s_waitcnt lgkmcnt(8)
v_mfma_f32_16x16x32_bf16 v[176:179],v[24:27],v[32:35],v[176:179]
ds_read_b64_tr_b16 v[236:237],v243 offset:0
v_mfma_f32_16x16x32_bf16 v[180:183],v[24:27],v[36:39],v[180:183]
ds_read_b64_tr_b16 v[238:239],v243 offset:2048
s_waitcnt lgkmcnt(8)
v_mfma_f32_16x16x32_bf16 v[188:191],v[28:31],v[36:39],v[188:191]
v_mfma_f32_16x16x32_bf16 v[184:187],v[28:31],v[32:35],v[184:187]
ds_read_b64_tr_b16 v[16:17],v8 offset:8192
ds_read_b64_tr_b16 v[18:19],v8 offset:10240
buffer_load_dwordx4 v[88:91],v246,s[8:11],s58 offen offset:2048 sc1
s_waitcnt lgkmcnt(8)
v_mfma_f32_16x16x32_bf16 v[192:195],v[224:227],v[32:35],v[192:195]
ds_read_b64_tr_b16 v[20:21],v9 offset:8192
v_mfma_f32_16x16x32_bf16 v[196:199],v[224:227],v[36:39],v[196:199]
ds_read_b64_tr_b16 v[22:23],v9 offset:10240
s_waitcnt lgkmcnt(8)
v_mfma_f32_16x16x32_bf16 v[204:207],v[228:231],v[36:39],v[204:207]
v_mfma_f32_16x16x32_bf16 v[200:203],v[228:231],v[32:35],v[200:203]
ds_read_b64_tr_b16 v[24:25],v10 offset:8192
ds_read_b64_tr_b16 v[26:27],v10 offset:10240
buffer_load_dwordx4 v[92:95],v246,s[8:11],s58 offen offset:2304 sc1
s_waitcnt lgkmcnt(8)
v_mfma_f32_16x16x32_bf16 v[208:211],v[232:235],v[32:35],v[208:211]
ds_read_b64_tr_b16 v[28:29],v11 offset:8192
v_mfma_f32_16x16x32_bf16 v[212:215],v[232:235],v[36:39],v[212:215]
ds_read_b64_tr_b16 v[30:31],v11 offset:10240
s_waitcnt lgkmcnt(8)
v_mfma_f32_16x16x32_bf16 v[220:223],v[236:239],v[36:39],v[220:223]
v_mfma_f32_16x16x32_bf16 v[216:219],v[236:239],v[32:35],v[216:219]
L_p3_j:
ds_read_b64_tr_b16 v[224:225],v240 offset:8192
ds_read_b64_tr_b16 v[226:227],v240 offset:10240
s_xor_b32 s58,s54,20480
buffer_load_dwordx4 v[104:107],v246,s[8:11],s58 offen offset:0 sc1
s_waitcnt lgkmcnt(8)
s_waitcnt vmcnt(10)
v_mfma_f32_16x16x32_bf16 v[160:163],v[16:19],v[40:43],v[160:163]
ds_read_b64_tr_b16 v[228:229],v241 offset:8192
s_waitcnt vmcnt(9)
v_mfma_f32_16x16x32_bf16 v[164:167],v[16:19],v[44:47],v[164:167]
ds_read_b64_tr_b16 v[230:231],v241 offset:10240
s_waitcnt lgkmcnt(8)
v_mfma_f32_16x16x32_bf16 v[172:175],v[20:23],v[44:47],v[172:175]
v_mfma_f32_16x16x32_bf16 v[168:171],v[20:23],v[40:43],v[168:171]
ds_read_b64_tr_b16 v[232:233],v242 offset:8192
ds_read_b64_tr_b16 v[234:235],v242 offset:10240
buffer_load_dwordx4 v[108:111],v246,s[8:11],s58 offen offset:256 sc1
s_waitcnt lgkmcnt(8)
v_mfma_f32_16x16x32_bf16 v[176:179],v[24:27],v[40:43],v[176:179]
ds_read_b64_tr_b16 v[236:237],v243 offset:8192
v_mfma_f32_16x16x32_bf16 v[180:183],v[24:27],v[44:47],v[180:183]
ds_read_b64_tr_b16 v[238:239],v243 offset:10240
s_waitcnt lgkmcnt(8)
v_mfma_f32_16x16x32_bf16 v[188:191],v[28:31],v[44:47],v[188:191]
v_mfma_f32_16x16x32_bf16 v[184:187],v[28:31],v[40:43],v[184:187]
ds_read_b64_tr_b16 v[16:17],v8 offset:16384
ds_read_b64_tr_b16 v[18:19],v8 offset:18432
buffer_load_dwordx4 v[120:123],v246,s[8:11],s58 offen offset:2048 sc1
s_waitcnt lgkmcnt(8)
v_mfma_f32_16x16x32_bf16 v[192:195],v[224:227],v[40:43],v[192:195]
ds_read_b64_tr_b16 v[20:21],v9 offset:16384
v_mfma_f32_16x16x32_bf16 v[196:199],v[224:227],v[44:47],v[196:199]
ds_read_b64_tr_b16 v[22:23],v9 offset:18432
s_waitcnt lgkmcnt(8)
v_mfma_f32_16x16x32_bf16 v[204:207],v[228:231],v[44:47],v[204:207]
v_mfma_f32_16x16x32_bf16 v[200:203],v[228:231],v[40:43],v[200:203]
ds_read_b64_tr_b16 v[24:25],v10 offset:16384
ds_read_b64_tr_b16 v[26:27],v10 offset:18432
buffer_load_dwordx4 v[124:127],v246,s[8:11],s58 offen offset:2304 sc1
s_waitcnt lgkmcnt(8)
v_mfma_f32_16x16x32_bf16 v[208:211],v[232:235],v[40:43],v[208:211]
ds_read_b64_tr_b16 v[28:29],v11 offset:16384
v_mfma_f32_16x16x32_bf16 v[212:215],v[232:235],v[44:47],v[212:215]
ds_read_b64_tr_b16 v[30:31],v11 offset:18432
s_waitcnt lgkmcnt(8)
v_mfma_f32_16x16x32_bf16 v[220:223],v[236:239],v[44:47],v[220:223]
v_mfma_f32_16x16x32_bf16 v[216:219],v[236:239],v[40:43],v[216:219]
ds_read_b64_tr_b16 v[224:225],v240 offset:16384
ds_read_b64_tr_b16 v[226:227],v240 offset:18432
s_xor_b32 s58,s54,24576
buffer_load_dwordx4 v[128:131],v246,s[8:11],s58 offen offset:0 sc1
s_waitcnt lgkmcnt(8)
s_waitcnt vmcnt(12)
v_mfma_f32_16x16x32_bf16 v[160:163],v[16:19],v[48:51],v[160:163]
ds_read_b64_tr_b16 v[228:229],v241 offset:16384
s_waitcnt vmcnt(11)
v_mfma_f32_16x16x32_bf16 v[164:167],v[16:19],v[52:55],v[164:167]
ds_read_b64_tr_b16 v[230:231],v241 offset:18432
s_waitcnt lgkmcnt(8)
v_mfma_f32_16x16x32_bf16 v[172:175],v[20:23],v[52:55],v[172:175]
v_mfma_f32_16x16x32_bf16 v[168:171],v[20:23],v[48:51],v[168:171]
ds_read_b64_tr_b16 v[232:233],v242 offset:16384
ds_read_b64_tr_b16 v[234:235],v242 offset:18432
buffer_load_dwordx4 v[132:135],v246,s[8:11],s58 offen offset:256 sc1
s_waitcnt lgkmcnt(8)
v_mfma_f32_16x16x32_bf16 v[176:179],v[24:27],v[48:51],v[176:179]
ds_read_b64_tr_b16 v[236:237],v243 offset:16384
v_mfma_f32_16x16x32_bf16 v[180:183],v[24:27],v[52:55],v[180:183]
ds_read_b64_tr_b16 v[238:239],v243 offset:18432
s_waitcnt lgkmcnt(8)
v_mfma_f32_16x16x32_bf16 v[188:191],v[28:31],v[52:55],v[188:191]
v_mfma_f32_16x16x32_bf16 v[184:187],v[28:31],v[48:51],v[184:187]
ds_read_b64_tr_b16 v[16:17],v8 offset:24576
ds_read_b64_tr_b16 v[18:19],v8 offset:26624
buffer_load_dwordx4 v[136:139],v246,s[8:11],s58 offen offset:2048 sc1
s_waitcnt lgkmcnt(8)
v_mfma_f32_16x16x32_bf16 v[192:195],v[224:227],v[48:51],v[192:195]
ds_read_b64_tr_b16 v[20:21],v9 offset:24576
v_mfma_f32_16x16x32_bf16 v[196:199],v[224:227],v[52:55],v[196:199]
ds_read_b64_tr_b16 v[22:23],v9 offset:26624
s_waitcnt lgkmcnt(8)
v_mfma_f32_16x16x32_bf16 v[204:207],v[228:231],v[52:55],v[204:207]
v_mfma_f32_16x16x32_bf16 v[200:203],v[228:231],v[48:51],v[200:203]
ds_read_b64_tr_b16 v[24:25],v10 offset:24576
ds_read_b64_tr_b16 v[26:27],v10 offset:26624
buffer_load_dwordx4 v[140:143],v246,s[8:11],s58 offen offset:2304 sc1
s_waitcnt lgkmcnt(8)
v_mfma_f32_16x16x32_bf16 v[208:211],v[232:235],v[48:51],v[208:211]
ds_read_b64_tr_b16 v[28:29],v11 offset:24576
v_mfma_f32_16x16x32_bf16 v[212:215],v[232:235],v[52:55],v[212:215]
ds_read_b64_tr_b16 v[30:31],v11 offset:26624
s_waitcnt lgkmcnt(8)
v_mfma_f32_16x16x32_bf16 v[220:223],v[236:239],v[52:55],v[220:223]
v_mfma_f32_16x16x32_bf16 v[216:219],v[236:239],v[48:51],v[216:219]
ds_read_b64_tr_b16 v[224:225],v240 offset:24576
ds_read_b64_tr_b16 v[226:227],v240 offset:26624
s_xor_b32 s58,s54,28672
buffer_load_dwordx4 v[144:147],v246,s[8:11],s58 offen offset:0 sc1
s_waitcnt lgkmcnt(8)
s_waitcnt vmcnt(14)
v_mfma_f32_16x16x32_bf16 v[160:163],v[16:19],v[56:59],v[160:163]
ds_read_b64_tr_b16 v[228:229],v241 offset:24576
s_waitcnt vmcnt(13)
v_mfma_f32_16x16x32_bf16 v[164:167],v[16:19],v[60:63],v[164:167]
ds_read_b64_tr_b16 v[230:231],v241 offset:26624
s_waitcnt lgkmcnt(8)
v_mfma_f32_16x16x32_bf16 v[172:175],v[20:23],v[60:63],v[172:175]
v_mfma_f32_16x16x32_bf16 v[168:171],v[20:23],v[56:59],v[168:171]
ds_read_b64_tr_b16 v[232:233],v242 offset:24576
ds_read_b64_tr_b16 v[234:235],v242 offset:26624
buffer_load_dwordx4 v[148:151],v246,s[8:11],s58 offen offset:256 sc1
s_waitcnt lgkmcnt(8)
v_mfma_f32_16x16x32_bf16 v[176:179],v[24:27],v[56:59],v[176:179]
ds_read_b64_tr_b16 v[236:237],v243 offset:24576
v_mfma_f32_16x16x32_bf16 v[180:183],v[24:27],v[60:63],v[180:183]
ds_read_b64_tr_b16 v[238:239],v243 offset:26624
s_waitcnt lgkmcnt(8)
v_mfma_f32_16x16x32_bf16 v[188:191],v[28:31],v[60:63],v[188:191]
v_mfma_f32_16x16x32_bf16 v[184:187],v[28:31],v[56:59],v[184:187]
v_add_u32 v13,s50,v3
v_xor_b32 v9,32,v13
v_xor_b32 v10,64,v13
ds_read_b64_tr_b16 v[16:17],v9 offset:0
ds_read_b64_tr_b16 v[18:19],v9 offset:2048
buffer_load_dwordx4 v[152:155],v246,s[8:11],s58 offen offset:2048 sc1
s_waitcnt lgkmcnt(8)
v_mfma_f32_16x16x32_bf16 v[192:195],v[224:227],v[56:59],v[192:195]
ds_read_b64_tr_b16 v[20:21],v10 offset:0
v_mfma_f32_16x16x32_bf16 v[196:199],v[224:227],v[60:63],v[196:199]
ds_read_b64_tr_b16 v[22:23],v10 offset:2048
s_waitcnt lgkmcnt(8)
v_mfma_f32_16x16x32_bf16 v[204:207],v[228:231],v[60:63],v[204:207]
v_mfma_f32_16x16x32_bf16 v[200:203],v[228:231],v[56:59],v[200:203]
v_xor_b32 v11,96,v13
v_xor_b32 v240,128,v13
ds_read_b64_tr_b16 v[24:25],v11 offset:0
ds_read_b64_tr_b16 v[26:27],v11 offset:2048
buffer_load_dwordx4 v[156:159],v246,s[8:11],s58 offen offset:2304 sc1
s_waitcnt lgkmcnt(8)
v_mfma_f32_16x16x32_bf16 v[208:211],v[232:235],v[56:59],v[208:211]
ds_read_b64_tr_b16 v[28:29],v240 offset:0
v_mfma_f32_16x16x32_bf16 v[212:215],v[232:235],v[60:63],v[212:215]
ds_read_b64_tr_b16 v[30:31],v240 offset:2048
s_waitcnt lgkmcnt(8)
v_mfma_f32_16x16x32_bf16 v[220:223],v[236:239],v[60:63],v[220:223]
v_mfma_f32_16x16x32_bf16 v[216:219],v[236:239],v[56:59],v[216:219]
v_xor_b32 v241,160,v13
v_xor_b32 v242,192,v13
ds_read_b64_tr_b16 v[224:225],v241 offset:0
ds_read_b64_tr_b16 v[226:227],v241 offset:2048
s_waitcnt lgkmcnt(8)
s_waitcnt vmcnt(15)
v_mfma_f32_16x16x32_bf16 v[168:171],v[16:19],v[72:75],v[168:171]
ds_read_b64_tr_b16 v[228:229],v242 offset:0
s_waitcnt vmcnt(14)
v_mfma_f32_16x16x32_bf16 v[172:175],v[16:19],v[76:79],v[172:175]
ds_read_b64_tr_b16 v[230:231],v242 offset:2048
s_waitcnt lgkmcnt(8)
v_mfma_f32_16x16x32_bf16 v[180:183],v[20:23],v[76:79],v[180:183]
v_mfma_f32_16x16x32_bf16 v[176:179],v[20:23],v[72:75],v[176:179]
v_xor_b32 v243,224,v13
ds_read_b64_tr_b16 v[232:233],v243 offset:0
ds_read_b64_tr_b16 v[234:235],v243 offset:2048
s_waitcnt lgkmcnt(8)
v_mfma_f32_16x16x32_bf16 v[184:187],v[24:27],v[72:75],v[184:187]
ds_read_b64_tr_b16 v[236:237],v9 offset:8192
v_mfma_f32_16x16x32_bf16 v[188:191],v[24:27],v[76:79],v[188:191]
ds_read_b64_tr_b16 v[238:239],v9 offset:10240
s_waitcnt lgkmcnt(8)
v_mfma_f32_16x16x32_bf16 v[196:199],v[28:31],v[76:79],v[196:199]
v_mfma_f32_16x16x32_bf16 v[192:195],v[28:31],v[72:75],v[192:195]
ds_read_b64_tr_b16 v[16:17],v10 offset:8192
ds_read_b64_tr_b16 v[18:19],v10 offset:10240
s_waitcnt lgkmcnt(8)
v_mfma_f32_16x16x32_bf16 v[200:203],v[224:227],v[72:75],v[200:203]
ds_read_b64_tr_b16 v[20:21],v11 offset:8192
v_mfma_f32_16x16x32_bf16 v[204:207],v[224:227],v[76:79],v[204:207]
ds_read_b64_tr_b16 v[22:23],v11 offset:10240
s_waitcnt lgkmcnt(8)
v_mfma_f32_16x16x32_bf16 v[212:215],v[228:231],v[76:79],v[212:215]
v_mfma_f32_16x16x32_bf16 v[208:211],v[228:231],v[72:75],v[208:211]
ds_read_b64_tr_b16 v[24:25],v240 offset:8192
ds_read_b64_tr_b16 v[26:27],v240 offset:10240
s_waitcnt lgkmcnt(8)
v_mfma_f32_16x16x32_bf16 v[216:219],v[232:235],v[72:75],v[216:219]
ds_read_b64_tr_b16 v[28:29],v241 offset:8192
v_mfma_f32_16x16x32_bf16 v[220:223],v[232:235],v[76:79],v[220:223]
ds_read_b64_tr_b16 v[30:31],v241 offset:10240
s_waitcnt lgkmcnt(8)
s_waitcnt vmcnt(12)
v_mfma_f32_16x16x32_bf16 v[172:175],v[236:239],v[92:95],v[172:175]
v_mfma_f32_16x16x32_bf16 v[168:171],v[236:239],v[88:91],v[168:171]
ds_read_b64_tr_b16 v[224:225],v242 offset:8192
ds_read_b64_tr_b16 v[226:227],v242 offset:10240
s_waitcnt lgkmcnt(8)
v_mfma_f32_16x16x32_bf16 v[176:179],v[16:19],v[88:91],v[176:179]
ds_read_b64_tr_b16 v[228:229],v243 offset:8192
v_mfma_f32_16x16x32_bf16 v[180:183],v[16:19],v[92:95],v[180:183]
ds_read_b64_tr_b16 v[230:231],v243 offset:10240
s_waitcnt lgkmcnt(8)
v_mfma_f32_16x16x32_bf16 v[188:191],v[20:23],v[92:95],v[188:191]
v_mfma_f32_16x16x32_bf16 v[184:187],v[20:23],v[88:91],v[184:187]
ds_read_b64_tr_b16 v[232:233],v9 offset:16384
ds_read_b64_tr_b16 v[234:235],v9 offset:18432
s_waitcnt lgkmcnt(8)
v_mfma_f32_16x16x32_bf16 v[192:195],v[24:27],v[88:91],v[192:195]
ds_read_b64_tr_b16 v[236:237],v10 offset:16384
v_mfma_f32_16x16x32_bf16 v[196:199],v[24:27],v[92:95],v[196:199]
ds_read_b64_tr_b16 v[238:239],v10 offset:18432
s_waitcnt lgkmcnt(8)
v_mfma_f32_16x16x32_bf16 v[204:207],v[28:31],v[92:95],v[204:207]
v_mfma_f32_16x16x32_bf16 v[200:203],v[28:31],v[88:91],v[200:203]
ds_read_b64_tr_b16 v[16:17],v11 offset:16384
ds_read_b64_tr_b16 v[18:19],v11 offset:18432
s_waitcnt lgkmcnt(8)
v_mfma_f32_16x16x32_bf16 v[208:211],v[224:227],v[88:91],v[208:211]
ds_read_b64_tr_b16 v[20:21],v240 offset:16384
v_mfma_f32_16x16x32_bf16 v[212:215],v[224:227],v[92:95],v[212:215]
ds_read_b64_tr_b16 v[22:23],v240 offset:18432
s_waitcnt lgkmcnt(8)
v_mfma_f32_16x16x32_bf16 v[220:223],v[228:231],v[92:95],v[220:223]
v_mfma_f32_16x16x32_bf16 v[216:219],v[228:231],v[88:91],v[216:219]
ds_read_b64_tr_b16 v[24:25],v241 offset:16384
ds_read_b64_tr_b16 v[26:27],v241 offset:18432
s_waitcnt lgkmcnt(8)
s_waitcnt vmcnt(11)
v_mfma_f32_16x16x32_bf16 v[168:171],v[232:235],v[104:107],v[168:171]
ds_read_b64_tr_b16 v[28:29],v242 offset:16384
s_waitcnt vmcnt(10)
v_mfma_f32_16x16x32_bf16 v[172:175],v[232:235],v[108:111],v[172:175]
ds_read_b64_tr_b16 v[30:31],v242 offset:18432
s_waitcnt lgkmcnt(8)
v_mfma_f32_16x16x32_bf16 v[180:183],v[236:239],v[108:111],v[180:183]
v_mfma_f32_16x16x32_bf16 v[176:179],v[236:239],v[104:107],v[176:179]
ds_read_b64_tr_b16 v[224:225],v243 offset:16384
ds_read_b64_tr_b16 v[226:227],v243 offset:18432
s_waitcnt lgkmcnt(8)
v_mfma_f32_16x16x32_bf16 v[184:187],v[16:19],v[104:107],v[184:187]
ds_read_b64_tr_b16 v[228:229],v9 offset:24576
v_mfma_f32_16x16x32_bf16 v[188:191],v[16:19],v[108:111],v[188:191]
ds_read_b64_tr_b16 v[230:231],v9 offset:26624
s_waitcnt lgkmcnt(8)
v_mfma_f32_16x16x32_bf16 v[196:199],v[20:23],v[108:111],v[196:199]
v_mfma_f32_16x16x32_bf16 v[192:195],v[20:23],v[104:107],v[192:195]
ds_read_b64_tr_b16 v[232:233],v10 offset:24576
ds_read_b64_tr_b16 v[234:235],v10 offset:26624
buffer_load_dword v244,v254,s[8:11],0 offen sc1
s_waitcnt lgkmcnt(8)
v_mfma_f32_16x16x32_bf16 v[200:203],v[24:27],v[104:107],v[200:203]
ds_read_b64_tr_b16 v[236:237],v11 offset:24576
v_mfma_f32_16x16x32_bf16 v[204:207],v[24:27],v[108:111],v[204:207]
ds_read_b64_tr_b16 v[238:239],v11 offset:26624
s_waitcnt lgkmcnt(8)
v_mfma_f32_16x16x32_bf16 v[212:215],v[28:31],v[108:111],v[212:215]
v_mfma_f32_16x16x32_bf16 v[208:211],v[28:31],v[104:107],v[208:211]
ds_read_b64_tr_b16 v[16:17],v240 offset:24576
ds_read_b64_tr_b16 v[18:19],v240 offset:26624
s_waitcnt lgkmcnt(8)
v_mfma_f32_16x16x32_bf16 v[216:219],v[224:227],v[104:107],v[216:219]
ds_read_b64_tr_b16 v[20:21],v241 offset:24576
v_mfma_f32_16x16x32_bf16 v[220:223],v[224:227],v[108:111],v[220:223]
ds_read_b64_tr_b16 v[22:23],v241 offset:26624
s_waitcnt lgkmcnt(8)
s_waitcnt vmcnt(9)
v_mfma_f32_16x16x32_bf16 v[172:175],v[228:231],v[124:127],v[172:175]
v_mfma_f32_16x16x32_bf16 v[168:171],v[228:231],v[120:123],v[168:171]
ds_read_b64_tr_b16 v[24:25],v242 offset:24576
ds_read_b64_tr_b16 v[26:27],v242 offset:26624
s_waitcnt lgkmcnt(8)
v_mfma_f32_16x16x32_bf16 v[176:179],v[232:235],v[120:123],v[176:179]
ds_read_b64_tr_b16 v[28:29],v243 offset:24576
v_mfma_f32_16x16x32_bf16 v[180:183],v[232:235],v[124:127],v[180:183]
ds_read_b64_tr_b16 v[30:31],v243 offset:26624
s_waitcnt lgkmcnt(8)
v_mfma_f32_16x16x32_bf16 v[188:191],v[236:239],v[124:127],v[188:191]
v_mfma_f32_16x16x32_bf16 v[184:187],v[236:239],v[120:123],v[184:187]
v_add_u32 v12,s51,v3
v_xor_b32 v243,224,v12
ds_read_b64_tr_b16 v[224:225],v243 offset:0
ds_read_b64_tr_b16 v[226:227],v243 offset:2048
s_waitcnt lgkmcnt(8)
v_mfma_f32_16x16x32_bf16 v[192:195],v[16:19],v[120:123],v[192:195]
ds_read_b64_tr_b16 v[228:229],v243 offset:8192
v_mfma_f32_16x16x32_bf16 v[196:199],v[16:19],v[124:127],v[196:199]
ds_read_b64_tr_b16 v[230:231],v243 offset:10240
s_waitcnt lgkmcnt(8)
v_mfma_f32_16x16x32_bf16 v[204:207],v[20:23],v[124:127],v[204:207]
v_mfma_f32_16x16x32_bf16 v[200:203],v[20:23],v[120:123],v[200:203]
ds_read_b64_tr_b16 v[232:233],v243 offset:16384
ds_read_b64_tr_b16 v[234:235],v243 offset:18432
s_waitcnt lgkmcnt(8)
v_mfma_f32_16x16x32_bf16 v[208:211],v[24:27],v[120:123],v[208:211]
ds_read_b64_tr_b16 v[236:237],v243 offset:24576
v_mfma_f32_16x16x32_bf16 v[212:215],v[24:27],v[124:127],v[212:215]
ds_read_b64_tr_b16 v[238:239],v243 offset:26624
s_waitcnt lgkmcnt(8)
v_mfma_f32_16x16x32_bf16 v[220:223],v[28:31],v[124:127],v[220:223]
v_mfma_f32_16x16x32_bf16 v[216:219],v[28:31],v[120:123],v[216:219]
v_xor_b32 v242,192,v12
ds_read_b64_tr_b16 v[16:17],v242 offset:0
ds_read_b64_tr_b16 v[18:19],v242 offset:2048
s_waitcnt lgkmcnt(8)
s_waitcnt vmcnt(8)
v_mfma_f32_16x16x32_bf16 v[216:219],v[224:227],v[128:131],v[216:219]
ds_read_b64_tr_b16 v[20:21],v242 offset:8192
s_waitcnt vmcnt(7)
v_mfma_f32_16x16x32_bf16 v[220:223],v[224:227],v[132:135],v[220:223]
ds_read_b64_tr_b16 v[22:23],v242 offset:10240
s_waitcnt lgkmcnt(8)
s_waitcnt vmcnt(6)
v_mfma_f32_16x16x32_bf16 v[216:219],v[228:231],v[136:139],v[216:219]
s_waitcnt vmcnt(5)
v_mfma_f32_16x16x32_bf16 v[220:223],v[228:231],v[140:143],v[220:223]
ds_read_b64_tr_b16 v[24:25],v242 offset:16384
ds_read_b64_tr_b16 v[26:27],v242 offset:18432
s_waitcnt lgkmcnt(8)
s_waitcnt vmcnt(4)
v_mfma_f32_16x16x32_bf16 v[216:219],v[232:235],v[144:147],v[216:219]
ds_read_b64_tr_b16 v[28:29],v242 offset:24576
s_waitcnt vmcnt(3)
v_mfma_f32_16x16x32_bf16 v[220:223],v[232:235],v[148:151],v[220:223]
ds_read_b64_tr_b16 v[30:31],v242 offset:26624
s_waitcnt lgkmcnt(8)
s_waitcnt vmcnt(2)
v_mfma_f32_16x16x32_bf16 v[216:219],v[236:239],v[152:155],v[216:219]
s_waitcnt vmcnt(1)
v_mfma_f32_16x16x32_bf16 v[220:223],v[236:239],v[156:159],v[220:223]
v_xor_b32 v241,160,v12
ds_read_b64_tr_b16 v[224:225],v241 offset:0
ds_read_b64_tr_b16 v[226:227],v241 offset:2048
s_waitcnt lgkmcnt(8)
v_mfma_f32_16x16x32_bf16 v[208:211],v[16:19],v[128:131],v[208:211]
ds_read_b64_tr_b16 v[228:229],v241 offset:8192
v_mfma_f32_16x16x32_bf16 v[212:215],v[16:19],v[132:135],v[212:215]
ds_read_b64_tr_b16 v[230:231],v241 offset:10240
s_waitcnt lgkmcnt(8)
v_mfma_f32_16x16x32_bf16 v[208:211],v[20:23],v[136:139],v[208:211]
v_mfma_f32_16x16x32_bf16 v[212:215],v[20:23],v[140:143],v[212:215]
ds_read_b64_tr_b16 v[232:233],v241 offset:16384
ds_read_b64_tr_b16 v[234:235],v241 offset:18432
s_waitcnt lgkmcnt(8)
v_mfma_f32_16x16x32_bf16 v[208:211],v[24:27],v[144:147],v[208:211]
ds_read_b64_tr_b16 v[236:237],v241 offset:24576
v_mfma_f32_16x16x32_bf16 v[212:215],v[24:27],v[148:151],v[212:215]
ds_read_b64_tr_b16 v[238:239],v241 offset:26624
s_waitcnt lgkmcnt(8)
v_mfma_f32_16x16x32_bf16 v[208:211],v[28:31],v[152:155],v[208:211]
v_mfma_f32_16x16x32_bf16 v[212:215],v[28:31],v[156:159],v[212:215]
v_xor_b32 v240,128,v12
ds_read_b64_tr_b16 v[16:17],v240 offset:0
ds_read_b64_tr_b16 v[18:19],v240 offset:2048
s_waitcnt lgkmcnt(8)
v_mfma_f32_16x16x32_bf16 v[200:203],v[224:227],v[128:131],v[200:203]
ds_read_b64_tr_b16 v[20:21],v240 offset:8192
v_mfma_f32_16x16x32_bf16 v[204:207],v[224:227],v[132:135],v[204:207]
ds_read_b64_tr_b16 v[22:23],v240 offset:10240
s_waitcnt lgkmcnt(8)
v_mfma_f32_16x16x32_bf16 v[200:203],v[228:231],v[136:139],v[200:203]
v_mfma_f32_16x16x32_bf16 v[204:207],v[228:231],v[140:143],v[204:207]
ds_read_b64_tr_b16 v[24:25],v240 offset:16384
ds_read_b64_tr_b16 v[26:27],v240 offset:18432
s_waitcnt lgkmcnt(8)
v_mfma_f32_16x16x32_bf16 v[200:203],v[232:235],v[144:147],v[200:203]
ds_read_b64_tr_b16 v[28:29],v240 offset:24576
v_mfma_f32_16x16x32_bf16 v[204:207],v[232:235],v[148:151],v[204:207]
ds_read_b64_tr_b16 v[30:31],v240 offset:26624
s_waitcnt lgkmcnt(8)
v_mfma_f32_16x16x32_bf16 v[200:203],v[236:239],v[152:155],v[200:203]
v_mfma_f32_16x16x32_bf16 v[204:207],v[236:239],v[156:159],v[204:207]
v_xor_b32 v11,96,v12
ds_read_b64_tr_b16 v[224:225],v11 offset:0
ds_read_b64_tr_b16 v[226:227],v11 offset:2048
s_waitcnt vmcnt(0)
v_cmp_ne_u32 vcc,s96,v244
s_and_b32 s4,vcc_lo,0xf0f0f0f0
s_cbranch_scc1 L_p3_ospinb
L_p3_ospinb_back:
buffer_load_dwordx4 v[64:67],v246,s[8:11],s55 offen offset:0 sc1
buffer_load_dwordx4 v[68:71],v246,s[8:11],s55 offen offset:256 sc1
buffer_load_dwordx4 v[80:83],v246,s[8:11],s55 offen offset:2048 sc1
buffer_load_dwordx4 v[84:87],v246,s[8:11],s55 offen offset:2304 sc1
s_cmp_lt_u32 s101,1200
s_cselect_b32 s55,s7,0
s_waitcnt lgkmcnt(8)
v_mfma_f32_16x16x32_bf16 v[192:195],v[16:19],v[128:131],v[192:195]
ds_read_b64_tr_b16 v[228:229],v11 offset:8192
v_mfma_f32_16x16x32_bf16 v[196:199],v[16:19],v[132:135],v[196:199]
ds_read_b64_tr_b16 v[230:231],v11 offset:10240
s_waitcnt lgkmcnt(8)
v_mfma_f32_16x16x32_bf16 v[192:195],v[20:23],v[136:139],v[192:195]
v_mfma_f32_16x16x32_bf16 v[196:199],v[20:23],v[140:143],v[196:199]
ds_read_b64_tr_b16 v[232:233],v11 offset:16384
ds_read_b64_tr_b16 v[234:235],v11 offset:18432
s_waitcnt lgkmcnt(8)
v_mfma_f32_16x16x32_bf16 v[192:195],v[24:27],v[144:147],v[192:195]
ds_read_b64_tr_b16 v[236:237],v11 offset:24576
v_mfma_f32_16x16x32_bf16 v[196:199],v[24:27],v[148:151],v[196:199]
ds_read_b64_tr_b16 v[238:239],v11 offset:26624
s_waitcnt lgkmcnt(8)
v_mfma_f32_16x16x32_bf16 v[192:195],v[28:31],v[152:155],v[192:195]
v_mfma_f32_16x16x32_bf16 v[196:199],v[28:31],v[156:159],v[196:199]
v_xor_b32 v10,64,v12
ds_read_b64_tr_b16 v[16:17],v10 offset:0
ds_read_b64_tr_b16 v[18:19],v10 offset:2048
s_waitcnt lgkmcnt(8)
v_mfma_f32_16x16x32_bf16 v[184:187],v[224:227],v[128:131],v[184:187]
ds_read_b64_tr_b16 v[20:21],v10 offset:8192
v_mfma_f32_16x16x32_bf16 v[188:191],v[224:227],v[132:135],v[188:191]
ds_read_b64_tr_b16 v[22:23],v10 offset:10240
s_waitcnt lgkmcnt(8)
v_mfma_f32_16x16x32_bf16 v[184:187],v[228:231],v[136:139],v[184:187]
v_mfma_f32_16x16x32_bf16 v[188:191],v[228:231],v[140:143],v[188:191]
ds_read_b64_tr_b16 v[24:25],v10 offset:16384
ds_read_b64_tr_b16 v[26:27],v10 offset:18432
s_waitcnt lgkmcnt(8)
v_mfma_f32_16x16x32_bf16 v[184:187],v[232:235],v[144:147],v[184:187]
ds_read_b64_tr_b16 v[28:29],v10 offset:24576
v_mfma_f32_16x16x32_bf16 v[188:191],v[232:235],v[148:151],v[188:191]
ds_read_b64_tr_b16 v[30:31],v10 offset:26624
s_waitcnt lgkmcnt(8)
v_mfma_f32_16x16x32_bf16 v[184:187],v[236:239],v[152:155],v[184:187]
v_mfma_f32_16x16x32_bf16 v[188:191],v[236:239],v[156:159],v[188:191]
v_xor_b32 v9,32,v12
ds_read_b64_tr_b16 v[224:225],v9 offset:0
ds_read_b64_tr_b16 v[226:227],v9 offset:2048
s_waitcnt lgkmcnt(8)
v_mfma_f32_16x16x32_bf16 v[176:179],v[16:19],v[128:131],v[176:179]
ds_read_b64_tr_b16 v[228:229],v9 offset:8192
v_mfma_f32_16x16x32_bf16 v[180:183],v[16:19],v[132:135],v[180:183]
ds_read_b64_tr_b16 v[230:231],v9 offset:10240
s_waitcnt lgkmcnt(8)
v_mfma_f32_16x16x32_bf16 v[176:179],v[20:23],v[136:139],v[176:179]
v_mfma_f32_16x16x32_bf16 v[180:183],v[20:23],v[140:143],v[180:183]
ds_read_b64_tr_b16 v[232:233],v9 offset:16384
ds_read_b64_tr_b16 v[234:235],v9 offset:18432
s_waitcnt lgkmcnt(8)
v_mfma_f32_16x16x32_bf16 v[176:179],v[24:27],v[144:147],v[176:179]
ds_read_b64_tr_b16 v[236:237],v9 offset:24576
v_mfma_f32_16x16x32_bf16 v[180:183],v[24:27],v[148:151],v[180:183]
ds_read_b64_tr_b16 v[238:239],v9 offset:26624
s_waitcnt lgkmcnt(8)
v_mfma_f32_16x16x32_bf16 v[176:179],v[28:31],v[152:155],v[176:179]
v_mfma_f32_16x16x32_bf16 v[180:183],v[28:31],v[156:159],v[180:183]
v_add_u32 v13,s52,v3
v_add_u32 v13,16384,v13
v_xor_b32 v243,224,v13
ds_read_b64_tr_b16 v[16:17],v243 offset:0
ds_read_b64_tr_b16 v[18:19],v243 offset:2048
s_waitcnt lgkmcnt(8)
v_mfma_f32_16x16x32_bf16 v[168:171],v[224:227],v[128:131],v[168:171]
ds_read_b64_tr_b16 v[20:21],v243 offset:8192
v_mfma_f32_16x16x32_bf16 v[172:175],v[224:227],v[132:135],v[172:175]
ds_read_b64_tr_b16 v[22:23],v243 offset:10240
s_waitcnt lgkmcnt(8)
v_mfma_f32_16x16x32_bf16 v[168:171],v[228:231],v[136:139],v[168:171]
v_mfma_f32_16x16x32_bf16 v[172:175],v[228:231],v[140:143],v[172:175]
v_xor_b32 v242,192,v13
ds_read_b64_tr_b16 v[24:25],v242 offset:0
ds_read_b64_tr_b16 v[26:27],v242 offset:2048
s_waitcnt lgkmcnt(8)
v_mfma_f32_16x16x32_bf16 v[168:171],v[232:235],v[144:147],v[168:171]
ds_read_b64_tr_b16 v[28:29],v242 offset:8192
v_mfma_f32_16x16x32_bf16 v[172:175],v[232:235],v[148:151],v[172:175]
ds_read_b64_tr_b16 v[30:31],v242 offset:10240
s_waitcnt lgkmcnt(8)
v_mfma_f32_16x16x32_bf16 v[168:171],v[236:239],v[152:155],v[168:171]
v_mfma_f32_16x16x32_bf16 v[172:175],v[236:239],v[156:159],v[172:175]
v_xor_b32 v241,160,v13
ds_read_b64_tr_b16 v[224:225],v241 offset:0
ds_read_b64_tr_b16 v[226:227],v241 offset:2048
s_waitcnt lgkmcnt(8)
s_waitcnt vmcnt(3)
v_mfma_f32_16x16x32_bf16 v[216:219],v[16:19],v[64:67],v[216:219]
ds_read_b64_tr_b16 v[228:229],v241 offset:8192
s_waitcnt vmcnt(2)
v_mfma_f32_16x16x32_bf16 v[220:223],v[16:19],v[68:71],v[220:223]
ds_read_b64_tr_b16 v[230:231],v241 offset:10240
s_waitcnt lgkmcnt(8)
s_waitcnt vmcnt(1)
v_mfma_f32_16x16x32_bf16 v[216:219],v[20:23],v[80:83],v[216:219]
s_waitcnt vmcnt(0)
v_mfma_f32_16x16x32_bf16 v[220:223],v[20:23],v[84:87],v[220:223]
v_xor_b32 v240,128,v13
ds_read_b64_tr_b16 v[232:233],v240 offset:0
ds_read_b64_tr_b16 v[234:235],v240 offset:2048
s_waitcnt lgkmcnt(8)
v_mfma_f32_16x16x32_bf16 v[208:211],v[24:27],v[64:67],v[208:211]
ds_read_b64_tr_b16 v[236:237],v240 offset:8192
v_mfma_f32_16x16x32_bf16 v[212:215],v[24:27],v[68:71],v[212:215]
ds_read_b64_tr_b16 v[238:239],v240 offset:10240
s_waitcnt lgkmcnt(8)
v_mfma_f32_16x16x32_bf16 v[208:211],v[28:31],v[80:83],v[208:211]
v_cvt_pk_bf16_f32 v216,v216,v217
v_cvt_pk_bf16_f32 v217,v218,v219
v_mfma_f32_16x16x32_bf16 v[212:215],v[28:31],v[84:87],v[212:215]
v_cvt_pk_bf16_f32 v218,v220,v221
v_cvt_pk_bf16_f32 v219,v222,v223
v_xor_b32 v11,96,v13
ds_read_b64_tr_b16 v[16:17],v11 offset:0
ds_read_b64_tr_b16 v[18:19],v11 offset:2048
s_waitcnt lgkmcnt(8)
v_mfma_f32_16x16x32_bf16 v[200:203],v[224:227],v[64:67],v[200:203]
ds_read_b64_tr_b16 v[20:21],v11 offset:8192
s_xor_b32 s57,s56,458752
s_add_u32 s57,s57,46194688
s_cmp_lg_u32 s55,0
s_cbranch_scc1 L_p3_nsb7
buffer_store_dwordx4 v[216:219],v2,s[8:11],s57 offen sc1
L_p3_nsb7:
v_mfma_f32_16x16x32_bf16 v[204:207],v[224:227],v[68:71],v[204:207]
ds_read_b64_tr_b16 v[22:23],v11 offset:10240
s_waitcnt lgkmcnt(8)
v_mfma_f32_16x16x32_bf16 v[200:203],v[228:231],v[80:83],v[200:203]
v_cvt_pk_bf16_f32 v208,v208,v209
v_cvt_pk_bf16_f32 v209,v210,v211
v_mfma_f32_16x16x32_bf16 v[204:207],v[228:231],v[84:87],v[204:207]
v_cvt_pk_bf16_f32 v210,v212,v213
v_cvt_pk_bf16_f32 v211,v214,v215
v_xor_b32 v10,64,v13
ds_read_b64_tr_b16 v[24:25],v10 offset:0
ds_read_b64_tr_b16 v[26:27],v10 offset:2048
s_waitcnt lgkmcnt(8)
v_mfma_f32_16x16x32_bf16 v[192:195],v[232:235],v[64:67],v[192:195]
ds_read_b64_tr_b16 v[28:29],v10 offset:8192
s_xor_b32 s57,s56,393216
s_add_u32 s57,s57,46186496
s_cmp_lg_u32 s55,0
s_cbranch_scc1 L_p3_nsb6
buffer_store_dwordx4 v[208:211],v2,s[8:11],s57 offen sc1
L_p3_nsb6:
v_mfma_f32_16x16x32_bf16 v[196:199],v[232:235],v[68:71],v[196:199]
ds_read_b64_tr_b16 v[30:31],v10 offset:10240
s_waitcnt lgkmcnt(8)
v_mfma_f32_16x16x32_bf16 v[192:195],v[236:239],v[80:83],v[192:195]
v_cvt_pk_bf16_f32 v200,v200,v201
v_cvt_pk_bf16_f32 v201,v202,v203
v_mfma_f32_16x16x32_bf16 v[196:199],v[236:239],v[84:87],v[196:199]
v_cvt_pk_bf16_f32 v202,v204,v205
v_cvt_pk_bf16_f32 v203,v206,v207
v_xor_b32 v9,32,v13
ds_read_b64_tr_b16 v[224:225],v9 offset:0
ds_read_b64_tr_b16 v[226:227],v9 offset:2048
s_waitcnt lgkmcnt(8)
v_mfma_f32_16x16x32_bf16 v[184:187],v[16:19],v[64:67],v[184:187]
ds_read_b64_tr_b16 v[228:229],v9 offset:8192
s_xor_b32 s57,s56,327680
s_add_u32 s57,s57,46178304
s_cmp_lg_u32 s55,0
s_cbranch_scc1 L_p3_nsb5
buffer_store_dwordx4 v[200:203],v2,s[8:11],s57 offen sc1
L_p3_nsb5:
v_mfma_f32_16x16x32_bf16 v[188:191],v[16:19],v[68:71],v[188:191]
ds_read_b64_tr_b16 v[230:231],v9 offset:10240
s_waitcnt lgkmcnt(8)
v_mfma_f32_16x16x32_bf16 v[184:187],v[20:23],v[80:83],v[184:187]
v_cvt_pk_bf16_f32 v192,v192,v193
v_cvt_pk_bf16_f32 v193,v194,v195
v_mfma_f32_16x16x32_bf16 v[188:191],v[20:23],v[84:87],v[188:191]
v_cvt_pk_bf16_f32 v194,v196,v197
v_cvt_pk_bf16_f32 v195,v198,v199
v_add_u32 v8,s50,v3
ds_read_b64_tr_b16 v[232:233],v8 offset:0
ds_read_b64_tr_b16 v[234:235],v8 offset:2048
s_waitcnt lgkmcnt(8)
v_mfma_f32_16x16x32_bf16 v[176:179],v[24:27],v[64:67],v[176:179]
ds_read_b64_tr_b16 v[236:237],v8 offset:8192
s_xor_b32 s57,s56,262144
s_add_u32 s57,s57,46170112
s_cmp_lg_u32 s55,0
s_cbranch_scc1 L_p3_nsb4
buffer_store_dwordx4 v[192:195],v2,s[8:11],s57 offen sc1
L_p3_nsb4:
v_mfma_f32_16x16x32_bf16 v[180:183],v[24:27],v[68:71],v[180:183]
ds_read_b64_tr_b16 v[238:239],v8 offset:10240
s_waitcnt lgkmcnt(8)
v_mfma_f32_16x16x32_bf16 v[176:179],v[28:31],v[80:83],v[176:179]
v_cvt_pk_bf16_f32 v184,v184,v185
v_cvt_pk_bf16_f32 v185,v186,v187
v_mfma_f32_16x16x32_bf16 v[180:183],v[28:31],v[84:87],v[180:183]
v_cvt_pk_bf16_f32 v186,v188,v189
v_cvt_pk_bf16_f32 v187,v190,v191
ds_read_b64_tr_b16 v[16:17],v8 offset:16384
ds_read_b64_tr_b16 v[18:19],v8 offset:18432
s_waitcnt lgkmcnt(8)
v_mfma_f32_16x16x32_bf16 v[168:171],v[224:227],v[64:67],v[168:171]
ds_read_b64_tr_b16 v[20:21],v8 offset:24576
s_xor_b32 s57,s56,196608
s_add_u32 s57,s57,46161920
s_cmp_lg_u32 s55,0
s_cbranch_scc1 L_p3_nsb3
buffer_store_dwordx4 v[184:187],v2,s[8:11],s57 offen sc1
L_p3_nsb3:
v_mfma_f32_16x16x32_bf16 v[172:175],v[224:227],v[68:71],v[172:175]
ds_read_b64_tr_b16 v[22:23],v8 offset:26624
s_waitcnt lgkmcnt(8)
v_mfma_f32_16x16x32_bf16 v[168:171],v[228:231],v[80:83],v[168:171]
v_cvt_pk_bf16_f32 v176,v176,v177
v_cvt_pk_bf16_f32 v177,v178,v179
v_mfma_f32_16x16x32_bf16 v[172:175],v[228:231],v[84:87],v[172:175]
v_cvt_pk_bf16_f32 v178,v180,v181
v_cvt_pk_bf16_f32 v179,v182,v183
v_add_u32 v8,s51,v3
ds_read_b64_tr_b16 v[24:25],v8 offset:0
ds_read_b64_tr_b16 v[26:27],v8 offset:2048
s_waitcnt lgkmcnt(8)
v_mfma_f32_16x16x32_bf16 v[160:163],v[232:235],v[72:75],v[160:163]
ds_read_b64_tr_b16 v[28:29],v8 offset:8192
s_xor_b32 s57,s56,131072
s_add_u32 s57,s57,46153728
s_cmp_lg_u32 s55,0
s_cbranch_scc1 L_p3_nsb2
buffer_store_dwordx4 v[176:179],v2,s[8:11],s57 offen sc1
L_p3_nsb2:
v_mfma_f32_16x16x32_bf16 v[164:167],v[232:235],v[76:79],v[164:167]
ds_read_b64_tr_b16 v[30:31],v8 offset:10240
s_waitcnt lgkmcnt(8)
v_mfma_f32_16x16x32_bf16 v[160:163],v[236:239],v[88:91],v[160:163]
v_cvt_pk_bf16_f32 v168,v168,v169
v_cvt_pk_bf16_f32 v169,v170,v171
v_mfma_f32_16x16x32_bf16 v[164:167],v[236:239],v[92:95],v[164:167]
v_cvt_pk_bf16_f32 v170,v172,v173
v_cvt_pk_bf16_f32 v171,v174,v175
ds_read_b64_tr_b16 v[224:225],v8 offset:16384
ds_read_b64_tr_b16 v[226:227],v8 offset:18432
s_waitcnt lgkmcnt(8)
v_mfma_f32_16x16x32_bf16 v[160:163],v[16:19],v[104:107],v[160:163]
ds_read_b64_tr_b16 v[228:229],v8 offset:24576
s_xor_b32 s57,s56,65536
s_add_u32 s57,s57,46145536
s_cmp_lg_u32 s55,0
s_cbranch_scc1 L_p3_nsb1
buffer_store_dwordx4 v[168:171],v2,s[8:11],s57 offen sc1
L_p3_nsb1:
v_mfma_f32_16x16x32_bf16 v[164:167],v[16:19],v[108:111],v[164:167]
ds_read_b64_tr_b16 v[230:231],v8 offset:26624
s_waitcnt lgkmcnt(8)
v_mfma_f32_16x16x32_bf16 v[160:163],v[20:23],v[120:123],v[160:163]
v_mfma_f32_16x16x32_bf16 v[164:167],v[20:23],v[124:127],v[164:167]
v_mov_b32 v8,v13
ds_read_b64_tr_b16 v[232:233],v8 offset:0
ds_read_b64_tr_b16 v[234:235],v8 offset:2048
s_waitcnt lgkmcnt(8)
v_mfma_f32_16x16x32_bf16 v[160:163],v[24:27],v[128:131],v[160:163]
ds_read_b64_tr_b16 v[236:237],v8 offset:8192
v_mfma_f32_16x16x32_bf16 v[164:167],v[24:27],v[132:135],v[164:167]
ds_read_b64_tr_b16 v[238:239],v8 offset:10240
s_waitcnt lgkmcnt(8)
v_mfma_f32_16x16x32_bf16 v[160:163],v[28:31],v[136:139],v[160:163]
v_mfma_f32_16x16x32_bf16 v[164:167],v[28:31],v[140:143],v[164:167]
s_waitcnt lgkmcnt(6)
v_mfma_f32_16x16x32_bf16 v[160:163],v[224:227],v[144:147],v[160:163]
v_mfma_f32_16x16x32_bf16 v[164:167],v[224:227],v[148:151],v[164:167]
s_waitcnt lgkmcnt(4)
v_mfma_f32_16x16x32_bf16 v[160:163],v[228:231],v[152:155],v[160:163]
v_mfma_f32_16x16x32_bf16 v[164:167],v[228:231],v[156:159],v[164:167]
s_waitcnt lgkmcnt(2)
v_mfma_f32_16x16x32_bf16 v[160:163],v[232:235],v[64:67],v[160:163]
v_mfma_f32_16x16x32_bf16 v[164:167],v[232:235],v[68:71],v[164:167]
s_waitcnt lgkmcnt(0)
v_mfma_f32_16x16x32_bf16 v[160:163],v[236:239],v[80:83],v[160:163]
v_mfma_f32_16x16x32_bf16 v[164:167],v[236:239],v[84:87],v[164:167]
L_p3_x:
s_lshl_b32 s57,s16,2
s_add_u32 s57,s57,s52
v_mov_b32 v5,s57
v_mov_b32 v6,s7
ds_write_b32 v5,v6
L_p3_st:
s_nop 1
L_p3_std:
v_mov_b32 v6,0
ds_write_b32 v7,v6 offset:64
s_add_u32 s56,s56,46137344
s_mov_b32 s54,1
s_waitcnt vmcnt(0) lgkmcnt(0)
s_barrier
s_cmp_eq_u32 s16,0
s_cbranch_scc1 L_p3_xspin
L_p3_xw:
ds_read_b32 v6,v7 offset:64
s_waitcnt lgkmcnt(0)
v_readfirstlane_b32 s4,v6
L_p3_xn:
s_andn2_b32 s58,s4,s54
s_or_b32 s54,s54,s4
s_bitcmp0_b32 s58,1
s_cbranch_scc1 L_p3_xg1
s_add_u32 s57,s56,8192
buffer_load_dwordx4 v[40:43],v2,s[8:11],s57 offen sc1
L_p3_xg1:
s_bitcmp0_b32 s58,2
s_cbranch_scc1 L_p3_xg2
s_add_u32 s57,s56,16384
buffer_load_dwordx4 v[48:51],v2,s[8:11],s57 offen sc1
L_p3_xg2:
s_bitcmp0_b32 s58,3
s_cbranch_scc1 L_p3_xg3
s_add_u32 s57,s56,24576
buffer_load_dwordx4 v[56:59],v2,s[8:11],s57 offen sc1
L_p3_xg3:
s_bitcmp0_b32 s58,4
s_cbranch_scc1 L_p3_xg4
s_add_u32 s57,s56,32768
buffer_load_dwordx4 v[64:67],v2,s[8:11],s57 offen sc1
L_p3_xg4:
s_bitcmp0_b32 s58,5
s_cbranch_scc1 L_p3_xg5
s_add_u32 s57,s56,40960
buffer_load_dwordx4 v[72:75],v2,s[8:11],s57 offen sc1
L_p3_xg5:
s_bitcmp0_b32 s58,6
s_cbranch_scc1 L_p3_xg6
s_add_u32 s57,s56,49152
buffer_load_dwordx4 v[80:83],v2,s[8:11],s57 offen sc1
L_p3_xg6:
s_bitcmp0_b32 s58,7
s_cbranch_scc1 L_p3_xg7
s_add_u32 s57,s56,57344
buffer_load_dwordx4 v[88:91],v2,s[8:11],s57 offen sc1
L_p3_xg7:
s_cmp_lg_u32 s54,0xff
s_cbranch_scc1 L_p3_xmore
s_waitcnt vmcnt(0)
v_lshlrev_b32 v44,16,v40
v_and_b32 v45,0xffff0000,v40
v_pk_add_f32 v[160:161],v[160:161],v[44:45]
v_lshlrev_b32 v46,16,v41
v_and_b32 v47,0xffff0000,v41
v_pk_add_f32 v[162:163],v[162:163],v[46:47]
v_lshlrev_b32 v40,16,v42
v_and_b32 v41,0xffff0000,v42
v_pk_add_f32 v[164:165],v[164:165],v[40:41]
v_lshlrev_b32 v42,16,v43
v_and_b32 v43,0xffff0000,v43
v_pk_add_f32 v[166:167],v[166:167],v[42:43]
v_lshlrev_b32 v52,16,v48
v_and_b32 v53,0xffff0000,v48
v_pk_add_f32 v[160:161],v[160:161],v[52:53]
v_lshlrev_b32 v54,16,v49
v_and_b32 v55,0xffff0000,v49
v_pk_add_f32 v[162:163],v[162:163],v[54:55]
v_lshlrev_b32 v48,16,v50
v_and_b32 v49,0xffff0000,v50
v_pk_add_f32 v[164:165],v[164:165],v[48:49]
v_lshlrev_b32 v50,16,v51
v_and_b32 v51,0xffff0000,v51
v_pk_add_f32 v[166:167],v[166:167],v[50:51]
v_lshlrev_b32 v60,16,v56
v_and_b32 v61,0xffff0000,v56
v_pk_add_f32 v[160:161],v[160:161],v[60:61]
v_lshlrev_b32 v62,16,v57
v_and_b32 v63,0xffff0000,v57
v_pk_add_f32 v[162:163],v[162:163],v[62:63]
v_lshlrev_b32 v56,16,v58
v_and_b32 v57,0xffff0000,v58
v_pk_add_f32 v[164:165],v[164:165],v[56:57]
v_lshlrev_b32 v58,16,v59
v_and_b32 v59,0xffff0000,v59
v_pk_add_f32 v[166:167],v[166:167],v[58:59]
v_lshlrev_b32 v68,16,v64
v_and_b32 v69,0xffff0000,v64
v_pk_add_f32 v[160:161],v[160:161],v[68:69]
v_lshlrev_b32 v70,16,v65
v_and_b32 v71,0xffff0000,v65
v_pk_add_f32 v[162:163],v[162:163],v[70:71]
v_lshlrev_b32 v64,16,v66
v_and_b32 v65,0xffff0000,v66
v_pk_add_f32 v[164:165],v[164:165],v[64:65]
v_lshlrev_b32 v66,16,v67
v_and_b32 v67,0xffff0000,v67
v_pk_add_f32 v[166:167],v[166:167],v[66:67]
v_lshlrev_b32 v76,16,v72
v_and_b32 v77,0xffff0000,v72
v_pk_add_f32 v[160:161],v[160:161],v[76:77]
v_lshlrev_b32 v78,16,v73
v_and_b32 v79,0xffff0000,v73
v_pk_add_f32 v[162:163],v[162:163],v[78:79]
v_lshlrev_b32 v72,16,v74
v_and_b32 v73,0xffff0000,v74
v_pk_add_f32 v[164:165],v[164:165],v[72:73]
v_lshlrev_b32 v74,16,v75
v_and_b32 v75,0xffff0000,v75
v_pk_add_f32 v[166:167],v[166:167],v[74:75]
v_lshlrev_b32 v84,16,v80
v_and_b32 v85,0xffff0000,v80
v_pk_add_f32 v[160:161],v[160:161],v[84:85]
v_lshlrev_b32 v86,16,v81
v_and_b32 v87,0xffff0000,v81
v_pk_add_f32 v[162:163],v[162:163],v[86:87]
v_lshlrev_b32 v80,16,v82
v_and_b32 v81,0xffff0000,v82
v_pk_add_f32 v[164:165],v[164:165],v[80:81]
v_lshlrev_b32 v82,16,v83
v_and_b32 v83,0xffff0000,v83
v_pk_add_f32 v[166:167],v[166:167],v[82:83]
v_lshlrev_b32 v92,16,v88
v_and_b32 v93,0xffff0000,v88
v_pk_add_f32 v[160:161],v[160:161],v[92:93]
v_lshlrev_b32 v94,16,v89
v_and_b32 v95,0xffff0000,v89
v_pk_add_f32 v[162:163],v[162:163],v[94:95]
v_lshlrev_b32 v88,16,v90
v_and_b32 v89,0xffff0000,v90
v_pk_add_f32 v[164:165],v[164:165],v[88:89]
v_lshlrev_b32 v90,16,v91
v_and_b32 v91,0xffff0000,v91
v_pk_add_f32 v[166:167],v[166:167],v[90:91]
v_cvt_pk_bf16_f32 v160,v160,v161
v_cvt_pk_bf16_f32 v161,v162,v163
v_cvt_pk_bf16_f32 v162,v164,v165
v_cvt_pk_bf16_f32 v163,v166,v167
s_nop 0
v_permlane16_swap_b32 v160,v162
v_permlane16_swap_b32 v161,v163
buffer_store_dwordx4 v[160:163],v252,s[40:43],s60 offen
L_k2_end:
L_k1_end:
s_waitcnt vmcnt(0)
s_endpgm
L_k2_spin1:
s_mov_b32 s32,0
L_k2_spin1_loop:
buffer_load_dword v15,v4,s[8:11],0 offen sc1
s_add_u32 s32,s32,1
s_waitcnt vmcnt(0)
v_cmp_ne_u32 vcc,s96,v15
s_cbranch_vccz L_k2_spin1_back
s_sleep 16
s_cmp_lt_u32 s32,150
s_cbranch_scc1 L_k2_spin1_loop
s_mov_b32 s7,1
s_branch L_k2_spin1_back
L_k2_spin2:
s_mov_b32 s32,0
L_k2_spin2_loop:
buffer_load_dword v15,v253,s[8:11],0 offen sc1
s_add_u32 s32,s32,1
s_waitcnt vmcnt(0)
v_cmp_ne_u32 vcc,s96,v15
s_cbranch_vccz L_k2_spin2_back
s_sleep 16
s_cmp_lt_u32 s32,150
s_cbranch_scc1 L_k2_spin2_loop
s_mov_b32 s7,1
s_branch L_k2_spin2_back
L_xf_spin4:
s_mov_b32 s32,0
L_xf_spin4_loop:
buffer_load_dword v14,v23,s[40:43],0 offen sc1
s_add_u32 s32,s32,1
s_waitcnt vmcnt(0)
v_cmp_ne_u32 vcc,s96,v14
s_cbranch_vccz L_xf_ok4
s_sleep 16
s_cmp_lt_u32 s32,150
s_cbranch_scc1 L_xf_spin4_loop
s_mov_b32 s7,1
s_branch L_xf_ok4
L_xf_spin8:
s_mov_b32 s32,0
L_xf_spin8_loop:
buffer_load_dword v14,v23,s[40:43],0 offen sc1
s_add_u32 s32,s32,1
s_waitcnt vmcnt(0)
v_cmp_ne_u32 vcc,s96,v14
s_cbranch_vccz L_xf_ok8
s_sleep 16
s_cmp_lt_u32 s32,150
s_cbranch_scc1 L_xf_spin8_loop
s_mov_b32 s7,1
s_branch L_xf_ok8
L_xf_spin12:
s_mov_b32 s32,0
L_xf_spin12_loop:
buffer_load_dword v14,v23,s[40:43],0 offen sc1
s_add_u32 s32,s32,1
s_waitcnt vmcnt(0)
v_cmp_ne_u32 vcc,s96,v14
s_cbranch_vccz L_xf_ok12
s_sleep 16
s_cmp_lt_u32 s32,150
s_cbranch_scc1 L_xf_spin12_loop
s_mov_b32 s7,1
s_branch L_xf_ok12
L_xf_spin16:
s_mov_b32 s32,0
L_xf_spin16_loop:
buffer_load_dword v14,v23,s[40:43],0 offen sc1
s_add_u32 s32,s32,1
s_waitcnt vmcnt(0)
v_cmp_ne_u32 vcc,s96,v14
s_cbranch_vccz L_xf_ok16
s_sleep 16
s_cmp_lt_u32 s32,150
s_cbranch_scc1 L_xf_spin16_loop
s_mov_b32 s7,1
s_branch L_xf_ok16
L_xf_spin22:
s_mov_b32 s32,0
L_xf_spin22_loop:
buffer_load_dword v14,v23,s[40:43],0 offen sc1
s_add_u32 s32,s32,1
s_waitcnt vmcnt(0)
v_cmp_ne_u32 vcc,s96,v14
s_cbranch_vccz L_xf_ok22
s_sleep 16
s_cmp_lt_u32 s32,150
s_cbranch_scc1 L_xf_spin22_loop
s_mov_b32 s7,1
s_branch L_xf_ok22
L_tag_slow:
s_mov_b32 s97,0
L_tag_sp:
buffer_load_dword v14,off,s[92:95],0 sc1
s_add_u32 s97,s97,1
s_waitcnt vmcnt(0)
v_readfirstlane_b32 s96,v14
s_cmp_eq_u32 s96,0
s_cbranch_scc1 L_tag_sq
s_setpc_b64 s[66:67]
L_tag_sq:
s_sleep 8
s_cmp_lt_u32 s97,8
s_cbranch_scc1 L_tag_sp
s_mov_b32 s96,0
v_lshrrev_b32 v14,1,v1
v_lshlrev_b32 v14,8,v14
v_and_b32 v15,1,v1
v_lshl_add_u32 v14,v15,4,v14
v_add_u32 v14,101777408,v14
v_lshlrev_b32 v15,4,v1
v_add_u32 v15,101785600,v15
L_tag_sn:
s_add_u32 s96,s96,1
buffer_load_dwordx4 v[16:19],v14,s[40:43],0 offen offset:0 sc1
s_waitcnt vmcnt(0)
v_cmp_eq_u32 vcc,s96,v16
s_cbranch_vccnz L_tag_sn
v_cmp_eq_u32 vcc,s96,v17
s_cbranch_vccnz L_tag_sn
v_cmp_eq_u32 vcc,s96,v18
s_cbranch_vccnz L_tag_sn
v_cmp_eq_u32 vcc,s96,v19
s_cbranch_vccnz L_tag_sn
s_mov_b32 s97,0
buffer_load_dwordx4 v[16:19],v15,s[40:43],s97 offen offset:0 sc1
s_waitcnt vmcnt(0)
v_cmp_eq_u32 vcc,s96,v16
s_cbranch_vccnz L_tag_sn
v_cmp_eq_u32 vcc,s96,v17
s_cbranch_vccnz L_tag_sn
v_cmp_eq_u32 vcc,s96,v18
s_cbranch_vccnz L_tag_sn
v_cmp_eq_u32 vcc,s96,v19
s_cbranch_vccnz L_tag_sn
buffer_load_dwordx4 v[16:19],v15,s[40:43],s97 offen offset:1024 sc1
s_waitcnt vmcnt(0)
v_cmp_eq_u32 vcc,s96,v16
s_cbranch_vccnz L_tag_sn
v_cmp_eq_u32 vcc,s96,v17
s_cbranch_vccnz L_tag_sn
v_cmp_eq_u32 vcc,s96,v18
s_cbranch_vccnz L_tag_sn
v_cmp_eq_u32 vcc,s96,v19
s_cbranch_vccnz L_tag_sn
buffer_load_dwordx4 v[16:19],v15,s[40:43],s97 offen offset:2048 sc1
s_waitcnt vmcnt(0)
v_cmp_eq_u32 vcc,s96,v16
s_cbranch_vccnz L_tag_sn
v_cmp_eq_u32 vcc,s96,v17
s_cbranch_vccnz L_tag_sn
v_cmp_eq_u32 vcc,s96,v18
s_cbranch_vccnz L_tag_sn
v_cmp_eq_u32 vcc,s96,v19
s_cbranch_vccnz L_tag_sn
buffer_load_dwordx4 v[16:19],v15,s[40:43],s97 offen offset:3072 sc1
s_waitcnt vmcnt(0)
v_cmp_eq_u32 vcc,s96,v16
s_cbranch_vccnz L_tag_sn
v_cmp_eq_u32 vcc,s96,v17
s_cbranch_vccnz L_tag_sn
v_cmp_eq_u32 vcc,s96,v18
s_cbranch_vccnz L_tag_sn
v_cmp_eq_u32 vcc,s96,v19
s_cbranch_vccnz L_tag_sn
s_mov_b32 s97,4096
buffer_load_dwordx4 v[16:19],v15,s[40:43],s97 offen offset:0 sc1
s_waitcnt vmcnt(0)
v_cmp_eq_u32 vcc,s96,v16
s_cbranch_vccnz L_tag_sn
v_cmp_eq_u32 vcc,s96,v17
s_cbranch_vccnz L_tag_sn
v_cmp_eq_u32 vcc,s96,v18
s_cbranch_vccnz L_tag_sn
v_cmp_eq_u32 vcc,s96,v19
s_cbranch_vccnz L_tag_sn
buffer_load_dwordx4 v[16:19],v15,s[40:43],s97 offen offset:1024 sc1
s_waitcnt vmcnt(0)
v_cmp_eq_u32 vcc,s96,v16
s_cbranch_vccnz L_tag_sn
v_cmp_eq_u32 vcc,s96,v17
s_cbranch_vccnz L_tag_sn
v_cmp_eq_u32 vcc,s96,v18
s_cbranch_vccnz L_tag_sn
v_cmp_eq_u32 vcc,s96,v19
s_cbranch_vccnz L_tag_sn
buffer_load_dwordx4 v[16:19],v15,s[40:43],s97 offen offset:2048 sc1
s_waitcnt vmcnt(0)
v_cmp_eq_u32 vcc,s96,v16
s_cbranch_vccnz L_tag_sn
v_cmp_eq_u32 vcc,s96,v17
s_cbranch_vccnz L_tag_sn
v_cmp_eq_u32 vcc,s96,v18
s_cbranch_vccnz L_tag_sn
v_cmp_eq_u32 vcc,s96,v19
s_cbranch_vccnz L_tag_sn
buffer_load_dwordx4 v[16:19],v15,s[40:43],s97 offen offset:3072 sc1
s_waitcnt vmcnt(0)
v_cmp_eq_u32 vcc,s96,v16
s_cbranch_vccnz L_tag_sn
v_cmp_eq_u32 vcc,s96,v17
s_cbranch_vccnz L_tag_sn
v_cmp_eq_u32 vcc,s96,v18
s_cbranch_vccnz L_tag_sn
v_cmp_eq_u32 vcc,s96,v19
s_cbranch_vccnz L_tag_sn
s_mov_b32 s97,8192
buffer_load_dwordx4 v[16:19],v15,s[40:43],s97 offen offset:0 sc1
s_waitcnt vmcnt(0)
v_cmp_eq_u32 vcc,s96,v16
s_cbranch_vccnz L_tag_sn
v_cmp_eq_u32 vcc,s96,v17
s_cbranch_vccnz L_tag_sn
v_cmp_eq_u32 vcc,s96,v18
s_cbranch_vccnz L_tag_sn
v_cmp_eq_u32 vcc,s96,v19
s_cbranch_vccnz L_tag_sn
buffer_load_dwordx4 v[16:19],v15,s[40:43],s97 offen offset:1024 sc1
s_waitcnt vmcnt(0)
v_cmp_eq_u32 vcc,s96,v16
s_cbranch_vccnz L_tag_sn
v_cmp_eq_u32 vcc,s96,v17
s_cbranch_vccnz L_tag_sn
v_cmp_eq_u32 vcc,s96,v18
s_cbranch_vccnz L_tag_sn
v_cmp_eq_u32 vcc,s96,v19
s_cbranch_vccnz L_tag_sn
buffer_load_dwordx4 v[16:19],v15,s[40:43],s97 offen offset:2048 sc1
s_waitcnt vmcnt(0)
v_cmp_eq_u32 vcc,s96,v16
s_cbranch_vccnz L_tag_sn
v_cmp_eq_u32 vcc,s96,v17
s_cbranch_vccnz L_tag_sn
v_cmp_eq_u32 vcc,s96,v18
s_cbranch_vccnz L_tag_sn
v_cmp_eq_u32 vcc,s96,v19
s_cbranch_vccnz L_tag_sn
buffer_load_dwordx4 v[16:19],v15,s[40:43],s97 offen offset:3072 sc1
s_waitcnt vmcnt(0)
v_cmp_eq_u32 vcc,s96,v16
s_cbranch_vccnz L_tag_sn
v_cmp_eq_u32 vcc,s96,v17
s_cbranch_vccnz L_tag_sn
v_cmp_eq_u32 vcc,s96,v18
s_cbranch_vccnz L_tag_sn
v_cmp_eq_u32 vcc,s96,v19
s_cbranch_vccnz L_tag_sn
s_mov_b32 s97,12288
buffer_load_dwordx4 v[16:19],v15,s[40:43],s97 offen offset:0 sc1
s_waitcnt vmcnt(0)
v_cmp_eq_u32 vcc,s96,v16
s_cbranch_vccnz L_tag_sn
v_cmp_eq_u32 vcc,s96,v17
s_cbranch_vccnz L_tag_sn
v_cmp_eq_u32 vcc,s96,v18
s_cbranch_vccnz L_tag_sn
v_cmp_eq_u32 vcc,s96,v19
s_cbranch_vccnz L_tag_sn
buffer_load_dwordx4 v[16:19],v15,s[40:43],s97 offen offset:1024 sc1
s_waitcnt vmcnt(0)
v_cmp_eq_u32 vcc,s96,v16
s_cbranch_vccnz L_tag_sn
v_cmp_eq_u32 vcc,s96,v17
s_cbranch_vccnz L_tag_sn
v_cmp_eq_u32 vcc,s96,v18
s_cbranch_vccnz L_tag_sn
v_cmp_eq_u32 vcc,s96,v19
s_cbranch_vccnz L_tag_sn
buffer_load_dwordx4 v[16:19],v14,s[40:43],0 offen offset:128 sc1
s_waitcnt vmcnt(0)
v_cmp_eq_u32 vcc,s96,v16
s_cbranch_vccnz L_tag_sn
v_cmp_eq_u32 vcc,s96,v17
s_cbranch_vccnz L_tag_sn
v_cmp_eq_u32 vcc,s96,v18
s_cbranch_vccnz L_tag_sn
v_cmp_eq_u32 vcc,s96,v19
s_cbranch_vccnz L_tag_sn
v_mov_b32 v14,s96
v_mov_b32 v15,0
s_mov_b64 exec,1
buffer_atomic_cmpswap v[14:15],off,s[92:95],0 sc0 sc1
s_mov_b64 exec,-1
s_waitcnt vmcnt(0)
v_readfirstlane_b32 s97,v14
s_cmp_eq_u32 s97,0
s_cselect_b32 s96,s96,s97
s_setpc_b64 s[66:67]
L_p3_g0:
s_waitcnt lgkmcnt(0)
v_add_u32 v8,s48,v3
v_xor_b32 v9,32,v8
ds_read_b64_tr_b16 v[16:17],v8 offset:0
ds_read_b64_tr_b16 v[18:19],v8 offset:2048
ds_read_b64_tr_b16 v[20:21],v9 offset:0
ds_read_b64_tr_b16 v[22:23],v9 offset:2048
v_xor_b32 v10,64,v8
v_xor_b32 v11,96,v8
ds_read_b64_tr_b16 v[24:25],v10 offset:0
ds_read_b64_tr_b16 v[26:27],v10 offset:2048
ds_read_b64_tr_b16 v[28:29],v11 offset:0
ds_read_b64_tr_b16 v[30:31],v11 offset:2048
v_xor_b32 v240,128,v8
v_xor_b32 v241,160,v8
ds_read_b64_tr_b16 v[224:225],v240 offset:0
ds_read_b64_tr_b16 v[226:227],v240 offset:2048
s_waitcnt lgkmcnt(8)
v_mfma_f32_16x16x32_bf16 v[160:163],v[16:19],v[64:67],0
ds_read_b64_tr_b16 v[228:229],v241 offset:0
v_mfma_f32_16x16x32_bf16 v[164:167],v[16:19],v[68:71],0
ds_read_b64_tr_b16 v[230:231],v241 offset:2048
s_lshl_b32 s62,s16,13
s_add_u32 s62,s62,s51
s_xor_b32 s63,s33,393216
s_add_u32 m0,s62,0
s_add_u32 s57,s63,0
buffer_load_dwordx4 v255,s[12:15],s57 offen lds
s_waitcnt lgkmcnt(8)
v_mfma_f32_16x16x32_bf16 v[172:175],v[20:23],v[68:71],0
v_mfma_f32_16x16x32_bf16 v[168:171],v[20:23],v[64:67],0
s_add_u32 m0,s62,1024
s_add_u32 s57,s63,4096
buffer_load_dwordx4 v255,s[12:15],s57 offen lds
v_xor_b32 v242,192,v8
v_xor_b32 v243,224,v8
ds_read_b64_tr_b16 v[232:233],v242 offset:0
ds_read_b64_tr_b16 v[234:235],v242 offset:2048
s_waitcnt lgkmcnt(8)
v_mfma_f32_16x16x32_bf16 v[176:179],v[24:27],v[64:67],0
ds_read_b64_tr_b16 v[236:237],v243 offset:0
v_mfma_f32_16x16x32_bf16 v[180:183],v[24:27],v[68:71],0
ds_read_b64_tr_b16 v[238:239],v243 offset:2048
s_add_u32 m0,s62,2048
s_add_u32 s57,s63,8192
buffer_load_dwordx4 v255,s[12:15],s57 offen lds
s_waitcnt lgkmcnt(8)
v_mfma_f32_16x16x32_bf16 v[188:191],v[28:31],v[68:71],0
v_mfma_f32_16x16x32_bf16 v[184:187],v[28:31],v[64:67],0
s_add_u32 m0,s62,3072
s_add_u32 s57,s63,12288
buffer_load_dwordx4 v255,s[12:15],s57 offen lds
ds_read_b64_tr_b16 v[16:17],v8 offset:8192
ds_read_b64_tr_b16 v[18:19],v8 offset:10240
s_waitcnt lgkmcnt(8)
v_mfma_f32_16x16x32_bf16 v[192:195],v[224:227],v[64:67],0
ds_read_b64_tr_b16 v[20:21],v9 offset:8192
v_mfma_f32_16x16x32_bf16 v[196:199],v[224:227],v[68:71],0
ds_read_b64_tr_b16 v[22:23],v9 offset:10240
v_xor_b32 v255,32,v255
s_add_u32 m0,s62,4096
s_add_u32 s57,s63,16384
buffer_load_dwordx4 v255,s[12:15],s57 offen lds
s_waitcnt lgkmcnt(8)
v_mfma_f32_16x16x32_bf16 v[204:207],v[228:231],v[68:71],0
v_mfma_f32_16x16x32_bf16 v[200:203],v[228:231],v[64:67],0
s_add_u32 m0,s62,5120
s_add_u32 s57,s63,20480
buffer_load_dwordx4 v255,s[12:15],s57 offen lds
ds_read_b64_tr_b16 v[24:25],v10 offset:8192
ds_read_b64_tr_b16 v[26:27],v10 offset:10240
s_waitcnt lgkmcnt(8)
v_mfma_f32_16x16x32_bf16 v[208:211],v[232:235],v[64:67],0
ds_read_b64_tr_b16 v[28:29],v11 offset:8192
v_mfma_f32_16x16x32_bf16 v[212:215],v[232:235],v[68:71],0
ds_read_b64_tr_b16 v[30:31],v11 offset:10240
s_add_u32 m0,s62,6144
s_add_u32 s57,s63,24576
buffer_load_dwordx4 v255,s[12:15],s57 offen lds
s_waitcnt lgkmcnt(8)
v_mfma_f32_16x16x32_bf16 v[220:223],v[236:239],v[68:71],0
v_mfma_f32_16x16x32_bf16 v[216:219],v[236:239],v[64:67],0
s_add_u32 m0,s62,7168
s_add_u32 s57,s63,28672
buffer_load_dwordx4 v255,s[12:15],s57 offen lds
ds_read_b64_tr_b16 v[224:225],v240 offset:8192
ds_read_b64_tr_b16 v[226:227],v240 offset:10240
s_waitcnt lgkmcnt(8)
v_mfma_f32_16x16x32_bf16 v[160:163],v[16:19],v[80:83],v[160:163]
ds_read_b64_tr_b16 v[228:229],v241 offset:8192
v_mfma_f32_16x16x32_bf16 v[164:167],v[16:19],v[84:87],v[164:167]
ds_read_b64_tr_b16 v[230:231],v241 offset:10240
s_lshl_b32 s64,s16,12
s_add_u32 s64,s64,s52
s_lshl_b32 s65,s53,2
s_add_u32 s65,s65,s16
s_lshl_b32 s65,s65,14
s_and_b32 s58,s33,0x3ff
s_add_u32 s65,s65,s58
s_andn2_b32 s58,1,s16
s_lshl_b32 s58,s58,5
v_xor_b32 v255,s58,v255
s_add_u32 m0,s64,16384
s_add_u32 s57,s65,0
buffer_load_dwordx4 v255,s[44:47],s57 offen lds
s_waitcnt lgkmcnt(8)
v_mfma_f32_16x16x32_bf16 v[172:175],v[20:23],v[84:87],v[172:175]
v_mfma_f32_16x16x32_bf16 v[168:171],v[20:23],v[80:83],v[168:171]
s_add_u32 m0,s64,17408
s_add_u32 s57,s65,4096
buffer_load_dwordx4 v255,s[44:47],s57 offen lds
ds_read_b64_tr_b16 v[232:233],v242 offset:8192
ds_read_b64_tr_b16 v[234:235],v242 offset:10240
s_waitcnt lgkmcnt(8)
v_mfma_f32_16x16x32_bf16 v[176:179],v[24:27],v[80:83],v[176:179]
ds_read_b64_tr_b16 v[236:237],v243 offset:8192
v_mfma_f32_16x16x32_bf16 v[180:183],v[24:27],v[84:87],v[180:183]
ds_read_b64_tr_b16 v[238:239],v243 offset:10240
s_add_u32 m0,s64,18432
s_add_u32 s57,s65,8192
buffer_load_dwordx4 v255,s[44:47],s57 offen lds
s_waitcnt lgkmcnt(8)
v_mfma_f32_16x16x32_bf16 v[188:191],v[28:31],v[84:87],v[188:191]
v_mfma_f32_16x16x32_bf16 v[184:187],v[28:31],v[80:83],v[184:187]
s_add_u32 m0,s64,19456
s_add_u32 s57,s65,12288
buffer_load_dwordx4 v255,s[44:47],s57 offen lds
s_and_b32 s57,s16,1
s_lshl_b32 s57,s57,5
v_xor_b32 v255,s57,v255
ds_read_b64_tr_b16 v[16:17],v8 offset:16384
ds_read_b64_tr_b16 v[18:19],v8 offset:18432
s_waitcnt lgkmcnt(8)
v_mfma_f32_16x16x32_bf16 v[192:195],v[224:227],v[80:83],v[192:195]
ds_read_b64_tr_b16 v[20:21],v9 offset:16384
v_mfma_f32_16x16x32_bf16 v[196:199],v[224:227],v[84:87],v[196:199]
ds_read_b64_tr_b16 v[22:23],v9 offset:18432
s_waitcnt lgkmcnt(8)
v_mfma_f32_16x16x32_bf16 v[204:207],v[228:231],v[84:87],v[204:207]
v_mfma_f32_16x16x32_bf16 v[200:203],v[228:231],v[80:83],v[200:203]
ds_read_b64_tr_b16 v[24:25],v10 offset:16384
ds_read_b64_tr_b16 v[26:27],v10 offset:18432
s_waitcnt lgkmcnt(8)
v_mfma_f32_16x16x32_bf16 v[208:211],v[232:235],v[80:83],v[208:211]
ds_read_b64_tr_b16 v[28:29],v11 offset:16384
v_mfma_f32_16x16x32_bf16 v[212:215],v[232:235],v[84:87],v[212:215]
ds_read_b64_tr_b16 v[30:31],v11 offset:18432
s_waitcnt lgkmcnt(8)
v_mfma_f32_16x16x32_bf16 v[220:223],v[236:239],v[84:87],v[220:223]
v_mfma_f32_16x16x32_bf16 v[216:219],v[236:239],v[80:83],v[216:219]
ds_read_b64_tr_b16 v[224:225],v240 offset:16384
ds_read_b64_tr_b16 v[226:227],v240 offset:18432
s_waitcnt lgkmcnt(8)
v_mfma_f32_16x16x32_bf16 v[160:163],v[16:19],v[96:99],v[160:163]
ds_read_b64_tr_b16 v[228:229],v241 offset:16384
v_mfma_f32_16x16x32_bf16 v[164:167],v[16:19],v[100:103],v[164:167]
ds_read_b64_tr_b16 v[230:231],v241 offset:18432
s_waitcnt lgkmcnt(8)
v_mfma_f32_16x16x32_bf16 v[172:175],v[20:23],v[100:103],v[172:175]
v_mfma_f32_16x16x32_bf16 v[168:171],v[20:23],v[96:99],v[168:171]
ds_read_b64_tr_b16 v[232:233],v242 offset:16384
ds_read_b64_tr_b16 v[234:235],v242 offset:18432
s_waitcnt lgkmcnt(8)
v_mfma_f32_16x16x32_bf16 v[176:179],v[24:27],v[96:99],v[176:179]
ds_read_b64_tr_b16 v[236:237],v243 offset:16384
v_mfma_f32_16x16x32_bf16 v[180:183],v[24:27],v[100:103],v[180:183]
ds_read_b64_tr_b16 v[238:239],v243 offset:18432
s_waitcnt lgkmcnt(8)
v_mfma_f32_16x16x32_bf16 v[188:191],v[28:31],v[100:103],v[188:191]
v_mfma_f32_16x16x32_bf16 v[184:187],v[28:31],v[96:99],v[184:187]
ds_read_b64_tr_b16 v[16:17],v8 offset:24576
ds_read_b64_tr_b16 v[18:19],v8 offset:26624
s_waitcnt lgkmcnt(8)
v_mfma_f32_16x16x32_bf16 v[192:195],v[224:227],v[96:99],v[192:195]
ds_read_b64_tr_b16 v[20:21],v9 offset:24576
v_mfma_f32_16x16x32_bf16 v[196:199],v[224:227],v[100:103],v[196:199]
ds_read_b64_tr_b16 v[22:23],v9 offset:26624
s_waitcnt lgkmcnt(8)
v_mfma_f32_16x16x32_bf16 v[204:207],v[228:231],v[100:103],v[204:207]
v_mfma_f32_16x16x32_bf16 v[200:203],v[228:231],v[96:99],v[200:203]
ds_read_b64_tr_b16 v[24:25],v10 offset:24576
ds_read_b64_tr_b16 v[26:27],v10 offset:26624
s_waitcnt lgkmcnt(8)
v_mfma_f32_16x16x32_bf16 v[208:211],v[232:235],v[96:99],v[208:211]
ds_read_b64_tr_b16 v[28:29],v11 offset:24576
v_mfma_f32_16x16x32_bf16 v[212:215],v[232:235],v[100:103],v[212:215]
ds_read_b64_tr_b16 v[30:31],v11 offset:26624
s_waitcnt lgkmcnt(8)
v_mfma_f32_16x16x32_bf16 v[220:223],v[236:239],v[100:103],v[220:223]
v_mfma_f32_16x16x32_bf16 v[216:219],v[236:239],v[96:99],v[216:219]
ds_read_b64_tr_b16 v[224:225],v240 offset:24576
ds_read_b64_tr_b16 v[226:227],v240 offset:26624
s_waitcnt lgkmcnt(8)
v_mfma_f32_16x16x32_bf16 v[160:163],v[16:19],v[112:115],v[160:163]
ds_read_b64_tr_b16 v[228:229],v241 offset:24576
v_mfma_f32_16x16x32_bf16 v[164:167],v[16:19],v[116:119],v[164:167]
ds_read_b64_tr_b16 v[230:231],v241 offset:26624
s_waitcnt lgkmcnt(8)
v_mfma_f32_16x16x32_bf16 v[172:175],v[20:23],v[116:119],v[172:175]
v_mfma_f32_16x16x32_bf16 v[168:171],v[20:23],v[112:115],v[168:171]
ds_read_b64_tr_b16 v[232:233],v242 offset:24576
ds_read_b64_tr_b16 v[234:235],v242 offset:26624
s_waitcnt lgkmcnt(8)
v_mfma_f32_16x16x32_bf16 v[176:179],v[24:27],v[112:115],v[176:179]
ds_read_b64_tr_b16 v[236:237],v243 offset:24576
v_mfma_f32_16x16x32_bf16 v[180:183],v[24:27],v[116:119],v[180:183]
ds_read_b64_tr_b16 v[238:239],v243 offset:26624
s_waitcnt lgkmcnt(8)
v_mfma_f32_16x16x32_bf16 v[188:191],v[28:31],v[116:119],v[188:191]
v_mfma_f32_16x16x32_bf16 v[184:187],v[28:31],v[112:115],v[184:187]
v_add_u32 v12,s49,v3
v_add_u32 v8,s49,v3
v_xor_b32 v9,32,v12
ds_read_b64_tr_b16 v[16:17],v8 offset:0
ds_read_b64_tr_b16 v[18:19],v8 offset:2048
s_waitcnt lgkmcnt(8)
v_mfma_f32_16x16x32_bf16 v[192:195],v[224:227],v[112:115],v[192:195]
ds_read_b64_tr_b16 v[20:21],v9 offset:0
v_mfma_f32_16x16x32_bf16 v[196:199],v[224:227],v[116:119],v[196:199]
ds_read_b64_tr_b16 v[22:23],v9 offset:2048
s_waitcnt lgkmcnt(8)
v_mfma_f32_16x16x32_bf16 v[204:207],v[228:231],v[116:119],v[204:207]
v_mfma_f32_16x16x32_bf16 v[200:203],v[228:231],v[112:115],v[200:203]
v_xor_b32 v10,64,v12
v_xor_b32 v11,96,v12
ds_read_b64_tr_b16 v[24:25],v10 offset:0
ds_read_b64_tr_b16 v[26:27],v10 offset:2048
s_waitcnt lgkmcnt(8)
v_mfma_f32_16x16x32_bf16 v[208:211],v[232:235],v[112:115],v[208:211]
ds_read_b64_tr_b16 v[28:29],v11 offset:0
v_mfma_f32_16x16x32_bf16 v[212:215],v[232:235],v[116:119],v[212:215]
ds_read_b64_tr_b16 v[30:31],v11 offset:2048
s_waitcnt lgkmcnt(8)
v_mfma_f32_16x16x32_bf16 v[220:223],v[236:239],v[116:119],v[220:223]
v_mfma_f32_16x16x32_bf16 v[216:219],v[236:239],v[112:115],v[216:219]
v_xor_b32 v240,128,v12
v_xor_b32 v241,160,v12
ds_read_b64_tr_b16 v[224:225],v240 offset:0
ds_read_b64_tr_b16 v[226:227],v240 offset:2048
s_waitcnt lgkmcnt(8)
v_mfma_f32_16x16x32_bf16 v[160:163],v[16:19],v[32:35],v[160:163]
ds_read_b64_tr_b16 v[228:229],v241 offset:0
v_mfma_f32_16x16x32_bf16 v[164:167],v[16:19],v[36:39],v[164:167]
ds_read_b64_tr_b16 v[230:231],v241 offset:2048
s_waitcnt lgkmcnt(8)
v_mfma_f32_16x16x32_bf16 v[172:175],v[20:23],v[36:39],v[172:175]
v_mfma_f32_16x16x32_bf16 v[168:171],v[20:23],v[32:35],v[168:171]
v_xor_b32 v242,192,v12
v_xor_b32 v243,224,v12
ds_read_b64_tr_b16 v[232:233],v242 offset:0
ds_read_b64_tr_b16 v[234:235],v242 offset:2048
s_waitcnt lgkmcnt(8)
v_mfma_f32_16x16x32_bf16 v[176:179],v[24:27],v[32:35],v[176:179]
ds_read_b64_tr_b16 v[236:237],v243 offset:0
v_mfma_f32_16x16x32_bf16 v[180:183],v[24:27],v[36:39],v[180:183]
ds_read_b64_tr_b16 v[238:239],v243 offset:2048
s_waitcnt lgkmcnt(8)
v_mfma_f32_16x16x32_bf16 v[188:191],v[28:31],v[36:39],v[188:191]
v_mfma_f32_16x16x32_bf16 v[184:187],v[28:31],v[32:35],v[184:187]
ds_read_b64_tr_b16 v[16:17],v8 offset:8192
ds_read_b64_tr_b16 v[18:19],v8 offset:10240
s_waitcnt lgkmcnt(8)
v_mfma_f32_16x16x32_bf16 v[192:195],v[224:227],v[32:35],v[192:195]
ds_read_b64_tr_b16 v[20:21],v9 offset:8192
v_mfma_f32_16x16x32_bf16 v[196:199],v[224:227],v[36:39],v[196:199]
ds_read_b64_tr_b16 v[22:23],v9 offset:10240
s_waitcnt lgkmcnt(8)
v_mfma_f32_16x16x32_bf16 v[204:207],v[228:231],v[36:39],v[204:207]
v_mfma_f32_16x16x32_bf16 v[200:203],v[228:231],v[32:35],v[200:203]
ds_read_b64_tr_b16 v[24:25],v10 offset:8192
ds_read_b64_tr_b16 v[26:27],v10 offset:10240
s_waitcnt lgkmcnt(8)
v_mfma_f32_16x16x32_bf16 v[208:211],v[232:235],v[32:35],v[208:211]
ds_read_b64_tr_b16 v[28:29],v11 offset:8192
v_mfma_f32_16x16x32_bf16 v[212:215],v[232:235],v[36:39],v[212:215]
ds_read_b64_tr_b16 v[30:31],v11 offset:10240
s_waitcnt lgkmcnt(8)
v_mfma_f32_16x16x32_bf16 v[220:223],v[236:239],v[36:39],v[220:223]
v_mfma_f32_16x16x32_bf16 v[216:219],v[236:239],v[32:35],v[216:219]
ds_read_b64_tr_b16 v[224:225],v240 offset:8192
ds_read_b64_tr_b16 v[226:227],v240 offset:10240
s_waitcnt lgkmcnt(8)
v_mfma_f32_16x16x32_bf16 v[160:163],v[16:19],v[40:43],v[160:163]
ds_read_b64_tr_b16 v[228:229],v241 offset:8192
v_mfma_f32_16x16x32_bf16 v[164:167],v[16:19],v[44:47],v[164:167]
ds_read_b64_tr_b16 v[230:231],v241 offset:10240
s_waitcnt lgkmcnt(8)
v_mfma_f32_16x16x32_bf16 v[172:175],v[20:23],v[44:47],v[172:175]
v_mfma_f32_16x16x32_bf16 v[168:171],v[20:23],v[40:43],v[168:171]
ds_read_b64_tr_b16 v[232:233],v242 offset:8192
ds_read_b64_tr_b16 v[234:235],v242 offset:10240
s_waitcnt lgkmcnt(8)
v_mfma_f32_16x16x32_bf16 v[176:179],v[24:27],v[40:43],v[176:179]
ds_read_b64_tr_b16 v[236:237],v243 offset:8192
v_mfma_f32_16x16x32_bf16 v[180:183],v[24:27],v[44:47],v[180:183]
ds_read_b64_tr_b16 v[238:239],v243 offset:10240
s_waitcnt lgkmcnt(8)
v_mfma_f32_16x16x32_bf16 v[188:191],v[28:31],v[44:47],v[188:191]
v_mfma_f32_16x16x32_bf16 v[184:187],v[28:31],v[40:43],v[184:187]
ds_read_b64_tr_b16 v[16:17],v8 offset:16384
ds_read_b64_tr_b16 v[18:19],v8 offset:18432
s_waitcnt lgkmcnt(8)
v_mfma_f32_16x16x32_bf16 v[192:195],v[224:227],v[40:43],v[192:195]
ds_read_b64_tr_b16 v[20:21],v9 offset:16384
v_mfma_f32_16x16x32_bf16 v[196:199],v[224:227],v[44:47],v[196:199]
ds_read_b64_tr_b16 v[22:23],v9 offset:18432
s_waitcnt lgkmcnt(8)
v_mfma_f32_16x16x32_bf16 v[204:207],v[228:231],v[44:47],v[204:207]
v_mfma_f32_16x16x32_bf16 v[200:203],v[228:231],v[40:43],v[200:203]
ds_read_b64_tr_b16 v[24:25],v10 offset:16384
ds_read_b64_tr_b16 v[26:27],v10 offset:18432
s_waitcnt lgkmcnt(8)
v_mfma_f32_16x16x32_bf16 v[208:211],v[232:235],v[40:43],v[208:211]
ds_read_b64_tr_b16 v[28:29],v11 offset:16384
v_mfma_f32_16x16x32_bf16 v[212:215],v[232:235],v[44:47],v[212:215]
ds_read_b64_tr_b16 v[30:31],v11 offset:18432
s_waitcnt lgkmcnt(8)
v_mfma_f32_16x16x32_bf16 v[220:223],v[236:239],v[44:47],v[220:223]
v_mfma_f32_16x16x32_bf16 v[216:219],v[236:239],v[40:43],v[216:219]
s_waitcnt vmcnt(0)
s_barrier
ds_read_b64_tr_b16 v[224:225],v240 offset:16384
ds_read_b64_tr_b16 v[226:227],v240 offset:18432
s_waitcnt lgkmcnt(8)
v_mfma_f32_16x16x32_bf16 v[160:163],v[16:19],v[48:51],v[160:163]
ds_read_b64_tr_b16 v[228:229],v241 offset:16384
v_mfma_f32_16x16x32_bf16 v[164:167],v[16:19],v[52:55],v[164:167]
ds_read_b64_tr_b16 v[230:231],v241 offset:18432
s_waitcnt lgkmcnt(8)
v_mfma_f32_16x16x32_bf16 v[172:175],v[20:23],v[52:55],v[172:175]
v_mfma_f32_16x16x32_bf16 v[168:171],v[20:23],v[48:51],v[168:171]
ds_read_b64_tr_b16 v[232:233],v242 offset:16384
ds_read_b64_tr_b16 v[234:235],v242 offset:18432
s_waitcnt lgkmcnt(8)
v_mfma_f32_16x16x32_bf16 v[176:179],v[24:27],v[48:51],v[176:179]
ds_read_b64_tr_b16 v[236:237],v243 offset:16384
v_mfma_f32_16x16x32_bf16 v[180:183],v[24:27],v[52:55],v[180:183]
ds_read_b64_tr_b16 v[238:239],v243 offset:18432
s_waitcnt lgkmcnt(8)
v_mfma_f32_16x16x32_bf16 v[188:191],v[28:31],v[52:55],v[188:191]
v_mfma_f32_16x16x32_bf16 v[184:187],v[28:31],v[48:51],v[184:187]
ds_read_b64_tr_b16 v[16:17],v8 offset:24576
ds_read_b64_tr_b16 v[18:19],v8 offset:26624
s_waitcnt lgkmcnt(8)
v_mfma_f32_16x16x32_bf16 v[192:195],v[224:227],v[48:51],v[192:195]
ds_read_b64_tr_b16 v[20:21],v9 offset:24576
v_mfma_f32_16x16x32_bf16 v[196:199],v[224:227],v[52:55],v[196:199]
ds_read_b64_tr_b16 v[22:23],v9 offset:26624
s_waitcnt lgkmcnt(8)
v_mfma_f32_16x16x32_bf16 v[204:207],v[228:231],v[52:55],v[204:207]
v_mfma_f32_16x16x32_bf16 v[200:203],v[228:231],v[48:51],v[200:203]
ds_read_b64_tr_b16 v[24:25],v10 offset:24576
ds_read_b64_tr_b16 v[26:27],v10 offset:26624
s_waitcnt lgkmcnt(8)
v_mfma_f32_16x16x32_bf16 v[208:211],v[232:235],v[48:51],v[208:211]
ds_read_b64_tr_b16 v[28:29],v11 offset:24576
v_mfma_f32_16x16x32_bf16 v[212:215],v[232:235],v[52:55],v[212:215]
ds_read_b64_tr_b16 v[30:31],v11 offset:26624
s_waitcnt lgkmcnt(8)
v_mfma_f32_16x16x32_bf16 v[220:223],v[236:239],v[52:55],v[220:223]
v_mfma_f32_16x16x32_bf16 v[216:219],v[236:239],v[48:51],v[216:219]
ds_read_b64_tr_b16 v[224:225],v240 offset:24576
ds_read_b64_tr_b16 v[226:227],v240 offset:26624
s_waitcnt lgkmcnt(8)
v_mfma_f32_16x16x32_bf16 v[160:163],v[16:19],v[56:59],v[160:163]
ds_read_b64_tr_b16 v[228:229],v241 offset:24576
v_mfma_f32_16x16x32_bf16 v[164:167],v[16:19],v[60:63],v[164:167]
ds_read_b64_tr_b16 v[230:231],v241 offset:26624
s_waitcnt lgkmcnt(8)
v_mfma_f32_16x16x32_bf16 v[172:175],v[20:23],v[60:63],v[172:175]
v_mfma_f32_16x16x32_bf16 v[168:171],v[20:23],v[56:59],v[168:171]
ds_read_b64_tr_b16 v[232:233],v242 offset:24576
ds_read_b64_tr_b16 v[234:235],v242 offset:26624
s_waitcnt lgkmcnt(8)
v_mfma_f32_16x16x32_bf16 v[176:179],v[24:27],v[56:59],v[176:179]
ds_read_b64_tr_b16 v[236:237],v243 offset:24576
v_mfma_f32_16x16x32_bf16 v[180:183],v[24:27],v[60:63],v[180:183]
ds_read_b64_tr_b16 v[238:239],v243 offset:26624
s_waitcnt lgkmcnt(8)
v_mfma_f32_16x16x32_bf16 v[188:191],v[28:31],v[60:63],v[188:191]
v_mfma_f32_16x16x32_bf16 v[184:187],v[28:31],v[56:59],v[184:187]
v_add_u32 v13,s50,v3
v_xor_b32 v9,32,v13
v_xor_b32 v10,64,v13
ds_read_b64_tr_b16 v[16:17],v9 offset:0
ds_read_b64_tr_b16 v[18:19],v9 offset:2048
s_waitcnt lgkmcnt(8)
v_mfma_f32_16x16x32_bf16 v[192:195],v[224:227],v[56:59],v[192:195]
ds_read_b64_tr_b16 v[20:21],v10 offset:0
v_mfma_f32_16x16x32_bf16 v[196:199],v[224:227],v[60:63],v[196:199]
ds_read_b64_tr_b16 v[22:23],v10 offset:2048
s_waitcnt lgkmcnt(8)
v_mfma_f32_16x16x32_bf16 v[204:207],v[228:231],v[60:63],v[204:207]
v_mfma_f32_16x16x32_bf16 v[200:203],v[228:231],v[56:59],v[200:203]
v_xor_b32 v11,96,v13
v_xor_b32 v240,128,v13
ds_read_b64_tr_b16 v[24:25],v11 offset:0
ds_read_b64_tr_b16 v[26:27],v11 offset:2048
s_waitcnt lgkmcnt(8)
v_mfma_f32_16x16x32_bf16 v[208:211],v[232:235],v[56:59],v[208:211]
ds_read_b64_tr_b16 v[28:29],v240 offset:0
v_mfma_f32_16x16x32_bf16 v[212:215],v[232:235],v[60:63],v[212:215]
ds_read_b64_tr_b16 v[30:31],v240 offset:2048
s_waitcnt lgkmcnt(8)
v_mfma_f32_16x16x32_bf16 v[220:223],v[236:239],v[60:63],v[220:223]
v_mfma_f32_16x16x32_bf16 v[216:219],v[236:239],v[56:59],v[216:219]
v_xor_b32 v241,160,v13
v_xor_b32 v242,192,v13
ds_read_b64_tr_b16 v[224:225],v241 offset:0
ds_read_b64_tr_b16 v[226:227],v241 offset:2048
s_waitcnt lgkmcnt(8)
v_mfma_f32_16x16x32_bf16 v[168:171],v[16:19],v[72:75],v[168:171]
ds_read_b64_tr_b16 v[228:229],v242 offset:0
v_mfma_f32_16x16x32_bf16 v[172:175],v[16:19],v[76:79],v[172:175]
ds_read_b64_tr_b16 v[230:231],v242 offset:2048
s_waitcnt lgkmcnt(8)
v_mfma_f32_16x16x32_bf16 v[180:183],v[20:23],v[76:79],v[180:183]
v_mfma_f32_16x16x32_bf16 v[176:179],v[20:23],v[72:75],v[176:179]
v_xor_b32 v243,224,v13
ds_read_b64_tr_b16 v[232:233],v243 offset:0
ds_read_b64_tr_b16 v[234:235],v243 offset:2048
s_waitcnt lgkmcnt(8)
v_mfma_f32_16x16x32_bf16 v[184:187],v[24:27],v[72:75],v[184:187]
ds_read_b64_tr_b16 v[236:237],v9 offset:8192
v_mfma_f32_16x16x32_bf16 v[188:191],v[24:27],v[76:79],v[188:191]
ds_read_b64_tr_b16 v[238:239],v9 offset:10240
s_waitcnt lgkmcnt(8)
v_mfma_f32_16x16x32_bf16 v[196:199],v[28:31],v[76:79],v[196:199]
v_mfma_f32_16x16x32_bf16 v[192:195],v[28:31],v[72:75],v[192:195]
ds_read_b64_tr_b16 v[16:17],v10 offset:8192
ds_read_b64_tr_b16 v[18:19],v10 offset:10240
s_waitcnt lgkmcnt(8)
v_mfma_f32_16x16x32_bf16 v[200:203],v[224:227],v[72:75],v[200:203]
ds_read_b64_tr_b16 v[20:21],v11 offset:8192
v_mfma_f32_16x16x32_bf16 v[204:207],v[224:227],v[76:79],v[204:207]
ds_read_b64_tr_b16 v[22:23],v11 offset:10240
s_waitcnt lgkmcnt(8)
v_mfma_f32_16x16x32_bf16 v[212:215],v[228:231],v[76:79],v[212:215]
v_mfma_f32_16x16x32_bf16 v[208:211],v[228:231],v[72:75],v[208:211]
ds_read_b64_tr_b16 v[24:25],v240 offset:8192
ds_read_b64_tr_b16 v[26:27],v240 offset:10240
s_waitcnt lgkmcnt(8)
v_mfma_f32_16x16x32_bf16 v[216:219],v[232:235],v[72:75],v[216:219]
ds_read_b64_tr_b16 v[28:29],v241 offset:8192
v_mfma_f32_16x16x32_bf16 v[220:223],v[232:235],v[76:79],v[220:223]
ds_read_b64_tr_b16 v[30:31],v241 offset:10240
s_waitcnt lgkmcnt(8)
v_mfma_f32_16x16x32_bf16 v[172:175],v[236:239],v[92:95],v[172:175]
v_mfma_f32_16x16x32_bf16 v[168:171],v[236:239],v[88:91],v[168:171]
ds_read_b64_tr_b16 v[224:225],v242 offset:8192
ds_read_b64_tr_b16 v[226:227],v242 offset:10240
s_waitcnt lgkmcnt(8)
v_mfma_f32_16x16x32_bf16 v[176:179],v[16:19],v[88:91],v[176:179]
ds_read_b64_tr_b16 v[228:229],v243 offset:8192
v_mfma_f32_16x16x32_bf16 v[180:183],v[16:19],v[92:95],v[180:183]
ds_read_b64_tr_b16 v[230:231],v243 offset:10240
s_waitcnt lgkmcnt(8)
v_mfma_f32_16x16x32_bf16 v[188:191],v[20:23],v[92:95],v[188:191]
v_mfma_f32_16x16x32_bf16 v[184:187],v[20:23],v[88:91],v[184:187]
ds_read_b64_tr_b16 v[232:233],v9 offset:16384
ds_read_b64_tr_b16 v[234:235],v9 offset:18432
s_waitcnt lgkmcnt(8)
v_mfma_f32_16x16x32_bf16 v[192:195],v[24:27],v[88:91],v[192:195]
ds_read_b64_tr_b16 v[236:237],v10 offset:16384
v_mfma_f32_16x16x32_bf16 v[196:199],v[24:27],v[92:95],v[196:199]
ds_read_b64_tr_b16 v[238:239],v10 offset:18432
s_waitcnt lgkmcnt(8)
v_mfma_f32_16x16x32_bf16 v[204:207],v[28:31],v[92:95],v[204:207]
v_mfma_f32_16x16x32_bf16 v[200:203],v[28:31],v[88:91],v[200:203]
ds_read_b64_tr_b16 v[16:17],v11 offset:16384
ds_read_b64_tr_b16 v[18:19],v11 offset:18432
s_waitcnt lgkmcnt(8)
v_mfma_f32_16x16x32_bf16 v[208:211],v[224:227],v[88:91],v[208:211]
ds_read_b64_tr_b16 v[20:21],v240 offset:16384
v_mfma_f32_16x16x32_bf16 v[212:215],v[224:227],v[92:95],v[212:215]
ds_read_b64_tr_b16 v[22:23],v240 offset:18432
s_waitcnt lgkmcnt(8)
v_mfma_f32_16x16x32_bf16 v[220:223],v[228:231],v[92:95],v[220:223]
v_mfma_f32_16x16x32_bf16 v[216:219],v[228:231],v[88:91],v[216:219]
ds_read_b64_tr_b16 v[24:25],v241 offset:16384
ds_read_b64_tr_b16 v[26:27],v241 offset:18432
s_waitcnt lgkmcnt(8)
v_mfma_f32_16x16x32_bf16 v[168:171],v[232:235],v[104:107],v[168:171]
ds_read_b64_tr_b16 v[28:29],v242 offset:16384
v_mfma_f32_16x16x32_bf16 v[172:175],v[232:235],v[108:111],v[172:175]
ds_read_b64_tr_b16 v[30:31],v242 offset:18432
s_waitcnt lgkmcnt(8)
v_mfma_f32_16x16x32_bf16 v[180:183],v[236:239],v[108:111],v[180:183]
v_mfma_f32_16x16x32_bf16 v[176:179],v[236:239],v[104:107],v[176:179]
ds_read_b64_tr_b16 v[224:225],v243 offset:16384
ds_read_b64_tr_b16 v[226:227],v243 offset:18432
s_waitcnt lgkmcnt(8)
v_mfma_f32_16x16x32_bf16 v[184:187],v[16:19],v[104:107],v[184:187]
ds_read_b64_tr_b16 v[228:229],v9 offset:24576
v_mfma_f32_16x16x32_bf16 v[188:191],v[16:19],v[108:111],v[188:191]
ds_read_b64_tr_b16 v[230:231],v9 offset:26624
s_waitcnt lgkmcnt(8)
v_mfma_f32_16x16x32_bf16 v[196:199],v[20:23],v[108:111],v[196:199]
v_mfma_f32_16x16x32_bf16 v[192:195],v[20:23],v[104:107],v[192:195]
ds_read_b64_tr_b16 v[232:233],v10 offset:24576
ds_read_b64_tr_b16 v[234:235],v10 offset:26624
buffer_load_dword v244,v254,s[8:11],0 offen sc1
s_waitcnt lgkmcnt(8)
v_mfma_f32_16x16x32_bf16 v[200:203],v[24:27],v[104:107],v[200:203]
ds_read_b64_tr_b16 v[236:237],v11 offset:24576
v_mfma_f32_16x16x32_bf16 v[204:207],v[24:27],v[108:111],v[204:207]
ds_read_b64_tr_b16 v[238:239],v11 offset:26624
s_waitcnt lgkmcnt(8)
v_mfma_f32_16x16x32_bf16 v[212:215],v[28:31],v[108:111],v[212:215]
v_mfma_f32_16x16x32_bf16 v[208:211],v[28:31],v[104:107],v[208:211]
ds_read_b64_tr_b16 v[16:17],v240 offset:24576
ds_read_b64_tr_b16 v[18:19],v240 offset:26624
s_waitcnt lgkmcnt(8)
v_mfma_f32_16x16x32_bf16 v[216:219],v[224:227],v[104:107],v[216:219]
ds_read_b64_tr_b16 v[20:21],v241 offset:24576
v_mfma_f32_16x16x32_bf16 v[220:223],v[224:227],v[108:111],v[220:223]
ds_read_b64_tr_b16 v[22:23],v241 offset:26624
s_waitcnt lgkmcnt(8)
v_mfma_f32_16x16x32_bf16 v[172:175],v[228:231],v[124:127],v[172:175]
v_mfma_f32_16x16x32_bf16 v[168:171],v[228:231],v[120:123],v[168:171]
ds_read_b64_tr_b16 v[24:25],v242 offset:24576
ds_read_b64_tr_b16 v[26:27],v242 offset:26624
s_waitcnt lgkmcnt(8)
v_mfma_f32_16x16x32_bf16 v[176:179],v[232:235],v[120:123],v[176:179]
ds_read_b64_tr_b16 v[28:29],v243 offset:24576
v_mfma_f32_16x16x32_bf16 v[180:183],v[232:235],v[124:127],v[180:183]
ds_read_b64_tr_b16 v[30:31],v243 offset:26624
s_waitcnt lgkmcnt(8)
v_mfma_f32_16x16x32_bf16 v[188:191],v[236:239],v[124:127],v[188:191]
v_mfma_f32_16x16x32_bf16 v[184:187],v[236:239],v[120:123],v[184:187]
v_add_u32 v12,s51,v3
v_xor_b32 v243,224,v12
ds_read_b64_tr_b16 v[224:225],v243 offset:0
ds_read_b64_tr_b16 v[226:227],v243 offset:2048
s_waitcnt lgkmcnt(8)
v_mfma_f32_16x16x32_bf16 v[192:195],v[16:19],v[120:123],v[192:195]
ds_read_b64_tr_b16 v[228:229],v243 offset:8192
v_mfma_f32_16x16x32_bf16 v[196:199],v[16:19],v[124:127],v[196:199]
ds_read_b64_tr_b16 v[230:231],v243 offset:10240
s_waitcnt lgkmcnt(8)
v_mfma_f32_16x16x32_bf16 v[204:207],v[20:23],v[124:127],v[204:207]
v_mfma_f32_16x16x32_bf16 v[200:203],v[20:23],v[120:123],v[200:203]
ds_read_b64_tr_b16 v[232:233],v243 offset:16384
ds_read_b64_tr_b16 v[234:235],v243 offset:18432
s_waitcnt lgkmcnt(8)
v_mfma_f32_16x16x32_bf16 v[208:211],v[24:27],v[120:123],v[208:211]
ds_read_b64_tr_b16 v[236:237],v243 offset:24576
v_mfma_f32_16x16x32_bf16 v[212:215],v[24:27],v[124:127],v[212:215]
ds_read_b64_tr_b16 v[238:239],v243 offset:26624
s_waitcnt lgkmcnt(8)
v_mfma_f32_16x16x32_bf16 v[220:223],v[28:31],v[124:127],v[220:223]
v_mfma_f32_16x16x32_bf16 v[216:219],v[28:31],v[120:123],v[216:219]
v_xor_b32 v242,192,v12
ds_read_b64_tr_b16 v[16:17],v242 offset:0
ds_read_b64_tr_b16 v[18:19],v242 offset:2048
s_waitcnt lgkmcnt(8)
v_mfma_f32_16x16x32_bf16 v[216:219],v[224:227],v[128:131],v[216:219]
ds_read_b64_tr_b16 v[20:21],v242 offset:8192
v_mfma_f32_16x16x32_bf16 v[220:223],v[224:227],v[132:135],v[220:223]
ds_read_b64_tr_b16 v[22:23],v242 offset:10240
s_waitcnt lgkmcnt(8)
v_mfma_f32_16x16x32_bf16 v[216:219],v[228:231],v[136:139],v[216:219]
v_mfma_f32_16x16x32_bf16 v[220:223],v[228:231],v[140:143],v[220:223]
ds_read_b64_tr_b16 v[24:25],v242 offset:16384
ds_read_b64_tr_b16 v[26:27],v242 offset:18432
s_waitcnt lgkmcnt(8)
v_mfma_f32_16x16x32_bf16 v[216:219],v[232:235],v[144:147],v[216:219]
ds_read_b64_tr_b16 v[28:29],v242 offset:24576
v_mfma_f32_16x16x32_bf16 v[220:223],v[232:235],v[148:151],v[220:223]
ds_read_b64_tr_b16 v[30:31],v242 offset:26624
s_waitcnt lgkmcnt(8)
v_mfma_f32_16x16x32_bf16 v[216:219],v[236:239],v[152:155],v[216:219]
v_mfma_f32_16x16x32_bf16 v[220:223],v[236:239],v[156:159],v[220:223]
v_xor_b32 v241,160,v12
ds_read_b64_tr_b16 v[224:225],v241 offset:0
ds_read_b64_tr_b16 v[226:227],v241 offset:2048
s_waitcnt lgkmcnt(8)
v_mfma_f32_16x16x32_bf16 v[208:211],v[16:19],v[128:131],v[208:211]
ds_read_b64_tr_b16 v[228:229],v241 offset:8192
v_mfma_f32_16x16x32_bf16 v[212:215],v[16:19],v[132:135],v[212:215]
ds_read_b64_tr_b16 v[230:231],v241 offset:10240
s_waitcnt lgkmcnt(8)
v_mfma_f32_16x16x32_bf16 v[208:211],v[20:23],v[136:139],v[208:211]
v_mfma_f32_16x16x32_bf16 v[212:215],v[20:23],v[140:143],v[212:215]
ds_read_b64_tr_b16 v[232:233],v241 offset:16384
ds_read_b64_tr_b16 v[234:235],v241 offset:18432
s_waitcnt lgkmcnt(8)
v_mfma_f32_16x16x32_bf16 v[208:211],v[24:27],v[144:147],v[208:211]
ds_read_b64_tr_b16 v[236:237],v241 offset:24576
v_mfma_f32_16x16x32_bf16 v[212:215],v[24:27],v[148:151],v[212:215]
ds_read_b64_tr_b16 v[238:239],v241 offset:26624
s_waitcnt lgkmcnt(8)
v_mfma_f32_16x16x32_bf16 v[208:211],v[28:31],v[152:155],v[208:211]
v_mfma_f32_16x16x32_bf16 v[212:215],v[28:31],v[156:159],v[212:215]
v_xor_b32 v240,128,v12
ds_read_b64_tr_b16 v[16:17],v240 offset:0
ds_read_b64_tr_b16 v[18:19],v240 offset:2048
s_waitcnt lgkmcnt(8)
v_mfma_f32_16x16x32_bf16 v[200:203],v[224:227],v[128:131],v[200:203]
ds_read_b64_tr_b16 v[20:21],v240 offset:8192
v_mfma_f32_16x16x32_bf16 v[204:207],v[224:227],v[132:135],v[204:207]
ds_read_b64_tr_b16 v[22:23],v240 offset:10240
s_waitcnt lgkmcnt(8)
v_mfma_f32_16x16x32_bf16 v[200:203],v[228:231],v[136:139],v[200:203]
v_mfma_f32_16x16x32_bf16 v[204:207],v[228:231],v[140:143],v[204:207]
ds_read_b64_tr_b16 v[24:25],v240 offset:16384
ds_read_b64_tr_b16 v[26:27],v240 offset:18432
s_waitcnt lgkmcnt(8)
v_mfma_f32_16x16x32_bf16 v[200:203],v[232:235],v[144:147],v[200:203]
ds_read_b64_tr_b16 v[28:29],v240 offset:24576
v_mfma_f32_16x16x32_bf16 v[204:207],v[232:235],v[148:151],v[204:207]
ds_read_b64_tr_b16 v[30:31],v240 offset:26624
s_waitcnt lgkmcnt(8)
v_mfma_f32_16x16x32_bf16 v[200:203],v[236:239],v[152:155],v[200:203]
v_mfma_f32_16x16x32_bf16 v[204:207],v[236:239],v[156:159],v[204:207]
v_xor_b32 v11,96,v12
ds_read_b64_tr_b16 v[224:225],v11 offset:0
ds_read_b64_tr_b16 v[226:227],v11 offset:2048
s_waitcnt vmcnt(0)
v_cmp_ne_u32 vcc,s96,v244
s_and_b32 s4,vcc_lo,0xf0f0f0f0
s_cbranch_scc1 L_p3_ospina
L_p3_ospina_back:
buffer_load_dwordx4 v[64:67],v246,s[8:11],s55 offen offset:0 sc1
buffer_load_dwordx4 v[68:71],v246,s[8:11],s55 offen offset:256 sc1
buffer_load_dwordx4 v[80:83],v246,s[8:11],s55 offen offset:2048 sc1
buffer_load_dwordx4 v[84:87],v246,s[8:11],s55 offen offset:2304 sc1
s_cmp_lt_u32 s101,1200
s_cselect_b32 s55,s7,0
s_waitcnt lgkmcnt(8)
v_mfma_f32_16x16x32_bf16 v[192:195],v[16:19],v[128:131],v[192:195]
ds_read_b64_tr_b16 v[228:229],v11 offset:8192
v_mfma_f32_16x16x32_bf16 v[196:199],v[16:19],v[132:135],v[196:199]
ds_read_b64_tr_b16 v[230:231],v11 offset:10240
s_waitcnt lgkmcnt(8)
v_mfma_f32_16x16x32_bf16 v[192:195],v[20:23],v[136:139],v[192:195]
v_mfma_f32_16x16x32_bf16 v[196:199],v[20:23],v[140:143],v[196:199]
ds_read_b64_tr_b16 v[232:233],v11 offset:16384
ds_read_b64_tr_b16 v[234:235],v11 offset:18432
s_waitcnt lgkmcnt(8)
v_mfma_f32_16x16x32_bf16 v[192:195],v[24:27],v[144:147],v[192:195]
ds_read_b64_tr_b16 v[236:237],v11 offset:24576
v_mfma_f32_16x16x32_bf16 v[196:199],v[24:27],v[148:151],v[196:199]
ds_read_b64_tr_b16 v[238:239],v11 offset:26624
s_waitcnt lgkmcnt(8)
v_mfma_f32_16x16x32_bf16 v[192:195],v[28:31],v[152:155],v[192:195]
v_mfma_f32_16x16x32_bf16 v[196:199],v[28:31],v[156:159],v[196:199]
v_xor_b32 v10,64,v12
ds_read_b64_tr_b16 v[16:17],v10 offset:0
ds_read_b64_tr_b16 v[18:19],v10 offset:2048
s_waitcnt lgkmcnt(8)
v_mfma_f32_16x16x32_bf16 v[184:187],v[224:227],v[128:131],v[184:187]
ds_read_b64_tr_b16 v[20:21],v10 offset:8192
v_mfma_f32_16x16x32_bf16 v[188:191],v[224:227],v[132:135],v[188:191]
ds_read_b64_tr_b16 v[22:23],v10 offset:10240
s_waitcnt lgkmcnt(8)
v_mfma_f32_16x16x32_bf16 v[184:187],v[228:231],v[136:139],v[184:187]
v_mfma_f32_16x16x32_bf16 v[188:191],v[228:231],v[140:143],v[188:191]
ds_read_b64_tr_b16 v[24:25],v10 offset:16384
ds_read_b64_tr_b16 v[26:27],v10 offset:18432
s_waitcnt lgkmcnt(8)
v_mfma_f32_16x16x32_bf16 v[184:187],v[232:235],v[144:147],v[184:187]
ds_read_b64_tr_b16 v[28:29],v10 offset:24576
v_mfma_f32_16x16x32_bf16 v[188:191],v[232:235],v[148:151],v[188:191]
ds_read_b64_tr_b16 v[30:31],v10 offset:26624
s_waitcnt lgkmcnt(8)
v_mfma_f32_16x16x32_bf16 v[184:187],v[236:239],v[152:155],v[184:187]
v_mfma_f32_16x16x32_bf16 v[188:191],v[236:239],v[156:159],v[188:191]
v_xor_b32 v9,32,v12
ds_read_b64_tr_b16 v[224:225],v9 offset:0
ds_read_b64_tr_b16 v[226:227],v9 offset:2048
s_waitcnt lgkmcnt(8)
v_mfma_f32_16x16x32_bf16 v[176:179],v[16:19],v[128:131],v[176:179]
ds_read_b64_tr_b16 v[228:229],v9 offset:8192
v_mfma_f32_16x16x32_bf16 v[180:183],v[16:19],v[132:135],v[180:183]
ds_read_b64_tr_b16 v[230:231],v9 offset:10240
s_waitcnt lgkmcnt(8)
v_mfma_f32_16x16x32_bf16 v[176:179],v[20:23],v[136:139],v[176:179]
v_mfma_f32_16x16x32_bf16 v[180:183],v[20:23],v[140:143],v[180:183]
ds_read_b64_tr_b16 v[232:233],v9 offset:16384
ds_read_b64_tr_b16 v[234:235],v9 offset:18432
s_waitcnt lgkmcnt(8)
v_mfma_f32_16x16x32_bf16 v[176:179],v[24:27],v[144:147],v[176:179]
ds_read_b64_tr_b16 v[236:237],v9 offset:24576
v_mfma_f32_16x16x32_bf16 v[180:183],v[24:27],v[148:151],v[180:183]
ds_read_b64_tr_b16 v[238:239],v9 offset:26624
s_waitcnt lgkmcnt(8)
v_mfma_f32_16x16x32_bf16 v[176:179],v[28:31],v[152:155],v[176:179]
v_mfma_f32_16x16x32_bf16 v[180:183],v[28:31],v[156:159],v[180:183]
v_add_u32 v13,s52,v3
v_add_u32 v13,16384,v13
v_xor_b32 v243,224,v13
ds_read_b64_tr_b16 v[16:17],v243 offset:0
ds_read_b64_tr_b16 v[18:19],v243 offset:2048
s_waitcnt lgkmcnt(8)
v_mfma_f32_16x16x32_bf16 v[168:171],v[224:227],v[128:131],v[168:171]
ds_read_b64_tr_b16 v[20:21],v243 offset:8192
v_mfma_f32_16x16x32_bf16 v[172:175],v[224:227],v[132:135],v[172:175]
ds_read_b64_tr_b16 v[22:23],v243 offset:10240
s_waitcnt lgkmcnt(8)
v_mfma_f32_16x16x32_bf16 v[168:171],v[228:231],v[136:139],v[168:171]
v_mfma_f32_16x16x32_bf16 v[172:175],v[228:231],v[140:143],v[172:175]
v_xor_b32 v242,192,v13
ds_read_b64_tr_b16 v[24:25],v242 offset:0
ds_read_b64_tr_b16 v[26:27],v242 offset:2048
s_waitcnt lgkmcnt(8)
v_mfma_f32_16x16x32_bf16 v[168:171],v[232:235],v[144:147],v[168:171]
ds_read_b64_tr_b16 v[28:29],v242 offset:8192
v_mfma_f32_16x16x32_bf16 v[172:175],v[232:235],v[148:151],v[172:175]
ds_read_b64_tr_b16 v[30:31],v242 offset:10240
s_waitcnt lgkmcnt(8)
v_mfma_f32_16x16x32_bf16 v[168:171],v[236:239],v[152:155],v[168:171]
v_mfma_f32_16x16x32_bf16 v[172:175],v[236:239],v[156:159],v[172:175]
v_xor_b32 v241,160,v13
ds_read_b64_tr_b16 v[224:225],v241 offset:0
ds_read_b64_tr_b16 v[226:227],v241 offset:2048
s_waitcnt lgkmcnt(8)
s_waitcnt vmcnt(3)
v_mfma_f32_16x16x32_bf16 v[216:219],v[16:19],v[64:67],v[216:219]
ds_read_b64_tr_b16 v[228:229],v241 offset:8192
s_waitcnt vmcnt(2)
v_mfma_f32_16x16x32_bf16 v[220:223],v[16:19],v[68:71],v[220:223]
ds_read_b64_tr_b16 v[230:231],v241 offset:10240
s_waitcnt lgkmcnt(8)
s_waitcnt vmcnt(1)
v_mfma_f32_16x16x32_bf16 v[216:219],v[20:23],v[80:83],v[216:219]
s_waitcnt vmcnt(0)
v_mfma_f32_16x16x32_bf16 v[220:223],v[20:23],v[84:87],v[220:223]
v_xor_b32 v240,128,v13
ds_read_b64_tr_b16 v[232:233],v240 offset:0
ds_read_b64_tr_b16 v[234:235],v240 offset:2048
s_waitcnt lgkmcnt(8)
v_mfma_f32_16x16x32_bf16 v[208:211],v[24:27],v[64:67],v[208:211]
ds_read_b64_tr_b16 v[236:237],v240 offset:8192
v_mfma_f32_16x16x32_bf16 v[212:215],v[24:27],v[68:71],v[212:215]
ds_read_b64_tr_b16 v[238:239],v240 offset:10240
s_waitcnt lgkmcnt(8)
v_mfma_f32_16x16x32_bf16 v[208:211],v[28:31],v[80:83],v[208:211]
v_cvt_pk_bf16_f32 v216,v216,v217
v_cvt_pk_bf16_f32 v217,v218,v219
v_mfma_f32_16x16x32_bf16 v[212:215],v[28:31],v[84:87],v[212:215]
v_cvt_pk_bf16_f32 v218,v220,v221
v_cvt_pk_bf16_f32 v219,v222,v223
v_xor_b32 v11,96,v13
ds_read_b64_tr_b16 v[16:17],v11 offset:0
ds_read_b64_tr_b16 v[18:19],v11 offset:2048
s_waitcnt lgkmcnt(8)
v_mfma_f32_16x16x32_bf16 v[200:203],v[224:227],v[64:67],v[200:203]
ds_read_b64_tr_b16 v[20:21],v11 offset:8192
s_xor_b32 s57,s56,458752
s_add_u32 s57,s57,46194688
s_cmp_lg_u32 s55,0
s_cbranch_scc1 L_p3_nsa7
buffer_store_dwordx4 v[216:219],v2,s[8:11],s57 offen sc1
L_p3_nsa7:
v_mfma_f32_16x16x32_bf16 v[204:207],v[224:227],v[68:71],v[204:207]
ds_read_b64_tr_b16 v[22:23],v11 offset:10240
s_waitcnt lgkmcnt(8)
v_mfma_f32_16x16x32_bf16 v[200:203],v[228:231],v[80:83],v[200:203]
v_cvt_pk_bf16_f32 v208,v208,v209
v_cvt_pk_bf16_f32 v209,v210,v211
v_mfma_f32_16x16x32_bf16 v[204:207],v[228:231],v[84:87],v[204:207]
v_cvt_pk_bf16_f32 v210,v212,v213
v_cvt_pk_bf16_f32 v211,v214,v215
v_xor_b32 v10,64,v13
ds_read_b64_tr_b16 v[24:25],v10 offset:0
ds_read_b64_tr_b16 v[26:27],v10 offset:2048
s_waitcnt lgkmcnt(8)
v_mfma_f32_16x16x32_bf16 v[192:195],v[232:235],v[64:67],v[192:195]
ds_read_b64_tr_b16 v[28:29],v10 offset:8192
s_xor_b32 s57,s56,393216
s_add_u32 s57,s57,46186496
s_cmp_lg_u32 s55,0
s_cbranch_scc1 L_p3_nsa6
buffer_store_dwordx4 v[208:211],v2,s[8:11],s57 offen sc1
L_p3_nsa6:
v_mfma_f32_16x16x32_bf16 v[196:199],v[232:235],v[68:71],v[196:199]
ds_read_b64_tr_b16 v[30:31],v10 offset:10240
s_waitcnt lgkmcnt(8)
v_mfma_f32_16x16x32_bf16 v[192:195],v[236:239],v[80:83],v[192:195]
v_cvt_pk_bf16_f32 v200,v200,v201
v_cvt_pk_bf16_f32 v201,v202,v203
v_mfma_f32_16x16x32_bf16 v[196:199],v[236:239],v[84:87],v[196:199]
v_cvt_pk_bf16_f32 v202,v204,v205
v_cvt_pk_bf16_f32 v203,v206,v207
v_xor_b32 v9,32,v13
ds_read_b64_tr_b16 v[224:225],v9 offset:0
ds_read_b64_tr_b16 v[226:227],v9 offset:2048
s_waitcnt lgkmcnt(8)
v_mfma_f32_16x16x32_bf16 v[184:187],v[16:19],v[64:67],v[184:187]
ds_read_b64_tr_b16 v[228:229],v9 offset:8192
s_xor_b32 s57,s56,327680
s_add_u32 s57,s57,46178304
s_cmp_lg_u32 s55,0
s_cbranch_scc1 L_p3_nsa5
buffer_store_dwordx4 v[200:203],v2,s[8:11],s57 offen sc1
L_p3_nsa5:
v_mfma_f32_16x16x32_bf16 v[188:191],v[16:19],v[68:71],v[188:191]
ds_read_b64_tr_b16 v[230:231],v9 offset:10240
s_waitcnt lgkmcnt(8)
v_mfma_f32_16x16x32_bf16 v[184:187],v[20:23],v[80:83],v[184:187]
v_cvt_pk_bf16_f32 v192,v192,v193
v_cvt_pk_bf16_f32 v193,v194,v195
v_mfma_f32_16x16x32_bf16 v[188:191],v[20:23],v[84:87],v[188:191]
v_cvt_pk_bf16_f32 v194,v196,v197
v_cvt_pk_bf16_f32 v195,v198,v199
v_add_u32 v8,s50,v3
ds_read_b64_tr_b16 v[232:233],v8 offset:0
ds_read_b64_tr_b16 v[234:235],v8 offset:2048
s_waitcnt lgkmcnt(8)
v_mfma_f32_16x16x32_bf16 v[176:179],v[24:27],v[64:67],v[176:179]
ds_read_b64_tr_b16 v[236:237],v8 offset:8192
s_xor_b32 s57,s56,262144
s_add_u32 s57,s57,46170112
s_cmp_lg_u32 s55,0
s_cbranch_scc1 L_p3_nsa4
buffer_store_dwordx4 v[192:195],v2,s[8:11],s57 offen sc1
L_p3_nsa4:
v_mfma_f32_16x16x32_bf16 v[180:183],v[24:27],v[68:71],v[180:183]
ds_read_b64_tr_b16 v[238:239],v8 offset:10240
s_waitcnt lgkmcnt(8)
v_mfma_f32_16x16x32_bf16 v[176:179],v[28:31],v[80:83],v[176:179]
v_cvt_pk_bf16_f32 v184,v184,v185
v_cvt_pk_bf16_f32 v185,v186,v187
v_mfma_f32_16x16x32_bf16 v[180:183],v[28:31],v[84:87],v[180:183]
v_cvt_pk_bf16_f32 v186,v188,v189
v_cvt_pk_bf16_f32 v187,v190,v191
ds_read_b64_tr_b16 v[16:17],v8 offset:16384
ds_read_b64_tr_b16 v[18:19],v8 offset:18432
s_waitcnt lgkmcnt(8)
v_mfma_f32_16x16x32_bf16 v[168:171],v[224:227],v[64:67],v[168:171]
ds_read_b64_tr_b16 v[20:21],v8 offset:24576
s_xor_b32 s57,s56,196608
s_add_u32 s57,s57,46161920
s_cmp_lg_u32 s55,0
s_cbranch_scc1 L_p3_nsa3
buffer_store_dwordx4 v[184:187],v2,s[8:11],s57 offen sc1
L_p3_nsa3:
v_mfma_f32_16x16x32_bf16 v[172:175],v[224:227],v[68:71],v[172:175]
ds_read_b64_tr_b16 v[22:23],v8 offset:26624
s_waitcnt lgkmcnt(8)
v_mfma_f32_16x16x32_bf16 v[168:171],v[228:231],v[80:83],v[168:171]
v_cvt_pk_bf16_f32 v176,v176,v177
v_cvt_pk_bf16_f32 v177,v178,v179
v_mfma_f32_16x16x32_bf16 v[172:175],v[228:231],v[84:87],v[172:175]
v_cvt_pk_bf16_f32 v178,v180,v181
v_cvt_pk_bf16_f32 v179,v182,v183
v_add_u32 v8,s51,v3
ds_read_b64_tr_b16 v[24:25],v8 offset:0
ds_read_b64_tr_b16 v[26:27],v8 offset:2048
s_waitcnt lgkmcnt(8)
v_mfma_f32_16x16x32_bf16 v[160:163],v[232:235],v[72:75],v[160:163]
ds_read_b64_tr_b16 v[28:29],v8 offset:8192
s_xor_b32 s57,s56,131072
s_add_u32 s57,s57,46153728
s_cmp_lg_u32 s55,0
s_cbranch_scc1 L_p3_nsa2
buffer_store_dwordx4 v[176:179],v2,s[8:11],s57 offen sc1
L_p3_nsa2:
v_mfma_f32_16x16x32_bf16 v[164:167],v[232:235],v[76:79],v[164:167]
ds_read_b64_tr_b16 v[30:31],v8 offset:10240
s_waitcnt lgkmcnt(8)
v_mfma_f32_16x16x32_bf16 v[160:163],v[236:239],v[88:91],v[160:163]
v_cvt_pk_bf16_f32 v168,v168,v169
v_cvt_pk_bf16_f32 v169,v170,v171
v_mfma_f32_16x16x32_bf16 v[164:167],v[236:239],v[92:95],v[164:167]
v_cvt_pk_bf16_f32 v170,v172,v173
v_cvt_pk_bf16_f32 v171,v174,v175
ds_read_b64_tr_b16 v[224:225],v8 offset:16384
ds_read_b64_tr_b16 v[226:227],v8 offset:18432
s_waitcnt lgkmcnt(8)
v_mfma_f32_16x16x32_bf16 v[160:163],v[16:19],v[104:107],v[160:163]
ds_read_b64_tr_b16 v[228:229],v8 offset:24576
s_xor_b32 s57,s56,65536
s_add_u32 s57,s57,46145536
s_cmp_lg_u32 s55,0
s_cbranch_scc1 L_p3_nsa1
buffer_store_dwordx4 v[168:171],v2,s[8:11],s57 offen sc1
L_p3_nsa1:
v_mfma_f32_16x16x32_bf16 v[164:167],v[16:19],v[108:111],v[164:167]
ds_read_b64_tr_b16 v[230:231],v8 offset:26624
s_waitcnt lgkmcnt(8)
v_mfma_f32_16x16x32_bf16 v[160:163],v[20:23],v[120:123],v[160:163]
v_mfma_f32_16x16x32_bf16 v[164:167],v[20:23],v[124:127],v[164:167]
v_mov_b32 v8,v13
ds_read_b64_tr_b16 v[232:233],v8 offset:0
ds_read_b64_tr_b16 v[234:235],v8 offset:2048
s_waitcnt lgkmcnt(8)
v_mfma_f32_16x16x32_bf16 v[160:163],v[24:27],v[128:131],v[160:163]
ds_read_b64_tr_b16 v[236:237],v8 offset:8192
v_mfma_f32_16x16x32_bf16 v[164:167],v[24:27],v[132:135],v[164:167]
ds_read_b64_tr_b16 v[238:239],v8 offset:10240
s_waitcnt lgkmcnt(8)
v_mfma_f32_16x16x32_bf16 v[160:163],v[28:31],v[136:139],v[160:163]
v_mfma_f32_16x16x32_bf16 v[164:167],v[28:31],v[140:143],v[164:167]
s_waitcnt lgkmcnt(6)
v_mfma_f32_16x16x32_bf16 v[160:163],v[224:227],v[144:147],v[160:163]
v_mfma_f32_16x16x32_bf16 v[164:167],v[224:227],v[148:151],v[164:167]
s_waitcnt lgkmcnt(4)
v_mfma_f32_16x16x32_bf16 v[160:163],v[228:231],v[152:155],v[160:163]
v_mfma_f32_16x16x32_bf16 v[164:167],v[228:231],v[156:159],v[164:167]
s_waitcnt lgkmcnt(2)
v_mfma_f32_16x16x32_bf16 v[160:163],v[232:235],v[64:67],v[160:163]
v_mfma_f32_16x16x32_bf16 v[164:167],v[232:235],v[68:71],v[164:167]
s_waitcnt lgkmcnt(0)
v_mfma_f32_16x16x32_bf16 v[160:163],v[236:239],v[80:83],v[160:163]
v_mfma_f32_16x16x32_bf16 v[164:167],v[236:239],v[84:87],v[164:167]
s_branch L_p3_x
L_p3_mid:
s_waitcnt lgkmcnt(0)
buffer_load_dword v244,v254,s[8:11],0 offen sc1
v_add_u32 v8,s48,v3
v_xor_b32 v9,32,v8
ds_read_b64_tr_b16 v[16:17],v8 offset:0
ds_read_b64_tr_b16 v[18:19],v8 offset:2048
ds_read_b64_tr_b16 v[20:21],v9 offset:0
ds_read_b64_tr_b16 v[22:23],v9 offset:2048
v_xor_b32 v10,64,v8
v_xor_b32 v11,96,v8
ds_read_b64_tr_b16 v[24:25],v10 offset:0
ds_read_b64_tr_b16 v[26:27],v10 offset:2048
ds_read_b64_tr_b16 v[28:29],v11 offset:0
ds_read_b64_tr_b16 v[30:31],v11 offset:2048
v_xor_b32 v240,128,v8
v_xor_b32 v241,160,v8
ds_read_b64_tr_b16 v[224:225],v240 offset:0
ds_read_b64_tr_b16 v[226:227],v240 offset:2048
s_waitcnt lgkmcnt(8)
v_mfma_f32_16x16x32_bf16 v[160:163],v[16:19],v[64:67],0
ds_read_b64_tr_b16 v[228:229],v241 offset:0
v_mfma_f32_16x16x32_bf16 v[164:167],v[16:19],v[68:71],0
ds_read_b64_tr_b16 v[230:231],v241 offset:2048
s_add_u32 s49,s48,32768
s_cmp_eq_u32 s49,163840
s_cselect_b32 s49,0,s49
s_waitcnt lgkmcnt(8)
v_mfma_f32_16x16x32_bf16 v[172:175],v[20:23],v[68:71],0
v_mfma_f32_16x16x32_bf16 v[168:171],v[20:23],v[64:67],0
s_add_u32 s50,s49,32768
s_cmp_eq_u32 s50,163840
s_cselect_b32 s50,0,s50
v_xor_b32 v242,192,v8
v_xor_b32 v243,224,v8
ds_read_b64_tr_b16 v[232:233],v242 offset:0
ds_read_b64_tr_b16 v[234:235],v242 offset:2048
s_waitcnt lgkmcnt(8)
v_mfma_f32_16x16x32_bf16 v[176:179],v[24:27],v[64:67],0
ds_read_b64_tr_b16 v[236:237],v243 offset:0
v_mfma_f32_16x16x32_bf16 v[180:183],v[24:27],v[68:71],0
ds_read_b64_tr_b16 v[238:239],v243 offset:2048
s_add_u32 s51,s50,32768
s_cmp_eq_u32 s51,163840
s_cselect_b32 s51,0,s51
s_waitcnt lgkmcnt(8)
v_mfma_f32_16x16x32_bf16 v[188:191],v[28:31],v[68:71],0
v_mfma_f32_16x16x32_bf16 v[184:187],v[28:31],v[64:67],0
s_add_u32 s52,s51,32768
s_cmp_eq_u32 s52,163840
s_cselect_b32 s52,0,s52
ds_read_b64_tr_b16 v[16:17],v8 offset:8192
ds_read_b64_tr_b16 v[18:19],v8 offset:10240
s_waitcnt lgkmcnt(8)
v_mfma_f32_16x16x32_bf16 v[192:195],v[224:227],v[64:67],0
ds_read_b64_tr_b16 v[20:21],v9 offset:8192
v_mfma_f32_16x16x32_bf16 v[196:199],v[224:227],v[68:71],0
ds_read_b64_tr_b16 v[22:23],v9 offset:10240
s_mul_i32 s54,s6,294912
s_add_u32 s54,s54,67108864
s_lshl_b32 s58,s53,12
s_add_u32 s55,s54,s58
s_add_u32 s55,s55,262144
s_waitcnt lgkmcnt(8)
v_mfma_f32_16x16x32_bf16 v[204:207],v[228:231],v[68:71],0
v_mfma_f32_16x16x32_bf16 v[200:203],v[228:231],v[64:67],0
s_lshl_b32 s58,s53,15
s_add_u32 s54,s54,s58
s_bfe_u32 s57,s99,0x20003
s_lshl_b32 s58,s57,13
s_add_u32 s54,s54,s58
s_lshl_b32 s60,s6,15
s_lshl_b32 s57,s57,8
s_add_u32 s60,s60,s57
ds_read_b64_tr_b16 v[24:25],v10 offset:8192
ds_read_b64_tr_b16 v[26:27],v10 offset:10240
s_waitcnt lgkmcnt(8)
v_mfma_f32_16x16x32_bf16 v[208:211],v[232:235],v[64:67],0
ds_read_b64_tr_b16 v[28:29],v11 offset:8192
v_mfma_f32_16x16x32_bf16 v[212:215],v[232:235],v[68:71],0
ds_read_b64_tr_b16 v[30:31],v11 offset:10240
s_lshl_b32 s58,s53,5
s_add_u32 s60,s60,s58
v_and_b32 v12,7,v1
v_lshlrev_b32 v7,2,v12
s_waitcnt lgkmcnt(8)
v_mfma_f32_16x16x32_bf16 v[220:223],v[236:239],v[68:71],0
v_mfma_f32_16x16x32_bf16 v[216:219],v[236:239],v[64:67],0
s_lshr_b32 s59,s99,3
s_lshl_b32 s59,s59,6
s_add_u32 s59,s59,s53
s_lshl_b32 s59,s59,2
v_xor_b32 v253,s59,v7
v_add_u32 v253,101777536,v253
v_add_u32 v7,s52,v7
ds_read_b64_tr_b16 v[224:225],v240 offset:8192
ds_read_b64_tr_b16 v[226:227],v240 offset:10240
s_waitcnt lgkmcnt(8)
v_mfma_f32_16x16x32_bf16 v[160:163],v[16:19],v[80:83],v[160:163]
ds_read_b64_tr_b16 v[228:229],v241 offset:8192
v_mfma_f32_16x16x32_bf16 v[164:167],v[16:19],v[84:87],v[164:167]
ds_read_b64_tr_b16 v[230:231],v241 offset:10240
v_lshrrev_b32 v13,5,v1
v_lshlrev_b32 v13,4,v13
v_and_b32 v252,31,v1
v_lshl_add_u32 v252,v252,10,v13
s_waitcnt lgkmcnt(8)
v_mfma_f32_16x16x32_bf16 v[172:175],v[20:23],v[84:87],v[172:175]
v_mfma_f32_16x16x32_bf16 v[168:171],v[20:23],v[80:83],v[168:171]
s_add_u32 s59,s59,101777536
s_lshl_b32 s56,s99,16
s_lshl_b32 s58,s16,10
s_add_u32 s56,s56,s58
ds_read_b64_tr_b16 v[232:233],v242 offset:8192
ds_read_b64_tr_b16 v[234:235],v242 offset:10240
s_waitcnt lgkmcnt(8)
v_mfma_f32_16x16x32_bf16 v[176:179],v[24:27],v[80:83],v[176:179]
ds_read_b64_tr_b16 v[236:237],v243 offset:8192
v_mfma_f32_16x16x32_bf16 v[180:183],v[24:27],v[84:87],v[180:183]
ds_read_b64_tr_b16 v[238:239],v243 offset:10240
s_mov_b32 s42,2097152
s_mov_b32 s43,0x20000
s_mov_b32 s46,524288
s_mov_b32 s47,0x20000
s_waitcnt lgkmcnt(8)
v_mfma_f32_16x16x32_bf16 v[188:191],v[28:31],v[84:87],v[188:191]
v_mfma_f32_16x16x32_bf16 v[184:187],v[28:31],v[80:83],v[184:187]
s_waitcnt vmcnt(0)
v_cmp_ne_u32 vcc,s96,v244
s_and_b32 s4,vcc_lo,0xf0f0f0f
s_cbranch_scc1 L_p3_mspin
L_p3_mspin_back:
s_xor_b32 s58,s54,8192
buffer_load_dwordx4 v[32:35],v246,s[8:11],s58 offen offset:0 sc1
buffer_load_dwordx4 v[36:39],v246,s[8:11],s58 offen offset:256 sc1
buffer_load_dwordx4 v[40:43],v246,s[8:11],s58 offen offset:2048 sc1
buffer_load_dwordx4 v[44:47],v246,s[8:11],s58 offen offset:2304 sc1
s_xor_b32 s58,s54,12288
buffer_load_dwordx4 v[48:51],v246,s[8:11],s58 offen offset:0 sc1
buffer_load_dwordx4 v[52:55],v246,s[8:11],s58 offen offset:256 sc1
buffer_load_dwordx4 v[56:59],v246,s[8:11],s58 offen offset:2048 sc1
buffer_load_dwordx4 v[60:63],v246,s[8:11],s58 offen offset:2304 sc1
ds_read_b64_tr_b16 v[16:17],v8 offset:16384
ds_read_b64_tr_b16 v[18:19],v8 offset:18432
s_waitcnt lgkmcnt(8)
v_mfma_f32_16x16x32_bf16 v[192:195],v[224:227],v[80:83],v[192:195]
ds_read_b64_tr_b16 v[20:21],v9 offset:16384
v_mfma_f32_16x16x32_bf16 v[196:199],v[224:227],v[84:87],v[196:199]
ds_read_b64_tr_b16 v[22:23],v9 offset:18432
s_waitcnt lgkmcnt(8)
v_mfma_f32_16x16x32_bf16 v[204:207],v[228:231],v[84:87],v[204:207]
v_mfma_f32_16x16x32_bf16 v[200:203],v[228:231],v[80:83],v[200:203]
s_xor_b32 s58,s54,16384
buffer_load_dwordx4 v[72:75],v246,s[8:11],s58 offen offset:0 sc1
ds_read_b64_tr_b16 v[24:25],v10 offset:16384
ds_read_b64_tr_b16 v[26:27],v10 offset:18432
s_waitcnt lgkmcnt(8)
v_mfma_f32_16x16x32_bf16 v[208:211],v[232:235],v[80:83],v[208:211]
ds_read_b64_tr_b16 v[28:29],v11 offset:16384
v_mfma_f32_16x16x32_bf16 v[212:215],v[232:235],v[84:87],v[212:215]
ds_read_b64_tr_b16 v[30:31],v11 offset:18432
s_waitcnt lgkmcnt(8)
v_mfma_f32_16x16x32_bf16 v[220:223],v[236:239],v[84:87],v[220:223]
v_mfma_f32_16x16x32_bf16 v[216:219],v[236:239],v[80:83],v[216:219]
buffer_load_dwordx4 v[76:79],v246,s[8:11],s58 offen offset:256 sc1
ds_read_b64_tr_b16 v[224:225],v240 offset:16384
ds_read_b64_tr_b16 v[226:227],v240 offset:18432
s_waitcnt lgkmcnt(8)
v_mfma_f32_16x16x32_bf16 v[160:163],v[16:19],v[96:99],v[160:163]
ds_read_b64_tr_b16 v[228:229],v241 offset:16384
v_mfma_f32_16x16x32_bf16 v[164:167],v[16:19],v[100:103],v[164:167]
ds_read_b64_tr_b16 v[230:231],v241 offset:18432
s_waitcnt lgkmcnt(8)
v_mfma_f32_16x16x32_bf16 v[172:175],v[20:23],v[100:103],v[172:175]
v_mfma_f32_16x16x32_bf16 v[168:171],v[20:23],v[96:99],v[168:171]
buffer_load_dwordx4 v[88:91],v246,s[8:11],s58 offen offset:2048 sc1
ds_read_b64_tr_b16 v[232:233],v242 offset:16384
ds_read_b64_tr_b16 v[234:235],v242 offset:18432
s_waitcnt lgkmcnt(8)
v_mfma_f32_16x16x32_bf16 v[176:179],v[24:27],v[96:99],v[176:179]
ds_read_b64_tr_b16 v[236:237],v243 offset:16384
v_mfma_f32_16x16x32_bf16 v[180:183],v[24:27],v[100:103],v[180:183]
ds_read_b64_tr_b16 v[238:239],v243 offset:18432
s_waitcnt lgkmcnt(8)
v_mfma_f32_16x16x32_bf16 v[188:191],v[28:31],v[100:103],v[188:191]
v_mfma_f32_16x16x32_bf16 v[184:187],v[28:31],v[96:99],v[184:187]
buffer_load_dwordx4 v[92:95],v246,s[8:11],s58 offen offset:2304 sc1
ds_read_b64_tr_b16 v[16:17],v8 offset:24576
ds_read_b64_tr_b16 v[18:19],v8 offset:26624
s_waitcnt lgkmcnt(8)
v_mfma_f32_16x16x32_bf16 v[192:195],v[224:227],v[96:99],v[192:195]
ds_read_b64_tr_b16 v[20:21],v9 offset:24576
v_mfma_f32_16x16x32_bf16 v[196:199],v[224:227],v[100:103],v[196:199]
ds_read_b64_tr_b16 v[22:23],v9 offset:26624
s_waitcnt lgkmcnt(8)
v_mfma_f32_16x16x32_bf16 v[204:207],v[228:231],v[100:103],v[204:207]
v_mfma_f32_16x16x32_bf16 v[200:203],v[228:231],v[96:99],v[200:203]
ds_read_b64_tr_b16 v[24:25],v10 offset:24576
ds_read_b64_tr_b16 v[26:27],v10 offset:26624
s_waitcnt lgkmcnt(8)
v_mfma_f32_16x16x32_bf16 v[208:211],v[232:235],v[96:99],v[208:211]
ds_read_b64_tr_b16 v[28:29],v11 offset:24576
v_mfma_f32_16x16x32_bf16 v[212:215],v[232:235],v[100:103],v[212:215]
ds_read_b64_tr_b16 v[30:31],v11 offset:26624
s_waitcnt lgkmcnt(8)
v_mfma_f32_16x16x32_bf16 v[220:223],v[236:239],v[100:103],v[220:223]
v_mfma_f32_16x16x32_bf16 v[216:219],v[236:239],v[96:99],v[216:219]
ds_read_b64_tr_b16 v[224:225],v240 offset:24576
ds_read_b64_tr_b16 v[226:227],v240 offset:26624
s_waitcnt lgkmcnt(8)
v_mfma_f32_16x16x32_bf16 v[160:163],v[16:19],v[112:115],v[160:163]
ds_read_b64_tr_b16 v[228:229],v241 offset:24576
v_mfma_f32_16x16x32_bf16 v[164:167],v[16:19],v[116:119],v[164:167]
ds_read_b64_tr_b16 v[230:231],v241 offset:26624
s_waitcnt lgkmcnt(8)
v_mfma_f32_16x16x32_bf16 v[172:175],v[20:23],v[116:119],v[172:175]
v_mfma_f32_16x16x32_bf16 v[168:171],v[20:23],v[112:115],v[168:171]
ds_read_b64_tr_b16 v[232:233],v242 offset:24576
ds_read_b64_tr_b16 v[234:235],v242 offset:26624
s_waitcnt lgkmcnt(8)
v_mfma_f32_16x16x32_bf16 v[176:179],v[24:27],v[112:115],v[176:179]
ds_read_b64_tr_b16 v[236:237],v243 offset:24576
v_mfma_f32_16x16x32_bf16 v[180:183],v[24:27],v[116:119],v[180:183]
ds_read_b64_tr_b16 v[238:239],v243 offset:26624
s_waitcnt lgkmcnt(8)
v_mfma_f32_16x16x32_bf16 v[188:191],v[28:31],v[116:119],v[188:191]
v_mfma_f32_16x16x32_bf16 v[184:187],v[28:31],v[112:115],v[184:187]
v_add_u32 v12,s49,v3
v_add_u32 v8,s49,v3
v_xor_b32 v9,32,v12
ds_read_b64_tr_b16 v[16:17],v8 offset:0
ds_read_b64_tr_b16 v[18:19],v8 offset:2048
s_waitcnt lgkmcnt(8)
v_mfma_f32_16x16x32_bf16 v[192:195],v[224:227],v[112:115],v[192:195]
ds_read_b64_tr_b16 v[20:21],v9 offset:0
v_mfma_f32_16x16x32_bf16 v[196:199],v[224:227],v[116:119],v[196:199]
ds_read_b64_tr_b16 v[22:23],v9 offset:2048
s_waitcnt lgkmcnt(8)
v_mfma_f32_16x16x32_bf16 v[204:207],v[228:231],v[116:119],v[204:207]
v_mfma_f32_16x16x32_bf16 v[200:203],v[228:231],v[112:115],v[200:203]
v_xor_b32 v10,64,v12
v_xor_b32 v11,96,v12
ds_read_b64_tr_b16 v[24:25],v10 offset:0
ds_read_b64_tr_b16 v[26:27],v10 offset:2048
s_waitcnt lgkmcnt(8)
v_mfma_f32_16x16x32_bf16 v[208:211],v[232:235],v[112:115],v[208:211]
ds_read_b64_tr_b16 v[28:29],v11 offset:0
v_mfma_f32_16x16x32_bf16 v[212:215],v[232:235],v[116:119],v[212:215]
ds_read_b64_tr_b16 v[30:31],v11 offset:2048
s_waitcnt lgkmcnt(8)
v_mfma_f32_16x16x32_bf16 v[220:223],v[236:239],v[116:119],v[220:223]
v_mfma_f32_16x16x32_bf16 v[216:219],v[236:239],v[112:115],v[216:219]
v_xor_b32 v240,128,v12
v_xor_b32 v241,160,v12
ds_read_b64_tr_b16 v[224:225],v240 offset:0
ds_read_b64_tr_b16 v[226:227],v240 offset:2048
s_waitcnt lgkmcnt(8)
s_waitcnt vmcnt(11)
v_mfma_f32_16x16x32_bf16 v[160:163],v[16:19],v[32:35],v[160:163]
ds_read_b64_tr_b16 v[228:229],v241 offset:0
s_waitcnt vmcnt(10)
v_mfma_f32_16x16x32_bf16 v[164:167],v[16:19],v[36:39],v[164:167]
ds_read_b64_tr_b16 v[230:231],v241 offset:2048
s_waitcnt lgkmcnt(8)
v_mfma_f32_16x16x32_bf16 v[172:175],v[20:23],v[36:39],v[172:175]
v_mfma_f32_16x16x32_bf16 v[168:171],v[20:23],v[32:35],v[168:171]
v_xor_b32 v242,192,v12
v_xor_b32 v243,224,v12
ds_read_b64_tr_b16 v[232:233],v242 offset:0
ds_read_b64_tr_b16 v[234:235],v242 offset:2048
s_waitcnt lgkmcnt(8)
v_mfma_f32_16x16x32_bf16 v[176:179],v[24:27],v[32:35],v[176:179]
ds_read_b64_tr_b16 v[236:237],v243 offset:0
v_mfma_f32_16x16x32_bf16 v[180:183],v[24:27],v[36:39],v[180:183]
ds_read_b64_tr_b16 v[238:239],v243 offset:2048
s_waitcnt lgkmcnt(8)
v_mfma_f32_16x16x32_bf16 v[188:191],v[28:31],v[36:39],v[188:191]
v_mfma_f32_16x16x32_bf16 v[184:187],v[28:31],v[32:35],v[184:187]
ds_read_b64_tr_b16 v[16:17],v8 offset:8192
ds_read_b64_tr_b16 v[18:19],v8 offset:10240
s_waitcnt lgkmcnt(8)
v_mfma_f32_16x16x32_bf16 v[192:195],v[224:227],v[32:35],v[192:195]
ds_read_b64_tr_b16 v[20:21],v9 offset:8192
v_mfma_f32_16x16x32_bf16 v[196:199],v[224:227],v[36:39],v[196:199]
ds_read_b64_tr_b16 v[22:23],v9 offset:10240
s_waitcnt lgkmcnt(8)
v_mfma_f32_16x16x32_bf16 v[204:207],v[228:231],v[36:39],v[204:207]
v_mfma_f32_16x16x32_bf16 v[200:203],v[228:231],v[32:35],v[200:203]
ds_read_b64_tr_b16 v[24:25],v10 offset:8192
ds_read_b64_tr_b16 v[26:27],v10 offset:10240
s_waitcnt lgkmcnt(8)
v_mfma_f32_16x16x32_bf16 v[208:211],v[232:235],v[32:35],v[208:211]
ds_read_b64_tr_b16 v[28:29],v11 offset:8192
v_mfma_f32_16x16x32_bf16 v[212:215],v[232:235],v[36:39],v[212:215]
ds_read_b64_tr_b16 v[30:31],v11 offset:10240
s_waitcnt lgkmcnt(8)
v_mfma_f32_16x16x32_bf16 v[220:223],v[236:239],v[36:39],v[220:223]
v_mfma_f32_16x16x32_bf16 v[216:219],v[236:239],v[32:35],v[216:219]
s_waitcnt vmcnt(0)
v_mov_b32 v4,s96
s_mov_b64 exec,1
buffer_store_dword v4,off,s[8:11],s38 sc1
s_mov_b64 exec,-1
s_branch L_p3_j
L_p3_spin:
s_mov_b32 s32,0
L_p3_spin_loop:
buffer_load_dword v244,v254,s[8:11],0 offen sc1
s_add_u32 s32,s32,1
s_waitcnt vmcnt(0)
v_cmp_ne_u32 vcc,s96,v244
s_and_b32 s4,vcc_lo,0xf0f0f0f
s_cbranch_scc0 L_p3_spin_back
s_sleep 4
s_cmp_lt_u32 s32,300
s_cbranch_scc1 L_p3_spin_loop
s_mov_b32 s7,1
s_branch L_p3_spin_back
L_p3_cspin:
s_mov_b32 s32,0
L_p3_cspin_loop:
buffer_load_dword v244,v254,s[8:11],0 offen sc1
s_add_u32 s32,s32,1
s_waitcnt vmcnt(0)
v_cmp_ne_u32 vcc,s96,v244
s_and_b32 s4,vcc_lo,0xf0f0f0f
s_cbranch_scc0 L_p3_cspin_back
s_sleep 4
s_cmp_lt_u32 s32,300
s_cbranch_scc1 L_p3_cspin_loop
s_mov_b32 s7,1
s_branch L_p3_cspin_back
L_p3_mspin:
s_mov_b32 s32,0
L_p3_mspin_loop:
buffer_load_dword v244,v254,s[8:11],0 offen sc1
s_add_u32 s32,s32,1
s_waitcnt vmcnt(0)
v_cmp_ne_u32 vcc,s96,v244
s_and_b32 s4,vcc_lo,0xf0f0f0f
s_cbranch_scc0 L_p3_mspin_back
s_sleep 4
s_cmp_lt_u32 s32,300
s_cbranch_scc1 L_p3_mspin_loop
s_mov_b32 s7,1
s_branch L_p3_mspin_back
L_p3_ospina:
s_mov_b32 s32,0
L_p3_ospina_loop:
buffer_load_dword v244,v254,s[8:11],0 offen sc1
s_add_u32 s32,s32,1
s_waitcnt vmcnt(0)
v_cmp_ne_u32 vcc,s96,v244
s_and_b32 s4,vcc_lo,0xf0f0f0f0
s_cbranch_scc0 L_p3_ospina_back
s_sleep 4
s_cmp_lt_u32 s32,300
s_cbranch_scc1 L_p3_ospina_loop
s_mov_b32 s7,1
s_branch L_p3_ospina_back
L_p3_ospinb:
s_mov_b32 s32,0
L_p3_ospinb_loop:
buffer_load_dword v244,v254,s[8:11],0 offen sc1
s_add_u32 s32,s32,1
s_waitcnt vmcnt(0)
v_cmp_ne_u32 vcc,s96,v244
s_and_b32 s4,vcc_lo,0xf0f0f0f0
s_cbranch_scc0 L_p3_ospinb_back
s_sleep 4
s_cmp_lt_u32 s32,300
s_cbranch_scc1 L_p3_ospinb_loop
s_mov_b32 s7,1
s_branch L_p3_ospinb_back
L_p3_nost:
s_cmp_ge_u32 s101,1200
s_cbranch_scc1 L_p3_st
s_branch L_p3_std
L_p3_xspin:
ds_read_b32 v6,v7
s_mov_b32 s32,0
s_mov_b32 s4,4096
s_waitcnt lgkmcnt(0)
v_cmp_ne_u32 vcc,0,v6
s_cbranch_vccz L_p3_xfl
s_cmp_lt_u32 s101,1200
s_cbranch_scc1 L_p3_xpub
L_p3_xfl:
v_mov_b32 v4,s96
s_mov_b64 exec,1
buffer_store_dword v4,off,s[8:11],s59 sc1
s_mov_b64 exec,-1
s_mov_b32 s4,2048
s_cmp_lg_u32 s99,s2
s_cbranch_scc1 L_p3_xpub
L_p3_xspin_loop:
buffer_load_dword v6,v253,s[8:11],0 offen sc1
s_add_u32 s32,s32,1
s_waitcnt vmcnt(0)
v_cmp_eq_u32 vcc,s96,v6
s_or_b32 s4,vcc_lo,1
s_and_b32 s4,s4,0xff
s_cmp_lt_u32 s32,300
s_cbranch_scc1 L_p3_xpub
s_cmp_eq_u32 s4,0xff
s_cbranch_scc1 L_p3_xpub
s_ff0_i32_b32 s4,s4
s_add_u32 s4,s4,32
s_lshl_b32 s4,s4,8
s_cmp_ge_u32 s101,1200
s_cselect_b32 s4,0xff,s4
L_p3_xpub:
v_mov_b32 v4,s4
ds_write_b32 v7,v4 offset:64
s_waitcnt lgkmcnt(0)
s_branch L_p3_xn
L_p3_xmore:
s_cmp_gt_u32 s54,0xff
s_cbranch_scc1 L_help3
s_sleep 1
s_cmp_eq_u32 s16,0
s_cbranch_scc1 L_p3_xspin_loop
s_branch L_p3_xw
L_help3:
s_lshr_b32 s4,s4,8
s_cmp_eq_u32 s4,16
s_cbranch_scc1 L_help2
s_cmp_eq_u32 s4,8
s_cbranch_scc1 L_help3_own
s_and_b32 s4,s4,7
s_xor_b32 s99,s2,s4
s_add_u32 s101,s101,1
s_branch L_p3_cold
L_help3_own:
s_mov_b32 s99,s2
L_p3_cold:
s_waitcnt vmcnt(0) lgkmcnt(0)
s_barrier
s_mov_b32 s7,0
s_and_b32 s26,s99,7
s_lshl_b32 s33,s26,19
s_bfe_u32 s27,s99,0x20003
s_mul_i32 s27,s27,131328
s_add_u32 s33,s33,s27
s_and_b32 s27,s16,3
s_lshl_b32 s27,s27,15
s_add_u32 s33,s33,s27
s_lshl_b32 s26,s26,4
v_and_b32 v254,3,v1
v_lshl_add_u32 v254,v254,2,s26
s_lshr_b32 s6,s99,5
s_lshl_b32 s6,s6,2
s_add_u32 s6,s6,s16
s_sub_u32 s27,67,s6
s_cmp_lt_u32 s16,4
s_cselect_b32 s6,s6,s27
s_lshl_b32 s26,s6,7
s_add_u32 s26,s26,101789696
v_add_u32 v254,s26,v254
s_sub_u32 s27,63,s6
s_min_u32 s27,s27,s6
s_lshr_b32 s27,s27,1
s_lshl_b32 s27,s27,7
s_add_u32 s27,s27,101797888
s_sub_u32 s27,s27,s26
v_bfe_u32 v12,v1,2,1
v_mad_u32_u24 v254,v12,s27,v254
v_lshrrev_b32 v255,4,v1
v_lshlrev_b32 v12,2,v255
v_and_b32 v13,15,v1
v_xor_b32 v12,v12,v13
v_lshlrev_b32 v12,4,v12
v_lshl_add_u32 v255,v255,10,v12
s_load_dwordx2 s[40:41],s[0:1],80
s_load_dwordx2 s[44:45],s[0:1],64
s_lshl_b32 s57,s18,2
s_lshr_b32 s57,0x30241302,s57
s_and_b32 s57,s57,7
s_lshl_b32 s48,s57,15
s_and_b32 s53,s99,7
s_lshl_b32 s58,s53,5
v_xor_b32 v3,s58,v247
s_add_u32 s49,s48,32768
s_cmp_eq_u32 s49,163840
s_cselect_b32 s49,0,s49
s_add_u32 s50,s49,32768
s_cmp_eq_u32 s50,163840
s_cselect_b32 s50,0,s50
s_add_u32 s51,s50,32768
s_cmp_eq_u32 s51,163840
s_cselect_b32 s51,0,s51
s_add_u32 s52,s51,32768
s_cmp_eq_u32 s52,163840
s_cselect_b32 s52,0,s52
s_mul_i32 s54,s6,294912
s_add_u32 s54,s54,67108864
s_lshl_b32 s58,s53,12
s_add_u32 s55,s54,s58
s_add_u32 s55,s55,262144
s_lshl_b32 s58,s53,15
s_add_u32 s54,s54,s58
s_bfe_u32 s57,s99,0x20003
s_lshl_b32 s58,s57,13
s_add_u32 s54,s54,s58
s_lshl_b32 s60,s6,15
s_lshl_b32 s57,s57,8
s_add_u32 s60,s60,s57
s_lshl_b32 s58,s53,5
s_add_u32 s60,s60,s58
v_and_b32 v12,7,v1
v_lshlrev_b32 v7,2,v12
s_lshr_b32 s59,s99,3
s_lshl_b32 s59,s59,6
s_add_u32 s59,s59,s53
s_lshl_b32 s59,s59,2
v_xor_b32 v253,s59,v7
v_add_u32 v253,101777536,v253
v_add_u32 v7,s52,v7
v_lshrrev_b32 v13,5,v1
v_lshlrev_b32 v13,4,v13
v_and_b32 v252,31,v1
v_lshl_add_u32 v252,v252,10,v13
s_add_u32 s59,s59,101777536
s_lshl_b32 s56,s99,16
s_lshl_b32 s58,s16,10
s_add_u32 s56,s56,s58
s_mov_b32 s42,2097152
s_mov_b32 s43,0x20000
s_mov_b32 s46,524288
s_mov_b32 s47,0x20000
s_mov_b32 s24,s48
s_add_u32 s29,s22,1
s_cmp_ge_u32 s16,4
s_cbranch_scc1 L_p3_cold1
s_call_b64 s[34:35],L_lda
s_call_b64 s[34:35],L_lda
s_call_b64 s[34:35],L_lda
s_call_b64 s[34:35],L_lda
s_lshl_b32 s57,s16,12
s_add_u32 s57,s57,s52
s_add_u32 m0,s57,16384
s_lshl_b32 s57,s53,2
s_add_u32 s57,s57,s16
s_lshl_b32 s57,s57,14
s_and_b32 s58,s33,0x3ff
s_add_u32 s57,s57,s58
s_and_b32 s58,s16,1
s_lshl_b32 s58,s58,5
v_xor_b32 v255,s58,v255
s_waitcnt lgkmcnt(0)
buffer_load_dwordx4 v255,s[44:47],s57 offen lds
s_add_u32 m0,m0,1024
s_add_u32 s57,s57,4096
buffer_load_dwordx4 v255,s[44:47],s57 offen lds
s_add_u32 m0,m0,1024
s_add_u32 s57,s57,4096
buffer_load_dwordx4 v255,s[44:47],s57 offen lds
s_add_u32 m0,m0,1024
s_add_u32 s57,s57,4096
buffer_load_dwordx4 v255,s[44:47],s57 offen lds
v_xor_b32 v255,s58,v255
L_p3_cold1:
s_branch L_p3_cspin
L_p3_cspin_back:
s_xor_b32 s58,s54,0
buffer_load_dwordx4 v[64:67],v246,s[8:11],s58 offen offset:0 sc1
buffer_load_dwordx4 v[68:71],v246,s[8:11],s58 offen offset:256 sc1
buffer_load_dwordx4 v[80:83],v246,s[8:11],s58 offen offset:2048 sc1
buffer_load_dwordx4 v[84:87],v246,s[8:11],s58 offen offset:2304 sc1
s_xor_b32 s58,s54,4096
buffer_load_dwordx4 v[96:99],v246,s[8:11],s58 offen offset:0 sc1
buffer_load_dwordx4 v[100:103],v246,s[8:11],s58 offen offset:256 sc1
buffer_load_dwordx4 v[112:115],v246,s[8:11],s58 offen offset:2048 sc1
buffer_load_dwordx4 v[116:119],v246,s[8:11],s58 offen offset:2304 sc1
s_waitcnt vmcnt(0)
s_barrier
s_branch L_p3_join
L_p3_foreign:
s_waitcnt vmcnt(0)
v_mov_b32 v4,s96
s_mov_b64 exec,1
buffer_store_dword v4,off,s[8:11],s38 sc1
s_mov_b64 exec,-1
L_help2:
s_waitcnt vmcnt(0) lgkmcnt(0)
s_barrier
s_add_u32 s101,s101,1
s_mov_b32 s7,0
s_mov_b32 s99,s2
v_mov_b32 v14,0
s_cmp_lg_u32 s16,0
s_cbranch_scc1 L_help2_w
s_mov_b32 s5,0
v_lshlrev_b32 v16,2,v1
v_add_u32 v16,101789696,v16
L_help2_scan:
s_lshl_b32 s4,s5,8
buffer_load_dword v15,v16,s[8:11],s4 offen sc1
s_waitcnt vmcnt(0)
v_cmp_ne_u32 vcc,s96,v15
s_cbranch_vccnz L_help2_found
s_add_u32 s5,s5,1
s_cmp_lt_u32 s5,40
s_cbranch_scc1 L_help2_scan
s_mov_b32 s4,256
s_branch L_help2_pub
L_help2_found:
s_ff1_i32_b64 s4,vcc
s_and_b32 s4,s4,31
s_sub_u32 s6,31,s5
s_min_u32 s6,s5,s6
s_lshr_b32 s6,s6,1
s_cmp_lt_u32 s5,32
s_cselect_b32 s5,s6,s5
s_and_b32 s5,s5,7
s_lshl_b32 s5,s5,5
s_and_b32 s6,s4,3
s_lshl_b32 s6,s6,3
s_add_u32 s5,s5,s6
s_lshr_b32 s4,s4,2
s_add_u32 s4,s4,s5
L_help2_pub:
v_mov_b32 v15,s4
ds_write_b32 v14,v15
s_waitcnt lgkmcnt(0)
L_help2_w:
s_barrier
ds_read_b32 v15,v14
s_waitcnt lgkmcnt(0)
v_readfirstlane_b32 s98,v15
s_barrier
s_cmp_ge_u32 s101,1200
s_cselect_b32 s98,256,s98
s_cmp_lt_u32 s98,256
s_cbranch_scc1 L_help
s_mov_b32 s98,s2
s_branch L_p3_cold
L_k2_setaba:
v_mov_b32 v15,1
ds_write_b32 v14,v15
s_waitcnt lgkmcnt(0)
s_branch L_k2_setab_backa
L_k2_setabb:
v_mov_b32 v15,1
ds_write_b32 v14,v15
s_waitcnt lgkmcnt(0)
s_branch L_k2_setab_backb
L_k2_abort:
s_cmp_ge_u32 s101,1200
s_cbranch_scc1 L_k2_abort_back
s_branch L_help
L_help_done:
s_waitcnt vmcnt(0)
s_barrier
s_cmp_lg_u32 s50,0
s_cbranch_scc1 L_sig4
s_and_b32 s4,s3,7
s_lshl_b32 s4,s4,2
s_bfe_u32 s5,s3,0x20003
s_add_u32 s4,s4,s5
v_lshlrev_b32 v18,8,v1
v_mov_b32 v15,s96
s_cmp_lt_u32 s4,26
s_cselect_b32 s5,8,5
s_lshl_b32 s4,s4,s5
s_cmp_eq_u32 s5,8
s_cselect_b32 s5,0,7360
s_cselect_b64 exec,1,0xff
s_add_u32 s4,s4,s5
s_add_u32 s4,s4,101777408
s_lshr_b32 s5,s3,5
s_lshl_b32 s5,s5,2
s_add_u32 s4,s4,s5
buffer_store_dword v15,v18,s[40:43],s4 offen sc1
s_mov_b64 exec,-1
L_sig4:
L_help:
s_waitcnt vmcnt(0) lgkmcnt(0)
s_barrier
s_add_u32 s101,s101,1
v_and_b32 v1,63,v0
v_lshrrev_b32 v16,6,v0
v_mov_b32 v14,0
v_readfirstlane_b32 s16,v16
s_load_dwordx2 s[8:9],s[0:1],96
s_mov_b32 s10,268435456
s_mov_b32 s11,0x20000
s_cmp_lg_u32 s16,0
s_cbranch_scc1 L_help_w
s_mov_b32 s5,0
s_waitcnt lgkmcnt(0)
L_help_scan:
v_lshrrev_b32 v16,3,v1
v_add_u32 v16,s5,v16
v_lshlrev_b32 v17,8,v16
v_add_u32 v17,101777408,v17
v_lshlrev_b32 v18,5,v16
v_add_u32 v18,101784768,v18
v_cmp_gt_u32 vcc,26,v16
v_and_b32 v16,7,v1
s_nop 1
v_cndmask_b32 v17,v18,v17,vcc
v_lshl_add_u32 v4,v16,2,v17
buffer_load_dword v15,v4,s[8:11],0 offen sc1
s_waitcnt vmcnt(0)
v_cmp_ne_u32 vcc,s96,v15
s_cbranch_vccnz L_help_found
s_add_u32 s5,s5,8
s_cmp_lt_u32 s5,32
s_cbranch_scc1 L_help_scan
s_mov_b32 s4,256
s_branch L_help_pub
L_help_found:
s_ff1_i32_b64 s4,vcc
s_lshr_b32 s6,s4,3
s_add_u32 s5,s5,s6
s_and_b32 s4,s4,7
s_lshl_b32 s4,s4,5
s_and_b32 s6,s5,3
s_lshl_b32 s6,s6,3
s_add_u32 s4,s4,s6
s_lshr_b32 s5,s5,2
s_add_u32 s4,s4,s5
L_help_pub:
v_mov_b32 v15,s4
ds_write_b32 v14,v15
s_waitcnt lgkmcnt(0)
L_help_w:
s_barrier
ds_read_b32 v15,v14
s_waitcnt lgkmcnt(0)
v_readfirstlane_b32 s3,v15
s_barrier
s_cmp_ge_u32 s101,1200
s_cselect_b32 s3,256,s3
s_cmp_lt_u32 s3,256
s_cbranch_scc1 L_k1_tramp
s_mov_b32 s3,s2
s_mov_b32 s7,0
s_load_dwordx2 s[8:9],s[0:1],16
s_load_dwordx2 s[14:15],s[0:1],40
s_load_dwordx2 s[40:41],s[0:1],96
s_mov_b32 s50,s16
s_waitcnt lgkmcnt(0)
s_mov_b64 s[76:77],s[8:9]
s_mov_b32 s78,4194304
s_mov_b32 s79,0x20000
s_mov_b64 s[8:9],s[40:41]
s_mov_b32 s10,268435456
s_mov_b32 s11,0x20000
s_mov_b64 s[12:13],s[14:15]
s_mov_b32 s14,4194304
s_mov_b32 s15,0x20000
s_mov_b32 s16,s50
s_and_b32 s26,s98,7
s_lshr_b32 s27,s98,3
s_and_b32 s17,s27,3
s_lshl_b32 s26,s26,2
s_add_u32 s17,s17,s26
s_lshr_b32 s18,s27,2
s_lshl_b32 s26,s18,2
s_add_u32 s19,s26,s16
s_sub_u32 s27,67,s19
s_cmp_lt_u32 s16,4
s_cselect_b32 s19,s19,s27
s_cselect_b32 s28,1,0
s_mov_b32 s37,s18
s_lshl_b32 s39,s16,11
s_lshl_b32 s29,s16,16
s_lshl_b32 s26,s17,8
s_add_u32 s29,s29,s26
s_lshl_b32 s24,s19,15
s_add_u32 s24,s24,41943040
v_lshrrev_b32 v20,4,v1
v_lshlrev_b32 v21,2,v20
v_and_b32 v10,15,v1
v_xor_b32 v10,v10,v21
s_and_b32 s26,s16,1
s_lshl_b32 s26,s26,1
v_xor_b32 v10,s26,v10
v_lshlrev_b32 v10,4,v10
v_lshl_add_u32 v10,v20,13,v10
v_lshlrev_b32 v2,4,v1
s_add_u32 s26,s37,0
s_and_b32 s26,s26,7
s_lshl_b32 s80,s26,19
s_add_u32 s80,s80,s29
s_lshl_b32 s26,s26,12
s_add_u32 s88,s26,s24
s_add_u32 s26,s37,1
s_and_b32 s26,s26,7
s_lshl_b32 s81,s26,19
s_add_u32 s81,s81,s29
s_lshl_b32 s26,s26,12
s_add_u32 s89,s26,s24
s_add_u32 s26,s37,2
s_and_b32 s26,s26,7
s_lshl_b32 s82,s26,19
s_add_u32 s82,s82,s29
s_lshl_b32 s26,s26,12
s_add_u32 s90,s26,s24
s_add_u32 s26,s37,3
s_and_b32 s26,s26,7
s_lshl_b32 s83,s26,19
s_add_u32 s83,s83,s29
s_lshl_b32 s26,s26,12
s_add_u32 s91,s26,s24
s_add_u32 s26,s37,4
s_and_b32 s26,s26,7
s_lshl_b32 s84,s26,19
s_add_u32 s84,s84,s29
s_lshl_b32 s26,s26,12
s_add_u32 s92,s26,s24
s_add_u32 s26,s37,5
s_and_b32 s26,s26,7
s_lshl_b32 s85,s26,19
s_add_u32 s85,s85,s29
s_lshl_b32 s26,s26,12
s_add_u32 s93,s26,s24
s_add_u32 s26,s37,6
s_and_b32 s26,s26,7
s_lshl_b32 s86,s26,19
s_add_u32 s86,s86,s29
s_lshl_b32 s26,s26,12
s_add_u32 s94,s26,s24
s_add_u32 s26,s37,7
s_and_b32 s26,s26,7
s_lshl_b32 s87,s26,19
s_add_u32 s87,s87,s29
s_lshl_b32 s26,s26,12
s_add_u32 s95,s26,s24
s_lshl_b32 s26,s18,1
s_sub_u32 s22,31,s26
s_lshl_b32 s36,s17,20
s_mov_b64 s[72:73],s[40:41]
s_mov_b32 s74,268435456
s_mov_b32 s75,0x20000
s_mov_b32 s29,0
s_mov_b32 s24,0
s_lshl_b32 s26,s16,13
s_add_u32 s25,s36,s26
s_add_u32 s25,s25,16384
s_mov_b32 s23,32768
s_mov_b32 s21,0
s_sub_u32 s20,s19,1
s_max_i32 s20,s20,0
s_add_u32 m0,s39,0
s_add_u32 s26,s80,0
buffer_load_dwordx4 v10,s[76:79],s26 offen lds
s_add_u32 m0,s39,1024
s_add_u32 s26,s80,32768
buffer_load_dwordx4 v10,s[76:79],s26 offen lds
s_add_u32 m0,s39,16384
s_add_u32 s26,s81,0
buffer_load_dwordx4 v10,s[76:79],s26 offen lds
s_add_u32 m0,s39,17408
s_add_u32 s26,s81,32768
buffer_load_dwordx4 v10,s[76:79],s26 offen lds
s_add_u32 m0,s39,32768
s_add_u32 s26,s82,0
buffer_load_dwordx4 v10,s[76:79],s26 offen lds
s_add_u32 m0,s39,33792
s_add_u32 s26,s82,32768
buffer_load_dwordx4 v10,s[76:79],s26 offen lds
s_add_u32 m0,s39,49152
s_add_u32 s26,s83,0
buffer_load_dwordx4 v10,s[76:79],s26 offen lds
s_add_u32 m0,s39,50176
s_add_u32 s26,s83,32768
buffer_load_dwordx4 v10,s[76:79],s26 offen lds
buffer_load_dwordx4 v[24:27],v2,s[8:11],s88 offen offset:0 sc1
buffer_load_dwordx4 v[28:31],v2,s[8:11],s88 offen offset:1024 sc1
buffer_load_dwordx4 v[32:35],v2,s[8:11],s88 offen offset:2048 sc1
buffer_load_dwordx4 v[36:39],v2,s[8:11],s88 offen offset:3072 sc1
buffer_load_dwordx4 v[48:51],v2,s[8:11],s89 offen offset:0 sc1
buffer_load_dwordx4 v[52:55],v2,s[8:11],s89 offen offset:1024 sc1
buffer_load_dwordx4 v[56:59],v2,s[8:11],s89 offen offset:2048 sc1
buffer_load_dwordx4 v[60:63],v2,s[8:11],s89 offen offset:3072 sc1
s_waitcnt vmcnt(0)
s_branch L_k2_late
L_lda_st6:
s_call_b64 s[34:35],L_lda
s_branch L_lda_bk6
L_lda_st11:
s_call_b64 s[34:35],L_lda
s_branch L_lda_bk11
L_lda_st15:
s_call_b64 s[34:35],L_lda
s_branch L_lda_bk15
L_lda_st16:
s_call_b64 s[34:35],L_lda
s_branch L_lda_bk16
L_lda_st17:
s_call_b64 s[34:35],L_lda
s_branch L_lda_bk17
L_lda_st18:
s_call_b64 s[34:35],L_lda
s_branch L_lda_bk18
L_lda_st19:
s_call_b64 s[34:35],L_lda
s_branch L_lda_bk19
L_lda_st20:
s_call_b64 s[34:35],L_lda
s_branch L_lda_bk20
L_lda_st21:
s_call_b64 s[34:35],L_lda
s_branch L_lda_bk21
L_lda_st22:
s_call_b64 s[34:35],L_lda
s_branch L_lda_bk22
L_lda:
s_lshl_b32 s26,s16,13
s_add_u32 m0,s24,s26
s_sub_u32 s27,s29,s22
s_sub_u32 s27,s27,1
s_lshl_b32 s27,s27,17
s_xor_b32 s27,s27,s33
buffer_load_dwordx4 v255,s[12:15],s27 offen lds
s_add_u32 m0,m0,1024
s_add_u32 s27,s27,4096
buffer_load_dwordx4 v255,s[12:15],s27 offen lds
s_add_u32 m0,m0,1024
s_add_u32 s27,s27,4096
buffer_load_dwordx4 v255,s[12:15],s27 offen lds
s_add_u32 m0,m0,1024
s_add_u32 s27,s27,4096
buffer_load_dwordx4 v255,s[12:15],s27 offen lds
s_add_u32 m0,m0,1024
s_add_u32 s27,s27,4096
v_xor_b32 v255,32,v255
buffer_load_dwordx4 v255,s[12:15],s27 offen lds
s_add_u32 m0,m0,1024
s_add_u32 s27,s27,4096
buffer_load_dwordx4 v255,s[12:15],s27 offen lds
s_add_u32 m0,m0,1024
s_add_u32 s27,s27,4096
buffer_load_dwordx4 v255,s[12:15],s27 offen lds
s_add_u32 m0,m0,1024
s_add_u32 s27,s27,4096
buffer_load_dwordx4 v255,s[12:15],s27 offen lds
v_xor_b32 v255,32,v255
s_add_u32 s29,s29,1
s_add_u32 s24,s24,32768
s_cmp_eq_u32 s24,163840
s_cselect_b32 s24,0,s24
s_setpc_b64 s[34:35]
L_k2_stub7:
s_call_b64 s[34:35],L_k2_slow1
s_branch L_k2_back7
L_k2_stub8:
s_call_b64 s[34:35],L_k2_slow0
s_branch L_k2_back8
L_k2_stub9:
s_call_b64 s[34:35],L_k2_slow1
s_branch L_k2_back9
L_k2_stub10:
s_call_b64 s[34:35],L_k2_slow0
s_branch L_k2_back10
L_k2_stub12:
s_call_b64 s[34:35],L_k2_slow1
s_branch L_k2_back12
L_k2_stub13:
s_call_b64 s[34:35],L_k2_slow0
s_branch L_k2_back13
L_k2_slow0:
s_nop 15
v_log_f32 v12,v7
v_max3_f32 v10,v128,v129,v130
v_max3_f32 v10,v10,v131,v132
v_max3_f32 v10,v10,v133,v134
v_max3_f32 v10,v10,v135,v136
v_max3_f32 v10,v10,v137,v138
v_max3_f32 v10,v10,v139,v140
v_max3_f32 v10,v10,v141,v142
v_max_f32 v10,v10,v143
v_max3_f32 v10,v10,v12,0
v_mov_b32 v11,v10
s_nop 1
v_permlane32_swap_b32 v10,v11
v_max_f32 v10,v10,v11
v_exp_f32 v12,-v10
v_sub_f32 v160,v160,v10
v_sub_f32 v128,v128,v10
v_sub_f32 v144,v144,v10
v_sub_f32 v161,v161,v10
v_sub_f32 v129,v129,v10
v_sub_f32 v145,v145,v10
v_sub_f32 v162,v162,v10
v_sub_f32 v130,v130,v10
v_sub_f32 v146,v146,v10
v_sub_f32 v163,v163,v10
v_sub_f32 v131,v131,v10
v_sub_f32 v147,v147,v10
v_sub_f32 v164,v164,v10
v_sub_f32 v132,v132,v10
v_sub_f32 v148,v148,v10
v_sub_f32 v165,v165,v10
v_sub_f32 v133,v133,v10
v_sub_f32 v149,v149,v10
v_sub_f32 v166,v166,v10
v_sub_f32 v134,v134,v10
v_sub_f32 v150,v150,v10
v_sub_f32 v167,v167,v10
v_sub_f32 v135,v135,v10
v_sub_f32 v151,v151,v10
v_sub_f32 v168,v168,v10
v_sub_f32 v136,v136,v10
v_sub_f32 v152,v152,v10
v_sub_f32 v169,v169,v10
v_sub_f32 v137,v137,v10
v_sub_f32 v153,v153,v10
v_sub_f32 v170,v170,v10
v_sub_f32 v138,v138,v10
v_sub_f32 v154,v154,v10
v_sub_f32 v171,v171,v10
v_sub_f32 v139,v139,v10
v_sub_f32 v155,v155,v10
v_sub_f32 v172,v172,v10
v_sub_f32 v140,v140,v10
v_sub_f32 v156,v156,v10
v_sub_f32 v173,v173,v10
v_sub_f32 v141,v141,v10
v_sub_f32 v157,v157,v10
v_sub_f32 v174,v174,v10
v_sub_f32 v142,v142,v10
v_sub_f32 v158,v158,v10
v_sub_f32 v175,v175,v10
v_sub_f32 v143,v143,v10
v_sub_f32 v159,v159,v10
v_mul_f32 v7,v7,v12
v_mul_f32 v64,v64,v12
v_mul_f32 v65,v65,v12
v_mul_f32 v66,v66,v12
v_mul_f32 v67,v67,v12
v_mul_f32 v68,v68,v12
v_mul_f32 v69,v69,v12
v_mul_f32 v70,v70,v12
v_mul_f32 v71,v71,v12
v_mul_f32 v72,v72,v12
v_mul_f32 v73,v73,v12
v_mul_f32 v74,v74,v12
v_mul_f32 v75,v75,v12
v_mul_f32 v76,v76,v12
v_mul_f32 v77,v77,v12
v_mul_f32 v78,v78,v12
v_mul_f32 v79,v79,v12
v_mul_f32 v80,v80,v12
v_mul_f32 v81,v81,v12
v_mul_f32 v82,v82,v12
v_mul_f32 v83,v83,v12
v_mul_f32 v84,v84,v12
v_mul_f32 v85,v85,v12
v_mul_f32 v86,v86,v12
v_mul_f32 v87,v87,v12
v_mul_f32 v88,v88,v12
v_mul_f32 v89,v89,v12
v_mul_f32 v90,v90,v12
v_mul_f32 v91,v91,v12
v_mul_f32 v92,v92,v12
v_mul_f32 v93,v93,v12
v_mul_f32 v94,v94,v12
v_mul_f32 v95,v95,v12
v_mul_f32 v96,v96,v12
v_mul_f32 v97,v97,v12
v_mul_f32 v98,v98,v12
v_mul_f32 v99,v99,v12
v_mul_f32 v100,v100,v12
v_mul_f32 v101,v101,v12
v_mul_f32 v102,v102,v12
v_mul_f32 v103,v103,v12
v_mul_f32 v104,v104,v12
v_mul_f32 v105,v105,v12
v_mul_f32 v106,v106,v12
v_mul_f32 v107,v107,v12
v_mul_f32 v108,v108,v12
v_mul_f32 v109,v109,v12
v_mul_f32 v110,v110,v12
v_mul_f32 v111,v111,v12
v_mul_f32 v112,v112,v12
v_mul_f32 v113,v113,v12
v_mul_f32 v114,v114,v12
v_mul_f32 v115,v115,v12
v_mul_f32 v116,v116,v12
v_mul_f32 v117,v117,v12
v_mul_f32 v118,v118,v12
v_mul_f32 v119,v119,v12
v_mul_f32 v120,v120,v12
v_mul_f32 v121,v121,v12
v_mul_f32 v122,v122,v12
v_mul_f32 v123,v123,v12
v_mul_f32 v124,v124,v12
v_mul_f32 v125,v125,v12
v_mul_f32 v126,v126,v12
v_mul_f32 v127,v127,v12
v_exp_f32 v16,v128
v_exp_f32 v17,v129
v_add_f32 v6,v7,v16
v_exp_f32 v18,v130
v_add_f32 v6,v6,v17
v_cvt_pk_bf16_f32 v176,v16,v17
v_exp_f32 v19,v131
v_add_f32 v6,v6,v18
v_exp_f32 v20,v132
v_add_f32 v6,v6,v19
v_cvt_pk_bf16_f32 v177,v18,v19
v_exp_f32 v21,v133
v_add_f32 v6,v6,v20
v_exp_f32 v22,v134
v_add_f32 v6,v6,v21
v_cvt_pk_bf16_f32 v178,v20,v21
v_exp_f32 v23,v135
v_add_f32 v6,v6,v22
v_exp_f32 v16,v136
v_add_f32 v6,v6,v23
v_cvt_pk_bf16_f32 v179,v22,v23
v_exp_f32 v17,v137
v_add_f32 v6,v6,v16
v_exp_f32 v18,v138
v_add_f32 v6,v6,v17
v_cvt_pk_bf16_f32 v180,v16,v17
v_exp_f32 v19,v139
v_add_f32 v6,v6,v18
v_exp_f32 v20,v140
v_add_f32 v6,v6,v19
v_cvt_pk_bf16_f32 v181,v18,v19
v_exp_f32 v21,v141
v_add_f32 v6,v6,v20
v_exp_f32 v22,v142
v_add_f32 v6,v6,v21
v_cvt_pk_bf16_f32 v182,v20,v21
v_exp_f32 v23,v143
v_add_f32 v6,v6,v22
v_add_f32 v6,v6,v23
v_cvt_pk_bf16_f32 v183,v22,v23
v_cmp_nle_f32 vcc,v6,v13
s_nop 1
s_setpc_b64 s[34:35]
L_k2_slow1:
s_nop 15
v_log_f32 v12,v6
v_max3_f32 v10,v144,v145,v146
v_max3_f32 v10,v10,v147,v148
v_max3_f32 v10,v10,v149,v150
v_max3_f32 v10,v10,v151,v152
v_max3_f32 v10,v10,v153,v154
v_max3_f32 v10,v10,v155,v156
v_max3_f32 v10,v10,v157,v158
v_max_f32 v10,v10,v159
v_max3_f32 v10,v10,v12,0
v_mov_b32 v11,v10
s_nop 1
v_permlane32_swap_b32 v10,v11
v_max_f32 v10,v10,v11
v_exp_f32 v12,-v10
v_sub_f32 v160,v160,v10
v_sub_f32 v144,v144,v10
v_sub_f32 v128,v128,v10
v_sub_f32 v161,v161,v10
v_sub_f32 v145,v145,v10
v_sub_f32 v129,v129,v10
v_sub_f32 v162,v162,v10
v_sub_f32 v146,v146,v10
v_sub_f32 v130,v130,v10
v_sub_f32 v163,v163,v10
v_sub_f32 v147,v147,v10
v_sub_f32 v131,v131,v10
v_sub_f32 v164,v164,v10
v_sub_f32 v148,v148,v10
v_sub_f32 v132,v132,v10
v_sub_f32 v165,v165,v10
v_sub_f32 v149,v149,v10
v_sub_f32 v133,v133,v10
v_sub_f32 v166,v166,v10
v_sub_f32 v150,v150,v10
v_sub_f32 v134,v134,v10
v_sub_f32 v167,v167,v10
v_sub_f32 v151,v151,v10
v_sub_f32 v135,v135,v10
v_sub_f32 v168,v168,v10
v_sub_f32 v152,v152,v10
v_sub_f32 v136,v136,v10
v_sub_f32 v169,v169,v10
v_sub_f32 v153,v153,v10
v_sub_f32 v137,v137,v10
v_sub_f32 v170,v170,v10
v_sub_f32 v154,v154,v10
v_sub_f32 v138,v138,v10
v_sub_f32 v171,v171,v10
v_sub_f32 v155,v155,v10
v_sub_f32 v139,v139,v10
v_sub_f32 v172,v172,v10
v_sub_f32 v156,v156,v10
v_sub_f32 v140,v140,v10
v_sub_f32 v173,v173,v10
v_sub_f32 v157,v157,v10
v_sub_f32 v141,v141,v10
v_sub_f32 v174,v174,v10
v_sub_f32 v158,v158,v10
v_sub_f32 v142,v142,v10
v_sub_f32 v175,v175,v10
v_sub_f32 v159,v159,v10
v_sub_f32 v143,v143,v10
v_mul_f32 v6,v6,v12
v_mul_f32 v64,v64,v12
v_mul_f32 v65,v65,v12
v_mul_f32 v66,v66,v12
v_mul_f32 v67,v67,v12
v_mul_f32 v68,v68,v12
v_mul_f32 v69,v69,v12
v_mul_f32 v70,v70,v12
v_mul_f32 v71,v71,v12
v_mul_f32 v72,v72,v12
v_mul_f32 v73,v73,v12
v_mul_f32 v74,v74,v12
v_mul_f32 v75,v75,v12
v_mul_f32 v76,v76,v12
v_mul_f32 v77,v77,v12
v_mul_f32 v78,v78,v12
v_mul_f32 v79,v79,v12
v_mul_f32 v80,v80,v12
v_mul_f32 v81,v81,v12
v_mul_f32 v82,v82,v12
v_mul_f32 v83,v83,v12
v_mul_f32 v84,v84,v12
v_mul_f32 v85,v85,v12
v_mul_f32 v86,v86,v12
v_mul_f32 v87,v87,v12
v_mul_f32 v88,v88,v12
v_mul_f32 v89,v89,v12
v_mul_f32 v90,v90,v12
v_mul_f32 v91,v91,v12
v_mul_f32 v92,v92,v12
v_mul_f32 v93,v93,v12
v_mul_f32 v94,v94,v12
v_mul_f32 v95,v95,v12
v_mul_f32 v96,v96,v12
v_mul_f32 v97,v97,v12
v_mul_f32 v98,v98,v12
v_mul_f32 v99,v99,v12
v_mul_f32 v100,v100,v12
v_mul_f32 v101,v101,v12
v_mul_f32 v102,v102,v12
v_mul_f32 v103,v103,v12
v_mul_f32 v104,v104,v12
v_mul_f32 v105,v105,v12
v_mul_f32 v106,v106,v12
v_mul_f32 v107,v107,v12
v_mul_f32 v108,v108,v12
v_mul_f32 v109,v109,v12
v_mul_f32 v110,v110,v12
v_mul_f32 v111,v111,v12
v_mul_f32 v112,v112,v12
v_mul_f32 v113,v113,v12
v_mul_f32 v114,v114,v12
v_mul_f32 v115,v115,v12
v_mul_f32 v116,v116,v12
v_mul_f32 v117,v117,v12
v_mul_f32 v118,v118,v12
v_mul_f32 v119,v119,v12
v_mul_f32 v120,v120,v12
v_mul_f32 v121,v121,v12
v_mul_f32 v122,v122,v12
v_mul_f32 v123,v123,v12
v_mul_f32 v124,v124,v12
v_mul_f32 v125,v125,v12
v_mul_f32 v126,v126,v12
v_mul_f32 v127,v127,v12
v_exp_f32 v16,v144
v_exp_f32 v17,v145
v_add_f32 v7,v6,v16
v_exp_f32 v18,v146
v_add_f32 v7,v7,v17
v_cvt_pk_bf16_f32 v184,v16,v17
v_exp_f32 v19,v147
v_add_f32 v7,v7,v18
v_exp_f32 v20,v148
v_add_f32 v7,v7,v19
v_cvt_pk_bf16_f32 v185,v18,v19
v_exp_f32 v21,v149
v_add_f32 v7,v7,v20
v_exp_f32 v22,v150
v_add_f32 v7,v7,v21
v_cvt_pk_bf16_f32 v186,v20,v21
v_exp_f32 v23,v151
v_add_f32 v7,v7,v22
v_exp_f32 v16,v152
v_add_f32 v7,v7,v23
v_cvt_pk_bf16_f32 v187,v22,v23
v_exp_f32 v17,v153
v_add_f32 v7,v7,v16
v_exp_f32 v18,v154
v_add_f32 v7,v7,v17
v_cvt_pk_bf16_f32 v188,v16,v17
v_exp_f32 v19,v155
v_add_f32 v7,v7,v18
v_exp_f32 v20,v156
v_add_f32 v7,v7,v19
v_cvt_pk_bf16_f32 v189,v18,v19
v_exp_f32 v21,v157
v_add_f32 v7,v7,v20
v_exp_f32 v22,v158
v_add_f32 v7,v7,v21
v_cvt_pk_bf16_f32 v190,v20,v21
v_exp_f32 v23,v159
v_add_f32 v7,v7,v22
v_add_f32 v7,v7,v23
v_cvt_pk_bf16_f32 v191,v22,v23
v_cmp_nle_f32 vcc,v7,v13
s_nop 1
s_setpc_b64 s[34:35]
L_code_end:
.section .rodata,"a"
.p2align 6
.amdhsa_kernel fused_kernel
  .amdhsa_next_free_vgpr 256
  .amdhsa_next_free_sgpr 102
  .amdhsa_accum_offset 256
  .amdhsa_group_segment_fixed_size 0
  .amdhsa_kernarg_size 104
  .amdhsa_user_sgpr_count 2
  .amdhsa_user_sgpr_kernarg_segment_ptr 1
  .amdhsa_system_sgpr_workgroup_id_x 1
.end_amdhsa_kernel
```
